```python
import torch

def _softmax(x, axis=-1):
    return torch.softmax(x, dim=axis)

def _gelu(x):
    return torch.nn.functional.gelu(x, approximate='tanh')

def _silu(x):
    return torch.nn.functional.silu(x)

def _sigmoid(x):
    return torch.sigmoid(x)

def _layernorm(x, axis=-1, eps=1e-05):
    m = x.mean(dim=axis, keepdim=True)
    v = x.var(dim=axis, keepdim=True, unbiased=False)
    return (x - m) / torch.sqrt(v + eps)

def _scatter_add(tgt, idx, src, axis=0):
    return tgt.clone().index_add_(axis, idx, src)

def _segment_sum(src, seg, n):
    out = torch.zeros((n,) + src.shape[1:], dtype=src.dtype)
    return out.index_add_(0, seg, src)

def _pad(x, pw):
    flat = tuple((v for pair in reversed(pw) for v in pair))
    return torch.nn.functional.pad(x, flat)
kernel_name = 'gated_mix__compressed_kv_cla__memory_aug_recurrent_mem_tr__prompt'

def setup_inputs():

    _w = lambda a: (lambda t: t.to(torch.bfloat16) if t.is_floating_point() else t)(torch.as_tensor(a))

    def _A_setup():
        B, H, Sq, Sk, D, M = (1, 32, 2048, 2048, 128, 512)
        Dc = 4 * D
        return {'x': _w((lambda *s: torch.randn(*s, dtype=torch.bfloat16) * 0.05)(B, Sq, M)), 'c_kv': _w((lambda *s: torch.randn(*s, dtype=torch.bfloat16) * 0.8)(B, Sk, Dc)), 'w_q': _w((lambda *s: torch.randn(*s, dtype=torch.bfloat16) * 6.4)(M, H, D) * M ** (-0.5)), 'w_uk': _w((lambda *s: torch.randn(*s, dtype=torch.bfloat16) * 6.4)(Dc, H, D) * Dc ** (-0.5)), 'w_uv': _w((lambda *s: torch.randn(*s, dtype=torch.bfloat16) * 0.8)(Dc, H, D) * Dc ** (-0.5)), 'w_o': _w((lambda *s: torch.randn(*s, dtype=torch.bfloat16) * 0.8)(H, D, M) * (H * D) ** (-0.5))}
    _A_in = _A_setup()

    def _B_setup():
        B, S, Dm = (1, 2048, 512)
        H, Dh = (32, 128)
        M, seg = (8, 32)
        seg = min(seg, S)
        S = S // seg * seg
        return {'x': _w((lambda *s: torch.randn(*s, dtype=torch.bfloat16) * 0.05)(B, S, Dm)), 'mem0': _w((lambda *s: torch.randn(*s, dtype=torch.bfloat16) * 0.8)(B, M, Dm)), 'Wq': _w((lambda *s: torch.randn(*s, dtype=torch.bfloat16) * 3.2)(Dm, H, Dh) * Dm ** (-0.5)), 'Wk': _w((lambda *s: torch.randn(*s, dtype=torch.bfloat16) * 3.2)(Dm, H, Dh) * Dm ** (-0.5)), 'Wv': _w((lambda *s: torch.randn(*s, dtype=torch.bfloat16) * 0.8)(Dm, H, Dh) * Dm ** (-0.5)), 'Wo': _w((lambda *s: torch.randn(*s, dtype=torch.bfloat16) * 0.8)(H, Dh, Dm) * (H * Dh) ** (-0.5)), 'seg_len': seg}
    _B_in = _B_setup()
    return {'A_x': _A_in['x'], 'A_c_kv': _A_in['c_kv'], 'A_w_q': _A_in['w_q'], 'A_w_uk': _A_in['w_uk'], 'A_w_uv': _A_in['w_uv'], 'A_w_o': _A_in['w_o'], 'B_x': _B_in['x'], 'B_mem0': _B_in['mem0'], 'B_Wq': _B_in['Wq'], 'B_Wk': _B_in['Wk'], 'B_Wv': _B_in['Wv'], 'B_Wo': _B_in['Wo'], 'B_seg_len': _B_in['seg_len'], 'gate_w': _w((lambda *s: torch.randn(*s, dtype=torch.bfloat16) * 0.05)(512) * 16.0)}

def reference(A_x, A_c_kv, A_w_q, A_w_uk, A_w_uv, A_w_o, B_x, B_mem0, B_Wq, B_Wk, B_Wv, B_Wo, B_seg_len, gate_w):

    def _A_ref(x, c_kv, w_q, w_uk, w_uv, w_o):
        B, Sq, M = (x.shape[0], x.shape[1], x.shape[2])
        Sk = c_kv.shape[1]
        H, D = (w_q.shape[1], w_q.shape[2])
        q = torch.einsum('bqm,mhd->bhqd', x, w_q)
        k = torch.einsum('bkc,chd->bhkd', c_kv, w_uk)
        v = torch.einsum('bkc,chd->bhkd', c_kv, w_uv)
        scores = torch.einsum('bhqd,bhkd->bhqk', q, k) * D ** (-0.5)
        off = Sk - Sq
        qi = torch.arange(Sq)[:, None]
        kj = torch.arange(Sk)[None, :]
        cmask = kj <= qi + off
        scores = torch.where(cmask[None, None], scores, -1000000000.0)
        p = _softmax(scores, axis=-1)
        ctx = torch.einsum('bhqk,bhkd->bhqd', p, v)
        return torch.einsum('bhqd,hdm->bqm', ctx, w_o)

    def _B_ref(x, mem0, Wq, Wk, Wv, Wo, seg_len):
        B, S, Dm = x.shape
        H, Dh = (Wq.shape[1], Wq.shape[2])
        M = mem0.shape[1]
        scale = Dh ** (-0.5)
        n_seg = S // seg_len
        L = M + seg_len
        idx = torch.arange(L)
        mask = (idx[:, None] < M) | (idx[:, None] >= idx[None, :])
        mem = mem0
        outs = []
        for s in range(n_seg):
            xs = x[:, s * seg_len:(s + 1) * seg_len, :].clone()
            h = torch.concatenate([mem, xs], axis=1)
            q = torch.einsum('btd,dhe->bhte', h, Wq)
            k = torch.einsum('btd,dhe->bhte', h, Wk)
            v = torch.einsum('btd,dhe->bhte', h, Wv)
            scores = torch.einsum('bhqe,bhke->bhqk', q, k) * scale
            scores = torch.where(mask[None, None], scores, -1000000000.0)
            p = _softmax(scores, axis=-1)
            o = torch.einsum('bhqk,bhke->bhqe', p, v)
            o = torch.einsum('bhte,hed->btd', o, Wo)
            mem = o[:, :M, :].clone()
            outs.append(o[:, M:, :])
        return torch.concatenate(outs, axis=1)
    x = A_x
    g = _sigmoid((x * gate_w).sum(-1, keepdims=True))
    a = _A_ref(x, A_c_kv, A_w_q, A_w_uk, A_w_uv, A_w_o)
    b = _B_ref(x, B_mem0, B_Wq, B_Wk, B_Wv, B_Wo, B_seg_len)
    return g * a + (1 - g) * b
```

```asm
; @launch grid=(256,1,1) block=(256,1,1) lds=163840
.amdgcn_target "amdgcn-amd-amdhsa--gfx950"
.text
.globl gated_mix__compressed_kv_cla__memory_aug_recurrent_mem_tr__prompt_kernel
.p2align 8
.type gated_mix__compressed_kv_cla__memory_aug_recurrent_mem_tr__prompt_kernel,@function
gated_mix__compressed_kv_cla__memory_aug_recurrent_mem_tr__prompt_kernel:
  s_cmp_ge_u32 s2, 256
  s_cbranch_scc1 L_exit
  s_load_dwordx16 s[8:23], s[0:1], 0
  s_load_dwordx16 s[24:39], s[0:1], 64
  s_load_dwordx2 s[40:41], s[0:1], 128
  s_getreg_b32 s46, hwreg(HW_REG_XCC_ID, 0, 4)
  v_lshrrev_b32 v1, 6, v0
  v_and_b32 v0, 63, v0
  v_readfirstlane_b32 s44, v1
  s_and_b32 s46, s46, 7
  s_waitcnt lgkmcnt(0)
  s_and_b32 s41, s41, 0xffff
  s_mov_b32 s42, 0x10000000
  s_mov_b32 s43, 0x20000
  s_and_b32 s47, s2, 7
  s_lshr_b32 s45, s2, 3
  s_cmp_eq_u32 s47, 0
  s_cbranch_scc1 L_team
  s_sub_u32 s3, s47, 1
  s_lshl_b32 s3, s3, 2
  s_lshr_b32 s4, s45, 3
  s_add_u32 s3, s3, s4
  s_and_b32 s70, s45, 7
  s_getpc_b64 s[4:5]
L_pc0:
  s_add_u32 s4, s4, L_ptab-L_pc0
  s_addc_u32 s5, s5, 0
  s_lshl_b32 s3, s3, 8
  v_lshl_add_u32 v2, v0, 2, s3
  global_load_dword v1, v2, s[4:5]
  s_waitcnt vmcnt(0)
  v_readlane_b32 s6, v1, 63
  s_nop 3
  s_and_b32 s7, s6, 2
  s_and_b32 s6, s6, 1
L_p_start:
  s_cmp_eq_u32 s6, 0
  s_cselect_b64 s[52:53], s[8:9], s[10:11]
  s_and_b32 s53, s53, 0xffff
  s_mov_b32 s54, 0x200000
  s_mov_b32 s55, 0x20000
  s_mov_b32 s50, 0x400000
  s_mov_b32 s51, 0x20000
  s_lshl_b32 s64, s44, 12
  v_readlane_b32 s57, v1, 0
  v_readlane_b32 s58, v1, 1
  s_mov_b32 s60, 4
  s_mov_b32 s61, 4
  s_mov_b32 s56, 2
  v_lshrrev_b32 v12, 3, v0
  v_lshlrev_b32 v2, 13, v12
  v_and_b32 v12, 7, v0
  v_lshrrev_b32 v13, 3, v0
  v_and_b32 v13, 2, v13
  v_xor_b32 v12, v12, v13
  v_lshl_add_u32 v2, v12, 4, v2
  s_lshl_b32 s67, s44, 18
  v_add_u32 v2, s67, v2
  v_xor_b32 v3, 64, v2
  s_lshl_b32 s67, s70, 8
  s_lshl_b32 s68, s44, 6
  s_add_u32 s67, s67, s68
  v_and_b32 v15, 31, v0
  v_add_u32 v15, s67, v15
  v_lshlrev_b32 v15, 2, v15
  s_lshl_b32 s71, s67, 10
  s_lshl_b32 s72, s44, 15
  s_add_u32 s72, s72, 0x8000
  v_lshlrev_b32 v14, 4, v0
  v_xor_b32 v32, 0, v14
  v_xor_b32 v33, 16, v14
  v_xor_b32 v34, 32, v14
  v_xor_b32 v35, 48, v14
  v_xor_b32 v36, 64, v14
  v_xor_b32 v37, 80, v14
  v_xor_b32 v38, 96, v14
  v_xor_b32 v39, 112, v14
  v_xor_b32 v40, 128, v14
  v_xor_b32 v41, 144, v14
  v_xor_b32 v42, 160, v14
  v_xor_b32 v43, 176, v14
  v_xor_b32 v44, 192, v14
  v_xor_b32 v45, 208, v14
  v_xor_b32 v46, 224, v14
  v_xor_b32 v47, 240, v14
  s_add_u32 m0, s72, 0
  s_add_u32 s63, s71, 0
  buffer_load_dwordx4 v32, s[52:55], s63 offen lds
  s_add_u32 m0, s72, 1024
  s_add_u32 s63, s71, 1024
  buffer_load_dwordx4 v33, s[52:55], s63 offen lds
  s_add_u32 m0, s72, 2048
  s_add_u32 s63, s71, 2048
  buffer_load_dwordx4 v34, s[52:55], s63 offen lds
  s_add_u32 m0, s72, 3072
  s_add_u32 s63, s71, 3072
  buffer_load_dwordx4 v35, s[52:55], s63 offen lds
  s_add_u32 m0, s72, 4096
  s_add_u32 s63, s71, 4096
  buffer_load_dwordx4 v36, s[52:55], s63 offen lds
  s_add_u32 m0, s72, 5120
  s_add_u32 s63, s71, 5120
  buffer_load_dwordx4 v37, s[52:55], s63 offen lds
  s_add_u32 m0, s72, 6144
  s_add_u32 s63, s71, 6144
  buffer_load_dwordx4 v38, s[52:55], s63 offen lds
  s_add_u32 m0, s72, 7168
  s_add_u32 s63, s71, 7168
  buffer_load_dwordx4 v39, s[52:55], s63 offen lds
  s_add_u32 m0, s72, 8192
  s_add_u32 s63, s71, 8192
  buffer_load_dwordx4 v40, s[52:55], s63 offen lds
  s_add_u32 m0, s72, 9216
  s_add_u32 s63, s71, 9216
  buffer_load_dwordx4 v41, s[52:55], s63 offen lds
  s_add_u32 m0, s72, 10240
  s_add_u32 s63, s71, 10240
  buffer_load_dwordx4 v42, s[52:55], s63 offen lds
  s_add_u32 m0, s72, 11264
  s_add_u32 s63, s71, 11264
  buffer_load_dwordx4 v43, s[52:55], s63 offen lds
  s_add_u32 m0, s72, 12288
  s_add_u32 s63, s71, 12288
  buffer_load_dwordx4 v44, s[52:55], s63 offen lds
  s_add_u32 m0, s72, 13312
  s_add_u32 s63, s71, 13312
  buffer_load_dwordx4 v45, s[52:55], s63 offen lds
  s_add_u32 m0, s72, 14336
  s_add_u32 s63, s71, 14336
  buffer_load_dwordx4 v46, s[52:55], s63 offen lds
  s_add_u32 m0, s72, 15360
  s_add_u32 s63, s71, 15360
  buffer_load_dwordx4 v47, s[52:55], s63 offen lds
  s_add_u32 m0, s72, 16384
  s_add_u32 s63, s71, 16384
  buffer_load_dwordx4 v32, s[52:55], s63 offen lds
  s_add_u32 m0, s72, 17408
  s_add_u32 s63, s71, 17408
  buffer_load_dwordx4 v33, s[52:55], s63 offen lds
  s_add_u32 m0, s72, 18432
  s_add_u32 s63, s71, 18432
  buffer_load_dwordx4 v34, s[52:55], s63 offen lds
  s_add_u32 m0, s72, 19456
  s_add_u32 s63, s71, 19456
  buffer_load_dwordx4 v35, s[52:55], s63 offen lds
  s_add_u32 m0, s72, 20480
  s_add_u32 s63, s71, 20480
  buffer_load_dwordx4 v36, s[52:55], s63 offen lds
  s_add_u32 m0, s72, 21504
  s_add_u32 s63, s71, 21504
  buffer_load_dwordx4 v37, s[52:55], s63 offen lds
  s_add_u32 m0, s72, 22528
  s_add_u32 s63, s71, 22528
  buffer_load_dwordx4 v38, s[52:55], s63 offen lds
  s_add_u32 m0, s72, 23552
  s_add_u32 s63, s71, 23552
  buffer_load_dwordx4 v39, s[52:55], s63 offen lds
  s_add_u32 m0, s72, 24576
  s_add_u32 s63, s71, 24576
  buffer_load_dwordx4 v40, s[52:55], s63 offen lds
  s_add_u32 m0, s72, 25600
  s_add_u32 s63, s71, 25600
  buffer_load_dwordx4 v41, s[52:55], s63 offen lds
  s_add_u32 m0, s72, 26624
  s_add_u32 s63, s71, 26624
  buffer_load_dwordx4 v42, s[52:55], s63 offen lds
  s_add_u32 m0, s72, 27648
  s_add_u32 s63, s71, 27648
  buffer_load_dwordx4 v43, s[52:55], s63 offen lds
  s_add_u32 m0, s72, 28672
  s_add_u32 s63, s71, 28672
  buffer_load_dwordx4 v44, s[52:55], s63 offen lds
  s_add_u32 m0, s72, 29696
  s_add_u32 s63, s71, 29696
  buffer_load_dwordx4 v45, s[52:55], s63 offen lds
  s_add_u32 m0, s72, 30720
  s_add_u32 s63, s71, 30720
  buffer_load_dwordx4 v46, s[52:55], s63 offen lds
  s_add_u32 m0, s72, 31744
  s_add_u32 s63, s71, 31744
  buffer_load_dwordx4 v47, s[52:55], s63 offen lds
  s_bfe_u32 s67, s57, 0x30018
  s_mov_b64 s[48:49], s[12:13]
  s_cmp_eq_u32 s67, 1
  s_cselect_b64 s[48:49], s[14:15], s[48:49]
  s_cmp_eq_u32 s67, 2
  s_cselect_b64 s[48:49], s[16:17], s[48:49]
  s_cmp_eq_u32 s67, 3
  s_cselect_b64 s[48:49], s[24:25], s[48:49]
  s_cmp_eq_u32 s67, 4
  s_cselect_b64 s[48:49], s[26:27], s[48:49]
  s_cmp_eq_u32 s67, 5
  s_cselect_b64 s[48:49], s[28:29], s[48:49]
  s_and_b32 s49, s49, 0xffff
  s_bfe_u32 s67, s57, 0x50013
  s_lshl_b32 s67, s67, 8
  s_bfe_u32 s68, s57, 0x1000c
  s_lshl_b32 s68, s68, 7
  s_or_b32 s62, s67, s68
  s_bitcmp1_b32 s57, 2
  s_cselect_b32 s62, 0x40000000, s62
  s_add_u32 m0, s64, 0
  s_add_u32 s63, s62, 0
  buffer_load_dwordx4 v2, s[48:51], s63 offen lds
  s_add_u32 m0, s64, 1024
  s_add_u32 s63, s62, 65536
  buffer_load_dwordx4 v3, s[48:51], s63 offen lds
  s_add_u32 m0, s64, 2048
  s_add_u32 s63, s62, 131072
  buffer_load_dwordx4 v2, s[48:51], s63 offen lds
  s_add_u32 m0, s64, 3072
  s_add_u32 s63, s62, 196608
  buffer_load_dwordx4 v3, s[48:51], s63 offen lds
  s_add_u32 m0, s64, 16384
  s_add_u32 s63, s62, 1048576
  buffer_load_dwordx4 v2, s[48:51], s63 offen lds
  s_add_u32 m0, s64, 17408
  s_add_u32 s63, s62, 1114112
  buffer_load_dwordx4 v3, s[48:51], s63 offen lds
  s_add_u32 m0, s64, 18432
  s_add_u32 s63, s62, 1179648
  buffer_load_dwordx4 v2, s[48:51], s63 offen lds
  s_add_u32 m0, s64, 19456
  s_add_u32 s63, s62, 1245184
  buffer_load_dwordx4 v3, s[48:51], s63 offen lds
  v_and_b32 v12, 15, v0
  v_lshrrev_b32 v13, 4, v0
  v_xor_b32 v13, v13, v12
  v_lshlrev_b32 v13, 4, v13
  v_lshl_add_u32 v12, v12, 10, v13
  v_add_u32 v64, s72, v12
  v_xor_b32 v65, 64, v64
  v_xor_b32 v66, 128, v64
  v_xor_b32 v67, 192, v64
  s_waitcnt vmcnt(8)
  ds_read_b128 a[0:3], v64 offset:0
  ds_read_b128 a[4:7], v65 offset:0
  ds_read_b128 a[8:11], v66 offset:0
  ds_read_b128 a[12:15], v67 offset:0
  ds_read_b128 a[16:19], v64 offset:256
  ds_read_b128 a[20:23], v65 offset:256
  ds_read_b128 a[24:27], v66 offset:256
  ds_read_b128 a[28:31], v67 offset:256
  ds_read_b128 a[32:35], v64 offset:512
  ds_read_b128 a[36:39], v65 offset:512
  ds_read_b128 a[40:43], v66 offset:512
  ds_read_b128 a[44:47], v67 offset:512
  ds_read_b128 a[48:51], v64 offset:768
  ds_read_b128 a[52:55], v65 offset:768
  ds_read_b128 a[56:59], v66 offset:768
  ds_read_b128 a[60:63], v67 offset:768
  ds_read_b128 a[64:67], v64 offset:16384
  ds_read_b128 a[68:71], v65 offset:16384
  ds_read_b128 a[72:75], v66 offset:16384
  ds_read_b128 a[76:79], v67 offset:16384
  ds_read_b128 a[80:83], v64 offset:16640
  ds_read_b128 a[84:87], v65 offset:16640
  ds_read_b128 a[88:91], v66 offset:16640
  ds_read_b128 a[92:95], v67 offset:16640
  ds_read_b128 a[96:99], v64 offset:16896
  ds_read_b128 a[100:103], v65 offset:16896
  ds_read_b128 a[104:107], v66 offset:16896
  ds_read_b128 a[108:111], v67 offset:16896
  ds_read_b128 a[112:115], v64 offset:17152
  ds_read_b128 a[116:119], v65 offset:17152
  ds_read_b128 a[120:123], v66 offset:17152
  ds_read_b128 a[124:127], v67 offset:17152
  s_waitcnt lgkmcnt(0)
  s_add_u32 m0, s72, 0
  s_add_u32 s63, s71, 32768
  buffer_load_dwordx4 v32, s[52:55], s63 offen lds
  s_add_u32 m0, s72, 1024
  s_add_u32 s63, s71, 33792
  buffer_load_dwordx4 v33, s[52:55], s63 offen lds
  s_add_u32 m0, s72, 2048
  s_add_u32 s63, s71, 34816
  buffer_load_dwordx4 v34, s[52:55], s63 offen lds
  s_add_u32 m0, s72, 3072
  s_add_u32 s63, s71, 35840
  buffer_load_dwordx4 v35, s[52:55], s63 offen lds
  s_add_u32 m0, s72, 4096
  s_add_u32 s63, s71, 36864
  buffer_load_dwordx4 v36, s[52:55], s63 offen lds
  s_add_u32 m0, s72, 5120
  s_add_u32 s63, s71, 37888
  buffer_load_dwordx4 v37, s[52:55], s63 offen lds
  s_add_u32 m0, s72, 6144
  s_add_u32 s63, s71, 38912
  buffer_load_dwordx4 v38, s[52:55], s63 offen lds
  s_add_u32 m0, s72, 7168
  s_add_u32 s63, s71, 39936
  buffer_load_dwordx4 v39, s[52:55], s63 offen lds
  s_add_u32 m0, s72, 8192
  s_add_u32 s63, s71, 40960
  buffer_load_dwordx4 v40, s[52:55], s63 offen lds
  s_add_u32 m0, s72, 9216
  s_add_u32 s63, s71, 41984
  buffer_load_dwordx4 v41, s[52:55], s63 offen lds
  s_add_u32 m0, s72, 10240
  s_add_u32 s63, s71, 43008
  buffer_load_dwordx4 v42, s[52:55], s63 offen lds
  s_add_u32 m0, s72, 11264
  s_add_u32 s63, s71, 44032
  buffer_load_dwordx4 v43, s[52:55], s63 offen lds
  s_add_u32 m0, s72, 12288
  s_add_u32 s63, s71, 45056
  buffer_load_dwordx4 v44, s[52:55], s63 offen lds
  s_add_u32 m0, s72, 13312
  s_add_u32 s63, s71, 46080
  buffer_load_dwordx4 v45, s[52:55], s63 offen lds
  s_add_u32 m0, s72, 14336
  s_add_u32 s63, s71, 47104
  buffer_load_dwordx4 v46, s[52:55], s63 offen lds
  s_add_u32 m0, s72, 15360
  s_add_u32 s63, s71, 48128
  buffer_load_dwordx4 v47, s[52:55], s63 offen lds
  s_add_u32 m0, s72, 16384
  s_add_u32 s63, s71, 49152
  buffer_load_dwordx4 v32, s[52:55], s63 offen lds
  s_add_u32 m0, s72, 17408
  s_add_u32 s63, s71, 50176
  buffer_load_dwordx4 v33, s[52:55], s63 offen lds
  s_add_u32 m0, s72, 18432
  s_add_u32 s63, s71, 51200
  buffer_load_dwordx4 v34, s[52:55], s63 offen lds
  s_add_u32 m0, s72, 19456
  s_add_u32 s63, s71, 52224
  buffer_load_dwordx4 v35, s[52:55], s63 offen lds
  s_add_u32 m0, s72, 20480
  s_add_u32 s63, s71, 53248
  buffer_load_dwordx4 v36, s[52:55], s63 offen lds
  s_add_u32 m0, s72, 21504
  s_add_u32 s63, s71, 54272
  buffer_load_dwordx4 v37, s[52:55], s63 offen lds
  s_add_u32 m0, s72, 22528
  s_add_u32 s63, s71, 55296
  buffer_load_dwordx4 v38, s[52:55], s63 offen lds
  s_add_u32 m0, s72, 23552
  s_add_u32 s63, s71, 56320
  buffer_load_dwordx4 v39, s[52:55], s63 offen lds
  s_add_u32 m0, s72, 24576
  s_add_u32 s63, s71, 57344
  buffer_load_dwordx4 v40, s[52:55], s63 offen lds
  s_add_u32 m0, s72, 25600
  s_add_u32 s63, s71, 58368
  buffer_load_dwordx4 v41, s[52:55], s63 offen lds
  s_add_u32 m0, s72, 26624
  s_add_u32 s63, s71, 59392
  buffer_load_dwordx4 v42, s[52:55], s63 offen lds
  s_add_u32 m0, s72, 27648
  s_add_u32 s63, s71, 60416
  buffer_load_dwordx4 v43, s[52:55], s63 offen lds
  s_add_u32 m0, s72, 28672
  s_add_u32 s63, s71, 61440
  buffer_load_dwordx4 v44, s[52:55], s63 offen lds
  s_add_u32 m0, s72, 29696
  s_add_u32 s63, s71, 62464
  buffer_load_dwordx4 v45, s[52:55], s63 offen lds
  s_add_u32 m0, s72, 30720
  s_add_u32 s63, s71, 63488
  buffer_load_dwordx4 v46, s[52:55], s63 offen lds
  s_add_u32 m0, s72, 31744
  s_add_u32 s63, s71, 64512
  buffer_load_dwordx4 v47, s[52:55], s63 offen lds
  v_lshrrev_b32 v12, 4, v0
  v_lshlrev_b32 v16, 10, v12
  v_bfe_u32 v12, v0, 2, 2
  v_lshl_add_u32 v16, v12, 7, v16
  v_bfe_u32 v12, v0, 3, 2
  v_lshl_add_u32 v16, v12, 5, v16
  v_and_b32 v12, 3, v0
  v_lshl_add_u32 v16, v12, 3, v16
  v_xor_b32 v17, 32, v16
  v_xor_b32 v18, 64, v16
  v_xor_b32 v19, 96, v16
  v_add_u32 v20, 0x10000, v16
  v_add_u32 v21, 0x10000, v17
  v_add_u32 v22, 0x10000, v18
  v_add_u32 v23, 0x10000, v19
  s_lshl_b32 s67, s70, 3
  s_lshl_b32 s68, s44, 1
  s_add_u32 s67, s67, s68
  s_lshl_b32 s67, s67, 13
  v_lshl_add_u32 v8, v0, 4, s67
  v_add_u32 v9, 0x2000, v8
  s_lshl_b32 s67, s70, 2
  s_add_u32 s67, s67, 0x9080000
  s_cmp_eq_u32 s44, 0
  s_cselect_b32 s67, s67, 0x40000000
  v_mov_b32 v10, 0x40000000
  v_mov_b32 v11, 1
  v_writelane_b32 v10, s67, 0
  s_waitcnt vmcnt(0)
  ds_read_b128 a[128:131], v64 offset:0
  ds_read_b128 a[132:135], v65 offset:0
  ds_read_b128 a[136:139], v66 offset:0
  ds_read_b128 a[140:143], v67 offset:0
  ds_read_b128 a[144:147], v64 offset:256
  ds_read_b128 a[148:151], v65 offset:256
  ds_read_b128 a[152:155], v66 offset:256
  ds_read_b128 a[156:159], v67 offset:256
  ds_read_b128 a[160:163], v64 offset:512
  ds_read_b128 a[164:167], v65 offset:512
  ds_read_b128 a[168:171], v66 offset:512
  ds_read_b128 a[172:175], v67 offset:512
  ds_read_b128 a[176:179], v64 offset:768
  ds_read_b128 a[180:183], v65 offset:768
  ds_read_b128 a[184:187], v66 offset:768
  ds_read_b128 a[188:191], v67 offset:768
  ds_read_b128 a[192:195], v64 offset:16384
  ds_read_b128 a[196:199], v65 offset:16384
  ds_read_b128 a[200:203], v66 offset:16384
  ds_read_b128 a[204:207], v67 offset:16384
  ds_read_b128 a[208:211], v64 offset:16640
  ds_read_b128 a[212:215], v65 offset:16640
  ds_read_b128 a[216:219], v66 offset:16640
  ds_read_b128 a[220:223], v67 offset:16640
  ds_read_b128 a[224:227], v64 offset:16896
  ds_read_b128 a[228:231], v65 offset:16896
  ds_read_b128 a[232:235], v66 offset:16896
  ds_read_b128 a[236:239], v67 offset:16896
  ds_read_b128 a[240:243], v64 offset:17152
  ds_read_b128 a[244:247], v65 offset:17152
  ds_read_b128 a[248:251], v66 offset:17152
  ds_read_b128 a[252:255], v67 offset:17152
  s_waitcnt lgkmcnt(0)
  s_barrier
  s_add_u32 m0, s64, 32768
  s_add_u32 s63, s62, 2097152
  buffer_load_dwordx4 v2, s[48:51], s63 offen lds
  s_add_u32 m0, s64, 33792
  s_add_u32 s63, s62, 2162688
  buffer_load_dwordx4 v3, s[48:51], s63 offen lds
  s_add_u32 m0, s64, 34816
  s_add_u32 s63, s62, 2228224
  buffer_load_dwordx4 v2, s[48:51], s63 offen lds
  s_add_u32 m0, s64, 35840
  s_add_u32 s63, s62, 2293760
  buffer_load_dwordx4 v3, s[48:51], s63 offen lds
  s_add_u32 m0, s64, 49152
  s_add_u32 s63, s62, 3145728
  buffer_load_dwordx4 v2, s[48:51], s63 offen lds
  s_add_u32 m0, s64, 50176
  s_add_u32 s63, s62, 3211264
  buffer_load_dwordx4 v3, s[48:51], s63 offen lds
  s_add_u32 m0, s64, 51200
  s_add_u32 s63, s62, 3276800
  buffer_load_dwordx4 v2, s[48:51], s63 offen lds
  s_add_u32 m0, s64, 52224
  s_add_u32 s63, s62, 3342336
  buffer_load_dwordx4 v3, s[48:51], s63 offen lds
  s_bfe_u32 s67, s58, 0x30018
  s_mov_b64 s[48:49], s[12:13]
  s_cmp_eq_u32 s67, 1
  s_cselect_b64 s[48:49], s[14:15], s[48:49]
  s_cmp_eq_u32 s67, 2
  s_cselect_b64 s[48:49], s[16:17], s[48:49]
  s_cmp_eq_u32 s67, 3
  s_cselect_b64 s[48:49], s[24:25], s[48:49]
  s_cmp_eq_u32 s67, 4
  s_cselect_b64 s[48:49], s[26:27], s[48:49]
  s_cmp_eq_u32 s67, 5
  s_cselect_b64 s[48:49], s[28:29], s[48:49]
  s_and_b32 s49, s49, 0xffff
  s_bfe_u32 s67, s58, 0x50013
  s_lshl_b32 s67, s67, 8
  s_bfe_u32 s68, s58, 0x1000c
  s_lshl_b32 s68, s68, 7
  s_or_b32 s62, s67, s68
  s_bitcmp1_b32 s58, 2
  s_cselect_b32 s62, 0x40000000, s62
  s_add_u32 m0, s64, 65536
  s_add_u32 s63, s62, 0
  buffer_load_dwordx4 v2, s[48:51], s63 offen lds
  s_add_u32 m0, s64, 66560
  s_add_u32 s63, s62, 65536
  buffer_load_dwordx4 v3, s[48:51], s63 offen lds
  s_add_u32 m0, s64, 67584
  s_add_u32 s63, s62, 131072
  buffer_load_dwordx4 v2, s[48:51], s63 offen lds
  s_add_u32 m0, s64, 68608
  s_add_u32 s63, s62, 196608
  buffer_load_dwordx4 v3, s[48:51], s63 offen lds
  s_add_u32 m0, s64, 81920
  s_add_u32 s63, s62, 1048576
  buffer_load_dwordx4 v2, s[48:51], s63 offen lds
  s_add_u32 m0, s64, 82944
  s_add_u32 s63, s62, 1114112
  buffer_load_dwordx4 v3, s[48:51], s63 offen lds
  s_add_u32 m0, s64, 83968
  s_add_u32 s63, s62, 1179648
  buffer_load_dwordx4 v2, s[48:51], s63 offen lds
  s_add_u32 m0, s64, 84992
  s_add_u32 s63, s62, 1245184
  buffer_load_dwordx4 v3, s[48:51], s63 offen lds
  s_cmp_eq_u32 s7, 0
  s_cbranch_scc1 L_p_nogate
  s_mov_b32 s52, s34
  s_and_b32 s53, s35, 0xffff
  s_mov_b32 s54, 0x400
  s_mov_b32 s55, 0x20000
  v_lshrrev_b32 v12, 4, v0
  v_lshlrev_b32 v12, 4, v12
  buffer_load_dwordx4 v[128:131], v12, s[52:55], 0 offen offset:0
  buffer_load_dwordx4 v[132:135], v12, s[52:55], 0 offen offset:64
  buffer_load_dwordx4 v[136:139], v12, s[52:55], 0 offen offset:128
  buffer_load_dwordx4 v[140:143], v12, s[52:55], 0 offen offset:192
  buffer_load_dwordx4 v[144:147], v12, s[52:55], 0 offen offset:256
  buffer_load_dwordx4 v[148:151], v12, s[52:55], 0 offen offset:320
  buffer_load_dwordx4 v[152:155], v12, s[52:55], 0 offen offset:384
  buffer_load_dwordx4 v[156:159], v12, s[52:55], 0 offen offset:448
  buffer_load_dwordx4 v[160:163], v12, s[52:55], 0 offen offset:512
  buffer_load_dwordx4 v[164:167], v12, s[52:55], 0 offen offset:576
  buffer_load_dwordx4 v[168:171], v12, s[52:55], 0 offen offset:640
  buffer_load_dwordx4 v[172:175], v12, s[52:55], 0 offen offset:704
  buffer_load_dwordx4 v[176:179], v12, s[52:55], 0 offen offset:768
  buffer_load_dwordx4 v[180:183], v12, s[52:55], 0 offen offset:832
  buffer_load_dwordx4 v[184:187], v12, s[52:55], 0 offen offset:896
  buffer_load_dwordx4 v[188:191], v12, s[52:55], 0 offen offset:960
  v_and_b32 v15, 0xffffffbf, v15
  s_waitcnt vmcnt(0)
  v_mfma_f32_16x16x32_bf16 v[80:83], v[128:131], a[0:3], 0
  v_mfma_f32_16x16x32_bf16 v[84:87], v[128:131], a[64:67], 0
  v_mfma_f32_16x16x32_bf16 v[88:91], v[128:131], a[128:131], 0
  v_mfma_f32_16x16x32_bf16 v[92:95], v[128:131], a[192:195], 0
  v_mfma_f32_16x16x32_bf16 v[80:83], v[132:135], a[4:7], v[80:83]
  v_mfma_f32_16x16x32_bf16 v[84:87], v[132:135], a[68:71], v[84:87]
  v_mfma_f32_16x16x32_bf16 v[88:91], v[132:135], a[132:135], v[88:91]
  v_mfma_f32_16x16x32_bf16 v[92:95], v[132:135], a[196:199], v[92:95]
  v_mfma_f32_16x16x32_bf16 v[80:83], v[136:139], a[8:11], v[80:83]
  v_mfma_f32_16x16x32_bf16 v[84:87], v[136:139], a[72:75], v[84:87]
  v_mfma_f32_16x16x32_bf16 v[88:91], v[136:139], a[136:139], v[88:91]
  v_mfma_f32_16x16x32_bf16 v[92:95], v[136:139], a[200:203], v[92:95]
  v_mfma_f32_16x16x32_bf16 v[80:83], v[140:143], a[12:15], v[80:83]
  v_mfma_f32_16x16x32_bf16 v[84:87], v[140:143], a[76:79], v[84:87]
  v_mfma_f32_16x16x32_bf16 v[88:91], v[140:143], a[140:143], v[88:91]
  v_mfma_f32_16x16x32_bf16 v[92:95], v[140:143], a[204:207], v[92:95]
  v_mfma_f32_16x16x32_bf16 v[80:83], v[144:147], a[16:19], v[80:83]
  v_mfma_f32_16x16x32_bf16 v[84:87], v[144:147], a[80:83], v[84:87]
  v_mfma_f32_16x16x32_bf16 v[88:91], v[144:147], a[144:147], v[88:91]
  v_mfma_f32_16x16x32_bf16 v[92:95], v[144:147], a[208:211], v[92:95]
  v_mfma_f32_16x16x32_bf16 v[80:83], v[148:151], a[20:23], v[80:83]
  v_mfma_f32_16x16x32_bf16 v[84:87], v[148:151], a[84:87], v[84:87]
  v_mfma_f32_16x16x32_bf16 v[88:91], v[148:151], a[148:151], v[88:91]
  v_mfma_f32_16x16x32_bf16 v[92:95], v[148:151], a[212:215], v[92:95]
  v_mfma_f32_16x16x32_bf16 v[80:83], v[152:155], a[24:27], v[80:83]
  v_mfma_f32_16x16x32_bf16 v[84:87], v[152:155], a[88:91], v[84:87]
  v_mfma_f32_16x16x32_bf16 v[88:91], v[152:155], a[152:155], v[88:91]
  v_mfma_f32_16x16x32_bf16 v[92:95], v[152:155], a[216:219], v[92:95]
  v_mfma_f32_16x16x32_bf16 v[80:83], v[156:159], a[28:31], v[80:83]
  v_mfma_f32_16x16x32_bf16 v[84:87], v[156:159], a[92:95], v[84:87]
  v_mfma_f32_16x16x32_bf16 v[88:91], v[156:159], a[156:159], v[88:91]
  v_mfma_f32_16x16x32_bf16 v[92:95], v[156:159], a[220:223], v[92:95]
  v_mfma_f32_16x16x32_bf16 v[80:83], v[160:163], a[32:35], v[80:83]
  v_mfma_f32_16x16x32_bf16 v[84:87], v[160:163], a[96:99], v[84:87]
  v_mfma_f32_16x16x32_bf16 v[88:91], v[160:163], a[160:163], v[88:91]
  v_mfma_f32_16x16x32_bf16 v[92:95], v[160:163], a[224:227], v[92:95]
  v_mfma_f32_16x16x32_bf16 v[80:83], v[164:167], a[36:39], v[80:83]
  v_mfma_f32_16x16x32_bf16 v[84:87], v[164:167], a[100:103], v[84:87]
  v_mfma_f32_16x16x32_bf16 v[88:91], v[164:167], a[164:167], v[88:91]
  v_mfma_f32_16x16x32_bf16 v[92:95], v[164:167], a[228:231], v[92:95]
  v_mfma_f32_16x16x32_bf16 v[80:83], v[168:171], a[40:43], v[80:83]
  v_mfma_f32_16x16x32_bf16 v[84:87], v[168:171], a[104:107], v[84:87]
  v_mfma_f32_16x16x32_bf16 v[88:91], v[168:171], a[168:171], v[88:91]
  v_mfma_f32_16x16x32_bf16 v[92:95], v[168:171], a[232:235], v[92:95]
  v_mfma_f32_16x16x32_bf16 v[80:83], v[172:175], a[44:47], v[80:83]
  v_mfma_f32_16x16x32_bf16 v[84:87], v[172:175], a[108:111], v[84:87]
  v_mfma_f32_16x16x32_bf16 v[88:91], v[172:175], a[172:175], v[88:91]
  v_mfma_f32_16x16x32_bf16 v[92:95], v[172:175], a[236:239], v[92:95]
  v_mfma_f32_16x16x32_bf16 v[80:83], v[176:179], a[48:51], v[80:83]
  v_mfma_f32_16x16x32_bf16 v[84:87], v[176:179], a[112:115], v[84:87]
  v_mfma_f32_16x16x32_bf16 v[88:91], v[176:179], a[176:179], v[88:91]
  v_mfma_f32_16x16x32_bf16 v[92:95], v[176:179], a[240:243], v[92:95]
  v_mfma_f32_16x16x32_bf16 v[80:83], v[180:183], a[52:55], v[80:83]
  v_mfma_f32_16x16x32_bf16 v[84:87], v[180:183], a[116:119], v[84:87]
  v_mfma_f32_16x16x32_bf16 v[88:91], v[180:183], a[180:183], v[88:91]
  v_mfma_f32_16x16x32_bf16 v[92:95], v[180:183], a[244:247], v[92:95]
  v_mfma_f32_16x16x32_bf16 v[80:83], v[184:187], a[56:59], v[80:83]
  v_mfma_f32_16x16x32_bf16 v[84:87], v[184:187], a[120:123], v[84:87]
  v_mfma_f32_16x16x32_bf16 v[88:91], v[184:187], a[184:187], v[88:91]
  v_mfma_f32_16x16x32_bf16 v[92:95], v[184:187], a[248:251], v[92:95]
  v_mfma_f32_16x16x32_bf16 v[80:83], v[188:191], a[60:63], v[80:83]
  v_mfma_f32_16x16x32_bf16 v[84:87], v[188:191], a[124:127], v[84:87]
  v_mfma_f32_16x16x32_bf16 v[88:91], v[188:191], a[188:191], v[88:91]
  v_mfma_f32_16x16x32_bf16 v[92:95], v[188:191], a[252:255], v[92:95]
  s_nop 15
  s_mov_b32 s67, 0x90c0000
  v_mul_f32 v80, 0xbfb8aa3b, v80
  v_exp_f32 v80, v80
  s_nop 0
  v_add_f32 v80, 1.0, v80
  v_rcp_f32 v80, v80
  s_nop 0
  buffer_store_dword v80, v15, s[40:43], s67 offen offset:0 sc1
  v_mul_f32 v84, 0xbfb8aa3b, v84
  v_exp_f32 v84, v84
  s_nop 0
  v_add_f32 v84, 1.0, v84
  v_rcp_f32 v84, v84
  s_nop 0
  buffer_store_dword v84, v15, s[40:43], s67 offen offset:64 sc1
  v_mul_f32 v88, 0xbfb8aa3b, v88
  v_exp_f32 v88, v88
  s_nop 0
  v_add_f32 v88, 1.0, v88
  v_rcp_f32 v88, v88
  s_nop 0
  buffer_store_dword v88, v15, s[40:43], s67 offen offset:128 sc1
  v_mul_f32 v92, 0xbfb8aa3b, v92
  v_exp_f32 v92, v92
  s_nop 0
  v_add_f32 v92, 1.0, v92
  v_rcp_f32 v92, v92
  s_nop 0
  buffer_store_dword v92, v15, s[40:43], s67 offen offset:192 sc1
L_p_nogate:
  s_mov_b32 s52, s38
  s_and_b32 s53, s39, 0xffff
  s_mov_b32 s54, 0x100
  s_mov_b32 s55, 0x20000
  v_mov_b32 v12, 0
  s_mov_b32 s67, 0
L_p_init:
  buffer_load_dword v13, v12, s[52:55], 0 offen sc1
  s_add_u32 s67, s67, 1
  s_cmp_gt_u32 s67, 1048576
  s_cbranch_scc1 L_exit
  s_waitcnt vmcnt(0)
  v_cmp_ne_u32 vcc, 32, v13
  s_cbranch_vccnz L_p_init
  s_barrier
  s_mul_i32 s69, s70, 124
  s_add_u32 s69, s69, 0x6400
  s_cmp_eq_u32 s7, 0
  s_cselect_b32 s69, 0x40000000, s69
  buffer_atomic_add v11, v10, s[40:43], s69 offen
  ds_read_b64_tr_b16 v[32:33], v16 offset:0
  ds_read_b64_tr_b16 v[34:35], v16 offset:512
  ds_read_b64_tr_b16 v[36:37], v17 offset:0
  ds_read_b64_tr_b16 v[38:39], v17 offset:512
  ds_read_b64_tr_b16 v[40:41], v18 offset:0
  ds_read_b64_tr_b16 v[42:43], v18 offset:512
  ds_read_b64_tr_b16 v[44:45], v19 offset:0
  ds_read_b64_tr_b16 v[46:47], v19 offset:512
  s_waitcnt lgkmcnt(4)
  s_bitcmp1_b32 s57, 0
  s_cbranch_scc1 L_p_body_0_1
L_p_body_0_0:
  v_mfma_f32_16x16x32_bf16 v[128:131], v[32:35], a[0:3], 0
  s_add_u32 m0, s64, 98304
  ds_read_b64_tr_b16 v[48:49], v16 offset:4096
  v_mfma_f32_16x16x32_bf16 v[136:139], v[32:35], a[64:67], 0
  v_mfma_f32_16x16x32_bf16 v[160:163], v[32:35], a[128:131], 0
  s_add_u32 s63, s62, 2097152
  ds_read_b64_tr_b16 v[50:51], v16 offset:4608
  v_mfma_f32_16x16x32_bf16 v[168:171], v[32:35], a[192:195], 0
  buffer_load_dwordx4 v2, s[48:51], s63 offen lds
  v_mfma_f32_16x16x32_bf16 v[132:135], v[36:39], a[0:3], 0
  s_and_b32 s65, s60, 0x7fff000
  s_bitcmp1_b32 s60, 2
  s_cselect_b32 s65, 0x40000000, s65
  ds_read_b64_tr_b16 v[52:53], v17 offset:4096
  v_mfma_f32_16x16x32_bf16 v[140:143], v[36:39], a[64:67], 0
  s_bitcmp1_b32 s60, 1
  s_cselect_b32 s66, 0x3e0293ee, 1.0
  v_mfma_f32_16x16x32_bf16 v[164:167], v[36:39], a[128:131], 0
  s_waitcnt lgkmcnt(3)
  ds_read_b64_tr_b16 v[54:55], v17 offset:4608
  v_mfma_f32_16x16x32_bf16 v[172:175], v[36:39], a[192:195], 0
  v_mfma_f32_16x16x32_bf16 v[144:147], v[40:43], a[0:3], 0
  s_add_u32 m0, s64, 99328
  ds_read_b64_tr_b16 v[56:57], v18 offset:4096
  v_mfma_f32_16x16x32_bf16 v[152:155], v[40:43], a[64:67], 0
  v_mfma_f32_16x16x32_bf16 v[176:179], v[40:43], a[128:131], 0
  s_add_u32 s63, s62, 2162688
  ds_read_b64_tr_b16 v[58:59], v18 offset:4608
  v_mul_f32 v192, s66, v192
  v_mfma_f32_16x16x32_bf16 v[184:187], v[40:43], a[192:195], 0
  buffer_load_dwordx4 v3, s[48:51], s63 offen lds
  v_mul_f32 v193, s66, v193
  v_cvt_pk_bf16_f32 v64, v192, v193
  v_mfma_f32_16x16x32_bf16 v[148:151], v[44:47], a[0:3], 0
  ds_read_b64_tr_b16 v[60:61], v19 offset:4096
  v_mul_f32 v194, s66, v194
  v_mfma_f32_16x16x32_bf16 v[156:159], v[44:47], a[64:67], 0
  v_mul_f32 v195, s66, v195
  v_cvt_pk_bf16_f32 v65, v194, v195
  v_mfma_f32_16x16x32_bf16 v[180:183], v[44:47], a[128:131], 0
  s_waitcnt lgkmcnt(3)
  ds_read_b64_tr_b16 v[62:63], v19 offset:4608
  v_mul_f32 v196, s66, v196
  v_mfma_f32_16x16x32_bf16 v[188:191], v[44:47], a[192:195], 0
  v_mul_f32 v197, s66, v197
  v_cvt_pk_bf16_f32 v66, v196, v197
  v_mfma_f32_16x16x32_bf16 v[128:131], v[48:51], a[4:7], v[128:131]
  s_add_u32 m0, s64, 100352
  ds_read_b64_tr_b16 v[32:33], v16 offset:8192
  v_readlane_b32 s59, v1, s56
  v_mfma_f32_16x16x32_bf16 v[136:139], v[48:51], a[68:71], v[136:139]
  v_mul_f32 v198, s66, v198
  v_mul_f32 v199, s66, v199
  v_cvt_pk_bf16_f32 v67, v198, v199
  v_mfma_f32_16x16x32_bf16 v[160:163], v[48:51], a[132:135], v[160:163]
  s_add_u32 s63, s62, 2228224
  ds_read_b64_tr_b16 v[34:35], v16 offset:8704
  v_mfma_f32_16x16x32_bf16 v[168:171], v[48:51], a[196:199], v[168:171]
  buffer_load_dwordx4 v2, s[48:51], s63 offen lds
  v_mfma_f32_16x16x32_bf16 v[132:135], v[52:55], a[4:7], v[132:135]
  ds_read_b64_tr_b16 v[36:37], v17 offset:8192
  v_mul_f32 v200, s66, v200
  v_mfma_f32_16x16x32_bf16 v[140:143], v[52:55], a[68:71], v[140:143]
  buffer_store_dwordx4 v[64:67], v8, s[40:43], s65 offen offset:0 sc1
  v_mul_f32 v201, s66, v201
  v_cvt_pk_bf16_f32 v68, v200, v201
  v_mfma_f32_16x16x32_bf16 v[164:167], v[52:55], a[132:135], v[164:167]
  s_waitcnt lgkmcnt(3)
  ds_read_b64_tr_b16 v[38:39], v17 offset:8704
  v_mul_f32 v202, s66, v202
  v_mfma_f32_16x16x32_bf16 v[172:175], v[52:55], a[196:199], v[172:175]
  v_mul_f32 v203, s66, v203
  v_cvt_pk_bf16_f32 v69, v202, v203
  v_mfma_f32_16x16x32_bf16 v[144:147], v[56:59], a[4:7], v[144:147]
  s_add_u32 m0, s64, 101376
  ds_read_b64_tr_b16 v[40:41], v18 offset:8192
  v_mul_f32 v204, s66, v204
  v_mfma_f32_16x16x32_bf16 v[152:155], v[56:59], a[68:71], v[152:155]
  v_mul_f32 v205, s66, v205
  v_cvt_pk_bf16_f32 v70, v204, v205
  v_mfma_f32_16x16x32_bf16 v[176:179], v[56:59], a[132:135], v[176:179]
  s_add_u32 s63, s62, 2293760
  ds_read_b64_tr_b16 v[42:43], v18 offset:8704
  v_mul_f32 v206, s66, v206
  v_mfma_f32_16x16x32_bf16 v[184:187], v[56:59], a[196:199], v[184:187]
  buffer_load_dwordx4 v3, s[48:51], s63 offen lds
  v_mul_f32 v207, s66, v207
  v_cvt_pk_bf16_f32 v71, v206, v207
  v_mfma_f32_16x16x32_bf16 v[148:151], v[60:63], a[4:7], v[148:151]
  ds_read_b64_tr_b16 v[44:45], v19 offset:8192
  v_mfma_f32_16x16x32_bf16 v[156:159], v[60:63], a[68:71], v[156:159]
  v_mfma_f32_16x16x32_bf16 v[180:183], v[60:63], a[132:135], v[180:183]
  s_waitcnt lgkmcnt(3)
  ds_read_b64_tr_b16 v[46:47], v19 offset:8704
  v_mfma_f32_16x16x32_bf16 v[188:191], v[60:63], a[196:199], v[188:191]
  buffer_store_dwordx4 v[68:71], v8, s[40:43], s65 offen offset:1024 sc1
  v_mfma_f32_16x16x32_bf16 v[128:131], v[32:35], a[8:11], v[128:131]
  ds_read_b64_tr_b16 v[48:49], v16 offset:12288
  v_mfma_f32_16x16x32_bf16 v[136:139], v[32:35], a[72:75], v[136:139]
  v_mfma_f32_16x16x32_bf16 v[160:163], v[32:35], a[136:139], v[160:163]
  ds_read_b64_tr_b16 v[50:51], v16 offset:12800
  v_mfma_f32_16x16x32_bf16 v[168:171], v[32:35], a[200:203], v[168:171]
  v_mfma_f32_16x16x32_bf16 v[132:135], v[36:39], a[8:11], v[132:135]
  ds_read_b64_tr_b16 v[52:53], v17 offset:12288
  v_mfma_f32_16x16x32_bf16 v[140:143], v[36:39], a[72:75], v[140:143]
  v_mfma_f32_16x16x32_bf16 v[164:167], v[36:39], a[136:139], v[164:167]
  s_waitcnt lgkmcnt(3)
  ds_read_b64_tr_b16 v[54:55], v17 offset:12800
  v_mul_f32 v208, s66, v208
  v_mfma_f32_16x16x32_bf16 v[172:175], v[36:39], a[200:203], v[172:175]
  v_mul_f32 v209, s66, v209
  v_cvt_pk_bf16_f32 v72, v208, v209
  v_mfma_f32_16x16x32_bf16 v[144:147], v[40:43], a[8:11], v[144:147]
  ds_read_b64_tr_b16 v[56:57], v18 offset:12288
  v_mul_f32 v210, s66, v210
  v_mfma_f32_16x16x32_bf16 v[152:155], v[40:43], a[72:75], v[152:155]
  v_mul_f32 v211, s66, v211
  v_cvt_pk_bf16_f32 v73, v210, v211
  v_mfma_f32_16x16x32_bf16 v[176:179], v[40:43], a[136:139], v[176:179]
  ds_read_b64_tr_b16 v[58:59], v18 offset:12800
  v_mul_f32 v212, s66, v212
  v_mfma_f32_16x16x32_bf16 v[184:187], v[40:43], a[200:203], v[184:187]
  v_mul_f32 v213, s66, v213
  v_cvt_pk_bf16_f32 v74, v212, v213
  v_mfma_f32_16x16x32_bf16 v[148:151], v[44:47], a[8:11], v[148:151]
  s_waitcnt vmcnt(28)
  ds_read_b64_tr_b16 v[60:61], v19 offset:12288
  v_mul_f32 v214, s66, v214
  v_mfma_f32_16x16x32_bf16 v[156:159], v[44:47], a[72:75], v[156:159]
  s_barrier
  v_mul_f32 v215, s66, v215
  v_cvt_pk_bf16_f32 v75, v214, v215
  v_mfma_f32_16x16x32_bf16 v[180:183], v[44:47], a[136:139], v[180:183]
  s_waitcnt lgkmcnt(3)
  ds_read_b64_tr_b16 v[62:63], v19 offset:12800
  v_mfma_f32_16x16x32_bf16 v[188:191], v[44:47], a[200:203], v[188:191]
  v_mfma_f32_16x16x32_bf16 v[128:131], v[48:51], a[12:15], v[128:131]
  ds_read_b64_tr_b16 v[32:33], v16 offset:16384
  v_mul_f32 v216, s66, v216
  v_mfma_f32_16x16x32_bf16 v[136:139], v[48:51], a[76:79], v[136:139]
  buffer_store_dwordx4 v[72:75], v8, s[40:43], s65 offen offset:2048 sc1
  v_mul_f32 v217, s66, v217
  v_cvt_pk_bf16_f32 v76, v216, v217
  v_mfma_f32_16x16x32_bf16 v[160:163], v[48:51], a[140:143], v[160:163]
  ds_read_b64_tr_b16 v[34:35], v16 offset:16896
  v_mul_f32 v218, s66, v218
  v_mfma_f32_16x16x32_bf16 v[168:171], v[48:51], a[204:207], v[168:171]
  v_mul_f32 v219, s66, v219
  v_cvt_pk_bf16_f32 v77, v218, v219
  v_mfma_f32_16x16x32_bf16 v[132:135], v[52:55], a[12:15], v[132:135]
  ds_read_b64_tr_b16 v[36:37], v17 offset:16384
  v_mul_f32 v220, s66, v220
  v_mfma_f32_16x16x32_bf16 v[140:143], v[52:55], a[76:79], v[140:143]
  v_mul_f32 v221, s66, v221
  v_cvt_pk_bf16_f32 v78, v220, v221
  v_mfma_f32_16x16x32_bf16 v[164:167], v[52:55], a[140:143], v[164:167]
  s_waitcnt lgkmcnt(3)
  ds_read_b64_tr_b16 v[38:39], v17 offset:16896
  v_mul_f32 v222, s66, v222
  v_mfma_f32_16x16x32_bf16 v[172:175], v[52:55], a[204:207], v[172:175]
  v_mul_f32 v223, s66, v223
  v_cvt_pk_bf16_f32 v79, v222, v223
  v_mfma_f32_16x16x32_bf16 v[144:147], v[56:59], a[12:15], v[144:147]
  ds_read_b64_tr_b16 v[40:41], v18 offset:16384
  v_mfma_f32_16x16x32_bf16 v[152:155], v[56:59], a[76:79], v[152:155]
  v_mfma_f32_16x16x32_bf16 v[176:179], v[56:59], a[140:143], v[176:179]
  ds_read_b64_tr_b16 v[42:43], v18 offset:16896
  v_mfma_f32_16x16x32_bf16 v[184:187], v[56:59], a[204:207], v[184:187]
  buffer_store_dwordx4 v[76:79], v8, s[40:43], s65 offen offset:3072 sc1
  v_mfma_f32_16x16x32_bf16 v[148:151], v[60:63], a[12:15], v[148:151]
  ds_read_b64_tr_b16 v[44:45], v19 offset:16384
  v_mfma_f32_16x16x32_bf16 v[156:159], v[60:63], a[76:79], v[156:159]
  v_mfma_f32_16x16x32_bf16 v[180:183], v[60:63], a[140:143], v[180:183]
  s_waitcnt lgkmcnt(3)
  ds_read_b64_tr_b16 v[46:47], v19 offset:16896
  v_mfma_f32_16x16x32_bf16 v[188:191], v[60:63], a[204:207], v[188:191]
  v_mfma_f32_16x16x32_bf16 v[128:131], v[32:35], a[16:19], v[128:131]
  s_add_u32 m0, s64, 114688
  ds_read_b64_tr_b16 v[48:49], v16 offset:20480
  v_mfma_f32_16x16x32_bf16 v[136:139], v[32:35], a[80:83], v[136:139]
  v_mfma_f32_16x16x32_bf16 v[160:163], v[32:35], a[144:147], v[160:163]
  s_add_u32 s63, s62, 3145728
  ds_read_b64_tr_b16 v[50:51], v16 offset:20992
  v_mul_f32 v224, s66, v224
  v_mfma_f32_16x16x32_bf16 v[168:171], v[32:35], a[208:211], v[168:171]
  buffer_load_dwordx4 v2, s[48:51], s63 offen lds
  v_mul_f32 v225, s66, v225
  v_cvt_pk_bf16_f32 v64, v224, v225
  v_mfma_f32_16x16x32_bf16 v[132:135], v[36:39], a[16:19], v[132:135]
  ds_read_b64_tr_b16 v[52:53], v17 offset:20480
  v_mul_f32 v226, s66, v226
  v_mfma_f32_16x16x32_bf16 v[140:143], v[36:39], a[80:83], v[140:143]
  v_mul_f32 v227, s66, v227
  v_cvt_pk_bf16_f32 v65, v226, v227
  v_mfma_f32_16x16x32_bf16 v[164:167], v[36:39], a[144:147], v[164:167]
  s_waitcnt lgkmcnt(3)
  ds_read_b64_tr_b16 v[54:55], v17 offset:20992
  v_mul_f32 v228, s66, v228
  v_mfma_f32_16x16x32_bf16 v[172:175], v[36:39], a[208:211], v[172:175]
  v_mul_f32 v229, s66, v229
  v_cvt_pk_bf16_f32 v66, v228, v229
  v_mfma_f32_16x16x32_bf16 v[144:147], v[40:43], a[16:19], v[144:147]
  s_add_u32 m0, s64, 115712
  ds_read_b64_tr_b16 v[56:57], v18 offset:20480
  v_mul_f32 v230, s66, v230
  v_mfma_f32_16x16x32_bf16 v[152:155], v[40:43], a[80:83], v[152:155]
  v_mul_f32 v231, s66, v231
  v_cvt_pk_bf16_f32 v67, v230, v231
  v_mfma_f32_16x16x32_bf16 v[176:179], v[40:43], a[144:147], v[176:179]
  s_add_u32 s63, s62, 3211264
  ds_read_b64_tr_b16 v[58:59], v18 offset:20992
  v_mfma_f32_16x16x32_bf16 v[184:187], v[40:43], a[208:211], v[184:187]
  buffer_load_dwordx4 v3, s[48:51], s63 offen lds
  v_mfma_f32_16x16x32_bf16 v[148:151], v[44:47], a[16:19], v[148:151]
  ds_read_b64_tr_b16 v[60:61], v19 offset:20480
  v_mul_f32 v232, s66, v232
  v_mfma_f32_16x16x32_bf16 v[156:159], v[44:47], a[80:83], v[156:159]
  buffer_store_dwordx4 v[64:67], v9, s[40:43], s65 offen offset:0 sc1
  v_mul_f32 v233, s66, v233
  v_cvt_pk_bf16_f32 v68, v232, v233
  v_mfma_f32_16x16x32_bf16 v[180:183], v[44:47], a[144:147], v[180:183]
  s_waitcnt lgkmcnt(3)
  ds_read_b64_tr_b16 v[62:63], v19 offset:20992
  v_mul_f32 v234, s66, v234
  v_mfma_f32_16x16x32_bf16 v[188:191], v[44:47], a[208:211], v[188:191]
  v_mul_f32 v235, s66, v235
  v_cvt_pk_bf16_f32 v69, v234, v235
  v_mfma_f32_16x16x32_bf16 v[128:131], v[48:51], a[20:23], v[128:131]
  s_add_u32 m0, s64, 116736
  ds_read_b64_tr_b16 v[32:33], v16 offset:24576
  v_mul_f32 v236, s66, v236
  v_mfma_f32_16x16x32_bf16 v[136:139], v[48:51], a[84:87], v[136:139]
  v_mul_f32 v237, s66, v237
  v_cvt_pk_bf16_f32 v70, v236, v237
  v_mfma_f32_16x16x32_bf16 v[160:163], v[48:51], a[148:151], v[160:163]
  s_add_u32 s63, s62, 3276800
  ds_read_b64_tr_b16 v[34:35], v16 offset:25088
  v_mul_f32 v238, s66, v238
  v_mfma_f32_16x16x32_bf16 v[168:171], v[48:51], a[212:215], v[168:171]
  buffer_load_dwordx4 v2, s[48:51], s63 offen lds
  v_mul_f32 v239, s66, v239
  v_cvt_pk_bf16_f32 v71, v238, v239
  v_mfma_f32_16x16x32_bf16 v[132:135], v[52:55], a[20:23], v[132:135]
  ds_read_b64_tr_b16 v[36:37], v17 offset:24576
  v_mfma_f32_16x16x32_bf16 v[140:143], v[52:55], a[84:87], v[140:143]
  v_mfma_f32_16x16x32_bf16 v[164:167], v[52:55], a[148:151], v[164:167]
  s_waitcnt lgkmcnt(3)
  ds_read_b64_tr_b16 v[38:39], v17 offset:25088
  v_mfma_f32_16x16x32_bf16 v[172:175], v[52:55], a[212:215], v[172:175]
  buffer_store_dwordx4 v[68:71], v9, s[40:43], s65 offen offset:1024 sc1
  v_mfma_f32_16x16x32_bf16 v[144:147], v[56:59], a[20:23], v[144:147]
  s_add_u32 m0, s64, 117760
  ds_read_b64_tr_b16 v[40:41], v18 offset:24576
  v_mfma_f32_16x16x32_bf16 v[152:155], v[56:59], a[84:87], v[152:155]
  v_mfma_f32_16x16x32_bf16 v[176:179], v[56:59], a[148:151], v[176:179]
  s_add_u32 s63, s62, 3342336
  ds_read_b64_tr_b16 v[42:43], v18 offset:25088
  v_mfma_f32_16x16x32_bf16 v[184:187], v[56:59], a[212:215], v[184:187]
  buffer_load_dwordx4 v3, s[48:51], s63 offen lds
  v_mfma_f32_16x16x32_bf16 v[148:151], v[60:63], a[20:23], v[148:151]
  ds_read_b64_tr_b16 v[44:45], v19 offset:24576
  v_mfma_f32_16x16x32_bf16 v[156:159], v[60:63], a[84:87], v[156:159]
  v_mfma_f32_16x16x32_bf16 v[180:183], v[60:63], a[148:151], v[180:183]
  s_waitcnt lgkmcnt(3)
  ds_read_b64_tr_b16 v[46:47], v19 offset:25088
  v_mul_f32 v240, s66, v240
  v_mfma_f32_16x16x32_bf16 v[188:191], v[60:63], a[212:215], v[188:191]
  v_mul_f32 v241, s66, v241
  v_cvt_pk_bf16_f32 v72, v240, v241
  v_mfma_f32_16x16x32_bf16 v[128:131], v[32:35], a[24:27], v[128:131]
  ds_read_b64_tr_b16 v[48:49], v16 offset:28672
  v_mul_f32 v242, s66, v242
  v_mfma_f32_16x16x32_bf16 v[136:139], v[32:35], a[88:91], v[136:139]
  v_mul_f32 v243, s66, v243
  v_cvt_pk_bf16_f32 v73, v242, v243
  v_mfma_f32_16x16x32_bf16 v[160:163], v[32:35], a[152:155], v[160:163]
  ds_read_b64_tr_b16 v[50:51], v16 offset:29184
  v_mul_f32 v244, s66, v244
  v_mfma_f32_16x16x32_bf16 v[168:171], v[32:35], a[216:219], v[168:171]
  v_mul_f32 v245, s66, v245
  v_cvt_pk_bf16_f32 v74, v244, v245
  v_mfma_f32_16x16x32_bf16 v[132:135], v[36:39], a[24:27], v[132:135]
  s_bfe_u32 s67, s59, 0x30018
  ds_read_b64_tr_b16 v[52:53], v17 offset:28672
  v_mul_f32 v246, s66, v246
  v_mfma_f32_16x16x32_bf16 v[140:143], v[36:39], a[88:91], v[140:143]
  s_mov_b64 s[48:49], s[12:13]
  v_mul_f32 v247, s66, v247
  v_cvt_pk_bf16_f32 v75, v246, v247
  v_mfma_f32_16x16x32_bf16 v[164:167], v[36:39], a[152:155], v[164:167]
  s_waitcnt lgkmcnt(3)
  s_cmp_eq_u32 s67, 1
  ds_read_b64_tr_b16 v[54:55], v17 offset:29184
  v_mfma_f32_16x16x32_bf16 v[172:175], v[36:39], a[216:219], v[172:175]
  s_cselect_b64 s[48:49], s[14:15], s[48:49]
  v_mfma_f32_16x16x32_bf16 v[144:147], v[40:43], a[24:27], v[144:147]
  s_cmp_eq_u32 s67, 2
  ds_read_b64_tr_b16 v[56:57], v18 offset:28672
  v_mul_f32 v248, s66, v248
  v_mfma_f32_16x16x32_bf16 v[152:155], v[40:43], a[88:91], v[152:155]
  s_cselect_b64 s[48:49], s[16:17], s[48:49]
  buffer_store_dwordx4 v[72:75], v9, s[40:43], s65 offen offset:2048 sc1
  v_mul_f32 v249, s66, v249
  v_cvt_pk_bf16_f32 v76, v248, v249
  v_mfma_f32_16x16x32_bf16 v[176:179], v[40:43], a[152:155], v[176:179]
  s_cmp_eq_u32 s67, 3
  ds_read_b64_tr_b16 v[58:59], v18 offset:29184
  v_mul_f32 v250, s66, v250
  v_mfma_f32_16x16x32_bf16 v[184:187], v[40:43], a[216:219], v[184:187]
  s_cselect_b64 s[48:49], s[24:25], s[48:49]
  v_mul_f32 v251, s66, v251
  v_cvt_pk_bf16_f32 v77, v250, v251
  v_mfma_f32_16x16x32_bf16 v[148:151], v[44:47], a[24:27], v[148:151]
  s_waitcnt vmcnt(28)
  s_barrier
  ds_read_b64_tr_b16 v[60:61], v19 offset:28672
  v_mul_f32 v252, s66, v252
  v_mfma_f32_16x16x32_bf16 v[156:159], v[44:47], a[88:91], v[156:159]
  s_cmp_eq_u32 s67, 4
  s_cselect_b64 s[48:49], s[26:27], s[48:49]
  v_mul_f32 v253, s66, v253
  v_cvt_pk_bf16_f32 v78, v252, v253
  v_mfma_f32_16x16x32_bf16 v[180:183], v[44:47], a[152:155], v[180:183]
  s_waitcnt lgkmcnt(3)
  s_cmp_eq_u32 s67, 5
  ds_read_b64_tr_b16 v[62:63], v19 offset:29184
  v_mul_f32 v254, s66, v254
  v_mfma_f32_16x16x32_bf16 v[188:191], v[44:47], a[216:219], v[188:191]
  s_cselect_b64 s[48:49], s[28:29], s[48:49]
  v_mul_f32 v255, s66, v255
  v_cvt_pk_bf16_f32 v79, v254, v255
  v_mfma_f32_16x16x32_bf16 v[128:131], v[48:51], a[28:31], v[128:131]
  s_and_b32 s49, s49, 0xffff
  ds_read_b64_tr_b16 v[32:33], v16 offset:32768
  v_mfma_f32_16x16x32_bf16 v[136:139], v[48:51], a[92:95], v[136:139]
  s_bfe_u32 s67, s59, 0x50013
  v_mfma_f32_16x16x32_bf16 v[160:163], v[48:51], a[156:159], v[160:163]
  s_lshl_b32 s67, s67, 8
  ds_read_b64_tr_b16 v[34:35], v16 offset:33280
  v_mfma_f32_16x16x32_bf16 v[168:171], v[48:51], a[220:223], v[168:171]
  s_bfe_u32 s68, s59, 0x1000c
  buffer_store_dwordx4 v[76:79], v9, s[40:43], s65 offen offset:3072 sc1
  v_mfma_f32_16x16x32_bf16 v[132:135], v[52:55], a[28:31], v[132:135]
  s_lshl_b32 s68, s68, 7
  ds_read_b64_tr_b16 v[36:37], v17 offset:32768
  v_mfma_f32_16x16x32_bf16 v[140:143], v[52:55], a[92:95], v[140:143]
  s_or_b32 s62, s67, s68
  v_mfma_f32_16x16x32_bf16 v[164:167], v[52:55], a[156:159], v[164:167]
  s_waitcnt lgkmcnt(3)
  s_bitcmp1_b32 s59, 2
  ds_read_b64_tr_b16 v[38:39], v17 offset:33280
  v_mfma_f32_16x16x32_bf16 v[172:175], v[52:55], a[220:223], v[172:175]
  s_cselect_b32 s62, 0x40000000, s62
  v_mfma_f32_16x16x32_bf16 v[144:147], v[56:59], a[28:31], v[144:147]
  ds_read_b64_tr_b16 v[40:41], v18 offset:32768
  v_mfma_f32_16x16x32_bf16 v[152:155], v[56:59], a[92:95], v[152:155]
  v_mfma_f32_16x16x32_bf16 v[176:179], v[56:59], a[156:159], v[176:179]
  ds_read_b64_tr_b16 v[42:43], v18 offset:33280
  v_mfma_f32_16x16x32_bf16 v[184:187], v[56:59], a[220:223], v[184:187]
  v_mfma_f32_16x16x32_bf16 v[148:151], v[60:63], a[28:31], v[148:151]
  ds_read_b64_tr_b16 v[44:45], v19 offset:32768
  v_mfma_f32_16x16x32_bf16 v[156:159], v[60:63], a[92:95], v[156:159]
  v_mfma_f32_16x16x32_bf16 v[180:183], v[60:63], a[156:159], v[180:183]
  s_waitcnt lgkmcnt(3)
  ds_read_b64_tr_b16 v[46:47], v19 offset:33280
  v_mfma_f32_16x16x32_bf16 v[188:191], v[60:63], a[220:223], v[188:191]
  v_mfma_f32_16x16x32_bf16 v[128:131], v[32:35], a[32:35], v[128:131]
  s_add_u32 m0, s64, 0
  ds_read_b64_tr_b16 v[48:49], v16 offset:36864
  v_mfma_f32_16x16x32_bf16 v[136:139], v[32:35], a[96:99], v[136:139]
  v_mfma_f32_16x16x32_bf16 v[160:163], v[32:35], a[160:163], v[160:163]
  s_add_u32 s63, s62, 0
  ds_read_b64_tr_b16 v[50:51], v16 offset:37376
  v_mfma_f32_16x16x32_bf16 v[168:171], v[32:35], a[224:227], v[168:171]
  buffer_load_dwordx4 v2, s[48:51], s63 offen lds
  v_mfma_f32_16x16x32_bf16 v[132:135], v[36:39], a[32:35], v[132:135]
  ds_read_b64_tr_b16 v[52:53], v17 offset:36864
  v_mfma_f32_16x16x32_bf16 v[140:143], v[36:39], a[96:99], v[140:143]
  v_mfma_f32_16x16x32_bf16 v[164:167], v[36:39], a[160:163], v[164:167]
  s_waitcnt lgkmcnt(3)
  ds_read_b64_tr_b16 v[54:55], v17 offset:37376
  v_mfma_f32_16x16x32_bf16 v[172:175], v[36:39], a[224:227], v[172:175]
  v_mfma_f32_16x16x32_bf16 v[144:147], v[40:43], a[32:35], v[144:147]
  s_add_u32 m0, s64, 1024
  ds_read_b64_tr_b16 v[56:57], v18 offset:36864
  v_mfma_f32_16x16x32_bf16 v[152:155], v[40:43], a[96:99], v[152:155]
  v_mfma_f32_16x16x32_bf16 v[176:179], v[40:43], a[160:163], v[176:179]
  s_add_u32 s63, s62, 65536
  ds_read_b64_tr_b16 v[58:59], v18 offset:37376
  v_mfma_f32_16x16x32_bf16 v[184:187], v[40:43], a[224:227], v[184:187]
  buffer_load_dwordx4 v3, s[48:51], s63 offen lds
  v_mfma_f32_16x16x32_bf16 v[148:151], v[44:47], a[32:35], v[148:151]
  ds_read_b64_tr_b16 v[60:61], v19 offset:36864
  v_mfma_f32_16x16x32_bf16 v[156:159], v[44:47], a[96:99], v[156:159]
  v_mfma_f32_16x16x32_bf16 v[180:183], v[44:47], a[160:163], v[180:183]
  s_waitcnt lgkmcnt(3)
  ds_read_b64_tr_b16 v[62:63], v19 offset:37376
  v_mfma_f32_16x16x32_bf16 v[188:191], v[44:47], a[224:227], v[188:191]
  v_mfma_f32_16x16x32_bf16 v[128:131], v[48:51], a[36:39], v[128:131]
  s_add_u32 m0, s64, 2048
  ds_read_b64_tr_b16 v[32:33], v16 offset:40960
  v_mfma_f32_16x16x32_bf16 v[136:139], v[48:51], a[100:103], v[136:139]
  v_mfma_f32_16x16x32_bf16 v[160:163], v[48:51], a[164:167], v[160:163]
  s_add_u32 s63, s62, 131072
  ds_read_b64_tr_b16 v[34:35], v16 offset:41472
  v_mfma_f32_16x16x32_bf16 v[168:171], v[48:51], a[228:231], v[168:171]
  buffer_load_dwordx4 v2, s[48:51], s63 offen lds
  v_mfma_f32_16x16x32_bf16 v[132:135], v[52:55], a[36:39], v[132:135]
  ds_read_b64_tr_b16 v[36:37], v17 offset:40960
  v_mfma_f32_16x16x32_bf16 v[140:143], v[52:55], a[100:103], v[140:143]
  v_mfma_f32_16x16x32_bf16 v[164:167], v[52:55], a[164:167], v[164:167]
  s_waitcnt lgkmcnt(3)
  ds_read_b64_tr_b16 v[38:39], v17 offset:41472
  v_mfma_f32_16x16x32_bf16 v[172:175], v[52:55], a[228:231], v[172:175]
  v_mfma_f32_16x16x32_bf16 v[144:147], v[56:59], a[36:39], v[144:147]
  s_add_u32 m0, s64, 3072
  ds_read_b64_tr_b16 v[40:41], v18 offset:40960
  v_mfma_f32_16x16x32_bf16 v[152:155], v[56:59], a[100:103], v[152:155]
  v_mfma_f32_16x16x32_bf16 v[176:179], v[56:59], a[164:167], v[176:179]
  s_add_u32 s63, s62, 196608
  ds_read_b64_tr_b16 v[42:43], v18 offset:41472
  v_mfma_f32_16x16x32_bf16 v[184:187], v[56:59], a[228:231], v[184:187]
  buffer_load_dwordx4 v3, s[48:51], s63 offen lds
  v_mfma_f32_16x16x32_bf16 v[148:151], v[60:63], a[36:39], v[148:151]
  s_bfe_u32 s67, s61, 0x50013
  ds_read_b64_tr_b16 v[44:45], v19 offset:40960
  v_mfma_f32_16x16x32_bf16 v[156:159], v[60:63], a[100:103], v[156:159]
  s_lshl_b32 s67, s67, 7
  v_mfma_f32_16x16x32_bf16 v[180:183], v[60:63], a[164:167], v[180:183]
  s_waitcnt lgkmcnt(3)
  s_bfe_u32 s68, s61, 0x20004
  ds_read_b64_tr_b16 v[46:47], v19 offset:41472
  v_mfma_f32_16x16x32_bf16 v[188:191], v[60:63], a[228:231], v[188:191]
  s_lshl_b32 s68, s68, 5
  v_mfma_f32_16x16x32_bf16 v[128:131], v[32:35], a[40:43], v[128:131]
  s_or_b32 s69, s67, s68
  ds_read_b64_tr_b16 v[48:49], v16 offset:45056
  v_mfma_f32_16x16x32_bf16 v[136:139], v[32:35], a[104:107], v[136:139]
  s_bitcmp1_b32 s61, 2
  v_mfma_f32_16x16x32_bf16 v[160:163], v[32:35], a[168:171], v[160:163]
  s_cselect_b32 s69, 0x40000000, s69
  ds_read_b64_tr_b16 v[50:51], v16 offset:45568
  v_mfma_f32_16x16x32_bf16 v[168:171], v[32:35], a[232:235], v[168:171]
  v_mfma_f32_16x16x32_bf16 v[132:135], v[36:39], a[40:43], v[132:135]
  ds_read_b64_tr_b16 v[52:53], v17 offset:45056
  v_mfma_f32_16x16x32_bf16 v[140:143], v[36:39], a[104:107], v[140:143]
  v_mfma_f32_16x16x32_bf16 v[164:167], v[36:39], a[168:171], v[164:167]
  s_waitcnt lgkmcnt(3)
  ds_read_b64_tr_b16 v[54:55], v17 offset:45568
  v_mfma_f32_16x16x32_bf16 v[172:175], v[36:39], a[232:235], v[172:175]
  v_mfma_f32_16x16x32_bf16 v[144:147], v[40:43], a[40:43], v[144:147]
  ds_read_b64_tr_b16 v[56:57], v18 offset:45056
  v_mfma_f32_16x16x32_bf16 v[152:155], v[40:43], a[104:107], v[152:155]
  v_mfma_f32_16x16x32_bf16 v[176:179], v[40:43], a[168:171], v[176:179]
  ds_read_b64_tr_b16 v[58:59], v18 offset:45568
  v_mfma_f32_16x16x32_bf16 v[184:187], v[40:43], a[232:235], v[184:187]
  v_mfma_f32_16x16x32_bf16 v[148:151], v[44:47], a[40:43], v[148:151]
  s_waitcnt vmcnt(28)
  ds_read_b64_tr_b16 v[60:61], v19 offset:45056
  v_mfma_f32_16x16x32_bf16 v[156:159], v[44:47], a[104:107], v[156:159]
  s_barrier
  v_mfma_f32_16x16x32_bf16 v[180:183], v[44:47], a[168:171], v[180:183]
  s_waitcnt lgkmcnt(3)
  ds_read_b64_tr_b16 v[62:63], v19 offset:45568
  v_mfma_f32_16x16x32_bf16 v[188:191], v[44:47], a[232:235], v[188:191]
  buffer_atomic_add v11, v10, s[40:43], s69 offen
  v_mfma_f32_16x16x32_bf16 v[128:131], v[48:51], a[44:47], v[128:131]
  ds_read_b64_tr_b16 v[32:33], v16 offset:49152
  v_mfma_f32_16x16x32_bf16 v[136:139], v[48:51], a[108:111], v[136:139]
  v_mfma_f32_16x16x32_bf16 v[160:163], v[48:51], a[172:175], v[160:163]
  ds_read_b64_tr_b16 v[34:35], v16 offset:49664
  v_mfma_f32_16x16x32_bf16 v[168:171], v[48:51], a[236:239], v[168:171]
  v_mfma_f32_16x16x32_bf16 v[132:135], v[52:55], a[44:47], v[132:135]
  ds_read_b64_tr_b16 v[36:37], v17 offset:49152
  v_mfma_f32_16x16x32_bf16 v[140:143], v[52:55], a[108:111], v[140:143]
  v_mfma_f32_16x16x32_bf16 v[164:167], v[52:55], a[172:175], v[164:167]
  s_waitcnt lgkmcnt(3)
  ds_read_b64_tr_b16 v[38:39], v17 offset:49664
  v_mfma_f32_16x16x32_bf16 v[172:175], v[52:55], a[236:239], v[172:175]
  v_mfma_f32_16x16x32_bf16 v[144:147], v[56:59], a[44:47], v[144:147]
  ds_read_b64_tr_b16 v[40:41], v18 offset:49152
  v_mfma_f32_16x16x32_bf16 v[152:155], v[56:59], a[108:111], v[152:155]
  v_mfma_f32_16x16x32_bf16 v[176:179], v[56:59], a[172:175], v[176:179]
  ds_read_b64_tr_b16 v[42:43], v18 offset:49664
  v_mfma_f32_16x16x32_bf16 v[184:187], v[56:59], a[236:239], v[184:187]
  v_mfma_f32_16x16x32_bf16 v[148:151], v[60:63], a[44:47], v[148:151]
  ds_read_b64_tr_b16 v[44:45], v19 offset:49152
  v_mfma_f32_16x16x32_bf16 v[156:159], v[60:63], a[108:111], v[156:159]
  v_mfma_f32_16x16x32_bf16 v[180:183], v[60:63], a[172:175], v[180:183]
  s_waitcnt lgkmcnt(3)
  ds_read_b64_tr_b16 v[46:47], v19 offset:49664
  v_mfma_f32_16x16x32_bf16 v[188:191], v[60:63], a[236:239], v[188:191]
  v_mfma_f32_16x16x32_bf16 v[128:131], v[32:35], a[48:51], v[128:131]
  s_add_u32 m0, s64, 16384
  ds_read_b64_tr_b16 v[48:49], v16 offset:53248
  v_mfma_f32_16x16x32_bf16 v[136:139], v[32:35], a[112:115], v[136:139]
  v_mfma_f32_16x16x32_bf16 v[160:163], v[32:35], a[176:179], v[160:163]
  s_add_u32 s63, s62, 1048576
  ds_read_b64_tr_b16 v[50:51], v16 offset:53760
  v_mfma_f32_16x16x32_bf16 v[168:171], v[32:35], a[240:243], v[168:171]
  buffer_load_dwordx4 v2, s[48:51], s63 offen lds
  v_mfma_f32_16x16x32_bf16 v[132:135], v[36:39], a[48:51], v[132:135]
  ds_read_b64_tr_b16 v[52:53], v17 offset:53248
  v_mfma_f32_16x16x32_bf16 v[140:143], v[36:39], a[112:115], v[140:143]
  v_mfma_f32_16x16x32_bf16 v[164:167], v[36:39], a[176:179], v[164:167]
  s_waitcnt lgkmcnt(3)
  ds_read_b64_tr_b16 v[54:55], v17 offset:53760
  v_mfma_f32_16x16x32_bf16 v[172:175], v[36:39], a[240:243], v[172:175]
  v_mfma_f32_16x16x32_bf16 v[144:147], v[40:43], a[48:51], v[144:147]
  s_add_u32 m0, s64, 17408
  ds_read_b64_tr_b16 v[56:57], v18 offset:53248
  v_mfma_f32_16x16x32_bf16 v[152:155], v[40:43], a[112:115], v[152:155]
  v_mfma_f32_16x16x32_bf16 v[176:179], v[40:43], a[176:179], v[176:179]
  s_add_u32 s63, s62, 1114112
  ds_read_b64_tr_b16 v[58:59], v18 offset:53760
  v_mfma_f32_16x16x32_bf16 v[184:187], v[40:43], a[240:243], v[184:187]
  buffer_load_dwordx4 v3, s[48:51], s63 offen lds
  v_mfma_f32_16x16x32_bf16 v[148:151], v[44:47], a[48:51], v[148:151]
  ds_read_b64_tr_b16 v[60:61], v19 offset:53248
  v_mfma_f32_16x16x32_bf16 v[156:159], v[44:47], a[112:115], v[156:159]
  v_mfma_f32_16x16x32_bf16 v[180:183], v[44:47], a[176:179], v[180:183]
  s_waitcnt lgkmcnt(3)
  ds_read_b64_tr_b16 v[62:63], v19 offset:53760
  v_mfma_f32_16x16x32_bf16 v[188:191], v[44:47], a[240:243], v[188:191]
  v_mfma_f32_16x16x32_bf16 v[128:131], v[48:51], a[52:55], v[128:131]
  s_add_u32 m0, s64, 18432
  ds_read_b64_tr_b16 v[32:33], v16 offset:57344
  v_mfma_f32_16x16x32_bf16 v[136:139], v[48:51], a[116:119], v[136:139]
  v_mfma_f32_16x16x32_bf16 v[160:163], v[48:51], a[180:183], v[160:163]
  s_add_u32 s63, s62, 1179648
  ds_read_b64_tr_b16 v[34:35], v16 offset:57856
  v_mfma_f32_16x16x32_bf16 v[168:171], v[48:51], a[244:247], v[168:171]
  buffer_load_dwordx4 v2, s[48:51], s63 offen lds
  v_mfma_f32_16x16x32_bf16 v[132:135], v[52:55], a[52:55], v[132:135]
  ds_read_b64_tr_b16 v[36:37], v17 offset:57344
  v_mfma_f32_16x16x32_bf16 v[140:143], v[52:55], a[116:119], v[140:143]
  v_mfma_f32_16x16x32_bf16 v[164:167], v[52:55], a[180:183], v[164:167]
  s_waitcnt lgkmcnt(3)
  ds_read_b64_tr_b16 v[38:39], v17 offset:57856
  v_mfma_f32_16x16x32_bf16 v[172:175], v[52:55], a[244:247], v[172:175]
  v_mfma_f32_16x16x32_bf16 v[144:147], v[56:59], a[52:55], v[144:147]
  s_add_u32 m0, s64, 19456
  ds_read_b64_tr_b16 v[40:41], v18 offset:57344
  v_mfma_f32_16x16x32_bf16 v[152:155], v[56:59], a[116:119], v[152:155]
  v_mfma_f32_16x16x32_bf16 v[176:179], v[56:59], a[180:183], v[176:179]
  s_add_u32 s63, s62, 1245184
  ds_read_b64_tr_b16 v[42:43], v18 offset:57856
  v_mfma_f32_16x16x32_bf16 v[184:187], v[56:59], a[244:247], v[184:187]
  buffer_load_dwordx4 v3, s[48:51], s63 offen lds
  v_mfma_f32_16x16x32_bf16 v[148:151], v[60:63], a[52:55], v[148:151]
  ds_read_b64_tr_b16 v[44:45], v19 offset:57344
  v_mfma_f32_16x16x32_bf16 v[156:159], v[60:63], a[116:119], v[156:159]
  v_mfma_f32_16x16x32_bf16 v[180:183], v[60:63], a[180:183], v[180:183]
  s_waitcnt lgkmcnt(3)
  ds_read_b64_tr_b16 v[46:47], v19 offset:57856
  v_mfma_f32_16x16x32_bf16 v[188:191], v[60:63], a[244:247], v[188:191]
  v_mfma_f32_16x16x32_bf16 v[128:131], v[32:35], a[56:59], v[128:131]
  ds_read_b64_tr_b16 v[48:49], v16 offset:61440
  v_mfma_f32_16x16x32_bf16 v[136:139], v[32:35], a[120:123], v[136:139]
  v_mfma_f32_16x16x32_bf16 v[160:163], v[32:35], a[184:187], v[160:163]
  ds_read_b64_tr_b16 v[50:51], v16 offset:61952
  v_mfma_f32_16x16x32_bf16 v[168:171], v[32:35], a[248:251], v[168:171]
  v_mfma_f32_16x16x32_bf16 v[132:135], v[36:39], a[56:59], v[132:135]
  ds_read_b64_tr_b16 v[52:53], v17 offset:61440
  v_mfma_f32_16x16x32_bf16 v[140:143], v[36:39], a[120:123], v[140:143]
  v_mfma_f32_16x16x32_bf16 v[164:167], v[36:39], a[184:187], v[164:167]
  s_waitcnt lgkmcnt(3)
  ds_read_b64_tr_b16 v[54:55], v17 offset:61952
  v_mfma_f32_16x16x32_bf16 v[172:175], v[36:39], a[248:251], v[172:175]
  v_mfma_f32_16x16x32_bf16 v[144:147], v[40:43], a[56:59], v[144:147]
  ds_read_b64_tr_b16 v[56:57], v18 offset:61440
  v_mfma_f32_16x16x32_bf16 v[152:155], v[40:43], a[120:123], v[152:155]
  v_mfma_f32_16x16x32_bf16 v[176:179], v[40:43], a[184:187], v[176:179]
  ds_read_b64_tr_b16 v[58:59], v18 offset:61952
  v_mfma_f32_16x16x32_bf16 v[184:187], v[40:43], a[248:251], v[184:187]
  v_mfma_f32_16x16x32_bf16 v[148:151], v[44:47], a[56:59], v[148:151]
  s_waitcnt vmcnt(28)
  ds_read_b64_tr_b16 v[60:61], v19 offset:61440
  v_mfma_f32_16x16x32_bf16 v[156:159], v[44:47], a[120:123], v[156:159]
  s_barrier
  v_mfma_f32_16x16x32_bf16 v[180:183], v[44:47], a[184:187], v[180:183]
  s_waitcnt lgkmcnt(3)
  ds_read_b64_tr_b16 v[62:63], v19 offset:61952
  v_mfma_f32_16x16x32_bf16 v[188:191], v[44:47], a[248:251], v[188:191]
  v_mfma_f32_16x16x32_bf16 v[128:131], v[48:51], a[60:63], v[128:131]
  s_mov_b32 s61, s60
  ds_read_b64_tr_b16 v[32:33], v20 offset:0
  v_mfma_f32_16x16x32_bf16 v[136:139], v[48:51], a[124:127], v[136:139]
  s_mov_b32 s60, s57
  v_mfma_f32_16x16x32_bf16 v[160:163], v[48:51], a[188:191], v[160:163]
  s_mov_b32 s57, s58
  ds_read_b64_tr_b16 v[34:35], v20 offset:512
  v_mfma_f32_16x16x32_bf16 v[168:171], v[48:51], a[252:255], v[168:171]
  s_mov_b32 s58, s59
  v_mfma_f32_16x16x32_bf16 v[132:135], v[52:55], a[60:63], v[132:135]
  s_add_u32 s56, s56, 1
  ds_read_b64_tr_b16 v[36:37], v21 offset:0
  v_mfma_f32_16x16x32_bf16 v[140:143], v[52:55], a[124:127], v[140:143]
  v_mfma_f32_16x16x32_bf16 v[164:167], v[52:55], a[188:191], v[164:167]
  s_waitcnt lgkmcnt(3)
  ds_read_b64_tr_b16 v[38:39], v21 offset:512
  v_mfma_f32_16x16x32_bf16 v[172:175], v[52:55], a[252:255], v[172:175]
  v_mfma_f32_16x16x32_bf16 v[144:147], v[56:59], a[60:63], v[144:147]
  ds_read_b64_tr_b16 v[40:41], v22 offset:0
  v_mfma_f32_16x16x32_bf16 v[152:155], v[56:59], a[124:127], v[152:155]
  v_mfma_f32_16x16x32_bf16 v[176:179], v[56:59], a[188:191], v[176:179]
  ds_read_b64_tr_b16 v[42:43], v22 offset:512
  v_mfma_f32_16x16x32_bf16 v[184:187], v[56:59], a[252:255], v[184:187]
  v_mfma_f32_16x16x32_bf16 v[148:151], v[60:63], a[60:63], v[148:151]
  ds_read_b64_tr_b16 v[44:45], v23 offset:0
  v_mfma_f32_16x16x32_bf16 v[156:159], v[60:63], a[124:127], v[156:159]
  v_mfma_f32_16x16x32_bf16 v[180:183], v[60:63], a[188:191], v[180:183]
  s_waitcnt lgkmcnt(3)
  ds_read_b64_tr_b16 v[46:47], v23 offset:512
  v_mfma_f32_16x16x32_bf16 v[188:191], v[60:63], a[252:255], v[188:191]
  s_bitcmp1_b32 s57, 2
  s_cbranch_scc1 L_p_done_0
  s_bitcmp1_b32 s57, 0
  s_cbranch_scc1 L_p_body_1_1
  s_branch L_p_body_1_0
L_p_body_0_1:
  v_mfma_f32_16x16x32_bf16 v[128:131], a[0:3], v[32:35], 0
  s_add_u32 m0, s64, 98304
  ds_read_b64_tr_b16 v[48:49], v16 offset:4096
  v_mfma_f32_16x16x32_bf16 v[132:135], a[64:67], v[32:35], 0
  v_mfma_f32_16x16x32_bf16 v[160:163], a[128:131], v[32:35], 0
  s_add_u32 s63, s62, 2097152
  ds_read_b64_tr_b16 v[50:51], v16 offset:4608
  v_mfma_f32_16x16x32_bf16 v[164:167], a[192:195], v[32:35], 0
  buffer_load_dwordx4 v2, s[48:51], s63 offen lds
  v_mfma_f32_16x16x32_bf16 v[136:139], a[0:3], v[36:39], 0
  s_and_b32 s65, s60, 0x7fff000
  s_bitcmp1_b32 s60, 2
  s_cselect_b32 s65, 0x40000000, s65
  ds_read_b64_tr_b16 v[52:53], v17 offset:4096
  v_mfma_f32_16x16x32_bf16 v[140:143], a[64:67], v[36:39], 0
  s_bitcmp1_b32 s60, 1
  s_cselect_b32 s66, 0x3e0293ee, 1.0
  v_mfma_f32_16x16x32_bf16 v[168:171], a[128:131], v[36:39], 0
  s_waitcnt lgkmcnt(3)
  ds_read_b64_tr_b16 v[54:55], v17 offset:4608
  v_mfma_f32_16x16x32_bf16 v[172:175], a[192:195], v[36:39], 0
  v_mfma_f32_16x16x32_bf16 v[144:147], a[0:3], v[40:43], 0
  s_add_u32 m0, s64, 99328
  ds_read_b64_tr_b16 v[56:57], v18 offset:4096
  v_mfma_f32_16x16x32_bf16 v[148:151], a[64:67], v[40:43], 0
  v_mfma_f32_16x16x32_bf16 v[176:179], a[128:131], v[40:43], 0
  s_add_u32 s63, s62, 2162688
  ds_read_b64_tr_b16 v[58:59], v18 offset:4608
  v_mul_f32 v192, s66, v192
  v_mfma_f32_16x16x32_bf16 v[180:183], a[192:195], v[40:43], 0
  buffer_load_dwordx4 v3, s[48:51], s63 offen lds
  v_mul_f32 v193, s66, v193
  v_cvt_pk_bf16_f32 v64, v192, v193
  v_mfma_f32_16x16x32_bf16 v[152:155], a[0:3], v[44:47], 0
  ds_read_b64_tr_b16 v[60:61], v19 offset:4096
  v_mul_f32 v194, s66, v194
  v_mfma_f32_16x16x32_bf16 v[156:159], a[64:67], v[44:47], 0
  v_mul_f32 v195, s66, v195
  v_cvt_pk_bf16_f32 v65, v194, v195
  v_mfma_f32_16x16x32_bf16 v[184:187], a[128:131], v[44:47], 0
  s_waitcnt lgkmcnt(3)
  ds_read_b64_tr_b16 v[62:63], v19 offset:4608
  v_mul_f32 v196, s66, v196
  v_mfma_f32_16x16x32_bf16 v[188:191], a[192:195], v[44:47], 0
  v_mul_f32 v197, s66, v197
  v_cvt_pk_bf16_f32 v66, v196, v197
  v_mfma_f32_16x16x32_bf16 v[128:131], a[4:7], v[48:51], v[128:131]
  s_add_u32 m0, s64, 100352
  ds_read_b64_tr_b16 v[32:33], v16 offset:8192
  v_readlane_b32 s59, v1, s56
  v_mfma_f32_16x16x32_bf16 v[132:135], a[68:71], v[48:51], v[132:135]
  v_mul_f32 v198, s66, v198
  v_mul_f32 v199, s66, v199
  v_cvt_pk_bf16_f32 v67, v198, v199
  v_mfma_f32_16x16x32_bf16 v[160:163], a[132:135], v[48:51], v[160:163]
  s_add_u32 s63, s62, 2228224
  ds_read_b64_tr_b16 v[34:35], v16 offset:8704
  v_mfma_f32_16x16x32_bf16 v[164:167], a[196:199], v[48:51], v[164:167]
  buffer_load_dwordx4 v2, s[48:51], s63 offen lds
  v_mfma_f32_16x16x32_bf16 v[136:139], a[4:7], v[52:55], v[136:139]
  ds_read_b64_tr_b16 v[36:37], v17 offset:8192
  v_mul_f32 v200, s66, v200
  v_mfma_f32_16x16x32_bf16 v[140:143], a[68:71], v[52:55], v[140:143]
  buffer_store_dwordx4 v[64:67], v8, s[40:43], s65 offen offset:0 sc1
  v_mul_f32 v201, s66, v201
  v_cvt_pk_bf16_f32 v68, v200, v201
  v_mfma_f32_16x16x32_bf16 v[168:171], a[132:135], v[52:55], v[168:171]
  s_waitcnt lgkmcnt(3)
  ds_read_b64_tr_b16 v[38:39], v17 offset:8704
  v_mul_f32 v202, s66, v202
  v_mfma_f32_16x16x32_bf16 v[172:175], a[196:199], v[52:55], v[172:175]
  v_mul_f32 v203, s66, v203
  v_cvt_pk_bf16_f32 v69, v202, v203
  v_mfma_f32_16x16x32_bf16 v[144:147], a[4:7], v[56:59], v[144:147]
  s_add_u32 m0, s64, 101376
  ds_read_b64_tr_b16 v[40:41], v18 offset:8192
  v_mul_f32 v204, s66, v204
  v_mfma_f32_16x16x32_bf16 v[148:151], a[68:71], v[56:59], v[148:151]
  v_mul_f32 v205, s66, v205
  v_cvt_pk_bf16_f32 v70, v204, v205
  v_mfma_f32_16x16x32_bf16 v[176:179], a[132:135], v[56:59], v[176:179]
  s_add_u32 s63, s62, 2293760
  ds_read_b64_tr_b16 v[42:43], v18 offset:8704
  v_mul_f32 v206, s66, v206
  v_mfma_f32_16x16x32_bf16 v[180:183], a[196:199], v[56:59], v[180:183]
  buffer_load_dwordx4 v3, s[48:51], s63 offen lds
  v_mul_f32 v207, s66, v207
  v_cvt_pk_bf16_f32 v71, v206, v207
  v_mfma_f32_16x16x32_bf16 v[152:155], a[4:7], v[60:63], v[152:155]
  ds_read_b64_tr_b16 v[44:45], v19 offset:8192
  v_mfma_f32_16x16x32_bf16 v[156:159], a[68:71], v[60:63], v[156:159]
  v_mfma_f32_16x16x32_bf16 v[184:187], a[132:135], v[60:63], v[184:187]
  s_waitcnt lgkmcnt(3)
  ds_read_b64_tr_b16 v[46:47], v19 offset:8704
  v_mfma_f32_16x16x32_bf16 v[188:191], a[196:199], v[60:63], v[188:191]
  buffer_store_dwordx4 v[68:71], v8, s[40:43], s65 offen offset:1024 sc1
  v_mfma_f32_16x16x32_bf16 v[128:131], a[8:11], v[32:35], v[128:131]
  ds_read_b64_tr_b16 v[48:49], v16 offset:12288
  v_mfma_f32_16x16x32_bf16 v[132:135], a[72:75], v[32:35], v[132:135]
  v_mfma_f32_16x16x32_bf16 v[160:163], a[136:139], v[32:35], v[160:163]
  ds_read_b64_tr_b16 v[50:51], v16 offset:12800
  v_mfma_f32_16x16x32_bf16 v[164:167], a[200:203], v[32:35], v[164:167]
  v_mfma_f32_16x16x32_bf16 v[136:139], a[8:11], v[36:39], v[136:139]
  ds_read_b64_tr_b16 v[52:53], v17 offset:12288
  v_mfma_f32_16x16x32_bf16 v[140:143], a[72:75], v[36:39], v[140:143]
  v_mfma_f32_16x16x32_bf16 v[168:171], a[136:139], v[36:39], v[168:171]
  s_waitcnt lgkmcnt(3)
  ds_read_b64_tr_b16 v[54:55], v17 offset:12800
  v_mul_f32 v208, s66, v208
  v_mfma_f32_16x16x32_bf16 v[172:175], a[200:203], v[36:39], v[172:175]
  v_mul_f32 v209, s66, v209
  v_cvt_pk_bf16_f32 v72, v208, v209
  v_mfma_f32_16x16x32_bf16 v[144:147], a[8:11], v[40:43], v[144:147]
  ds_read_b64_tr_b16 v[56:57], v18 offset:12288
  v_mul_f32 v210, s66, v210
  v_mfma_f32_16x16x32_bf16 v[148:151], a[72:75], v[40:43], v[148:151]
  v_mul_f32 v211, s66, v211
  v_cvt_pk_bf16_f32 v73, v210, v211
  v_mfma_f32_16x16x32_bf16 v[176:179], a[136:139], v[40:43], v[176:179]
  ds_read_b64_tr_b16 v[58:59], v18 offset:12800
  v_mul_f32 v212, s66, v212
  v_mfma_f32_16x16x32_bf16 v[180:183], a[200:203], v[40:43], v[180:183]
  v_mul_f32 v213, s66, v213
  v_cvt_pk_bf16_f32 v74, v212, v213
  v_mfma_f32_16x16x32_bf16 v[152:155], a[8:11], v[44:47], v[152:155]
  s_waitcnt vmcnt(28)
  ds_read_b64_tr_b16 v[60:61], v19 offset:12288
  v_mul_f32 v214, s66, v214
  v_mfma_f32_16x16x32_bf16 v[156:159], a[72:75], v[44:47], v[156:159]
  s_barrier
  v_mul_f32 v215, s66, v215
  v_cvt_pk_bf16_f32 v75, v214, v215
  v_mfma_f32_16x16x32_bf16 v[184:187], a[136:139], v[44:47], v[184:187]
  s_waitcnt lgkmcnt(3)
  ds_read_b64_tr_b16 v[62:63], v19 offset:12800
  v_mfma_f32_16x16x32_bf16 v[188:191], a[200:203], v[44:47], v[188:191]
  v_mfma_f32_16x16x32_bf16 v[128:131], a[12:15], v[48:51], v[128:131]
  ds_read_b64_tr_b16 v[32:33], v16 offset:16384
  v_mul_f32 v216, s66, v216
  v_mfma_f32_16x16x32_bf16 v[132:135], a[76:79], v[48:51], v[132:135]
  buffer_store_dwordx4 v[72:75], v8, s[40:43], s65 offen offset:2048 sc1
  v_mul_f32 v217, s66, v217
  v_cvt_pk_bf16_f32 v76, v216, v217
  v_mfma_f32_16x16x32_bf16 v[160:163], a[140:143], v[48:51], v[160:163]
  ds_read_b64_tr_b16 v[34:35], v16 offset:16896
  v_mul_f32 v218, s66, v218
  v_mfma_f32_16x16x32_bf16 v[164:167], a[204:207], v[48:51], v[164:167]
  v_mul_f32 v219, s66, v219
  v_cvt_pk_bf16_f32 v77, v218, v219
  v_mfma_f32_16x16x32_bf16 v[136:139], a[12:15], v[52:55], v[136:139]
  ds_read_b64_tr_b16 v[36:37], v17 offset:16384
  v_mul_f32 v220, s66, v220
  v_mfma_f32_16x16x32_bf16 v[140:143], a[76:79], v[52:55], v[140:143]
  v_mul_f32 v221, s66, v221
  v_cvt_pk_bf16_f32 v78, v220, v221
  v_mfma_f32_16x16x32_bf16 v[168:171], a[140:143], v[52:55], v[168:171]
  s_waitcnt lgkmcnt(3)
  ds_read_b64_tr_b16 v[38:39], v17 offset:16896
  v_mul_f32 v222, s66, v222
  v_mfma_f32_16x16x32_bf16 v[172:175], a[204:207], v[52:55], v[172:175]
  v_mul_f32 v223, s66, v223
  v_cvt_pk_bf16_f32 v79, v222, v223
  v_mfma_f32_16x16x32_bf16 v[144:147], a[12:15], v[56:59], v[144:147]
  ds_read_b64_tr_b16 v[40:41], v18 offset:16384
  v_mfma_f32_16x16x32_bf16 v[148:151], a[76:79], v[56:59], v[148:151]
  v_mfma_f32_16x16x32_bf16 v[176:179], a[140:143], v[56:59], v[176:179]
  ds_read_b64_tr_b16 v[42:43], v18 offset:16896
  v_mfma_f32_16x16x32_bf16 v[180:183], a[204:207], v[56:59], v[180:183]
  buffer_store_dwordx4 v[76:79], v8, s[40:43], s65 offen offset:3072 sc1
  v_mfma_f32_16x16x32_bf16 v[152:155], a[12:15], v[60:63], v[152:155]
  ds_read_b64_tr_b16 v[44:45], v19 offset:16384
  v_mfma_f32_16x16x32_bf16 v[156:159], a[76:79], v[60:63], v[156:159]
  v_mfma_f32_16x16x32_bf16 v[184:187], a[140:143], v[60:63], v[184:187]
  s_waitcnt lgkmcnt(3)
  ds_read_b64_tr_b16 v[46:47], v19 offset:16896
  v_mfma_f32_16x16x32_bf16 v[188:191], a[204:207], v[60:63], v[188:191]
  v_mfma_f32_16x16x32_bf16 v[128:131], a[16:19], v[32:35], v[128:131]
  s_add_u32 m0, s64, 114688
  ds_read_b64_tr_b16 v[48:49], v16 offset:20480
  v_mfma_f32_16x16x32_bf16 v[132:135], a[80:83], v[32:35], v[132:135]
  v_mfma_f32_16x16x32_bf16 v[160:163], a[144:147], v[32:35], v[160:163]
  s_add_u32 s63, s62, 3145728
  ds_read_b64_tr_b16 v[50:51], v16 offset:20992
  v_mul_f32 v224, s66, v224
  v_mfma_f32_16x16x32_bf16 v[164:167], a[208:211], v[32:35], v[164:167]
  buffer_load_dwordx4 v2, s[48:51], s63 offen lds
  v_mul_f32 v225, s66, v225
  v_cvt_pk_bf16_f32 v64, v224, v225
  v_mfma_f32_16x16x32_bf16 v[136:139], a[16:19], v[36:39], v[136:139]
  ds_read_b64_tr_b16 v[52:53], v17 offset:20480
  v_mul_f32 v226, s66, v226
  v_mfma_f32_16x16x32_bf16 v[140:143], a[80:83], v[36:39], v[140:143]
  v_mul_f32 v227, s66, v227
  v_cvt_pk_bf16_f32 v65, v226, v227
  v_mfma_f32_16x16x32_bf16 v[168:171], a[144:147], v[36:39], v[168:171]
  s_waitcnt lgkmcnt(3)
  ds_read_b64_tr_b16 v[54:55], v17 offset:20992
  v_mul_f32 v228, s66, v228
  v_mfma_f32_16x16x32_bf16 v[172:175], a[208:211], v[36:39], v[172:175]
  v_mul_f32 v229, s66, v229
  v_cvt_pk_bf16_f32 v66, v228, v229
  v_mfma_f32_16x16x32_bf16 v[144:147], a[16:19], v[40:43], v[144:147]
  s_add_u32 m0, s64, 115712
  ds_read_b64_tr_b16 v[56:57], v18 offset:20480
  v_mul_f32 v230, s66, v230
  v_mfma_f32_16x16x32_bf16 v[148:151], a[80:83], v[40:43], v[148:151]
  v_mul_f32 v231, s66, v231
  v_cvt_pk_bf16_f32 v67, v230, v231
  v_mfma_f32_16x16x32_bf16 v[176:179], a[144:147], v[40:43], v[176:179]
  s_add_u32 s63, s62, 3211264
  ds_read_b64_tr_b16 v[58:59], v18 offset:20992
  v_mfma_f32_16x16x32_bf16 v[180:183], a[208:211], v[40:43], v[180:183]
  buffer_load_dwordx4 v3, s[48:51], s63 offen lds
  v_mfma_f32_16x16x32_bf16 v[152:155], a[16:19], v[44:47], v[152:155]
  ds_read_b64_tr_b16 v[60:61], v19 offset:20480
  v_mul_f32 v232, s66, v232
  v_mfma_f32_16x16x32_bf16 v[156:159], a[80:83], v[44:47], v[156:159]
  buffer_store_dwordx4 v[64:67], v9, s[40:43], s65 offen offset:0 sc1
  v_mul_f32 v233, s66, v233
  v_cvt_pk_bf16_f32 v68, v232, v233
  v_mfma_f32_16x16x32_bf16 v[184:187], a[144:147], v[44:47], v[184:187]
  s_waitcnt lgkmcnt(3)
  ds_read_b64_tr_b16 v[62:63], v19 offset:20992
  v_mul_f32 v234, s66, v234
  v_mfma_f32_16x16x32_bf16 v[188:191], a[208:211], v[44:47], v[188:191]
  v_mul_f32 v235, s66, v235
  v_cvt_pk_bf16_f32 v69, v234, v235
  v_mfma_f32_16x16x32_bf16 v[128:131], a[20:23], v[48:51], v[128:131]
  s_add_u32 m0, s64, 116736
  ds_read_b64_tr_b16 v[32:33], v16 offset:24576
  v_mul_f32 v236, s66, v236
  v_mfma_f32_16x16x32_bf16 v[132:135], a[84:87], v[48:51], v[132:135]
  v_mul_f32 v237, s66, v237
  v_cvt_pk_bf16_f32 v70, v236, v237
  v_mfma_f32_16x16x32_bf16 v[160:163], a[148:151], v[48:51], v[160:163]
  s_add_u32 s63, s62, 3276800
  ds_read_b64_tr_b16 v[34:35], v16 offset:25088
  v_mul_f32 v238, s66, v238
  v_mfma_f32_16x16x32_bf16 v[164:167], a[212:215], v[48:51], v[164:167]
  buffer_load_dwordx4 v2, s[48:51], s63 offen lds
  v_mul_f32 v239, s66, v239
  v_cvt_pk_bf16_f32 v71, v238, v239
  v_mfma_f32_16x16x32_bf16 v[136:139], a[20:23], v[52:55], v[136:139]
  ds_read_b64_tr_b16 v[36:37], v17 offset:24576
  v_mfma_f32_16x16x32_bf16 v[140:143], a[84:87], v[52:55], v[140:143]
  v_mfma_f32_16x16x32_bf16 v[168:171], a[148:151], v[52:55], v[168:171]
  s_waitcnt lgkmcnt(3)
  ds_read_b64_tr_b16 v[38:39], v17 offset:25088
  v_mfma_f32_16x16x32_bf16 v[172:175], a[212:215], v[52:55], v[172:175]
  buffer_store_dwordx4 v[68:71], v9, s[40:43], s65 offen offset:1024 sc1
  v_mfma_f32_16x16x32_bf16 v[144:147], a[20:23], v[56:59], v[144:147]
  s_add_u32 m0, s64, 117760
  ds_read_b64_tr_b16 v[40:41], v18 offset:24576
  v_mfma_f32_16x16x32_bf16 v[148:151], a[84:87], v[56:59], v[148:151]
  v_mfma_f32_16x16x32_bf16 v[176:179], a[148:151], v[56:59], v[176:179]
  s_add_u32 s63, s62, 3342336
  ds_read_b64_tr_b16 v[42:43], v18 offset:25088
  v_mfma_f32_16x16x32_bf16 v[180:183], a[212:215], v[56:59], v[180:183]
  buffer_load_dwordx4 v3, s[48:51], s63 offen lds
  v_mfma_f32_16x16x32_bf16 v[152:155], a[20:23], v[60:63], v[152:155]
  ds_read_b64_tr_b16 v[44:45], v19 offset:24576
  v_mfma_f32_16x16x32_bf16 v[156:159], a[84:87], v[60:63], v[156:159]
  v_mfma_f32_16x16x32_bf16 v[184:187], a[148:151], v[60:63], v[184:187]
  s_waitcnt lgkmcnt(3)
  ds_read_b64_tr_b16 v[46:47], v19 offset:25088
  v_mul_f32 v240, s66, v240
  v_mfma_f32_16x16x32_bf16 v[188:191], a[212:215], v[60:63], v[188:191]
  v_mul_f32 v241, s66, v241
  v_cvt_pk_bf16_f32 v72, v240, v241
  v_mfma_f32_16x16x32_bf16 v[128:131], a[24:27], v[32:35], v[128:131]
  ds_read_b64_tr_b16 v[48:49], v16 offset:28672
  v_mul_f32 v242, s66, v242
  v_mfma_f32_16x16x32_bf16 v[132:135], a[88:91], v[32:35], v[132:135]
  v_mul_f32 v243, s66, v243
  v_cvt_pk_bf16_f32 v73, v242, v243
  v_mfma_f32_16x16x32_bf16 v[160:163], a[152:155], v[32:35], v[160:163]
  ds_read_b64_tr_b16 v[50:51], v16 offset:29184
  v_mul_f32 v244, s66, v244
  v_mfma_f32_16x16x32_bf16 v[164:167], a[216:219], v[32:35], v[164:167]
  v_mul_f32 v245, s66, v245
  v_cvt_pk_bf16_f32 v74, v244, v245
  v_mfma_f32_16x16x32_bf16 v[136:139], a[24:27], v[36:39], v[136:139]
  s_bfe_u32 s67, s59, 0x30018
  ds_read_b64_tr_b16 v[52:53], v17 offset:28672
  v_mul_f32 v246, s66, v246
  v_mfma_f32_16x16x32_bf16 v[140:143], a[88:91], v[36:39], v[140:143]
  s_mov_b64 s[48:49], s[12:13]
  v_mul_f32 v247, s66, v247
  v_cvt_pk_bf16_f32 v75, v246, v247
  v_mfma_f32_16x16x32_bf16 v[168:171], a[152:155], v[36:39], v[168:171]
  s_waitcnt lgkmcnt(3)
  s_cmp_eq_u32 s67, 1
  ds_read_b64_tr_b16 v[54:55], v17 offset:29184
  v_mfma_f32_16x16x32_bf16 v[172:175], a[216:219], v[36:39], v[172:175]
  s_cselect_b64 s[48:49], s[14:15], s[48:49]
  v_mfma_f32_16x16x32_bf16 v[144:147], a[24:27], v[40:43], v[144:147]
  s_cmp_eq_u32 s67, 2
  ds_read_b64_tr_b16 v[56:57], v18 offset:28672
  v_mul_f32 v248, s66, v248
  v_mfma_f32_16x16x32_bf16 v[148:151], a[88:91], v[40:43], v[148:151]
  s_cselect_b64 s[48:49], s[16:17], s[48:49]
  buffer_store_dwordx4 v[72:75], v9, s[40:43], s65 offen offset:2048 sc1
  v_mul_f32 v249, s66, v249
  v_cvt_pk_bf16_f32 v76, v248, v249
  v_mfma_f32_16x16x32_bf16 v[176:179], a[152:155], v[40:43], v[176:179]
  s_cmp_eq_u32 s67, 3
  ds_read_b64_tr_b16 v[58:59], v18 offset:29184
  v_mul_f32 v250, s66, v250
  v_mfma_f32_16x16x32_bf16 v[180:183], a[216:219], v[40:43], v[180:183]
  s_cselect_b64 s[48:49], s[24:25], s[48:49]
  v_mul_f32 v251, s66, v251
  v_cvt_pk_bf16_f32 v77, v250, v251
  v_mfma_f32_16x16x32_bf16 v[152:155], a[24:27], v[44:47], v[152:155]
  s_waitcnt vmcnt(28)
  s_barrier
  ds_read_b64_tr_b16 v[60:61], v19 offset:28672
  v_mul_f32 v252, s66, v252
  v_mfma_f32_16x16x32_bf16 v[156:159], a[88:91], v[44:47], v[156:159]
  s_cmp_eq_u32 s67, 4
  s_cselect_b64 s[48:49], s[26:27], s[48:49]
  v_mul_f32 v253, s66, v253
  v_cvt_pk_bf16_f32 v78, v252, v253
  v_mfma_f32_16x16x32_bf16 v[184:187], a[152:155], v[44:47], v[184:187]
  s_waitcnt lgkmcnt(3)
  s_cmp_eq_u32 s67, 5
  ds_read_b64_tr_b16 v[62:63], v19 offset:29184
  v_mul_f32 v254, s66, v254
  v_mfma_f32_16x16x32_bf16 v[188:191], a[216:219], v[44:47], v[188:191]
  s_cselect_b64 s[48:49], s[28:29], s[48:49]
  v_mul_f32 v255, s66, v255
  v_cvt_pk_bf16_f32 v79, v254, v255
  v_mfma_f32_16x16x32_bf16 v[128:131], a[28:31], v[48:51], v[128:131]
  s_and_b32 s49, s49, 0xffff
  ds_read_b64_tr_b16 v[32:33], v16 offset:32768
  v_mfma_f32_16x16x32_bf16 v[132:135], a[92:95], v[48:51], v[132:135]
  s_bfe_u32 s67, s59, 0x50013
  v_mfma_f32_16x16x32_bf16 v[160:163], a[156:159], v[48:51], v[160:163]
  s_lshl_b32 s67, s67, 8
  ds_read_b64_tr_b16 v[34:35], v16 offset:33280
  v_mfma_f32_16x16x32_bf16 v[164:167], a[220:223], v[48:51], v[164:167]
  s_bfe_u32 s68, s59, 0x1000c
  buffer_store_dwordx4 v[76:79], v9, s[40:43], s65 offen offset:3072 sc1
  v_mfma_f32_16x16x32_bf16 v[136:139], a[28:31], v[52:55], v[136:139]
  s_lshl_b32 s68, s68, 7
  ds_read_b64_tr_b16 v[36:37], v17 offset:32768
  v_mfma_f32_16x16x32_bf16 v[140:143], a[92:95], v[52:55], v[140:143]
  s_or_b32 s62, s67, s68
  v_mfma_f32_16x16x32_bf16 v[168:171], a[156:159], v[52:55], v[168:171]
  s_waitcnt lgkmcnt(3)
  s_bitcmp1_b32 s59, 2
  ds_read_b64_tr_b16 v[38:39], v17 offset:33280
  v_mfma_f32_16x16x32_bf16 v[172:175], a[220:223], v[52:55], v[172:175]
  s_cselect_b32 s62, 0x40000000, s62
  v_mfma_f32_16x16x32_bf16 v[144:147], a[28:31], v[56:59], v[144:147]
  ds_read_b64_tr_b16 v[40:41], v18 offset:32768
  v_mfma_f32_16x16x32_bf16 v[148:151], a[92:95], v[56:59], v[148:151]
  v_mfma_f32_16x16x32_bf16 v[176:179], a[156:159], v[56:59], v[176:179]
  ds_read_b64_tr_b16 v[42:43], v18 offset:33280
  v_mfma_f32_16x16x32_bf16 v[180:183], a[220:223], v[56:59], v[180:183]
  v_mfma_f32_16x16x32_bf16 v[152:155], a[28:31], v[60:63], v[152:155]
  ds_read_b64_tr_b16 v[44:45], v19 offset:32768
  v_mfma_f32_16x16x32_bf16 v[156:159], a[92:95], v[60:63], v[156:159]
  v_mfma_f32_16x16x32_bf16 v[184:187], a[156:159], v[60:63], v[184:187]
  s_waitcnt lgkmcnt(3)
  ds_read_b64_tr_b16 v[46:47], v19 offset:33280
  v_mfma_f32_16x16x32_bf16 v[188:191], a[220:223], v[60:63], v[188:191]
  v_mfma_f32_16x16x32_bf16 v[128:131], a[32:35], v[32:35], v[128:131]
  s_add_u32 m0, s64, 0
  ds_read_b64_tr_b16 v[48:49], v16 offset:36864
  v_mfma_f32_16x16x32_bf16 v[132:135], a[96:99], v[32:35], v[132:135]
  v_mfma_f32_16x16x32_bf16 v[160:163], a[160:163], v[32:35], v[160:163]
  s_add_u32 s63, s62, 0
  ds_read_b64_tr_b16 v[50:51], v16 offset:37376
  v_mfma_f32_16x16x32_bf16 v[164:167], a[224:227], v[32:35], v[164:167]
  buffer_load_dwordx4 v2, s[48:51], s63 offen lds
  v_mfma_f32_16x16x32_bf16 v[136:139], a[32:35], v[36:39], v[136:139]
  ds_read_b64_tr_b16 v[52:53], v17 offset:36864
  v_mfma_f32_16x16x32_bf16 v[140:143], a[96:99], v[36:39], v[140:143]
  v_mfma_f32_16x16x32_bf16 v[168:171], a[160:163], v[36:39], v[168:171]
  s_waitcnt lgkmcnt(3)
  ds_read_b64_tr_b16 v[54:55], v17 offset:37376
  v_mfma_f32_16x16x32_bf16 v[172:175], a[224:227], v[36:39], v[172:175]
  v_mfma_f32_16x16x32_bf16 v[144:147], a[32:35], v[40:43], v[144:147]
  s_add_u32 m0, s64, 1024
  ds_read_b64_tr_b16 v[56:57], v18 offset:36864
  v_mfma_f32_16x16x32_bf16 v[148:151], a[96:99], v[40:43], v[148:151]
  v_mfma_f32_16x16x32_bf16 v[176:179], a[160:163], v[40:43], v[176:179]
  s_add_u32 s63, s62, 65536
  ds_read_b64_tr_b16 v[58:59], v18 offset:37376
  v_mfma_f32_16x16x32_bf16 v[180:183], a[224:227], v[40:43], v[180:183]
  buffer_load_dwordx4 v3, s[48:51], s63 offen lds
  v_mfma_f32_16x16x32_bf16 v[152:155], a[32:35], v[44:47], v[152:155]
  ds_read_b64_tr_b16 v[60:61], v19 offset:36864
  v_mfma_f32_16x16x32_bf16 v[156:159], a[96:99], v[44:47], v[156:159]
  v_mfma_f32_16x16x32_bf16 v[184:187], a[160:163], v[44:47], v[184:187]
  s_waitcnt lgkmcnt(3)
  ds_read_b64_tr_b16 v[62:63], v19 offset:37376
  v_mfma_f32_16x16x32_bf16 v[188:191], a[224:227], v[44:47], v[188:191]
  v_mfma_f32_16x16x32_bf16 v[128:131], a[36:39], v[48:51], v[128:131]
  s_add_u32 m0, s64, 2048
  ds_read_b64_tr_b16 v[32:33], v16 offset:40960
  v_mfma_f32_16x16x32_bf16 v[132:135], a[100:103], v[48:51], v[132:135]
  v_mfma_f32_16x16x32_bf16 v[160:163], a[164:167], v[48:51], v[160:163]
  s_add_u32 s63, s62, 131072
  ds_read_b64_tr_b16 v[34:35], v16 offset:41472
  v_mfma_f32_16x16x32_bf16 v[164:167], a[228:231], v[48:51], v[164:167]
  buffer_load_dwordx4 v2, s[48:51], s63 offen lds
  v_mfma_f32_16x16x32_bf16 v[136:139], a[36:39], v[52:55], v[136:139]
  ds_read_b64_tr_b16 v[36:37], v17 offset:40960
  v_mfma_f32_16x16x32_bf16 v[140:143], a[100:103], v[52:55], v[140:143]
  v_mfma_f32_16x16x32_bf16 v[168:171], a[164:167], v[52:55], v[168:171]
  s_waitcnt lgkmcnt(3)
  ds_read_b64_tr_b16 v[38:39], v17 offset:41472
  v_mfma_f32_16x16x32_bf16 v[172:175], a[228:231], v[52:55], v[172:175]
  v_mfma_f32_16x16x32_bf16 v[144:147], a[36:39], v[56:59], v[144:147]
  s_add_u32 m0, s64, 3072
  ds_read_b64_tr_b16 v[40:41], v18 offset:40960
  v_mfma_f32_16x16x32_bf16 v[148:151], a[100:103], v[56:59], v[148:151]
  v_mfma_f32_16x16x32_bf16 v[176:179], a[164:167], v[56:59], v[176:179]
  s_add_u32 s63, s62, 196608
  ds_read_b64_tr_b16 v[42:43], v18 offset:41472
  v_mfma_f32_16x16x32_bf16 v[180:183], a[228:231], v[56:59], v[180:183]
  buffer_load_dwordx4 v3, s[48:51], s63 offen lds
  v_mfma_f32_16x16x32_bf16 v[152:155], a[36:39], v[60:63], v[152:155]
  s_bfe_u32 s67, s61, 0x50013
  ds_read_b64_tr_b16 v[44:45], v19 offset:40960
  v_mfma_f32_16x16x32_bf16 v[156:159], a[100:103], v[60:63], v[156:159]
  s_lshl_b32 s67, s67, 7
  v_mfma_f32_16x16x32_bf16 v[184:187], a[164:167], v[60:63], v[184:187]
  s_waitcnt lgkmcnt(3)
  s_bfe_u32 s68, s61, 0x20004
  ds_read_b64_tr_b16 v[46:47], v19 offset:41472
  v_mfma_f32_16x16x32_bf16 v[188:191], a[228:231], v[60:63], v[188:191]
  s_lshl_b32 s68, s68, 5
  v_mfma_f32_16x16x32_bf16 v[128:131], a[40:43], v[32:35], v[128:131]
  s_or_b32 s69, s67, s68
  ds_read_b64_tr_b16 v[48:49], v16 offset:45056
  v_mfma_f32_16x16x32_bf16 v[132:135], a[104:107], v[32:35], v[132:135]
  s_bitcmp1_b32 s61, 2
  v_mfma_f32_16x16x32_bf16 v[160:163], a[168:171], v[32:35], v[160:163]
  s_cselect_b32 s69, 0x40000000, s69
  ds_read_b64_tr_b16 v[50:51], v16 offset:45568
  v_mfma_f32_16x16x32_bf16 v[164:167], a[232:235], v[32:35], v[164:167]
  v_mfma_f32_16x16x32_bf16 v[136:139], a[40:43], v[36:39], v[136:139]
  ds_read_b64_tr_b16 v[52:53], v17 offset:45056
  v_mfma_f32_16x16x32_bf16 v[140:143], a[104:107], v[36:39], v[140:143]
  v_mfma_f32_16x16x32_bf16 v[168:171], a[168:171], v[36:39], v[168:171]
  s_waitcnt lgkmcnt(3)
  ds_read_b64_tr_b16 v[54:55], v17 offset:45568
  v_mfma_f32_16x16x32_bf16 v[172:175], a[232:235], v[36:39], v[172:175]
  v_mfma_f32_16x16x32_bf16 v[144:147], a[40:43], v[40:43], v[144:147]
  ds_read_b64_tr_b16 v[56:57], v18 offset:45056
  v_mfma_f32_16x16x32_bf16 v[148:151], a[104:107], v[40:43], v[148:151]
  v_mfma_f32_16x16x32_bf16 v[176:179], a[168:171], v[40:43], v[176:179]
  ds_read_b64_tr_b16 v[58:59], v18 offset:45568
  v_mfma_f32_16x16x32_bf16 v[180:183], a[232:235], v[40:43], v[180:183]
  v_mfma_f32_16x16x32_bf16 v[152:155], a[40:43], v[44:47], v[152:155]
  s_waitcnt vmcnt(28)
  ds_read_b64_tr_b16 v[60:61], v19 offset:45056
  v_mfma_f32_16x16x32_bf16 v[156:159], a[104:107], v[44:47], v[156:159]
  s_barrier
  v_mfma_f32_16x16x32_bf16 v[184:187], a[168:171], v[44:47], v[184:187]
  s_waitcnt lgkmcnt(3)
  ds_read_b64_tr_b16 v[62:63], v19 offset:45568
  v_mfma_f32_16x16x32_bf16 v[188:191], a[232:235], v[44:47], v[188:191]
  buffer_atomic_add v11, v10, s[40:43], s69 offen
  v_mfma_f32_16x16x32_bf16 v[128:131], a[44:47], v[48:51], v[128:131]
  ds_read_b64_tr_b16 v[32:33], v16 offset:49152
  v_mfma_f32_16x16x32_bf16 v[132:135], a[108:111], v[48:51], v[132:135]
  v_mfma_f32_16x16x32_bf16 v[160:163], a[172:175], v[48:51], v[160:163]
  ds_read_b64_tr_b16 v[34:35], v16 offset:49664
  v_mfma_f32_16x16x32_bf16 v[164:167], a[236:239], v[48:51], v[164:167]
  v_mfma_f32_16x16x32_bf16 v[136:139], a[44:47], v[52:55], v[136:139]
  ds_read_b64_tr_b16 v[36:37], v17 offset:49152
  v_mfma_f32_16x16x32_bf16 v[140:143], a[108:111], v[52:55], v[140:143]
  v_mfma_f32_16x16x32_bf16 v[168:171], a[172:175], v[52:55], v[168:171]
  s_waitcnt lgkmcnt(3)
  ds_read_b64_tr_b16 v[38:39], v17 offset:49664
  v_mfma_f32_16x16x32_bf16 v[172:175], a[236:239], v[52:55], v[172:175]
  v_mfma_f32_16x16x32_bf16 v[144:147], a[44:47], v[56:59], v[144:147]
  ds_read_b64_tr_b16 v[40:41], v18 offset:49152
  v_mfma_f32_16x16x32_bf16 v[148:151], a[108:111], v[56:59], v[148:151]
  v_mfma_f32_16x16x32_bf16 v[176:179], a[172:175], v[56:59], v[176:179]
  ds_read_b64_tr_b16 v[42:43], v18 offset:49664
  v_mfma_f32_16x16x32_bf16 v[180:183], a[236:239], v[56:59], v[180:183]
  v_mfma_f32_16x16x32_bf16 v[152:155], a[44:47], v[60:63], v[152:155]
  ds_read_b64_tr_b16 v[44:45], v19 offset:49152
  v_mfma_f32_16x16x32_bf16 v[156:159], a[108:111], v[60:63], v[156:159]
  v_mfma_f32_16x16x32_bf16 v[184:187], a[172:175], v[60:63], v[184:187]
  s_waitcnt lgkmcnt(3)
  ds_read_b64_tr_b16 v[46:47], v19 offset:49664
  v_mfma_f32_16x16x32_bf16 v[188:191], a[236:239], v[60:63], v[188:191]
  v_mfma_f32_16x16x32_bf16 v[128:131], a[48:51], v[32:35], v[128:131]
  s_add_u32 m0, s64, 16384
  ds_read_b64_tr_b16 v[48:49], v16 offset:53248
  v_mfma_f32_16x16x32_bf16 v[132:135], a[112:115], v[32:35], v[132:135]
  v_mfma_f32_16x16x32_bf16 v[160:163], a[176:179], v[32:35], v[160:163]
  s_add_u32 s63, s62, 1048576
  ds_read_b64_tr_b16 v[50:51], v16 offset:53760
  v_mfma_f32_16x16x32_bf16 v[164:167], a[240:243], v[32:35], v[164:167]
  buffer_load_dwordx4 v2, s[48:51], s63 offen lds
  v_mfma_f32_16x16x32_bf16 v[136:139], a[48:51], v[36:39], v[136:139]
  ds_read_b64_tr_b16 v[52:53], v17 offset:53248
  v_mfma_f32_16x16x32_bf16 v[140:143], a[112:115], v[36:39], v[140:143]
  v_mfma_f32_16x16x32_bf16 v[168:171], a[176:179], v[36:39], v[168:171]
  s_waitcnt lgkmcnt(3)
  ds_read_b64_tr_b16 v[54:55], v17 offset:53760
  v_mfma_f32_16x16x32_bf16 v[172:175], a[240:243], v[36:39], v[172:175]
  v_mfma_f32_16x16x32_bf16 v[144:147], a[48:51], v[40:43], v[144:147]
  s_add_u32 m0, s64, 17408
  ds_read_b64_tr_b16 v[56:57], v18 offset:53248
  v_mfma_f32_16x16x32_bf16 v[148:151], a[112:115], v[40:43], v[148:151]
  v_mfma_f32_16x16x32_bf16 v[176:179], a[176:179], v[40:43], v[176:179]
  s_add_u32 s63, s62, 1114112
  ds_read_b64_tr_b16 v[58:59], v18 offset:53760
  v_mfma_f32_16x16x32_bf16 v[180:183], a[240:243], v[40:43], v[180:183]
  buffer_load_dwordx4 v3, s[48:51], s63 offen lds
  v_mfma_f32_16x16x32_bf16 v[152:155], a[48:51], v[44:47], v[152:155]
  ds_read_b64_tr_b16 v[60:61], v19 offset:53248
  v_mfma_f32_16x16x32_bf16 v[156:159], a[112:115], v[44:47], v[156:159]
  v_mfma_f32_16x16x32_bf16 v[184:187], a[176:179], v[44:47], v[184:187]
  s_waitcnt lgkmcnt(3)
  ds_read_b64_tr_b16 v[62:63], v19 offset:53760
  v_mfma_f32_16x16x32_bf16 v[188:191], a[240:243], v[44:47], v[188:191]
  v_mfma_f32_16x16x32_bf16 v[128:131], a[52:55], v[48:51], v[128:131]
  s_add_u32 m0, s64, 18432
  ds_read_b64_tr_b16 v[32:33], v16 offset:57344
  v_mfma_f32_16x16x32_bf16 v[132:135], a[116:119], v[48:51], v[132:135]
  v_mfma_f32_16x16x32_bf16 v[160:163], a[180:183], v[48:51], v[160:163]
  s_add_u32 s63, s62, 1179648
  ds_read_b64_tr_b16 v[34:35], v16 offset:57856
  v_mfma_f32_16x16x32_bf16 v[164:167], a[244:247], v[48:51], v[164:167]
  buffer_load_dwordx4 v2, s[48:51], s63 offen lds
  v_mfma_f32_16x16x32_bf16 v[136:139], a[52:55], v[52:55], v[136:139]
  ds_read_b64_tr_b16 v[36:37], v17 offset:57344
  v_mfma_f32_16x16x32_bf16 v[140:143], a[116:119], v[52:55], v[140:143]
  v_mfma_f32_16x16x32_bf16 v[168:171], a[180:183], v[52:55], v[168:171]
  s_waitcnt lgkmcnt(3)
  ds_read_b64_tr_b16 v[38:39], v17 offset:57856
  v_mfma_f32_16x16x32_bf16 v[172:175], a[244:247], v[52:55], v[172:175]
  v_mfma_f32_16x16x32_bf16 v[144:147], a[52:55], v[56:59], v[144:147]
  s_add_u32 m0, s64, 19456
  ds_read_b64_tr_b16 v[40:41], v18 offset:57344
  v_mfma_f32_16x16x32_bf16 v[148:151], a[116:119], v[56:59], v[148:151]
  v_mfma_f32_16x16x32_bf16 v[176:179], a[180:183], v[56:59], v[176:179]
  s_add_u32 s63, s62, 1245184
  ds_read_b64_tr_b16 v[42:43], v18 offset:57856
  v_mfma_f32_16x16x32_bf16 v[180:183], a[244:247], v[56:59], v[180:183]
  buffer_load_dwordx4 v3, s[48:51], s63 offen lds
  v_mfma_f32_16x16x32_bf16 v[152:155], a[52:55], v[60:63], v[152:155]
  ds_read_b64_tr_b16 v[44:45], v19 offset:57344
  v_mfma_f32_16x16x32_bf16 v[156:159], a[116:119], v[60:63], v[156:159]
  v_mfma_f32_16x16x32_bf16 v[184:187], a[180:183], v[60:63], v[184:187]
  s_waitcnt lgkmcnt(3)
  ds_read_b64_tr_b16 v[46:47], v19 offset:57856
  v_mfma_f32_16x16x32_bf16 v[188:191], a[244:247], v[60:63], v[188:191]
  v_mfma_f32_16x16x32_bf16 v[128:131], a[56:59], v[32:35], v[128:131]
  ds_read_b64_tr_b16 v[48:49], v16 offset:61440
  v_mfma_f32_16x16x32_bf16 v[132:135], a[120:123], v[32:35], v[132:135]
  v_mfma_f32_16x16x32_bf16 v[160:163], a[184:187], v[32:35], v[160:163]
  ds_read_b64_tr_b16 v[50:51], v16 offset:61952
  v_mfma_f32_16x16x32_bf16 v[164:167], a[248:251], v[32:35], v[164:167]
  v_mfma_f32_16x16x32_bf16 v[136:139], a[56:59], v[36:39], v[136:139]
  ds_read_b64_tr_b16 v[52:53], v17 offset:61440
  v_mfma_f32_16x16x32_bf16 v[140:143], a[120:123], v[36:39], v[140:143]
  v_mfma_f32_16x16x32_bf16 v[168:171], a[184:187], v[36:39], v[168:171]
  s_waitcnt lgkmcnt(3)
  ds_read_b64_tr_b16 v[54:55], v17 offset:61952
  v_mfma_f32_16x16x32_bf16 v[172:175], a[248:251], v[36:39], v[172:175]
  v_mfma_f32_16x16x32_bf16 v[144:147], a[56:59], v[40:43], v[144:147]
  ds_read_b64_tr_b16 v[56:57], v18 offset:61440
  v_mfma_f32_16x16x32_bf16 v[148:151], a[120:123], v[40:43], v[148:151]
  v_mfma_f32_16x16x32_bf16 v[176:179], a[184:187], v[40:43], v[176:179]
  ds_read_b64_tr_b16 v[58:59], v18 offset:61952
  v_mfma_f32_16x16x32_bf16 v[180:183], a[248:251], v[40:43], v[180:183]
  v_mfma_f32_16x16x32_bf16 v[152:155], a[56:59], v[44:47], v[152:155]
  s_waitcnt vmcnt(28)
  ds_read_b64_tr_b16 v[60:61], v19 offset:61440
  v_mfma_f32_16x16x32_bf16 v[156:159], a[120:123], v[44:47], v[156:159]
  s_barrier
  v_mfma_f32_16x16x32_bf16 v[184:187], a[184:187], v[44:47], v[184:187]
  s_waitcnt lgkmcnt(3)
  ds_read_b64_tr_b16 v[62:63], v19 offset:61952
  v_mfma_f32_16x16x32_bf16 v[188:191], a[248:251], v[44:47], v[188:191]
  v_mfma_f32_16x16x32_bf16 v[128:131], a[60:63], v[48:51], v[128:131]
  s_mov_b32 s61, s60
  ds_read_b64_tr_b16 v[32:33], v20 offset:0
  v_mfma_f32_16x16x32_bf16 v[132:135], a[124:127], v[48:51], v[132:135]
  s_mov_b32 s60, s57
  v_mfma_f32_16x16x32_bf16 v[160:163], a[188:191], v[48:51], v[160:163]
  s_mov_b32 s57, s58
  ds_read_b64_tr_b16 v[34:35], v20 offset:512
  v_mfma_f32_16x16x32_bf16 v[164:167], a[252:255], v[48:51], v[164:167]
  s_mov_b32 s58, s59
  v_mfma_f32_16x16x32_bf16 v[136:139], a[60:63], v[52:55], v[136:139]
  s_add_u32 s56, s56, 1
  ds_read_b64_tr_b16 v[36:37], v21 offset:0
  v_mfma_f32_16x16x32_bf16 v[140:143], a[124:127], v[52:55], v[140:143]
  v_mfma_f32_16x16x32_bf16 v[168:171], a[188:191], v[52:55], v[168:171]
  s_waitcnt lgkmcnt(3)
  ds_read_b64_tr_b16 v[38:39], v21 offset:512
  v_mfma_f32_16x16x32_bf16 v[172:175], a[252:255], v[52:55], v[172:175]
  v_mfma_f32_16x16x32_bf16 v[144:147], a[60:63], v[56:59], v[144:147]
  ds_read_b64_tr_b16 v[40:41], v22 offset:0
  v_mfma_f32_16x16x32_bf16 v[148:151], a[124:127], v[56:59], v[148:151]
  v_mfma_f32_16x16x32_bf16 v[176:179], a[188:191], v[56:59], v[176:179]
  ds_read_b64_tr_b16 v[42:43], v22 offset:512
  v_mfma_f32_16x16x32_bf16 v[180:183], a[252:255], v[56:59], v[180:183]
  v_mfma_f32_16x16x32_bf16 v[152:155], a[60:63], v[60:63], v[152:155]
  ds_read_b64_tr_b16 v[44:45], v23 offset:0
  v_mfma_f32_16x16x32_bf16 v[156:159], a[124:127], v[60:63], v[156:159]
  v_mfma_f32_16x16x32_bf16 v[184:187], a[188:191], v[60:63], v[184:187]
  s_waitcnt lgkmcnt(3)
  ds_read_b64_tr_b16 v[46:47], v23 offset:512
  v_mfma_f32_16x16x32_bf16 v[188:191], a[252:255], v[60:63], v[188:191]
  s_bitcmp1_b32 s57, 2
  s_cbranch_scc1 L_p_done_0
  s_bitcmp1_b32 s57, 0
  s_cbranch_scc1 L_p_body_1_1
  s_branch L_p_body_1_0
L_p_body_1_0:
  v_mfma_f32_16x16x32_bf16 v[192:195], v[32:35], a[0:3], 0
  s_add_u32 m0, s64, 32768
  ds_read_b64_tr_b16 v[48:49], v20 offset:4096
  v_mfma_f32_16x16x32_bf16 v[200:203], v[32:35], a[64:67], 0
  v_mfma_f32_16x16x32_bf16 v[224:227], v[32:35], a[128:131], 0
  s_add_u32 s63, s62, 2097152
  ds_read_b64_tr_b16 v[50:51], v20 offset:4608
  v_mfma_f32_16x16x32_bf16 v[232:235], v[32:35], a[192:195], 0
  buffer_load_dwordx4 v2, s[48:51], s63 offen lds
  v_mfma_f32_16x16x32_bf16 v[196:199], v[36:39], a[0:3], 0
  s_and_b32 s65, s60, 0x7fff000
  s_bitcmp1_b32 s60, 2
  s_cselect_b32 s65, 0x40000000, s65
  ds_read_b64_tr_b16 v[52:53], v21 offset:4096
  v_mfma_f32_16x16x32_bf16 v[204:207], v[36:39], a[64:67], 0
  s_bitcmp1_b32 s60, 1
  s_cselect_b32 s66, 0x3e0293ee, 1.0
  v_mfma_f32_16x16x32_bf16 v[228:231], v[36:39], a[128:131], 0
  s_waitcnt lgkmcnt(3)
  ds_read_b64_tr_b16 v[54:55], v21 offset:4608
  v_mfma_f32_16x16x32_bf16 v[236:239], v[36:39], a[192:195], 0
  v_mfma_f32_16x16x32_bf16 v[208:211], v[40:43], a[0:3], 0
  s_add_u32 m0, s64, 33792
  ds_read_b64_tr_b16 v[56:57], v22 offset:4096
  v_mfma_f32_16x16x32_bf16 v[216:219], v[40:43], a[64:67], 0
  v_mfma_f32_16x16x32_bf16 v[240:243], v[40:43], a[128:131], 0
  s_add_u32 s63, s62, 2162688
  ds_read_b64_tr_b16 v[58:59], v22 offset:4608
  v_mul_f32 v128, s66, v128
  v_mfma_f32_16x16x32_bf16 v[248:251], v[40:43], a[192:195], 0
  buffer_load_dwordx4 v3, s[48:51], s63 offen lds
  v_mul_f32 v129, s66, v129
  v_cvt_pk_bf16_f32 v64, v128, v129
  v_mfma_f32_16x16x32_bf16 v[212:215], v[44:47], a[0:3], 0
  ds_read_b64_tr_b16 v[60:61], v23 offset:4096
  v_mul_f32 v130, s66, v130
  v_mfma_f32_16x16x32_bf16 v[220:223], v[44:47], a[64:67], 0
  v_mul_f32 v131, s66, v131
  v_cvt_pk_bf16_f32 v65, v130, v131
  v_mfma_f32_16x16x32_bf16 v[244:247], v[44:47], a[128:131], 0
  s_waitcnt lgkmcnt(3)
  ds_read_b64_tr_b16 v[62:63], v23 offset:4608
  v_mul_f32 v132, s66, v132
  v_mfma_f32_16x16x32_bf16 v[252:255], v[44:47], a[192:195], 0
  v_mul_f32 v133, s66, v133
  v_cvt_pk_bf16_f32 v66, v132, v133
  v_mfma_f32_16x16x32_bf16 v[192:195], v[48:51], a[4:7], v[192:195]
  s_add_u32 m0, s64, 34816
  ds_read_b64_tr_b16 v[32:33], v20 offset:8192
  v_readlane_b32 s59, v1, s56
  v_mfma_f32_16x16x32_bf16 v[200:203], v[48:51], a[68:71], v[200:203]
  v_mul_f32 v134, s66, v134
  v_mul_f32 v135, s66, v135
  v_cvt_pk_bf16_f32 v67, v134, v135
  v_mfma_f32_16x16x32_bf16 v[224:227], v[48:51], a[132:135], v[224:227]
  s_add_u32 s63, s62, 2228224
  ds_read_b64_tr_b16 v[34:35], v20 offset:8704
  v_mfma_f32_16x16x32_bf16 v[232:235], v[48:51], a[196:199], v[232:235]
  buffer_load_dwordx4 v2, s[48:51], s63 offen lds
  v_mfma_f32_16x16x32_bf16 v[196:199], v[52:55], a[4:7], v[196:199]
  ds_read_b64_tr_b16 v[36:37], v21 offset:8192
  v_mul_f32 v136, s66, v136
  v_mfma_f32_16x16x32_bf16 v[204:207], v[52:55], a[68:71], v[204:207]
  buffer_store_dwordx4 v[64:67], v8, s[40:43], s65 offen offset:0 sc1
  v_mul_f32 v137, s66, v137
  v_cvt_pk_bf16_f32 v68, v136, v137
  v_mfma_f32_16x16x32_bf16 v[228:231], v[52:55], a[132:135], v[228:231]
  s_waitcnt lgkmcnt(3)
  ds_read_b64_tr_b16 v[38:39], v21 offset:8704
  v_mul_f32 v138, s66, v138
  v_mfma_f32_16x16x32_bf16 v[236:239], v[52:55], a[196:199], v[236:239]
  v_mul_f32 v139, s66, v139
  v_cvt_pk_bf16_f32 v69, v138, v139
  v_mfma_f32_16x16x32_bf16 v[208:211], v[56:59], a[4:7], v[208:211]
  s_add_u32 m0, s64, 35840
  ds_read_b64_tr_b16 v[40:41], v22 offset:8192
  v_mul_f32 v140, s66, v140
  v_mfma_f32_16x16x32_bf16 v[216:219], v[56:59], a[68:71], v[216:219]
  v_mul_f32 v141, s66, v141
  v_cvt_pk_bf16_f32 v70, v140, v141
  v_mfma_f32_16x16x32_bf16 v[240:243], v[56:59], a[132:135], v[240:243]
  s_add_u32 s63, s62, 2293760
  ds_read_b64_tr_b16 v[42:43], v22 offset:8704
  v_mul_f32 v142, s66, v142
  v_mfma_f32_16x16x32_bf16 v[248:251], v[56:59], a[196:199], v[248:251]
  buffer_load_dwordx4 v3, s[48:51], s63 offen lds
  v_mul_f32 v143, s66, v143
  v_cvt_pk_bf16_f32 v71, v142, v143
  v_mfma_f32_16x16x32_bf16 v[212:215], v[60:63], a[4:7], v[212:215]
  ds_read_b64_tr_b16 v[44:45], v23 offset:8192
  v_mfma_f32_16x16x32_bf16 v[220:223], v[60:63], a[68:71], v[220:223]
  v_mfma_f32_16x16x32_bf16 v[244:247], v[60:63], a[132:135], v[244:247]
  s_waitcnt lgkmcnt(3)
  ds_read_b64_tr_b16 v[46:47], v23 offset:8704
  v_mfma_f32_16x16x32_bf16 v[252:255], v[60:63], a[196:199], v[252:255]
  buffer_store_dwordx4 v[68:71], v8, s[40:43], s65 offen offset:1024 sc1
  v_mfma_f32_16x16x32_bf16 v[192:195], v[32:35], a[8:11], v[192:195]
  ds_read_b64_tr_b16 v[48:49], v20 offset:12288
  v_mfma_f32_16x16x32_bf16 v[200:203], v[32:35], a[72:75], v[200:203]
  v_mfma_f32_16x16x32_bf16 v[224:227], v[32:35], a[136:139], v[224:227]
  ds_read_b64_tr_b16 v[50:51], v20 offset:12800
  v_mfma_f32_16x16x32_bf16 v[232:235], v[32:35], a[200:203], v[232:235]
  v_mfma_f32_16x16x32_bf16 v[196:199], v[36:39], a[8:11], v[196:199]
  ds_read_b64_tr_b16 v[52:53], v21 offset:12288
  v_mfma_f32_16x16x32_bf16 v[204:207], v[36:39], a[72:75], v[204:207]
  v_mfma_f32_16x16x32_bf16 v[228:231], v[36:39], a[136:139], v[228:231]
  s_waitcnt lgkmcnt(3)
  ds_read_b64_tr_b16 v[54:55], v21 offset:12800
  v_mul_f32 v144, s66, v144
  v_mfma_f32_16x16x32_bf16 v[236:239], v[36:39], a[200:203], v[236:239]
  v_mul_f32 v145, s66, v145
  v_cvt_pk_bf16_f32 v72, v144, v145
  v_mfma_f32_16x16x32_bf16 v[208:211], v[40:43], a[8:11], v[208:211]
  ds_read_b64_tr_b16 v[56:57], v22 offset:12288
  v_mul_f32 v146, s66, v146
  v_mfma_f32_16x16x32_bf16 v[216:219], v[40:43], a[72:75], v[216:219]
  v_mul_f32 v147, s66, v147
  v_cvt_pk_bf16_f32 v73, v146, v147
  v_mfma_f32_16x16x32_bf16 v[240:243], v[40:43], a[136:139], v[240:243]
  ds_read_b64_tr_b16 v[58:59], v22 offset:12800
  v_mul_f32 v148, s66, v148
  v_mfma_f32_16x16x32_bf16 v[248:251], v[40:43], a[200:203], v[248:251]
  v_mul_f32 v149, s66, v149
  v_cvt_pk_bf16_f32 v74, v148, v149
  v_mfma_f32_16x16x32_bf16 v[212:215], v[44:47], a[8:11], v[212:215]
  s_waitcnt vmcnt(28)
  ds_read_b64_tr_b16 v[60:61], v23 offset:12288
  v_mul_f32 v150, s66, v150
  v_mfma_f32_16x16x32_bf16 v[220:223], v[44:47], a[72:75], v[220:223]
  s_barrier
  v_mul_f32 v151, s66, v151
  v_cvt_pk_bf16_f32 v75, v150, v151
  v_mfma_f32_16x16x32_bf16 v[244:247], v[44:47], a[136:139], v[244:247]
  s_waitcnt lgkmcnt(3)
  ds_read_b64_tr_b16 v[62:63], v23 offset:12800
  v_mfma_f32_16x16x32_bf16 v[252:255], v[44:47], a[200:203], v[252:255]
  v_mfma_f32_16x16x32_bf16 v[192:195], v[48:51], a[12:15], v[192:195]
  ds_read_b64_tr_b16 v[32:33], v20 offset:16384
  v_mul_f32 v152, s66, v152
  v_mfma_f32_16x16x32_bf16 v[200:203], v[48:51], a[76:79], v[200:203]
  buffer_store_dwordx4 v[72:75], v8, s[40:43], s65 offen offset:2048 sc1
  v_mul_f32 v153, s66, v153
  v_cvt_pk_bf16_f32 v76, v152, v153
  v_mfma_f32_16x16x32_bf16 v[224:227], v[48:51], a[140:143], v[224:227]
  ds_read_b64_tr_b16 v[34:35], v20 offset:16896
  v_mul_f32 v154, s66, v154
  v_mfma_f32_16x16x32_bf16 v[232:235], v[48:51], a[204:207], v[232:235]
  v_mul_f32 v155, s66, v155
  v_cvt_pk_bf16_f32 v77, v154, v155
  v_mfma_f32_16x16x32_bf16 v[196:199], v[52:55], a[12:15], v[196:199]
  ds_read_b64_tr_b16 v[36:37], v21 offset:16384
  v_mul_f32 v156, s66, v156
  v_mfma_f32_16x16x32_bf16 v[204:207], v[52:55], a[76:79], v[204:207]
  v_mul_f32 v157, s66, v157
  v_cvt_pk_bf16_f32 v78, v156, v157
  v_mfma_f32_16x16x32_bf16 v[228:231], v[52:55], a[140:143], v[228:231]
  s_waitcnt lgkmcnt(3)
  ds_read_b64_tr_b16 v[38:39], v21 offset:16896
  v_mul_f32 v158, s66, v158
  v_mfma_f32_16x16x32_bf16 v[236:239], v[52:55], a[204:207], v[236:239]
  v_mul_f32 v159, s66, v159
  v_cvt_pk_bf16_f32 v79, v158, v159
  v_mfma_f32_16x16x32_bf16 v[208:211], v[56:59], a[12:15], v[208:211]
  ds_read_b64_tr_b16 v[40:41], v22 offset:16384
  v_mfma_f32_16x16x32_bf16 v[216:219], v[56:59], a[76:79], v[216:219]
  v_mfma_f32_16x16x32_bf16 v[240:243], v[56:59], a[140:143], v[240:243]
  ds_read_b64_tr_b16 v[42:43], v22 offset:16896
  v_mfma_f32_16x16x32_bf16 v[248:251], v[56:59], a[204:207], v[248:251]
  buffer_store_dwordx4 v[76:79], v8, s[40:43], s65 offen offset:3072 sc1
  v_mfma_f32_16x16x32_bf16 v[212:215], v[60:63], a[12:15], v[212:215]
  ds_read_b64_tr_b16 v[44:45], v23 offset:16384
  v_mfma_f32_16x16x32_bf16 v[220:223], v[60:63], a[76:79], v[220:223]
  v_mfma_f32_16x16x32_bf16 v[244:247], v[60:63], a[140:143], v[244:247]
  s_waitcnt lgkmcnt(3)
  ds_read_b64_tr_b16 v[46:47], v23 offset:16896
  v_mfma_f32_16x16x32_bf16 v[252:255], v[60:63], a[204:207], v[252:255]
  v_mfma_f32_16x16x32_bf16 v[192:195], v[32:35], a[16:19], v[192:195]
  s_add_u32 m0, s64, 49152
  ds_read_b64_tr_b16 v[48:49], v20 offset:20480
  v_mfma_f32_16x16x32_bf16 v[200:203], v[32:35], a[80:83], v[200:203]
  v_mfma_f32_16x16x32_bf16 v[224:227], v[32:35], a[144:147], v[224:227]
  s_add_u32 s63, s62, 3145728
  ds_read_b64_tr_b16 v[50:51], v20 offset:20992
  v_mul_f32 v160, s66, v160
  v_mfma_f32_16x16x32_bf16 v[232:235], v[32:35], a[208:211], v[232:235]
  buffer_load_dwordx4 v2, s[48:51], s63 offen lds
  v_mul_f32 v161, s66, v161
  v_cvt_pk_bf16_f32 v64, v160, v161
  v_mfma_f32_16x16x32_bf16 v[196:199], v[36:39], a[16:19], v[196:199]
  ds_read_b64_tr_b16 v[52:53], v21 offset:20480
  v_mul_f32 v162, s66, v162
  v_mfma_f32_16x16x32_bf16 v[204:207], v[36:39], a[80:83], v[204:207]
  v_mul_f32 v163, s66, v163
  v_cvt_pk_bf16_f32 v65, v162, v163
  v_mfma_f32_16x16x32_bf16 v[228:231], v[36:39], a[144:147], v[228:231]
  s_waitcnt lgkmcnt(3)
  ds_read_b64_tr_b16 v[54:55], v21 offset:20992
  v_mul_f32 v164, s66, v164
  v_mfma_f32_16x16x32_bf16 v[236:239], v[36:39], a[208:211], v[236:239]
  v_mul_f32 v165, s66, v165
  v_cvt_pk_bf16_f32 v66, v164, v165
  v_mfma_f32_16x16x32_bf16 v[208:211], v[40:43], a[16:19], v[208:211]
  s_add_u32 m0, s64, 50176
  ds_read_b64_tr_b16 v[56:57], v22 offset:20480
  v_mul_f32 v166, s66, v166
  v_mfma_f32_16x16x32_bf16 v[216:219], v[40:43], a[80:83], v[216:219]
  v_mul_f32 v167, s66, v167
  v_cvt_pk_bf16_f32 v67, v166, v167
  v_mfma_f32_16x16x32_bf16 v[240:243], v[40:43], a[144:147], v[240:243]
  s_add_u32 s63, s62, 3211264
  ds_read_b64_tr_b16 v[58:59], v22 offset:20992
  v_mfma_f32_16x16x32_bf16 v[248:251], v[40:43], a[208:211], v[248:251]
  buffer_load_dwordx4 v3, s[48:51], s63 offen lds
  v_mfma_f32_16x16x32_bf16 v[212:215], v[44:47], a[16:19], v[212:215]
  ds_read_b64_tr_b16 v[60:61], v23 offset:20480
  v_mul_f32 v168, s66, v168
  v_mfma_f32_16x16x32_bf16 v[220:223], v[44:47], a[80:83], v[220:223]
  buffer_store_dwordx4 v[64:67], v9, s[40:43], s65 offen offset:0 sc1
  v_mul_f32 v169, s66, v169
  v_cvt_pk_bf16_f32 v68, v168, v169
  v_mfma_f32_16x16x32_bf16 v[244:247], v[44:47], a[144:147], v[244:247]
  s_waitcnt lgkmcnt(3)
  ds_read_b64_tr_b16 v[62:63], v23 offset:20992
  v_mul_f32 v170, s66, v170
  v_mfma_f32_16x16x32_bf16 v[252:255], v[44:47], a[208:211], v[252:255]
  v_mul_f32 v171, s66, v171
  v_cvt_pk_bf16_f32 v69, v170, v171
  v_mfma_f32_16x16x32_bf16 v[192:195], v[48:51], a[20:23], v[192:195]
  s_add_u32 m0, s64, 51200
  ds_read_b64_tr_b16 v[32:33], v20 offset:24576
  v_mul_f32 v172, s66, v172
  v_mfma_f32_16x16x32_bf16 v[200:203], v[48:51], a[84:87], v[200:203]
  v_mul_f32 v173, s66, v173
  v_cvt_pk_bf16_f32 v70, v172, v173
  v_mfma_f32_16x16x32_bf16 v[224:227], v[48:51], a[148:151], v[224:227]
  s_add_u32 s63, s62, 3276800
  ds_read_b64_tr_b16 v[34:35], v20 offset:25088
  v_mul_f32 v174, s66, v174
  v_mfma_f32_16x16x32_bf16 v[232:235], v[48:51], a[212:215], v[232:235]
  buffer_load_dwordx4 v2, s[48:51], s63 offen lds
  v_mul_f32 v175, s66, v175
  v_cvt_pk_bf16_f32 v71, v174, v175
  v_mfma_f32_16x16x32_bf16 v[196:199], v[52:55], a[20:23], v[196:199]
  ds_read_b64_tr_b16 v[36:37], v21 offset:24576
  v_mfma_f32_16x16x32_bf16 v[204:207], v[52:55], a[84:87], v[204:207]
  v_mfma_f32_16x16x32_bf16 v[228:231], v[52:55], a[148:151], v[228:231]
  s_waitcnt lgkmcnt(3)
  ds_read_b64_tr_b16 v[38:39], v21 offset:25088
  v_mfma_f32_16x16x32_bf16 v[236:239], v[52:55], a[212:215], v[236:239]
  buffer_store_dwordx4 v[68:71], v9, s[40:43], s65 offen offset:1024 sc1
  v_mfma_f32_16x16x32_bf16 v[208:211], v[56:59], a[20:23], v[208:211]
  s_add_u32 m0, s64, 52224
  ds_read_b64_tr_b16 v[40:41], v22 offset:24576
  v_mfma_f32_16x16x32_bf16 v[216:219], v[56:59], a[84:87], v[216:219]
  v_mfma_f32_16x16x32_bf16 v[240:243], v[56:59], a[148:151], v[240:243]
  s_add_u32 s63, s62, 3342336
  ds_read_b64_tr_b16 v[42:43], v22 offset:25088
  v_mfma_f32_16x16x32_bf16 v[248:251], v[56:59], a[212:215], v[248:251]
  buffer_load_dwordx4 v3, s[48:51], s63 offen lds
  v_mfma_f32_16x16x32_bf16 v[212:215], v[60:63], a[20:23], v[212:215]
  ds_read_b64_tr_b16 v[44:45], v23 offset:24576
  v_mfma_f32_16x16x32_bf16 v[220:223], v[60:63], a[84:87], v[220:223]
  v_mfma_f32_16x16x32_bf16 v[244:247], v[60:63], a[148:151], v[244:247]
  s_waitcnt lgkmcnt(3)
  ds_read_b64_tr_b16 v[46:47], v23 offset:25088
  v_mul_f32 v176, s66, v176
  v_mfma_f32_16x16x32_bf16 v[252:255], v[60:63], a[212:215], v[252:255]
  v_mul_f32 v177, s66, v177
  v_cvt_pk_bf16_f32 v72, v176, v177
  v_mfma_f32_16x16x32_bf16 v[192:195], v[32:35], a[24:27], v[192:195]
  ds_read_b64_tr_b16 v[48:49], v20 offset:28672
  v_mul_f32 v178, s66, v178
  v_mfma_f32_16x16x32_bf16 v[200:203], v[32:35], a[88:91], v[200:203]
  v_mul_f32 v179, s66, v179
  v_cvt_pk_bf16_f32 v73, v178, v179
  v_mfma_f32_16x16x32_bf16 v[224:227], v[32:35], a[152:155], v[224:227]
  ds_read_b64_tr_b16 v[50:51], v20 offset:29184
  v_mul_f32 v180, s66, v180
  v_mfma_f32_16x16x32_bf16 v[232:235], v[32:35], a[216:219], v[232:235]
  v_mul_f32 v181, s66, v181
  v_cvt_pk_bf16_f32 v74, v180, v181
  v_mfma_f32_16x16x32_bf16 v[196:199], v[36:39], a[24:27], v[196:199]
  s_bfe_u32 s67, s59, 0x30018
  ds_read_b64_tr_b16 v[52:53], v21 offset:28672
  v_mul_f32 v182, s66, v182
  v_mfma_f32_16x16x32_bf16 v[204:207], v[36:39], a[88:91], v[204:207]
  s_mov_b64 s[48:49], s[12:13]
  v_mul_f32 v183, s66, v183
  v_cvt_pk_bf16_f32 v75, v182, v183
  v_mfma_f32_16x16x32_bf16 v[228:231], v[36:39], a[152:155], v[228:231]
  s_waitcnt lgkmcnt(3)
  s_cmp_eq_u32 s67, 1
  ds_read_b64_tr_b16 v[54:55], v21 offset:29184
  v_mfma_f32_16x16x32_bf16 v[236:239], v[36:39], a[216:219], v[236:239]
  s_cselect_b64 s[48:49], s[14:15], s[48:49]
  v_mfma_f32_16x16x32_bf16 v[208:211], v[40:43], a[24:27], v[208:211]
  s_cmp_eq_u32 s67, 2
  ds_read_b64_tr_b16 v[56:57], v22 offset:28672
  v_mul_f32 v184, s66, v184
  v_mfma_f32_16x16x32_bf16 v[216:219], v[40:43], a[88:91], v[216:219]
  s_cselect_b64 s[48:49], s[16:17], s[48:49]
  buffer_store_dwordx4 v[72:75], v9, s[40:43], s65 offen offset:2048 sc1
  v_mul_f32 v185, s66, v185
  v_cvt_pk_bf16_f32 v76, v184, v185
  v_mfma_f32_16x16x32_bf16 v[240:243], v[40:43], a[152:155], v[240:243]
  s_cmp_eq_u32 s67, 3
  ds_read_b64_tr_b16 v[58:59], v22 offset:29184
  v_mul_f32 v186, s66, v186
  v_mfma_f32_16x16x32_bf16 v[248:251], v[40:43], a[216:219], v[248:251]
  s_cselect_b64 s[48:49], s[24:25], s[48:49]
  v_mul_f32 v187, s66, v187
  v_cvt_pk_bf16_f32 v77, v186, v187
  v_mfma_f32_16x16x32_bf16 v[212:215], v[44:47], a[24:27], v[212:215]
  s_waitcnt vmcnt(28)
  s_barrier
  ds_read_b64_tr_b16 v[60:61], v23 offset:28672
  v_mul_f32 v188, s66, v188
  v_mfma_f32_16x16x32_bf16 v[220:223], v[44:47], a[88:91], v[220:223]
  s_cmp_eq_u32 s67, 4
  s_cselect_b64 s[48:49], s[26:27], s[48:49]
  v_mul_f32 v189, s66, v189
  v_cvt_pk_bf16_f32 v78, v188, v189
  v_mfma_f32_16x16x32_bf16 v[244:247], v[44:47], a[152:155], v[244:247]
  s_waitcnt lgkmcnt(3)
  s_cmp_eq_u32 s67, 5
  ds_read_b64_tr_b16 v[62:63], v23 offset:29184
  v_mul_f32 v190, s66, v190
  v_mfma_f32_16x16x32_bf16 v[252:255], v[44:47], a[216:219], v[252:255]
  s_cselect_b64 s[48:49], s[28:29], s[48:49]
  v_mul_f32 v191, s66, v191
  v_cvt_pk_bf16_f32 v79, v190, v191
  v_mfma_f32_16x16x32_bf16 v[192:195], v[48:51], a[28:31], v[192:195]
  s_and_b32 s49, s49, 0xffff
  ds_read_b64_tr_b16 v[32:33], v20 offset:32768
  v_mfma_f32_16x16x32_bf16 v[200:203], v[48:51], a[92:95], v[200:203]
  s_bfe_u32 s67, s59, 0x50013
  v_mfma_f32_16x16x32_bf16 v[224:227], v[48:51], a[156:159], v[224:227]
  s_lshl_b32 s67, s67, 8
  ds_read_b64_tr_b16 v[34:35], v20 offset:33280
  v_mfma_f32_16x16x32_bf16 v[232:235], v[48:51], a[220:223], v[232:235]
  s_bfe_u32 s68, s59, 0x1000c
  buffer_store_dwordx4 v[76:79], v9, s[40:43], s65 offen offset:3072 sc1
  v_mfma_f32_16x16x32_bf16 v[196:199], v[52:55], a[28:31], v[196:199]
  s_lshl_b32 s68, s68, 7
  ds_read_b64_tr_b16 v[36:37], v21 offset:32768
  v_mfma_f32_16x16x32_bf16 v[204:207], v[52:55], a[92:95], v[204:207]
  s_or_b32 s62, s67, s68
  v_mfma_f32_16x16x32_bf16 v[228:231], v[52:55], a[156:159], v[228:231]
  s_waitcnt lgkmcnt(3)
  s_bitcmp1_b32 s59, 2
  ds_read_b64_tr_b16 v[38:39], v21 offset:33280
  v_mfma_f32_16x16x32_bf16 v[236:239], v[52:55], a[220:223], v[236:239]
  s_cselect_b32 s62, 0x40000000, s62
  v_mfma_f32_16x16x32_bf16 v[208:211], v[56:59], a[28:31], v[208:211]
  ds_read_b64_tr_b16 v[40:41], v22 offset:32768
  v_mfma_f32_16x16x32_bf16 v[216:219], v[56:59], a[92:95], v[216:219]
  v_mfma_f32_16x16x32_bf16 v[240:243], v[56:59], a[156:159], v[240:243]
  ds_read_b64_tr_b16 v[42:43], v22 offset:33280
  v_mfma_f32_16x16x32_bf16 v[248:251], v[56:59], a[220:223], v[248:251]
  v_mfma_f32_16x16x32_bf16 v[212:215], v[60:63], a[28:31], v[212:215]
  ds_read_b64_tr_b16 v[44:45], v23 offset:32768
  v_mfma_f32_16x16x32_bf16 v[220:223], v[60:63], a[92:95], v[220:223]
  v_mfma_f32_16x16x32_bf16 v[244:247], v[60:63], a[156:159], v[244:247]
  s_waitcnt lgkmcnt(3)
  ds_read_b64_tr_b16 v[46:47], v23 offset:33280
  v_mfma_f32_16x16x32_bf16 v[252:255], v[60:63], a[220:223], v[252:255]
  v_mfma_f32_16x16x32_bf16 v[192:195], v[32:35], a[32:35], v[192:195]
  s_add_u32 m0, s64, 65536
  ds_read_b64_tr_b16 v[48:49], v20 offset:36864
  v_mfma_f32_16x16x32_bf16 v[200:203], v[32:35], a[96:99], v[200:203]
  v_mfma_f32_16x16x32_bf16 v[224:227], v[32:35], a[160:163], v[224:227]
  s_add_u32 s63, s62, 0
  ds_read_b64_tr_b16 v[50:51], v20 offset:37376
  v_mfma_f32_16x16x32_bf16 v[232:235], v[32:35], a[224:227], v[232:235]
  buffer_load_dwordx4 v2, s[48:51], s63 offen lds
  v_mfma_f32_16x16x32_bf16 v[196:199], v[36:39], a[32:35], v[196:199]
  ds_read_b64_tr_b16 v[52:53], v21 offset:36864
  v_mfma_f32_16x16x32_bf16 v[204:207], v[36:39], a[96:99], v[204:207]
  v_mfma_f32_16x16x32_bf16 v[228:231], v[36:39], a[160:163], v[228:231]
  s_waitcnt lgkmcnt(3)
  ds_read_b64_tr_b16 v[54:55], v21 offset:37376
  v_mfma_f32_16x16x32_bf16 v[236:239], v[36:39], a[224:227], v[236:239]
  v_mfma_f32_16x16x32_bf16 v[208:211], v[40:43], a[32:35], v[208:211]
  s_add_u32 m0, s64, 66560
  ds_read_b64_tr_b16 v[56:57], v22 offset:36864
  v_mfma_f32_16x16x32_bf16 v[216:219], v[40:43], a[96:99], v[216:219]
  v_mfma_f32_16x16x32_bf16 v[240:243], v[40:43], a[160:163], v[240:243]
  s_add_u32 s63, s62, 65536
  ds_read_b64_tr_b16 v[58:59], v22 offset:37376
  v_mfma_f32_16x16x32_bf16 v[248:251], v[40:43], a[224:227], v[248:251]
  buffer_load_dwordx4 v3, s[48:51], s63 offen lds
  v_mfma_f32_16x16x32_bf16 v[212:215], v[44:47], a[32:35], v[212:215]
  ds_read_b64_tr_b16 v[60:61], v23 offset:36864
  v_mfma_f32_16x16x32_bf16 v[220:223], v[44:47], a[96:99], v[220:223]
  v_mfma_f32_16x16x32_bf16 v[244:247], v[44:47], a[160:163], v[244:247]
  s_waitcnt lgkmcnt(3)
  ds_read_b64_tr_b16 v[62:63], v23 offset:37376
  v_mfma_f32_16x16x32_bf16 v[252:255], v[44:47], a[224:227], v[252:255]
  v_mfma_f32_16x16x32_bf16 v[192:195], v[48:51], a[36:39], v[192:195]
  s_add_u32 m0, s64, 67584
  ds_read_b64_tr_b16 v[32:33], v20 offset:40960
  v_mfma_f32_16x16x32_bf16 v[200:203], v[48:51], a[100:103], v[200:203]
  v_mfma_f32_16x16x32_bf16 v[224:227], v[48:51], a[164:167], v[224:227]
  s_add_u32 s63, s62, 131072
  ds_read_b64_tr_b16 v[34:35], v20 offset:41472
  v_mfma_f32_16x16x32_bf16 v[232:235], v[48:51], a[228:231], v[232:235]
  buffer_load_dwordx4 v2, s[48:51], s63 offen lds
  v_mfma_f32_16x16x32_bf16 v[196:199], v[52:55], a[36:39], v[196:199]
  ds_read_b64_tr_b16 v[36:37], v21 offset:40960
  v_mfma_f32_16x16x32_bf16 v[204:207], v[52:55], a[100:103], v[204:207]
  v_mfma_f32_16x16x32_bf16 v[228:231], v[52:55], a[164:167], v[228:231]
  s_waitcnt lgkmcnt(3)
  ds_read_b64_tr_b16 v[38:39], v21 offset:41472
  v_mfma_f32_16x16x32_bf16 v[236:239], v[52:55], a[228:231], v[236:239]
  v_mfma_f32_16x16x32_bf16 v[208:211], v[56:59], a[36:39], v[208:211]
  s_add_u32 m0, s64, 68608
  ds_read_b64_tr_b16 v[40:41], v22 offset:40960
  v_mfma_f32_16x16x32_bf16 v[216:219], v[56:59], a[100:103], v[216:219]
  v_mfma_f32_16x16x32_bf16 v[240:243], v[56:59], a[164:167], v[240:243]
  s_add_u32 s63, s62, 196608
  ds_read_b64_tr_b16 v[42:43], v22 offset:41472
  v_mfma_f32_16x16x32_bf16 v[248:251], v[56:59], a[228:231], v[248:251]
  buffer_load_dwordx4 v3, s[48:51], s63 offen lds
  v_mfma_f32_16x16x32_bf16 v[212:215], v[60:63], a[36:39], v[212:215]
  s_bfe_u32 s67, s61, 0x50013
  ds_read_b64_tr_b16 v[44:45], v23 offset:40960
  v_mfma_f32_16x16x32_bf16 v[220:223], v[60:63], a[100:103], v[220:223]
  s_lshl_b32 s67, s67, 7
  v_mfma_f32_16x16x32_bf16 v[244:247], v[60:63], a[164:167], v[244:247]
  s_waitcnt lgkmcnt(3)
  s_bfe_u32 s68, s61, 0x20004
  ds_read_b64_tr_b16 v[46:47], v23 offset:41472
  v_mfma_f32_16x16x32_bf16 v[252:255], v[60:63], a[228:231], v[252:255]
  s_lshl_b32 s68, s68, 5
  v_mfma_f32_16x16x32_bf16 v[192:195], v[32:35], a[40:43], v[192:195]
  s_or_b32 s69, s67, s68
  ds_read_b64_tr_b16 v[48:49], v20 offset:45056
  v_mfma_f32_16x16x32_bf16 v[200:203], v[32:35], a[104:107], v[200:203]
  s_bitcmp1_b32 s61, 2
  v_mfma_f32_16x16x32_bf16 v[224:227], v[32:35], a[168:171], v[224:227]
  s_cselect_b32 s69, 0x40000000, s69
  ds_read_b64_tr_b16 v[50:51], v20 offset:45568
  v_mfma_f32_16x16x32_bf16 v[232:235], v[32:35], a[232:235], v[232:235]
  v_mfma_f32_16x16x32_bf16 v[196:199], v[36:39], a[40:43], v[196:199]
  ds_read_b64_tr_b16 v[52:53], v21 offset:45056
  v_mfma_f32_16x16x32_bf16 v[204:207], v[36:39], a[104:107], v[204:207]
  v_mfma_f32_16x16x32_bf16 v[228:231], v[36:39], a[168:171], v[228:231]
  s_waitcnt lgkmcnt(3)
  ds_read_b64_tr_b16 v[54:55], v21 offset:45568
  v_mfma_f32_16x16x32_bf16 v[236:239], v[36:39], a[232:235], v[236:239]
  v_mfma_f32_16x16x32_bf16 v[208:211], v[40:43], a[40:43], v[208:211]
  ds_read_b64_tr_b16 v[56:57], v22 offset:45056
  v_mfma_f32_16x16x32_bf16 v[216:219], v[40:43], a[104:107], v[216:219]
  v_mfma_f32_16x16x32_bf16 v[240:243], v[40:43], a[168:171], v[240:243]
  ds_read_b64_tr_b16 v[58:59], v22 offset:45568
  v_mfma_f32_16x16x32_bf16 v[248:251], v[40:43], a[232:235], v[248:251]
  v_mfma_f32_16x16x32_bf16 v[212:215], v[44:47], a[40:43], v[212:215]
  s_waitcnt vmcnt(28)
  ds_read_b64_tr_b16 v[60:61], v23 offset:45056
  v_mfma_f32_16x16x32_bf16 v[220:223], v[44:47], a[104:107], v[220:223]
  s_barrier
  v_mfma_f32_16x16x32_bf16 v[244:247], v[44:47], a[168:171], v[244:247]
  s_waitcnt lgkmcnt(3)
  ds_read_b64_tr_b16 v[62:63], v23 offset:45568
  v_mfma_f32_16x16x32_bf16 v[252:255], v[44:47], a[232:235], v[252:255]
  buffer_atomic_add v11, v10, s[40:43], s69 offen
  v_mfma_f32_16x16x32_bf16 v[192:195], v[48:51], a[44:47], v[192:195]
  ds_read_b64_tr_b16 v[32:33], v20 offset:49152
  v_mfma_f32_16x16x32_bf16 v[200:203], v[48:51], a[108:111], v[200:203]
  v_mfma_f32_16x16x32_bf16 v[224:227], v[48:51], a[172:175], v[224:227]
  ds_read_b64_tr_b16 v[34:35], v20 offset:49664
  v_mfma_f32_16x16x32_bf16 v[232:235], v[48:51], a[236:239], v[232:235]
  v_mfma_f32_16x16x32_bf16 v[196:199], v[52:55], a[44:47], v[196:199]
  ds_read_b64_tr_b16 v[36:37], v21 offset:49152
  v_mfma_f32_16x16x32_bf16 v[204:207], v[52:55], a[108:111], v[204:207]
  v_mfma_f32_16x16x32_bf16 v[228:231], v[52:55], a[172:175], v[228:231]
  s_waitcnt lgkmcnt(3)
  ds_read_b64_tr_b16 v[38:39], v21 offset:49664
  v_mfma_f32_16x16x32_bf16 v[236:239], v[52:55], a[236:239], v[236:239]
  v_mfma_f32_16x16x32_bf16 v[208:211], v[56:59], a[44:47], v[208:211]
  ds_read_b64_tr_b16 v[40:41], v22 offset:49152
  v_mfma_f32_16x16x32_bf16 v[216:219], v[56:59], a[108:111], v[216:219]
  v_mfma_f32_16x16x32_bf16 v[240:243], v[56:59], a[172:175], v[240:243]
  ds_read_b64_tr_b16 v[42:43], v22 offset:49664
  v_mfma_f32_16x16x32_bf16 v[248:251], v[56:59], a[236:239], v[248:251]
  v_mfma_f32_16x16x32_bf16 v[212:215], v[60:63], a[44:47], v[212:215]
  ds_read_b64_tr_b16 v[44:45], v23 offset:49152
  v_mfma_f32_16x16x32_bf16 v[220:223], v[60:63], a[108:111], v[220:223]
  v_mfma_f32_16x16x32_bf16 v[244:247], v[60:63], a[172:175], v[244:247]
  s_waitcnt lgkmcnt(3)
  ds_read_b64_tr_b16 v[46:47], v23 offset:49664
  v_mfma_f32_16x16x32_bf16 v[252:255], v[60:63], a[236:239], v[252:255]
  v_mfma_f32_16x16x32_bf16 v[192:195], v[32:35], a[48:51], v[192:195]
  s_add_u32 m0, s64, 81920
  ds_read_b64_tr_b16 v[48:49], v20 offset:53248
  v_mfma_f32_16x16x32_bf16 v[200:203], v[32:35], a[112:115], v[200:203]
  v_mfma_f32_16x16x32_bf16 v[224:227], v[32:35], a[176:179], v[224:227]
  s_add_u32 s63, s62, 1048576
  ds_read_b64_tr_b16 v[50:51], v20 offset:53760
  v_mfma_f32_16x16x32_bf16 v[232:235], v[32:35], a[240:243], v[232:235]
  buffer_load_dwordx4 v2, s[48:51], s63 offen lds
  v_mfma_f32_16x16x32_bf16 v[196:199], v[36:39], a[48:51], v[196:199]
  ds_read_b64_tr_b16 v[52:53], v21 offset:53248
  v_mfma_f32_16x16x32_bf16 v[204:207], v[36:39], a[112:115], v[204:207]
  v_mfma_f32_16x16x32_bf16 v[228:231], v[36:39], a[176:179], v[228:231]
  s_waitcnt lgkmcnt(3)
  ds_read_b64_tr_b16 v[54:55], v21 offset:53760
  v_mfma_f32_16x16x32_bf16 v[236:239], v[36:39], a[240:243], v[236:239]
  v_mfma_f32_16x16x32_bf16 v[208:211], v[40:43], a[48:51], v[208:211]
  s_add_u32 m0, s64, 82944
  ds_read_b64_tr_b16 v[56:57], v22 offset:53248
  v_mfma_f32_16x16x32_bf16 v[216:219], v[40:43], a[112:115], v[216:219]
  v_mfma_f32_16x16x32_bf16 v[240:243], v[40:43], a[176:179], v[240:243]
  s_add_u32 s63, s62, 1114112
  ds_read_b64_tr_b16 v[58:59], v22 offset:53760
  v_mfma_f32_16x16x32_bf16 v[248:251], v[40:43], a[240:243], v[248:251]
  buffer_load_dwordx4 v3, s[48:51], s63 offen lds
  v_mfma_f32_16x16x32_bf16 v[212:215], v[44:47], a[48:51], v[212:215]
  ds_read_b64_tr_b16 v[60:61], v23 offset:53248
  v_mfma_f32_16x16x32_bf16 v[220:223], v[44:47], a[112:115], v[220:223]
  v_mfma_f32_16x16x32_bf16 v[244:247], v[44:47], a[176:179], v[244:247]
  s_waitcnt lgkmcnt(3)
  ds_read_b64_tr_b16 v[62:63], v23 offset:53760
  v_mfma_f32_16x16x32_bf16 v[252:255], v[44:47], a[240:243], v[252:255]
  v_mfma_f32_16x16x32_bf16 v[192:195], v[48:51], a[52:55], v[192:195]
  s_add_u32 m0, s64, 83968
  ds_read_b64_tr_b16 v[32:33], v20 offset:57344
  v_mfma_f32_16x16x32_bf16 v[200:203], v[48:51], a[116:119], v[200:203]
  v_mfma_f32_16x16x32_bf16 v[224:227], v[48:51], a[180:183], v[224:227]
  s_add_u32 s63, s62, 1179648
  ds_read_b64_tr_b16 v[34:35], v20 offset:57856
  v_mfma_f32_16x16x32_bf16 v[232:235], v[48:51], a[244:247], v[232:235]
  buffer_load_dwordx4 v2, s[48:51], s63 offen lds
  v_mfma_f32_16x16x32_bf16 v[196:199], v[52:55], a[52:55], v[196:199]
  ds_read_b64_tr_b16 v[36:37], v21 offset:57344
  v_mfma_f32_16x16x32_bf16 v[204:207], v[52:55], a[116:119], v[204:207]
  v_mfma_f32_16x16x32_bf16 v[228:231], v[52:55], a[180:183], v[228:231]
  s_waitcnt lgkmcnt(3)
  ds_read_b64_tr_b16 v[38:39], v21 offset:57856
  v_mfma_f32_16x16x32_bf16 v[236:239], v[52:55], a[244:247], v[236:239]
  v_mfma_f32_16x16x32_bf16 v[208:211], v[56:59], a[52:55], v[208:211]
  s_add_u32 m0, s64, 84992
  ds_read_b64_tr_b16 v[40:41], v22 offset:57344
  v_mfma_f32_16x16x32_bf16 v[216:219], v[56:59], a[116:119], v[216:219]
  v_mfma_f32_16x16x32_bf16 v[240:243], v[56:59], a[180:183], v[240:243]
  s_add_u32 s63, s62, 1245184
  ds_read_b64_tr_b16 v[42:43], v22 offset:57856
  v_mfma_f32_16x16x32_bf16 v[248:251], v[56:59], a[244:247], v[248:251]
  buffer_load_dwordx4 v3, s[48:51], s63 offen lds
  v_mfma_f32_16x16x32_bf16 v[212:215], v[60:63], a[52:55], v[212:215]
  ds_read_b64_tr_b16 v[44:45], v23 offset:57344
  v_mfma_f32_16x16x32_bf16 v[220:223], v[60:63], a[116:119], v[220:223]
  v_mfma_f32_16x16x32_bf16 v[244:247], v[60:63], a[180:183], v[244:247]
  s_waitcnt lgkmcnt(3)
  ds_read_b64_tr_b16 v[46:47], v23 offset:57856
  v_mfma_f32_16x16x32_bf16 v[252:255], v[60:63], a[244:247], v[252:255]
  v_mfma_f32_16x16x32_bf16 v[192:195], v[32:35], a[56:59], v[192:195]
  ds_read_b64_tr_b16 v[48:49], v20 offset:61440
  v_mfma_f32_16x16x32_bf16 v[200:203], v[32:35], a[120:123], v[200:203]
  v_mfma_f32_16x16x32_bf16 v[224:227], v[32:35], a[184:187], v[224:227]
  ds_read_b64_tr_b16 v[50:51], v20 offset:61952
  v_mfma_f32_16x16x32_bf16 v[232:235], v[32:35], a[248:251], v[232:235]
  v_mfma_f32_16x16x32_bf16 v[196:199], v[36:39], a[56:59], v[196:199]
  ds_read_b64_tr_b16 v[52:53], v21 offset:61440
  v_mfma_f32_16x16x32_bf16 v[204:207], v[36:39], a[120:123], v[204:207]
  v_mfma_f32_16x16x32_bf16 v[228:231], v[36:39], a[184:187], v[228:231]
  s_waitcnt lgkmcnt(3)
  ds_read_b64_tr_b16 v[54:55], v21 offset:61952
  v_mfma_f32_16x16x32_bf16 v[236:239], v[36:39], a[248:251], v[236:239]
  v_mfma_f32_16x16x32_bf16 v[208:211], v[40:43], a[56:59], v[208:211]
  ds_read_b64_tr_b16 v[56:57], v22 offset:61440
  v_mfma_f32_16x16x32_bf16 v[216:219], v[40:43], a[120:123], v[216:219]
  v_mfma_f32_16x16x32_bf16 v[240:243], v[40:43], a[184:187], v[240:243]
  ds_read_b64_tr_b16 v[58:59], v22 offset:61952
  v_mfma_f32_16x16x32_bf16 v[248:251], v[40:43], a[248:251], v[248:251]
  v_mfma_f32_16x16x32_bf16 v[212:215], v[44:47], a[56:59], v[212:215]
  s_waitcnt vmcnt(28)
  ds_read_b64_tr_b16 v[60:61], v23 offset:61440
  v_mfma_f32_16x16x32_bf16 v[220:223], v[44:47], a[120:123], v[220:223]
  s_barrier
  v_mfma_f32_16x16x32_bf16 v[244:247], v[44:47], a[184:187], v[244:247]
  s_waitcnt lgkmcnt(3)
  ds_read_b64_tr_b16 v[62:63], v23 offset:61952
  v_mfma_f32_16x16x32_bf16 v[252:255], v[44:47], a[248:251], v[252:255]
  v_mfma_f32_16x16x32_bf16 v[192:195], v[48:51], a[60:63], v[192:195]
  s_mov_b32 s61, s60
  ds_read_b64_tr_b16 v[32:33], v16 offset:0
  v_mfma_f32_16x16x32_bf16 v[200:203], v[48:51], a[124:127], v[200:203]
  s_mov_b32 s60, s57
  v_mfma_f32_16x16x32_bf16 v[224:227], v[48:51], a[188:191], v[224:227]
  s_mov_b32 s57, s58
  ds_read_b64_tr_b16 v[34:35], v16 offset:512
  v_mfma_f32_16x16x32_bf16 v[232:235], v[48:51], a[252:255], v[232:235]
  s_mov_b32 s58, s59
  v_mfma_f32_16x16x32_bf16 v[196:199], v[52:55], a[60:63], v[196:199]
  s_add_u32 s56, s56, 1
  ds_read_b64_tr_b16 v[36:37], v17 offset:0
  v_mfma_f32_16x16x32_bf16 v[204:207], v[52:55], a[124:127], v[204:207]
  v_mfma_f32_16x16x32_bf16 v[228:231], v[52:55], a[188:191], v[228:231]
  s_waitcnt lgkmcnt(3)
  ds_read_b64_tr_b16 v[38:39], v17 offset:512
  v_mfma_f32_16x16x32_bf16 v[236:239], v[52:55], a[252:255], v[236:239]
  v_mfma_f32_16x16x32_bf16 v[208:211], v[56:59], a[60:63], v[208:211]
  ds_read_b64_tr_b16 v[40:41], v18 offset:0
  v_mfma_f32_16x16x32_bf16 v[216:219], v[56:59], a[124:127], v[216:219]
  v_mfma_f32_16x16x32_bf16 v[240:243], v[56:59], a[188:191], v[240:243]
  ds_read_b64_tr_b16 v[42:43], v18 offset:512
  v_mfma_f32_16x16x32_bf16 v[248:251], v[56:59], a[252:255], v[248:251]
  v_mfma_f32_16x16x32_bf16 v[212:215], v[60:63], a[60:63], v[212:215]
  ds_read_b64_tr_b16 v[44:45], v19 offset:0
  v_mfma_f32_16x16x32_bf16 v[220:223], v[60:63], a[124:127], v[220:223]
  v_mfma_f32_16x16x32_bf16 v[244:247], v[60:63], a[188:191], v[244:247]
  s_waitcnt lgkmcnt(3)
  ds_read_b64_tr_b16 v[46:47], v19 offset:512
  v_mfma_f32_16x16x32_bf16 v[252:255], v[60:63], a[252:255], v[252:255]
  s_bitcmp1_b32 s57, 2
  s_cbranch_scc1 L_p_done_1
  s_bitcmp1_b32 s57, 0
  s_cbranch_scc1 L_p_body_0_1
  s_branch L_p_body_0_0
L_p_body_1_1:
  v_mfma_f32_16x16x32_bf16 v[192:195], a[0:3], v[32:35], 0
  s_add_u32 m0, s64, 32768
  ds_read_b64_tr_b16 v[48:49], v20 offset:4096
  v_mfma_f32_16x16x32_bf16 v[196:199], a[64:67], v[32:35], 0
  v_mfma_f32_16x16x32_bf16 v[224:227], a[128:131], v[32:35], 0
  s_add_u32 s63, s62, 2097152
  ds_read_b64_tr_b16 v[50:51], v20 offset:4608
  v_mfma_f32_16x16x32_bf16 v[228:231], a[192:195], v[32:35], 0
  buffer_load_dwordx4 v2, s[48:51], s63 offen lds
  v_mfma_f32_16x16x32_bf16 v[200:203], a[0:3], v[36:39], 0
  s_and_b32 s65, s60, 0x7fff000
  s_bitcmp1_b32 s60, 2
  s_cselect_b32 s65, 0x40000000, s65
  ds_read_b64_tr_b16 v[52:53], v21 offset:4096
  v_mfma_f32_16x16x32_bf16 v[204:207], a[64:67], v[36:39], 0
  s_bitcmp1_b32 s60, 1
  s_cselect_b32 s66, 0x3e0293ee, 1.0
  v_mfma_f32_16x16x32_bf16 v[232:235], a[128:131], v[36:39], 0
  s_waitcnt lgkmcnt(3)
  ds_read_b64_tr_b16 v[54:55], v21 offset:4608
  v_mfma_f32_16x16x32_bf16 v[236:239], a[192:195], v[36:39], 0
  v_mfma_f32_16x16x32_bf16 v[208:211], a[0:3], v[40:43], 0
  s_add_u32 m0, s64, 33792
  ds_read_b64_tr_b16 v[56:57], v22 offset:4096
  v_mfma_f32_16x16x32_bf16 v[212:215], a[64:67], v[40:43], 0
  v_mfma_f32_16x16x32_bf16 v[240:243], a[128:131], v[40:43], 0
  s_add_u32 s63, s62, 2162688
  ds_read_b64_tr_b16 v[58:59], v22 offset:4608
  v_mul_f32 v128, s66, v128
  v_mfma_f32_16x16x32_bf16 v[244:247], a[192:195], v[40:43], 0
  buffer_load_dwordx4 v3, s[48:51], s63 offen lds
  v_mul_f32 v129, s66, v129
  v_cvt_pk_bf16_f32 v64, v128, v129
  v_mfma_f32_16x16x32_bf16 v[216:219], a[0:3], v[44:47], 0
  ds_read_b64_tr_b16 v[60:61], v23 offset:4096
  v_mul_f32 v130, s66, v130
  v_mfma_f32_16x16x32_bf16 v[220:223], a[64:67], v[44:47], 0
  v_mul_f32 v131, s66, v131
  v_cvt_pk_bf16_f32 v65, v130, v131
  v_mfma_f32_16x16x32_bf16 v[248:251], a[128:131], v[44:47], 0
  s_waitcnt lgkmcnt(3)
  ds_read_b64_tr_b16 v[62:63], v23 offset:4608
  v_mul_f32 v132, s66, v132
  v_mfma_f32_16x16x32_bf16 v[252:255], a[192:195], v[44:47], 0
  v_mul_f32 v133, s66, v133
  v_cvt_pk_bf16_f32 v66, v132, v133
  v_mfma_f32_16x16x32_bf16 v[192:195], a[4:7], v[48:51], v[192:195]
  s_add_u32 m0, s64, 34816
  ds_read_b64_tr_b16 v[32:33], v20 offset:8192
  v_readlane_b32 s59, v1, s56
  v_mfma_f32_16x16x32_bf16 v[196:199], a[68:71], v[48:51], v[196:199]
  v_mul_f32 v134, s66, v134
  v_mul_f32 v135, s66, v135
  v_cvt_pk_bf16_f32 v67, v134, v135
  v_mfma_f32_16x16x32_bf16 v[224:227], a[132:135], v[48:51], v[224:227]
  s_add_u32 s63, s62, 2228224
  ds_read_b64_tr_b16 v[34:35], v20 offset:8704
  v_mfma_f32_16x16x32_bf16 v[228:231], a[196:199], v[48:51], v[228:231]
  buffer_load_dwordx4 v2, s[48:51], s63 offen lds
  v_mfma_f32_16x16x32_bf16 v[200:203], a[4:7], v[52:55], v[200:203]
  ds_read_b64_tr_b16 v[36:37], v21 offset:8192
  v_mul_f32 v136, s66, v136
  v_mfma_f32_16x16x32_bf16 v[204:207], a[68:71], v[52:55], v[204:207]
  buffer_store_dwordx4 v[64:67], v8, s[40:43], s65 offen offset:0 sc1
  v_mul_f32 v137, s66, v137
  v_cvt_pk_bf16_f32 v68, v136, v137
  v_mfma_f32_16x16x32_bf16 v[232:235], a[132:135], v[52:55], v[232:235]
  s_waitcnt lgkmcnt(3)
  ds_read_b64_tr_b16 v[38:39], v21 offset:8704
  v_mul_f32 v138, s66, v138
  v_mfma_f32_16x16x32_bf16 v[236:239], a[196:199], v[52:55], v[236:239]
  v_mul_f32 v139, s66, v139
  v_cvt_pk_bf16_f32 v69, v138, v139
  v_mfma_f32_16x16x32_bf16 v[208:211], a[4:7], v[56:59], v[208:211]
  s_add_u32 m0, s64, 35840
  ds_read_b64_tr_b16 v[40:41], v22 offset:8192
  v_mul_f32 v140, s66, v140
  v_mfma_f32_16x16x32_bf16 v[212:215], a[68:71], v[56:59], v[212:215]
  v_mul_f32 v141, s66, v141
  v_cvt_pk_bf16_f32 v70, v140, v141
  v_mfma_f32_16x16x32_bf16 v[240:243], a[132:135], v[56:59], v[240:243]
  s_add_u32 s63, s62, 2293760
  ds_read_b64_tr_b16 v[42:43], v22 offset:8704
  v_mul_f32 v142, s66, v142
  v_mfma_f32_16x16x32_bf16 v[244:247], a[196:199], v[56:59], v[244:247]
  buffer_load_dwordx4 v3, s[48:51], s63 offen lds
  v_mul_f32 v143, s66, v143
  v_cvt_pk_bf16_f32 v71, v142, v143
  v_mfma_f32_16x16x32_bf16 v[216:219], a[4:7], v[60:63], v[216:219]
  ds_read_b64_tr_b16 v[44:45], v23 offset:8192
  v_mfma_f32_16x16x32_bf16 v[220:223], a[68:71], v[60:63], v[220:223]
  v_mfma_f32_16x16x32_bf16 v[248:251], a[132:135], v[60:63], v[248:251]
  s_waitcnt lgkmcnt(3)
  ds_read_b64_tr_b16 v[46:47], v23 offset:8704
  v_mfma_f32_16x16x32_bf16 v[252:255], a[196:199], v[60:63], v[252:255]
  buffer_store_dwordx4 v[68:71], v8, s[40:43], s65 offen offset:1024 sc1
  v_mfma_f32_16x16x32_bf16 v[192:195], a[8:11], v[32:35], v[192:195]
  ds_read_b64_tr_b16 v[48:49], v20 offset:12288
  v_mfma_f32_16x16x32_bf16 v[196:199], a[72:75], v[32:35], v[196:199]
  v_mfma_f32_16x16x32_bf16 v[224:227], a[136:139], v[32:35], v[224:227]
  ds_read_b64_tr_b16 v[50:51], v20 offset:12800
  v_mfma_f32_16x16x32_bf16 v[228:231], a[200:203], v[32:35], v[228:231]
  v_mfma_f32_16x16x32_bf16 v[200:203], a[8:11], v[36:39], v[200:203]
  ds_read_b64_tr_b16 v[52:53], v21 offset:12288
  v_mfma_f32_16x16x32_bf16 v[204:207], a[72:75], v[36:39], v[204:207]
  v_mfma_f32_16x16x32_bf16 v[232:235], a[136:139], v[36:39], v[232:235]
  s_waitcnt lgkmcnt(3)
  ds_read_b64_tr_b16 v[54:55], v21 offset:12800
  v_mul_f32 v144, s66, v144
  v_mfma_f32_16x16x32_bf16 v[236:239], a[200:203], v[36:39], v[236:239]
  v_mul_f32 v145, s66, v145
  v_cvt_pk_bf16_f32 v72, v144, v145
  v_mfma_f32_16x16x32_bf16 v[208:211], a[8:11], v[40:43], v[208:211]
  ds_read_b64_tr_b16 v[56:57], v22 offset:12288
  v_mul_f32 v146, s66, v146
  v_mfma_f32_16x16x32_bf16 v[212:215], a[72:75], v[40:43], v[212:215]
  v_mul_f32 v147, s66, v147
  v_cvt_pk_bf16_f32 v73, v146, v147
  v_mfma_f32_16x16x32_bf16 v[240:243], a[136:139], v[40:43], v[240:243]
  ds_read_b64_tr_b16 v[58:59], v22 offset:12800
  v_mul_f32 v148, s66, v148
  v_mfma_f32_16x16x32_bf16 v[244:247], a[200:203], v[40:43], v[244:247]
  v_mul_f32 v149, s66, v149
  v_cvt_pk_bf16_f32 v74, v148, v149
  v_mfma_f32_16x16x32_bf16 v[216:219], a[8:11], v[44:47], v[216:219]
  s_waitcnt vmcnt(28)
  ds_read_b64_tr_b16 v[60:61], v23 offset:12288
  v_mul_f32 v150, s66, v150
  v_mfma_f32_16x16x32_bf16 v[220:223], a[72:75], v[44:47], v[220:223]
  s_barrier
  v_mul_f32 v151, s66, v151
  v_cvt_pk_bf16_f32 v75, v150, v151
  v_mfma_f32_16x16x32_bf16 v[248:251], a[136:139], v[44:47], v[248:251]
  s_waitcnt lgkmcnt(3)
  ds_read_b64_tr_b16 v[62:63], v23 offset:12800
  v_mfma_f32_16x16x32_bf16 v[252:255], a[200:203], v[44:47], v[252:255]
  v_mfma_f32_16x16x32_bf16 v[192:195], a[12:15], v[48:51], v[192:195]
  ds_read_b64_tr_b16 v[32:33], v20 offset:16384
  v_mul_f32 v152, s66, v152
  v_mfma_f32_16x16x32_bf16 v[196:199], a[76:79], v[48:51], v[196:199]
  buffer_store_dwordx4 v[72:75], v8, s[40:43], s65 offen offset:2048 sc1
  v_mul_f32 v153, s66, v153
  v_cvt_pk_bf16_f32 v76, v152, v153
  v_mfma_f32_16x16x32_bf16 v[224:227], a[140:143], v[48:51], v[224:227]
  ds_read_b64_tr_b16 v[34:35], v20 offset:16896
  v_mul_f32 v154, s66, v154
  v_mfma_f32_16x16x32_bf16 v[228:231], a[204:207], v[48:51], v[228:231]
  v_mul_f32 v155, s66, v155
  v_cvt_pk_bf16_f32 v77, v154, v155
  v_mfma_f32_16x16x32_bf16 v[200:203], a[12:15], v[52:55], v[200:203]
  ds_read_b64_tr_b16 v[36:37], v21 offset:16384
  v_mul_f32 v156, s66, v156
  v_mfma_f32_16x16x32_bf16 v[204:207], a[76:79], v[52:55], v[204:207]
  v_mul_f32 v157, s66, v157
  v_cvt_pk_bf16_f32 v78, v156, v157
  v_mfma_f32_16x16x32_bf16 v[232:235], a[140:143], v[52:55], v[232:235]
  s_waitcnt lgkmcnt(3)
  ds_read_b64_tr_b16 v[38:39], v21 offset:16896
  v_mul_f32 v158, s66, v158
  v_mfma_f32_16x16x32_bf16 v[236:239], a[204:207], v[52:55], v[236:239]
  v_mul_f32 v159, s66, v159
  v_cvt_pk_bf16_f32 v79, v158, v159
  v_mfma_f32_16x16x32_bf16 v[208:211], a[12:15], v[56:59], v[208:211]
  ds_read_b64_tr_b16 v[40:41], v22 offset:16384
  v_mfma_f32_16x16x32_bf16 v[212:215], a[76:79], v[56:59], v[212:215]
  v_mfma_f32_16x16x32_bf16 v[240:243], a[140:143], v[56:59], v[240:243]
  ds_read_b64_tr_b16 v[42:43], v22 offset:16896
  v_mfma_f32_16x16x32_bf16 v[244:247], a[204:207], v[56:59], v[244:247]
  buffer_store_dwordx4 v[76:79], v8, s[40:43], s65 offen offset:3072 sc1
  v_mfma_f32_16x16x32_bf16 v[216:219], a[12:15], v[60:63], v[216:219]
  ds_read_b64_tr_b16 v[44:45], v23 offset:16384
  v_mfma_f32_16x16x32_bf16 v[220:223], a[76:79], v[60:63], v[220:223]
  v_mfma_f32_16x16x32_bf16 v[248:251], a[140:143], v[60:63], v[248:251]
  s_waitcnt lgkmcnt(3)
  ds_read_b64_tr_b16 v[46:47], v23 offset:16896
  v_mfma_f32_16x16x32_bf16 v[252:255], a[204:207], v[60:63], v[252:255]
  v_mfma_f32_16x16x32_bf16 v[192:195], a[16:19], v[32:35], v[192:195]
  s_add_u32 m0, s64, 49152
  ds_read_b64_tr_b16 v[48:49], v20 offset:20480
  v_mfma_f32_16x16x32_bf16 v[196:199], a[80:83], v[32:35], v[196:199]
  v_mfma_f32_16x16x32_bf16 v[224:227], a[144:147], v[32:35], v[224:227]
  s_add_u32 s63, s62, 3145728
  ds_read_b64_tr_b16 v[50:51], v20 offset:20992
  v_mul_f32 v160, s66, v160
  v_mfma_f32_16x16x32_bf16 v[228:231], a[208:211], v[32:35], v[228:231]
  buffer_load_dwordx4 v2, s[48:51], s63 offen lds
  v_mul_f32 v161, s66, v161
  v_cvt_pk_bf16_f32 v64, v160, v161
  v_mfma_f32_16x16x32_bf16 v[200:203], a[16:19], v[36:39], v[200:203]
  ds_read_b64_tr_b16 v[52:53], v21 offset:20480
  v_mul_f32 v162, s66, v162
  v_mfma_f32_16x16x32_bf16 v[204:207], a[80:83], v[36:39], v[204:207]
  v_mul_f32 v163, s66, v163
  v_cvt_pk_bf16_f32 v65, v162, v163
  v_mfma_f32_16x16x32_bf16 v[232:235], a[144:147], v[36:39], v[232:235]
  s_waitcnt lgkmcnt(3)
  ds_read_b64_tr_b16 v[54:55], v21 offset:20992
  v_mul_f32 v164, s66, v164
  v_mfma_f32_16x16x32_bf16 v[236:239], a[208:211], v[36:39], v[236:239]
  v_mul_f32 v165, s66, v165
  v_cvt_pk_bf16_f32 v66, v164, v165
  v_mfma_f32_16x16x32_bf16 v[208:211], a[16:19], v[40:43], v[208:211]
  s_add_u32 m0, s64, 50176
  ds_read_b64_tr_b16 v[56:57], v22 offset:20480
  v_mul_f32 v166, s66, v166
  v_mfma_f32_16x16x32_bf16 v[212:215], a[80:83], v[40:43], v[212:215]
  v_mul_f32 v167, s66, v167
  v_cvt_pk_bf16_f32 v67, v166, v167
  v_mfma_f32_16x16x32_bf16 v[240:243], a[144:147], v[40:43], v[240:243]
  s_add_u32 s63, s62, 3211264
  ds_read_b64_tr_b16 v[58:59], v22 offset:20992
  v_mfma_f32_16x16x32_bf16 v[244:247], a[208:211], v[40:43], v[244:247]
  buffer_load_dwordx4 v3, s[48:51], s63 offen lds
  v_mfma_f32_16x16x32_bf16 v[216:219], a[16:19], v[44:47], v[216:219]
  ds_read_b64_tr_b16 v[60:61], v23 offset:20480
  v_mul_f32 v168, s66, v168
  v_mfma_f32_16x16x32_bf16 v[220:223], a[80:83], v[44:47], v[220:223]
  buffer_store_dwordx4 v[64:67], v9, s[40:43], s65 offen offset:0 sc1
  v_mul_f32 v169, s66, v169
  v_cvt_pk_bf16_f32 v68, v168, v169
  v_mfma_f32_16x16x32_bf16 v[248:251], a[144:147], v[44:47], v[248:251]
  s_waitcnt lgkmcnt(3)
  ds_read_b64_tr_b16 v[62:63], v23 offset:20992
  v_mul_f32 v170, s66, v170
  v_mfma_f32_16x16x32_bf16 v[252:255], a[208:211], v[44:47], v[252:255]
  v_mul_f32 v171, s66, v171
  v_cvt_pk_bf16_f32 v69, v170, v171
  v_mfma_f32_16x16x32_bf16 v[192:195], a[20:23], v[48:51], v[192:195]
  s_add_u32 m0, s64, 51200
  ds_read_b64_tr_b16 v[32:33], v20 offset:24576
  v_mul_f32 v172, s66, v172
  v_mfma_f32_16x16x32_bf16 v[196:199], a[84:87], v[48:51], v[196:199]
  v_mul_f32 v173, s66, v173
  v_cvt_pk_bf16_f32 v70, v172, v173
  v_mfma_f32_16x16x32_bf16 v[224:227], a[148:151], v[48:51], v[224:227]
  s_add_u32 s63, s62, 3276800
  ds_read_b64_tr_b16 v[34:35], v20 offset:25088
  v_mul_f32 v174, s66, v174
  v_mfma_f32_16x16x32_bf16 v[228:231], a[212:215], v[48:51], v[228:231]
  buffer_load_dwordx4 v2, s[48:51], s63 offen lds
  v_mul_f32 v175, s66, v175
  v_cvt_pk_bf16_f32 v71, v174, v175
  v_mfma_f32_16x16x32_bf16 v[200:203], a[20:23], v[52:55], v[200:203]
  ds_read_b64_tr_b16 v[36:37], v21 offset:24576
  v_mfma_f32_16x16x32_bf16 v[204:207], a[84:87], v[52:55], v[204:207]
  v_mfma_f32_16x16x32_bf16 v[232:235], a[148:151], v[52:55], v[232:235]
  s_waitcnt lgkmcnt(3)
  ds_read_b64_tr_b16 v[38:39], v21 offset:25088
  v_mfma_f32_16x16x32_bf16 v[236:239], a[212:215], v[52:55], v[236:239]
  buffer_store_dwordx4 v[68:71], v9, s[40:43], s65 offen offset:1024 sc1
  v_mfma_f32_16x16x32_bf16 v[208:211], a[20:23], v[56:59], v[208:211]
  s_add_u32 m0, s64, 52224
  ds_read_b64_tr_b16 v[40:41], v22 offset:24576
  v_mfma_f32_16x16x32_bf16 v[212:215], a[84:87], v[56:59], v[212:215]
  v_mfma_f32_16x16x32_bf16 v[240:243], a[148:151], v[56:59], v[240:243]
  s_add_u32 s63, s62, 3342336
  ds_read_b64_tr_b16 v[42:43], v22 offset:25088
  v_mfma_f32_16x16x32_bf16 v[244:247], a[212:215], v[56:59], v[244:247]
  buffer_load_dwordx4 v3, s[48:51], s63 offen lds
  v_mfma_f32_16x16x32_bf16 v[216:219], a[20:23], v[60:63], v[216:219]
  ds_read_b64_tr_b16 v[44:45], v23 offset:24576
  v_mfma_f32_16x16x32_bf16 v[220:223], a[84:87], v[60:63], v[220:223]
  v_mfma_f32_16x16x32_bf16 v[248:251], a[148:151], v[60:63], v[248:251]
  s_waitcnt lgkmcnt(3)
  ds_read_b64_tr_b16 v[46:47], v23 offset:25088
  v_mul_f32 v176, s66, v176
  v_mfma_f32_16x16x32_bf16 v[252:255], a[212:215], v[60:63], v[252:255]
  v_mul_f32 v177, s66, v177
  v_cvt_pk_bf16_f32 v72, v176, v177
  v_mfma_f32_16x16x32_bf16 v[192:195], a[24:27], v[32:35], v[192:195]
  ds_read_b64_tr_b16 v[48:49], v20 offset:28672
  v_mul_f32 v178, s66, v178
  v_mfma_f32_16x16x32_bf16 v[196:199], a[88:91], v[32:35], v[196:199]
  v_mul_f32 v179, s66, v179
  v_cvt_pk_bf16_f32 v73, v178, v179
  v_mfma_f32_16x16x32_bf16 v[224:227], a[152:155], v[32:35], v[224:227]
  ds_read_b64_tr_b16 v[50:51], v20 offset:29184
  v_mul_f32 v180, s66, v180
  v_mfma_f32_16x16x32_bf16 v[228:231], a[216:219], v[32:35], v[228:231]
  v_mul_f32 v181, s66, v181
  v_cvt_pk_bf16_f32 v74, v180, v181
  v_mfma_f32_16x16x32_bf16 v[200:203], a[24:27], v[36:39], v[200:203]
  s_bfe_u32 s67, s59, 0x30018
  ds_read_b64_tr_b16 v[52:53], v21 offset:28672
  v_mul_f32 v182, s66, v182
  v_mfma_f32_16x16x32_bf16 v[204:207], a[88:91], v[36:39], v[204:207]
  s_mov_b64 s[48:49], s[12:13]
  v_mul_f32 v183, s66, v183
  v_cvt_pk_bf16_f32 v75, v182, v183
  v_mfma_f32_16x16x32_bf16 v[232:235], a[152:155], v[36:39], v[232:235]
  s_waitcnt lgkmcnt(3)
  s_cmp_eq_u32 s67, 1
  ds_read_b64_tr_b16 v[54:55], v21 offset:29184
  v_mfma_f32_16x16x32_bf16 v[236:239], a[216:219], v[36:39], v[236:239]
  s_cselect_b64 s[48:49], s[14:15], s[48:49]
  v_mfma_f32_16x16x32_bf16 v[208:211], a[24:27], v[40:43], v[208:211]
  s_cmp_eq_u32 s67, 2
  ds_read_b64_tr_b16 v[56:57], v22 offset:28672
  v_mul_f32 v184, s66, v184
  v_mfma_f32_16x16x32_bf16 v[212:215], a[88:91], v[40:43], v[212:215]
  s_cselect_b64 s[48:49], s[16:17], s[48:49]
  buffer_store_dwordx4 v[72:75], v9, s[40:43], s65 offen offset:2048 sc1
  v_mul_f32 v185, s66, v185
  v_cvt_pk_bf16_f32 v76, v184, v185
  v_mfma_f32_16x16x32_bf16 v[240:243], a[152:155], v[40:43], v[240:243]
  s_cmp_eq_u32 s67, 3
  ds_read_b64_tr_b16 v[58:59], v22 offset:29184
  v_mul_f32 v186, s66, v186
  v_mfma_f32_16x16x32_bf16 v[244:247], a[216:219], v[40:43], v[244:247]
  s_cselect_b64 s[48:49], s[24:25], s[48:49]
  v_mul_f32 v187, s66, v187
  v_cvt_pk_bf16_f32 v77, v186, v187
  v_mfma_f32_16x16x32_bf16 v[216:219], a[24:27], v[44:47], v[216:219]
  s_waitcnt vmcnt(28)
  s_barrier
  ds_read_b64_tr_b16 v[60:61], v23 offset:28672
  v_mul_f32 v188, s66, v188
  v_mfma_f32_16x16x32_bf16 v[220:223], a[88:91], v[44:47], v[220:223]
  s_cmp_eq_u32 s67, 4
  s_cselect_b64 s[48:49], s[26:27], s[48:49]
  v_mul_f32 v189, s66, v189
  v_cvt_pk_bf16_f32 v78, v188, v189
  v_mfma_f32_16x16x32_bf16 v[248:251], a[152:155], v[44:47], v[248:251]
  s_waitcnt lgkmcnt(3)
  s_cmp_eq_u32 s67, 5
  ds_read_b64_tr_b16 v[62:63], v23 offset:29184
  v_mul_f32 v190, s66, v190
  v_mfma_f32_16x16x32_bf16 v[252:255], a[216:219], v[44:47], v[252:255]
  s_cselect_b64 s[48:49], s[28:29], s[48:49]
  v_mul_f32 v191, s66, v191
  v_cvt_pk_bf16_f32 v79, v190, v191
  v_mfma_f32_16x16x32_bf16 v[192:195], a[28:31], v[48:51], v[192:195]
  s_and_b32 s49, s49, 0xffff
  ds_read_b64_tr_b16 v[32:33], v20 offset:32768
  v_mfma_f32_16x16x32_bf16 v[196:199], a[92:95], v[48:51], v[196:199]
  s_bfe_u32 s67, s59, 0x50013
  v_mfma_f32_16x16x32_bf16 v[224:227], a[156:159], v[48:51], v[224:227]
  s_lshl_b32 s67, s67, 8
  ds_read_b64_tr_b16 v[34:35], v20 offset:33280
  v_mfma_f32_16x16x32_bf16 v[228:231], a[220:223], v[48:51], v[228:231]
  s_bfe_u32 s68, s59, 0x1000c
  buffer_store_dwordx4 v[76:79], v9, s[40:43], s65 offen offset:3072 sc1
  v_mfma_f32_16x16x32_bf16 v[200:203], a[28:31], v[52:55], v[200:203]
  s_lshl_b32 s68, s68, 7
  ds_read_b64_tr_b16 v[36:37], v21 offset:32768
  v_mfma_f32_16x16x32_bf16 v[204:207], a[92:95], v[52:55], v[204:207]
  s_or_b32 s62, s67, s68
  v_mfma_f32_16x16x32_bf16 v[232:235], a[156:159], v[52:55], v[232:235]
  s_waitcnt lgkmcnt(3)
  s_bitcmp1_b32 s59, 2
  ds_read_b64_tr_b16 v[38:39], v21 offset:33280
  v_mfma_f32_16x16x32_bf16 v[236:239], a[220:223], v[52:55], v[236:239]
  s_cselect_b32 s62, 0x40000000, s62
  v_mfma_f32_16x16x32_bf16 v[208:211], a[28:31], v[56:59], v[208:211]
  ds_read_b64_tr_b16 v[40:41], v22 offset:32768
  v_mfma_f32_16x16x32_bf16 v[212:215], a[92:95], v[56:59], v[212:215]
  v_mfma_f32_16x16x32_bf16 v[240:243], a[156:159], v[56:59], v[240:243]
  ds_read_b64_tr_b16 v[42:43], v22 offset:33280
  v_mfma_f32_16x16x32_bf16 v[244:247], a[220:223], v[56:59], v[244:247]
  v_mfma_f32_16x16x32_bf16 v[216:219], a[28:31], v[60:63], v[216:219]
  ds_read_b64_tr_b16 v[44:45], v23 offset:32768
  v_mfma_f32_16x16x32_bf16 v[220:223], a[92:95], v[60:63], v[220:223]
  v_mfma_f32_16x16x32_bf16 v[248:251], a[156:159], v[60:63], v[248:251]
  s_waitcnt lgkmcnt(3)
  ds_read_b64_tr_b16 v[46:47], v23 offset:33280
  v_mfma_f32_16x16x32_bf16 v[252:255], a[220:223], v[60:63], v[252:255]
  v_mfma_f32_16x16x32_bf16 v[192:195], a[32:35], v[32:35], v[192:195]
  s_add_u32 m0, s64, 65536
  ds_read_b64_tr_b16 v[48:49], v20 offset:36864
  v_mfma_f32_16x16x32_bf16 v[196:199], a[96:99], v[32:35], v[196:199]
  v_mfma_f32_16x16x32_bf16 v[224:227], a[160:163], v[32:35], v[224:227]
  s_add_u32 s63, s62, 0
  ds_read_b64_tr_b16 v[50:51], v20 offset:37376
  v_mfma_f32_16x16x32_bf16 v[228:231], a[224:227], v[32:35], v[228:231]
  buffer_load_dwordx4 v2, s[48:51], s63 offen lds
  v_mfma_f32_16x16x32_bf16 v[200:203], a[32:35], v[36:39], v[200:203]
  ds_read_b64_tr_b16 v[52:53], v21 offset:36864
  v_mfma_f32_16x16x32_bf16 v[204:207], a[96:99], v[36:39], v[204:207]
  v_mfma_f32_16x16x32_bf16 v[232:235], a[160:163], v[36:39], v[232:235]
  s_waitcnt lgkmcnt(3)
  ds_read_b64_tr_b16 v[54:55], v21 offset:37376
  v_mfma_f32_16x16x32_bf16 v[236:239], a[224:227], v[36:39], v[236:239]
  v_mfma_f32_16x16x32_bf16 v[208:211], a[32:35], v[40:43], v[208:211]
  s_add_u32 m0, s64, 66560
  ds_read_b64_tr_b16 v[56:57], v22 offset:36864
  v_mfma_f32_16x16x32_bf16 v[212:215], a[96:99], v[40:43], v[212:215]
  v_mfma_f32_16x16x32_bf16 v[240:243], a[160:163], v[40:43], v[240:243]
  s_add_u32 s63, s62, 65536
  ds_read_b64_tr_b16 v[58:59], v22 offset:37376
  v_mfma_f32_16x16x32_bf16 v[244:247], a[224:227], v[40:43], v[244:247]
  buffer_load_dwordx4 v3, s[48:51], s63 offen lds
  v_mfma_f32_16x16x32_bf16 v[216:219], a[32:35], v[44:47], v[216:219]
  ds_read_b64_tr_b16 v[60:61], v23 offset:36864
  v_mfma_f32_16x16x32_bf16 v[220:223], a[96:99], v[44:47], v[220:223]
  v_mfma_f32_16x16x32_bf16 v[248:251], a[160:163], v[44:47], v[248:251]
  s_waitcnt lgkmcnt(3)
  ds_read_b64_tr_b16 v[62:63], v23 offset:37376
  v_mfma_f32_16x16x32_bf16 v[252:255], a[224:227], v[44:47], v[252:255]
  v_mfma_f32_16x16x32_bf16 v[192:195], a[36:39], v[48:51], v[192:195]
  s_add_u32 m0, s64, 67584
  ds_read_b64_tr_b16 v[32:33], v20 offset:40960
  v_mfma_f32_16x16x32_bf16 v[196:199], a[100:103], v[48:51], v[196:199]
  v_mfma_f32_16x16x32_bf16 v[224:227], a[164:167], v[48:51], v[224:227]
  s_add_u32 s63, s62, 131072
  ds_read_b64_tr_b16 v[34:35], v20 offset:41472
  v_mfma_f32_16x16x32_bf16 v[228:231], a[228:231], v[48:51], v[228:231]
  buffer_load_dwordx4 v2, s[48:51], s63 offen lds
  v_mfma_f32_16x16x32_bf16 v[200:203], a[36:39], v[52:55], v[200:203]
  ds_read_b64_tr_b16 v[36:37], v21 offset:40960
  v_mfma_f32_16x16x32_bf16 v[204:207], a[100:103], v[52:55], v[204:207]
  v_mfma_f32_16x16x32_bf16 v[232:235], a[164:167], v[52:55], v[232:235]
  s_waitcnt lgkmcnt(3)
  ds_read_b64_tr_b16 v[38:39], v21 offset:41472
  v_mfma_f32_16x16x32_bf16 v[236:239], a[228:231], v[52:55], v[236:239]
  v_mfma_f32_16x16x32_bf16 v[208:211], a[36:39], v[56:59], v[208:211]
  s_add_u32 m0, s64, 68608
  ds_read_b64_tr_b16 v[40:41], v22 offset:40960
  v_mfma_f32_16x16x32_bf16 v[212:215], a[100:103], v[56:59], v[212:215]
  v_mfma_f32_16x16x32_bf16 v[240:243], a[164:167], v[56:59], v[240:243]
  s_add_u32 s63, s62, 196608
  ds_read_b64_tr_b16 v[42:43], v22 offset:41472
  v_mfma_f32_16x16x32_bf16 v[244:247], a[228:231], v[56:59], v[244:247]
  buffer_load_dwordx4 v3, s[48:51], s63 offen lds
  v_mfma_f32_16x16x32_bf16 v[216:219], a[36:39], v[60:63], v[216:219]
  s_bfe_u32 s67, s61, 0x50013
  ds_read_b64_tr_b16 v[44:45], v23 offset:40960
  v_mfma_f32_16x16x32_bf16 v[220:223], a[100:103], v[60:63], v[220:223]
  s_lshl_b32 s67, s67, 7
  v_mfma_f32_16x16x32_bf16 v[248:251], a[164:167], v[60:63], v[248:251]
  s_waitcnt lgkmcnt(3)
  s_bfe_u32 s68, s61, 0x20004
  ds_read_b64_tr_b16 v[46:47], v23 offset:41472
  v_mfma_f32_16x16x32_bf16 v[252:255], a[228:231], v[60:63], v[252:255]
  s_lshl_b32 s68, s68, 5
  v_mfma_f32_16x16x32_bf16 v[192:195], a[40:43], v[32:35], v[192:195]
  s_or_b32 s69, s67, s68
  ds_read_b64_tr_b16 v[48:49], v20 offset:45056
  v_mfma_f32_16x16x32_bf16 v[196:199], a[104:107], v[32:35], v[196:199]
  s_bitcmp1_b32 s61, 2
  v_mfma_f32_16x16x32_bf16 v[224:227], a[168:171], v[32:35], v[224:227]
  s_cselect_b32 s69, 0x40000000, s69
  ds_read_b64_tr_b16 v[50:51], v20 offset:45568
  v_mfma_f32_16x16x32_bf16 v[228:231], a[232:235], v[32:35], v[228:231]
  v_mfma_f32_16x16x32_bf16 v[200:203], a[40:43], v[36:39], v[200:203]
  ds_read_b64_tr_b16 v[52:53], v21 offset:45056
  v_mfma_f32_16x16x32_bf16 v[204:207], a[104:107], v[36:39], v[204:207]
  v_mfma_f32_16x16x32_bf16 v[232:235], a[168:171], v[36:39], v[232:235]
  s_waitcnt lgkmcnt(3)
  ds_read_b64_tr_b16 v[54:55], v21 offset:45568
  v_mfma_f32_16x16x32_bf16 v[236:239], a[232:235], v[36:39], v[236:239]
  v_mfma_f32_16x16x32_bf16 v[208:211], a[40:43], v[40:43], v[208:211]
  ds_read_b64_tr_b16 v[56:57], v22 offset:45056
  v_mfma_f32_16x16x32_bf16 v[212:215], a[104:107], v[40:43], v[212:215]
  v_mfma_f32_16x16x32_bf16 v[240:243], a[168:171], v[40:43], v[240:243]
  ds_read_b64_tr_b16 v[58:59], v22 offset:45568
  v_mfma_f32_16x16x32_bf16 v[244:247], a[232:235], v[40:43], v[244:247]
  v_mfma_f32_16x16x32_bf16 v[216:219], a[40:43], v[44:47], v[216:219]
  s_waitcnt vmcnt(28)
  ds_read_b64_tr_b16 v[60:61], v23 offset:45056
  v_mfma_f32_16x16x32_bf16 v[220:223], a[104:107], v[44:47], v[220:223]
  s_barrier
  v_mfma_f32_16x16x32_bf16 v[248:251], a[168:171], v[44:47], v[248:251]
  s_waitcnt lgkmcnt(3)
  ds_read_b64_tr_b16 v[62:63], v23 offset:45568
  v_mfma_f32_16x16x32_bf16 v[252:255], a[232:235], v[44:47], v[252:255]
  buffer_atomic_add v11, v10, s[40:43], s69 offen
  v_mfma_f32_16x16x32_bf16 v[192:195], a[44:47], v[48:51], v[192:195]
  ds_read_b64_tr_b16 v[32:33], v20 offset:49152
  v_mfma_f32_16x16x32_bf16 v[196:199], a[108:111], v[48:51], v[196:199]
  v_mfma_f32_16x16x32_bf16 v[224:227], a[172:175], v[48:51], v[224:227]
  ds_read_b64_tr_b16 v[34:35], v20 offset:49664
  v_mfma_f32_16x16x32_bf16 v[228:231], a[236:239], v[48:51], v[228:231]
  v_mfma_f32_16x16x32_bf16 v[200:203], a[44:47], v[52:55], v[200:203]
  ds_read_b64_tr_b16 v[36:37], v21 offset:49152
  v_mfma_f32_16x16x32_bf16 v[204:207], a[108:111], v[52:55], v[204:207]
  v_mfma_f32_16x16x32_bf16 v[232:235], a[172:175], v[52:55], v[232:235]
  s_waitcnt lgkmcnt(3)
  ds_read_b64_tr_b16 v[38:39], v21 offset:49664
  v_mfma_f32_16x16x32_bf16 v[236:239], a[236:239], v[52:55], v[236:239]
  v_mfma_f32_16x16x32_bf16 v[208:211], a[44:47], v[56:59], v[208:211]
  ds_read_b64_tr_b16 v[40:41], v22 offset:49152
  v_mfma_f32_16x16x32_bf16 v[212:215], a[108:111], v[56:59], v[212:215]
  v_mfma_f32_16x16x32_bf16 v[240:243], a[172:175], v[56:59], v[240:243]
  ds_read_b64_tr_b16 v[42:43], v22 offset:49664
  v_mfma_f32_16x16x32_bf16 v[244:247], a[236:239], v[56:59], v[244:247]
  v_mfma_f32_16x16x32_bf16 v[216:219], a[44:47], v[60:63], v[216:219]
  ds_read_b64_tr_b16 v[44:45], v23 offset:49152
  v_mfma_f32_16x16x32_bf16 v[220:223], a[108:111], v[60:63], v[220:223]
  v_mfma_f32_16x16x32_bf16 v[248:251], a[172:175], v[60:63], v[248:251]
  s_waitcnt lgkmcnt(3)
  ds_read_b64_tr_b16 v[46:47], v23 offset:49664
  v_mfma_f32_16x16x32_bf16 v[252:255], a[236:239], v[60:63], v[252:255]
  v_mfma_f32_16x16x32_bf16 v[192:195], a[48:51], v[32:35], v[192:195]
  s_add_u32 m0, s64, 81920
  ds_read_b64_tr_b16 v[48:49], v20 offset:53248
  v_mfma_f32_16x16x32_bf16 v[196:199], a[112:115], v[32:35], v[196:199]
  v_mfma_f32_16x16x32_bf16 v[224:227], a[176:179], v[32:35], v[224:227]
  s_add_u32 s63, s62, 1048576
  ds_read_b64_tr_b16 v[50:51], v20 offset:53760
  v_mfma_f32_16x16x32_bf16 v[228:231], a[240:243], v[32:35], v[228:231]
  buffer_load_dwordx4 v2, s[48:51], s63 offen lds
  v_mfma_f32_16x16x32_bf16 v[200:203], a[48:51], v[36:39], v[200:203]
  ds_read_b64_tr_b16 v[52:53], v21 offset:53248
  v_mfma_f32_16x16x32_bf16 v[204:207], a[112:115], v[36:39], v[204:207]
  v_mfma_f32_16x16x32_bf16 v[232:235], a[176:179], v[36:39], v[232:235]
  s_waitcnt lgkmcnt(3)
  ds_read_b64_tr_b16 v[54:55], v21 offset:53760
  v_mfma_f32_16x16x32_bf16 v[236:239], a[240:243], v[36:39], v[236:239]
  v_mfma_f32_16x16x32_bf16 v[208:211], a[48:51], v[40:43], v[208:211]
  s_add_u32 m0, s64, 82944
  ds_read_b64_tr_b16 v[56:57], v22 offset:53248
  v_mfma_f32_16x16x32_bf16 v[212:215], a[112:115], v[40:43], v[212:215]
  v_mfma_f32_16x16x32_bf16 v[240:243], a[176:179], v[40:43], v[240:243]
  s_add_u32 s63, s62, 1114112
  ds_read_b64_tr_b16 v[58:59], v22 offset:53760
  v_mfma_f32_16x16x32_bf16 v[244:247], a[240:243], v[40:43], v[244:247]
  buffer_load_dwordx4 v3, s[48:51], s63 offen lds
  v_mfma_f32_16x16x32_bf16 v[216:219], a[48:51], v[44:47], v[216:219]
  ds_read_b64_tr_b16 v[60:61], v23 offset:53248
  v_mfma_f32_16x16x32_bf16 v[220:223], a[112:115], v[44:47], v[220:223]
  v_mfma_f32_16x16x32_bf16 v[248:251], a[176:179], v[44:47], v[248:251]
  s_waitcnt lgkmcnt(3)
  ds_read_b64_tr_b16 v[62:63], v23 offset:53760
  v_mfma_f32_16x16x32_bf16 v[252:255], a[240:243], v[44:47], v[252:255]
  v_mfma_f32_16x16x32_bf16 v[192:195], a[52:55], v[48:51], v[192:195]
  s_add_u32 m0, s64, 83968
  ds_read_b64_tr_b16 v[32:33], v20 offset:57344
  v_mfma_f32_16x16x32_bf16 v[196:199], a[116:119], v[48:51], v[196:199]
  v_mfma_f32_16x16x32_bf16 v[224:227], a[180:183], v[48:51], v[224:227]
  s_add_u32 s63, s62, 1179648
  ds_read_b64_tr_b16 v[34:35], v20 offset:57856
  v_mfma_f32_16x16x32_bf16 v[228:231], a[244:247], v[48:51], v[228:231]
  buffer_load_dwordx4 v2, s[48:51], s63 offen lds
  v_mfma_f32_16x16x32_bf16 v[200:203], a[52:55], v[52:55], v[200:203]
  ds_read_b64_tr_b16 v[36:37], v21 offset:57344
  v_mfma_f32_16x16x32_bf16 v[204:207], a[116:119], v[52:55], v[204:207]
  v_mfma_f32_16x16x32_bf16 v[232:235], a[180:183], v[52:55], v[232:235]
  s_waitcnt lgkmcnt(3)
  ds_read_b64_tr_b16 v[38:39], v21 offset:57856
  v_mfma_f32_16x16x32_bf16 v[236:239], a[244:247], v[52:55], v[236:239]
  v_mfma_f32_16x16x32_bf16 v[208:211], a[52:55], v[56:59], v[208:211]
  s_add_u32 m0, s64, 84992
  ds_read_b64_tr_b16 v[40:41], v22 offset:57344
  v_mfma_f32_16x16x32_bf16 v[212:215], a[116:119], v[56:59], v[212:215]
  v_mfma_f32_16x16x32_bf16 v[240:243], a[180:183], v[56:59], v[240:243]
  s_add_u32 s63, s62, 1245184
  ds_read_b64_tr_b16 v[42:43], v22 offset:57856
  v_mfma_f32_16x16x32_bf16 v[244:247], a[244:247], v[56:59], v[244:247]
  buffer_load_dwordx4 v3, s[48:51], s63 offen lds
  v_mfma_f32_16x16x32_bf16 v[216:219], a[52:55], v[60:63], v[216:219]
  ds_read_b64_tr_b16 v[44:45], v23 offset:57344
  v_mfma_f32_16x16x32_bf16 v[220:223], a[116:119], v[60:63], v[220:223]
  v_mfma_f32_16x16x32_bf16 v[248:251], a[180:183], v[60:63], v[248:251]
  s_waitcnt lgkmcnt(3)
  ds_read_b64_tr_b16 v[46:47], v23 offset:57856
  v_mfma_f32_16x16x32_bf16 v[252:255], a[244:247], v[60:63], v[252:255]
  v_mfma_f32_16x16x32_bf16 v[192:195], a[56:59], v[32:35], v[192:195]
  ds_read_b64_tr_b16 v[48:49], v20 offset:61440
  v_mfma_f32_16x16x32_bf16 v[196:199], a[120:123], v[32:35], v[196:199]
  v_mfma_f32_16x16x32_bf16 v[224:227], a[184:187], v[32:35], v[224:227]
  ds_read_b64_tr_b16 v[50:51], v20 offset:61952
  v_mfma_f32_16x16x32_bf16 v[228:231], a[248:251], v[32:35], v[228:231]
  v_mfma_f32_16x16x32_bf16 v[200:203], a[56:59], v[36:39], v[200:203]
  ds_read_b64_tr_b16 v[52:53], v21 offset:61440
  v_mfma_f32_16x16x32_bf16 v[204:207], a[120:123], v[36:39], v[204:207]
  v_mfma_f32_16x16x32_bf16 v[232:235], a[184:187], v[36:39], v[232:235]
  s_waitcnt lgkmcnt(3)
  ds_read_b64_tr_b16 v[54:55], v21 offset:61952
  v_mfma_f32_16x16x32_bf16 v[236:239], a[248:251], v[36:39], v[236:239]
  v_mfma_f32_16x16x32_bf16 v[208:211], a[56:59], v[40:43], v[208:211]
  ds_read_b64_tr_b16 v[56:57], v22 offset:61440
  v_mfma_f32_16x16x32_bf16 v[212:215], a[120:123], v[40:43], v[212:215]
  v_mfma_f32_16x16x32_bf16 v[240:243], a[184:187], v[40:43], v[240:243]
  ds_read_b64_tr_b16 v[58:59], v22 offset:61952
  v_mfma_f32_16x16x32_bf16 v[244:247], a[248:251], v[40:43], v[244:247]
  v_mfma_f32_16x16x32_bf16 v[216:219], a[56:59], v[44:47], v[216:219]
  s_waitcnt vmcnt(28)
  ds_read_b64_tr_b16 v[60:61], v23 offset:61440
  v_mfma_f32_16x16x32_bf16 v[220:223], a[120:123], v[44:47], v[220:223]
  s_barrier
  v_mfma_f32_16x16x32_bf16 v[248:251], a[184:187], v[44:47], v[248:251]
  s_waitcnt lgkmcnt(3)
  ds_read_b64_tr_b16 v[62:63], v23 offset:61952
  v_mfma_f32_16x16x32_bf16 v[252:255], a[248:251], v[44:47], v[252:255]
  v_mfma_f32_16x16x32_bf16 v[192:195], a[60:63], v[48:51], v[192:195]
  s_mov_b32 s61, s60
  ds_read_b64_tr_b16 v[32:33], v16 offset:0
  v_mfma_f32_16x16x32_bf16 v[196:199], a[124:127], v[48:51], v[196:199]
  s_mov_b32 s60, s57
  v_mfma_f32_16x16x32_bf16 v[224:227], a[188:191], v[48:51], v[224:227]
  s_mov_b32 s57, s58
  ds_read_b64_tr_b16 v[34:35], v16 offset:512
  v_mfma_f32_16x16x32_bf16 v[228:231], a[252:255], v[48:51], v[228:231]
  s_mov_b32 s58, s59
  v_mfma_f32_16x16x32_bf16 v[200:203], a[60:63], v[52:55], v[200:203]
  s_add_u32 s56, s56, 1
  ds_read_b64_tr_b16 v[36:37], v17 offset:0
  v_mfma_f32_16x16x32_bf16 v[204:207], a[124:127], v[52:55], v[204:207]
  v_mfma_f32_16x16x32_bf16 v[232:235], a[188:191], v[52:55], v[232:235]
  s_waitcnt lgkmcnt(3)
  ds_read_b64_tr_b16 v[38:39], v17 offset:512
  v_mfma_f32_16x16x32_bf16 v[236:239], a[252:255], v[52:55], v[236:239]
  v_mfma_f32_16x16x32_bf16 v[208:211], a[60:63], v[56:59], v[208:211]
  ds_read_b64_tr_b16 v[40:41], v18 offset:0
  v_mfma_f32_16x16x32_bf16 v[212:215], a[124:127], v[56:59], v[212:215]
  v_mfma_f32_16x16x32_bf16 v[240:243], a[188:191], v[56:59], v[240:243]
  ds_read_b64_tr_b16 v[42:43], v18 offset:512
  v_mfma_f32_16x16x32_bf16 v[244:247], a[252:255], v[56:59], v[244:247]
  v_mfma_f32_16x16x32_bf16 v[216:219], a[60:63], v[60:63], v[216:219]
  ds_read_b64_tr_b16 v[44:45], v19 offset:0
  v_mfma_f32_16x16x32_bf16 v[220:223], a[124:127], v[60:63], v[220:223]
  v_mfma_f32_16x16x32_bf16 v[248:251], a[188:191], v[60:63], v[248:251]
  s_waitcnt lgkmcnt(3)
  ds_read_b64_tr_b16 v[46:47], v19 offset:512
  v_mfma_f32_16x16x32_bf16 v[252:255], a[252:255], v[60:63], v[252:255]
  s_bitcmp1_b32 s57, 2
  s_cbranch_scc1 L_p_done_1
  s_bitcmp1_b32 s57, 0
  s_cbranch_scc1 L_p_body_0_1
  s_branch L_p_body_0_0
L_p_done_0:
  s_and_b32 s65, s60, 0x7fff000
  s_bitcmp1_b32 s60, 2
  s_cselect_b32 s65, 0x40000000, s65
  s_bitcmp1_b32 s60, 1
  s_cselect_b32 s66, 0x3e0293ee, 1.0
  s_nop 7
  v_mul_f32 v128, s66, v128
  v_mul_f32 v129, s66, v129
  v_cvt_pk_bf16_f32 v64, v128, v129
  v_mul_f32 v130, s66, v130
  v_mul_f32 v131, s66, v131
  v_cvt_pk_bf16_f32 v65, v130, v131
  v_mul_f32 v132, s66, v132
  v_mul_f32 v133, s66, v133
  v_cvt_pk_bf16_f32 v66, v132, v133
  v_mul_f32 v134, s66, v134
  v_mul_f32 v135, s66, v135
  v_cvt_pk_bf16_f32 v67, v134, v135
  buffer_store_dwordx4 v[64:67], v8, s[40:43], s65 offen offset:0 sc1
  v_mul_f32 v136, s66, v136
  v_mul_f32 v137, s66, v137
  v_cvt_pk_bf16_f32 v68, v136, v137
  v_mul_f32 v138, s66, v138
  v_mul_f32 v139, s66, v139
  v_cvt_pk_bf16_f32 v69, v138, v139
  v_mul_f32 v140, s66, v140
  v_mul_f32 v141, s66, v141
  v_cvt_pk_bf16_f32 v70, v140, v141
  v_mul_f32 v142, s66, v142
  v_mul_f32 v143, s66, v143
  v_cvt_pk_bf16_f32 v71, v142, v143
  buffer_store_dwordx4 v[68:71], v8, s[40:43], s65 offen offset:1024 sc1
  v_mul_f32 v144, s66, v144
  v_mul_f32 v145, s66, v145
  v_cvt_pk_bf16_f32 v72, v144, v145
  v_mul_f32 v146, s66, v146
  v_mul_f32 v147, s66, v147
  v_cvt_pk_bf16_f32 v73, v146, v147
  v_mul_f32 v148, s66, v148
  v_mul_f32 v149, s66, v149
  v_cvt_pk_bf16_f32 v74, v148, v149
  v_mul_f32 v150, s66, v150
  v_mul_f32 v151, s66, v151
  v_cvt_pk_bf16_f32 v75, v150, v151
  buffer_store_dwordx4 v[72:75], v8, s[40:43], s65 offen offset:2048 sc1
  v_mul_f32 v152, s66, v152
  v_mul_f32 v153, s66, v153
  v_cvt_pk_bf16_f32 v76, v152, v153
  v_mul_f32 v154, s66, v154
  v_mul_f32 v155, s66, v155
  v_cvt_pk_bf16_f32 v77, v154, v155
  v_mul_f32 v156, s66, v156
  v_mul_f32 v157, s66, v157
  v_cvt_pk_bf16_f32 v78, v156, v157
  v_mul_f32 v158, s66, v158
  v_mul_f32 v159, s66, v159
  v_cvt_pk_bf16_f32 v79, v158, v159
  buffer_store_dwordx4 v[76:79], v8, s[40:43], s65 offen offset:3072 sc1
  v_mul_f32 v160, s66, v160
  v_mul_f32 v161, s66, v161
  v_cvt_pk_bf16_f32 v64, v160, v161
  v_mul_f32 v162, s66, v162
  v_mul_f32 v163, s66, v163
  v_cvt_pk_bf16_f32 v65, v162, v163
  v_mul_f32 v164, s66, v164
  v_mul_f32 v165, s66, v165
  v_cvt_pk_bf16_f32 v66, v164, v165
  v_mul_f32 v166, s66, v166
  v_mul_f32 v167, s66, v167
  v_cvt_pk_bf16_f32 v67, v166, v167
  buffer_store_dwordx4 v[64:67], v9, s[40:43], s65 offen offset:0 sc1
  v_mul_f32 v168, s66, v168
  v_mul_f32 v169, s66, v169
  v_cvt_pk_bf16_f32 v68, v168, v169
  v_mul_f32 v170, s66, v170
  v_mul_f32 v171, s66, v171
  v_cvt_pk_bf16_f32 v69, v170, v171
  v_mul_f32 v172, s66, v172
  v_mul_f32 v173, s66, v173
  v_cvt_pk_bf16_f32 v70, v172, v173
  v_mul_f32 v174, s66, v174
  v_mul_f32 v175, s66, v175
  v_cvt_pk_bf16_f32 v71, v174, v175
  buffer_store_dwordx4 v[68:71], v9, s[40:43], s65 offen offset:1024 sc1
  v_mul_f32 v176, s66, v176
  v_mul_f32 v177, s66, v177
  v_cvt_pk_bf16_f32 v72, v176, v177
  v_mul_f32 v178, s66, v178
  v_mul_f32 v179, s66, v179
  v_cvt_pk_bf16_f32 v73, v178, v179
  v_mul_f32 v180, s66, v180
  v_mul_f32 v181, s66, v181
  v_cvt_pk_bf16_f32 v74, v180, v181
  v_mul_f32 v182, s66, v182
  v_mul_f32 v183, s66, v183
  v_cvt_pk_bf16_f32 v75, v182, v183
  buffer_store_dwordx4 v[72:75], v9, s[40:43], s65 offen offset:2048 sc1
  v_mul_f32 v184, s66, v184
  v_mul_f32 v185, s66, v185
  v_cvt_pk_bf16_f32 v76, v184, v185
  v_mul_f32 v186, s66, v186
  v_mul_f32 v187, s66, v187
  v_cvt_pk_bf16_f32 v77, v186, v187
  v_mul_f32 v188, s66, v188
  v_mul_f32 v189, s66, v189
  v_cvt_pk_bf16_f32 v78, v188, v189
  v_mul_f32 v190, s66, v190
  v_mul_f32 v191, s66, v191
  v_cvt_pk_bf16_f32 v79, v190, v191
  buffer_store_dwordx4 v[76:79], v9, s[40:43], s65 offen offset:3072 sc1
  s_branch L_p_fin
L_p_done_1:
  s_and_b32 s65, s60, 0x7fff000
  s_bitcmp1_b32 s60, 2
  s_cselect_b32 s65, 0x40000000, s65
  s_bitcmp1_b32 s60, 1
  s_cselect_b32 s66, 0x3e0293ee, 1.0
  s_nop 7
  v_mul_f32 v192, s66, v192
  v_mul_f32 v193, s66, v193
  v_cvt_pk_bf16_f32 v64, v192, v193
  v_mul_f32 v194, s66, v194
  v_mul_f32 v195, s66, v195
  v_cvt_pk_bf16_f32 v65, v194, v195
  v_mul_f32 v196, s66, v196
  v_mul_f32 v197, s66, v197
  v_cvt_pk_bf16_f32 v66, v196, v197
  v_mul_f32 v198, s66, v198
  v_mul_f32 v199, s66, v199
  v_cvt_pk_bf16_f32 v67, v198, v199
  buffer_store_dwordx4 v[64:67], v8, s[40:43], s65 offen offset:0 sc1
  v_mul_f32 v200, s66, v200
  v_mul_f32 v201, s66, v201
  v_cvt_pk_bf16_f32 v68, v200, v201
  v_mul_f32 v202, s66, v202
  v_mul_f32 v203, s66, v203
  v_cvt_pk_bf16_f32 v69, v202, v203
  v_mul_f32 v204, s66, v204
  v_mul_f32 v205, s66, v205
  v_cvt_pk_bf16_f32 v70, v204, v205
  v_mul_f32 v206, s66, v206
  v_mul_f32 v207, s66, v207
  v_cvt_pk_bf16_f32 v71, v206, v207
  buffer_store_dwordx4 v[68:71], v8, s[40:43], s65 offen offset:1024 sc1
  v_mul_f32 v208, s66, v208
  v_mul_f32 v209, s66, v209
  v_cvt_pk_bf16_f32 v72, v208, v209
  v_mul_f32 v210, s66, v210
  v_mul_f32 v211, s66, v211
  v_cvt_pk_bf16_f32 v73, v210, v211
  v_mul_f32 v212, s66, v212
  v_mul_f32 v213, s66, v213
  v_cvt_pk_bf16_f32 v74, v212, v213
  v_mul_f32 v214, s66, v214
  v_mul_f32 v215, s66, v215
  v_cvt_pk_bf16_f32 v75, v214, v215
  buffer_store_dwordx4 v[72:75], v8, s[40:43], s65 offen offset:2048 sc1
  v_mul_f32 v216, s66, v216
  v_mul_f32 v217, s66, v217
  v_cvt_pk_bf16_f32 v76, v216, v217
  v_mul_f32 v218, s66, v218
  v_mul_f32 v219, s66, v219
  v_cvt_pk_bf16_f32 v77, v218, v219
  v_mul_f32 v220, s66, v220
  v_mul_f32 v221, s66, v221
  v_cvt_pk_bf16_f32 v78, v220, v221
  v_mul_f32 v222, s66, v222
  v_mul_f32 v223, s66, v223
  v_cvt_pk_bf16_f32 v79, v222, v223
  buffer_store_dwordx4 v[76:79], v8, s[40:43], s65 offen offset:3072 sc1
  v_mul_f32 v224, s66, v224
  v_mul_f32 v225, s66, v225
  v_cvt_pk_bf16_f32 v64, v224, v225
  v_mul_f32 v226, s66, v226
  v_mul_f32 v227, s66, v227
  v_cvt_pk_bf16_f32 v65, v226, v227
  v_mul_f32 v228, s66, v228
  v_mul_f32 v229, s66, v229
  v_cvt_pk_bf16_f32 v66, v228, v229
  v_mul_f32 v230, s66, v230
  v_mul_f32 v231, s66, v231
  v_cvt_pk_bf16_f32 v67, v230, v231
  buffer_store_dwordx4 v[64:67], v9, s[40:43], s65 offen offset:0 sc1
  v_mul_f32 v232, s66, v232
  v_mul_f32 v233, s66, v233
  v_cvt_pk_bf16_f32 v68, v232, v233
  v_mul_f32 v234, s66, v234
  v_mul_f32 v235, s66, v235
  v_cvt_pk_bf16_f32 v69, v234, v235
  v_mul_f32 v236, s66, v236
  v_mul_f32 v237, s66, v237
  v_cvt_pk_bf16_f32 v70, v236, v237
  v_mul_f32 v238, s66, v238
  v_mul_f32 v239, s66, v239
  v_cvt_pk_bf16_f32 v71, v238, v239
  buffer_store_dwordx4 v[68:71], v9, s[40:43], s65 offen offset:1024 sc1
  v_mul_f32 v240, s66, v240
  v_mul_f32 v241, s66, v241
  v_cvt_pk_bf16_f32 v72, v240, v241
  v_mul_f32 v242, s66, v242
  v_mul_f32 v243, s66, v243
  v_cvt_pk_bf16_f32 v73, v242, v243
  v_mul_f32 v244, s66, v244
  v_mul_f32 v245, s66, v245
  v_cvt_pk_bf16_f32 v74, v244, v245
  v_mul_f32 v246, s66, v246
  v_mul_f32 v247, s66, v247
  v_cvt_pk_bf16_f32 v75, v246, v247
  buffer_store_dwordx4 v[72:75], v9, s[40:43], s65 offen offset:2048 sc1
  v_mul_f32 v248, s66, v248
  v_mul_f32 v249, s66, v249
  v_cvt_pk_bf16_f32 v76, v248, v249
  v_mul_f32 v250, s66, v250
  v_mul_f32 v251, s66, v251
  v_cvt_pk_bf16_f32 v77, v250, v251
  v_mul_f32 v252, s66, v252
  v_mul_f32 v253, s66, v253
  v_cvt_pk_bf16_f32 v78, v252, v253
  v_mul_f32 v254, s66, v254
  v_mul_f32 v255, s66, v255
  v_cvt_pk_bf16_f32 v79, v254, v255
  buffer_store_dwordx4 v[76:79], v9, s[40:43], s65 offen offset:3072 sc1
L_p_fin:
  s_waitcnt vmcnt(0) lgkmcnt(0)
  s_barrier
  s_bfe_u32 s67, s61, 0x50013
  s_lshl_b32 s67, s67, 7
  s_bfe_u32 s68, s61, 0x20004
  s_lshl_b32 s68, s68, 5
  s_or_b32 s69, s67, s68
  s_bitcmp1_b32 s61, 2
  s_cselect_b32 s69, 0x40000000, s69
  buffer_atomic_add v11, v10, s[40:43], s69 offen
  s_bfe_u32 s67, s60, 0x50013
  s_lshl_b32 s67, s67, 7
  s_bfe_u32 s68, s60, 0x20004
  s_lshl_b32 s68, s68, 5
  s_or_b32 s69, s67, s68
  s_bitcmp1_b32 s60, 2
  s_cselect_b32 s69, 0x40000000, s69
  buffer_atomic_add v11, v10, s[40:43], s69 offen
  s_branch L_p_end
L_p_end:
  s_mov_b32 s95, 32
L_next:
  v_readlane_b32 s3, v1, s95
  s_add_u32 s95, s95, 1
  s_and_b32 s5, s45, 7
  s_and_b32 s4, s3, 3
  s_cmp_eq_u32 s4, 0
  s_cbranch_scc1 L_after_p
  s_cmp_eq_u32 s4, 2
  s_cbranch_scc1 L_go_outx
  s_bfe_u32 s4, s3, 0x20002
  s_lshl3_add_u32 s56, s4, s5
  s_bfe_u32 s57, s3, 0x30004
L_att:
  v_lshlrev_b32 v2, 4, v0
  s_lshl_b32 s66, s44, 11
  v_add_u32 v3, s66, v2
  s_mov_b32 s84, 0
  v_and_b32 v6, 7, v0
  v_min_u32 v6, s57, v6
  v_mov_b32 v7, s57
  v_add_u32 v7, 8, v7
  v_cmp_gt_u32 vcc, 8, v0
  s_lshl_b32 s67, s56, 7
  s_add_u32 s67, s67, 0x9080000
  v_cndmask_b32 v6, v7, v6, vcc
  v_cndmask_b32 v7, 2, 4, vcc
  v_lshl_add_u32 v6, v6, 2, s67
  s_lshl_b32 s67, s57, 7
  s_add_u32 s67, s67, 0x9086400
  v_writelane_b32 v6, s67, 63
  v_writelane_b32 v7, 1, 63
L_a_wait:
  buffer_load_dword v24, v6, s[40:43], 0 offen sc1
  s_add_u32 s84, s84, 1
  s_cmp_gt_u32 s84, 1048576
  s_cbranch_scc1 L_exit
  s_waitcnt vmcnt(0)
  v_cmp_ne_u32 vcc, v7, v24
  s_cbranch_vccnz L_a_wait
  s_lshl_b32 s67, s56, 19
  s_add_u32 s61, s67, 0x1000000
  s_add_u32 s62, s67, 0x2000000
  s_lshl_b32 s59, s57, 3
  s_lshl_b32 s68, s44, 1
  s_add_u32 s68, s68, s59
  s_add_u32 s60, s68, 1
  s_sub_u32 s69, s68, 1
  s_lshl_b32 s71, s68, 13
  s_add_u32 s71, s71, s67
  s_lshl_b32 s72, s68, 19
  s_lshl_b32 s67, s56, 13
  s_add_u32 s72, s72, s67
  s_add_u32 s72, s72, 0x6000000
  s_add_u32 s64, s59, 7
  s_lshl_b32 s64, s64, 13
  s_add_u32 s64, s64, s61
  s_add_u32 s59, s59, 1
  s_add_u32 s63, s61, 0x4000
  s_mov_b32 s65, 0
  s_mov_b32 s73, 0x40004000
  s_add_u32 m0, s66, 131072
  s_add_u32 s67, s61, 0x2000
  buffer_load_dwordx4 v3, s[40:43], s61 offen sc1 lds
  buffer_load_dwordx4 v3, s[40:43], s61 offen offset:1024 sc1 lds
  s_add_u32 s58, s71, 0x1000
  buffer_load_dwordx4 a[0:3], v2, s[40:43], s71 offen offset:0 sc1
  buffer_load_dwordx4 a[4:7], v2, s[40:43], s71 offen offset:2048 sc1
  buffer_load_dwordx4 a[8:11], v2, s[40:43], s58 offen offset:0 sc1
  buffer_load_dwordx4 a[12:15], v2, s[40:43], s58 offen offset:2048 sc1
  s_add_u32 s58, s71, 0x1000
  buffer_load_dwordx4 a[16:19], v2, s[40:43], s71 offen offset:1024 sc1
  buffer_load_dwordx4 a[20:23], v2, s[40:43], s71 offen offset:3072 sc1
  buffer_load_dwordx4 a[24:27], v2, s[40:43], s58 offen offset:1024 sc1
  buffer_load_dwordx4 a[28:31], v2, s[40:43], s58 offen offset:3072 sc1
  s_add_u32 s71, s71, 0x2000
  s_add_u32 s58, s71, 0x1000
  buffer_load_dwordx4 a[32:35], v2, s[40:43], s71 offen offset:0 sc1
  buffer_load_dwordx4 a[36:39], v2, s[40:43], s71 offen offset:2048 sc1
  buffer_load_dwordx4 a[40:43], v2, s[40:43], s58 offen offset:0 sc1
  buffer_load_dwordx4 a[44:47], v2, s[40:43], s58 offen offset:2048 sc1
  s_add_u32 s58, s71, 0x1000
  buffer_load_dwordx4 a[48:51], v2, s[40:43], s71 offen offset:1024 sc1
  buffer_load_dwordx4 a[52:55], v2, s[40:43], s71 offen offset:3072 sc1
  buffer_load_dwordx4 a[56:59], v2, s[40:43], s58 offen offset:1024 sc1
  buffer_load_dwordx4 a[60:63], v2, s[40:43], s58 offen offset:3072 sc1
  s_add_u32 m0, s66, 139264
  v_and_b32 v6, 15, v0
  v_lshlrev_b32 v6, 2, v6
  buffer_load_dwordx4 v3, s[40:43], s67 offen sc1 lds
  buffer_load_dwordx4 v3, s[40:43], s67 offen offset:1024 sc1 lds
  s_lshl_b32 s68, s68, 7
  s_add_u32 s68, s68, 0x90c0000
  buffer_load_dword v20, v6, s[40:43], s68 offen offset:0 sc1
  buffer_load_dword v21, v6, s[40:43], s68 offen offset:64 sc1
  buffer_load_dword v22, v6, s[40:43], s68 offen offset:128 sc1
  buffer_load_dword v23, v6, s[40:43], s68 offen offset:192 sc1
  s_add_u32 m0, s65, s66
  s_nop 0
  buffer_load_dwordx4 v3, s[40:43], s62 offen sc1 lds
  s_min_u32 s67, s63, s64
  s_nop 0
  buffer_load_dwordx4 v3, s[40:43], s62 offen offset:1024 sc1 lds
  s_add_u32 m0, m0, 0x2000
  s_nop 0
  buffer_load_dwordx4 v3, s[40:43], s67 offen sc1 lds
  s_add_u32 s62, s62, 0x2000
  s_nop 0
  buffer_load_dwordx4 v3, s[40:43], s67 offen offset:1024 sc1 lds
  s_add_u32 s63, s63, 0x2000
  s_add_u32 s65, s65, 0x4000
  s_and_b32 s65, s65, 0x1ffff
  s_add_u32 m0, s65, s66
  s_nop 0
  buffer_load_dwordx4 v3, s[40:43], s62 offen sc1 lds
  s_min_u32 s67, s63, s64
  s_nop 0
  buffer_load_dwordx4 v3, s[40:43], s62 offen offset:1024 sc1 lds
  s_add_u32 m0, m0, 0x2000
  s_nop 0
  buffer_load_dwordx4 v3, s[40:43], s67 offen sc1 lds
  s_add_u32 s62, s62, 0x2000
  s_nop 0
  buffer_load_dwordx4 v3, s[40:43], s67 offen offset:1024 sc1 lds
  s_add_u32 s63, s63, 0x2000
  s_add_u32 s65, s65, 0x4000
  s_and_b32 s65, s65, 0x1ffff
  s_add_u32 m0, s65, s66
  s_nop 0
  buffer_load_dwordx4 v3, s[40:43], s62 offen sc1 lds
  s_min_u32 s67, s63, s64
  s_nop 0
  buffer_load_dwordx4 v3, s[40:43], s62 offen offset:1024 sc1 lds
  s_add_u32 m0, m0, 0x2000
  s_nop 0
  buffer_load_dwordx4 v3, s[40:43], s67 offen sc1 lds
  s_add_u32 s62, s62, 0x2000
  s_nop 0
  buffer_load_dwordx4 v3, s[40:43], s67 offen offset:1024 sc1 lds
  s_add_u32 s63, s63, 0x2000
  s_add_u32 s65, s65, 0x4000
  s_and_b32 s65, s65, 0x1ffff
  s_add_u32 m0, s65, s66
  s_nop 0
  buffer_load_dwordx4 v3, s[40:43], s62 offen sc1 lds
  s_min_u32 s67, s63, s64
  s_nop 0
  buffer_load_dwordx4 v3, s[40:43], s62 offen offset:1024 sc1 lds
  s_add_u32 m0, m0, 0x2000
  s_nop 0
  buffer_load_dwordx4 v3, s[40:43], s67 offen sc1 lds
  s_add_u32 s62, s62, 0x2000
  s_nop 0
  buffer_load_dwordx4 v3, s[40:43], s67 offen offset:1024 sc1 lds
  s_add_u32 s63, s63, 0x2000
  s_add_u32 s65, s65, 0x4000
  s_and_b32 s65, s65, 0x1ffff
  s_add_u32 m0, s65, s66
  s_nop 0
  buffer_load_dwordx4 v3, s[40:43], s62 offen sc1 lds
  s_min_u32 s67, s63, s64
  s_nop 0
  buffer_load_dwordx4 v3, s[40:43], s62 offen offset:1024 sc1 lds
  s_add_u32 m0, m0, 0x2000
  s_nop 0
  buffer_load_dwordx4 v3, s[40:43], s67 offen sc1 lds
  s_add_u32 s62, s62, 0x2000
  s_nop 0
  buffer_load_dwordx4 v3, s[40:43], s67 offen offset:1024 sc1 lds
  s_add_u32 s63, s63, 0x2000
  s_add_u32 s65, s65, 0x4000
  s_and_b32 s65, s65, 0x1ffff
  s_add_u32 m0, s65, s66
  s_nop 0
  buffer_load_dwordx4 v3, s[40:43], s62 offen sc1 lds
  s_min_u32 s67, s63, s64
  s_nop 0
  buffer_load_dwordx4 v3, s[40:43], s62 offen offset:1024 sc1 lds
  s_add_u32 m0, m0, 0x2000
  s_nop 0
  buffer_load_dwordx4 v3, s[40:43], s67 offen sc1 lds
  s_add_u32 s62, s62, 0x2000
  s_nop 0
  buffer_load_dwordx4 v3, s[40:43], s67 offen offset:1024 sc1 lds
  s_add_u32 s63, s63, 0x2000
  s_add_u32 s65, s65, 0x4000
  s_and_b32 s65, s65, 0x1ffff
  s_add_u32 m0, s65, s66
  s_nop 0
  buffer_load_dwordx4 v3, s[40:43], s62 offen sc1 lds
  s_min_u32 s67, s63, s64
  s_nop 0
  buffer_load_dwordx4 v3, s[40:43], s62 offen offset:1024 sc1 lds
  s_add_u32 m0, m0, 0x2000
  s_nop 0
  buffer_load_dwordx4 v3, s[40:43], s67 offen sc1 lds
  s_add_u32 s62, s62, 0x2000
  s_nop 0
  buffer_load_dwordx4 v3, s[40:43], s67 offen offset:1024 sc1 lds
  s_add_u32 s63, s63, 0x2000
  s_add_u32 s65, s65, 0x4000
  s_and_b32 s65, s65, 0x1ffff
  v_mov_b64 v[128:129], 0
  v_mov_b64 v[130:131], 0
  v_mov_b64 v[132:133], 0
  v_mov_b64 v[134:135], 0
  v_mov_b64 v[136:137], 0
  v_mov_b64 v[138:139], 0
  v_mov_b64 v[140:141], 0
  v_mov_b64 v[142:143], 0
  v_mov_b64 v[144:145], 0
  v_mov_b64 v[146:147], 0
  v_mov_b64 v[148:149], 0
  v_mov_b64 v[150:151], 0
  v_mov_b64 v[152:153], 0
  v_mov_b64 v[154:155], 0
  v_mov_b64 v[156:157], 0
  v_mov_b64 v[158:159], 0
  v_mov_b64 v[160:161], 0
  v_mov_b64 v[162:163], 0
  v_mov_b64 v[164:165], 0
  v_mov_b64 v[166:167], 0
  v_mov_b64 v[168:169], 0
  v_mov_b64 v[170:171], 0
  v_mov_b64 v[172:173], 0
  v_mov_b64 v[174:175], 0
  v_mov_b64 v[176:177], 0
  v_mov_b64 v[178:179], 0
  v_mov_b64 v[180:181], 0
  v_mov_b64 v[182:183], 0
  v_mov_b64 v[184:185], 0
  v_mov_b64 v[186:187], 0
  v_mov_b64 v[188:189], 0
  v_mov_b64 v[190:191], 0
  v_mov_b64 v[192:193], 0
  v_mov_b64 v[194:195], 0
  v_mov_b64 v[196:197], 0
  v_mov_b64 v[198:199], 0
  v_mov_b64 v[200:201], 0
  v_mov_b64 v[202:203], 0
  v_mov_b64 v[204:205], 0
  v_mov_b64 v[206:207], 0
  v_mov_b64 v[208:209], 0
  v_mov_b64 v[210:211], 0
  v_mov_b64 v[212:213], 0
  v_mov_b64 v[214:215], 0
  v_mov_b64 v[216:217], 0
  v_mov_b64 v[218:219], 0
  v_mov_b64 v[220:221], 0
  v_mov_b64 v[222:223], 0
  v_mov_b64 v[224:225], 0
  v_mov_b64 v[226:227], 0
  v_mov_b64 v[228:229], 0
  v_mov_b64 v[230:231], 0
  v_mov_b64 v[232:233], 0
  v_mov_b64 v[234:235], 0
  v_mov_b64 v[236:237], 0
  v_mov_b64 v[238:239], 0
  v_mov_b64 v[240:241], 0
  v_mov_b64 v[242:243], 0
  v_mov_b64 v[244:245], 0
  v_mov_b64 v[246:247], 0
  v_mov_b64 v[248:249], 0
  v_mov_b64 v[250:251], 0
  v_mov_b64 v[252:253], 0
  v_mov_b64 v[254:255], 0
  v_mov_b64 v[96:97], 0
  v_accvgpr_write_b32 a128, 0
  v_mov_b64 v[98:99], 0
  v_accvgpr_write_b32 a129, 0
  v_mov_b64 v[100:101], 0
  v_accvgpr_write_b32 a130, 0
  v_mov_b64 v[102:103], 0
  v_accvgpr_write_b32 a131, 0
  v_mov_b64 v[104:105], 0
  v_accvgpr_write_b32 a132, 0
  v_mov_b64 v[106:107], 0
  v_accvgpr_write_b32 a133, 0
  v_mov_b64 v[108:109], 0
  v_accvgpr_write_b32 a134, 0
  v_mov_b64 v[110:111], 0
  v_accvgpr_write_b32 a135, 0
  v_mov_b64 v[112:113], 0
  v_accvgpr_write_b32 a136, 0
  v_mov_b64 v[114:115], 0
  v_accvgpr_write_b32 a137, 0
  v_mov_b64 v[116:117], 0
  v_accvgpr_write_b32 a138, 0
  v_mov_b64 v[118:119], 0
  v_accvgpr_write_b32 a139, 0
  v_mov_b64 v[120:121], 0
  v_accvgpr_write_b32 a140, 0
  v_mov_b64 v[122:123], 0
  v_accvgpr_write_b32 a141, 0
  v_mov_b64 v[124:125], 0
  v_accvgpr_write_b32 a142, 0
  v_mov_b64 v[126:127], 0
  v_accvgpr_write_b32 a143, 0
  v_mov_b32 v16, 0x3f803f80
  v_mov_b32 v17, 0x3f803f80
  v_mov_b32 v18, 0x3f803f80
  v_mov_b32 v19, 0x3f803f80
  v_lshrrev_b32 v6, 4, v0
  v_lshlrev_b32 v6, 2, v6
  v_and_b32 v7, 15, v0
  v_sub_u32 v6, v7, v6
  v_cmp_gt_i32 s[76:77], 0, v6
  v_cmp_gt_i32 s[78:79], 1, v6
  v_cmp_gt_i32 s[80:81], 2, v6
  v_cmp_gt_i32 s[82:83], 3, v6
  v_add_u32 v4, 122880, v2
  s_mov_b32 s58, -1
  s_mov_b32 s74, 4
  s_waitcnt vmcnt(28)
  s_sub_u32 s68, s58, s69
  s_cmp_lt_u32 s68, 2
  s_cbranch_scc1 L_a_mask
L_a_pre_m:
  s_cmp_eq_u32 s58, 0
  s_cbranch_scc1 L_a_s0
  s_barrier
  ds_read_b128 a[64:67], v4 offset:8192
  ds_read_b128 a[68:71], v4 offset:9216
  ds_read_b128 a[72:75], v4 offset:10240
  ds_read_b128 a[76:79], v4 offset:11264
  ds_read_b128 a[80:83], v4 offset:12288
  ds_read_b128 a[84:87], v4 offset:13312
  ds_read_b128 a[88:91], v4 offset:14336
  ds_read_b128 a[92:95], v4 offset:15360
  v_add_u32 v4, 0x2000, v4
  s_waitcnt lgkmcnt(0)
  v_mfma_f32_16x16x32_bf16 v[32:35], a[64:67], a[0:3], v[96:99]
  v_mfma_f32_16x16x32_bf16 v[32:35], a[72:75], a[4:7], v[32:35]
  v_mfma_f32_16x16x32_bf16 v[32:35], a[80:83], a[8:11], v[32:35]
  v_mfma_f32_16x16x32_bf16 v[32:35], a[88:91], a[12:15], v[32:35]
  v_mfma_f32_16x16x32_bf16 v[36:39], a[68:71], a[0:3], v[100:103]
  v_mfma_f32_16x16x32_bf16 v[36:39], a[76:79], a[4:7], v[36:39]
  v_mfma_f32_16x16x32_bf16 v[36:39], a[84:87], a[8:11], v[36:39]
  v_mfma_f32_16x16x32_bf16 v[36:39], a[92:95], a[12:15], v[36:39]
  v_mfma_f32_16x16x32_bf16 v[40:43], a[64:67], a[16:19], v[104:107]
  v_mfma_f32_16x16x32_bf16 v[40:43], a[72:75], a[20:23], v[40:43]
  v_mfma_f32_16x16x32_bf16 v[40:43], a[80:83], a[24:27], v[40:43]
  v_mfma_f32_16x16x32_bf16 v[40:43], a[88:91], a[28:31], v[40:43]
  v_mfma_f32_16x16x32_bf16 v[44:47], a[68:71], a[16:19], v[108:111]
  v_mfma_f32_16x16x32_bf16 v[44:47], a[76:79], a[20:23], v[44:47]
  v_mfma_f32_16x16x32_bf16 v[44:47], a[84:87], a[24:27], v[44:47]
  v_mfma_f32_16x16x32_bf16 v[44:47], a[92:95], a[28:31], v[44:47]
  v_mfma_f32_16x16x32_bf16 v[48:51], a[64:67], a[32:35], v[112:115]
  v_mfma_f32_16x16x32_bf16 v[48:51], a[72:75], a[36:39], v[48:51]
  v_mfma_f32_16x16x32_bf16 v[48:51], a[80:83], a[40:43], v[48:51]
  v_mfma_f32_16x16x32_bf16 v[48:51], a[88:91], a[44:47], v[48:51]
  v_mfma_f32_16x16x32_bf16 v[52:55], a[68:71], a[32:35], v[116:119]
  v_mfma_f32_16x16x32_bf16 v[52:55], a[76:79], a[36:39], v[52:55]
  v_mfma_f32_16x16x32_bf16 v[52:55], a[84:87], a[40:43], v[52:55]
  v_mfma_f32_16x16x32_bf16 v[52:55], a[92:95], a[44:47], v[52:55]
  v_mfma_f32_16x16x32_bf16 v[56:59], a[64:67], a[48:51], v[120:123]
  v_mfma_f32_16x16x32_bf16 v[56:59], a[72:75], a[52:55], v[56:59]
  v_mfma_f32_16x16x32_bf16 v[56:59], a[80:83], a[56:59], v[56:59]
  v_mfma_f32_16x16x32_bf16 v[56:59], a[88:91], a[60:63], v[56:59]
  v_mfma_f32_16x16x32_bf16 v[60:63], a[68:71], a[48:51], v[124:127]
  v_mfma_f32_16x16x32_bf16 v[60:63], a[76:79], a[52:55], v[60:63]
  v_mfma_f32_16x16x32_bf16 v[60:63], a[84:87], a[56:59], v[60:63]
  v_mfma_f32_16x16x32_bf16 v[60:63], a[92:95], a[60:63], v[60:63]
  ds_read_b128 a[64:67], v4 offset:8192
  ds_read_b128 a[68:71], v4 offset:9216
  ds_read_b128 a[72:75], v4 offset:10240
  ds_read_b128 a[76:79], v4 offset:11264
  ds_read_b128 a[80:83], v4 offset:12288
  ds_read_b128 a[84:87], v4 offset:13312
  ds_read_b128 a[88:91], v4 offset:14336
  ds_read_b128 a[92:95], v4 offset:15360
  v_mov_b32 v4, v2
  v_max3_f32 v6, v32, v33, v34
  v_max3_f32 v7, v35, v36, v37
  v_max3_f32 v6, v6, v38, v39
  v_max_f32 v6, v6, v7
  v_mov_b32 v7, v6
  s_nop 1
  v_permlane32_swap_b32 v7, v6
  v_max_f32 v6, v6, v7
  v_mov_b32 v7, v6
  s_nop 1
  v_permlane16_swap_b32 v7, v6
  v_max_f32 v6, v6, v7
  v_add_f32 v6, 0x41800000, v6
  v_sub_f32 v96, v96, v6
  v_sub_f32 v97, v97, v6
  v_sub_f32 v98, v98, v6
  v_sub_f32 v99, v99, v6
  v_sub_f32 v100, v100, v6
  v_sub_f32 v101, v101, v6
  v_sub_f32 v102, v102, v6
  v_sub_f32 v103, v103, v6
  v_sub_f32 v8, v32, v6
  v_sub_f32 v9, v33, v6
  v_sub_f32 v10, v34, v6
  v_sub_f32 v11, v35, v6
  v_sub_f32 v12, v36, v6
  v_sub_f32 v13, v37, v6
  v_sub_f32 v14, v38, v6
  v_sub_f32 v15, v39, v6
  v_exp_f32 v8, v8
  v_exp_f32 v9, v9
  v_exp_f32 v10, v10
  v_exp_f32 v11, v11
  v_exp_f32 v12, v12
  v_exp_f32 v13, v13
  v_exp_f32 v14, v14
  v_exp_f32 v15, v15
  v_cvt_pk_bf16_f32 v64, v8, v9
  v_cvt_pk_bf16_f32 v65, v10, v11
  v_cvt_pk_bf16_f32 v66, v12, v13
  v_cvt_pk_bf16_f32 v67, v14, v15
  v_max3_f32 v6, v40, v41, v42
  v_max3_f32 v7, v43, v44, v45
  v_max3_f32 v6, v6, v46, v47
  v_max_f32 v6, v6, v7
  v_mov_b32 v7, v6
  s_nop 1
  v_permlane32_swap_b32 v7, v6
  v_max_f32 v6, v6, v7
  v_mov_b32 v7, v6
  s_nop 1
  v_permlane16_swap_b32 v7, v6
  v_max_f32 v6, v6, v7
  v_add_f32 v6, 0x41800000, v6
  v_sub_f32 v104, v104, v6
  v_sub_f32 v105, v105, v6
  v_sub_f32 v106, v106, v6
  v_sub_f32 v107, v107, v6
  v_sub_f32 v108, v108, v6
  v_sub_f32 v109, v109, v6
  v_sub_f32 v110, v110, v6
  v_sub_f32 v111, v111, v6
  v_sub_f32 v8, v40, v6
  v_sub_f32 v9, v41, v6
  v_sub_f32 v10, v42, v6
  v_sub_f32 v11, v43, v6
  v_sub_f32 v12, v44, v6
  v_sub_f32 v13, v45, v6
  v_sub_f32 v14, v46, v6
  v_sub_f32 v15, v47, v6
  v_exp_f32 v8, v8
  v_exp_f32 v9, v9
  v_exp_f32 v10, v10
  v_exp_f32 v11, v11
  v_exp_f32 v12, v12
  v_exp_f32 v13, v13
  v_exp_f32 v14, v14
  v_exp_f32 v15, v15
  v_cvt_pk_bf16_f32 v68, v8, v9
  v_cvt_pk_bf16_f32 v69, v10, v11
  v_cvt_pk_bf16_f32 v70, v12, v13
  v_cvt_pk_bf16_f32 v71, v14, v15
  v_max3_f32 v6, v48, v49, v50
  v_max3_f32 v7, v51, v52, v53
  v_max3_f32 v6, v6, v54, v55
  v_max_f32 v6, v6, v7
  v_mov_b32 v7, v6
  s_nop 1
  v_permlane32_swap_b32 v7, v6
  v_max_f32 v6, v6, v7
  v_mov_b32 v7, v6
  s_nop 1
  v_permlane16_swap_b32 v7, v6
  v_max_f32 v6, v6, v7
  v_add_f32 v6, 0x41800000, v6
  v_sub_f32 v112, v112, v6
  v_sub_f32 v113, v113, v6
  v_sub_f32 v114, v114, v6
  v_sub_f32 v115, v115, v6
  v_sub_f32 v116, v116, v6
  v_sub_f32 v117, v117, v6
  v_sub_f32 v118, v118, v6
  v_sub_f32 v119, v119, v6
  v_sub_f32 v8, v48, v6
  v_sub_f32 v9, v49, v6
  v_sub_f32 v10, v50, v6
  v_sub_f32 v11, v51, v6
  v_sub_f32 v12, v52, v6
  v_sub_f32 v13, v53, v6
  v_sub_f32 v14, v54, v6
  v_sub_f32 v15, v55, v6
  v_exp_f32 v8, v8
  v_exp_f32 v9, v9
  v_exp_f32 v10, v10
  v_exp_f32 v11, v11
  v_exp_f32 v12, v12
  v_exp_f32 v13, v13
  v_exp_f32 v14, v14
  v_exp_f32 v15, v15
  v_cvt_pk_bf16_f32 v72, v8, v9
  v_cvt_pk_bf16_f32 v73, v10, v11
  v_cvt_pk_bf16_f32 v74, v12, v13
  v_cvt_pk_bf16_f32 v75, v14, v15
  v_max3_f32 v6, v56, v57, v58
  v_max3_f32 v7, v59, v60, v61
  v_max3_f32 v6, v6, v62, v63
  v_max_f32 v6, v6, v7
  v_mov_b32 v7, v6
  s_nop 1
  v_permlane32_swap_b32 v7, v6
  v_max_f32 v6, v6, v7
  v_mov_b32 v7, v6
  s_nop 1
  v_permlane16_swap_b32 v7, v6
  v_max_f32 v6, v6, v7
  v_add_f32 v6, 0x41800000, v6
  v_sub_f32 v120, v120, v6
  v_sub_f32 v121, v121, v6
  v_sub_f32 v122, v122, v6
  v_sub_f32 v123, v123, v6
  v_sub_f32 v124, v124, v6
  v_sub_f32 v125, v125, v6
  v_sub_f32 v126, v126, v6
  v_sub_f32 v127, v127, v6
  v_sub_f32 v8, v56, v6
  v_sub_f32 v9, v57, v6
  v_sub_f32 v10, v58, v6
  v_sub_f32 v11, v59, v6
  v_sub_f32 v12, v60, v6
  v_sub_f32 v13, v61, v6
  v_sub_f32 v14, v62, v6
  v_sub_f32 v15, v63, v6
  v_exp_f32 v8, v8
  v_exp_f32 v9, v9
  v_exp_f32 v10, v10
  v_exp_f32 v11, v11
  v_exp_f32 v12, v12
  v_exp_f32 v13, v13
  v_exp_f32 v14, v14
  v_exp_f32 v15, v15
  v_cvt_pk_bf16_f32 v76, v8, v9
  v_cvt_pk_bf16_f32 v77, v10, v11
  v_cvt_pk_bf16_f32 v78, v12, v13
  v_cvt_pk_bf16_f32 v79, v14, v15
  s_mov_b32 s58, 0
  s_sub_u32 s68, s58, s69
  s_cmp_lt_u32 s68, 2
  s_cbranch_scc1 L_a_mask
L_a_s0:
  s_waitcnt vmcnt(24) lgkmcnt(0)
  v_mfma_f32_16x16x32_bf16 v[32:35], a[64:67], a[0:3], v[96:99]
  s_barrier
  ds_read_b128 a[96:99], v4 offset:0
  v_mfma_f32_16x16x32_bf16 v[32:35], a[72:75], a[4:7], v[32:35]
  ds_read_b128 a[100:103], v4 offset:1024
  v_mfma_f32_16x16x32_bf16 v[32:35], a[80:83], a[8:11], v[32:35]
  ds_read_b128 a[104:107], v4 offset:2048
  v_mfma_f32_16x16x32_bf16 v[32:35], a[88:91], a[12:15], v[32:35]
  s_nop 0
  ds_read_b128 a[108:111], v4 offset:3072
  v_mfma_f32_16x16x32_bf16 v[36:39], a[68:71], a[0:3], v[100:103]
  s_nop 0
  ds_read_b128 a[112:115], v4 offset:4096
  v_mfma_f32_16x16x32_bf16 v[36:39], a[76:79], a[4:7], v[36:39]
  s_nop 0
  ds_read_b128 a[116:119], v4 offset:5120
  v_mfma_f32_16x16x32_bf16 v[36:39], a[84:87], a[8:11], v[36:39]
  v_exp_f32 v8, v32
  v_mfma_f32_16x16x32_bf16 v[36:39], a[92:95], a[12:15], v[36:39]
  v_exp_f32 v9, v33
  v_mfma_f32_16x16x32_bf16 v[40:43], a[64:67], a[16:19], v[104:107]
  v_exp_f32 v10, v34
  v_mfma_f32_16x16x32_bf16 v[40:43], a[72:75], a[20:23], v[40:43]
  v_exp_f32 v11, v35
  v_mfma_f32_16x16x32_bf16 v[40:43], a[80:83], a[24:27], v[40:43]
  v_cvt_pk_bf16_f32 v80, v8, v9
  v_cvt_pk_bf16_f32 v81, v10, v11
  v_mfma_f32_16x16x32_bf16 v[40:43], a[88:91], a[28:31], v[40:43]
  ds_read_b128 a[120:123], v4 offset:6144
  v_or_b32 v5, v80, v81
  v_mfma_f32_16x16x32_bf16 v[44:47], a[68:71], a[16:19], v[108:111]
  v_exp_f32 v12, v36
  v_mfma_f32_16x16x32_bf16 v[44:47], a[76:79], a[20:23], v[44:47]
  v_exp_f32 v13, v37
  v_mfma_f32_16x16x32_bf16 v[44:47], a[84:87], a[24:27], v[44:47]
  v_exp_f32 v14, v38
  v_mfma_f32_16x16x32_bf16 v[44:47], a[92:95], a[28:31], v[44:47]
  ds_read_b128 a[124:127], v4 offset:7168
  v_mfma_f32_16x16x32_bf16 v[48:51], a[64:67], a[32:35], v[112:115]
  v_exp_f32 v15, v39
  v_mfma_f32_16x16x32_bf16 v[48:51], a[72:75], a[36:39], v[48:51]
  v_cvt_pk_bf16_f32 v82, v12, v13
  v_cvt_pk_bf16_f32 v83, v14, v15
  v_mfma_f32_16x16x32_bf16 v[48:51], a[80:83], a[40:43], v[48:51]
  s_add_u32 m0, s65, s66
  v_or3_b32 v5, v5, v82, v83
  v_mfma_f32_16x16x32_bf16 v[48:51], a[88:91], a[44:47], v[48:51]
  buffer_load_dwordx4 v3, s[40:43], s62 offen sc1 lds
  v_mfma_f32_16x16x32_bf16 v[52:55], a[68:71], a[32:35], v[116:119]
  v_exp_f32 v8, v40
  v_mfma_f32_16x16x32_bf16 v[52:55], a[76:79], a[36:39], v[52:55]
  s_min_u32 s67, s63, s64
  v_exp_f32 v9, v41
  v_mfma_f32_16x16x32_bf16 v[52:55], a[84:87], a[40:43], v[52:55]
  buffer_load_dwordx4 v3, s[40:43], s62 offen offset:1024 sc1 lds
  v_mfma_f32_16x16x32_bf16 v[52:55], a[92:95], a[44:47], v[52:55]
  v_exp_f32 v10, v42
  v_mfma_f32_16x16x32_bf16 v[56:59], a[64:67], a[48:51], v[120:123]
  s_add_u32 m0, m0, 0x2000
  v_exp_f32 v11, v43
  v_mfma_f32_16x16x32_bf16 v[56:59], a[72:75], a[52:55], v[56:59]
  buffer_load_dwordx4 v3, s[40:43], s67 offen sc1 lds
  v_cvt_pk_bf16_f32 v84, v8, v9
  v_mfma_f32_16x16x32_bf16 v[56:59], a[80:83], a[56:59], v[56:59]
  v_cvt_pk_bf16_f32 v85, v10, v11
  v_or3_b32 v5, v5, v84, v85
  v_mfma_f32_16x16x32_bf16 v[56:59], a[88:91], a[60:63], v[56:59]
  s_add_u32 s62, s62, 0x2000
  v_exp_f32 v12, v44
  v_mfma_f32_16x16x32_bf16 v[60:63], a[68:71], a[48:51], v[124:127]
  buffer_load_dwordx4 v3, s[40:43], s67 offen offset:1024 sc1 lds
  v_mfma_f32_16x16x32_bf16 v[60:63], a[76:79], a[52:55], v[60:63]
  v_exp_f32 v13, v45
  v_mfma_f32_16x16x32_bf16 v[60:63], a[84:87], a[56:59], v[60:63]
  v_exp_f32 v14, v46
  v_mfma_f32_16x16x32_bf16 v[60:63], a[92:95], a[60:63], v[60:63]
  s_waitcnt lgkmcnt(0)
  v_exp_f32 v15, v47
  v_mfma_f32_16x16x32_bf16 a[128:131], v[16:19], v[64:67], a[128:131]
  v_cvt_pk_bf16_f32 v86, v12, v13
  v_cvt_pk_bf16_f32 v87, v14, v15
  v_mfma_f32_16x16x32_bf16 a[132:135], v[16:19], v[68:71], a[132:135]
  ds_read_b128 a[64:67], v4 offset:8192
  v_or3_b32 v5, v5, v86, v87
  v_mfma_f32_16x16x32_bf16 a[136:139], v[16:19], v[72:75], a[136:139]
  v_exp_f32 v8, v48
  v_mfma_f32_16x16x32_bf16 a[140:143], v[16:19], v[76:79], a[140:143]
  v_exp_f32 v9, v49
  v_mfma_f32_16x16x32_bf16 v[128:131], a[96:99], v[64:67], v[128:131]
  ds_read_b128 a[68:71], v4 offset:9216
  v_mfma_f32_16x16x32_bf16 v[160:163], a[96:99], v[68:71], v[160:163]
  v_exp_f32 v10, v50
  v_mfma_f32_16x16x32_bf16 v[192:195], a[96:99], v[72:75], v[192:195]
  v_exp_f32 v11, v51
  v_mfma_f32_16x16x32_bf16 v[224:227], a[96:99], v[76:79], v[224:227]
  ds_read_b128 a[72:75], v4 offset:10240
  v_cvt_pk_bf16_f32 v88, v8, v9
  v_mfma_f32_16x16x32_bf16 v[132:135], a[100:103], v[64:67], v[132:135]
  s_add_u32 s63, s63, 0x2000
  v_cvt_pk_bf16_f32 v89, v10, v11
  v_or3_b32 v5, v5, v88, v89
  v_mfma_f32_16x16x32_bf16 v[164:167], a[100:103], v[68:71], v[164:167]
  s_add_u32 s65, s65, 0x4000
  v_exp_f32 v12, v52
  v_mfma_f32_16x16x32_bf16 v[196:199], a[100:103], v[72:75], v[196:199]
  s_and_b32 s65, s65, 0x1ffff
  ds_read_b128 a[76:79], v4 offset:11264
  v_mfma_f32_16x16x32_bf16 v[228:231], a[100:103], v[76:79], v[228:231]
  v_exp_f32 v13, v53
  v_mfma_f32_16x16x32_bf16 v[136:139], a[104:107], v[64:67], v[136:139]
  s_add_u32 s58, s58, 1
  v_exp_f32 v14, v54
  v_mfma_f32_16x16x32_bf16 v[168:171], a[104:107], v[68:71], v[168:171]
  ds_read_b128 a[80:83], v4 offset:12288
  v_mfma_f32_16x16x32_bf16 v[200:203], a[104:107], v[72:75], v[200:203]
  v_exp_f32 v15, v55
  v_mfma_f32_16x16x32_bf16 v[232:235], a[104:107], v[76:79], v[232:235]
  v_cvt_pk_bf16_f32 v90, v12, v13
  v_cvt_pk_bf16_f32 v91, v14, v15
  v_mfma_f32_16x16x32_bf16 v[140:143], a[108:111], v[64:67], v[140:143]
  ds_read_b128 a[84:87], v4 offset:13312
  v_or3_b32 v5, v5, v90, v91
  v_mfma_f32_16x16x32_bf16 v[172:175], a[108:111], v[68:71], v[172:175]
  v_exp_f32 v8, v56
  v_mfma_f32_16x16x32_bf16 v[204:207], a[108:111], v[72:75], v[204:207]
  v_exp_f32 v9, v57
  v_mfma_f32_16x16x32_bf16 v[236:239], a[108:111], v[76:79], v[236:239]
  ds_read_b128 a[88:91], v4 offset:14336
  v_mfma_f32_16x16x32_bf16 v[144:147], a[112:115], v[64:67], v[144:147]
  v_exp_f32 v10, v58
  v_mfma_f32_16x16x32_bf16 v[176:179], a[112:115], v[68:71], v[176:179]
  v_exp_f32 v11, v59
  v_mfma_f32_16x16x32_bf16 v[208:211], a[112:115], v[72:75], v[208:211]
  ds_read_b128 a[92:95], v4 offset:15360
  v_cvt_pk_bf16_f32 v92, v8, v9
  v_mfma_f32_16x16x32_bf16 v[240:243], a[112:115], v[76:79], v[240:243]
  v_cvt_pk_bf16_f32 v93, v10, v11
  v_or3_b32 v5, v5, v92, v93
  v_mfma_f32_16x16x32_bf16 v[148:151], a[116:119], v[64:67], v[148:151]
  v_exp_f32 v12, v60
  v_mfma_f32_16x16x32_bf16 v[180:183], a[116:119], v[68:71], v[180:183]
  v_exp_f32 v13, v61
  v_mfma_f32_16x16x32_bf16 v[212:215], a[116:119], v[72:75], v[212:215]
  v_exp_f32 v14, v62
  v_mfma_f32_16x16x32_bf16 v[244:247], a[116:119], v[76:79], v[244:247]
  v_exp_f32 v15, v63
  v_mfma_f32_16x16x32_bf16 v[152:155], a[120:123], v[64:67], v[152:155]
  v_cvt_pk_bf16_f32 v94, v12, v13
  v_cvt_pk_bf16_f32 v95, v14, v15
  v_mfma_f32_16x16x32_bf16 v[184:187], a[120:123], v[68:71], v[184:187]
  v_or3_b32 v5, v5, v94, v95
  v_and_b32 v5, s73, v5
  v_mfma_f32_16x16x32_bf16 v[216:219], a[120:123], v[72:75], v[216:219]
  v_cmp_ne_u32 vcc, 0, v5
  v_add_u32 v4, 0x4000, v4
  v_mfma_f32_16x16x32_bf16 v[248:251], a[120:123], v[76:79], v[248:251]
  v_and_b32 v4, 0x1ffff, v4
  v_mfma_f32_16x16x32_bf16 v[156:159], a[124:127], v[64:67], v[156:159]
  v_mfma_f32_16x16x32_bf16 v[188:191], a[124:127], v[68:71], v[188:191]
  s_mov_b32 s74, 2
  v_mfma_f32_16x16x32_bf16 v[220:223], a[124:127], v[72:75], v[220:223]
  s_sub_u32 s68, s58, s69
  v_mfma_f32_16x16x32_bf16 v[252:255], a[124:127], v[76:79], v[252:255]
  s_cbranch_vccnz L_a_slow1
L_a_s0_r:
  s_cmp_lt_u32 s68, 2
  s_cbranch_scc1 L_a_mask
L_a_s0_m:
  s_cmp_eq_u32 s58, s59
  s_cbranch_scc1 L_a_final
L_a_s1:
  s_waitcnt vmcnt(24) lgkmcnt(0)
  v_mfma_f32_16x16x32_bf16 v[32:35], a[64:67], a[0:3], v[96:99]
  s_barrier
  ds_read_b128 a[96:99], v4 offset:0
  v_mfma_f32_16x16x32_bf16 v[32:35], a[72:75], a[4:7], v[32:35]
  ds_read_b128 a[100:103], v4 offset:1024
  v_mfma_f32_16x16x32_bf16 v[32:35], a[80:83], a[8:11], v[32:35]
  ds_read_b128 a[104:107], v4 offset:2048
  v_mfma_f32_16x16x32_bf16 v[32:35], a[88:91], a[12:15], v[32:35]
  s_nop 0
  ds_read_b128 a[108:111], v4 offset:3072
  v_mfma_f32_16x16x32_bf16 v[36:39], a[68:71], a[0:3], v[100:103]
  s_nop 0
  ds_read_b128 a[112:115], v4 offset:4096
  v_mfma_f32_16x16x32_bf16 v[36:39], a[76:79], a[4:7], v[36:39]
  s_nop 0
  ds_read_b128 a[116:119], v4 offset:5120
  v_mfma_f32_16x16x32_bf16 v[36:39], a[84:87], a[8:11], v[36:39]
  v_exp_f32 v8, v32
  v_mfma_f32_16x16x32_bf16 v[36:39], a[92:95], a[12:15], v[36:39]
  v_exp_f32 v9, v33
  v_mfma_f32_16x16x32_bf16 v[40:43], a[64:67], a[16:19], v[104:107]
  v_exp_f32 v10, v34
  v_mfma_f32_16x16x32_bf16 v[40:43], a[72:75], a[20:23], v[40:43]
  v_exp_f32 v11, v35
  v_mfma_f32_16x16x32_bf16 v[40:43], a[80:83], a[24:27], v[40:43]
  v_cvt_pk_bf16_f32 v64, v8, v9
  v_cvt_pk_bf16_f32 v65, v10, v11
  v_mfma_f32_16x16x32_bf16 v[40:43], a[88:91], a[28:31], v[40:43]
  ds_read_b128 a[120:123], v4 offset:6144
  v_or_b32 v5, v64, v65
  v_mfma_f32_16x16x32_bf16 v[44:47], a[68:71], a[16:19], v[108:111]
  v_exp_f32 v12, v36
  v_mfma_f32_16x16x32_bf16 v[44:47], a[76:79], a[20:23], v[44:47]
  v_exp_f32 v13, v37
  v_mfma_f32_16x16x32_bf16 v[44:47], a[84:87], a[24:27], v[44:47]
  v_exp_f32 v14, v38
  v_mfma_f32_16x16x32_bf16 v[44:47], a[92:95], a[28:31], v[44:47]
  ds_read_b128 a[124:127], v4 offset:7168
  v_mfma_f32_16x16x32_bf16 v[48:51], a[64:67], a[32:35], v[112:115]
  v_exp_f32 v15, v39
  v_mfma_f32_16x16x32_bf16 v[48:51], a[72:75], a[36:39], v[48:51]
  v_cvt_pk_bf16_f32 v66, v12, v13
  v_cvt_pk_bf16_f32 v67, v14, v15
  v_mfma_f32_16x16x32_bf16 v[48:51], a[80:83], a[40:43], v[48:51]
  s_add_u32 m0, s65, s66
  v_or3_b32 v5, v5, v66, v67
  v_mfma_f32_16x16x32_bf16 v[48:51], a[88:91], a[44:47], v[48:51]
  buffer_load_dwordx4 v3, s[40:43], s62 offen sc1 lds
  v_mfma_f32_16x16x32_bf16 v[52:55], a[68:71], a[32:35], v[116:119]
  v_exp_f32 v8, v40
  v_mfma_f32_16x16x32_bf16 v[52:55], a[76:79], a[36:39], v[52:55]
  s_min_u32 s67, s63, s64
  v_exp_f32 v9, v41
  v_mfma_f32_16x16x32_bf16 v[52:55], a[84:87], a[40:43], v[52:55]
  buffer_load_dwordx4 v3, s[40:43], s62 offen offset:1024 sc1 lds
  v_mfma_f32_16x16x32_bf16 v[52:55], a[92:95], a[44:47], v[52:55]
  v_exp_f32 v10, v42
  v_mfma_f32_16x16x32_bf16 v[56:59], a[64:67], a[48:51], v[120:123]
  s_add_u32 m0, m0, 0x2000
  v_exp_f32 v11, v43
  v_mfma_f32_16x16x32_bf16 v[56:59], a[72:75], a[52:55], v[56:59]
  buffer_load_dwordx4 v3, s[40:43], s67 offen sc1 lds
  v_cvt_pk_bf16_f32 v68, v8, v9
  v_mfma_f32_16x16x32_bf16 v[56:59], a[80:83], a[56:59], v[56:59]
  v_cvt_pk_bf16_f32 v69, v10, v11
  v_or3_b32 v5, v5, v68, v69
  v_mfma_f32_16x16x32_bf16 v[56:59], a[88:91], a[60:63], v[56:59]
  s_add_u32 s62, s62, 0x2000
  v_exp_f32 v12, v44
  v_mfma_f32_16x16x32_bf16 v[60:63], a[68:71], a[48:51], v[124:127]
  buffer_load_dwordx4 v3, s[40:43], s67 offen offset:1024 sc1 lds
  v_mfma_f32_16x16x32_bf16 v[60:63], a[76:79], a[52:55], v[60:63]
  v_exp_f32 v13, v45
  v_mfma_f32_16x16x32_bf16 v[60:63], a[84:87], a[56:59], v[60:63]
  v_exp_f32 v14, v46
  v_mfma_f32_16x16x32_bf16 v[60:63], a[92:95], a[60:63], v[60:63]
  s_waitcnt lgkmcnt(0)
  v_exp_f32 v15, v47
  v_mfma_f32_16x16x32_bf16 a[128:131], v[16:19], v[80:83], a[128:131]
  v_cvt_pk_bf16_f32 v70, v12, v13
  v_cvt_pk_bf16_f32 v71, v14, v15
  v_mfma_f32_16x16x32_bf16 a[132:135], v[16:19], v[84:87], a[132:135]
  ds_read_b128 a[64:67], v4 offset:8192
  v_or3_b32 v5, v5, v70, v71
  v_mfma_f32_16x16x32_bf16 a[136:139], v[16:19], v[88:91], a[136:139]
  v_exp_f32 v8, v48
  v_mfma_f32_16x16x32_bf16 a[140:143], v[16:19], v[92:95], a[140:143]
  v_exp_f32 v9, v49
  v_mfma_f32_16x16x32_bf16 v[128:131], a[96:99], v[80:83], v[128:131]
  ds_read_b128 a[68:71], v4 offset:9216
  v_mfma_f32_16x16x32_bf16 v[160:163], a[96:99], v[84:87], v[160:163]
  v_exp_f32 v10, v50
  v_mfma_f32_16x16x32_bf16 v[192:195], a[96:99], v[88:91], v[192:195]
  v_exp_f32 v11, v51
  v_mfma_f32_16x16x32_bf16 v[224:227], a[96:99], v[92:95], v[224:227]
  ds_read_b128 a[72:75], v4 offset:10240
  v_cvt_pk_bf16_f32 v72, v8, v9
  v_mfma_f32_16x16x32_bf16 v[132:135], a[100:103], v[80:83], v[132:135]
  s_add_u32 s63, s63, 0x2000
  v_cvt_pk_bf16_f32 v73, v10, v11
  v_or3_b32 v5, v5, v72, v73
  v_mfma_f32_16x16x32_bf16 v[164:167], a[100:103], v[84:87], v[164:167]
  s_add_u32 s65, s65, 0x4000
  v_exp_f32 v12, v52
  v_mfma_f32_16x16x32_bf16 v[196:199], a[100:103], v[88:91], v[196:199]
  s_and_b32 s65, s65, 0x1ffff
  ds_read_b128 a[76:79], v4 offset:11264
  v_mfma_f32_16x16x32_bf16 v[228:231], a[100:103], v[92:95], v[228:231]
  v_exp_f32 v13, v53
  v_mfma_f32_16x16x32_bf16 v[136:139], a[104:107], v[80:83], v[136:139]
  s_add_u32 s58, s58, 1
  v_exp_f32 v14, v54
  v_mfma_f32_16x16x32_bf16 v[168:171], a[104:107], v[84:87], v[168:171]
  ds_read_b128 a[80:83], v4 offset:12288
  v_mfma_f32_16x16x32_bf16 v[200:203], a[104:107], v[88:91], v[200:203]
  v_exp_f32 v15, v55
  v_mfma_f32_16x16x32_bf16 v[232:235], a[104:107], v[92:95], v[232:235]
  v_cvt_pk_bf16_f32 v74, v12, v13
  v_cvt_pk_bf16_f32 v75, v14, v15
  v_mfma_f32_16x16x32_bf16 v[140:143], a[108:111], v[80:83], v[140:143]
  ds_read_b128 a[84:87], v4 offset:13312
  v_or3_b32 v5, v5, v74, v75
  v_mfma_f32_16x16x32_bf16 v[172:175], a[108:111], v[84:87], v[172:175]
  v_exp_f32 v8, v56
  v_mfma_f32_16x16x32_bf16 v[204:207], a[108:111], v[88:91], v[204:207]
  v_exp_f32 v9, v57
  v_mfma_f32_16x16x32_bf16 v[236:239], a[108:111], v[92:95], v[236:239]
  ds_read_b128 a[88:91], v4 offset:14336
  v_mfma_f32_16x16x32_bf16 v[144:147], a[112:115], v[80:83], v[144:147]
  v_exp_f32 v10, v58
  v_mfma_f32_16x16x32_bf16 v[176:179], a[112:115], v[84:87], v[176:179]
  v_exp_f32 v11, v59
  v_mfma_f32_16x16x32_bf16 v[208:211], a[112:115], v[88:91], v[208:211]
  ds_read_b128 a[92:95], v4 offset:15360
  v_cvt_pk_bf16_f32 v76, v8, v9
  v_mfma_f32_16x16x32_bf16 v[240:243], a[112:115], v[92:95], v[240:243]
  v_cvt_pk_bf16_f32 v77, v10, v11
  v_or3_b32 v5, v5, v76, v77
  v_mfma_f32_16x16x32_bf16 v[148:151], a[116:119], v[80:83], v[148:151]
  v_exp_f32 v12, v60
  v_mfma_f32_16x16x32_bf16 v[180:183], a[116:119], v[84:87], v[180:183]
  v_exp_f32 v13, v61
  v_mfma_f32_16x16x32_bf16 v[212:215], a[116:119], v[88:91], v[212:215]
  v_exp_f32 v14, v62
  v_mfma_f32_16x16x32_bf16 v[244:247], a[116:119], v[92:95], v[244:247]
  v_exp_f32 v15, v63
  v_mfma_f32_16x16x32_bf16 v[152:155], a[120:123], v[80:83], v[152:155]
  v_cvt_pk_bf16_f32 v78, v12, v13
  v_cvt_pk_bf16_f32 v79, v14, v15
  v_mfma_f32_16x16x32_bf16 v[184:187], a[120:123], v[84:87], v[184:187]
  v_or3_b32 v5, v5, v78, v79
  v_and_b32 v5, s73, v5
  v_mfma_f32_16x16x32_bf16 v[216:219], a[120:123], v[88:91], v[216:219]
  v_cmp_ne_u32 vcc, 0, v5
  v_add_u32 v4, 0x4000, v4
  v_mfma_f32_16x16x32_bf16 v[248:251], a[120:123], v[92:95], v[248:251]
  v_and_b32 v4, 0x1ffff, v4
  v_mfma_f32_16x16x32_bf16 v[156:159], a[124:127], v[80:83], v[156:159]
  v_mfma_f32_16x16x32_bf16 v[188:191], a[124:127], v[84:87], v[188:191]
  s_mov_b32 s74, 3
  v_mfma_f32_16x16x32_bf16 v[220:223], a[124:127], v[88:91], v[220:223]
  s_sub_u32 s68, s58, s69
  v_mfma_f32_16x16x32_bf16 v[252:255], a[124:127], v[92:95], v[252:255]
  s_cbranch_vccnz L_a_slow0
L_a_s1_r:
  s_cmp_lt_u32 s68, 2
  s_cbranch_scc1 L_a_mask
L_a_s1_m:
  s_branch L_a_s0
L_a_final:
  s_waitcnt vmcnt(0)
  s_barrier
  s_cmp_eq_u32 s58, s60
  s_cbranch_scc1 L_a_last
L_a_f1:
  s_waitcnt lgkmcnt(0)
  v_mfma_f32_16x16x32_bf16 v[32:35], a[64:67], a[0:3], v[96:99]
  ds_read_b128 a[96:99], v4 offset:0
  v_mfma_f32_16x16x32_bf16 v[32:35], a[72:75], a[4:7], v[32:35]
  ds_read_b128 a[100:103], v4 offset:1024
  v_mfma_f32_16x16x32_bf16 v[32:35], a[80:83], a[8:11], v[32:35]
  ds_read_b128 a[104:107], v4 offset:2048
  v_mfma_f32_16x16x32_bf16 v[32:35], a[88:91], a[12:15], v[32:35]
  s_nop 0
  ds_read_b128 a[108:111], v4 offset:3072
  v_mfma_f32_16x16x32_bf16 v[36:39], a[68:71], a[0:3], v[100:103]
  s_nop 0
  ds_read_b128 a[112:115], v4 offset:4096
  v_mfma_f32_16x16x32_bf16 v[36:39], a[76:79], a[4:7], v[36:39]
  s_nop 0
  ds_read_b128 a[116:119], v4 offset:5120
  v_mfma_f32_16x16x32_bf16 v[36:39], a[84:87], a[8:11], v[36:39]
  v_exp_f32 v8, v32
  v_mfma_f32_16x16x32_bf16 v[36:39], a[92:95], a[12:15], v[36:39]
  v_exp_f32 v9, v33
  v_mfma_f32_16x16x32_bf16 v[40:43], a[64:67], a[16:19], v[104:107]
  v_exp_f32 v10, v34
  v_mfma_f32_16x16x32_bf16 v[40:43], a[72:75], a[20:23], v[40:43]
  v_exp_f32 v11, v35
  v_mfma_f32_16x16x32_bf16 v[40:43], a[80:83], a[24:27], v[40:43]
  v_cvt_pk_bf16_f32 v64, v8, v9
  v_cvt_pk_bf16_f32 v65, v10, v11
  v_mfma_f32_16x16x32_bf16 v[40:43], a[88:91], a[28:31], v[40:43]
  ds_read_b128 a[120:123], v4 offset:6144
  v_or_b32 v5, v64, v65
  v_mfma_f32_16x16x32_bf16 v[44:47], a[68:71], a[16:19], v[108:111]
  v_exp_f32 v12, v36
  v_mfma_f32_16x16x32_bf16 v[44:47], a[76:79], a[20:23], v[44:47]
  v_exp_f32 v13, v37
  v_mfma_f32_16x16x32_bf16 v[44:47], a[84:87], a[24:27], v[44:47]
  v_exp_f32 v14, v38
  v_mfma_f32_16x16x32_bf16 v[44:47], a[92:95], a[28:31], v[44:47]
  ds_read_b128 a[124:127], v4 offset:7168
  v_mfma_f32_16x16x32_bf16 v[48:51], a[64:67], a[32:35], v[112:115]
  v_exp_f32 v15, v39
  v_mfma_f32_16x16x32_bf16 v[48:51], a[72:75], a[36:39], v[48:51]
  v_cvt_pk_bf16_f32 v66, v12, v13
  v_cvt_pk_bf16_f32 v67, v14, v15
  v_mfma_f32_16x16x32_bf16 v[48:51], a[80:83], a[40:43], v[48:51]
  v_or3_b32 v5, v5, v66, v67
  v_mfma_f32_16x16x32_bf16 v[48:51], a[88:91], a[44:47], v[48:51]
  v_exp_f32 v8, v40
  v_mfma_f32_16x16x32_bf16 v[52:55], a[68:71], a[32:35], v[116:119]
  v_exp_f32 v9, v41
  v_mfma_f32_16x16x32_bf16 v[52:55], a[76:79], a[36:39], v[52:55]
  v_exp_f32 v10, v42
  v_mfma_f32_16x16x32_bf16 v[52:55], a[84:87], a[40:43], v[52:55]
  v_exp_f32 v11, v43
  v_mfma_f32_16x16x32_bf16 v[52:55], a[92:95], a[44:47], v[52:55]
  v_cvt_pk_bf16_f32 v68, v8, v9
  v_cvt_pk_bf16_f32 v69, v10, v11
  v_mfma_f32_16x16x32_bf16 v[56:59], a[64:67], a[48:51], v[120:123]
  v_or3_b32 v5, v5, v68, v69
  v_mfma_f32_16x16x32_bf16 v[56:59], a[72:75], a[52:55], v[56:59]
  v_exp_f32 v12, v44
  v_mfma_f32_16x16x32_bf16 v[56:59], a[80:83], a[56:59], v[56:59]
  v_exp_f32 v13, v45
  v_mfma_f32_16x16x32_bf16 v[56:59], a[88:91], a[60:63], v[56:59]
  v_exp_f32 v14, v46
  v_mfma_f32_16x16x32_bf16 v[60:63], a[68:71], a[48:51], v[124:127]
  v_exp_f32 v15, v47
  v_mfma_f32_16x16x32_bf16 v[60:63], a[76:79], a[52:55], v[60:63]
  v_cvt_pk_bf16_f32 v70, v12, v13
  v_cvt_pk_bf16_f32 v71, v14, v15
  v_mfma_f32_16x16x32_bf16 v[60:63], a[84:87], a[56:59], v[60:63]
  v_or3_b32 v5, v5, v70, v71
  v_mfma_f32_16x16x32_bf16 v[60:63], a[92:95], a[60:63], v[60:63]
  s_waitcnt lgkmcnt(0)
  v_exp_f32 v8, v48
  v_mfma_f32_16x16x32_bf16 a[128:131], v[16:19], v[80:83], a[128:131]
  v_exp_f32 v9, v49
  v_mfma_f32_16x16x32_bf16 a[132:135], v[16:19], v[84:87], a[132:135]
  ds_read_b128 a[64:67], v4 offset:8192
  v_mfma_f32_16x16x32_bf16 a[136:139], v[16:19], v[88:91], a[136:139]
  v_exp_f32 v10, v50
  v_mfma_f32_16x16x32_bf16 a[140:143], v[16:19], v[92:95], a[140:143]
  v_exp_f32 v11, v51
  v_mfma_f32_16x16x32_bf16 v[128:131], a[96:99], v[80:83], v[128:131]
  ds_read_b128 a[68:71], v4 offset:9216
  v_cvt_pk_bf16_f32 v72, v8, v9
  v_mfma_f32_16x16x32_bf16 v[160:163], a[96:99], v[84:87], v[160:163]
  v_cvt_pk_bf16_f32 v73, v10, v11
  v_or3_b32 v5, v5, v72, v73
  v_mfma_f32_16x16x32_bf16 v[192:195], a[96:99], v[88:91], v[192:195]
  v_exp_f32 v12, v52
  v_mfma_f32_16x16x32_bf16 v[224:227], a[96:99], v[92:95], v[224:227]
  ds_read_b128 a[72:75], v4 offset:10240
  v_mfma_f32_16x16x32_bf16 v[132:135], a[100:103], v[80:83], v[132:135]
  v_exp_f32 v13, v53
  v_mfma_f32_16x16x32_bf16 v[164:167], a[100:103], v[84:87], v[164:167]
  v_exp_f32 v14, v54
  v_mfma_f32_16x16x32_bf16 v[196:199], a[100:103], v[88:91], v[196:199]
  ds_read_b128 a[76:79], v4 offset:11264
  v_mfma_f32_16x16x32_bf16 v[228:231], a[100:103], v[92:95], v[228:231]
  v_exp_f32 v15, v55
  v_mfma_f32_16x16x32_bf16 v[136:139], a[104:107], v[80:83], v[136:139]
  s_add_u32 s58, s58, 1
  v_cvt_pk_bf16_f32 v74, v12, v13
  v_cvt_pk_bf16_f32 v75, v14, v15
  v_mfma_f32_16x16x32_bf16 v[168:171], a[104:107], v[84:87], v[168:171]
  ds_read_b128 a[80:83], v4 offset:12288
  v_or3_b32 v5, v5, v74, v75
  v_mfma_f32_16x16x32_bf16 v[200:203], a[104:107], v[88:91], v[200:203]
  v_exp_f32 v8, v56
  v_mfma_f32_16x16x32_bf16 v[232:235], a[104:107], v[92:95], v[232:235]
  v_exp_f32 v9, v57
  v_mfma_f32_16x16x32_bf16 v[140:143], a[108:111], v[80:83], v[140:143]
  ds_read_b128 a[84:87], v4 offset:13312
  v_mfma_f32_16x16x32_bf16 v[172:175], a[108:111], v[84:87], v[172:175]
  v_exp_f32 v10, v58
  v_mfma_f32_16x16x32_bf16 v[204:207], a[108:111], v[88:91], v[204:207]
  v_exp_f32 v11, v59
  v_mfma_f32_16x16x32_bf16 v[236:239], a[108:111], v[92:95], v[236:239]
  ds_read_b128 a[88:91], v4 offset:14336
  v_cvt_pk_bf16_f32 v76, v8, v9
  v_mfma_f32_16x16x32_bf16 v[144:147], a[112:115], v[80:83], v[144:147]
  v_cvt_pk_bf16_f32 v77, v10, v11
  v_or3_b32 v5, v5, v76, v77
  v_mfma_f32_16x16x32_bf16 v[176:179], a[112:115], v[84:87], v[176:179]
  v_exp_f32 v12, v60
  v_mfma_f32_16x16x32_bf16 v[208:211], a[112:115], v[88:91], v[208:211]
  ds_read_b128 a[92:95], v4 offset:15360
  v_mfma_f32_16x16x32_bf16 v[240:243], a[112:115], v[92:95], v[240:243]
  v_exp_f32 v13, v61
  v_mfma_f32_16x16x32_bf16 v[148:151], a[116:119], v[80:83], v[148:151]
  v_exp_f32 v14, v62
  v_mfma_f32_16x16x32_bf16 v[180:183], a[116:119], v[84:87], v[180:183]
  v_exp_f32 v15, v63
  v_mfma_f32_16x16x32_bf16 v[212:215], a[116:119], v[88:91], v[212:215]
  v_cvt_pk_bf16_f32 v78, v12, v13
  v_cvt_pk_bf16_f32 v79, v14, v15
  v_mfma_f32_16x16x32_bf16 v[244:247], a[116:119], v[92:95], v[244:247]
  v_or3_b32 v5, v5, v78, v79
  v_and_b32 v5, s73, v5
  v_mfma_f32_16x16x32_bf16 v[152:155], a[120:123], v[80:83], v[152:155]
  v_cmp_ne_u32 vcc, 0, v5
  v_add_u32 v4, 0x4000, v4
  v_mfma_f32_16x16x32_bf16 v[184:187], a[120:123], v[84:87], v[184:187]
  v_and_b32 v4, 0x1ffff, v4
  v_mfma_f32_16x16x32_bf16 v[216:219], a[120:123], v[88:91], v[216:219]
  v_mfma_f32_16x16x32_bf16 v[248:251], a[120:123], v[92:95], v[248:251]
  v_mfma_f32_16x16x32_bf16 v[156:159], a[124:127], v[80:83], v[156:159]
  v_mfma_f32_16x16x32_bf16 v[188:191], a[124:127], v[84:87], v[188:191]
  s_mov_b32 s74, 1
  v_mfma_f32_16x16x32_bf16 v[220:223], a[124:127], v[88:91], v[220:223]
  s_sub_u32 s68, s58, s69
  v_mfma_f32_16x16x32_bf16 v[252:255], a[124:127], v[92:95], v[252:255]
  s_cbranch_vccnz L_a_slow0
L_a_f1_r:
  s_cmp_lt_u32 s68, 2
  s_cbranch_scc1 L_a_mask
L_a_f1_m:
L_a_f0:
  s_waitcnt lgkmcnt(0)
  v_mfma_f32_16x16x32_bf16 v[32:35], a[64:67], a[0:3], v[96:99]
  ds_read_b128 a[96:99], v4 offset:0
  v_mfma_f32_16x16x32_bf16 v[32:35], a[72:75], a[4:7], v[32:35]
  ds_read_b128 a[100:103], v4 offset:1024
  v_mfma_f32_16x16x32_bf16 v[32:35], a[80:83], a[8:11], v[32:35]
  ds_read_b128 a[104:107], v4 offset:2048
  v_mfma_f32_16x16x32_bf16 v[32:35], a[88:91], a[12:15], v[32:35]
  s_nop 0
  ds_read_b128 a[108:111], v4 offset:3072
  v_mfma_f32_16x16x32_bf16 v[36:39], a[68:71], a[0:3], v[100:103]
  s_nop 0
  ds_read_b128 a[112:115], v4 offset:4096
  v_mfma_f32_16x16x32_bf16 v[36:39], a[76:79], a[4:7], v[36:39]
  s_nop 0
  ds_read_b128 a[116:119], v4 offset:5120
  v_mfma_f32_16x16x32_bf16 v[36:39], a[84:87], a[8:11], v[36:39]
  v_exp_f32 v8, v32
  v_mfma_f32_16x16x32_bf16 v[36:39], a[92:95], a[12:15], v[36:39]
  v_exp_f32 v9, v33
  v_mfma_f32_16x16x32_bf16 v[40:43], a[64:67], a[16:19], v[104:107]
  v_exp_f32 v10, v34
  v_mfma_f32_16x16x32_bf16 v[40:43], a[72:75], a[20:23], v[40:43]
  v_exp_f32 v11, v35
  v_mfma_f32_16x16x32_bf16 v[40:43], a[80:83], a[24:27], v[40:43]
  v_cvt_pk_bf16_f32 v80, v8, v9
  v_cvt_pk_bf16_f32 v81, v10, v11
  v_mfma_f32_16x16x32_bf16 v[40:43], a[88:91], a[28:31], v[40:43]
  ds_read_b128 a[120:123], v4 offset:6144
  v_or_b32 v5, v80, v81
  v_mfma_f32_16x16x32_bf16 v[44:47], a[68:71], a[16:19], v[108:111]
  v_exp_f32 v12, v36
  v_mfma_f32_16x16x32_bf16 v[44:47], a[76:79], a[20:23], v[44:47]
  v_exp_f32 v13, v37
  v_mfma_f32_16x16x32_bf16 v[44:47], a[84:87], a[24:27], v[44:47]
  v_exp_f32 v14, v38
  v_mfma_f32_16x16x32_bf16 v[44:47], a[92:95], a[28:31], v[44:47]
  ds_read_b128 a[124:127], v4 offset:7168
  v_mfma_f32_16x16x32_bf16 v[48:51], a[64:67], a[32:35], v[112:115]
  v_exp_f32 v15, v39
  v_mfma_f32_16x16x32_bf16 v[48:51], a[72:75], a[36:39], v[48:51]
  v_cvt_pk_bf16_f32 v82, v12, v13
  v_cvt_pk_bf16_f32 v83, v14, v15
  v_mfma_f32_16x16x32_bf16 v[48:51], a[80:83], a[40:43], v[48:51]
  v_or3_b32 v5, v5, v82, v83
  v_mfma_f32_16x16x32_bf16 v[48:51], a[88:91], a[44:47], v[48:51]
  v_exp_f32 v8, v40
  v_mfma_f32_16x16x32_bf16 v[52:55], a[68:71], a[32:35], v[116:119]
  v_exp_f32 v9, v41
  v_mfma_f32_16x16x32_bf16 v[52:55], a[76:79], a[36:39], v[52:55]
  v_exp_f32 v10, v42
  v_mfma_f32_16x16x32_bf16 v[52:55], a[84:87], a[40:43], v[52:55]
  v_exp_f32 v11, v43
  v_mfma_f32_16x16x32_bf16 v[52:55], a[92:95], a[44:47], v[52:55]
  v_cvt_pk_bf16_f32 v84, v8, v9
  v_cvt_pk_bf16_f32 v85, v10, v11
  v_mfma_f32_16x16x32_bf16 v[56:59], a[64:67], a[48:51], v[120:123]
  v_or3_b32 v5, v5, v84, v85
  v_mfma_f32_16x16x32_bf16 v[56:59], a[72:75], a[52:55], v[56:59]
  v_exp_f32 v12, v44
  v_mfma_f32_16x16x32_bf16 v[56:59], a[80:83], a[56:59], v[56:59]
  v_exp_f32 v13, v45
  v_mfma_f32_16x16x32_bf16 v[56:59], a[88:91], a[60:63], v[56:59]
  v_exp_f32 v14, v46
  v_mfma_f32_16x16x32_bf16 v[60:63], a[68:71], a[48:51], v[124:127]
  v_exp_f32 v15, v47
  v_mfma_f32_16x16x32_bf16 v[60:63], a[76:79], a[52:55], v[60:63]
  v_cvt_pk_bf16_f32 v86, v12, v13
  v_cvt_pk_bf16_f32 v87, v14, v15
  v_mfma_f32_16x16x32_bf16 v[60:63], a[84:87], a[56:59], v[60:63]
  v_or3_b32 v5, v5, v86, v87
  v_mfma_f32_16x16x32_bf16 v[60:63], a[92:95], a[60:63], v[60:63]
  s_waitcnt lgkmcnt(0)
  v_exp_f32 v8, v48
  v_mfma_f32_16x16x32_bf16 a[128:131], v[16:19], v[64:67], a[128:131]
  v_exp_f32 v9, v49
  v_mfma_f32_16x16x32_bf16 a[132:135], v[16:19], v[68:71], a[132:135]
  ds_read_b128 a[64:67], v4 offset:8192
  v_mfma_f32_16x16x32_bf16 a[136:139], v[16:19], v[72:75], a[136:139]
  v_exp_f32 v10, v50
  v_mfma_f32_16x16x32_bf16 a[140:143], v[16:19], v[76:79], a[140:143]
  v_exp_f32 v11, v51
  v_mfma_f32_16x16x32_bf16 v[128:131], a[96:99], v[64:67], v[128:131]
  ds_read_b128 a[68:71], v4 offset:9216
  v_cvt_pk_bf16_f32 v88, v8, v9
  v_mfma_f32_16x16x32_bf16 v[160:163], a[96:99], v[68:71], v[160:163]
  v_cvt_pk_bf16_f32 v89, v10, v11
  v_or3_b32 v5, v5, v88, v89
  v_mfma_f32_16x16x32_bf16 v[192:195], a[96:99], v[72:75], v[192:195]
  v_exp_f32 v12, v52
  v_mfma_f32_16x16x32_bf16 v[224:227], a[96:99], v[76:79], v[224:227]
  ds_read_b128 a[72:75], v4 offset:10240
  v_mfma_f32_16x16x32_bf16 v[132:135], a[100:103], v[64:67], v[132:135]
  v_exp_f32 v13, v53
  v_mfma_f32_16x16x32_bf16 v[164:167], a[100:103], v[68:71], v[164:167]
  v_exp_f32 v14, v54
  v_mfma_f32_16x16x32_bf16 v[196:199], a[100:103], v[72:75], v[196:199]
  ds_read_b128 a[76:79], v4 offset:11264
  v_mfma_f32_16x16x32_bf16 v[228:231], a[100:103], v[76:79], v[228:231]
  v_exp_f32 v15, v55
  v_mfma_f32_16x16x32_bf16 v[136:139], a[104:107], v[64:67], v[136:139]
  s_add_u32 s58, s58, 1
  v_cvt_pk_bf16_f32 v90, v12, v13
  v_cvt_pk_bf16_f32 v91, v14, v15
  v_mfma_f32_16x16x32_bf16 v[168:171], a[104:107], v[68:71], v[168:171]
  ds_read_b128 a[80:83], v4 offset:12288
  v_or3_b32 v5, v5, v90, v91
  v_mfma_f32_16x16x32_bf16 v[200:203], a[104:107], v[72:75], v[200:203]
  v_exp_f32 v8, v56
  v_mfma_f32_16x16x32_bf16 v[232:235], a[104:107], v[76:79], v[232:235]
  v_exp_f32 v9, v57
  v_mfma_f32_16x16x32_bf16 v[140:143], a[108:111], v[64:67], v[140:143]
  ds_read_b128 a[84:87], v4 offset:13312
  v_mfma_f32_16x16x32_bf16 v[172:175], a[108:111], v[68:71], v[172:175]
  v_exp_f32 v10, v58
  v_mfma_f32_16x16x32_bf16 v[204:207], a[108:111], v[72:75], v[204:207]
  v_exp_f32 v11, v59
  v_mfma_f32_16x16x32_bf16 v[236:239], a[108:111], v[76:79], v[236:239]
  ds_read_b128 a[88:91], v4 offset:14336
  v_cvt_pk_bf16_f32 v92, v8, v9
  v_mfma_f32_16x16x32_bf16 v[144:147], a[112:115], v[64:67], v[144:147]
  v_cvt_pk_bf16_f32 v93, v10, v11
  v_or3_b32 v5, v5, v92, v93
  v_mfma_f32_16x16x32_bf16 v[176:179], a[112:115], v[68:71], v[176:179]
  v_exp_f32 v12, v60
  v_mfma_f32_16x16x32_bf16 v[208:211], a[112:115], v[72:75], v[208:211]
  ds_read_b128 a[92:95], v4 offset:15360
  v_mfma_f32_16x16x32_bf16 v[240:243], a[112:115], v[76:79], v[240:243]
  v_exp_f32 v13, v61
  v_mfma_f32_16x16x32_bf16 v[148:151], a[116:119], v[64:67], v[148:151]
  v_exp_f32 v14, v62
  v_mfma_f32_16x16x32_bf16 v[180:183], a[116:119], v[68:71], v[180:183]
  v_exp_f32 v15, v63
  v_mfma_f32_16x16x32_bf16 v[212:215], a[116:119], v[72:75], v[212:215]
  v_cvt_pk_bf16_f32 v94, v12, v13
  v_cvt_pk_bf16_f32 v95, v14, v15
  v_mfma_f32_16x16x32_bf16 v[244:247], a[116:119], v[76:79], v[244:247]
  v_or3_b32 v5, v5, v94, v95
  v_and_b32 v5, s73, v5
  v_mfma_f32_16x16x32_bf16 v[152:155], a[120:123], v[64:67], v[152:155]
  v_cmp_ne_u32 vcc, 0, v5
  v_add_u32 v4, 0x4000, v4
  v_mfma_f32_16x16x32_bf16 v[184:187], a[120:123], v[68:71], v[184:187]
  v_and_b32 v4, 0x1ffff, v4
  v_mfma_f32_16x16x32_bf16 v[216:219], a[120:123], v[72:75], v[216:219]
  v_mfma_f32_16x16x32_bf16 v[248:251], a[120:123], v[76:79], v[248:251]
  v_mfma_f32_16x16x32_bf16 v[156:159], a[124:127], v[64:67], v[156:159]
  v_mfma_f32_16x16x32_bf16 v[188:191], a[124:127], v[68:71], v[188:191]
  s_mov_b32 s74, 0
  v_mfma_f32_16x16x32_bf16 v[220:223], a[124:127], v[72:75], v[220:223]
  s_sub_u32 s68, s58, s69
  v_mfma_f32_16x16x32_bf16 v[252:255], a[124:127], v[76:79], v[252:255]
  s_cbranch_vccnz L_a_slow1
L_a_f0_r:
  s_cmp_lt_u32 s68, 2
  s_cbranch_scc1 L_a_mask
L_a_f0_m:
  s_cmp_eq_u32 s58, s60
  s_cbranch_scc0 L_a_f1
L_a_last:
  ds_read_b128 a[96:99], v4 offset:0
  ds_read_b128 a[100:103], v4 offset:1024
  ds_read_b128 a[104:107], v4 offset:2048
  ds_read_b128 a[108:111], v4 offset:3072
  ds_read_b128 a[112:115], v4 offset:4096
  ds_read_b128 a[116:119], v4 offset:5120
  ds_read_b128 a[120:123], v4 offset:6144
  ds_read_b128 a[124:127], v4 offset:7168
  v_mfma_f32_16x16x32_bf16 a[128:131], v[16:19], v[80:83], a[128:131]
  v_mfma_f32_16x16x32_bf16 a[132:135], v[16:19], v[84:87], a[132:135]
  v_mfma_f32_16x16x32_bf16 a[136:139], v[16:19], v[88:91], a[136:139]
  v_mfma_f32_16x16x32_bf16 a[140:143], v[16:19], v[92:95], a[140:143]
  s_waitcnt lgkmcnt(7)
  v_mfma_f32_16x16x32_bf16 v[128:131], a[96:99], v[80:83], v[128:131]
  v_mfma_f32_16x16x32_bf16 v[160:163], a[96:99], v[84:87], v[160:163]
  v_mfma_f32_16x16x32_bf16 v[192:195], a[96:99], v[88:91], v[192:195]
  v_mfma_f32_16x16x32_bf16 v[224:227], a[96:99], v[92:95], v[224:227]
  s_waitcnt lgkmcnt(6)
  v_mfma_f32_16x16x32_bf16 v[132:135], a[100:103], v[80:83], v[132:135]
  v_mfma_f32_16x16x32_bf16 v[164:167], a[100:103], v[84:87], v[164:167]
  v_mfma_f32_16x16x32_bf16 v[196:199], a[100:103], v[88:91], v[196:199]
  v_mfma_f32_16x16x32_bf16 v[228:231], a[100:103], v[92:95], v[228:231]
  s_waitcnt lgkmcnt(5)
  v_mfma_f32_16x16x32_bf16 v[136:139], a[104:107], v[80:83], v[136:139]
  v_mfma_f32_16x16x32_bf16 v[168:171], a[104:107], v[84:87], v[168:171]
  v_mfma_f32_16x16x32_bf16 v[200:203], a[104:107], v[88:91], v[200:203]
  v_mfma_f32_16x16x32_bf16 v[232:235], a[104:107], v[92:95], v[232:235]
  s_waitcnt lgkmcnt(4)
  v_mfma_f32_16x16x32_bf16 v[140:143], a[108:111], v[80:83], v[140:143]
  v_mfma_f32_16x16x32_bf16 v[172:175], a[108:111], v[84:87], v[172:175]
  v_mfma_f32_16x16x32_bf16 v[204:207], a[108:111], v[88:91], v[204:207]
  v_mfma_f32_16x16x32_bf16 v[236:239], a[108:111], v[92:95], v[236:239]
  s_waitcnt lgkmcnt(3)
  v_mfma_f32_16x16x32_bf16 v[144:147], a[112:115], v[80:83], v[144:147]
  v_mfma_f32_16x16x32_bf16 v[176:179], a[112:115], v[84:87], v[176:179]
  v_mfma_f32_16x16x32_bf16 v[208:211], a[112:115], v[88:91], v[208:211]
  v_mfma_f32_16x16x32_bf16 v[240:243], a[112:115], v[92:95], v[240:243]
  s_waitcnt lgkmcnt(2)
  v_mfma_f32_16x16x32_bf16 v[148:151], a[116:119], v[80:83], v[148:151]
  v_mfma_f32_16x16x32_bf16 v[180:183], a[116:119], v[84:87], v[180:183]
  v_mfma_f32_16x16x32_bf16 v[212:215], a[116:119], v[88:91], v[212:215]
  v_mfma_f32_16x16x32_bf16 v[244:247], a[116:119], v[92:95], v[244:247]
  s_waitcnt lgkmcnt(1)
  v_mfma_f32_16x16x32_bf16 v[152:155], a[120:123], v[80:83], v[152:155]
  v_mfma_f32_16x16x32_bf16 v[184:187], a[120:123], v[84:87], v[184:187]
  v_mfma_f32_16x16x32_bf16 v[216:219], a[120:123], v[88:91], v[216:219]
  v_mfma_f32_16x16x32_bf16 v[248:251], a[120:123], v[92:95], v[248:251]
  s_waitcnt lgkmcnt(0)
  v_mfma_f32_16x16x32_bf16 v[156:159], a[124:127], v[80:83], v[156:159]
  v_mfma_f32_16x16x32_bf16 v[188:191], a[124:127], v[84:87], v[188:191]
  v_mfma_f32_16x16x32_bf16 v[220:223], a[124:127], v[88:91], v[220:223]
  v_mfma_f32_16x16x32_bf16 v[252:255], a[124:127], v[92:95], v[252:255]
  v_accvgpr_read_b32 v6, a128
  v_rcp_f32 v6, v6
  s_nop 0
  v_mul_f32 v20, v20, v6
  v_accvgpr_read_b32 v6, a132
  v_rcp_f32 v6, v6
  s_nop 0
  v_mul_f32 v21, v21, v6
  v_accvgpr_read_b32 v6, a136
  v_rcp_f32 v6, v6
  s_nop 0
  v_mul_f32 v22, v22, v6
  v_accvgpr_read_b32 v6, a140
  v_rcp_f32 v6, v6
  s_nop 0
  v_mul_f32 v23, v23, v6
  s_add_u32 s67, s72, 0x1000
  v_mul_f32 v128, v128, v20
  v_mul_f32 v129, v129, v20
  v_mul_f32 v130, v130, v20
  v_mul_f32 v131, v131, v20
  v_mul_f32 v132, v132, v20
  v_mul_f32 v133, v133, v20
  v_mul_f32 v134, v134, v20
  v_mul_f32 v135, v135, v20
  v_cvt_pk_bf16_f32 v32, v128, v129
  v_cvt_pk_bf16_f32 v33, v130, v131
  v_cvt_pk_bf16_f32 v34, v132, v133
  v_cvt_pk_bf16_f32 v35, v134, v135
  buffer_store_dwordx4 v[32:35], v2, s[40:43], s72 offen offset:0 sc1
  v_mul_f32 v136, v136, v20
  v_mul_f32 v137, v137, v20
  v_mul_f32 v138, v138, v20
  v_mul_f32 v139, v139, v20
  v_mul_f32 v140, v140, v20
  v_mul_f32 v141, v141, v20
  v_mul_f32 v142, v142, v20
  v_mul_f32 v143, v143, v20
  v_cvt_pk_bf16_f32 v36, v136, v137
  v_cvt_pk_bf16_f32 v37, v138, v139
  v_cvt_pk_bf16_f32 v38, v140, v141
  v_cvt_pk_bf16_f32 v39, v142, v143
  buffer_store_dwordx4 v[36:39], v2, s[40:43], s72 offen offset:2048 sc1
  v_mul_f32 v144, v144, v20
  v_mul_f32 v145, v145, v20
  v_mul_f32 v146, v146, v20
  v_mul_f32 v147, v147, v20
  v_mul_f32 v148, v148, v20
  v_mul_f32 v149, v149, v20
  v_mul_f32 v150, v150, v20
  v_mul_f32 v151, v151, v20
  v_cvt_pk_bf16_f32 v40, v144, v145
  v_cvt_pk_bf16_f32 v41, v146, v147
  v_cvt_pk_bf16_f32 v42, v148, v149
  v_cvt_pk_bf16_f32 v43, v150, v151
  buffer_store_dwordx4 v[40:43], v2, s[40:43], s67 offen offset:0 sc1
  v_mul_f32 v152, v152, v20
  v_mul_f32 v153, v153, v20
  v_mul_f32 v154, v154, v20
  v_mul_f32 v155, v155, v20
  v_mul_f32 v156, v156, v20
  v_mul_f32 v157, v157, v20
  v_mul_f32 v158, v158, v20
  v_mul_f32 v159, v159, v20
  v_cvt_pk_bf16_f32 v44, v152, v153
  v_cvt_pk_bf16_f32 v45, v154, v155
  v_cvt_pk_bf16_f32 v46, v156, v157
  v_cvt_pk_bf16_f32 v47, v158, v159
  buffer_store_dwordx4 v[44:47], v2, s[40:43], s67 offen offset:2048 sc1
  s_add_u32 s67, s72, 0x1000
  v_mul_f32 v160, v160, v21
  v_mul_f32 v161, v161, v21
  v_mul_f32 v162, v162, v21
  v_mul_f32 v163, v163, v21
  v_mul_f32 v164, v164, v21
  v_mul_f32 v165, v165, v21
  v_mul_f32 v166, v166, v21
  v_mul_f32 v167, v167, v21
  v_cvt_pk_bf16_f32 v48, v160, v161
  v_cvt_pk_bf16_f32 v49, v162, v163
  v_cvt_pk_bf16_f32 v50, v164, v165
  v_cvt_pk_bf16_f32 v51, v166, v167
  buffer_store_dwordx4 v[48:51], v2, s[40:43], s72 offen offset:1024 sc1
  v_mul_f32 v168, v168, v21
  v_mul_f32 v169, v169, v21
  v_mul_f32 v170, v170, v21
  v_mul_f32 v171, v171, v21
  v_mul_f32 v172, v172, v21
  v_mul_f32 v173, v173, v21
  v_mul_f32 v174, v174, v21
  v_mul_f32 v175, v175, v21
  v_cvt_pk_bf16_f32 v52, v168, v169
  v_cvt_pk_bf16_f32 v53, v170, v171
  v_cvt_pk_bf16_f32 v54, v172, v173
  v_cvt_pk_bf16_f32 v55, v174, v175
  buffer_store_dwordx4 v[52:55], v2, s[40:43], s72 offen offset:3072 sc1
  v_mul_f32 v176, v176, v21
  v_mul_f32 v177, v177, v21
  v_mul_f32 v178, v178, v21
  v_mul_f32 v179, v179, v21
  v_mul_f32 v180, v180, v21
  v_mul_f32 v181, v181, v21
  v_mul_f32 v182, v182, v21
  v_mul_f32 v183, v183, v21
  v_cvt_pk_bf16_f32 v56, v176, v177
  v_cvt_pk_bf16_f32 v57, v178, v179
  v_cvt_pk_bf16_f32 v58, v180, v181
  v_cvt_pk_bf16_f32 v59, v182, v183
  buffer_store_dwordx4 v[56:59], v2, s[40:43], s67 offen offset:1024 sc1
  v_mul_f32 v184, v184, v21
  v_mul_f32 v185, v185, v21
  v_mul_f32 v186, v186, v21
  v_mul_f32 v187, v187, v21
  v_mul_f32 v188, v188, v21
  v_mul_f32 v189, v189, v21
  v_mul_f32 v190, v190, v21
  v_mul_f32 v191, v191, v21
  v_cvt_pk_bf16_f32 v60, v184, v185
  v_cvt_pk_bf16_f32 v61, v186, v187
  v_cvt_pk_bf16_f32 v62, v188, v189
  v_cvt_pk_bf16_f32 v63, v190, v191
  buffer_store_dwordx4 v[60:63], v2, s[40:43], s67 offen offset:3072 sc1
  s_add_u32 s72, s72, 0x80000
  s_add_u32 s67, s72, 0x1000
  v_mul_f32 v192, v192, v22
  v_mul_f32 v193, v193, v22
  v_mul_f32 v194, v194, v22
  v_mul_f32 v195, v195, v22
  v_mul_f32 v196, v196, v22
  v_mul_f32 v197, v197, v22
  v_mul_f32 v198, v198, v22
  v_mul_f32 v199, v199, v22
  v_cvt_pk_bf16_f32 v32, v192, v193
  v_cvt_pk_bf16_f32 v33, v194, v195
  v_cvt_pk_bf16_f32 v34, v196, v197
  v_cvt_pk_bf16_f32 v35, v198, v199
  buffer_store_dwordx4 v[32:35], v2, s[40:43], s72 offen offset:0 sc1
  v_mul_f32 v200, v200, v22
  v_mul_f32 v201, v201, v22
  v_mul_f32 v202, v202, v22
  v_mul_f32 v203, v203, v22
  v_mul_f32 v204, v204, v22
  v_mul_f32 v205, v205, v22
  v_mul_f32 v206, v206, v22
  v_mul_f32 v207, v207, v22
  v_cvt_pk_bf16_f32 v36, v200, v201
  v_cvt_pk_bf16_f32 v37, v202, v203
  v_cvt_pk_bf16_f32 v38, v204, v205
  v_cvt_pk_bf16_f32 v39, v206, v207
  buffer_store_dwordx4 v[36:39], v2, s[40:43], s72 offen offset:2048 sc1
  v_mul_f32 v208, v208, v22
  v_mul_f32 v209, v209, v22
  v_mul_f32 v210, v210, v22
  v_mul_f32 v211, v211, v22
  v_mul_f32 v212, v212, v22
  v_mul_f32 v213, v213, v22
  v_mul_f32 v214, v214, v22
  v_mul_f32 v215, v215, v22
  v_cvt_pk_bf16_f32 v40, v208, v209
  v_cvt_pk_bf16_f32 v41, v210, v211
  v_cvt_pk_bf16_f32 v42, v212, v213
  v_cvt_pk_bf16_f32 v43, v214, v215
  buffer_store_dwordx4 v[40:43], v2, s[40:43], s67 offen offset:0 sc1
  v_mul_f32 v216, v216, v22
  v_mul_f32 v217, v217, v22
  v_mul_f32 v218, v218, v22
  v_mul_f32 v219, v219, v22
  v_mul_f32 v220, v220, v22
  v_mul_f32 v221, v221, v22
  v_mul_f32 v222, v222, v22
  v_mul_f32 v223, v223, v22
  v_cvt_pk_bf16_f32 v44, v216, v217
  v_cvt_pk_bf16_f32 v45, v218, v219
  v_cvt_pk_bf16_f32 v46, v220, v221
  v_cvt_pk_bf16_f32 v47, v222, v223
  buffer_store_dwordx4 v[44:47], v2, s[40:43], s67 offen offset:2048 sc1
  s_add_u32 s67, s72, 0x1000
  v_mul_f32 v224, v224, v23
  v_mul_f32 v225, v225, v23
  v_mul_f32 v226, v226, v23
  v_mul_f32 v227, v227, v23
  v_mul_f32 v228, v228, v23
  v_mul_f32 v229, v229, v23
  v_mul_f32 v230, v230, v23
  v_mul_f32 v231, v231, v23
  v_cvt_pk_bf16_f32 v48, v224, v225
  v_cvt_pk_bf16_f32 v49, v226, v227
  v_cvt_pk_bf16_f32 v50, v228, v229
  v_cvt_pk_bf16_f32 v51, v230, v231
  buffer_store_dwordx4 v[48:51], v2, s[40:43], s72 offen offset:1024 sc1
  v_mul_f32 v232, v232, v23
  v_mul_f32 v233, v233, v23
  v_mul_f32 v234, v234, v23
  v_mul_f32 v235, v235, v23
  v_mul_f32 v236, v236, v23
  v_mul_f32 v237, v237, v23
  v_mul_f32 v238, v238, v23
  v_mul_f32 v239, v239, v23
  v_cvt_pk_bf16_f32 v52, v232, v233
  v_cvt_pk_bf16_f32 v53, v234, v235
  v_cvt_pk_bf16_f32 v54, v236, v237
  v_cvt_pk_bf16_f32 v55, v238, v239
  buffer_store_dwordx4 v[52:55], v2, s[40:43], s72 offen offset:3072 sc1
  v_mul_f32 v240, v240, v23
  v_mul_f32 v241, v241, v23
  v_mul_f32 v242, v242, v23
  v_mul_f32 v243, v243, v23
  v_mul_f32 v244, v244, v23
  v_mul_f32 v245, v245, v23
  v_mul_f32 v246, v246, v23
  v_mul_f32 v247, v247, v23
  v_cvt_pk_bf16_f32 v56, v240, v241
  v_cvt_pk_bf16_f32 v57, v242, v243
  v_cvt_pk_bf16_f32 v58, v244, v245
  v_cvt_pk_bf16_f32 v59, v246, v247
  buffer_store_dwordx4 v[56:59], v2, s[40:43], s67 offen offset:1024 sc1
  v_mul_f32 v248, v248, v23
  v_mul_f32 v249, v249, v23
  v_mul_f32 v250, v250, v23
  v_mul_f32 v251, v251, v23
  v_mul_f32 v252, v252, v23
  v_mul_f32 v253, v253, v23
  v_mul_f32 v254, v254, v23
  v_mul_f32 v255, v255, v23
  v_cvt_pk_bf16_f32 v60, v248, v249
  v_cvt_pk_bf16_f32 v61, v250, v251
  v_cvt_pk_bf16_f32 v62, v252, v253
  v_cvt_pk_bf16_f32 v63, v254, v255
  buffer_store_dwordx4 v[60:63], v2, s[40:43], s67 offen offset:3072 sc1
  s_lshl_b32 s67, s57, 7
  s_add_u32 s67, s67, 0x9086000
  s_cmp_eq_u32 s44, 0
  s_cselect_b32 s67, s67, 0x40000000
  v_mov_b32 v6, 1
  s_waitcnt vmcnt(0)
  s_barrier
  s_mov_b64 exec, 1
  buffer_atomic_add v6, v2, s[40:43], s67 offen
  s_mov_b64 exec, -1
  s_branch L_att_end
L_a_slow0:
  s_nop 7
  v_max3_f32 v6, v32, v33, v34
  v_max3_f32 v7, v35, v36, v37
  v_max3_f32 v6, v6, v38, v39
  v_max_f32 v6, v6, v7
  v_mov_b32 v7, v6
  s_nop 1
  v_permlane32_swap_b32 v7, v6
  v_max_f32 v6, v6, v7
  v_mov_b32 v7, v6
  s_nop 1
  v_permlane16_swap_b32 v7, v6
  v_max_f32 v6, v6, v7
  v_add_f32 v6, 0x41800000, v6
  v_max_f32 v6, 0, v6
  v_exp_f32 v7, -v6
  v_sub_f32 v96, v96, v6
  v_sub_f32 v97, v97, v6
  v_sub_f32 v98, v98, v6
  v_sub_f32 v99, v99, v6
  v_sub_f32 v100, v100, v6
  v_sub_f32 v101, v101, v6
  v_sub_f32 v102, v102, v6
  v_sub_f32 v103, v103, v6
  v_mul_f32 v128, v128, v7
  v_mul_f32 v129, v129, v7
  v_mul_f32 v130, v130, v7
  v_mul_f32 v131, v131, v7
  v_mul_f32 v132, v132, v7
  v_mul_f32 v133, v133, v7
  v_mul_f32 v134, v134, v7
  v_mul_f32 v135, v135, v7
  v_mul_f32 v136, v136, v7
  v_mul_f32 v137, v137, v7
  v_mul_f32 v138, v138, v7
  v_mul_f32 v139, v139, v7
  v_mul_f32 v140, v140, v7
  v_mul_f32 v141, v141, v7
  v_mul_f32 v142, v142, v7
  v_mul_f32 v143, v143, v7
  v_mul_f32 v144, v144, v7
  v_mul_f32 v145, v145, v7
  v_mul_f32 v146, v146, v7
  v_mul_f32 v147, v147, v7
  v_mul_f32 v148, v148, v7
  v_mul_f32 v149, v149, v7
  v_mul_f32 v150, v150, v7
  v_mul_f32 v151, v151, v7
  v_mul_f32 v152, v152, v7
  v_mul_f32 v153, v153, v7
  v_mul_f32 v154, v154, v7
  v_mul_f32 v155, v155, v7
  v_mul_f32 v156, v156, v7
  v_mul_f32 v157, v157, v7
  v_mul_f32 v158, v158, v7
  v_mul_f32 v159, v159, v7
  v_accvgpr_read_b32 v24, a128
  v_mul_f32 v24, v24, v7
  v_accvgpr_write_b32 a128, v24
  v_accvgpr_read_b32 v24, a129
  v_mul_f32 v24, v24, v7
  v_accvgpr_write_b32 a129, v24
  v_accvgpr_read_b32 v24, a130
  v_mul_f32 v24, v24, v7
  v_accvgpr_write_b32 a130, v24
  v_accvgpr_read_b32 v24, a131
  v_mul_f32 v24, v24, v7
  v_accvgpr_write_b32 a131, v24
  v_sub_f32 v8, v32, v6
  v_sub_f32 v9, v33, v6
  v_sub_f32 v10, v34, v6
  v_sub_f32 v11, v35, v6
  v_sub_f32 v12, v36, v6
  v_sub_f32 v13, v37, v6
  v_sub_f32 v14, v38, v6
  v_sub_f32 v15, v39, v6
  v_exp_f32 v8, v8
  v_exp_f32 v9, v9
  v_exp_f32 v10, v10
  v_exp_f32 v11, v11
  v_exp_f32 v12, v12
  v_exp_f32 v13, v13
  v_exp_f32 v14, v14
  v_exp_f32 v15, v15
  v_cvt_pk_bf16_f32 v64, v8, v9
  v_cvt_pk_bf16_f32 v65, v10, v11
  v_cvt_pk_bf16_f32 v66, v12, v13
  v_cvt_pk_bf16_f32 v67, v14, v15
  v_max3_f32 v6, v40, v41, v42
  v_max3_f32 v7, v43, v44, v45
  v_max3_f32 v6, v6, v46, v47
  v_max_f32 v6, v6, v7
  v_mov_b32 v7, v6
  s_nop 1
  v_permlane32_swap_b32 v7, v6
  v_max_f32 v6, v6, v7
  v_mov_b32 v7, v6
  s_nop 1
  v_permlane16_swap_b32 v7, v6
  v_max_f32 v6, v6, v7
  v_add_f32 v6, 0x41800000, v6
  v_max_f32 v6, 0, v6
  v_exp_f32 v7, -v6
  v_sub_f32 v104, v104, v6
  v_sub_f32 v105, v105, v6
  v_sub_f32 v106, v106, v6
  v_sub_f32 v107, v107, v6
  v_sub_f32 v108, v108, v6
  v_sub_f32 v109, v109, v6
  v_sub_f32 v110, v110, v6
  v_sub_f32 v111, v111, v6
  v_mul_f32 v160, v160, v7
  v_mul_f32 v161, v161, v7
  v_mul_f32 v162, v162, v7
  v_mul_f32 v163, v163, v7
  v_mul_f32 v164, v164, v7
  v_mul_f32 v165, v165, v7
  v_mul_f32 v166, v166, v7
  v_mul_f32 v167, v167, v7
  v_mul_f32 v168, v168, v7
  v_mul_f32 v169, v169, v7
  v_mul_f32 v170, v170, v7
  v_mul_f32 v171, v171, v7
  v_mul_f32 v172, v172, v7
  v_mul_f32 v173, v173, v7
  v_mul_f32 v174, v174, v7
  v_mul_f32 v175, v175, v7
  v_mul_f32 v176, v176, v7
  v_mul_f32 v177, v177, v7
  v_mul_f32 v178, v178, v7
  v_mul_f32 v179, v179, v7
  v_mul_f32 v180, v180, v7
  v_mul_f32 v181, v181, v7
  v_mul_f32 v182, v182, v7
  v_mul_f32 v183, v183, v7
  v_mul_f32 v184, v184, v7
  v_mul_f32 v185, v185, v7
  v_mul_f32 v186, v186, v7
  v_mul_f32 v187, v187, v7
  v_mul_f32 v188, v188, v7
  v_mul_f32 v189, v189, v7
  v_mul_f32 v190, v190, v7
  v_mul_f32 v191, v191, v7
  v_accvgpr_read_b32 v24, a132
  v_mul_f32 v24, v24, v7
  v_accvgpr_write_b32 a132, v24
  v_accvgpr_read_b32 v24, a133
  v_mul_f32 v24, v24, v7
  v_accvgpr_write_b32 a133, v24
  v_accvgpr_read_b32 v24, a134
  v_mul_f32 v24, v24, v7
  v_accvgpr_write_b32 a134, v24
  v_accvgpr_read_b32 v24, a135
  v_mul_f32 v24, v24, v7
  v_accvgpr_write_b32 a135, v24
  v_sub_f32 v8, v40, v6
  v_sub_f32 v9, v41, v6
  v_sub_f32 v10, v42, v6
  v_sub_f32 v11, v43, v6
  v_sub_f32 v12, v44, v6
  v_sub_f32 v13, v45, v6
  v_sub_f32 v14, v46, v6
  v_sub_f32 v15, v47, v6
  v_exp_f32 v8, v8
  v_exp_f32 v9, v9
  v_exp_f32 v10, v10
  v_exp_f32 v11, v11
  v_exp_f32 v12, v12
  v_exp_f32 v13, v13
  v_exp_f32 v14, v14
  v_exp_f32 v15, v15
  v_cvt_pk_bf16_f32 v68, v8, v9
  v_cvt_pk_bf16_f32 v69, v10, v11
  v_cvt_pk_bf16_f32 v70, v12, v13
  v_cvt_pk_bf16_f32 v71, v14, v15
  v_max3_f32 v6, v48, v49, v50
  v_max3_f32 v7, v51, v52, v53
  v_max3_f32 v6, v6, v54, v55
  v_max_f32 v6, v6, v7
  v_mov_b32 v7, v6
  s_nop 1
  v_permlane32_swap_b32 v7, v6
  v_max_f32 v6, v6, v7
  v_mov_b32 v7, v6
  s_nop 1
  v_permlane16_swap_b32 v7, v6
  v_max_f32 v6, v6, v7
  v_add_f32 v6, 0x41800000, v6
  v_max_f32 v6, 0, v6
  v_exp_f32 v7, -v6
  v_sub_f32 v112, v112, v6
  v_sub_f32 v113, v113, v6
  v_sub_f32 v114, v114, v6
  v_sub_f32 v115, v115, v6
  v_sub_f32 v116, v116, v6
  v_sub_f32 v117, v117, v6
  v_sub_f32 v118, v118, v6
  v_sub_f32 v119, v119, v6
  v_mul_f32 v192, v192, v7
  v_mul_f32 v193, v193, v7
  v_mul_f32 v194, v194, v7
  v_mul_f32 v195, v195, v7
  v_mul_f32 v196, v196, v7
  v_mul_f32 v197, v197, v7
  v_mul_f32 v198, v198, v7
  v_mul_f32 v199, v199, v7
  v_mul_f32 v200, v200, v7
  v_mul_f32 v201, v201, v7
  v_mul_f32 v202, v202, v7
  v_mul_f32 v203, v203, v7
  v_mul_f32 v204, v204, v7
  v_mul_f32 v205, v205, v7
  v_mul_f32 v206, v206, v7
  v_mul_f32 v207, v207, v7
  v_mul_f32 v208, v208, v7
  v_mul_f32 v209, v209, v7
  v_mul_f32 v210, v210, v7
  v_mul_f32 v211, v211, v7
  v_mul_f32 v212, v212, v7
  v_mul_f32 v213, v213, v7
  v_mul_f32 v214, v214, v7
  v_mul_f32 v215, v215, v7
  v_mul_f32 v216, v216, v7
  v_mul_f32 v217, v217, v7
  v_mul_f32 v218, v218, v7
  v_mul_f32 v219, v219, v7
  v_mul_f32 v220, v220, v7
  v_mul_f32 v221, v221, v7
  v_mul_f32 v222, v222, v7
  v_mul_f32 v223, v223, v7
  v_accvgpr_read_b32 v24, a136
  v_mul_f32 v24, v24, v7
  v_accvgpr_write_b32 a136, v24
  v_accvgpr_read_b32 v24, a137
  v_mul_f32 v24, v24, v7
  v_accvgpr_write_b32 a137, v24
  v_accvgpr_read_b32 v24, a138
  v_mul_f32 v24, v24, v7
  v_accvgpr_write_b32 a138, v24
  v_accvgpr_read_b32 v24, a139
  v_mul_f32 v24, v24, v7
  v_accvgpr_write_b32 a139, v24
  v_sub_f32 v8, v48, v6
  v_sub_f32 v9, v49, v6
  v_sub_f32 v10, v50, v6
  v_sub_f32 v11, v51, v6
  v_sub_f32 v12, v52, v6
  v_sub_f32 v13, v53, v6
  v_sub_f32 v14, v54, v6
  v_sub_f32 v15, v55, v6
  v_exp_f32 v8, v8
  v_exp_f32 v9, v9
  v_exp_f32 v10, v10
  v_exp_f32 v11, v11
  v_exp_f32 v12, v12
  v_exp_f32 v13, v13
  v_exp_f32 v14, v14
  v_exp_f32 v15, v15
  v_cvt_pk_bf16_f32 v72, v8, v9
  v_cvt_pk_bf16_f32 v73, v10, v11
  v_cvt_pk_bf16_f32 v74, v12, v13
  v_cvt_pk_bf16_f32 v75, v14, v15
  v_max3_f32 v6, v56, v57, v58
  v_max3_f32 v7, v59, v60, v61
  v_max3_f32 v6, v6, v62, v63
  v_max_f32 v6, v6, v7
  v_mov_b32 v7, v6
  s_nop 1
  v_permlane32_swap_b32 v7, v6
  v_max_f32 v6, v6, v7
  v_mov_b32 v7, v6
  s_nop 1
  v_permlane16_swap_b32 v7, v6
  v_max_f32 v6, v6, v7
  v_add_f32 v6, 0x41800000, v6
  v_max_f32 v6, 0, v6
  v_exp_f32 v7, -v6
  v_sub_f32 v120, v120, v6
  v_sub_f32 v121, v121, v6
  v_sub_f32 v122, v122, v6
  v_sub_f32 v123, v123, v6
  v_sub_f32 v124, v124, v6
  v_sub_f32 v125, v125, v6
  v_sub_f32 v126, v126, v6
  v_sub_f32 v127, v127, v6
  v_mul_f32 v224, v224, v7
  v_mul_f32 v225, v225, v7
  v_mul_f32 v226, v226, v7
  v_mul_f32 v227, v227, v7
  v_mul_f32 v228, v228, v7
  v_mul_f32 v229, v229, v7
  v_mul_f32 v230, v230, v7
  v_mul_f32 v231, v231, v7
  v_mul_f32 v232, v232, v7
  v_mul_f32 v233, v233, v7
  v_mul_f32 v234, v234, v7
  v_mul_f32 v235, v235, v7
  v_mul_f32 v236, v236, v7
  v_mul_f32 v237, v237, v7
  v_mul_f32 v238, v238, v7
  v_mul_f32 v239, v239, v7
  v_mul_f32 v240, v240, v7
  v_mul_f32 v241, v241, v7
  v_mul_f32 v242, v242, v7
  v_mul_f32 v243, v243, v7
  v_mul_f32 v244, v244, v7
  v_mul_f32 v245, v245, v7
  v_mul_f32 v246, v246, v7
  v_mul_f32 v247, v247, v7
  v_mul_f32 v248, v248, v7
  v_mul_f32 v249, v249, v7
  v_mul_f32 v250, v250, v7
  v_mul_f32 v251, v251, v7
  v_mul_f32 v252, v252, v7
  v_mul_f32 v253, v253, v7
  v_mul_f32 v254, v254, v7
  v_mul_f32 v255, v255, v7
  v_accvgpr_read_b32 v24, a140
  v_mul_f32 v24, v24, v7
  v_accvgpr_write_b32 a140, v24
  v_accvgpr_read_b32 v24, a141
  v_mul_f32 v24, v24, v7
  v_accvgpr_write_b32 a141, v24
  v_accvgpr_read_b32 v24, a142
  v_mul_f32 v24, v24, v7
  v_accvgpr_write_b32 a142, v24
  v_accvgpr_read_b32 v24, a143
  v_mul_f32 v24, v24, v7
  v_accvgpr_write_b32 a143, v24
  v_sub_f32 v8, v56, v6
  v_sub_f32 v9, v57, v6
  v_sub_f32 v10, v58, v6
  v_sub_f32 v11, v59, v6
  v_sub_f32 v12, v60, v6
  v_sub_f32 v13, v61, v6
  v_sub_f32 v14, v62, v6
  v_sub_f32 v15, v63, v6
  v_exp_f32 v8, v8
  v_exp_f32 v9, v9
  v_exp_f32 v10, v10
  v_exp_f32 v11, v11
  v_exp_f32 v12, v12
  v_exp_f32 v13, v13
  v_exp_f32 v14, v14
  v_exp_f32 v15, v15
  v_cvt_pk_bf16_f32 v76, v8, v9
  v_cvt_pk_bf16_f32 v77, v10, v11
  v_cvt_pk_bf16_f32 v78, v12, v13
  v_cvt_pk_bf16_f32 v79, v14, v15
  s_nop 1
  s_cmp_eq_u32 s74, 1
  s_cbranch_scc1 L_a_f1_r
  s_branch L_a_s1_r
L_a_slow1:
  s_nop 7
  v_max3_f32 v6, v32, v33, v34
  v_max3_f32 v7, v35, v36, v37
  v_max3_f32 v6, v6, v38, v39
  v_max_f32 v6, v6, v7
  v_mov_b32 v7, v6
  s_nop 1
  v_permlane32_swap_b32 v7, v6
  v_max_f32 v6, v6, v7
  v_mov_b32 v7, v6
  s_nop 1
  v_permlane16_swap_b32 v7, v6
  v_max_f32 v6, v6, v7
  v_add_f32 v6, 0x41800000, v6
  v_max_f32 v6, 0, v6
  v_exp_f32 v7, -v6
  v_sub_f32 v96, v96, v6
  v_sub_f32 v97, v97, v6
  v_sub_f32 v98, v98, v6
  v_sub_f32 v99, v99, v6
  v_sub_f32 v100, v100, v6
  v_sub_f32 v101, v101, v6
  v_sub_f32 v102, v102, v6
  v_sub_f32 v103, v103, v6
  v_mul_f32 v128, v128, v7
  v_mul_f32 v129, v129, v7
  v_mul_f32 v130, v130, v7
  v_mul_f32 v131, v131, v7
  v_mul_f32 v132, v132, v7
  v_mul_f32 v133, v133, v7
  v_mul_f32 v134, v134, v7
  v_mul_f32 v135, v135, v7
  v_mul_f32 v136, v136, v7
  v_mul_f32 v137, v137, v7
  v_mul_f32 v138, v138, v7
  v_mul_f32 v139, v139, v7
  v_mul_f32 v140, v140, v7
  v_mul_f32 v141, v141, v7
  v_mul_f32 v142, v142, v7
  v_mul_f32 v143, v143, v7
  v_mul_f32 v144, v144, v7
  v_mul_f32 v145, v145, v7
  v_mul_f32 v146, v146, v7
  v_mul_f32 v147, v147, v7
  v_mul_f32 v148, v148, v7
  v_mul_f32 v149, v149, v7
  v_mul_f32 v150, v150, v7
  v_mul_f32 v151, v151, v7
  v_mul_f32 v152, v152, v7
  v_mul_f32 v153, v153, v7
  v_mul_f32 v154, v154, v7
  v_mul_f32 v155, v155, v7
  v_mul_f32 v156, v156, v7
  v_mul_f32 v157, v157, v7
  v_mul_f32 v158, v158, v7
  v_mul_f32 v159, v159, v7
  v_accvgpr_read_b32 v24, a128
  v_mul_f32 v24, v24, v7
  v_accvgpr_write_b32 a128, v24
  v_accvgpr_read_b32 v24, a129
  v_mul_f32 v24, v24, v7
  v_accvgpr_write_b32 a129, v24
  v_accvgpr_read_b32 v24, a130
  v_mul_f32 v24, v24, v7
  v_accvgpr_write_b32 a130, v24
  v_accvgpr_read_b32 v24, a131
  v_mul_f32 v24, v24, v7
  v_accvgpr_write_b32 a131, v24
  v_sub_f32 v8, v32, v6
  v_sub_f32 v9, v33, v6
  v_sub_f32 v10, v34, v6
  v_sub_f32 v11, v35, v6
  v_sub_f32 v12, v36, v6
  v_sub_f32 v13, v37, v6
  v_sub_f32 v14, v38, v6
  v_sub_f32 v15, v39, v6
  v_exp_f32 v8, v8
  v_exp_f32 v9, v9
  v_exp_f32 v10, v10
  v_exp_f32 v11, v11
  v_exp_f32 v12, v12
  v_exp_f32 v13, v13
  v_exp_f32 v14, v14
  v_exp_f32 v15, v15
  v_cvt_pk_bf16_f32 v80, v8, v9
  v_cvt_pk_bf16_f32 v81, v10, v11
  v_cvt_pk_bf16_f32 v82, v12, v13
  v_cvt_pk_bf16_f32 v83, v14, v15
  v_max3_f32 v6, v40, v41, v42
  v_max3_f32 v7, v43, v44, v45
  v_max3_f32 v6, v6, v46, v47
  v_max_f32 v6, v6, v7
  v_mov_b32 v7, v6
  s_nop 1
  v_permlane32_swap_b32 v7, v6
  v_max_f32 v6, v6, v7
  v_mov_b32 v7, v6
  s_nop 1
  v_permlane16_swap_b32 v7, v6
  v_max_f32 v6, v6, v7
  v_add_f32 v6, 0x41800000, v6
  v_max_f32 v6, 0, v6
  v_exp_f32 v7, -v6
  v_sub_f32 v104, v104, v6
  v_sub_f32 v105, v105, v6
  v_sub_f32 v106, v106, v6
  v_sub_f32 v107, v107, v6
  v_sub_f32 v108, v108, v6
  v_sub_f32 v109, v109, v6
  v_sub_f32 v110, v110, v6
  v_sub_f32 v111, v111, v6
  v_mul_f32 v160, v160, v7
  v_mul_f32 v161, v161, v7
  v_mul_f32 v162, v162, v7
  v_mul_f32 v163, v163, v7
  v_mul_f32 v164, v164, v7
  v_mul_f32 v165, v165, v7
  v_mul_f32 v166, v166, v7
  v_mul_f32 v167, v167, v7
  v_mul_f32 v168, v168, v7
  v_mul_f32 v169, v169, v7
  v_mul_f32 v170, v170, v7
  v_mul_f32 v171, v171, v7
  v_mul_f32 v172, v172, v7
  v_mul_f32 v173, v173, v7
  v_mul_f32 v174, v174, v7
  v_mul_f32 v175, v175, v7
  v_mul_f32 v176, v176, v7
  v_mul_f32 v177, v177, v7
  v_mul_f32 v178, v178, v7
  v_mul_f32 v179, v179, v7
  v_mul_f32 v180, v180, v7
  v_mul_f32 v181, v181, v7
  v_mul_f32 v182, v182, v7
  v_mul_f32 v183, v183, v7
  v_mul_f32 v184, v184, v7
  v_mul_f32 v185, v185, v7
  v_mul_f32 v186, v186, v7
  v_mul_f32 v187, v187, v7
  v_mul_f32 v188, v188, v7
  v_mul_f32 v189, v189, v7
  v_mul_f32 v190, v190, v7
  v_mul_f32 v191, v191, v7
  v_accvgpr_read_b32 v24, a132
  v_mul_f32 v24, v24, v7
  v_accvgpr_write_b32 a132, v24
  v_accvgpr_read_b32 v24, a133
  v_mul_f32 v24, v24, v7
  v_accvgpr_write_b32 a133, v24
  v_accvgpr_read_b32 v24, a134
  v_mul_f32 v24, v24, v7
  v_accvgpr_write_b32 a134, v24
  v_accvgpr_read_b32 v24, a135
  v_mul_f32 v24, v24, v7
  v_accvgpr_write_b32 a135, v24
  v_sub_f32 v8, v40, v6
  v_sub_f32 v9, v41, v6
  v_sub_f32 v10, v42, v6
  v_sub_f32 v11, v43, v6
  v_sub_f32 v12, v44, v6
  v_sub_f32 v13, v45, v6
  v_sub_f32 v14, v46, v6
  v_sub_f32 v15, v47, v6
  v_exp_f32 v8, v8
  v_exp_f32 v9, v9
  v_exp_f32 v10, v10
  v_exp_f32 v11, v11
  v_exp_f32 v12, v12
  v_exp_f32 v13, v13
  v_exp_f32 v14, v14
  v_exp_f32 v15, v15
  v_cvt_pk_bf16_f32 v84, v8, v9
  v_cvt_pk_bf16_f32 v85, v10, v11
  v_cvt_pk_bf16_f32 v86, v12, v13
  v_cvt_pk_bf16_f32 v87, v14, v15
  v_max3_f32 v6, v48, v49, v50
  v_max3_f32 v7, v51, v52, v53
  v_max3_f32 v6, v6, v54, v55
  v_max_f32 v6, v6, v7
  v_mov_b32 v7, v6
  s_nop 1
  v_permlane32_swap_b32 v7, v6
  v_max_f32 v6, v6, v7
  v_mov_b32 v7, v6
  s_nop 1
  v_permlane16_swap_b32 v7, v6
  v_max_f32 v6, v6, v7
  v_add_f32 v6, 0x41800000, v6
  v_max_f32 v6, 0, v6
  v_exp_f32 v7, -v6
  v_sub_f32 v112, v112, v6
  v_sub_f32 v113, v113, v6
  v_sub_f32 v114, v114, v6
  v_sub_f32 v115, v115, v6
  v_sub_f32 v116, v116, v6
  v_sub_f32 v117, v117, v6
  v_sub_f32 v118, v118, v6
  v_sub_f32 v119, v119, v6
  v_mul_f32 v192, v192, v7
  v_mul_f32 v193, v193, v7
  v_mul_f32 v194, v194, v7
  v_mul_f32 v195, v195, v7
  v_mul_f32 v196, v196, v7
  v_mul_f32 v197, v197, v7
  v_mul_f32 v198, v198, v7
  v_mul_f32 v199, v199, v7
  v_mul_f32 v200, v200, v7
  v_mul_f32 v201, v201, v7
  v_mul_f32 v202, v202, v7
  v_mul_f32 v203, v203, v7
  v_mul_f32 v204, v204, v7
  v_mul_f32 v205, v205, v7
  v_mul_f32 v206, v206, v7
  v_mul_f32 v207, v207, v7
  v_mul_f32 v208, v208, v7
  v_mul_f32 v209, v209, v7
  v_mul_f32 v210, v210, v7
  v_mul_f32 v211, v211, v7
  v_mul_f32 v212, v212, v7
  v_mul_f32 v213, v213, v7
  v_mul_f32 v214, v214, v7
  v_mul_f32 v215, v215, v7
  v_mul_f32 v216, v216, v7
  v_mul_f32 v217, v217, v7
  v_mul_f32 v218, v218, v7
  v_mul_f32 v219, v219, v7
  v_mul_f32 v220, v220, v7
  v_mul_f32 v221, v221, v7
  v_mul_f32 v222, v222, v7
  v_mul_f32 v223, v223, v7
  v_accvgpr_read_b32 v24, a136
  v_mul_f32 v24, v24, v7
  v_accvgpr_write_b32 a136, v24
  v_accvgpr_read_b32 v24, a137
  v_mul_f32 v24, v24, v7
  v_accvgpr_write_b32 a137, v24
  v_accvgpr_read_b32 v24, a138
  v_mul_f32 v24, v24, v7
  v_accvgpr_write_b32 a138, v24
  v_accvgpr_read_b32 v24, a139
  v_mul_f32 v24, v24, v7
  v_accvgpr_write_b32 a139, v24
  v_sub_f32 v8, v48, v6
  v_sub_f32 v9, v49, v6
  v_sub_f32 v10, v50, v6
  v_sub_f32 v11, v51, v6
  v_sub_f32 v12, v52, v6
  v_sub_f32 v13, v53, v6
  v_sub_f32 v14, v54, v6
  v_sub_f32 v15, v55, v6
  v_exp_f32 v8, v8
  v_exp_f32 v9, v9
  v_exp_f32 v10, v10
  v_exp_f32 v11, v11
  v_exp_f32 v12, v12
  v_exp_f32 v13, v13
  v_exp_f32 v14, v14
  v_exp_f32 v15, v15
  v_cvt_pk_bf16_f32 v88, v8, v9
  v_cvt_pk_bf16_f32 v89, v10, v11
  v_cvt_pk_bf16_f32 v90, v12, v13
  v_cvt_pk_bf16_f32 v91, v14, v15
  v_max3_f32 v6, v56, v57, v58
  v_max3_f32 v7, v59, v60, v61
  v_max3_f32 v6, v6, v62, v63
  v_max_f32 v6, v6, v7
  v_mov_b32 v7, v6
  s_nop 1
  v_permlane32_swap_b32 v7, v6
  v_max_f32 v6, v6, v7
  v_mov_b32 v7, v6
  s_nop 1
  v_permlane16_swap_b32 v7, v6
  v_max_f32 v6, v6, v7
  v_add_f32 v6, 0x41800000, v6
  v_max_f32 v6, 0, v6
  v_exp_f32 v7, -v6
  v_sub_f32 v120, v120, v6
  v_sub_f32 v121, v121, v6
  v_sub_f32 v122, v122, v6
  v_sub_f32 v123, v123, v6
  v_sub_f32 v124, v124, v6
  v_sub_f32 v125, v125, v6
  v_sub_f32 v126, v126, v6
  v_sub_f32 v127, v127, v6
  v_mul_f32 v224, v224, v7
  v_mul_f32 v225, v225, v7
  v_mul_f32 v226, v226, v7
  v_mul_f32 v227, v227, v7
  v_mul_f32 v228, v228, v7
  v_mul_f32 v229, v229, v7
  v_mul_f32 v230, v230, v7
  v_mul_f32 v231, v231, v7
  v_mul_f32 v232, v232, v7
  v_mul_f32 v233, v233, v7
  v_mul_f32 v234, v234, v7
  v_mul_f32 v235, v235, v7
  v_mul_f32 v236, v236, v7
  v_mul_f32 v237, v237, v7
  v_mul_f32 v238, v238, v7
  v_mul_f32 v239, v239, v7
  v_mul_f32 v240, v240, v7
  v_mul_f32 v241, v241, v7
  v_mul_f32 v242, v242, v7
  v_mul_f32 v243, v243, v7
  v_mul_f32 v244, v244, v7
  v_mul_f32 v245, v245, v7
  v_mul_f32 v246, v246, v7
  v_mul_f32 v247, v247, v7
  v_mul_f32 v248, v248, v7
  v_mul_f32 v249, v249, v7
  v_mul_f32 v250, v250, v7
  v_mul_f32 v251, v251, v7
  v_mul_f32 v252, v252, v7
  v_mul_f32 v253, v253, v7
  v_mul_f32 v254, v254, v7
  v_mul_f32 v255, v255, v7
  v_accvgpr_read_b32 v24, a140
  v_mul_f32 v24, v24, v7
  v_accvgpr_write_b32 a140, v24
  v_accvgpr_read_b32 v24, a141
  v_mul_f32 v24, v24, v7
  v_accvgpr_write_b32 a141, v24
  v_accvgpr_read_b32 v24, a142
  v_mul_f32 v24, v24, v7
  v_accvgpr_write_b32 a142, v24
  v_accvgpr_read_b32 v24, a143
  v_mul_f32 v24, v24, v7
  v_accvgpr_write_b32 a143, v24
  v_sub_f32 v8, v56, v6
  v_sub_f32 v9, v57, v6
  v_sub_f32 v10, v58, v6
  v_sub_f32 v11, v59, v6
  v_sub_f32 v12, v60, v6
  v_sub_f32 v13, v61, v6
  v_sub_f32 v14, v62, v6
  v_sub_f32 v15, v63, v6
  v_exp_f32 v8, v8
  v_exp_f32 v9, v9
  v_exp_f32 v10, v10
  v_exp_f32 v11, v11
  v_exp_f32 v12, v12
  v_exp_f32 v13, v13
  v_exp_f32 v14, v14
  v_exp_f32 v15, v15
  v_cvt_pk_bf16_f32 v92, v8, v9
  v_cvt_pk_bf16_f32 v93, v10, v11
  v_cvt_pk_bf16_f32 v94, v12, v13
  v_cvt_pk_bf16_f32 v95, v14, v15
  s_nop 1
  s_cmp_eq_u32 s74, 0
  s_cbranch_scc1 L_a_f0_r
  s_branch L_a_s0_r
L_a_mask:
  v_mov_b32 v6, 0xff800000
  s_cmp_eq_u32 s68, 0
  s_cbranch_scc0 L_a_mask2
  v_cndmask_b32 v96, v96, v6, s[76:77]
  v_mov_b32 v100, v6
  v_cndmask_b32 v108, v108, v6, s[76:77]
  v_cndmask_b32 v97, v97, v6, s[78:79]
  v_mov_b32 v101, v6
  v_cndmask_b32 v109, v109, v6, s[78:79]
  v_cndmask_b32 v98, v98, v6, s[80:81]
  v_mov_b32 v102, v6
  v_cndmask_b32 v110, v110, v6, s[80:81]
  v_cndmask_b32 v99, v99, v6, s[82:83]
  v_mov_b32 v103, v6
  v_cndmask_b32 v111, v111, v6, s[82:83]
  s_branch L_a_maskret
L_a_mask2:
  v_mov_b32 v96, v6
  v_mov_b32 v97, v6
  v_mov_b32 v98, v6
  v_mov_b32 v99, v6
  v_mov_b32 v100, v6
  v_mov_b32 v101, v6
  v_mov_b32 v102, v6
  v_mov_b32 v103, v6
  v_mov_b32 v104, v6
  v_mov_b32 v105, v6
  v_mov_b32 v106, v6
  v_mov_b32 v107, v6
  v_mov_b32 v108, v6
  v_mov_b32 v109, v6
  v_mov_b32 v110, v6
  v_mov_b32 v111, v6
  v_cndmask_b32 v112, v112, v6, s[76:77]
  v_mov_b32 v116, v6
  v_cndmask_b32 v124, v124, v6, s[76:77]
  v_cndmask_b32 v113, v113, v6, s[78:79]
  v_mov_b32 v117, v6
  v_cndmask_b32 v125, v125, v6, s[78:79]
  v_cndmask_b32 v114, v114, v6, s[80:81]
  v_mov_b32 v118, v6
  v_cndmask_b32 v126, v126, v6, s[80:81]
  v_cndmask_b32 v115, v115, v6, s[82:83]
  v_mov_b32 v119, v6
  v_cndmask_b32 v127, v127, v6, s[82:83]
L_a_maskret:
  s_cmp_eq_u32 s74, 0
  s_cbranch_scc1 L_a_f0_m
  s_cmp_eq_u32 s74, 1
  s_cbranch_scc1 L_a_f1_m
  s_cmp_eq_u32 s74, 2
  s_cbranch_scc1 L_a_s0_m
  s_cmp_eq_u32 s74, 3
  s_cbranch_scc1 L_a_s1_m
  s_branch L_a_pre_m
L_att_end:
  s_branch L_next
L_go_outx:
  s_bfe_u32 s58, s3, 0x20002
  s_bfe_u32 s56, s3, 0x50004
  s_mov_b32 s57, s5
L_outx:
  v_lshlrev_b32 v2, 4, v0
  s_mov_b32 s59, 0
  v_accvgpr_write_b32 a192, 0
  v_accvgpr_write_b32 a193, 0
  v_accvgpr_write_b32 a194, 0
  v_accvgpr_write_b32 a195, 0
  v_accvgpr_write_b32 a196, 0
  v_accvgpr_write_b32 a197, 0
  v_accvgpr_write_b32 a198, 0
  v_accvgpr_write_b32 a199, 0
  v_accvgpr_write_b32 a200, 0
  v_accvgpr_write_b32 a201, 0
  v_accvgpr_write_b32 a202, 0
  v_accvgpr_write_b32 a203, 0
  v_accvgpr_write_b32 a204, 0
  v_accvgpr_write_b32 a205, 0
  v_accvgpr_write_b32 a206, 0
  v_accvgpr_write_b32 a207, 0
  v_accvgpr_write_b32 a208, 0
  v_accvgpr_write_b32 a209, 0
  v_accvgpr_write_b32 a210, 0
  v_accvgpr_write_b32 a211, 0
  v_accvgpr_write_b32 a212, 0
  v_accvgpr_write_b32 a213, 0
  v_accvgpr_write_b32 a214, 0
  v_accvgpr_write_b32 a215, 0
  v_accvgpr_write_b32 a216, 0
  v_accvgpr_write_b32 a217, 0
  v_accvgpr_write_b32 a218, 0
  v_accvgpr_write_b32 a219, 0
  v_accvgpr_write_b32 a220, 0
  v_accvgpr_write_b32 a221, 0
  v_accvgpr_write_b32 a222, 0
  v_accvgpr_write_b32 a223, 0
  v_accvgpr_write_b32 a224, 0
  v_accvgpr_write_b32 a225, 0
  v_accvgpr_write_b32 a226, 0
  v_accvgpr_write_b32 a227, 0
  v_accvgpr_write_b32 a228, 0
  v_accvgpr_write_b32 a229, 0
  v_accvgpr_write_b32 a230, 0
  v_accvgpr_write_b32 a231, 0
  v_accvgpr_write_b32 a232, 0
  v_accvgpr_write_b32 a233, 0
  v_accvgpr_write_b32 a234, 0
  v_accvgpr_write_b32 a235, 0
  v_accvgpr_write_b32 a236, 0
  v_accvgpr_write_b32 a237, 0
  v_accvgpr_write_b32 a238, 0
  v_accvgpr_write_b32 a239, 0
  v_accvgpr_write_b32 a240, 0
  v_accvgpr_write_b32 a241, 0
  v_accvgpr_write_b32 a242, 0
  v_accvgpr_write_b32 a243, 0
  v_accvgpr_write_b32 a244, 0
  v_accvgpr_write_b32 a245, 0
  v_accvgpr_write_b32 a246, 0
  v_accvgpr_write_b32 a247, 0
  v_accvgpr_write_b32 a248, 0
  v_accvgpr_write_b32 a249, 0
  v_accvgpr_write_b32 a250, 0
  v_accvgpr_write_b32 a251, 0
  v_accvgpr_write_b32 a252, 0
  v_accvgpr_write_b32 a253, 0
  v_accvgpr_write_b32 a254, 0
  v_accvgpr_write_b32 a255, 0
  s_mov_b32 s67, 0
  s_cmp_eq_u32 s58, 0
  s_cbranch_scc1 L_o_half
L_o_xb:
  s_lshl_b32 s62, s57, 2
  s_add_u32 s62, s62, s44
  s_lshl_b32 s60, s62, 7
  s_lshr_b32 s61, s56, 2
  s_lshl2_add_u32 s60, s61, s60
  s_add_u32 s60, s60, 0x9080060
  v_mov_b32 v3, 0
L_x_w1:
  buffer_load_dword v4, v3, s[40:43], s60 offen sc1
  s_add_u32 s59, s59, 1
  s_cmp_gt_u32 s59, 1048576
  s_cbranch_scc1 L_exit
  s_waitcnt vmcnt(0)
  v_cmp_gt_u32 vcc, 2, v4
  s_cbranch_vccnz L_x_w1
  s_sub_u32 s60, s60, 32
  v_mov_b32 v3, 0
L_x_w2:
  buffer_load_dword v4, v3, s[40:43], s60 offen sc1
  s_add_u32 s59, s59, 1
  s_cmp_gt_u32 s59, 1048576
  s_cbranch_scc1 L_exit
  s_waitcnt vmcnt(0)
  v_cmp_gt_u32 vcc, 4, v4
  s_cbranch_vccnz L_x_w2
  s_lshl_b32 s60, s61, 7
  s_add_u32 s60, s60, 0x9086400
  v_mov_b32 v3, 0
L_x_w0:
  buffer_load_dword v4, v3, s[40:43], s60 offen sc1
  s_add_u32 s59, s59, 1
  s_cmp_gt_u32 s59, 1048576
  s_cbranch_scc1 L_exit
  s_waitcnt vmcnt(0)
  v_cmp_gt_u32 vcc, 1, v4
  s_cbranch_vccnz L_x_w0
  s_lshl_b32 s69, s62, 19
  s_lshl_b32 s60, s56, 14
  s_add_u32 s69, s69, s60
  s_add_u32 s69, s69, 0x3000000
  s_add_u32 s60, s69, 0x0
  buffer_load_dwordx4 a[0:3], v2, s[40:43], s60 offen offset:0 sc1
  buffer_load_dwordx4 a[4:7], v2, s[40:43], s60 offen offset:1024 sc1
  buffer_load_dwordx4 a[8:11], v2, s[40:43], s60 offen offset:2048 sc1
  buffer_load_dwordx4 a[12:15], v2, s[40:43], s60 offen offset:3072 sc1
  s_add_u32 s60, s69, 0x1000
  buffer_load_dwordx4 a[16:19], v2, s[40:43], s60 offen offset:0 sc1
  buffer_load_dwordx4 a[20:23], v2, s[40:43], s60 offen offset:1024 sc1
  buffer_load_dwordx4 a[24:27], v2, s[40:43], s60 offen offset:2048 sc1
  buffer_load_dwordx4 a[28:31], v2, s[40:43], s60 offen offset:3072 sc1
  s_add_u32 s60, s69, 0x1000000
  buffer_load_dwordx4 a[32:35], v2, s[40:43], s60 offen offset:0 sc1
  buffer_load_dwordx4 a[36:39], v2, s[40:43], s60 offen offset:1024 sc1
  buffer_load_dwordx4 a[40:43], v2, s[40:43], s60 offen offset:2048 sc1
  buffer_load_dwordx4 a[44:47], v2, s[40:43], s60 offen offset:3072 sc1
  s_add_u32 s60, s69, 0x1001000
  buffer_load_dwordx4 a[48:51], v2, s[40:43], s60 offen offset:0 sc1
  buffer_load_dwordx4 a[52:55], v2, s[40:43], s60 offen offset:1024 sc1
  buffer_load_dwordx4 a[56:59], v2, s[40:43], s60 offen offset:2048 sc1
  buffer_load_dwordx4 a[60:63], v2, s[40:43], s60 offen offset:3072 sc1
  s_add_u32 s60, s69, 0x2000000
  buffer_load_dwordx4 a[64:67], v2, s[40:43], s60 offen offset:0 sc1
  buffer_load_dwordx4 a[68:71], v2, s[40:43], s60 offen offset:1024 sc1
  buffer_load_dwordx4 a[72:75], v2, s[40:43], s60 offen offset:2048 sc1
  buffer_load_dwordx4 a[76:79], v2, s[40:43], s60 offen offset:3072 sc1
  s_add_u32 s60, s69, 0x2001000
  buffer_load_dwordx4 a[80:83], v2, s[40:43], s60 offen offset:0 sc1
  buffer_load_dwordx4 a[84:87], v2, s[40:43], s60 offen offset:1024 sc1
  buffer_load_dwordx4 a[88:91], v2, s[40:43], s60 offen offset:2048 sc1
  buffer_load_dwordx4 a[92:95], v2, s[40:43], s60 offen offset:3072 sc1
  s_add_u32 s60, s69, 0x2000
  buffer_load_dwordx4 a[96:99], v2, s[40:43], s60 offen offset:0 sc1
  buffer_load_dwordx4 a[100:103], v2, s[40:43], s60 offen offset:1024 sc1
  buffer_load_dwordx4 a[104:107], v2, s[40:43], s60 offen offset:2048 sc1
  buffer_load_dwordx4 a[108:111], v2, s[40:43], s60 offen offset:3072 sc1
  s_add_u32 s60, s69, 0x3000
  buffer_load_dwordx4 a[112:115], v2, s[40:43], s60 offen offset:0 sc1
  buffer_load_dwordx4 a[116:119], v2, s[40:43], s60 offen offset:1024 sc1
  buffer_load_dwordx4 a[120:123], v2, s[40:43], s60 offen offset:2048 sc1
  buffer_load_dwordx4 a[124:127], v2, s[40:43], s60 offen offset:3072 sc1
  s_add_u32 s60, s69, 0x1002000
  buffer_load_dwordx4 a[128:131], v2, s[40:43], s60 offen offset:0 sc1
  buffer_load_dwordx4 a[132:135], v2, s[40:43], s60 offen offset:1024 sc1
  buffer_load_dwordx4 a[136:139], v2, s[40:43], s60 offen offset:2048 sc1
  buffer_load_dwordx4 a[140:143], v2, s[40:43], s60 offen offset:3072 sc1
  s_add_u32 s60, s69, 0x1003000
  buffer_load_dwordx4 a[144:147], v2, s[40:43], s60 offen offset:0 sc1
  buffer_load_dwordx4 a[148:151], v2, s[40:43], s60 offen offset:1024 sc1
  buffer_load_dwordx4 a[152:155], v2, s[40:43], s60 offen offset:2048 sc1
  buffer_load_dwordx4 a[156:159], v2, s[40:43], s60 offen offset:3072 sc1
  s_add_u32 s60, s69, 0x2002000
  buffer_load_dwordx4 a[160:163], v2, s[40:43], s60 offen offset:0 sc1
  buffer_load_dwordx4 a[164:167], v2, s[40:43], s60 offen offset:1024 sc1
  buffer_load_dwordx4 a[168:171], v2, s[40:43], s60 offen offset:2048 sc1
  buffer_load_dwordx4 a[172:175], v2, s[40:43], s60 offen offset:3072 sc1
  s_add_u32 s60, s69, 0x2003000
  buffer_load_dwordx4 a[176:179], v2, s[40:43], s60 offen offset:0 sc1
  buffer_load_dwordx4 a[180:183], v2, s[40:43], s60 offen offset:1024 sc1
  buffer_load_dwordx4 a[184:187], v2, s[40:43], s60 offen offset:2048 sc1
  buffer_load_dwordx4 a[188:191], v2, s[40:43], s60 offen offset:3072 sc1
  v_and_b32 v5, 15, v0
  v_lshlrev_b32 v6, 2, v5
  s_lshl_b32 s60, s56, 8
  s_add_u32 s60, s60, 0x90c0000
  buffer_load_dword v10, v6, s[40:43], s60 offen offset:0 sc1
  buffer_load_dword v11, v6, s[40:43], s60 offen offset:64 sc1
  buffer_load_dword v12, v6, s[40:43], s60 offen offset:128 sc1
  buffer_load_dword v13, v6, s[40:43], s60 offen offset:192 sc1
  s_lshl_b32 s60, s44, 12
  v_bfe_u32 v6, v0, 3, 1
  v_lshl_add_u32 v8, v6, 8, s60
  v_lshrrev_b32 v6, 4, v0
  v_lshl_add_u32 v8, v6, 6, v8
  v_lshlrev_b32 v6, 2, v6
  v_sub_u32 v5, v5, v6
  v_and_b32 v6, 7, v0
  v_lshl_add_u32 v8, v6, 3, v8
  v_lshrrev_b32 v6, 5, v0
  v_lshl_add_u32 v9, v6, 8, s60
  v_and_b32 v6, 3, v0
  v_lshl_add_u32 v9, v6, 6, v9
  v_bfe_u32 v6, v0, 2, 3
  v_lshl_add_u32 v9, v6, 3, v9
  v_mov_b32 v6, 0xff800000
  v_cmp_gt_i32 vcc, 0, v5
  v_mov_b32 v16, 0x3f803f80
  s_nop 0
  v_cndmask_b32 v20, 0, v6, vcc
  v_cmp_gt_i32 vcc, 1, v5
  v_mov_b32 v17, 0x3f803f80
  s_nop 0
  v_cndmask_b32 v21, 0, v6, vcc
  v_cmp_gt_i32 vcc, 2, v5
  v_mov_b32 v18, 0x3f803f80
  s_nop 0
  v_cndmask_b32 v22, 0, v6, vcc
  v_cmp_gt_i32 vcc, 3, v5
  v_mov_b32 v19, 0x3f803f80
  s_nop 0
  v_cndmask_b32 v23, 0, v6, vcc
  v_mov_b32 v33, 0
  v_mov_b32 v34, 0
  v_mov_b32 v37, 0
  v_mov_b32 v38, 0
  v_mov_b32 v62, 0
  v_mov_b32 v63, 0
  s_lshl_b32 s60, s62, 7
  s_add_u32 s60, s60, 0x9084000
  s_lshl_b32 s61, s56, 1
  s_add_u32 s61, s61, 2
  v_mov_b32 v3, 0
L_x_w3:
  buffer_load_dword v4, v3, s[40:43], s60 offen sc1
  s_add_u32 s59, s59, 1
  s_cmp_gt_u32 s59, 1048576
  s_cbranch_scc1 L_exit
  s_waitcnt vmcnt(0)
  v_cmp_gt_u32 vcc, s61, v4
  s_cbranch_vccnz L_x_w3
  s_lshl_b32 s70, s56, 18
  s_lshl_b32 s60, s62, 12
  s_add_u32 s70, s70, s60
  s_add_u32 s70, s70, 0x8020000
  s_add_u32 s60, s70, 0x20000
  s_lshl_b32 s71, s56, 20
  s_lshl_b32 s61, s62, 13
  s_add_u32 s71, s71, s61
  s_add_u32 s71, s71, 0x6040000
  buffer_load_dwordx4 v[192:195], v2, s[40:43], s70 offen offset:0 sc1
  buffer_load_dwordx4 v[196:199], v2, s[40:43], s70 offen offset:1024 sc1
  buffer_load_dwordx4 v[200:203], v2, s[40:43], s70 offen offset:2048 sc1
  buffer_load_dwordx4 v[204:207], v2, s[40:43], s70 offen offset:3072 sc1
  buffer_load_dwordx4 v[208:211], v2, s[40:43], s60 offen offset:0 sc1
  buffer_load_dwordx4 v[212:215], v2, s[40:43], s60 offen offset:1024 sc1
  buffer_load_dwordx4 v[216:219], v2, s[40:43], s60 offen offset:2048 sc1
  buffer_load_dwordx4 v[220:223], v2, s[40:43], s60 offen offset:3072 sc1
  v_sub_f32 v10, 1.0, v10
  v_sub_f32 v11, 1.0, v11
  v_sub_f32 v12, 1.0, v12
  v_sub_f32 v13, 1.0, v13
  v_mfma_f32_16x16x32_bf16 v[40:43], a[32:35], a[0:3], v[20:23]
  v_mfma_f32_16x16x32_bf16 v[40:43], a[40:43], a[8:11], v[40:43]
  v_mfma_f32_16x16x32_bf16 v[40:43], a[48:51], a[16:19], v[40:43]
  v_mfma_f32_16x16x32_bf16 v[40:43], a[56:59], a[24:27], v[40:43]
  v_mfma_f32_16x16x32_bf16 v[44:47], a[32:35], a[4:7], 0
  v_mfma_f32_16x16x32_bf16 v[44:47], a[40:43], a[12:15], v[44:47]
  v_mfma_f32_16x16x32_bf16 v[44:47], a[48:51], a[20:23], v[44:47]
  v_mfma_f32_16x16x32_bf16 v[44:47], a[56:59], a[28:31], v[44:47]
  v_mfma_f32_16x16x32_bf16 v[48:51], a[36:39], a[4:7], v[20:23]
  v_mfma_f32_16x16x32_bf16 v[48:51], a[44:47], a[12:15], v[48:51]
  v_mfma_f32_16x16x32_bf16 v[48:51], a[52:55], a[20:23], v[48:51]
  v_mfma_f32_16x16x32_bf16 v[48:51], a[60:63], a[28:31], v[48:51]
  s_waitcnt vmcnt(4)
  ds_write2st64_b32 v8, v192, v193 offset0:0 offset1:8
  ds_write2st64_b32 v8, v196, v197 offset0:2 offset1:10
  ds_write2st64_b32 v8, v200, v201 offset0:4 offset1:12
  ds_write2st64_b32 v8, v204, v205 offset0:6 offset1:14
  ds_read_b64_tr_b16 v[68:69], v9 offset:0
  ds_read_b64_tr_b16 v[70:71], v9 offset:2048
  ds_read_b64_tr_b16 v[72:73], v9 offset:512
  ds_read_b64_tr_b16 v[74:75], v9 offset:2560
  ds_read_b64_tr_b16 v[76:77], v9 offset:1024
  ds_read_b64_tr_b16 v[78:79], v9 offset:3072
  ds_read_b64_tr_b16 v[80:81], v9 offset:1536
  ds_read_b64_tr_b16 v[82:83], v9 offset:3584
  s_waitcnt lgkmcnt(0)
  v_mfma_f32_16x16x32_bf16 v[52:55], v[68:71], a[0:3], 0
  v_mfma_f32_16x16x32_bf16 v[52:55], v[72:75], a[8:11], v[52:55]
  v_mfma_f32_16x16x32_bf16 v[52:55], v[76:79], a[16:19], v[52:55]
  v_mfma_f32_16x16x32_bf16 v[52:55], v[80:83], a[24:27], v[52:55]
  v_mfma_f32_16x16x32_bf16 v[56:59], v[68:71], a[4:7], 0
  v_mfma_f32_16x16x32_bf16 v[56:59], v[72:75], a[12:15], v[56:59]
  v_mfma_f32_16x16x32_bf16 v[56:59], v[76:79], a[20:23], v[56:59]
  v_mfma_f32_16x16x32_bf16 v[56:59], v[80:83], a[28:31], v[56:59]
  s_nop 3
  v_max_f32 v3, v40, v41
  v_max3_f32 v3, v3, v42, v43
  v_max3_f32 v3, v3, v52, v53
  v_mov_b32 v4, v3
  s_nop 1
  v_permlane32_swap_b32 v4, v3
  v_max_f32 v3, v3, v4
  v_mov_b32 v4, v3
  s_nop 1
  v_permlane16_swap_b32 v4, v3
  v_max_f32 v3, v3, v4
  v_sub_f32 v40, v40, v3
  v_sub_f32 v41, v41, v3
  v_sub_f32 v42, v42, v3
  v_sub_f32 v43, v43, v3
  v_sub_f32 v52, v52, v3
  v_sub_f32 v53, v53, v3
  v_exp_f32 v40, v40
  v_exp_f32 v41, v41
  v_exp_f32 v42, v42
  v_exp_f32 v43, v43
  v_exp_f32 v52, v52
  v_exp_f32 v53, v53
  v_cvt_pk_bf16_f32 v60, v40, v41
  v_cvt_pk_bf16_f32 v61, v42, v43
  v_cvt_pk_bf16_f32 v32, v52, v53
  v_cvt_pk_bf16_f32 v35, v52, v53
  v_max_f32 v3, v44, v45
  v_max3_f32 v3, v3, v46, v47
  v_max3_f32 v3, v3, v48, v49
  v_max3_f32 v3, v3, v50, v51
  v_max3_f32 v3, v3, v56, v57
  v_mov_b32 v4, v3
  s_nop 1
  v_permlane32_swap_b32 v4, v3
  v_max_f32 v3, v3, v4
  v_mov_b32 v4, v3
  s_nop 1
  v_permlane16_swap_b32 v4, v3
  v_max_f32 v3, v3, v4
  v_sub_f32 v44, v44, v3
  v_sub_f32 v45, v45, v3
  v_sub_f32 v46, v46, v3
  v_sub_f32 v47, v47, v3
  v_sub_f32 v48, v48, v3
  v_sub_f32 v49, v49, v3
  v_sub_f32 v50, v50, v3
  v_sub_f32 v51, v51, v3
  v_sub_f32 v56, v56, v3
  v_sub_f32 v57, v57, v3
  v_exp_f32 v44, v44
  v_exp_f32 v45, v45
  v_exp_f32 v46, v46
  v_exp_f32 v47, v47
  v_exp_f32 v48, v48
  v_exp_f32 v49, v49
  v_exp_f32 v50, v50
  v_exp_f32 v51, v51
  v_exp_f32 v56, v56
  v_exp_f32 v57, v57
  v_cvt_pk_bf16_f32 v64, v44, v45
  v_cvt_pk_bf16_f32 v65, v46, v47
  v_cvt_pk_bf16_f32 v66, v48, v49
  v_cvt_pk_bf16_f32 v67, v50, v51
  v_cvt_pk_bf16_f32 v36, v56, v57
  v_cvt_pk_bf16_f32 v39, v56, v57
  s_nop 1
  v_mfma_f32_16x16x32_bf16 v[84:87], v[16:19], v[60:63], 0
  v_mfma_f32_16x16x32_bf16 v[88:91], v[16:19], v[64:67], 0
  v_mfma_f32_16x16x32_bf16 v[128:131], a[64:67], v[60:63], 0
  v_mfma_f32_16x16x32_bf16 v[160:163], a[64:67], v[64:67], 0
  v_mfma_f32_16x16x32_bf16 v[132:135], a[68:71], v[60:63], 0
  v_mfma_f32_16x16x32_bf16 v[164:167], a[68:71], v[64:67], 0
  v_mfma_f32_16x16x32_bf16 v[136:139], a[72:75], v[60:63], 0
  v_mfma_f32_16x16x32_bf16 v[168:171], a[72:75], v[64:67], 0
  v_mfma_f32_16x16x32_bf16 v[140:143], a[76:79], v[60:63], 0
  v_mfma_f32_16x16x32_bf16 v[172:175], a[76:79], v[64:67], 0
  v_mfma_f32_16x16x32_bf16 v[144:147], a[80:83], v[60:63], 0
  v_mfma_f32_16x16x32_bf16 v[176:179], a[80:83], v[64:67], 0
  v_mfma_f32_16x16x32_bf16 v[148:151], a[84:87], v[60:63], 0
  v_mfma_f32_16x16x32_bf16 v[180:183], a[84:87], v[64:67], 0
  v_mfma_f32_16x16x32_bf16 v[152:155], a[88:91], v[60:63], 0
  v_mfma_f32_16x16x32_bf16 v[184:187], a[88:91], v[64:67], 0
  v_mfma_f32_16x16x32_bf16 v[156:159], a[92:95], v[60:63], 0
  v_mfma_f32_16x16x32_bf16 v[188:191], a[92:95], v[64:67], 0
  v_mfma_f32_16x16x16_bf16 v[84:87], v[16:17], v[32:33], v[84:87]
  v_mfma_f32_16x16x16_bf16 v[88:91], v[16:17], v[36:37], v[88:91]
  v_mfma_f32_16x16x16_bf16 v[128:131], v[194:195], v[32:33], v[128:131]
  v_mfma_f32_16x16x16_bf16 v[132:135], v[194:195], v[34:35], v[132:135]
  v_mfma_f32_16x16x16_bf16 v[136:139], v[198:199], v[32:33], v[136:139]
  v_mfma_f32_16x16x16_bf16 v[140:143], v[198:199], v[34:35], v[140:143]
  v_mfma_f32_16x16x16_bf16 v[144:147], v[202:203], v[32:33], v[144:147]
  v_mfma_f32_16x16x16_bf16 v[148:151], v[202:203], v[34:35], v[148:151]
  v_mfma_f32_16x16x16_bf16 v[152:155], v[206:207], v[32:33], v[152:155]
  v_mfma_f32_16x16x16_bf16 v[156:159], v[206:207], v[34:35], v[156:159]
  v_mfma_f32_16x16x16_bf16 v[160:163], v[194:195], v[36:37], v[160:163]
  v_mfma_f32_16x16x16_bf16 v[164:167], v[194:195], v[38:39], v[164:167]
  v_mfma_f32_16x16x16_bf16 v[168:171], v[198:199], v[36:37], v[168:171]
  v_mfma_f32_16x16x16_bf16 v[172:175], v[198:199], v[38:39], v[172:175]
  v_mfma_f32_16x16x16_bf16 v[176:179], v[202:203], v[36:37], v[176:179]
  v_mfma_f32_16x16x16_bf16 v[180:183], v[202:203], v[38:39], v[180:183]
  v_mfma_f32_16x16x16_bf16 v[184:187], v[206:207], v[36:37], v[184:187]
  v_mfma_f32_16x16x16_bf16 v[188:191], v[206:207], v[38:39], v[188:191]
  v_rcp_f32 v3, v84
  s_nop 0
  v_mul_f32 v3, v3, v10
  v_rcp_f32 v4, v88
  s_nop 0
  v_mul_f32 v4, v4, v11
  s_add_u32 s60, s71, 0x1000
  v_mul_f32 v128, v128, v3
  v_mul_f32 v129, v129, v3
  v_mul_f32 v130, v130, v3
  v_mul_f32 v131, v131, v3
  v_mul_f32 v132, v132, v3
  v_mul_f32 v133, v133, v3
  v_mul_f32 v134, v134, v3
  v_mul_f32 v135, v135, v3
  v_cvt_pk_bf16_f32 v96, v128, v129
  v_cvt_pk_bf16_f32 v97, v130, v131
  v_cvt_pk_bf16_f32 v98, v132, v133
  v_cvt_pk_bf16_f32 v99, v134, v135
  buffer_store_dwordx4 v[96:99], v2, s[40:43], s71 offen offset:0 sc1
  v_mul_f32 v136, v136, v3
  v_mul_f32 v137, v137, v3
  v_mul_f32 v138, v138, v3
  v_mul_f32 v139, v139, v3
  v_mul_f32 v140, v140, v3
  v_mul_f32 v141, v141, v3
  v_mul_f32 v142, v142, v3
  v_mul_f32 v143, v143, v3
  v_cvt_pk_bf16_f32 v100, v136, v137
  v_cvt_pk_bf16_f32 v101, v138, v139
  v_cvt_pk_bf16_f32 v102, v140, v141
  v_cvt_pk_bf16_f32 v103, v142, v143
  buffer_store_dwordx4 v[100:103], v2, s[40:43], s71 offen offset:2048 sc1
  v_mul_f32 v144, v144, v3
  v_mul_f32 v145, v145, v3
  v_mul_f32 v146, v146, v3
  v_mul_f32 v147, v147, v3
  v_mul_f32 v148, v148, v3
  v_mul_f32 v149, v149, v3
  v_mul_f32 v150, v150, v3
  v_mul_f32 v151, v151, v3
  v_cvt_pk_bf16_f32 v104, v144, v145
  v_cvt_pk_bf16_f32 v105, v146, v147
  v_cvt_pk_bf16_f32 v106, v148, v149
  v_cvt_pk_bf16_f32 v107, v150, v151
  buffer_store_dwordx4 v[104:107], v2, s[40:43], s60 offen offset:0 sc1
  v_mul_f32 v152, v152, v3
  v_mul_f32 v153, v153, v3
  v_mul_f32 v154, v154, v3
  v_mul_f32 v155, v155, v3
  v_mul_f32 v156, v156, v3
  v_mul_f32 v157, v157, v3
  v_mul_f32 v158, v158, v3
  v_mul_f32 v159, v159, v3
  v_cvt_pk_bf16_f32 v108, v152, v153
  v_cvt_pk_bf16_f32 v109, v154, v155
  v_cvt_pk_bf16_f32 v110, v156, v157
  v_cvt_pk_bf16_f32 v111, v158, v159
  buffer_store_dwordx4 v[108:111], v2, s[40:43], s60 offen offset:2048 sc1
  v_mul_f32 v160, v160, v4
  v_mul_f32 v161, v161, v4
  v_mul_f32 v162, v162, v4
  v_mul_f32 v163, v163, v4
  v_mul_f32 v164, v164, v4
  v_mul_f32 v165, v165, v4
  v_mul_f32 v166, v166, v4
  v_mul_f32 v167, v167, v4
  v_cvt_pk_bf16_f32 v112, v160, v161
  v_cvt_pk_bf16_f32 v113, v162, v163
  v_cvt_pk_bf16_f32 v114, v164, v165
  v_cvt_pk_bf16_f32 v115, v166, v167
  buffer_store_dwordx4 v[112:115], v2, s[40:43], s71 offen offset:1024 sc1
  v_mul_f32 v168, v168, v4
  v_mul_f32 v169, v169, v4
  v_mul_f32 v170, v170, v4
  v_mul_f32 v171, v171, v4
  v_mul_f32 v172, v172, v4
  v_mul_f32 v173, v173, v4
  v_mul_f32 v174, v174, v4
  v_mul_f32 v175, v175, v4
  v_cvt_pk_bf16_f32 v116, v168, v169
  v_cvt_pk_bf16_f32 v117, v170, v171
  v_cvt_pk_bf16_f32 v118, v172, v173
  v_cvt_pk_bf16_f32 v119, v174, v175
  buffer_store_dwordx4 v[116:119], v2, s[40:43], s71 offen offset:3072 sc1
  v_mul_f32 v176, v176, v4
  v_mul_f32 v177, v177, v4
  v_mul_f32 v178, v178, v4
  v_mul_f32 v179, v179, v4
  v_mul_f32 v180, v180, v4
  v_mul_f32 v181, v181, v4
  v_mul_f32 v182, v182, v4
  v_mul_f32 v183, v183, v4
  v_cvt_pk_bf16_f32 v120, v176, v177
  v_cvt_pk_bf16_f32 v121, v178, v179
  v_cvt_pk_bf16_f32 v122, v180, v181
  v_cvt_pk_bf16_f32 v123, v182, v183
  buffer_store_dwordx4 v[120:123], v2, s[40:43], s60 offen offset:1024 sc1
  v_mul_f32 v184, v184, v4
  v_mul_f32 v185, v185, v4
  v_mul_f32 v186, v186, v4
  v_mul_f32 v187, v187, v4
  v_mul_f32 v188, v188, v4
  v_mul_f32 v189, v189, v4
  v_mul_f32 v190, v190, v4
  v_mul_f32 v191, v191, v4
  v_cvt_pk_bf16_f32 v124, v184, v185
  v_cvt_pk_bf16_f32 v125, v186, v187
  v_cvt_pk_bf16_f32 v126, v188, v189
  v_cvt_pk_bf16_f32 v127, v190, v191
  buffer_store_dwordx4 v[124:127], v2, s[40:43], s60 offen offset:3072 sc1
  s_add_u32 s71, s71, 0x80000
  v_mfma_f32_16x16x32_bf16 v[40:43], a[128:131], a[96:99], v[20:23]
  v_mfma_f32_16x16x32_bf16 v[40:43], a[136:139], a[104:107], v[40:43]
  v_mfma_f32_16x16x32_bf16 v[40:43], a[144:147], a[112:115], v[40:43]
  v_mfma_f32_16x16x32_bf16 v[40:43], a[152:155], a[120:123], v[40:43]
  v_mfma_f32_16x16x32_bf16 v[44:47], a[128:131], a[100:103], 0
  v_mfma_f32_16x16x32_bf16 v[44:47], a[136:139], a[108:111], v[44:47]
  v_mfma_f32_16x16x32_bf16 v[44:47], a[144:147], a[116:119], v[44:47]
  v_mfma_f32_16x16x32_bf16 v[44:47], a[152:155], a[124:127], v[44:47]
  v_mfma_f32_16x16x32_bf16 v[48:51], a[132:135], a[100:103], v[20:23]
  v_mfma_f32_16x16x32_bf16 v[48:51], a[140:143], a[108:111], v[48:51]
  v_mfma_f32_16x16x32_bf16 v[48:51], a[148:151], a[116:119], v[48:51]
  v_mfma_f32_16x16x32_bf16 v[48:51], a[156:159], a[124:127], v[48:51]
  s_waitcnt vmcnt(8)
  ds_write2st64_b32 v8, v208, v209 offset0:0 offset1:8
  ds_write2st64_b32 v8, v212, v213 offset0:2 offset1:10
  ds_write2st64_b32 v8, v216, v217 offset0:4 offset1:12
  ds_write2st64_b32 v8, v220, v221 offset0:6 offset1:14
  ds_read_b64_tr_b16 v[68:69], v9 offset:0
  ds_read_b64_tr_b16 v[70:71], v9 offset:2048
  ds_read_b64_tr_b16 v[72:73], v9 offset:512
  ds_read_b64_tr_b16 v[74:75], v9 offset:2560
  ds_read_b64_tr_b16 v[76:77], v9 offset:1024
  ds_read_b64_tr_b16 v[78:79], v9 offset:3072
  ds_read_b64_tr_b16 v[80:81], v9 offset:1536
  ds_read_b64_tr_b16 v[82:83], v9 offset:3584
  s_waitcnt lgkmcnt(0)
  v_mfma_f32_16x16x32_bf16 v[52:55], v[68:71], a[96:99], 0
  v_mfma_f32_16x16x32_bf16 v[52:55], v[72:75], a[104:107], v[52:55]
  v_mfma_f32_16x16x32_bf16 v[52:55], v[76:79], a[112:115], v[52:55]
  v_mfma_f32_16x16x32_bf16 v[52:55], v[80:83], a[120:123], v[52:55]
  v_mfma_f32_16x16x32_bf16 v[56:59], v[68:71], a[100:103], 0
  v_mfma_f32_16x16x32_bf16 v[56:59], v[72:75], a[108:111], v[56:59]
  v_mfma_f32_16x16x32_bf16 v[56:59], v[76:79], a[116:119], v[56:59]
  v_mfma_f32_16x16x32_bf16 v[56:59], v[80:83], a[124:127], v[56:59]
  s_nop 3
  v_max_f32 v3, v40, v41
  v_max3_f32 v3, v3, v42, v43
  v_max3_f32 v3, v3, v52, v53
  v_mov_b32 v4, v3
  s_nop 1
  v_permlane32_swap_b32 v4, v3
  v_max_f32 v3, v3, v4
  v_mov_b32 v4, v3
  s_nop 1
  v_permlane16_swap_b32 v4, v3
  v_max_f32 v3, v3, v4
  v_sub_f32 v40, v40, v3
  v_sub_f32 v41, v41, v3
  v_sub_f32 v42, v42, v3
  v_sub_f32 v43, v43, v3
  v_sub_f32 v52, v52, v3
  v_sub_f32 v53, v53, v3
  v_exp_f32 v40, v40
  v_exp_f32 v41, v41
  v_exp_f32 v42, v42
  v_exp_f32 v43, v43
  v_exp_f32 v52, v52
  v_exp_f32 v53, v53
  v_cvt_pk_bf16_f32 v60, v40, v41
  v_cvt_pk_bf16_f32 v61, v42, v43
  v_cvt_pk_bf16_f32 v32, v52, v53
  v_cvt_pk_bf16_f32 v35, v52, v53
  v_max_f32 v3, v44, v45
  v_max3_f32 v3, v3, v46, v47
  v_max3_f32 v3, v3, v48, v49
  v_max3_f32 v3, v3, v50, v51
  v_max3_f32 v3, v3, v56, v57
  v_mov_b32 v4, v3
  s_nop 1
  v_permlane32_swap_b32 v4, v3
  v_max_f32 v3, v3, v4
  v_mov_b32 v4, v3
  s_nop 1
  v_permlane16_swap_b32 v4, v3
  v_max_f32 v3, v3, v4
  v_sub_f32 v44, v44, v3
  v_sub_f32 v45, v45, v3
  v_sub_f32 v46, v46, v3
  v_sub_f32 v47, v47, v3
  v_sub_f32 v48, v48, v3
  v_sub_f32 v49, v49, v3
  v_sub_f32 v50, v50, v3
  v_sub_f32 v51, v51, v3
  v_sub_f32 v56, v56, v3
  v_sub_f32 v57, v57, v3
  v_exp_f32 v44, v44
  v_exp_f32 v45, v45
  v_exp_f32 v46, v46
  v_exp_f32 v47, v47
  v_exp_f32 v48, v48
  v_exp_f32 v49, v49
  v_exp_f32 v50, v50
  v_exp_f32 v51, v51
  v_exp_f32 v56, v56
  v_exp_f32 v57, v57
  v_cvt_pk_bf16_f32 v64, v44, v45
  v_cvt_pk_bf16_f32 v65, v46, v47
  v_cvt_pk_bf16_f32 v66, v48, v49
  v_cvt_pk_bf16_f32 v67, v50, v51
  v_cvt_pk_bf16_f32 v36, v56, v57
  v_cvt_pk_bf16_f32 v39, v56, v57
  s_nop 1
  v_mfma_f32_16x16x32_bf16 v[84:87], v[16:19], v[60:63], 0
  v_mfma_f32_16x16x32_bf16 v[88:91], v[16:19], v[64:67], 0
  v_mfma_f32_16x16x32_bf16 v[128:131], a[160:163], v[60:63], 0
  v_mfma_f32_16x16x32_bf16 v[160:163], a[160:163], v[64:67], 0
  v_mfma_f32_16x16x32_bf16 v[132:135], a[164:167], v[60:63], 0
  v_mfma_f32_16x16x32_bf16 v[164:167], a[164:167], v[64:67], 0
  v_mfma_f32_16x16x32_bf16 v[136:139], a[168:171], v[60:63], 0
  v_mfma_f32_16x16x32_bf16 v[168:171], a[168:171], v[64:67], 0
  v_mfma_f32_16x16x32_bf16 v[140:143], a[172:175], v[60:63], 0
  v_mfma_f32_16x16x32_bf16 v[172:175], a[172:175], v[64:67], 0
  v_mfma_f32_16x16x32_bf16 v[144:147], a[176:179], v[60:63], 0
  v_mfma_f32_16x16x32_bf16 v[176:179], a[176:179], v[64:67], 0
  v_mfma_f32_16x16x32_bf16 v[148:151], a[180:183], v[60:63], 0
  v_mfma_f32_16x16x32_bf16 v[180:183], a[180:183], v[64:67], 0
  v_mfma_f32_16x16x32_bf16 v[152:155], a[184:187], v[60:63], 0
  v_mfma_f32_16x16x32_bf16 v[184:187], a[184:187], v[64:67], 0
  v_mfma_f32_16x16x32_bf16 v[156:159], a[188:191], v[60:63], 0
  v_mfma_f32_16x16x32_bf16 v[188:191], a[188:191], v[64:67], 0
  v_mfma_f32_16x16x16_bf16 v[84:87], v[16:17], v[32:33], v[84:87]
  v_mfma_f32_16x16x16_bf16 v[88:91], v[16:17], v[36:37], v[88:91]
  v_mfma_f32_16x16x16_bf16 v[128:131], v[210:211], v[32:33], v[128:131]
  v_mfma_f32_16x16x16_bf16 v[132:135], v[210:211], v[34:35], v[132:135]
  v_mfma_f32_16x16x16_bf16 v[136:139], v[214:215], v[32:33], v[136:139]
  v_mfma_f32_16x16x16_bf16 v[140:143], v[214:215], v[34:35], v[140:143]
  v_mfma_f32_16x16x16_bf16 v[144:147], v[218:219], v[32:33], v[144:147]
  v_mfma_f32_16x16x16_bf16 v[148:151], v[218:219], v[34:35], v[148:151]
  v_mfma_f32_16x16x16_bf16 v[152:155], v[222:223], v[32:33], v[152:155]
  v_mfma_f32_16x16x16_bf16 v[156:159], v[222:223], v[34:35], v[156:159]
  v_mfma_f32_16x16x16_bf16 v[160:163], v[210:211], v[36:37], v[160:163]
  v_mfma_f32_16x16x16_bf16 v[164:167], v[210:211], v[38:39], v[164:167]
  v_mfma_f32_16x16x16_bf16 v[168:171], v[214:215], v[36:37], v[168:171]
  v_mfma_f32_16x16x16_bf16 v[172:175], v[214:215], v[38:39], v[172:175]
  v_mfma_f32_16x16x16_bf16 v[176:179], v[218:219], v[36:37], v[176:179]
  v_mfma_f32_16x16x16_bf16 v[180:183], v[218:219], v[38:39], v[180:183]
  v_mfma_f32_16x16x16_bf16 v[184:187], v[222:223], v[36:37], v[184:187]
  v_mfma_f32_16x16x16_bf16 v[188:191], v[222:223], v[38:39], v[188:191]
  v_rcp_f32 v3, v84
  s_nop 0
  v_mul_f32 v3, v3, v12
  v_rcp_f32 v4, v88
  s_nop 0
  v_mul_f32 v4, v4, v13
  s_add_u32 s60, s71, 0x1000
  v_mul_f32 v128, v128, v3
  v_mul_f32 v129, v129, v3
  v_mul_f32 v130, v130, v3
  v_mul_f32 v131, v131, v3
  v_mul_f32 v132, v132, v3
  v_mul_f32 v133, v133, v3
  v_mul_f32 v134, v134, v3
  v_mul_f32 v135, v135, v3
  v_cvt_pk_bf16_f32 v96, v128, v129
  v_cvt_pk_bf16_f32 v97, v130, v131
  v_cvt_pk_bf16_f32 v98, v132, v133
  v_cvt_pk_bf16_f32 v99, v134, v135
  buffer_store_dwordx4 v[96:99], v2, s[40:43], s71 offen offset:0 sc1
  v_mul_f32 v136, v136, v3
  v_mul_f32 v137, v137, v3
  v_mul_f32 v138, v138, v3
  v_mul_f32 v139, v139, v3
  v_mul_f32 v140, v140, v3
  v_mul_f32 v141, v141, v3
  v_mul_f32 v142, v142, v3
  v_mul_f32 v143, v143, v3
  v_cvt_pk_bf16_f32 v100, v136, v137
  v_cvt_pk_bf16_f32 v101, v138, v139
  v_cvt_pk_bf16_f32 v102, v140, v141
  v_cvt_pk_bf16_f32 v103, v142, v143
  buffer_store_dwordx4 v[100:103], v2, s[40:43], s71 offen offset:2048 sc1
  v_mul_f32 v144, v144, v3
  v_mul_f32 v145, v145, v3
  v_mul_f32 v146, v146, v3
  v_mul_f32 v147, v147, v3
  v_mul_f32 v148, v148, v3
  v_mul_f32 v149, v149, v3
  v_mul_f32 v150, v150, v3
  v_mul_f32 v151, v151, v3
  v_cvt_pk_bf16_f32 v104, v144, v145
  v_cvt_pk_bf16_f32 v105, v146, v147
  v_cvt_pk_bf16_f32 v106, v148, v149
  v_cvt_pk_bf16_f32 v107, v150, v151
  buffer_store_dwordx4 v[104:107], v2, s[40:43], s60 offen offset:0 sc1
  v_mul_f32 v152, v152, v3
  v_mul_f32 v153, v153, v3
  v_mul_f32 v154, v154, v3
  v_mul_f32 v155, v155, v3
  v_mul_f32 v156, v156, v3
  v_mul_f32 v157, v157, v3
  v_mul_f32 v158, v158, v3
  v_mul_f32 v159, v159, v3
  v_cvt_pk_bf16_f32 v108, v152, v153
  v_cvt_pk_bf16_f32 v109, v154, v155
  v_cvt_pk_bf16_f32 v110, v156, v157
  v_cvt_pk_bf16_f32 v111, v158, v159
  buffer_store_dwordx4 v[108:111], v2, s[40:43], s60 offen offset:2048 sc1
  v_mul_f32 v160, v160, v4
  v_mul_f32 v161, v161, v4
  v_mul_f32 v162, v162, v4
  v_mul_f32 v163, v163, v4
  v_mul_f32 v164, v164, v4
  v_mul_f32 v165, v165, v4
  v_mul_f32 v166, v166, v4
  v_mul_f32 v167, v167, v4
  v_cvt_pk_bf16_f32 v112, v160, v161
  v_cvt_pk_bf16_f32 v113, v162, v163
  v_cvt_pk_bf16_f32 v114, v164, v165
  v_cvt_pk_bf16_f32 v115, v166, v167
  buffer_store_dwordx4 v[112:115], v2, s[40:43], s71 offen offset:1024 sc1
  v_mul_f32 v168, v168, v4
  v_mul_f32 v169, v169, v4
  v_mul_f32 v170, v170, v4
  v_mul_f32 v171, v171, v4
  v_mul_f32 v172, v172, v4
  v_mul_f32 v173, v173, v4
  v_mul_f32 v174, v174, v4
  v_mul_f32 v175, v175, v4
  v_cvt_pk_bf16_f32 v116, v168, v169
  v_cvt_pk_bf16_f32 v117, v170, v171
  v_cvt_pk_bf16_f32 v118, v172, v173
  v_cvt_pk_bf16_f32 v119, v174, v175
  buffer_store_dwordx4 v[116:119], v2, s[40:43], s71 offen offset:3072 sc1
  v_mul_f32 v176, v176, v4
  v_mul_f32 v177, v177, v4
  v_mul_f32 v178, v178, v4
  v_mul_f32 v179, v179, v4
  v_mul_f32 v180, v180, v4
  v_mul_f32 v181, v181, v4
  v_mul_f32 v182, v182, v4
  v_mul_f32 v183, v183, v4
  v_cvt_pk_bf16_f32 v120, v176, v177
  v_cvt_pk_bf16_f32 v121, v178, v179
  v_cvt_pk_bf16_f32 v122, v180, v181
  v_cvt_pk_bf16_f32 v123, v182, v183
  buffer_store_dwordx4 v[120:123], v2, s[40:43], s60 offen offset:1024 sc1
  v_mul_f32 v184, v184, v4
  v_mul_f32 v185, v185, v4
  v_mul_f32 v186, v186, v4
  v_mul_f32 v187, v187, v4
  v_mul_f32 v188, v188, v4
  v_mul_f32 v189, v189, v4
  v_mul_f32 v190, v190, v4
  v_mul_f32 v191, v191, v4
  v_cvt_pk_bf16_f32 v124, v184, v185
  v_cvt_pk_bf16_f32 v125, v186, v187
  v_cvt_pk_bf16_f32 v126, v188, v189
  v_cvt_pk_bf16_f32 v127, v190, v191
  buffer_store_dwordx4 v[124:127], v2, s[40:43], s60 offen offset:3072 sc1
  s_lshl_b32 s60, s56, 7
  s_add_u32 s60, s60, 0x9087000
  s_cmp_eq_u32 s44, 0
  s_cselect_b32 s60, s60, 0x40000000
  v_mov_b32 v3, 1
  s_waitcnt vmcnt(0)
  s_barrier
  s_mov_b64 exec, 1
  buffer_atomic_add v3, v2, s[40:43], s60 offen
  s_mov_b64 exec, -1
  s_cmp_eq_u32 s58, 1
  s_cselect_b32 s67, 0, 1
L_o_half:
  s_cmp_eq_u32 s67, 0
  s_cselect_b64 s[48:49], s[18:19], s[30:31]
  s_and_b32 s49, s49, 0xffff
  s_mov_b32 s50, 0x400000
  s_mov_b32 s51, 0x20000
  s_lshr_b32 s60, s56, 2
  s_lshl_b32 s60, s60, 7
  s_add_u32 s60, s60, 0x9086000
  s_lshl_b32 s61, s56, 7
  s_add_u32 s61, s61, 0x9087000
  s_cmp_eq_u32 s67, 0
  s_cselect_b32 s62, s60, s61
  s_cselect_b32 s61, 32, 8
  s_lshl_b32 s63, s44, 20
  s_lshl_b32 s60, s57, 7
  s_add_u32 s63, s63, s60
  s_lshl_b32 s64, s56, 20
  s_lshl_b32 s60, s67, 2
  s_add_u32 s60, s60, s44
  s_lshl_b32 s60, s60, 16
  s_add_u32 s64, s64, s60
  s_add_u32 s64, s64, 0x6000000
  s_lshl_b32 s65, s44, 15
  s_mov_b32 s68, 8
  s_mov_b32 s66, 0
  v_lshrrev_b32 v5, 4, v0
  v_lshlrev_b32 v5, 1, v5
  v_and_b32 v6, 7, v0
  v_xor_b32 v5, v5, v6
  v_lshlrev_b32 v5, 4, v5
  v_lshrrev_b32 v6, 3, v0
  v_lshl_add_u32 v8, v6, 10, v5
  v_lshrrev_b32 v5, 2, v0
  v_lshl_add_u32 v12, v5, 7, s65
  v_bfe_u32 v5, v0, 3, 2
  v_lshl_add_u32 v12, v5, 5, v12
  v_and_b32 v5, 3, v0
  v_lshl_add_u32 v12, v5, 3, v12
  v_xor_b32 v13, 32, v12
  v_xor_b32 v14, 64, v12
  v_xor_b32 v15, 96, v12
  v_mov_b32 v3, 0
L_o_w:
  buffer_load_dword v4, v3, s[40:43], s62 offen sc1
  s_add_u32 s59, s59, 1
  s_cmp_gt_u32 s59, 1048576
  s_cbranch_scc1 L_exit
  s_waitcnt vmcnt(0)
  v_cmp_gt_u32 vcc, s61, v4
  s_cbranch_vccnz L_o_w
  s_add_u32 m0, s65, 0
  s_add_u32 s60, s63, 0
  buffer_load_dwordx4 v8, s[48:51], s60 offen lds
  s_add_u32 m0, s65, 1024
  s_add_u32 s60, s63, 8192
  buffer_load_dwordx4 v8, s[48:51], s60 offen lds
  s_add_u32 m0, s65, 2048
  s_add_u32 s60, s63, 16384
  buffer_load_dwordx4 v8, s[48:51], s60 offen lds
  s_add_u32 m0, s65, 3072
  s_add_u32 s60, s63, 24576
  buffer_load_dwordx4 v8, s[48:51], s60 offen lds
  s_add_u32 m0, s65, 4096
  s_add_u32 s60, s63, 32768
  buffer_load_dwordx4 v8, s[48:51], s60 offen lds
  s_add_u32 m0, s65, 5120
  s_add_u32 s60, s63, 40960
  buffer_load_dwordx4 v8, s[48:51], s60 offen lds
  s_add_u32 m0, s65, 6144
  s_add_u32 s60, s63, 49152
  buffer_load_dwordx4 v8, s[48:51], s60 offen lds
  s_add_u32 m0, s65, 7168
  s_add_u32 s60, s63, 57344
  buffer_load_dwordx4 v8, s[48:51], s60 offen lds
  s_add_u32 s60, s64, 0x0
  buffer_load_dwordx4 v[128:131], v2, s[40:43], s60 offen offset:0 sc1
  buffer_load_dwordx4 v[132:135], v2, s[40:43], s60 offen offset:1024 sc1
  buffer_load_dwordx4 v[136:139], v2, s[40:43], s60 offen offset:2048 sc1
  buffer_load_dwordx4 v[140:143], v2, s[40:43], s60 offen offset:3072 sc1
  s_add_u32 s60, s64, 0x80000
  buffer_load_dwordx4 v[144:147], v2, s[40:43], s60 offen offset:0 sc1
  buffer_load_dwordx4 v[148:151], v2, s[40:43], s60 offen offset:1024 sc1
  buffer_load_dwordx4 v[152:155], v2, s[40:43], s60 offen offset:2048 sc1
  buffer_load_dwordx4 v[156:159], v2, s[40:43], s60 offen offset:3072 sc1
  s_add_u32 m0, s65, 8192
  s_add_u32 s60, s63, 65536
  buffer_load_dwordx4 v8, s[48:51], s60 offen lds
  s_add_u32 m0, s65, 9216
  s_add_u32 s60, s63, 73728
  buffer_load_dwordx4 v8, s[48:51], s60 offen lds
  s_add_u32 m0, s65, 10240
  s_add_u32 s60, s63, 81920
  buffer_load_dwordx4 v8, s[48:51], s60 offen lds
  s_add_u32 m0, s65, 11264
  s_add_u32 s60, s63, 90112
  buffer_load_dwordx4 v8, s[48:51], s60 offen lds
  s_add_u32 m0, s65, 12288
  s_add_u32 s60, s63, 98304
  buffer_load_dwordx4 v8, s[48:51], s60 offen lds
  s_add_u32 m0, s65, 13312
  s_add_u32 s60, s63, 106496
  buffer_load_dwordx4 v8, s[48:51], s60 offen lds
  s_add_u32 m0, s65, 14336
  s_add_u32 s60, s63, 114688
  buffer_load_dwordx4 v8, s[48:51], s60 offen lds
  s_add_u32 m0, s65, 15360
  s_add_u32 s60, s63, 122880
  buffer_load_dwordx4 v8, s[48:51], s60 offen lds
  s_add_u32 s60, s64, 0x1000
  buffer_load_dwordx4 v[160:163], v2, s[40:43], s60 offen offset:0 sc1
  buffer_load_dwordx4 v[164:167], v2, s[40:43], s60 offen offset:1024 sc1
  buffer_load_dwordx4 v[168:171], v2, s[40:43], s60 offen offset:2048 sc1
  buffer_load_dwordx4 v[172:175], v2, s[40:43], s60 offen offset:3072 sc1
  s_add_u32 s60, s64, 0x81000
  buffer_load_dwordx4 v[176:179], v2, s[40:43], s60 offen offset:0 sc1
  buffer_load_dwordx4 v[180:183], v2, s[40:43], s60 offen offset:1024 sc1
  buffer_load_dwordx4 v[184:187], v2, s[40:43], s60 offen offset:2048 sc1
  buffer_load_dwordx4 v[188:191], v2, s[40:43], s60 offen offset:3072 sc1
  s_add_u32 s63, s63, 0x20000
  s_add_u32 s64, s64, 0x2000
  s_sub_u32 s68, s68, 1
  s_cmp_eq_u32 s68, 0
  s_cselect_b32 s63, 0x40000000, s63
  s_cselect_b32 s64, 0x40000000, s64
  s_add_u32 m0, s65, 16384
  s_add_u32 s60, s63, 0
  buffer_load_dwordx4 v8, s[48:51], s60 offen lds
  s_add_u32 m0, s65, 17408
  s_add_u32 s60, s63, 8192
  buffer_load_dwordx4 v8, s[48:51], s60 offen lds
  s_add_u32 m0, s65, 18432
  s_add_u32 s60, s63, 16384
  buffer_load_dwordx4 v8, s[48:51], s60 offen lds
  s_add_u32 m0, s65, 19456
  s_add_u32 s60, s63, 24576
  buffer_load_dwordx4 v8, s[48:51], s60 offen lds
  s_add_u32 m0, s65, 20480
  s_add_u32 s60, s63, 32768
  buffer_load_dwordx4 v8, s[48:51], s60 offen lds
  s_add_u32 m0, s65, 21504
  s_add_u32 s60, s63, 40960
  buffer_load_dwordx4 v8, s[48:51], s60 offen lds
  s_add_u32 m0, s65, 22528
  s_add_u32 s60, s63, 49152
  buffer_load_dwordx4 v8, s[48:51], s60 offen lds
  s_add_u32 m0, s65, 23552
  s_add_u32 s60, s63, 57344
  buffer_load_dwordx4 v8, s[48:51], s60 offen lds
  s_add_u32 s60, s64, 0x0
  buffer_load_dwordx4 v[192:195], v2, s[40:43], s60 offen offset:0 sc1
  buffer_load_dwordx4 v[196:199], v2, s[40:43], s60 offen offset:1024 sc1
  buffer_load_dwordx4 v[200:203], v2, s[40:43], s60 offen offset:2048 sc1
  buffer_load_dwordx4 v[204:207], v2, s[40:43], s60 offen offset:3072 sc1
  s_add_u32 s60, s64, 0x80000
  buffer_load_dwordx4 v[208:211], v2, s[40:43], s60 offen offset:0 sc1
  buffer_load_dwordx4 v[212:215], v2, s[40:43], s60 offen offset:1024 sc1
  buffer_load_dwordx4 v[216:219], v2, s[40:43], s60 offen offset:2048 sc1
  buffer_load_dwordx4 v[220:223], v2, s[40:43], s60 offen offset:3072 sc1
L_o_loop:
  s_waitcnt vmcnt(32)
  ds_read_b64_tr_b16 v[32:33], v12 offset:0
  ds_read_b64_tr_b16 v[34:35], v12 offset:2048
  ds_read_b64_tr_b16 v[36:37], v13 offset:0
  ds_read_b64_tr_b16 v[38:39], v13 offset:2048
  ds_read_b64_tr_b16 v[40:41], v14 offset:0
  ds_read_b64_tr_b16 v[42:43], v14 offset:2048
  ds_read_b64_tr_b16 v[44:45], v15 offset:0
  ds_read_b64_tr_b16 v[46:47], v15 offset:2048
  ds_read_b64_tr_b16 v[48:49], v12 offset:4096
  ds_read_b64_tr_b16 v[50:51], v12 offset:6144
  ds_read_b64_tr_b16 v[52:53], v13 offset:4096
  ds_read_b64_tr_b16 v[54:55], v13 offset:6144
  ds_read_b64_tr_b16 v[56:57], v14 offset:4096
  ds_read_b64_tr_b16 v[58:59], v14 offset:6144
  ds_read_b64_tr_b16 v[60:61], v15 offset:4096
  ds_read_b64_tr_b16 v[62:63], v15 offset:6144
  s_add_u32 m0, s65, 24576
  s_add_u32 s60, s63, 65536
  buffer_load_dwordx4 v8, s[48:51], s60 offen lds
  s_add_u32 m0, s65, 25600
  s_add_u32 s60, s63, 73728
  buffer_load_dwordx4 v8, s[48:51], s60 offen lds
  s_waitcnt lgkmcnt(8)
  v_mfma_f32_16x16x32_bf16 a[192:195], v[32:35], v[128:131], a[192:195]
  s_add_u32 m0, s65, 26624
  s_add_u32 s60, s63, 81920
  v_mfma_f32_16x16x32_bf16 a[208:211], v[32:35], v[132:135], a[208:211]
  buffer_load_dwordx4 v8, s[48:51], s60 offen lds
  s_add_u32 m0, s65, 27648
  v_mfma_f32_16x16x32_bf16 a[224:227], v[32:35], v[144:147], a[224:227]
  s_add_u32 s60, s63, 90112
  buffer_load_dwordx4 v8, s[48:51], s60 offen lds
  v_mfma_f32_16x16x32_bf16 a[240:243], v[32:35], v[148:151], a[240:243]
  s_add_u32 m0, s65, 28672
  s_add_u32 s60, s63, 98304
  v_mfma_f32_16x16x32_bf16 a[196:199], v[36:39], v[128:131], a[196:199]
  buffer_load_dwordx4 v8, s[48:51], s60 offen lds
  s_add_u32 m0, s65, 29696
  v_mfma_f32_16x16x32_bf16 a[212:215], v[36:39], v[132:135], a[212:215]
  s_add_u32 s60, s63, 106496
  buffer_load_dwordx4 v8, s[48:51], s60 offen lds
  v_mfma_f32_16x16x32_bf16 a[228:231], v[36:39], v[144:147], a[228:231]
  s_add_u32 m0, s65, 30720
  s_add_u32 s60, s63, 114688
  v_mfma_f32_16x16x32_bf16 a[244:247], v[36:39], v[148:151], a[244:247]
  buffer_load_dwordx4 v8, s[48:51], s60 offen lds
  s_add_u32 m0, s65, 31744
  v_mfma_f32_16x16x32_bf16 a[200:203], v[40:43], v[128:131], a[200:203]
  s_add_u32 s60, s63, 122880
  buffer_load_dwordx4 v8, s[48:51], s60 offen lds
  v_mfma_f32_16x16x32_bf16 a[216:219], v[40:43], v[132:135], a[216:219]
  s_add_u32 s60, s64, 0x1000
  buffer_load_dwordx4 v[224:227], v2, s[40:43], s60 offen offset:0 sc1
  v_mfma_f32_16x16x32_bf16 a[232:235], v[40:43], v[144:147], a[232:235]
  buffer_load_dwordx4 v[228:231], v2, s[40:43], s60 offen offset:1024 sc1
  buffer_load_dwordx4 v[232:235], v2, s[40:43], s60 offen offset:2048 sc1
  v_mfma_f32_16x16x32_bf16 a[248:251], v[40:43], v[148:151], a[248:251]
  buffer_load_dwordx4 v[236:239], v2, s[40:43], s60 offen offset:3072 sc1
  s_add_u32 s60, s64, 0x81000
  v_mfma_f32_16x16x32_bf16 a[204:207], v[44:47], v[128:131], a[204:207]
  buffer_load_dwordx4 v[240:243], v2, s[40:43], s60 offen offset:0 sc1
  buffer_load_dwordx4 v[244:247], v2, s[40:43], s60 offen offset:1024 sc1
  v_mfma_f32_16x16x32_bf16 a[220:223], v[44:47], v[132:135], a[220:223]
  buffer_load_dwordx4 v[248:251], v2, s[40:43], s60 offen offset:2048 sc1
  buffer_load_dwordx4 v[252:255], v2, s[40:43], s60 offen offset:3072 sc1
  v_mfma_f32_16x16x32_bf16 a[236:239], v[44:47], v[144:147], a[236:239]
  s_add_u32 s63, s63, 0x20000
  s_add_u32 s64, s64, 0x2000
  v_mfma_f32_16x16x32_bf16 a[252:255], v[44:47], v[148:151], a[252:255]
  s_sub_u32 s68, s68, 1
  s_cmp_eq_u32 s68, 0
  s_waitcnt lgkmcnt(0)
  v_mfma_f32_16x16x32_bf16 a[192:195], v[48:51], v[136:139], a[192:195]
  s_cselect_b32 s63, 0x40000000, s63
  s_cselect_b32 s64, 0x40000000, s64
  v_mfma_f32_16x16x32_bf16 a[208:211], v[48:51], v[140:143], a[208:211]
  v_mfma_f32_16x16x32_bf16 a[224:227], v[48:51], v[152:155], a[224:227]
  v_mfma_f32_16x16x32_bf16 a[240:243], v[48:51], v[156:159], a[240:243]
  v_mfma_f32_16x16x32_bf16 a[196:199], v[52:55], v[136:139], a[196:199]
  v_mfma_f32_16x16x32_bf16 a[212:215], v[52:55], v[140:143], a[212:215]
  v_mfma_f32_16x16x32_bf16 a[228:231], v[52:55], v[152:155], a[228:231]
  v_mfma_f32_16x16x32_bf16 a[244:247], v[52:55], v[156:159], a[244:247]
  v_mfma_f32_16x16x32_bf16 a[200:203], v[56:59], v[136:139], a[200:203]
  v_mfma_f32_16x16x32_bf16 a[216:219], v[56:59], v[140:143], a[216:219]
  v_mfma_f32_16x16x32_bf16 a[232:235], v[56:59], v[152:155], a[232:235]
  v_mfma_f32_16x16x32_bf16 a[248:251], v[56:59], v[156:159], a[248:251]
  v_mfma_f32_16x16x32_bf16 a[204:207], v[60:63], v[136:139], a[204:207]
  v_mfma_f32_16x16x32_bf16 a[220:223], v[60:63], v[140:143], a[220:223]
  v_mfma_f32_16x16x32_bf16 a[236:239], v[60:63], v[152:155], a[236:239]
  v_mfma_f32_16x16x32_bf16 a[252:255], v[60:63], v[156:159], a[252:255]
  s_waitcnt vmcnt(32)
  ds_read_b64_tr_b16 v[64:65], v12 offset:8192
  ds_read_b64_tr_b16 v[66:67], v12 offset:10240
  ds_read_b64_tr_b16 v[68:69], v13 offset:8192
  ds_read_b64_tr_b16 v[70:71], v13 offset:10240
  ds_read_b64_tr_b16 v[72:73], v14 offset:8192
  ds_read_b64_tr_b16 v[74:75], v14 offset:10240
  ds_read_b64_tr_b16 v[76:77], v15 offset:8192
  ds_read_b64_tr_b16 v[78:79], v15 offset:10240
  ds_read_b64_tr_b16 v[80:81], v12 offset:12288
  ds_read_b64_tr_b16 v[82:83], v12 offset:14336
  ds_read_b64_tr_b16 v[84:85], v13 offset:12288
  ds_read_b64_tr_b16 v[86:87], v13 offset:14336
  ds_read_b64_tr_b16 v[88:89], v14 offset:12288
  ds_read_b64_tr_b16 v[90:91], v14 offset:14336
  ds_read_b64_tr_b16 v[92:93], v15 offset:12288
  ds_read_b64_tr_b16 v[94:95], v15 offset:14336
  s_add_u32 m0, s65, 0
  s_add_u32 s60, s63, 0
  buffer_load_dwordx4 v8, s[48:51], s60 offen lds
  s_add_u32 m0, s65, 1024
  s_add_u32 s60, s63, 8192
  buffer_load_dwordx4 v8, s[48:51], s60 offen lds
  s_waitcnt lgkmcnt(8)
  v_mfma_f32_16x16x32_bf16 a[192:195], v[64:67], v[160:163], a[192:195]
  s_add_u32 m0, s65, 2048
  s_add_u32 s60, s63, 16384
  v_mfma_f32_16x16x32_bf16 a[208:211], v[64:67], v[164:167], a[208:211]
  buffer_load_dwordx4 v8, s[48:51], s60 offen lds
  s_add_u32 m0, s65, 3072
  v_mfma_f32_16x16x32_bf16 a[224:227], v[64:67], v[176:179], a[224:227]
  s_add_u32 s60, s63, 24576
  buffer_load_dwordx4 v8, s[48:51], s60 offen lds
  v_mfma_f32_16x16x32_bf16 a[240:243], v[64:67], v[180:183], a[240:243]
  s_add_u32 m0, s65, 4096
  s_add_u32 s60, s63, 32768
  v_mfma_f32_16x16x32_bf16 a[196:199], v[68:71], v[160:163], a[196:199]
  buffer_load_dwordx4 v8, s[48:51], s60 offen lds
  s_add_u32 m0, s65, 5120
  v_mfma_f32_16x16x32_bf16 a[212:215], v[68:71], v[164:167], a[212:215]
  s_add_u32 s60, s63, 40960
  buffer_load_dwordx4 v8, s[48:51], s60 offen lds
  v_mfma_f32_16x16x32_bf16 a[228:231], v[68:71], v[176:179], a[228:231]
  s_add_u32 m0, s65, 6144
  s_add_u32 s60, s63, 49152
  v_mfma_f32_16x16x32_bf16 a[244:247], v[68:71], v[180:183], a[244:247]
  buffer_load_dwordx4 v8, s[48:51], s60 offen lds
  s_add_u32 m0, s65, 7168
  v_mfma_f32_16x16x32_bf16 a[200:203], v[72:75], v[160:163], a[200:203]
  s_add_u32 s60, s63, 57344
  buffer_load_dwordx4 v8, s[48:51], s60 offen lds
  v_mfma_f32_16x16x32_bf16 a[216:219], v[72:75], v[164:167], a[216:219]
  s_add_u32 s60, s64, 0x0
  buffer_load_dwordx4 v[128:131], v2, s[40:43], s60 offen offset:0 sc1
  v_mfma_f32_16x16x32_bf16 a[232:235], v[72:75], v[176:179], a[232:235]
  buffer_load_dwordx4 v[132:135], v2, s[40:43], s60 offen offset:1024 sc1
  buffer_load_dwordx4 v[136:139], v2, s[40:43], s60 offen offset:2048 sc1
  v_mfma_f32_16x16x32_bf16 a[248:251], v[72:75], v[180:183], a[248:251]
  buffer_load_dwordx4 v[140:143], v2, s[40:43], s60 offen offset:3072 sc1
  s_add_u32 s60, s64, 0x80000
  v_mfma_f32_16x16x32_bf16 a[204:207], v[76:79], v[160:163], a[204:207]
  buffer_load_dwordx4 v[144:147], v2, s[40:43], s60 offen offset:0 sc1
  buffer_load_dwordx4 v[148:151], v2, s[40:43], s60 offen offset:1024 sc1
  v_mfma_f32_16x16x32_bf16 a[220:223], v[76:79], v[164:167], a[220:223]
  buffer_load_dwordx4 v[152:155], v2, s[40:43], s60 offen offset:2048 sc1
  buffer_load_dwordx4 v[156:159], v2, s[40:43], s60 offen offset:3072 sc1
  v_mfma_f32_16x16x32_bf16 a[236:239], v[76:79], v[176:179], a[236:239]
  v_mfma_f32_16x16x32_bf16 a[252:255], v[76:79], v[180:183], a[252:255]
  s_waitcnt lgkmcnt(0)
  v_mfma_f32_16x16x32_bf16 a[192:195], v[80:83], v[168:171], a[192:195]
  v_mfma_f32_16x16x32_bf16 a[208:211], v[80:83], v[172:175], a[208:211]
  v_mfma_f32_16x16x32_bf16 a[224:227], v[80:83], v[184:187], a[224:227]
  v_mfma_f32_16x16x32_bf16 a[240:243], v[80:83], v[188:191], a[240:243]
  v_mfma_f32_16x16x32_bf16 a[196:199], v[84:87], v[168:171], a[196:199]
  v_mfma_f32_16x16x32_bf16 a[212:215], v[84:87], v[172:175], a[212:215]
  v_mfma_f32_16x16x32_bf16 a[228:231], v[84:87], v[184:187], a[228:231]
  v_mfma_f32_16x16x32_bf16 a[244:247], v[84:87], v[188:191], a[244:247]
  v_mfma_f32_16x16x32_bf16 a[200:203], v[88:91], v[168:171], a[200:203]
  v_mfma_f32_16x16x32_bf16 a[216:219], v[88:91], v[172:175], a[216:219]
  v_mfma_f32_16x16x32_bf16 a[232:235], v[88:91], v[184:187], a[232:235]
  v_mfma_f32_16x16x32_bf16 a[248:251], v[88:91], v[188:191], a[248:251]
  v_mfma_f32_16x16x32_bf16 a[204:207], v[92:95], v[168:171], a[204:207]
  v_mfma_f32_16x16x32_bf16 a[220:223], v[92:95], v[172:175], a[220:223]
  v_mfma_f32_16x16x32_bf16 a[236:239], v[92:95], v[184:187], a[236:239]
  v_mfma_f32_16x16x32_bf16 a[252:255], v[92:95], v[188:191], a[252:255]
  s_waitcnt vmcnt(32)
  ds_read_b64_tr_b16 v[32:33], v12 offset:16384
  ds_read_b64_tr_b16 v[34:35], v12 offset:18432
  ds_read_b64_tr_b16 v[36:37], v13 offset:16384
  ds_read_b64_tr_b16 v[38:39], v13 offset:18432
  ds_read_b64_tr_b16 v[40:41], v14 offset:16384
  ds_read_b64_tr_b16 v[42:43], v14 offset:18432
  ds_read_b64_tr_b16 v[44:45], v15 offset:16384
  ds_read_b64_tr_b16 v[46:47], v15 offset:18432
  ds_read_b64_tr_b16 v[48:49], v12 offset:20480
  ds_read_b64_tr_b16 v[50:51], v12 offset:22528
  ds_read_b64_tr_b16 v[52:53], v13 offset:20480
  ds_read_b64_tr_b16 v[54:55], v13 offset:22528
  ds_read_b64_tr_b16 v[56:57], v14 offset:20480
  ds_read_b64_tr_b16 v[58:59], v14 offset:22528
  ds_read_b64_tr_b16 v[60:61], v15 offset:20480
  ds_read_b64_tr_b16 v[62:63], v15 offset:22528
  s_add_u32 m0, s65, 8192
  s_add_u32 s60, s63, 65536
  buffer_load_dwordx4 v8, s[48:51], s60 offen lds
  s_add_u32 m0, s65, 9216
  s_add_u32 s60, s63, 73728
  buffer_load_dwordx4 v8, s[48:51], s60 offen lds
  s_waitcnt lgkmcnt(8)
  v_mfma_f32_16x16x32_bf16 a[192:195], v[32:35], v[192:195], a[192:195]
  s_add_u32 m0, s65, 10240
  s_add_u32 s60, s63, 81920
  v_mfma_f32_16x16x32_bf16 a[208:211], v[32:35], v[196:199], a[208:211]
  buffer_load_dwordx4 v8, s[48:51], s60 offen lds
  s_add_u32 m0, s65, 11264
  v_mfma_f32_16x16x32_bf16 a[224:227], v[32:35], v[208:211], a[224:227]
  s_add_u32 s60, s63, 90112
  buffer_load_dwordx4 v8, s[48:51], s60 offen lds
  v_mfma_f32_16x16x32_bf16 a[240:243], v[32:35], v[212:215], a[240:243]
  s_add_u32 m0, s65, 12288
  s_add_u32 s60, s63, 98304
  v_mfma_f32_16x16x32_bf16 a[196:199], v[36:39], v[192:195], a[196:199]
  buffer_load_dwordx4 v8, s[48:51], s60 offen lds
  s_add_u32 m0, s65, 13312
  v_mfma_f32_16x16x32_bf16 a[212:215], v[36:39], v[196:199], a[212:215]
  s_add_u32 s60, s63, 106496
  buffer_load_dwordx4 v8, s[48:51], s60 offen lds
  v_mfma_f32_16x16x32_bf16 a[228:231], v[36:39], v[208:211], a[228:231]
  s_add_u32 m0, s65, 14336
  s_add_u32 s60, s63, 114688
  v_mfma_f32_16x16x32_bf16 a[244:247], v[36:39], v[212:215], a[244:247]
  buffer_load_dwordx4 v8, s[48:51], s60 offen lds
  s_add_u32 m0, s65, 15360
  v_mfma_f32_16x16x32_bf16 a[200:203], v[40:43], v[192:195], a[200:203]
  s_add_u32 s60, s63, 122880
  buffer_load_dwordx4 v8, s[48:51], s60 offen lds
  v_mfma_f32_16x16x32_bf16 a[216:219], v[40:43], v[196:199], a[216:219]
  s_add_u32 s60, s64, 0x1000
  buffer_load_dwordx4 v[160:163], v2, s[40:43], s60 offen offset:0 sc1
  v_mfma_f32_16x16x32_bf16 a[232:235], v[40:43], v[208:211], a[232:235]
  buffer_load_dwordx4 v[164:167], v2, s[40:43], s60 offen offset:1024 sc1
  buffer_load_dwordx4 v[168:171], v2, s[40:43], s60 offen offset:2048 sc1
  v_mfma_f32_16x16x32_bf16 a[248:251], v[40:43], v[212:215], a[248:251]
  buffer_load_dwordx4 v[172:175], v2, s[40:43], s60 offen offset:3072 sc1
  s_add_u32 s60, s64, 0x81000
  v_mfma_f32_16x16x32_bf16 a[204:207], v[44:47], v[192:195], a[204:207]
  buffer_load_dwordx4 v[176:179], v2, s[40:43], s60 offen offset:0 sc1
  buffer_load_dwordx4 v[180:183], v2, s[40:43], s60 offen offset:1024 sc1
  v_mfma_f32_16x16x32_bf16 a[220:223], v[44:47], v[196:199], a[220:223]
  buffer_load_dwordx4 v[184:187], v2, s[40:43], s60 offen offset:2048 sc1
  buffer_load_dwordx4 v[188:191], v2, s[40:43], s60 offen offset:3072 sc1
  v_mfma_f32_16x16x32_bf16 a[236:239], v[44:47], v[208:211], a[236:239]
  s_add_u32 s63, s63, 0x20000
  s_add_u32 s64, s64, 0x2000
  v_mfma_f32_16x16x32_bf16 a[252:255], v[44:47], v[212:215], a[252:255]
  s_sub_u32 s68, s68, 1
  s_cmp_eq_u32 s68, 0
  s_waitcnt lgkmcnt(0)
  v_mfma_f32_16x16x32_bf16 a[192:195], v[48:51], v[200:203], a[192:195]
  s_cselect_b32 s63, 0x40000000, s63
  s_cselect_b32 s64, 0x40000000, s64
  v_mfma_f32_16x16x32_bf16 a[208:211], v[48:51], v[204:207], a[208:211]
  v_mfma_f32_16x16x32_bf16 a[224:227], v[48:51], v[216:219], a[224:227]
  v_mfma_f32_16x16x32_bf16 a[240:243], v[48:51], v[220:223], a[240:243]
  v_mfma_f32_16x16x32_bf16 a[196:199], v[52:55], v[200:203], a[196:199]
  v_mfma_f32_16x16x32_bf16 a[212:215], v[52:55], v[204:207], a[212:215]
  v_mfma_f32_16x16x32_bf16 a[228:231], v[52:55], v[216:219], a[228:231]
  v_mfma_f32_16x16x32_bf16 a[244:247], v[52:55], v[220:223], a[244:247]
  v_mfma_f32_16x16x32_bf16 a[200:203], v[56:59], v[200:203], a[200:203]
  v_mfma_f32_16x16x32_bf16 a[216:219], v[56:59], v[204:207], a[216:219]
  v_mfma_f32_16x16x32_bf16 a[232:235], v[56:59], v[216:219], a[232:235]
  v_mfma_f32_16x16x32_bf16 a[248:251], v[56:59], v[220:223], a[248:251]
  v_mfma_f32_16x16x32_bf16 a[204:207], v[60:63], v[200:203], a[204:207]
  v_mfma_f32_16x16x32_bf16 a[220:223], v[60:63], v[204:207], a[220:223]
  v_mfma_f32_16x16x32_bf16 a[236:239], v[60:63], v[216:219], a[236:239]
  v_mfma_f32_16x16x32_bf16 a[252:255], v[60:63], v[220:223], a[252:255]
  s_waitcnt vmcnt(32)
  ds_read_b64_tr_b16 v[64:65], v12 offset:24576
  ds_read_b64_tr_b16 v[66:67], v12 offset:26624
  ds_read_b64_tr_b16 v[68:69], v13 offset:24576
  ds_read_b64_tr_b16 v[70:71], v13 offset:26624
  ds_read_b64_tr_b16 v[72:73], v14 offset:24576
  ds_read_b64_tr_b16 v[74:75], v14 offset:26624
  ds_read_b64_tr_b16 v[76:77], v15 offset:24576
  ds_read_b64_tr_b16 v[78:79], v15 offset:26624
  ds_read_b64_tr_b16 v[80:81], v12 offset:28672
  ds_read_b64_tr_b16 v[82:83], v12 offset:30720
  ds_read_b64_tr_b16 v[84:85], v13 offset:28672
  ds_read_b64_tr_b16 v[86:87], v13 offset:30720
  ds_read_b64_tr_b16 v[88:89], v14 offset:28672
  ds_read_b64_tr_b16 v[90:91], v14 offset:30720
  ds_read_b64_tr_b16 v[92:93], v15 offset:28672
  ds_read_b64_tr_b16 v[94:95], v15 offset:30720
  s_add_u32 m0, s65, 16384
  s_add_u32 s60, s63, 0
  buffer_load_dwordx4 v8, s[48:51], s60 offen lds
  s_add_u32 m0, s65, 17408
  s_add_u32 s60, s63, 8192
  buffer_load_dwordx4 v8, s[48:51], s60 offen lds
  s_waitcnt lgkmcnt(8)
  v_mfma_f32_16x16x32_bf16 a[192:195], v[64:67], v[224:227], a[192:195]
  s_add_u32 m0, s65, 18432
  s_add_u32 s60, s63, 16384
  v_mfma_f32_16x16x32_bf16 a[208:211], v[64:67], v[228:231], a[208:211]
  buffer_load_dwordx4 v8, s[48:51], s60 offen lds
  s_add_u32 m0, s65, 19456
  v_mfma_f32_16x16x32_bf16 a[224:227], v[64:67], v[240:243], a[224:227]
  s_add_u32 s60, s63, 24576
  buffer_load_dwordx4 v8, s[48:51], s60 offen lds
  v_mfma_f32_16x16x32_bf16 a[240:243], v[64:67], v[244:247], a[240:243]
  s_add_u32 m0, s65, 20480
  s_add_u32 s60, s63, 32768
  v_mfma_f32_16x16x32_bf16 a[196:199], v[68:71], v[224:227], a[196:199]
  buffer_load_dwordx4 v8, s[48:51], s60 offen lds
  s_add_u32 m0, s65, 21504
  v_mfma_f32_16x16x32_bf16 a[212:215], v[68:71], v[228:231], a[212:215]
  s_add_u32 s60, s63, 40960
  buffer_load_dwordx4 v8, s[48:51], s60 offen lds
  v_mfma_f32_16x16x32_bf16 a[228:231], v[68:71], v[240:243], a[228:231]
  s_add_u32 m0, s65, 22528
  s_add_u32 s60, s63, 49152
  v_mfma_f32_16x16x32_bf16 a[244:247], v[68:71], v[244:247], a[244:247]
  buffer_load_dwordx4 v8, s[48:51], s60 offen lds
  s_add_u32 m0, s65, 23552
  v_mfma_f32_16x16x32_bf16 a[200:203], v[72:75], v[224:227], a[200:203]
  s_add_u32 s60, s63, 57344
  buffer_load_dwordx4 v8, s[48:51], s60 offen lds
  v_mfma_f32_16x16x32_bf16 a[216:219], v[72:75], v[228:231], a[216:219]
  s_add_u32 s60, s64, 0x0
  buffer_load_dwordx4 v[192:195], v2, s[40:43], s60 offen offset:0 sc1
  v_mfma_f32_16x16x32_bf16 a[232:235], v[72:75], v[240:243], a[232:235]
  buffer_load_dwordx4 v[196:199], v2, s[40:43], s60 offen offset:1024 sc1
  buffer_load_dwordx4 v[200:203], v2, s[40:43], s60 offen offset:2048 sc1
  v_mfma_f32_16x16x32_bf16 a[248:251], v[72:75], v[244:247], a[248:251]
  buffer_load_dwordx4 v[204:207], v2, s[40:43], s60 offen offset:3072 sc1
  s_add_u32 s60, s64, 0x80000
  v_mfma_f32_16x16x32_bf16 a[204:207], v[76:79], v[224:227], a[204:207]
  buffer_load_dwordx4 v[208:211], v2, s[40:43], s60 offen offset:0 sc1
  buffer_load_dwordx4 v[212:215], v2, s[40:43], s60 offen offset:1024 sc1
  v_mfma_f32_16x16x32_bf16 a[220:223], v[76:79], v[228:231], a[220:223]
  buffer_load_dwordx4 v[216:219], v2, s[40:43], s60 offen offset:2048 sc1
  buffer_load_dwordx4 v[220:223], v2, s[40:43], s60 offen offset:3072 sc1
  v_mfma_f32_16x16x32_bf16 a[236:239], v[76:79], v[240:243], a[236:239]
  v_mfma_f32_16x16x32_bf16 a[252:255], v[76:79], v[244:247], a[252:255]
  s_waitcnt lgkmcnt(0)
  v_mfma_f32_16x16x32_bf16 a[192:195], v[80:83], v[232:235], a[192:195]
  v_mfma_f32_16x16x32_bf16 a[208:211], v[80:83], v[236:239], a[208:211]
  v_mfma_f32_16x16x32_bf16 a[224:227], v[80:83], v[248:251], a[224:227]
  v_mfma_f32_16x16x32_bf16 a[240:243], v[80:83], v[252:255], a[240:243]
  v_mfma_f32_16x16x32_bf16 a[196:199], v[84:87], v[232:235], a[196:199]
  v_mfma_f32_16x16x32_bf16 a[212:215], v[84:87], v[236:239], a[212:215]
  v_mfma_f32_16x16x32_bf16 a[228:231], v[84:87], v[248:251], a[228:231]
  v_mfma_f32_16x16x32_bf16 a[244:247], v[84:87], v[252:255], a[244:247]
  v_mfma_f32_16x16x32_bf16 a[200:203], v[88:91], v[232:235], a[200:203]
  v_mfma_f32_16x16x32_bf16 a[216:219], v[88:91], v[236:239], a[216:219]
  v_mfma_f32_16x16x32_bf16 a[232:235], v[88:91], v[248:251], a[232:235]
  v_mfma_f32_16x16x32_bf16 a[248:251], v[88:91], v[252:255], a[248:251]
  v_mfma_f32_16x16x32_bf16 a[204:207], v[92:95], v[232:235], a[204:207]
  v_mfma_f32_16x16x32_bf16 a[220:223], v[92:95], v[236:239], a[220:223]
  v_mfma_f32_16x16x32_bf16 a[236:239], v[92:95], v[248:251], a[236:239]
  v_mfma_f32_16x16x32_bf16 a[252:255], v[92:95], v[252:255], a[252:255]
  s_add_u32 s66, s66, 1
  s_cmp_lt_u32 s66, 4
  s_cbranch_scc1 L_o_loop
  s_waitcnt vmcnt(0)
  s_cmp_eq_u32 s58, 4
  s_cbranch_scc1 L_o_fin
  s_xor_b32 s67, s67, 1
  s_mov_b32 s60, s58
  s_mov_b32 s58, 4
  s_cmp_eq_u32 s60, 0
  s_cbranch_scc0 L_o_half
  s_barrier
  s_branch L_o_xb
L_o_fin:
  s_barrier
  s_lshl_b32 s60, s44, 14
  v_add_u32 v3, s60, v2
  ds_write_b128 v3, a[192:195] offset:0
  ds_write_b128 v3, a[196:199] offset:1024
  ds_write_b128 v3, a[200:203] offset:2048
  ds_write_b128 v3, a[204:207] offset:3072
  ds_write_b128 v3, a[208:211] offset:4096
  ds_write_b128 v3, a[212:215] offset:5120
  ds_write_b128 v3, a[216:219] offset:6144
  ds_write_b128 v3, a[220:223] offset:7168
  ds_write_b128 v3, a[224:227] offset:8192
  ds_write_b128 v3, a[228:231] offset:9216
  ds_write_b128 v3, a[232:235] offset:10240
  ds_write_b128 v3, a[236:239] offset:11264
  ds_write_b128 v3, a[240:243] offset:12288
  ds_write_b128 v3, a[244:247] offset:13312
  ds_write_b128 v3, a[248:251] offset:14336
  ds_write_b128 v3, a[252:255] offset:15360
  s_mov_b32 s48, s36
  s_and_b32 s49, s37, 0xffff
  s_mov_b32 s50, 0x200000
  s_mov_b32 s51, 0x20000
  s_lshl_b32 s60, s44, 12
  v_bfe_u32 v4, v0, 1, 2
  v_lshl_add_u32 v3, v4, 10, s60
  v_and_b32 v4, 1, v0
  v_lshl_add_u32 v3, v4, 9, v3
  v_lshrrev_b32 v4, 3, v0
  v_lshl_add_u32 v3, v4, 4, v3
  v_and_b32 v5, 7, v0
  v_lshlrev_b32 v5, 4, v5
  v_lshl_add_u32 v5, v4, 10, v5
  s_lshl_b32 s60, s56, 16
  s_lshl_b32 s61, s44, 14
  s_add_u32 s60, s60, s61
  s_lshl_b32 s61, s57, 7
  s_add_u32 s60, s60, s61
  s_add_u32 s61, s60, 0x2000
  s_waitcnt lgkmcnt(0)
  s_barrier
  ds_read_b128 v[128:131], v3 offset:0
  ds_read_b128 v[132:135], v3 offset:256
  ds_read_b128 v[136:139], v3 offset:16384
  ds_read_b128 v[140:143], v3 offset:16640
  ds_read_b128 v[144:147], v3 offset:32768
  ds_read_b128 v[148:151], v3 offset:33024
  ds_read_b128 v[152:155], v3 offset:49152
  ds_read_b128 v[156:159], v3 offset:49408
  ds_read_b128 v[160:163], v3 offset:128
  ds_read_b128 v[164:167], v3 offset:384
  ds_read_b128 v[168:171], v3 offset:16512
  ds_read_b128 v[172:175], v3 offset:16768
  ds_read_b128 v[176:179], v3 offset:32896
  ds_read_b128 v[180:183], v3 offset:33152
  ds_read_b128 v[184:187], v3 offset:49280
  ds_read_b128 v[188:191], v3 offset:49536
  s_waitcnt lgkmcnt(8)
  v_add_f32 v128, v128, v136
  v_add_f32 v144, v144, v152
  v_add_f32 v129, v129, v137
  v_add_f32 v145, v145, v153
  v_add_f32 v130, v130, v138
  v_add_f32 v146, v146, v154
  v_add_f32 v131, v131, v139
  v_add_f32 v147, v147, v155
  v_add_f32 v132, v132, v140
  v_add_f32 v148, v148, v156
  v_add_f32 v133, v133, v141
  v_add_f32 v149, v149, v157
  v_add_f32 v134, v134, v142
  v_add_f32 v150, v150, v158
  v_add_f32 v135, v135, v143
  v_add_f32 v151, v151, v159
  v_add_f32 v128, v128, v144
  v_add_f32 v129, v129, v145
  v_add_f32 v130, v130, v146
  v_add_f32 v131, v131, v147
  v_add_f32 v132, v132, v148
  v_add_f32 v133, v133, v149
  v_add_f32 v134, v134, v150
  v_add_f32 v135, v135, v151
  v_cvt_pk_bf16_f32 v136, v128, v129
  v_cvt_pk_bf16_f32 v137, v130, v131
  v_cvt_pk_bf16_f32 v138, v132, v133
  v_cvt_pk_bf16_f32 v139, v134, v135
  buffer_store_dwordx4 v[136:139], v5, s[48:51], s60 offen
  s_waitcnt lgkmcnt(0)
  v_add_f32 v160, v160, v168
  v_add_f32 v176, v176, v184
  v_add_f32 v161, v161, v169
  v_add_f32 v177, v177, v185
  v_add_f32 v162, v162, v170
  v_add_f32 v178, v178, v186
  v_add_f32 v163, v163, v171
  v_add_f32 v179, v179, v187
  v_add_f32 v164, v164, v172
  v_add_f32 v180, v180, v188
  v_add_f32 v165, v165, v173
  v_add_f32 v181, v181, v189
  v_add_f32 v166, v166, v174
  v_add_f32 v182, v182, v190
  v_add_f32 v167, v167, v175
  v_add_f32 v183, v183, v191
  v_add_f32 v160, v160, v176
  v_add_f32 v161, v161, v177
  v_add_f32 v162, v162, v178
  v_add_f32 v163, v163, v179
  v_add_f32 v164, v164, v180
  v_add_f32 v165, v165, v181
  v_add_f32 v166, v166, v182
  v_add_f32 v167, v167, v183
  v_cvt_pk_bf16_f32 v168, v160, v161
  v_cvt_pk_bf16_f32 v169, v162, v163
  v_cvt_pk_bf16_f32 v170, v164, v165
  v_cvt_pk_bf16_f32 v171, v166, v167
  buffer_store_dwordx4 v[168:171], v5, s[48:51], s61 offen
  s_barrier
  s_branch L_next
L_after_p:
  s_waitcnt vmcnt(0)
  s_endpgm
L_team:
  s_mov_b32 s67, 0
  v_lshrrev_b32 v20, 4, v0
  v_and_b32 v21, 15, v0
  v_and_b32 v22, 1, v0
  v_cmp_eq_u32 vcc, 1, v22
  v_mov_b32 v23, 0x44444444
  v_mov_b32 v24, 0xeeeeeeee
  v_cndmask_b32 v1, v23, v24, vcc
  s_lshl_b32 s68, s44, 11
  s_add_u32 s68, s68, 131072
  v_lshl_add_u32 v2, v0, 4, s68
  v_add_u32 v11, 24576, v2
  s_sub_u32 s73, 0x1000000, s68
  s_lshl_b32 s68, s44, 12
  v_lshl_add_u32 v3, v0, 4, s68
  s_lshl_b32 s68, s44, 9
  s_add_u32 s68, s68, 131072
  v_bfe_u32 v22, v0, 3, 1
  v_lshl_add_u32 v5, v22, 8, s68
  v_lshl_add_u32 v5, v20, 6, v5
  v_and_b32 v22, 7, v0
  v_lshl_add_u32 v5, v22, 3, v5
  v_lshrrev_b32 v22, 5, v0
  v_lshlrev_b32 v6, 8, v22
  v_and_b32 v22, 3, v0
  v_lshl_add_u32 v6, v22, 6, v6
  v_bfe_u32 v22, v0, 2, 3
  v_lshl_add_u32 v6, v22, 3, v6
  v_add_u32 v6, 131072, v6
  s_lshl_b32 s68, s44, 9
  s_add_u32 s68, s68, 131072
  v_lshrrev_b32 v22, 1, v0
  v_lshl_add_u32 v7, v22, 4, s68
  s_lshl_b32 s68, s44, 14
  s_lshl_b32 s69, s45, 6
  s_add_u32 s68, s68, s69
  v_lshrrev_b32 v22, 3, v0
  v_lshl_add_u32 v8, v22, 11, s68
  v_and_b32 v22, 7, v0
  v_lshl_add_u32 v8, v22, 3, v8
  v_lshlrev_b32 v9, 8, v20
  v_bfe_u32 v22, v0, 2, 1
  v_lshl_add_u32 v9, v22, 7, v9
  v_and_b32 v22, 1, v0
  v_lshl_add_u32 v9, v22, 6, v9
  v_bfe_u32 v22, v0, 3, 1
  v_lshl_add_u32 v9, v22, 5, v9
  v_bfe_u32 v22, v0, 1, 1
  v_lshl_add_u32 v9, v22, 4, v9
  s_lshl_b32 s68, s44, 16
  s_lshl_b32 s69, s45, 11
  s_add_u32 s68, s68, s69
  s_add_u32 s62, s68, 0x9000000
  v_bfe_u32 v22, v0, 3, 1
  v_lshlrev_b32 v10, 13, v22
  v_lshl_add_u32 v10, v20, 3, v10
  v_bfe_u32 v22, v0, 1, 1
  v_lshl_add_u32 v10, v22, 5, v10
  v_bfe_u32 v22, v0, 2, 1
  v_lshl_add_u32 v10, v22, 2, v10
  v_and_b32 v22, 1, v0
  v_lshl_add_u32 v10, v22, 1, v10
  s_lshl_b32 s64, s44, 11
  s_lshr_b32 s68, s45, 3
  s_lshl_b32 s68, s68, 9
  s_add_u32 s64, s64, s68
  s_and_b32 s68, s45, 1
  s_lshl_b32 s68, s68, 8
  s_add_u32 s64, s64, s68
  s_bfe_u32 s68, s45, 0x20001
  s_lshl_b32 s68, s68, 6
  s_add_u32 s64, s64, s68
  s_add_u32 s64, s64, 0x9040000
  s_mov_b32 s63, 0x901c000
  s_lshl_b32 s92, s45, 7
  s_add_u32 s92, s92, 0x9080040
  s_lshl_b32 s72, s45, 19
  s_add_u32 s72, s72, 0x3fe0000
  s_mov_b32 s94, 0xaaaaaaaa
  s_mov_b32 s95, 0xaaaaaaaa
  v_mov_b32 v17, 0
  v_mov_b32 v18, 0
  v_mov_b32 v16, 0
  v_mov_b32 v12, 0x3f803f80
  v_mov_b32 v13, 0x3f803f80
  v_mov_b32 v14, 0x3f803f80
  v_mov_b32 v15, 0x3f803f80
  s_mov_b32 s78, 0xff00ff00
  s_mov_b32 s79, 0xff00ff00
  s_mov_b32 s88, 0x3e0293ee
  s_mov_b32 s89, 0x21800000
  s_mov_b32 s91, 0x3c000000
  s_mov_b32 s90, 0xfffe
  s_lshl_b32 s68, s44, 11
  s_add_u32 s70, s68, 147456
  s_add_u32 s71, s68, 139264
  s_lshl_b32 s68, s45, 7
  s_add_u32 s68, s68, 0x9084000
  s_cmp_eq_u32 s44, 0
  s_cselect_b32 s66, s68, 0x40000000
  s_mov_b32 s80, 0x3030303
  s_mov_b32 s81, 0x3030303
  s_mov_b32 s74, 0x9000000
  s_mov_b32 s82, 0xc0c0c0c
  s_mov_b32 s83, 0xc0c0c0c
  s_mov_b32 s75, 0x9010000
  s_mov_b32 s84, 0x30303030
  s_mov_b32 s85, 0x30303030
  s_mov_b32 s76, 0x9020000
  s_mov_b32 s86, 0xc0c0c0c0
  s_mov_b32 s87, 0xc0c0c0c0
  s_mov_b32 s77, 0x9030000
  buffer_store_dwordx2 v[16:17], v8, s[40:43], s74 offen sc1
  buffer_store_dwordx2 v[16:17], v8, s[40:43], s75 offen sc1
  buffer_store_dwordx2 v[16:17], v8, s[40:43], s76 offen sc1
  buffer_store_dwordx2 v[16:17], v8, s[40:43], s77 offen sc1
  v_mov_b32 v22, 0xffff
  buffer_store_short v22, v10, s[40:43], s64 offen sc1
  s_mul_i32 s68, s44, 4
  s_lshr_b32 s68, 0x7640, s68
  s_and_b32 s68, s68, 15
  s_lshl_b32 s68, s68, 12
  s_lshl_b32 s69, s45, 7
  s_add_u32 s68, s68, s69
  s_add_u32 s68, s68, 0x9080000
  v_and_b32 v23, 31, v0
  v_lshlrev_b32 v23, 2, v23
  buffer_store_dword v17, v23, s[40:43], s68 offen sc1
  s_mov_b32 s52, s38
  s_and_b32 s53, s39, 0xffff
  s_mov_b32 s54, 0x100
  s_mov_b32 s55, 0x20000
  s_lshl_b32 s68, 1, s46
  v_mov_b32 v22, s68
  s_cmp_eq_u32 s44, 0
  s_cselect_b32 s69, 0, 0x40000000
  s_mov_b64 exec, 1
  buffer_atomic_or v22, v17, s[52:55], s69 offen offset:128
  s_mov_b64 exec, -1
  v_bfe_u32 v22, v0, 4, 1
  v_lshrrev_b32 v23, 5, v0
  s_lshl_b32 s68, s44, 1
  v_or_b32 v24, s68, v22
  v_lshlrev_b32 v24, 1, v24
  v_xor_b32 v24, v24, v21
  v_lshlrev_b32 v24, 4, v24
  v_lshl_add_u32 v25, v22, 4, v23
  v_add_u32 v25, s68, v25
  v_lshl_add_u32 v26, v25, 13, v24
  s_lshl_b32 s69, s45, 8
  v_add_u32 v26, s69, v26
  s_lshl_b32 s68, s44, 4
  v_add_u32 v25, s68, v20
  v_lshl_add_u32 v27, v25, 10, v24
  s_lshl_b32 s69, s45, 17
  v_add_u32 v27, s69, v27
  v_lshrrev_b32 v22, 5, v0
  v_lshlrev_b32 v28, 12, v22
  v_bfe_u32 v22, v0, 3, 1
  v_lshl_add_u32 v28, v22, 11, v28
  v_lshlrev_b32 v24, 2, v22
  v_bfe_u32 v22, v0, 4, 1
  v_lshl_add_u32 v28, v22, 10, v28
  v_lshl_add_u32 v24, v22, 1, v24
  v_bfe_u32 v22, v0, 2, 1
  v_lshl_add_u32 v28, v22, 8, v28
  v_add_u32 v24, v24, v22
  s_lshl_b32 s68, s44, 1
  v_xor_b32 v24, s68, v24
  v_lshl_add_u32 v28, v24, 5, v28
  v_and_b32 v22, 3, v0
  v_lshl_add_u32 v28, v22, 3, v28
  v_xor_b32 v29, 32, v28
  v_bfe_u32 v22, v0, 3, 1
  v_mul_u32_u24 v22, 2208, v22
  v_xor_b32 v32, v22, v28
  v_xor_b32 v33, 2176, v32
  s_mov_b32 s50, 0x400000
  s_mov_b32 s51, 0x20000
  s_lshl_b32 s56, s44, 10
  s_mov_b32 s48, s24
  s_and_b32 s49, s25, 0xffff
  s_add_u32 m0, s56, 0
  s_mov_b32 s68, 0
  buffer_load_dwordx4 v26, s[48:51], s68 offen lds
  s_add_u32 m0, s56, 4096
  s_mov_b32 s68, 65536
  buffer_load_dwordx4 v26, s[48:51], s68 offen lds
  s_add_u32 m0, s56, 8192
  s_mov_b32 s68, 262144
  buffer_load_dwordx4 v26, s[48:51], s68 offen lds
  s_add_u32 m0, s56, 12288
  s_mov_b32 s68, 327680
  buffer_load_dwordx4 v26, s[48:51], s68 offen lds
  s_add_u32 m0, s56, 16384
  s_mov_b32 s68, 524288
  buffer_load_dwordx4 v26, s[48:51], s68 offen lds
  s_add_u32 m0, s56, 20480
  s_mov_b32 s68, 589824
  buffer_load_dwordx4 v26, s[48:51], s68 offen lds
  s_add_u32 m0, s56, 24576
  s_mov_b32 s68, 786432
  buffer_load_dwordx4 v26, s[48:51], s68 offen lds
  s_add_u32 m0, s56, 28672
  s_mov_b32 s68, 851968
  buffer_load_dwordx4 v26, s[48:51], s68 offen lds
  s_add_u32 m0, s56, 32768
  s_mov_b32 s68, 1048576
  buffer_load_dwordx4 v26, s[48:51], s68 offen lds
  s_add_u32 m0, s56, 36864
  s_mov_b32 s68, 1114112
  buffer_load_dwordx4 v26, s[48:51], s68 offen lds
  s_add_u32 m0, s56, 40960
  s_mov_b32 s68, 1310720
  buffer_load_dwordx4 v26, s[48:51], s68 offen lds
  s_add_u32 m0, s56, 45056
  s_mov_b32 s68, 1376256
  buffer_load_dwordx4 v26, s[48:51], s68 offen lds
  s_add_u32 m0, s56, 49152
  s_mov_b32 s68, 1572864
  buffer_load_dwordx4 v26, s[48:51], s68 offen lds
  s_add_u32 m0, s56, 53248
  s_mov_b32 s68, 1638400
  buffer_load_dwordx4 v26, s[48:51], s68 offen lds
  s_add_u32 m0, s56, 57344
  s_mov_b32 s68, 1835008
  buffer_load_dwordx4 v26, s[48:51], s68 offen lds
  s_add_u32 m0, s56, 61440
  s_mov_b32 s68, 1900544
  buffer_load_dwordx4 v26, s[48:51], s68 offen lds
  s_add_u32 m0, s56, 65536
  s_mov_b32 s68, 2097152
  buffer_load_dwordx4 v26, s[48:51], s68 offen lds
  s_add_u32 m0, s56, 69632
  s_mov_b32 s68, 2162688
  buffer_load_dwordx4 v26, s[48:51], s68 offen lds
  s_add_u32 m0, s56, 73728
  s_mov_b32 s68, 2359296
  buffer_load_dwordx4 v26, s[48:51], s68 offen lds
  s_add_u32 m0, s56, 77824
  s_mov_b32 s68, 2424832
  buffer_load_dwordx4 v26, s[48:51], s68 offen lds
  s_add_u32 m0, s56, 81920
  s_mov_b32 s68, 2621440
  buffer_load_dwordx4 v26, s[48:51], s68 offen lds
  s_add_u32 m0, s56, 86016
  s_mov_b32 s68, 2686976
  buffer_load_dwordx4 v26, s[48:51], s68 offen lds
  s_add_u32 m0, s56, 90112
  s_mov_b32 s68, 2883584
  buffer_load_dwordx4 v26, s[48:51], s68 offen lds
  s_add_u32 m0, s56, 94208
  s_mov_b32 s68, 2949120
  buffer_load_dwordx4 v26, s[48:51], s68 offen lds
  s_add_u32 m0, s56, 98304
  s_mov_b32 s68, 3145728
  buffer_load_dwordx4 v26, s[48:51], s68 offen lds
  s_add_u32 m0, s56, 102400
  s_mov_b32 s68, 3211264
  buffer_load_dwordx4 v26, s[48:51], s68 offen lds
  s_add_u32 m0, s56, 106496
  s_mov_b32 s68, 3407872
  buffer_load_dwordx4 v26, s[48:51], s68 offen lds
  s_add_u32 m0, s56, 110592
  s_mov_b32 s68, 3473408
  buffer_load_dwordx4 v26, s[48:51], s68 offen lds
  s_waitcnt vmcnt(24)
  s_barrier
  v_mov_b32 v22, 1
  s_cmp_eq_u32 s44, 0
  s_cselect_b32 s69, 0, 0x40000000
  s_mov_b64 exec, 1
  buffer_atomic_add v22, v17, s[52:55], s69 offen
  s_mov_b64 exec, -1
  s_add_u32 m0, s56, 114688
  s_mov_b32 s68, 3670016
  buffer_load_dwordx4 v26, s[48:51], s68 offen lds
  s_add_u32 m0, s56, 118784
  s_mov_b32 s68, 3735552
  buffer_load_dwordx4 v26, s[48:51], s68 offen lds
  s_add_u32 m0, s56, 122880
  s_mov_b32 s68, 3932160
  buffer_load_dwordx4 v26, s[48:51], s68 offen lds
  s_add_u32 m0, s56, 126976
  s_mov_b32 s68, 3997696
  buffer_load_dwordx4 v26, s[48:51], s68 offen lds
  v_add_u32 v30, 0, v28
  v_add_u32 v31, 0, v29
  s_cmp_lg_u32 s44, 0
  s_cbranch_scc1 L_wr_0_1
  ds_read_b64_tr_b16 a[0:1], v30 offset:0
  ds_read_b64_tr_b16 a[2:3], v30 offset:512
  ds_read_b64_tr_b16 a[4:5], v30 offset:8192
  ds_read_b64_tr_b16 a[6:7], v30 offset:8704
  ds_read_b64_tr_b16 a[64:65], v31 offset:0
  ds_read_b64_tr_b16 a[66:67], v31 offset:512
  ds_read_b64_tr_b16 a[68:69], v31 offset:8192
  ds_read_b64_tr_b16 a[70:71], v31 offset:8704
  s_branch L_wr_0_e
L_wr_0_1:
  s_cmp_lg_u32 s44, 1
  s_cbranch_scc1 L_wr_0_2
  ds_read_b64_tr_b16 a[16:17], v30 offset:0
  ds_read_b64_tr_b16 a[18:19], v30 offset:512
  ds_read_b64_tr_b16 a[20:21], v30 offset:8192
  ds_read_b64_tr_b16 a[22:23], v30 offset:8704
  ds_read_b64_tr_b16 a[80:81], v31 offset:0
  ds_read_b64_tr_b16 a[82:83], v31 offset:512
  ds_read_b64_tr_b16 a[84:85], v31 offset:8192
  ds_read_b64_tr_b16 a[86:87], v31 offset:8704
  s_branch L_wr_0_e
L_wr_0_2:
  s_cmp_lg_u32 s44, 2
  s_cbranch_scc1 L_wr_0_3
  ds_read_b64_tr_b16 a[32:33], v30 offset:0
  ds_read_b64_tr_b16 a[34:35], v30 offset:512
  ds_read_b64_tr_b16 a[36:37], v30 offset:8192
  ds_read_b64_tr_b16 a[38:39], v30 offset:8704
  ds_read_b64_tr_b16 a[96:97], v31 offset:0
  ds_read_b64_tr_b16 a[98:99], v31 offset:512
  ds_read_b64_tr_b16 a[100:101], v31 offset:8192
  ds_read_b64_tr_b16 a[102:103], v31 offset:8704
  s_branch L_wr_0_e
L_wr_0_3:
  ds_read_b64_tr_b16 a[48:49], v30 offset:0
  ds_read_b64_tr_b16 a[50:51], v30 offset:512
  ds_read_b64_tr_b16 a[52:53], v30 offset:8192
  ds_read_b64_tr_b16 a[54:55], v30 offset:8704
  ds_read_b64_tr_b16 a[112:113], v31 offset:0
  ds_read_b64_tr_b16 a[114:115], v31 offset:512
  ds_read_b64_tr_b16 a[116:117], v31 offset:8192
  ds_read_b64_tr_b16 a[118:119], v31 offset:8704
L_wr_0_e:
  s_waitcnt lgkmcnt(0)
  s_waitcnt vmcnt(24)
  s_barrier
  s_mov_b32 s48, s26
  s_and_b32 s49, s27, 0xffff
  s_add_u32 m0, s56, 0
  s_mov_b32 s68, 0
  buffer_load_dwordx4 v26, s[48:51], s68 offen lds
  s_add_u32 m0, s56, 4096
  s_mov_b32 s68, 65536
  buffer_load_dwordx4 v26, s[48:51], s68 offen lds
  s_add_u32 m0, s56, 8192
  s_mov_b32 s68, 262144
  buffer_load_dwordx4 v26, s[48:51], s68 offen lds
  s_add_u32 m0, s56, 12288
  s_mov_b32 s68, 327680
  buffer_load_dwordx4 v26, s[48:51], s68 offen lds
  v_add_u32 v30, 16384, v28
  v_add_u32 v31, 16384, v29
  s_cmp_lg_u32 s44, 0
  s_cbranch_scc1 L_wr_1_1
  ds_read_b64_tr_b16 a[8:9], v30 offset:0
  ds_read_b64_tr_b16 a[10:11], v30 offset:512
  ds_read_b64_tr_b16 a[12:13], v30 offset:8192
  ds_read_b64_tr_b16 a[14:15], v30 offset:8704
  ds_read_b64_tr_b16 a[72:73], v31 offset:0
  ds_read_b64_tr_b16 a[74:75], v31 offset:512
  ds_read_b64_tr_b16 a[76:77], v31 offset:8192
  ds_read_b64_tr_b16 a[78:79], v31 offset:8704
  s_branch L_wr_1_e
L_wr_1_1:
  s_cmp_lg_u32 s44, 1
  s_cbranch_scc1 L_wr_1_2
  ds_read_b64_tr_b16 a[24:25], v30 offset:0
  ds_read_b64_tr_b16 a[26:27], v30 offset:512
  ds_read_b64_tr_b16 a[28:29], v30 offset:8192
  ds_read_b64_tr_b16 a[30:31], v30 offset:8704
  ds_read_b64_tr_b16 a[88:89], v31 offset:0
  ds_read_b64_tr_b16 a[90:91], v31 offset:512
  ds_read_b64_tr_b16 a[92:93], v31 offset:8192
  ds_read_b64_tr_b16 a[94:95], v31 offset:8704
  s_branch L_wr_1_e
L_wr_1_2:
  s_cmp_lg_u32 s44, 2
  s_cbranch_scc1 L_wr_1_3
  ds_read_b64_tr_b16 a[40:41], v30 offset:0
  ds_read_b64_tr_b16 a[42:43], v30 offset:512
  ds_read_b64_tr_b16 a[44:45], v30 offset:8192
  ds_read_b64_tr_b16 a[46:47], v30 offset:8704
  ds_read_b64_tr_b16 a[104:105], v31 offset:0
  ds_read_b64_tr_b16 a[106:107], v31 offset:512
  ds_read_b64_tr_b16 a[108:109], v31 offset:8192
  ds_read_b64_tr_b16 a[110:111], v31 offset:8704
  s_branch L_wr_1_e
L_wr_1_3:
  ds_read_b64_tr_b16 a[56:57], v30 offset:0
  ds_read_b64_tr_b16 a[58:59], v30 offset:512
  ds_read_b64_tr_b16 a[60:61], v30 offset:8192
  ds_read_b64_tr_b16 a[62:63], v30 offset:8704
  ds_read_b64_tr_b16 a[120:121], v31 offset:0
  ds_read_b64_tr_b16 a[122:123], v31 offset:512
  ds_read_b64_tr_b16 a[124:125], v31 offset:8192
  ds_read_b64_tr_b16 a[126:127], v31 offset:8704
L_wr_1_e:
  s_waitcnt lgkmcnt(0)
  s_waitcnt vmcnt(24)
  s_barrier
  s_add_u32 m0, s56, 16384
  s_mov_b32 s68, 524288
  buffer_load_dwordx4 v26, s[48:51], s68 offen lds
  s_add_u32 m0, s56, 20480
  s_mov_b32 s68, 589824
  buffer_load_dwordx4 v26, s[48:51], s68 offen lds
  s_add_u32 m0, s56, 24576
  s_mov_b32 s68, 786432
  buffer_load_dwordx4 v26, s[48:51], s68 offen lds
  s_add_u32 m0, s56, 28672
  s_mov_b32 s68, 851968
  buffer_load_dwordx4 v26, s[48:51], s68 offen lds
  v_add_u32 v30, 32768, v28
  v_add_u32 v31, 32768, v29
  s_cmp_lg_u32 s44, 0
  s_cbranch_scc1 L_wr_2_1
  ds_read_b64_tr_b16 a[16:17], v30 offset:0
  ds_read_b64_tr_b16 a[18:19], v30 offset:512
  ds_read_b64_tr_b16 a[20:21], v30 offset:8192
  ds_read_b64_tr_b16 a[22:23], v30 offset:8704
  ds_read_b64_tr_b16 a[80:81], v31 offset:0
  ds_read_b64_tr_b16 a[82:83], v31 offset:512
  ds_read_b64_tr_b16 a[84:85], v31 offset:8192
  ds_read_b64_tr_b16 a[86:87], v31 offset:8704
  s_branch L_wr_2_e
L_wr_2_1:
  s_cmp_lg_u32 s44, 1
  s_cbranch_scc1 L_wr_2_2
  ds_read_b64_tr_b16 a[0:1], v30 offset:0
  ds_read_b64_tr_b16 a[2:3], v30 offset:512
  ds_read_b64_tr_b16 a[4:5], v30 offset:8192
  ds_read_b64_tr_b16 a[6:7], v30 offset:8704
  ds_read_b64_tr_b16 a[64:65], v31 offset:0
  ds_read_b64_tr_b16 a[66:67], v31 offset:512
  ds_read_b64_tr_b16 a[68:69], v31 offset:8192
  ds_read_b64_tr_b16 a[70:71], v31 offset:8704
  s_branch L_wr_2_e
L_wr_2_2:
  s_cmp_lg_u32 s44, 2
  s_cbranch_scc1 L_wr_2_3
  ds_read_b64_tr_b16 a[48:49], v30 offset:0
  ds_read_b64_tr_b16 a[50:51], v30 offset:512
  ds_read_b64_tr_b16 a[52:53], v30 offset:8192
  ds_read_b64_tr_b16 a[54:55], v30 offset:8704
  ds_read_b64_tr_b16 a[112:113], v31 offset:0
  ds_read_b64_tr_b16 a[114:115], v31 offset:512
  ds_read_b64_tr_b16 a[116:117], v31 offset:8192
  ds_read_b64_tr_b16 a[118:119], v31 offset:8704
  s_branch L_wr_2_e
L_wr_2_3:
  ds_read_b64_tr_b16 a[32:33], v30 offset:0
  ds_read_b64_tr_b16 a[34:35], v30 offset:512
  ds_read_b64_tr_b16 a[36:37], v30 offset:8192
  ds_read_b64_tr_b16 a[38:39], v30 offset:8704
  ds_read_b64_tr_b16 a[96:97], v31 offset:0
  ds_read_b64_tr_b16 a[98:99], v31 offset:512
  ds_read_b64_tr_b16 a[100:101], v31 offset:8192
  ds_read_b64_tr_b16 a[102:103], v31 offset:8704
L_wr_2_e:
  s_waitcnt lgkmcnt(0)
  s_waitcnt vmcnt(24)
  s_barrier
  s_add_u32 m0, s56, 32768
  s_mov_b32 s68, 1048576
  buffer_load_dwordx4 v26, s[48:51], s68 offen lds
  s_add_u32 m0, s56, 36864
  s_mov_b32 s68, 1114112
  buffer_load_dwordx4 v26, s[48:51], s68 offen lds
  s_add_u32 m0, s56, 40960
  s_mov_b32 s68, 1310720
  buffer_load_dwordx4 v26, s[48:51], s68 offen lds
  s_add_u32 m0, s56, 45056
  s_mov_b32 s68, 1376256
  buffer_load_dwordx4 v26, s[48:51], s68 offen lds
  v_add_u32 v30, 49152, v28
  v_add_u32 v31, 49152, v29
  s_cmp_lg_u32 s44, 0
  s_cbranch_scc1 L_wr_3_1
  ds_read_b64_tr_b16 a[24:25], v30 offset:0
  ds_read_b64_tr_b16 a[26:27], v30 offset:512
  ds_read_b64_tr_b16 a[28:29], v30 offset:8192
  ds_read_b64_tr_b16 a[30:31], v30 offset:8704
  ds_read_b64_tr_b16 a[88:89], v31 offset:0
  ds_read_b64_tr_b16 a[90:91], v31 offset:512
  ds_read_b64_tr_b16 a[92:93], v31 offset:8192
  ds_read_b64_tr_b16 a[94:95], v31 offset:8704
  s_branch L_wr_3_e
L_wr_3_1:
  s_cmp_lg_u32 s44, 1
  s_cbranch_scc1 L_wr_3_2
  ds_read_b64_tr_b16 a[8:9], v30 offset:0
  ds_read_b64_tr_b16 a[10:11], v30 offset:512
  ds_read_b64_tr_b16 a[12:13], v30 offset:8192
  ds_read_b64_tr_b16 a[14:15], v30 offset:8704
  ds_read_b64_tr_b16 a[72:73], v31 offset:0
  ds_read_b64_tr_b16 a[74:75], v31 offset:512
  ds_read_b64_tr_b16 a[76:77], v31 offset:8192
  ds_read_b64_tr_b16 a[78:79], v31 offset:8704
  s_branch L_wr_3_e
L_wr_3_2:
  s_cmp_lg_u32 s44, 2
  s_cbranch_scc1 L_wr_3_3
  ds_read_b64_tr_b16 a[56:57], v30 offset:0
  ds_read_b64_tr_b16 a[58:59], v30 offset:512
  ds_read_b64_tr_b16 a[60:61], v30 offset:8192
  ds_read_b64_tr_b16 a[62:63], v30 offset:8704
  ds_read_b64_tr_b16 a[120:121], v31 offset:0
  ds_read_b64_tr_b16 a[122:123], v31 offset:512
  ds_read_b64_tr_b16 a[124:125], v31 offset:8192
  ds_read_b64_tr_b16 a[126:127], v31 offset:8704
  s_branch L_wr_3_e
L_wr_3_3:
  ds_read_b64_tr_b16 a[40:41], v30 offset:0
  ds_read_b64_tr_b16 a[42:43], v30 offset:512
  ds_read_b64_tr_b16 a[44:45], v30 offset:8192
  ds_read_b64_tr_b16 a[46:47], v30 offset:8704
  ds_read_b64_tr_b16 a[104:105], v31 offset:0
  ds_read_b64_tr_b16 a[106:107], v31 offset:512
  ds_read_b64_tr_b16 a[108:109], v31 offset:8192
  ds_read_b64_tr_b16 a[110:111], v31 offset:8704
L_wr_3_e:
  s_waitcnt lgkmcnt(0)
  s_waitcnt vmcnt(24)
  s_barrier
  s_add_u32 m0, s56, 49152
  s_mov_b32 s68, 1572864
  buffer_load_dwordx4 v26, s[48:51], s68 offen lds
  s_add_u32 m0, s56, 53248
  s_mov_b32 s68, 1638400
  buffer_load_dwordx4 v26, s[48:51], s68 offen lds
  s_add_u32 m0, s56, 57344
  s_mov_b32 s68, 1835008
  buffer_load_dwordx4 v26, s[48:51], s68 offen lds
  s_add_u32 m0, s56, 61440
  s_mov_b32 s68, 1900544
  buffer_load_dwordx4 v26, s[48:51], s68 offen lds
  v_add_u32 v30, 65536, v28
  v_add_u32 v31, 65536, v29
  s_cmp_lg_u32 s44, 0
  s_cbranch_scc1 L_wr_4_1
  ds_read_b64_tr_b16 a[32:33], v30 offset:0
  ds_read_b64_tr_b16 a[34:35], v30 offset:512
  ds_read_b64_tr_b16 a[36:37], v30 offset:8192
  ds_read_b64_tr_b16 a[38:39], v30 offset:8704
  ds_read_b64_tr_b16 a[96:97], v31 offset:0
  ds_read_b64_tr_b16 a[98:99], v31 offset:512
  ds_read_b64_tr_b16 a[100:101], v31 offset:8192
  ds_read_b64_tr_b16 a[102:103], v31 offset:8704
  s_branch L_wr_4_e
L_wr_4_1:
  s_cmp_lg_u32 s44, 1
  s_cbranch_scc1 L_wr_4_2
  ds_read_b64_tr_b16 a[48:49], v30 offset:0
  ds_read_b64_tr_b16 a[50:51], v30 offset:512
  ds_read_b64_tr_b16 a[52:53], v30 offset:8192
  ds_read_b64_tr_b16 a[54:55], v30 offset:8704
  ds_read_b64_tr_b16 a[112:113], v31 offset:0
  ds_read_b64_tr_b16 a[114:115], v31 offset:512
  ds_read_b64_tr_b16 a[116:117], v31 offset:8192
  ds_read_b64_tr_b16 a[118:119], v31 offset:8704
  s_branch L_wr_4_e
L_wr_4_2:
  s_cmp_lg_u32 s44, 2
  s_cbranch_scc1 L_wr_4_3
  ds_read_b64_tr_b16 a[0:1], v30 offset:0
  ds_read_b64_tr_b16 a[2:3], v30 offset:512
  ds_read_b64_tr_b16 a[4:5], v30 offset:8192
  ds_read_b64_tr_b16 a[6:7], v30 offset:8704
  ds_read_b64_tr_b16 a[64:65], v31 offset:0
  ds_read_b64_tr_b16 a[66:67], v31 offset:512
  ds_read_b64_tr_b16 a[68:69], v31 offset:8192
  ds_read_b64_tr_b16 a[70:71], v31 offset:8704
  s_branch L_wr_4_e
L_wr_4_3:
  ds_read_b64_tr_b16 a[16:17], v30 offset:0
  ds_read_b64_tr_b16 a[18:19], v30 offset:512
  ds_read_b64_tr_b16 a[20:21], v30 offset:8192
  ds_read_b64_tr_b16 a[22:23], v30 offset:8704
  ds_read_b64_tr_b16 a[80:81], v31 offset:0
  ds_read_b64_tr_b16 a[82:83], v31 offset:512
  ds_read_b64_tr_b16 a[84:85], v31 offset:8192
  ds_read_b64_tr_b16 a[86:87], v31 offset:8704
L_wr_4_e:
  s_waitcnt lgkmcnt(0)
  s_waitcnt vmcnt(24)
  s_barrier
  s_add_u32 m0, s56, 65536
  s_mov_b32 s68, 2097152
  buffer_load_dwordx4 v26, s[48:51], s68 offen lds
  s_add_u32 m0, s56, 69632
  s_mov_b32 s68, 2162688
  buffer_load_dwordx4 v26, s[48:51], s68 offen lds
  s_add_u32 m0, s56, 73728
  s_mov_b32 s68, 2359296
  buffer_load_dwordx4 v26, s[48:51], s68 offen lds
  s_add_u32 m0, s56, 77824
  s_mov_b32 s68, 2424832
  buffer_load_dwordx4 v26, s[48:51], s68 offen lds
  v_add_u32 v30, 81920, v28
  v_add_u32 v31, 81920, v29
  s_cmp_lg_u32 s44, 0
  s_cbranch_scc1 L_wr_5_1
  ds_read_b64_tr_b16 a[40:41], v30 offset:0
  ds_read_b64_tr_b16 a[42:43], v30 offset:512
  ds_read_b64_tr_b16 a[44:45], v30 offset:8192
  ds_read_b64_tr_b16 a[46:47], v30 offset:8704
  ds_read_b64_tr_b16 a[104:105], v31 offset:0
  ds_read_b64_tr_b16 a[106:107], v31 offset:512
  ds_read_b64_tr_b16 a[108:109], v31 offset:8192
  ds_read_b64_tr_b16 a[110:111], v31 offset:8704
  s_branch L_wr_5_e
L_wr_5_1:
  s_cmp_lg_u32 s44, 1
  s_cbranch_scc1 L_wr_5_2
  ds_read_b64_tr_b16 a[56:57], v30 offset:0
  ds_read_b64_tr_b16 a[58:59], v30 offset:512
  ds_read_b64_tr_b16 a[60:61], v30 offset:8192
  ds_read_b64_tr_b16 a[62:63], v30 offset:8704
  ds_read_b64_tr_b16 a[120:121], v31 offset:0
  ds_read_b64_tr_b16 a[122:123], v31 offset:512
  ds_read_b64_tr_b16 a[124:125], v31 offset:8192
  ds_read_b64_tr_b16 a[126:127], v31 offset:8704
  s_branch L_wr_5_e
L_wr_5_2:
  s_cmp_lg_u32 s44, 2
  s_cbranch_scc1 L_wr_5_3
  ds_read_b64_tr_b16 a[8:9], v30 offset:0
  ds_read_b64_tr_b16 a[10:11], v30 offset:512
  ds_read_b64_tr_b16 a[12:13], v30 offset:8192
  ds_read_b64_tr_b16 a[14:15], v30 offset:8704
  ds_read_b64_tr_b16 a[72:73], v31 offset:0
  ds_read_b64_tr_b16 a[74:75], v31 offset:512
  ds_read_b64_tr_b16 a[76:77], v31 offset:8192
  ds_read_b64_tr_b16 a[78:79], v31 offset:8704
  s_branch L_wr_5_e
L_wr_5_3:
  ds_read_b64_tr_b16 a[24:25], v30 offset:0
  ds_read_b64_tr_b16 a[26:27], v30 offset:512
  ds_read_b64_tr_b16 a[28:29], v30 offset:8192
  ds_read_b64_tr_b16 a[30:31], v30 offset:8704
  ds_read_b64_tr_b16 a[88:89], v31 offset:0
  ds_read_b64_tr_b16 a[90:91], v31 offset:512
  ds_read_b64_tr_b16 a[92:93], v31 offset:8192
  ds_read_b64_tr_b16 a[94:95], v31 offset:8704
L_wr_5_e:
  s_waitcnt lgkmcnt(0)
  s_waitcnt vmcnt(24)
  s_barrier
  s_add_u32 m0, s56, 81920
  s_mov_b32 s68, 2621440
  buffer_load_dwordx4 v26, s[48:51], s68 offen lds
  s_add_u32 m0, s56, 86016
  s_mov_b32 s68, 2686976
  buffer_load_dwordx4 v26, s[48:51], s68 offen lds
  s_add_u32 m0, s56, 90112
  s_mov_b32 s68, 2883584
  buffer_load_dwordx4 v26, s[48:51], s68 offen lds
  s_add_u32 m0, s56, 94208
  s_mov_b32 s68, 2949120
  buffer_load_dwordx4 v26, s[48:51], s68 offen lds
  v_add_u32 v30, 98304, v28
  v_add_u32 v31, 98304, v29
  s_cmp_lg_u32 s44, 0
  s_cbranch_scc1 L_wr_6_1
  ds_read_b64_tr_b16 a[48:49], v30 offset:0
  ds_read_b64_tr_b16 a[50:51], v30 offset:512
  ds_read_b64_tr_b16 a[52:53], v30 offset:8192
  ds_read_b64_tr_b16 a[54:55], v30 offset:8704
  ds_read_b64_tr_b16 a[112:113], v31 offset:0
  ds_read_b64_tr_b16 a[114:115], v31 offset:512
  ds_read_b64_tr_b16 a[116:117], v31 offset:8192
  ds_read_b64_tr_b16 a[118:119], v31 offset:8704
  s_branch L_wr_6_e
L_wr_6_1:
  s_cmp_lg_u32 s44, 1
  s_cbranch_scc1 L_wr_6_2
  ds_read_b64_tr_b16 a[32:33], v30 offset:0
  ds_read_b64_tr_b16 a[34:35], v30 offset:512
  ds_read_b64_tr_b16 a[36:37], v30 offset:8192
  ds_read_b64_tr_b16 a[38:39], v30 offset:8704
  ds_read_b64_tr_b16 a[96:97], v31 offset:0
  ds_read_b64_tr_b16 a[98:99], v31 offset:512
  ds_read_b64_tr_b16 a[100:101], v31 offset:8192
  ds_read_b64_tr_b16 a[102:103], v31 offset:8704
  s_branch L_wr_6_e
L_wr_6_2:
  s_cmp_lg_u32 s44, 2
  s_cbranch_scc1 L_wr_6_3
  ds_read_b64_tr_b16 a[16:17], v30 offset:0
  ds_read_b64_tr_b16 a[18:19], v30 offset:512
  ds_read_b64_tr_b16 a[20:21], v30 offset:8192
  ds_read_b64_tr_b16 a[22:23], v30 offset:8704
  ds_read_b64_tr_b16 a[80:81], v31 offset:0
  ds_read_b64_tr_b16 a[82:83], v31 offset:512
  ds_read_b64_tr_b16 a[84:85], v31 offset:8192
  ds_read_b64_tr_b16 a[86:87], v31 offset:8704
  s_branch L_wr_6_e
L_wr_6_3:
  ds_read_b64_tr_b16 a[0:1], v30 offset:0
  ds_read_b64_tr_b16 a[2:3], v30 offset:512
  ds_read_b64_tr_b16 a[4:5], v30 offset:8192
  ds_read_b64_tr_b16 a[6:7], v30 offset:8704
  ds_read_b64_tr_b16 a[64:65], v31 offset:0
  ds_read_b64_tr_b16 a[66:67], v31 offset:512
  ds_read_b64_tr_b16 a[68:69], v31 offset:8192
  ds_read_b64_tr_b16 a[70:71], v31 offset:8704
L_wr_6_e:
  s_waitcnt lgkmcnt(0)
  s_waitcnt vmcnt(24)
  s_barrier
  s_add_u32 m0, s56, 98304
  s_mov_b32 s68, 3145728
  buffer_load_dwordx4 v26, s[48:51], s68 offen lds
  s_add_u32 m0, s56, 102400
  s_mov_b32 s68, 3211264
  buffer_load_dwordx4 v26, s[48:51], s68 offen lds
  s_add_u32 m0, s56, 106496
  s_mov_b32 s68, 3407872
  buffer_load_dwordx4 v26, s[48:51], s68 offen lds
  s_add_u32 m0, s56, 110592
  s_mov_b32 s68, 3473408
  buffer_load_dwordx4 v26, s[48:51], s68 offen lds
  v_add_u32 v30, 114688, v28
  v_add_u32 v31, 114688, v29
  s_cmp_lg_u32 s44, 0
  s_cbranch_scc1 L_wr_7_1
  ds_read_b64_tr_b16 a[56:57], v30 offset:0
  ds_read_b64_tr_b16 a[58:59], v30 offset:512
  ds_read_b64_tr_b16 a[60:61], v30 offset:8192
  ds_read_b64_tr_b16 a[62:63], v30 offset:8704
  ds_read_b64_tr_b16 a[120:121], v31 offset:0
  ds_read_b64_tr_b16 a[122:123], v31 offset:512
  ds_read_b64_tr_b16 a[124:125], v31 offset:8192
  ds_read_b64_tr_b16 a[126:127], v31 offset:8704
  s_branch L_wr_7_e
L_wr_7_1:
  s_cmp_lg_u32 s44, 1
  s_cbranch_scc1 L_wr_7_2
  ds_read_b64_tr_b16 a[40:41], v30 offset:0
  ds_read_b64_tr_b16 a[42:43], v30 offset:512
  ds_read_b64_tr_b16 a[44:45], v30 offset:8192
  ds_read_b64_tr_b16 a[46:47], v30 offset:8704
  ds_read_b64_tr_b16 a[104:105], v31 offset:0
  ds_read_b64_tr_b16 a[106:107], v31 offset:512
  ds_read_b64_tr_b16 a[108:109], v31 offset:8192
  ds_read_b64_tr_b16 a[110:111], v31 offset:8704
  s_branch L_wr_7_e
L_wr_7_2:
  s_cmp_lg_u32 s44, 2
  s_cbranch_scc1 L_wr_7_3
  ds_read_b64_tr_b16 a[24:25], v30 offset:0
  ds_read_b64_tr_b16 a[26:27], v30 offset:512
  ds_read_b64_tr_b16 a[28:29], v30 offset:8192
  ds_read_b64_tr_b16 a[30:31], v30 offset:8704
  ds_read_b64_tr_b16 a[88:89], v31 offset:0
  ds_read_b64_tr_b16 a[90:91], v31 offset:512
  ds_read_b64_tr_b16 a[92:93], v31 offset:8192
  ds_read_b64_tr_b16 a[94:95], v31 offset:8704
  s_branch L_wr_7_e
L_wr_7_3:
  ds_read_b64_tr_b16 a[8:9], v30 offset:0
  ds_read_b64_tr_b16 a[10:11], v30 offset:512
  ds_read_b64_tr_b16 a[12:13], v30 offset:8192
  ds_read_b64_tr_b16 a[14:15], v30 offset:8704
  ds_read_b64_tr_b16 a[72:73], v31 offset:0
  ds_read_b64_tr_b16 a[74:75], v31 offset:512
  ds_read_b64_tr_b16 a[76:77], v31 offset:8192
  ds_read_b64_tr_b16 a[78:79], v31 offset:8704
L_wr_7_e:
  s_waitcnt lgkmcnt(0)
  s_waitcnt vmcnt(24)
  s_barrier
  s_add_u32 m0, s56, 114688
  s_mov_b32 s68, 3670016
  buffer_load_dwordx4 v26, s[48:51], s68 offen lds
  s_add_u32 m0, s56, 118784
  s_mov_b32 s68, 3735552
  buffer_load_dwordx4 v26, s[48:51], s68 offen lds
  s_add_u32 m0, s56, 122880
  s_mov_b32 s68, 3932160
  buffer_load_dwordx4 v26, s[48:51], s68 offen lds
  s_add_u32 m0, s56, 126976
  s_mov_b32 s68, 3997696
  buffer_load_dwordx4 v26, s[48:51], s68 offen lds
  v_add_u32 v30, 0, v28
  v_add_u32 v31, 0, v29
  s_cmp_lg_u32 s44, 0
  s_cbranch_scc1 L_wr_8_1
  ds_read_b64_tr_b16 a[128:129], v30 offset:0
  ds_read_b64_tr_b16 a[130:131], v30 offset:512
  ds_read_b64_tr_b16 a[132:133], v30 offset:8192
  ds_read_b64_tr_b16 a[134:135], v30 offset:8704
  ds_read_b64_tr_b16 a[192:193], v31 offset:0
  ds_read_b64_tr_b16 a[194:195], v31 offset:512
  ds_read_b64_tr_b16 a[196:197], v31 offset:8192
  ds_read_b64_tr_b16 a[198:199], v31 offset:8704
  s_branch L_wr_8_e
L_wr_8_1:
  s_cmp_lg_u32 s44, 1
  s_cbranch_scc1 L_wr_8_2
  ds_read_b64_tr_b16 a[144:145], v30 offset:0
  ds_read_b64_tr_b16 a[146:147], v30 offset:512
  ds_read_b64_tr_b16 a[148:149], v30 offset:8192
  ds_read_b64_tr_b16 a[150:151], v30 offset:8704
  ds_read_b64_tr_b16 a[208:209], v31 offset:0
  ds_read_b64_tr_b16 a[210:211], v31 offset:512
  ds_read_b64_tr_b16 a[212:213], v31 offset:8192
  ds_read_b64_tr_b16 a[214:215], v31 offset:8704
  s_branch L_wr_8_e
L_wr_8_2:
  s_cmp_lg_u32 s44, 2
  s_cbranch_scc1 L_wr_8_3
  ds_read_b64_tr_b16 a[160:161], v30 offset:0
  ds_read_b64_tr_b16 a[162:163], v30 offset:512
  ds_read_b64_tr_b16 a[164:165], v30 offset:8192
  ds_read_b64_tr_b16 a[166:167], v30 offset:8704
  ds_read_b64_tr_b16 a[224:225], v31 offset:0
  ds_read_b64_tr_b16 a[226:227], v31 offset:512
  ds_read_b64_tr_b16 a[228:229], v31 offset:8192
  ds_read_b64_tr_b16 a[230:231], v31 offset:8704
  s_branch L_wr_8_e
L_wr_8_3:
  ds_read_b64_tr_b16 a[176:177], v30 offset:0
  ds_read_b64_tr_b16 a[178:179], v30 offset:512
  ds_read_b64_tr_b16 a[180:181], v30 offset:8192
  ds_read_b64_tr_b16 a[182:183], v30 offset:8704
  ds_read_b64_tr_b16 a[240:241], v31 offset:0
  ds_read_b64_tr_b16 a[242:243], v31 offset:512
  ds_read_b64_tr_b16 a[244:245], v31 offset:8192
  ds_read_b64_tr_b16 a[246:247], v31 offset:8704
L_wr_8_e:
  s_waitcnt lgkmcnt(0)
  s_waitcnt vmcnt(24)
  s_barrier
  s_mov_b32 s48, s30
  s_and_b32 s49, s31, 0xffff
  s_add_u32 m0, s56, 0
  s_mov_b32 s68, 0
  buffer_load_dwordx4 v27, s[48:51], s68 offen lds
  s_add_u32 m0, s56, 4096
  s_mov_b32 s68, 4096
  buffer_load_dwordx4 v27, s[48:51], s68 offen lds
  s_add_u32 m0, s56, 8192
  s_mov_b32 s68, 8192
  buffer_load_dwordx4 v27, s[48:51], s68 offen lds
  s_add_u32 m0, s56, 12288
  s_mov_b32 s68, 12288
  buffer_load_dwordx4 v27, s[48:51], s68 offen lds
  v_add_u32 v30, 16384, v28
  v_add_u32 v31, 16384, v29
  s_cmp_lg_u32 s44, 0
  s_cbranch_scc1 L_wr_9_1
  ds_read_b64_tr_b16 a[136:137], v30 offset:0
  ds_read_b64_tr_b16 a[138:139], v30 offset:512
  ds_read_b64_tr_b16 a[140:141], v30 offset:8192
  ds_read_b64_tr_b16 a[142:143], v30 offset:8704
  ds_read_b64_tr_b16 a[200:201], v31 offset:0
  ds_read_b64_tr_b16 a[202:203], v31 offset:512
  ds_read_b64_tr_b16 a[204:205], v31 offset:8192
  ds_read_b64_tr_b16 a[206:207], v31 offset:8704
  s_branch L_wr_9_e
L_wr_9_1:
  s_cmp_lg_u32 s44, 1
  s_cbranch_scc1 L_wr_9_2
  ds_read_b64_tr_b16 a[152:153], v30 offset:0
  ds_read_b64_tr_b16 a[154:155], v30 offset:512
  ds_read_b64_tr_b16 a[156:157], v30 offset:8192
  ds_read_b64_tr_b16 a[158:159], v30 offset:8704
  ds_read_b64_tr_b16 a[216:217], v31 offset:0
  ds_read_b64_tr_b16 a[218:219], v31 offset:512
  ds_read_b64_tr_b16 a[220:221], v31 offset:8192
  ds_read_b64_tr_b16 a[222:223], v31 offset:8704
  s_branch L_wr_9_e
L_wr_9_2:
  s_cmp_lg_u32 s44, 2
  s_cbranch_scc1 L_wr_9_3
  ds_read_b64_tr_b16 a[168:169], v30 offset:0
  ds_read_b64_tr_b16 a[170:171], v30 offset:512
  ds_read_b64_tr_b16 a[172:173], v30 offset:8192
  ds_read_b64_tr_b16 a[174:175], v30 offset:8704
  ds_read_b64_tr_b16 a[232:233], v31 offset:0
  ds_read_b64_tr_b16 a[234:235], v31 offset:512
  ds_read_b64_tr_b16 a[236:237], v31 offset:8192
  ds_read_b64_tr_b16 a[238:239], v31 offset:8704
  s_branch L_wr_9_e
L_wr_9_3:
  ds_read_b64_tr_b16 a[184:185], v30 offset:0
  ds_read_b64_tr_b16 a[186:187], v30 offset:512
  ds_read_b64_tr_b16 a[188:189], v30 offset:8192
  ds_read_b64_tr_b16 a[190:191], v30 offset:8704
  ds_read_b64_tr_b16 a[248:249], v31 offset:0
  ds_read_b64_tr_b16 a[250:251], v31 offset:512
  ds_read_b64_tr_b16 a[252:253], v31 offset:8192
  ds_read_b64_tr_b16 a[254:255], v31 offset:8704
L_wr_9_e:
  s_waitcnt lgkmcnt(0)
  s_waitcnt vmcnt(24)
  s_barrier
  s_add_u32 m0, s56, 16384
  s_mov_b32 s68, 65536
  buffer_load_dwordx4 v27, s[48:51], s68 offen lds
  s_add_u32 m0, s56, 20480
  s_mov_b32 s68, 69632
  buffer_load_dwordx4 v27, s[48:51], s68 offen lds
  s_add_u32 m0, s56, 24576
  s_mov_b32 s68, 73728
  buffer_load_dwordx4 v27, s[48:51], s68 offen lds
  s_add_u32 m0, s56, 28672
  s_mov_b32 s68, 77824
  buffer_load_dwordx4 v27, s[48:51], s68 offen lds
  v_add_u32 v30, 32768, v28
  v_add_u32 v31, 32768, v29
  s_cmp_lg_u32 s44, 0
  s_cbranch_scc1 L_wr_10_1
  ds_read_b64_tr_b16 a[144:145], v30 offset:0
  ds_read_b64_tr_b16 a[146:147], v30 offset:512
  ds_read_b64_tr_b16 a[148:149], v30 offset:8192
  ds_read_b64_tr_b16 a[150:151], v30 offset:8704
  ds_read_b64_tr_b16 a[208:209], v31 offset:0
  ds_read_b64_tr_b16 a[210:211], v31 offset:512
  ds_read_b64_tr_b16 a[212:213], v31 offset:8192
  ds_read_b64_tr_b16 a[214:215], v31 offset:8704
  s_branch L_wr_10_e
L_wr_10_1:
  s_cmp_lg_u32 s44, 1
  s_cbranch_scc1 L_wr_10_2
  ds_read_b64_tr_b16 a[128:129], v30 offset:0
  ds_read_b64_tr_b16 a[130:131], v30 offset:512
  ds_read_b64_tr_b16 a[132:133], v30 offset:8192
  ds_read_b64_tr_b16 a[134:135], v30 offset:8704
  ds_read_b64_tr_b16 a[192:193], v31 offset:0
  ds_read_b64_tr_b16 a[194:195], v31 offset:512
  ds_read_b64_tr_b16 a[196:197], v31 offset:8192
  ds_read_b64_tr_b16 a[198:199], v31 offset:8704
  s_branch L_wr_10_e
L_wr_10_2:
  s_cmp_lg_u32 s44, 2
  s_cbranch_scc1 L_wr_10_3
  ds_read_b64_tr_b16 a[176:177], v30 offset:0
  ds_read_b64_tr_b16 a[178:179], v30 offset:512
  ds_read_b64_tr_b16 a[180:181], v30 offset:8192
  ds_read_b64_tr_b16 a[182:183], v30 offset:8704
  ds_read_b64_tr_b16 a[240:241], v31 offset:0
  ds_read_b64_tr_b16 a[242:243], v31 offset:512
  ds_read_b64_tr_b16 a[244:245], v31 offset:8192
  ds_read_b64_tr_b16 a[246:247], v31 offset:8704
  s_branch L_wr_10_e
L_wr_10_3:
  ds_read_b64_tr_b16 a[160:161], v30 offset:0
  ds_read_b64_tr_b16 a[162:163], v30 offset:512
  ds_read_b64_tr_b16 a[164:165], v30 offset:8192
  ds_read_b64_tr_b16 a[166:167], v30 offset:8704
  ds_read_b64_tr_b16 a[224:225], v31 offset:0
  ds_read_b64_tr_b16 a[226:227], v31 offset:512
  ds_read_b64_tr_b16 a[228:229], v31 offset:8192
  ds_read_b64_tr_b16 a[230:231], v31 offset:8704
L_wr_10_e:
  s_waitcnt lgkmcnt(0)
  s_waitcnt vmcnt(24)
  s_barrier
  s_add_u32 m0, s56, 32768
  s_mov_b32 s68, 256
  buffer_load_dwordx4 v27, s[48:51], s68 offen lds
  s_add_u32 m0, s56, 36864
  s_mov_b32 s68, 4352
  buffer_load_dwordx4 v27, s[48:51], s68 offen lds
  s_add_u32 m0, s56, 40960
  s_mov_b32 s68, 8448
  buffer_load_dwordx4 v27, s[48:51], s68 offen lds
  s_add_u32 m0, s56, 45056
  s_mov_b32 s68, 12544
  buffer_load_dwordx4 v27, s[48:51], s68 offen lds
  v_add_u32 v30, 49152, v28
  v_add_u32 v31, 49152, v29
  s_cmp_lg_u32 s44, 0
  s_cbranch_scc1 L_wr_11_1
  ds_read_b64_tr_b16 a[152:153], v30 offset:0
  ds_read_b64_tr_b16 a[154:155], v30 offset:512
  ds_read_b64_tr_b16 a[156:157], v30 offset:8192
  ds_read_b64_tr_b16 a[158:159], v30 offset:8704
  ds_read_b64_tr_b16 a[216:217], v31 offset:0
  ds_read_b64_tr_b16 a[218:219], v31 offset:512
  ds_read_b64_tr_b16 a[220:221], v31 offset:8192
  ds_read_b64_tr_b16 a[222:223], v31 offset:8704
  s_branch L_wr_11_e
L_wr_11_1:
  s_cmp_lg_u32 s44, 1
  s_cbranch_scc1 L_wr_11_2
  ds_read_b64_tr_b16 a[136:137], v30 offset:0
  ds_read_b64_tr_b16 a[138:139], v30 offset:512
  ds_read_b64_tr_b16 a[140:141], v30 offset:8192
  ds_read_b64_tr_b16 a[142:143], v30 offset:8704
  ds_read_b64_tr_b16 a[200:201], v31 offset:0
  ds_read_b64_tr_b16 a[202:203], v31 offset:512
  ds_read_b64_tr_b16 a[204:205], v31 offset:8192
  ds_read_b64_tr_b16 a[206:207], v31 offset:8704
  s_branch L_wr_11_e
L_wr_11_2:
  s_cmp_lg_u32 s44, 2
  s_cbranch_scc1 L_wr_11_3
  ds_read_b64_tr_b16 a[184:185], v30 offset:0
  ds_read_b64_tr_b16 a[186:187], v30 offset:512
  ds_read_b64_tr_b16 a[188:189], v30 offset:8192
  ds_read_b64_tr_b16 a[190:191], v30 offset:8704
  ds_read_b64_tr_b16 a[248:249], v31 offset:0
  ds_read_b64_tr_b16 a[250:251], v31 offset:512
  ds_read_b64_tr_b16 a[252:253], v31 offset:8192
  ds_read_b64_tr_b16 a[254:255], v31 offset:8704
  s_branch L_wr_11_e
L_wr_11_3:
  ds_read_b64_tr_b16 a[168:169], v30 offset:0
  ds_read_b64_tr_b16 a[170:171], v30 offset:512
  ds_read_b64_tr_b16 a[172:173], v30 offset:8192
  ds_read_b64_tr_b16 a[174:175], v30 offset:8704
  ds_read_b64_tr_b16 a[232:233], v31 offset:0
  ds_read_b64_tr_b16 a[234:235], v31 offset:512
  ds_read_b64_tr_b16 a[236:237], v31 offset:8192
  ds_read_b64_tr_b16 a[238:239], v31 offset:8704
L_wr_11_e:
  s_waitcnt lgkmcnt(0)
  s_waitcnt vmcnt(24)
  s_barrier
  s_add_u32 m0, s56, 49152
  s_mov_b32 s68, 65792
  buffer_load_dwordx4 v27, s[48:51], s68 offen lds
  s_add_u32 m0, s56, 53248
  s_mov_b32 s68, 69888
  buffer_load_dwordx4 v27, s[48:51], s68 offen lds
  s_add_u32 m0, s56, 57344
  s_mov_b32 s68, 73984
  buffer_load_dwordx4 v27, s[48:51], s68 offen lds
  s_add_u32 m0, s56, 61440
  s_mov_b32 s68, 78080
  buffer_load_dwordx4 v27, s[48:51], s68 offen lds
  v_add_u32 v30, 65536, v28
  v_add_u32 v31, 65536, v29
  s_cmp_lg_u32 s44, 0
  s_cbranch_scc1 L_wr_12_1
  ds_read_b64_tr_b16 a[160:161], v30 offset:0
  ds_read_b64_tr_b16 a[162:163], v30 offset:512
  ds_read_b64_tr_b16 a[164:165], v30 offset:8192
  ds_read_b64_tr_b16 a[166:167], v30 offset:8704
  ds_read_b64_tr_b16 a[224:225], v31 offset:0
  ds_read_b64_tr_b16 a[226:227], v31 offset:512
  ds_read_b64_tr_b16 a[228:229], v31 offset:8192
  ds_read_b64_tr_b16 a[230:231], v31 offset:8704
  s_branch L_wr_12_e
L_wr_12_1:
  s_cmp_lg_u32 s44, 1
  s_cbranch_scc1 L_wr_12_2
  ds_read_b64_tr_b16 a[176:177], v30 offset:0
  ds_read_b64_tr_b16 a[178:179], v30 offset:512
  ds_read_b64_tr_b16 a[180:181], v30 offset:8192
  ds_read_b64_tr_b16 a[182:183], v30 offset:8704
  ds_read_b64_tr_b16 a[240:241], v31 offset:0
  ds_read_b64_tr_b16 a[242:243], v31 offset:512
  ds_read_b64_tr_b16 a[244:245], v31 offset:8192
  ds_read_b64_tr_b16 a[246:247], v31 offset:8704
  s_branch L_wr_12_e
L_wr_12_2:
  s_cmp_lg_u32 s44, 2
  s_cbranch_scc1 L_wr_12_3
  ds_read_b64_tr_b16 a[128:129], v30 offset:0
  ds_read_b64_tr_b16 a[130:131], v30 offset:512
  ds_read_b64_tr_b16 a[132:133], v30 offset:8192
  ds_read_b64_tr_b16 a[134:135], v30 offset:8704
  ds_read_b64_tr_b16 a[192:193], v31 offset:0
  ds_read_b64_tr_b16 a[194:195], v31 offset:512
  ds_read_b64_tr_b16 a[196:197], v31 offset:8192
  ds_read_b64_tr_b16 a[198:199], v31 offset:8704
  s_branch L_wr_12_e
L_wr_12_3:
  ds_read_b64_tr_b16 a[144:145], v30 offset:0
  ds_read_b64_tr_b16 a[146:147], v30 offset:512
  ds_read_b64_tr_b16 a[148:149], v30 offset:8192
  ds_read_b64_tr_b16 a[150:151], v30 offset:8704
  ds_read_b64_tr_b16 a[208:209], v31 offset:0
  ds_read_b64_tr_b16 a[210:211], v31 offset:512
  ds_read_b64_tr_b16 a[212:213], v31 offset:8192
  ds_read_b64_tr_b16 a[214:215], v31 offset:8704
L_wr_12_e:
  s_waitcnt lgkmcnt(0)
  s_waitcnt vmcnt(24)
  s_barrier
  s_add_u32 m0, s56, 65536
  s_mov_b32 s68, 512
  buffer_load_dwordx4 v27, s[48:51], s68 offen lds
  s_add_u32 m0, s56, 69632
  s_mov_b32 s68, 4608
  buffer_load_dwordx4 v27, s[48:51], s68 offen lds
  s_add_u32 m0, s56, 73728
  s_mov_b32 s68, 8704
  buffer_load_dwordx4 v27, s[48:51], s68 offen lds
  s_add_u32 m0, s56, 77824
  s_mov_b32 s68, 12800
  buffer_load_dwordx4 v27, s[48:51], s68 offen lds
  v_add_u32 v30, 81920, v28
  v_add_u32 v31, 81920, v29
  s_cmp_lg_u32 s44, 0
  s_cbranch_scc1 L_wr_13_1
  ds_read_b64_tr_b16 a[168:169], v30 offset:0
  ds_read_b64_tr_b16 a[170:171], v30 offset:512
  ds_read_b64_tr_b16 a[172:173], v30 offset:8192
  ds_read_b64_tr_b16 a[174:175], v30 offset:8704
  ds_read_b64_tr_b16 a[232:233], v31 offset:0
  ds_read_b64_tr_b16 a[234:235], v31 offset:512
  ds_read_b64_tr_b16 a[236:237], v31 offset:8192
  ds_read_b64_tr_b16 a[238:239], v31 offset:8704
  s_branch L_wr_13_e
L_wr_13_1:
  s_cmp_lg_u32 s44, 1
  s_cbranch_scc1 L_wr_13_2
  ds_read_b64_tr_b16 a[184:185], v30 offset:0
  ds_read_b64_tr_b16 a[186:187], v30 offset:512
  ds_read_b64_tr_b16 a[188:189], v30 offset:8192
  ds_read_b64_tr_b16 a[190:191], v30 offset:8704
  ds_read_b64_tr_b16 a[248:249], v31 offset:0
  ds_read_b64_tr_b16 a[250:251], v31 offset:512
  ds_read_b64_tr_b16 a[252:253], v31 offset:8192
  ds_read_b64_tr_b16 a[254:255], v31 offset:8704
  s_branch L_wr_13_e
L_wr_13_2:
  s_cmp_lg_u32 s44, 2
  s_cbranch_scc1 L_wr_13_3
  ds_read_b64_tr_b16 a[136:137], v30 offset:0
  ds_read_b64_tr_b16 a[138:139], v30 offset:512
  ds_read_b64_tr_b16 a[140:141], v30 offset:8192
  ds_read_b64_tr_b16 a[142:143], v30 offset:8704
  ds_read_b64_tr_b16 a[200:201], v31 offset:0
  ds_read_b64_tr_b16 a[202:203], v31 offset:512
  ds_read_b64_tr_b16 a[204:205], v31 offset:8192
  ds_read_b64_tr_b16 a[206:207], v31 offset:8704
  s_branch L_wr_13_e
L_wr_13_3:
  ds_read_b64_tr_b16 a[152:153], v30 offset:0
  ds_read_b64_tr_b16 a[154:155], v30 offset:512
  ds_read_b64_tr_b16 a[156:157], v30 offset:8192
  ds_read_b64_tr_b16 a[158:159], v30 offset:8704
  ds_read_b64_tr_b16 a[216:217], v31 offset:0
  ds_read_b64_tr_b16 a[218:219], v31 offset:512
  ds_read_b64_tr_b16 a[220:221], v31 offset:8192
  ds_read_b64_tr_b16 a[222:223], v31 offset:8704
L_wr_13_e:
  s_waitcnt lgkmcnt(0)
  s_waitcnt vmcnt(24)
  s_barrier
  s_add_u32 m0, s56, 81920
  s_mov_b32 s68, 66048
  buffer_load_dwordx4 v27, s[48:51], s68 offen lds
  s_add_u32 m0, s56, 86016
  s_mov_b32 s68, 70144
  buffer_load_dwordx4 v27, s[48:51], s68 offen lds
  s_add_u32 m0, s56, 90112
  s_mov_b32 s68, 74240
  buffer_load_dwordx4 v27, s[48:51], s68 offen lds
  s_add_u32 m0, s56, 94208
  s_mov_b32 s68, 78336
  buffer_load_dwordx4 v27, s[48:51], s68 offen lds
  v_add_u32 v30, 98304, v28
  v_add_u32 v31, 98304, v29
  s_cmp_lg_u32 s44, 0
  s_cbranch_scc1 L_wr_14_1
  ds_read_b64_tr_b16 a[176:177], v30 offset:0
  ds_read_b64_tr_b16 a[178:179], v30 offset:512
  ds_read_b64_tr_b16 a[180:181], v30 offset:8192
  ds_read_b64_tr_b16 a[182:183], v30 offset:8704
  ds_read_b64_tr_b16 a[240:241], v31 offset:0
  ds_read_b64_tr_b16 a[242:243], v31 offset:512
  ds_read_b64_tr_b16 a[244:245], v31 offset:8192
  ds_read_b64_tr_b16 a[246:247], v31 offset:8704
  s_branch L_wr_14_e
L_wr_14_1:
  s_cmp_lg_u32 s44, 1
  s_cbranch_scc1 L_wr_14_2
  ds_read_b64_tr_b16 a[160:161], v30 offset:0
  ds_read_b64_tr_b16 a[162:163], v30 offset:512
  ds_read_b64_tr_b16 a[164:165], v30 offset:8192
  ds_read_b64_tr_b16 a[166:167], v30 offset:8704
  ds_read_b64_tr_b16 a[224:225], v31 offset:0
  ds_read_b64_tr_b16 a[226:227], v31 offset:512
  ds_read_b64_tr_b16 a[228:229], v31 offset:8192
  ds_read_b64_tr_b16 a[230:231], v31 offset:8704
  s_branch L_wr_14_e
L_wr_14_2:
  s_cmp_lg_u32 s44, 2
  s_cbranch_scc1 L_wr_14_3
  ds_read_b64_tr_b16 a[144:145], v30 offset:0
  ds_read_b64_tr_b16 a[146:147], v30 offset:512
  ds_read_b64_tr_b16 a[148:149], v30 offset:8192
  ds_read_b64_tr_b16 a[150:151], v30 offset:8704
  ds_read_b64_tr_b16 a[208:209], v31 offset:0
  ds_read_b64_tr_b16 a[210:211], v31 offset:512
  ds_read_b64_tr_b16 a[212:213], v31 offset:8192
  ds_read_b64_tr_b16 a[214:215], v31 offset:8704
  s_branch L_wr_14_e
L_wr_14_3:
  ds_read_b64_tr_b16 a[128:129], v30 offset:0
  ds_read_b64_tr_b16 a[130:131], v30 offset:512
  ds_read_b64_tr_b16 a[132:133], v30 offset:8192
  ds_read_b64_tr_b16 a[134:135], v30 offset:8704
  ds_read_b64_tr_b16 a[192:193], v31 offset:0
  ds_read_b64_tr_b16 a[194:195], v31 offset:512
  ds_read_b64_tr_b16 a[196:197], v31 offset:8192
  ds_read_b64_tr_b16 a[198:199], v31 offset:8704
L_wr_14_e:
  s_waitcnt lgkmcnt(0)
  s_waitcnt vmcnt(24)
  s_barrier
  s_add_u32 m0, s56, 98304
  s_mov_b32 s68, 768
  buffer_load_dwordx4 v27, s[48:51], s68 offen lds
  s_add_u32 m0, s56, 102400
  s_mov_b32 s68, 4864
  buffer_load_dwordx4 v27, s[48:51], s68 offen lds
  s_add_u32 m0, s56, 106496
  s_mov_b32 s68, 8960
  buffer_load_dwordx4 v27, s[48:51], s68 offen lds
  s_add_u32 m0, s56, 110592
  s_mov_b32 s68, 13056
  buffer_load_dwordx4 v27, s[48:51], s68 offen lds
  v_add_u32 v30, 114688, v28
  v_add_u32 v31, 114688, v29
  s_cmp_lg_u32 s44, 0
  s_cbranch_scc1 L_wr_15_1
  ds_read_b64_tr_b16 a[184:185], v30 offset:0
  ds_read_b64_tr_b16 a[186:187], v30 offset:512
  ds_read_b64_tr_b16 a[188:189], v30 offset:8192
  ds_read_b64_tr_b16 a[190:191], v30 offset:8704
  ds_read_b64_tr_b16 a[248:249], v31 offset:0
  ds_read_b64_tr_b16 a[250:251], v31 offset:512
  ds_read_b64_tr_b16 a[252:253], v31 offset:8192
  ds_read_b64_tr_b16 a[254:255], v31 offset:8704
  s_branch L_wr_15_e
L_wr_15_1:
  s_cmp_lg_u32 s44, 1
  s_cbranch_scc1 L_wr_15_2
  ds_read_b64_tr_b16 a[168:169], v30 offset:0
  ds_read_b64_tr_b16 a[170:171], v30 offset:512
  ds_read_b64_tr_b16 a[172:173], v30 offset:8192
  ds_read_b64_tr_b16 a[174:175], v30 offset:8704
  ds_read_b64_tr_b16 a[232:233], v31 offset:0
  ds_read_b64_tr_b16 a[234:235], v31 offset:512
  ds_read_b64_tr_b16 a[236:237], v31 offset:8192
  ds_read_b64_tr_b16 a[238:239], v31 offset:8704
  s_branch L_wr_15_e
L_wr_15_2:
  s_cmp_lg_u32 s44, 2
  s_cbranch_scc1 L_wr_15_3
  ds_read_b64_tr_b16 a[152:153], v30 offset:0
  ds_read_b64_tr_b16 a[154:155], v30 offset:512
  ds_read_b64_tr_b16 a[156:157], v30 offset:8192
  ds_read_b64_tr_b16 a[158:159], v30 offset:8704
  ds_read_b64_tr_b16 a[216:217], v31 offset:0
  ds_read_b64_tr_b16 a[218:219], v31 offset:512
  ds_read_b64_tr_b16 a[220:221], v31 offset:8192
  ds_read_b64_tr_b16 a[222:223], v31 offset:8704
  s_branch L_wr_15_e
L_wr_15_3:
  ds_read_b64_tr_b16 a[136:137], v30 offset:0
  ds_read_b64_tr_b16 a[138:139], v30 offset:512
  ds_read_b64_tr_b16 a[140:141], v30 offset:8192
  ds_read_b64_tr_b16 a[142:143], v30 offset:8704
  ds_read_b64_tr_b16 a[200:201], v31 offset:0
  ds_read_b64_tr_b16 a[202:203], v31 offset:512
  ds_read_b64_tr_b16 a[204:205], v31 offset:8192
  ds_read_b64_tr_b16 a[206:207], v31 offset:8704
L_wr_15_e:
  s_waitcnt lgkmcnt(0)
  s_waitcnt vmcnt(24)
  s_barrier
  s_add_u32 m0, s56, 114688
  s_mov_b32 s68, 66304
  buffer_load_dwordx4 v27, s[48:51], s68 offen lds
  s_add_u32 m0, s56, 118784
  s_mov_b32 s68, 70400
  buffer_load_dwordx4 v27, s[48:51], s68 offen lds
  s_add_u32 m0, s56, 122880
  s_mov_b32 s68, 74496
  buffer_load_dwordx4 v27, s[48:51], s68 offen lds
  s_add_u32 m0, s56, 126976
  s_mov_b32 s68, 78592
  buffer_load_dwordx4 v27, s[48:51], s68 offen lds
  v_add_u32 v30, 0, v32
  v_add_u32 v31, 0, v33
  s_cmp_lg_u32 s44, 0
  s_cbranch_scc1 L_wr_16_1
  ds_read_b64_tr_b16 v[128:129], v30 offset:0
  ds_read_b64_tr_b16 v[130:131], v30 offset:512
  ds_read_b64_tr_b16 v[132:133], v30 offset:8192
  ds_read_b64_tr_b16 v[134:135], v30 offset:8704
  ds_read_b64_tr_b16 v[136:137], v31 offset:0
  ds_read_b64_tr_b16 v[138:139], v31 offset:512
  ds_read_b64_tr_b16 v[140:141], v31 offset:8192
  ds_read_b64_tr_b16 v[142:143], v31 offset:8704
  s_branch L_wr_16_e
L_wr_16_1:
  s_cmp_lg_u32 s44, 1
  s_cbranch_scc1 L_wr_16_2
  ds_read_b64_tr_b16 v[136:137], v30 offset:0
  ds_read_b64_tr_b16 v[138:139], v30 offset:512
  ds_read_b64_tr_b16 v[140:141], v30 offset:8192
  ds_read_b64_tr_b16 v[142:143], v30 offset:8704
  ds_read_b64_tr_b16 v[128:129], v31 offset:0
  ds_read_b64_tr_b16 v[130:131], v31 offset:512
  ds_read_b64_tr_b16 v[132:133], v31 offset:8192
  ds_read_b64_tr_b16 v[134:135], v31 offset:8704
  s_branch L_wr_16_e
L_wr_16_2:
  s_cmp_lg_u32 s44, 2
  s_cbranch_scc1 L_wr_16_3
  ds_read_b64_tr_b16 v[144:145], v30 offset:0
  ds_read_b64_tr_b16 v[146:147], v30 offset:512
  ds_read_b64_tr_b16 v[148:149], v30 offset:8192
  ds_read_b64_tr_b16 v[150:151], v30 offset:8704
  ds_read_b64_tr_b16 v[152:153], v31 offset:0
  ds_read_b64_tr_b16 v[154:155], v31 offset:512
  ds_read_b64_tr_b16 v[156:157], v31 offset:8192
  ds_read_b64_tr_b16 v[158:159], v31 offset:8704
  s_branch L_wr_16_e
L_wr_16_3:
  ds_read_b64_tr_b16 v[152:153], v30 offset:0
  ds_read_b64_tr_b16 v[154:155], v30 offset:512
  ds_read_b64_tr_b16 v[156:157], v30 offset:8192
  ds_read_b64_tr_b16 v[158:159], v30 offset:8704
  ds_read_b64_tr_b16 v[144:145], v31 offset:0
  ds_read_b64_tr_b16 v[146:147], v31 offset:512
  ds_read_b64_tr_b16 v[148:149], v31 offset:8192
  ds_read_b64_tr_b16 v[150:151], v31 offset:8704
L_wr_16_e:
  s_waitcnt lgkmcnt(0)
  s_waitcnt vmcnt(24)
  s_barrier
  s_mov_b32 s48, s28
  s_and_b32 s49, s29, 0xffff
  s_add_u32 m0, s56, 0
  s_mov_b32 s68, 0
  buffer_load_dwordx4 v26, s[48:51], s68 offen lds
  s_add_u32 m0, s56, 4096
  s_mov_b32 s68, 65536
  buffer_load_dwordx4 v26, s[48:51], s68 offen lds
  s_add_u32 m0, s56, 8192
  s_mov_b32 s68, 262144
  buffer_load_dwordx4 v26, s[48:51], s68 offen lds
  s_add_u32 m0, s56, 12288
  s_mov_b32 s68, 327680
  buffer_load_dwordx4 v26, s[48:51], s68 offen lds
  v_add_u32 v30, 16384, v32
  v_add_u32 v31, 16384, v33
  s_cmp_lg_u32 s44, 0
  s_cbranch_scc1 L_wr_17_1
  ds_read_b64_tr_b16 v[144:145], v30 offset:0
  ds_read_b64_tr_b16 v[146:147], v30 offset:512
  ds_read_b64_tr_b16 v[148:149], v30 offset:8192
  ds_read_b64_tr_b16 v[150:151], v30 offset:8704
  ds_read_b64_tr_b16 v[152:153], v31 offset:0
  ds_read_b64_tr_b16 v[154:155], v31 offset:512
  ds_read_b64_tr_b16 v[156:157], v31 offset:8192
  ds_read_b64_tr_b16 v[158:159], v31 offset:8704
  s_branch L_wr_17_e
L_wr_17_1:
  s_cmp_lg_u32 s44, 1
  s_cbranch_scc1 L_wr_17_2
  ds_read_b64_tr_b16 v[152:153], v30 offset:0
  ds_read_b64_tr_b16 v[154:155], v30 offset:512
  ds_read_b64_tr_b16 v[156:157], v30 offset:8192
  ds_read_b64_tr_b16 v[158:159], v30 offset:8704
  ds_read_b64_tr_b16 v[144:145], v31 offset:0
  ds_read_b64_tr_b16 v[146:147], v31 offset:512
  ds_read_b64_tr_b16 v[148:149], v31 offset:8192
  ds_read_b64_tr_b16 v[150:151], v31 offset:8704
  s_branch L_wr_17_e
L_wr_17_2:
  s_cmp_lg_u32 s44, 2
  s_cbranch_scc1 L_wr_17_3
  ds_read_b64_tr_b16 v[128:129], v30 offset:0
  ds_read_b64_tr_b16 v[130:131], v30 offset:512
  ds_read_b64_tr_b16 v[132:133], v30 offset:8192
  ds_read_b64_tr_b16 v[134:135], v30 offset:8704
  ds_read_b64_tr_b16 v[136:137], v31 offset:0
  ds_read_b64_tr_b16 v[138:139], v31 offset:512
  ds_read_b64_tr_b16 v[140:141], v31 offset:8192
  ds_read_b64_tr_b16 v[142:143], v31 offset:8704
  s_branch L_wr_17_e
L_wr_17_3:
  ds_read_b64_tr_b16 v[136:137], v30 offset:0
  ds_read_b64_tr_b16 v[138:139], v30 offset:512
  ds_read_b64_tr_b16 v[140:141], v30 offset:8192
  ds_read_b64_tr_b16 v[142:143], v30 offset:8704
  ds_read_b64_tr_b16 v[128:129], v31 offset:0
  ds_read_b64_tr_b16 v[130:131], v31 offset:512
  ds_read_b64_tr_b16 v[132:133], v31 offset:8192
  ds_read_b64_tr_b16 v[134:135], v31 offset:8704
L_wr_17_e:
  s_waitcnt lgkmcnt(0)
  s_waitcnt vmcnt(24)
  s_barrier
  s_add_u32 m0, s56, 16384
  s_mov_b32 s68, 524288
  buffer_load_dwordx4 v26, s[48:51], s68 offen lds
  s_add_u32 m0, s56, 20480
  s_mov_b32 s68, 589824
  buffer_load_dwordx4 v26, s[48:51], s68 offen lds
  s_add_u32 m0, s56, 24576
  s_mov_b32 s68, 786432
  buffer_load_dwordx4 v26, s[48:51], s68 offen lds
  s_add_u32 m0, s56, 28672
  s_mov_b32 s68, 851968
  buffer_load_dwordx4 v26, s[48:51], s68 offen lds
  v_add_u32 v30, 32768, v32
  v_add_u32 v31, 32768, v33
  s_cmp_lg_u32 s44, 0
  s_cbranch_scc1 L_wr_18_1
  ds_read_b64_tr_b16 v[160:161], v30 offset:0
  ds_read_b64_tr_b16 v[162:163], v30 offset:512
  ds_read_b64_tr_b16 v[164:165], v30 offset:8192
  ds_read_b64_tr_b16 v[166:167], v30 offset:8704
  ds_read_b64_tr_b16 v[168:169], v31 offset:0
  ds_read_b64_tr_b16 v[170:171], v31 offset:512
  ds_read_b64_tr_b16 v[172:173], v31 offset:8192
  ds_read_b64_tr_b16 v[174:175], v31 offset:8704
  s_branch L_wr_18_e
L_wr_18_1:
  s_cmp_lg_u32 s44, 1
  s_cbranch_scc1 L_wr_18_2
  ds_read_b64_tr_b16 v[168:169], v30 offset:0
  ds_read_b64_tr_b16 v[170:171], v30 offset:512
  ds_read_b64_tr_b16 v[172:173], v30 offset:8192
  ds_read_b64_tr_b16 v[174:175], v30 offset:8704
  ds_read_b64_tr_b16 v[160:161], v31 offset:0
  ds_read_b64_tr_b16 v[162:163], v31 offset:512
  ds_read_b64_tr_b16 v[164:165], v31 offset:8192
  ds_read_b64_tr_b16 v[166:167], v31 offset:8704
  s_branch L_wr_18_e
L_wr_18_2:
  s_cmp_lg_u32 s44, 2
  s_cbranch_scc1 L_wr_18_3
  ds_read_b64_tr_b16 v[176:177], v30 offset:0
  ds_read_b64_tr_b16 v[178:179], v30 offset:512
  ds_read_b64_tr_b16 v[180:181], v30 offset:8192
  ds_read_b64_tr_b16 v[182:183], v30 offset:8704
  ds_read_b64_tr_b16 v[184:185], v31 offset:0
  ds_read_b64_tr_b16 v[186:187], v31 offset:512
  ds_read_b64_tr_b16 v[188:189], v31 offset:8192
  ds_read_b64_tr_b16 v[190:191], v31 offset:8704
  s_branch L_wr_18_e
L_wr_18_3:
  ds_read_b64_tr_b16 v[184:185], v30 offset:0
  ds_read_b64_tr_b16 v[186:187], v30 offset:512
  ds_read_b64_tr_b16 v[188:189], v30 offset:8192
  ds_read_b64_tr_b16 v[190:191], v30 offset:8704
  ds_read_b64_tr_b16 v[176:177], v31 offset:0
  ds_read_b64_tr_b16 v[178:179], v31 offset:512
  ds_read_b64_tr_b16 v[180:181], v31 offset:8192
  ds_read_b64_tr_b16 v[182:183], v31 offset:8704
L_wr_18_e:
  s_waitcnt lgkmcnt(0)
  s_waitcnt vmcnt(24)
  s_barrier
  s_add_u32 m0, s56, 32768
  s_mov_b32 s68, 1048576
  buffer_load_dwordx4 v26, s[48:51], s68 offen lds
  s_add_u32 m0, s56, 36864
  s_mov_b32 s68, 1114112
  buffer_load_dwordx4 v26, s[48:51], s68 offen lds
  s_add_u32 m0, s56, 40960
  s_mov_b32 s68, 1310720
  buffer_load_dwordx4 v26, s[48:51], s68 offen lds
  s_add_u32 m0, s56, 45056
  s_mov_b32 s68, 1376256
  buffer_load_dwordx4 v26, s[48:51], s68 offen lds
  v_add_u32 v30, 49152, v32
  v_add_u32 v31, 49152, v33
  s_cmp_lg_u32 s44, 0
  s_cbranch_scc1 L_wr_19_1
  ds_read_b64_tr_b16 v[176:177], v30 offset:0
  ds_read_b64_tr_b16 v[178:179], v30 offset:512
  ds_read_b64_tr_b16 v[180:181], v30 offset:8192
  ds_read_b64_tr_b16 v[182:183], v30 offset:8704
  ds_read_b64_tr_b16 v[184:185], v31 offset:0
  ds_read_b64_tr_b16 v[186:187], v31 offset:512
  ds_read_b64_tr_b16 v[188:189], v31 offset:8192
  ds_read_b64_tr_b16 v[190:191], v31 offset:8704
  s_branch L_wr_19_e
L_wr_19_1:
  s_cmp_lg_u32 s44, 1
  s_cbranch_scc1 L_wr_19_2
  ds_read_b64_tr_b16 v[184:185], v30 offset:0
  ds_read_b64_tr_b16 v[186:187], v30 offset:512
  ds_read_b64_tr_b16 v[188:189], v30 offset:8192
  ds_read_b64_tr_b16 v[190:191], v30 offset:8704
  ds_read_b64_tr_b16 v[176:177], v31 offset:0
  ds_read_b64_tr_b16 v[178:179], v31 offset:512
  ds_read_b64_tr_b16 v[180:181], v31 offset:8192
  ds_read_b64_tr_b16 v[182:183], v31 offset:8704
  s_branch L_wr_19_e
L_wr_19_2:
  s_cmp_lg_u32 s44, 2
  s_cbranch_scc1 L_wr_19_3
  ds_read_b64_tr_b16 v[160:161], v30 offset:0
  ds_read_b64_tr_b16 v[162:163], v30 offset:512
  ds_read_b64_tr_b16 v[164:165], v30 offset:8192
  ds_read_b64_tr_b16 v[166:167], v30 offset:8704
  ds_read_b64_tr_b16 v[168:169], v31 offset:0
  ds_read_b64_tr_b16 v[170:171], v31 offset:512
  ds_read_b64_tr_b16 v[172:173], v31 offset:8192
  ds_read_b64_tr_b16 v[174:175], v31 offset:8704
  s_branch L_wr_19_e
L_wr_19_3:
  ds_read_b64_tr_b16 v[168:169], v30 offset:0
  ds_read_b64_tr_b16 v[170:171], v30 offset:512
  ds_read_b64_tr_b16 v[172:173], v30 offset:8192
  ds_read_b64_tr_b16 v[174:175], v30 offset:8704
  ds_read_b64_tr_b16 v[160:161], v31 offset:0
  ds_read_b64_tr_b16 v[162:163], v31 offset:512
  ds_read_b64_tr_b16 v[164:165], v31 offset:8192
  ds_read_b64_tr_b16 v[166:167], v31 offset:8704
L_wr_19_e:
  s_waitcnt lgkmcnt(0)
  s_waitcnt vmcnt(24)
  s_barrier
  s_add_u32 m0, s56, 49152
  s_mov_b32 s68, 1572864
  buffer_load_dwordx4 v26, s[48:51], s68 offen lds
  s_add_u32 m0, s56, 53248
  s_mov_b32 s68, 1638400
  buffer_load_dwordx4 v26, s[48:51], s68 offen lds
  s_add_u32 m0, s56, 57344
  s_mov_b32 s68, 1835008
  buffer_load_dwordx4 v26, s[48:51], s68 offen lds
  s_add_u32 m0, s56, 61440
  s_mov_b32 s68, 1900544
  buffer_load_dwordx4 v26, s[48:51], s68 offen lds
  v_add_u32 v30, 65536, v32
  v_add_u32 v31, 65536, v33
  s_cmp_lg_u32 s44, 0
  s_cbranch_scc1 L_wr_20_1
  ds_read_b64_tr_b16 v[192:193], v30 offset:0
  ds_read_b64_tr_b16 v[194:195], v30 offset:512
  ds_read_b64_tr_b16 v[196:197], v30 offset:8192
  ds_read_b64_tr_b16 v[198:199], v30 offset:8704
  ds_read_b64_tr_b16 v[200:201], v31 offset:0
  ds_read_b64_tr_b16 v[202:203], v31 offset:512
  ds_read_b64_tr_b16 v[204:205], v31 offset:8192
  ds_read_b64_tr_b16 v[206:207], v31 offset:8704
  s_branch L_wr_20_e
L_wr_20_1:
  s_cmp_lg_u32 s44, 1
  s_cbranch_scc1 L_wr_20_2
  ds_read_b64_tr_b16 v[200:201], v30 offset:0
  ds_read_b64_tr_b16 v[202:203], v30 offset:512
  ds_read_b64_tr_b16 v[204:205], v30 offset:8192
  ds_read_b64_tr_b16 v[206:207], v30 offset:8704
  ds_read_b64_tr_b16 v[192:193], v31 offset:0
  ds_read_b64_tr_b16 v[194:195], v31 offset:512
  ds_read_b64_tr_b16 v[196:197], v31 offset:8192
  ds_read_b64_tr_b16 v[198:199], v31 offset:8704
  s_branch L_wr_20_e
L_wr_20_2:
  s_cmp_lg_u32 s44, 2
  s_cbranch_scc1 L_wr_20_3
  ds_read_b64_tr_b16 v[208:209], v30 offset:0
  ds_read_b64_tr_b16 v[210:211], v30 offset:512
  ds_read_b64_tr_b16 v[212:213], v30 offset:8192
  ds_read_b64_tr_b16 v[214:215], v30 offset:8704
  ds_read_b64_tr_b16 v[216:217], v31 offset:0
  ds_read_b64_tr_b16 v[218:219], v31 offset:512
  ds_read_b64_tr_b16 v[220:221], v31 offset:8192
  ds_read_b64_tr_b16 v[222:223], v31 offset:8704
  s_branch L_wr_20_e
L_wr_20_3:
  ds_read_b64_tr_b16 v[216:217], v30 offset:0
  ds_read_b64_tr_b16 v[218:219], v30 offset:512
  ds_read_b64_tr_b16 v[220:221], v30 offset:8192
  ds_read_b64_tr_b16 v[222:223], v30 offset:8704
  ds_read_b64_tr_b16 v[208:209], v31 offset:0
  ds_read_b64_tr_b16 v[210:211], v31 offset:512
  ds_read_b64_tr_b16 v[212:213], v31 offset:8192
  ds_read_b64_tr_b16 v[214:215], v31 offset:8704
L_wr_20_e:
  s_waitcnt lgkmcnt(0)
  s_waitcnt vmcnt(24)
  s_barrier
  s_add_u32 m0, s56, 65536
  s_mov_b32 s68, 2097152
  buffer_load_dwordx4 v26, s[48:51], s68 offen lds
  s_add_u32 m0, s56, 69632
  s_mov_b32 s68, 2162688
  buffer_load_dwordx4 v26, s[48:51], s68 offen lds
  s_add_u32 m0, s56, 73728
  s_mov_b32 s68, 2359296
  buffer_load_dwordx4 v26, s[48:51], s68 offen lds
  s_add_u32 m0, s56, 77824
  s_mov_b32 s68, 2424832
  buffer_load_dwordx4 v26, s[48:51], s68 offen lds
  v_add_u32 v30, 81920, v32
  v_add_u32 v31, 81920, v33
  s_cmp_lg_u32 s44, 0
  s_cbranch_scc1 L_wr_21_1
  ds_read_b64_tr_b16 v[208:209], v30 offset:0
  ds_read_b64_tr_b16 v[210:211], v30 offset:512
  ds_read_b64_tr_b16 v[212:213], v30 offset:8192
  ds_read_b64_tr_b16 v[214:215], v30 offset:8704
  ds_read_b64_tr_b16 v[216:217], v31 offset:0
  ds_read_b64_tr_b16 v[218:219], v31 offset:512
  ds_read_b64_tr_b16 v[220:221], v31 offset:8192
  ds_read_b64_tr_b16 v[222:223], v31 offset:8704
  s_branch L_wr_21_e
L_wr_21_1:
  s_cmp_lg_u32 s44, 1
  s_cbranch_scc1 L_wr_21_2
  ds_read_b64_tr_b16 v[216:217], v30 offset:0
  ds_read_b64_tr_b16 v[218:219], v30 offset:512
  ds_read_b64_tr_b16 v[220:221], v30 offset:8192
  ds_read_b64_tr_b16 v[222:223], v30 offset:8704
  ds_read_b64_tr_b16 v[208:209], v31 offset:0
  ds_read_b64_tr_b16 v[210:211], v31 offset:512
  ds_read_b64_tr_b16 v[212:213], v31 offset:8192
  ds_read_b64_tr_b16 v[214:215], v31 offset:8704
  s_branch L_wr_21_e
L_wr_21_2:
  s_cmp_lg_u32 s44, 2
  s_cbranch_scc1 L_wr_21_3
  ds_read_b64_tr_b16 v[192:193], v30 offset:0
  ds_read_b64_tr_b16 v[194:195], v30 offset:512
  ds_read_b64_tr_b16 v[196:197], v30 offset:8192
  ds_read_b64_tr_b16 v[198:199], v30 offset:8704
  ds_read_b64_tr_b16 v[200:201], v31 offset:0
  ds_read_b64_tr_b16 v[202:203], v31 offset:512
  ds_read_b64_tr_b16 v[204:205], v31 offset:8192
  ds_read_b64_tr_b16 v[206:207], v31 offset:8704
  s_branch L_wr_21_e
L_wr_21_3:
  ds_read_b64_tr_b16 v[200:201], v30 offset:0
  ds_read_b64_tr_b16 v[202:203], v30 offset:512
  ds_read_b64_tr_b16 v[204:205], v30 offset:8192
  ds_read_b64_tr_b16 v[206:207], v30 offset:8704
  ds_read_b64_tr_b16 v[192:193], v31 offset:0
  ds_read_b64_tr_b16 v[194:195], v31 offset:512
  ds_read_b64_tr_b16 v[196:197], v31 offset:8192
  ds_read_b64_tr_b16 v[198:199], v31 offset:8704
L_wr_21_e:
  s_waitcnt lgkmcnt(0)
  s_waitcnt vmcnt(24)
  s_barrier
  s_add_u32 m0, s56, 81920
  s_mov_b32 s68, 2621440
  buffer_load_dwordx4 v26, s[48:51], s68 offen lds
  s_add_u32 m0, s56, 86016
  s_mov_b32 s68, 2686976
  buffer_load_dwordx4 v26, s[48:51], s68 offen lds
  s_add_u32 m0, s56, 90112
  s_mov_b32 s68, 2883584
  buffer_load_dwordx4 v26, s[48:51], s68 offen lds
  s_add_u32 m0, s56, 94208
  s_mov_b32 s68, 2949120
  buffer_load_dwordx4 v26, s[48:51], s68 offen lds
  v_add_u32 v30, 98304, v32
  v_add_u32 v31, 98304, v33
  s_cmp_lg_u32 s44, 0
  s_cbranch_scc1 L_wr_22_1
  ds_read_b64_tr_b16 v[224:225], v30 offset:0
  ds_read_b64_tr_b16 v[226:227], v30 offset:512
  ds_read_b64_tr_b16 v[228:229], v30 offset:8192
  ds_read_b64_tr_b16 v[230:231], v30 offset:8704
  ds_read_b64_tr_b16 v[232:233], v31 offset:0
  ds_read_b64_tr_b16 v[234:235], v31 offset:512
  ds_read_b64_tr_b16 v[236:237], v31 offset:8192
  ds_read_b64_tr_b16 v[238:239], v31 offset:8704
  s_branch L_wr_22_e
L_wr_22_1:
  s_cmp_lg_u32 s44, 1
  s_cbranch_scc1 L_wr_22_2
  ds_read_b64_tr_b16 v[232:233], v30 offset:0
  ds_read_b64_tr_b16 v[234:235], v30 offset:512
  ds_read_b64_tr_b16 v[236:237], v30 offset:8192
  ds_read_b64_tr_b16 v[238:239], v30 offset:8704
  ds_read_b64_tr_b16 v[224:225], v31 offset:0
  ds_read_b64_tr_b16 v[226:227], v31 offset:512
  ds_read_b64_tr_b16 v[228:229], v31 offset:8192
  ds_read_b64_tr_b16 v[230:231], v31 offset:8704
  s_branch L_wr_22_e
L_wr_22_2:
  s_cmp_lg_u32 s44, 2
  s_cbranch_scc1 L_wr_22_3
  ds_read_b64_tr_b16 v[240:241], v30 offset:0
  ds_read_b64_tr_b16 v[242:243], v30 offset:512
  ds_read_b64_tr_b16 v[244:245], v30 offset:8192
  ds_read_b64_tr_b16 v[246:247], v30 offset:8704
  ds_read_b64_tr_b16 v[248:249], v31 offset:0
  ds_read_b64_tr_b16 v[250:251], v31 offset:512
  ds_read_b64_tr_b16 v[252:253], v31 offset:8192
  ds_read_b64_tr_b16 v[254:255], v31 offset:8704
  s_branch L_wr_22_e
L_wr_22_3:
  ds_read_b64_tr_b16 v[248:249], v30 offset:0
  ds_read_b64_tr_b16 v[250:251], v30 offset:512
  ds_read_b64_tr_b16 v[252:253], v30 offset:8192
  ds_read_b64_tr_b16 v[254:255], v30 offset:8704
  ds_read_b64_tr_b16 v[240:241], v31 offset:0
  ds_read_b64_tr_b16 v[242:243], v31 offset:512
  ds_read_b64_tr_b16 v[244:245], v31 offset:8192
  ds_read_b64_tr_b16 v[246:247], v31 offset:8704
L_wr_22_e:
  s_waitcnt lgkmcnt(0)
  s_waitcnt vmcnt(24)
  s_barrier
  s_add_u32 m0, s56, 98304
  s_mov_b32 s68, 3145728
  buffer_load_dwordx4 v26, s[48:51], s68 offen lds
  s_add_u32 m0, s56, 102400
  s_mov_b32 s68, 3211264
  buffer_load_dwordx4 v26, s[48:51], s68 offen lds
  s_add_u32 m0, s56, 106496
  s_mov_b32 s68, 3407872
  buffer_load_dwordx4 v26, s[48:51], s68 offen lds
  s_add_u32 m0, s56, 110592
  s_mov_b32 s68, 3473408
  buffer_load_dwordx4 v26, s[48:51], s68 offen lds
  v_add_u32 v30, 114688, v32
  v_add_u32 v31, 114688, v33
  s_cmp_lg_u32 s44, 0
  s_cbranch_scc1 L_wr_23_1
  ds_read_b64_tr_b16 v[240:241], v30 offset:0
  ds_read_b64_tr_b16 v[242:243], v30 offset:512
  ds_read_b64_tr_b16 v[244:245], v30 offset:8192
  ds_read_b64_tr_b16 v[246:247], v30 offset:8704
  ds_read_b64_tr_b16 v[248:249], v31 offset:0
  ds_read_b64_tr_b16 v[250:251], v31 offset:512
  ds_read_b64_tr_b16 v[252:253], v31 offset:8192
  ds_read_b64_tr_b16 v[254:255], v31 offset:8704
  s_branch L_wr_23_e
L_wr_23_1:
  s_cmp_lg_u32 s44, 1
  s_cbranch_scc1 L_wr_23_2
  ds_read_b64_tr_b16 v[248:249], v30 offset:0
  ds_read_b64_tr_b16 v[250:251], v30 offset:512
  ds_read_b64_tr_b16 v[252:253], v30 offset:8192
  ds_read_b64_tr_b16 v[254:255], v30 offset:8704
  ds_read_b64_tr_b16 v[240:241], v31 offset:0
  ds_read_b64_tr_b16 v[242:243], v31 offset:512
  ds_read_b64_tr_b16 v[244:245], v31 offset:8192
  ds_read_b64_tr_b16 v[246:247], v31 offset:8704
  s_branch L_wr_23_e
L_wr_23_2:
  s_cmp_lg_u32 s44, 2
  s_cbranch_scc1 L_wr_23_3
  ds_read_b64_tr_b16 v[224:225], v30 offset:0
  ds_read_b64_tr_b16 v[226:227], v30 offset:512
  ds_read_b64_tr_b16 v[228:229], v30 offset:8192
  ds_read_b64_tr_b16 v[230:231], v30 offset:8704
  ds_read_b64_tr_b16 v[232:233], v31 offset:0
  ds_read_b64_tr_b16 v[234:235], v31 offset:512
  ds_read_b64_tr_b16 v[236:237], v31 offset:8192
  ds_read_b64_tr_b16 v[238:239], v31 offset:8704
  s_branch L_wr_23_e
L_wr_23_3:
  ds_read_b64_tr_b16 v[232:233], v30 offset:0
  ds_read_b64_tr_b16 v[234:235], v30 offset:512
  ds_read_b64_tr_b16 v[236:237], v30 offset:8192
  ds_read_b64_tr_b16 v[238:239], v30 offset:8704
  ds_read_b64_tr_b16 v[224:225], v31 offset:0
  ds_read_b64_tr_b16 v[226:227], v31 offset:512
  ds_read_b64_tr_b16 v[228:229], v31 offset:8192
  ds_read_b64_tr_b16 v[230:231], v31 offset:8704
L_wr_23_e:
  s_waitcnt lgkmcnt(0)
  s_waitcnt vmcnt(24)
  s_barrier
  s_add_u32 m0, s56, 114688
  s_mov_b32 s68, 3670016
  buffer_load_dwordx4 v26, s[48:51], s68 offen lds
  s_add_u32 m0, s56, 118784
  s_mov_b32 s68, 3735552
  buffer_load_dwordx4 v26, s[48:51], s68 offen lds
  s_add_u32 m0, s56, 122880
  s_mov_b32 s68, 3932160
  buffer_load_dwordx4 v26, s[48:51], s68 offen lds
  s_add_u32 m0, s56, 126976
  s_mov_b32 s68, 3997696
  buffer_load_dwordx4 v26, s[48:51], s68 offen lds
  v_add_u32 v30, 0, v28
  v_add_u32 v31, 0, v29
  ds_read_b64_tr_b16 v[108:109], v30 offset:0
  ds_read_b64_tr_b16 v[110:111], v30 offset:512
  ds_read_b64_tr_b16 v[112:113], v30 offset:8192
  ds_read_b64_tr_b16 v[114:115], v30 offset:8704
  ds_read_b64_tr_b16 v[116:117], v31 offset:0
  ds_read_b64_tr_b16 v[118:119], v31 offset:512
  ds_read_b64_tr_b16 v[120:121], v31 offset:8192
  ds_read_b64_tr_b16 v[122:123], v31 offset:8704
  s_waitcnt lgkmcnt(0)
  s_barrier
  v_add_u32 v30, 0, v3
  ds_write_b128 v30, v[108:111] offset:0
  ds_write_b128 v30, v[112:115] offset:1024
  ds_write_b128 v30, v[116:119] offset:2048
  ds_write_b128 v30, v[120:123] offset:3072
  s_waitcnt lgkmcnt(0)
  s_waitcnt vmcnt(24)
  s_barrier
  v_add_u32 v30, 16384, v28
  v_add_u32 v31, 16384, v29
  ds_read_b64_tr_b16 v[108:109], v30 offset:0
  ds_read_b64_tr_b16 v[110:111], v30 offset:512
  ds_read_b64_tr_b16 v[112:113], v30 offset:8192
  ds_read_b64_tr_b16 v[114:115], v30 offset:8704
  ds_read_b64_tr_b16 v[116:117], v31 offset:0
  ds_read_b64_tr_b16 v[118:119], v31 offset:512
  ds_read_b64_tr_b16 v[120:121], v31 offset:8192
  ds_read_b64_tr_b16 v[122:123], v31 offset:8704
  s_waitcnt lgkmcnt(0)
  s_barrier
  v_add_u32 v30, 16384, v3
  ds_write_b128 v30, v[108:111] offset:0
  ds_write_b128 v30, v[112:115] offset:1024
  ds_write_b128 v30, v[116:119] offset:2048
  ds_write_b128 v30, v[120:123] offset:3072
  s_waitcnt lgkmcnt(0)
  s_waitcnt vmcnt(20)
  s_barrier
  v_add_u32 v30, 32768, v28
  v_add_u32 v31, 32768, v29
  ds_read_b64_tr_b16 v[108:109], v30 offset:0
  ds_read_b64_tr_b16 v[110:111], v30 offset:512
  ds_read_b64_tr_b16 v[112:113], v30 offset:8192
  ds_read_b64_tr_b16 v[114:115], v30 offset:8704
  ds_read_b64_tr_b16 v[116:117], v31 offset:0
  ds_read_b64_tr_b16 v[118:119], v31 offset:512
  ds_read_b64_tr_b16 v[120:121], v31 offset:8192
  ds_read_b64_tr_b16 v[122:123], v31 offset:8704
  s_waitcnt lgkmcnt(0)
  s_barrier
  v_add_u32 v30, 32768, v3
  ds_write_b128 v30, v[108:111] offset:0
  ds_write_b128 v30, v[112:115] offset:1024
  ds_write_b128 v30, v[116:119] offset:2048
  ds_write_b128 v30, v[120:123] offset:3072
  s_waitcnt lgkmcnt(0)
  s_waitcnt vmcnt(16)
  s_barrier
  v_add_u32 v30, 49152, v28
  v_add_u32 v31, 49152, v29
  ds_read_b64_tr_b16 v[108:109], v30 offset:0
  ds_read_b64_tr_b16 v[110:111], v30 offset:512
  ds_read_b64_tr_b16 v[112:113], v30 offset:8192
  ds_read_b64_tr_b16 v[114:115], v30 offset:8704
  ds_read_b64_tr_b16 v[116:117], v31 offset:0
  ds_read_b64_tr_b16 v[118:119], v31 offset:512
  ds_read_b64_tr_b16 v[120:121], v31 offset:8192
  ds_read_b64_tr_b16 v[122:123], v31 offset:8704
  s_waitcnt lgkmcnt(0)
  s_barrier
  v_add_u32 v30, 49152, v3
  ds_write_b128 v30, v[108:111] offset:0
  ds_write_b128 v30, v[112:115] offset:1024
  ds_write_b128 v30, v[116:119] offset:2048
  ds_write_b128 v30, v[120:123] offset:3072
  s_waitcnt lgkmcnt(0)
  s_waitcnt vmcnt(12)
  s_barrier
  v_add_u32 v30, 65536, v28
  v_add_u32 v31, 65536, v29
  ds_read_b64_tr_b16 v[108:109], v30 offset:0
  ds_read_b64_tr_b16 v[110:111], v30 offset:512
  ds_read_b64_tr_b16 v[112:113], v30 offset:8192
  ds_read_b64_tr_b16 v[114:115], v30 offset:8704
  ds_read_b64_tr_b16 v[116:117], v31 offset:0
  ds_read_b64_tr_b16 v[118:119], v31 offset:512
  ds_read_b64_tr_b16 v[120:121], v31 offset:8192
  ds_read_b64_tr_b16 v[122:123], v31 offset:8704
  s_waitcnt lgkmcnt(0)
  s_barrier
  v_add_u32 v30, 65536, v3
  ds_write_b128 v30, v[108:111] offset:0
  ds_write_b128 v30, v[112:115] offset:1024
  ds_write_b128 v30, v[116:119] offset:2048
  ds_write_b128 v30, v[120:123] offset:3072
  s_waitcnt lgkmcnt(0)
  s_waitcnt vmcnt(8)
  s_barrier
  v_add_u32 v30, 81920, v28
  v_add_u32 v31, 81920, v29
  ds_read_b64_tr_b16 v[108:109], v30 offset:0
  ds_read_b64_tr_b16 v[110:111], v30 offset:512
  ds_read_b64_tr_b16 v[112:113], v30 offset:8192
  ds_read_b64_tr_b16 v[114:115], v30 offset:8704
  ds_read_b64_tr_b16 v[116:117], v31 offset:0
  ds_read_b64_tr_b16 v[118:119], v31 offset:512
  ds_read_b64_tr_b16 v[120:121], v31 offset:8192
  ds_read_b64_tr_b16 v[122:123], v31 offset:8704
  s_waitcnt lgkmcnt(0)
  s_barrier
  v_add_u32 v30, 81920, v3
  ds_write_b128 v30, v[108:111] offset:0
  ds_write_b128 v30, v[112:115] offset:1024
  ds_write_b128 v30, v[116:119] offset:2048
  ds_write_b128 v30, v[120:123] offset:3072
  s_waitcnt lgkmcnt(0)
  s_waitcnt vmcnt(4)
  s_barrier
  v_add_u32 v30, 98304, v28
  v_add_u32 v31, 98304, v29
  ds_read_b64_tr_b16 v[108:109], v30 offset:0
  ds_read_b64_tr_b16 v[110:111], v30 offset:512
  ds_read_b64_tr_b16 v[112:113], v30 offset:8192
  ds_read_b64_tr_b16 v[114:115], v30 offset:8704
  ds_read_b64_tr_b16 v[116:117], v31 offset:0
  ds_read_b64_tr_b16 v[118:119], v31 offset:512
  ds_read_b64_tr_b16 v[120:121], v31 offset:8192
  ds_read_b64_tr_b16 v[122:123], v31 offset:8704
  s_waitcnt lgkmcnt(0)
  s_barrier
  v_add_u32 v30, 98304, v3
  ds_write_b128 v30, v[108:111] offset:0
  ds_write_b128 v30, v[112:115] offset:1024
  ds_write_b128 v30, v[116:119] offset:2048
  ds_write_b128 v30, v[120:123] offset:3072
  s_waitcnt lgkmcnt(0)
  s_waitcnt vmcnt(0)
  s_barrier
  v_add_u32 v30, 114688, v28
  v_add_u32 v31, 114688, v29
  ds_read_b64_tr_b16 v[108:109], v30 offset:0
  ds_read_b64_tr_b16 v[110:111], v30 offset:512
  ds_read_b64_tr_b16 v[112:113], v30 offset:8192
  ds_read_b64_tr_b16 v[114:115], v30 offset:8704
  ds_read_b64_tr_b16 v[116:117], v31 offset:0
  ds_read_b64_tr_b16 v[118:119], v31 offset:512
  ds_read_b64_tr_b16 v[120:121], v31 offset:8192
  ds_read_b64_tr_b16 v[122:123], v31 offset:8704
  s_waitcnt lgkmcnt(0)
  s_barrier
  v_add_u32 v30, 114688, v3
  ds_write_b128 v30, v[108:111] offset:0
  ds_write_b128 v30, v[112:115] offset:1024
  ds_write_b128 v30, v[116:119] offset:2048
  ds_write_b128 v30, v[120:123] offset:3072
  s_waitcnt lgkmcnt(0)
  s_lshl_b32 s68, s44, 15
  v_add_u32 v3, s68, v3
  s_mov_b32 s48, s22
  s_and_b32 s49, s23, 0xffff
  s_mov_b32 s50, 0x2000
  s_mov_b32 s51, 0x20000
  v_bfe_u32 v22, v0, 1, 3
  v_lshlrev_b32 v23, 10, v22
  v_lshrrev_b32 v22, 5, v0
  v_lshl_add_u32 v23, v22, 6, v23
  v_bfe_u32 v22, v0, 4, 1
  v_lshl_add_u32 v23, v22, 4, v23
  v_and_b32 v22, 1, v0
  v_lshl_add_u32 v23, v22, 3, v23
  s_lshl_b32 s68, s44, 8
  buffer_load_dwordx2 v[92:93], v23, s[48:51], s68 offen
  buffer_load_dwordx2 v[94:95], v23, s[48:51], s68 offen offset:32
  buffer_load_dwordx2 v[96:97], v23, s[48:51], s68 offen offset:128
  buffer_load_dwordx2 v[98:99], v23, s[48:51], s68 offen offset:160
  v_lshlrev_b32 v0, 4, v0
  v_add_u32 v0, 147456, v0
  s_mov_b32 s68, 0x05040100
  s_mov_b32 s69, 0x07060302
  s_waitcnt vmcnt(0)
  v_perm_b32 v20, v94, v92, s68
  v_perm_b32 v21, v94, v92, s69
  v_perm_b32 v22, v95, v93, s68
  v_perm_b32 v23, v95, v93, s69
  v_min_u32 v20, -2, v20
  v_min_u32 v21, -2, v21
  v_min_u32 v22, -2, v22
  v_min_u32 v23, -2, v23
  v_perm_b32 v24, v98, v96, s68
  v_perm_b32 v25, v98, v96, s69
  v_perm_b32 v26, v99, v97, s68
  v_perm_b32 v27, v99, v97, s69
  v_min_u32 v24, -2, v24
  v_min_u32 v25, -2, v25
  v_min_u32 v26, -2, v26
  v_min_u32 v27, -2, v27
L_team_init:
  buffer_load_dword v52, v17, s[52:55], 0 offen sc1
  s_add_u32 s67, s67, 1
  s_cmp_gt_u32 s67, 1048576
  s_cbranch_scc1 L_exit
  s_waitcnt vmcnt(0)
  v_cmp_ne_u32 vcc, 32, v52
  s_cbranch_vccnz L_team_init
  buffer_load_dword v52, v17, s[52:55], 0 offen offset:128 sc1
  s_mov_b32 s60, s92
L_fs_pre:
  buffer_load_dword v4, v17, s[40:43], s60 offen sc1
  s_add_u32 s67, s67, 1
  s_cmp_gt_u32 s67, 1048576
  s_cbranch_scc1 L_exit
  s_waitcnt vmcnt(0)
  v_cmp_ne_u32 vcc, 4, v4
  s_cbranch_vccnz L_fs_pre
  v_readfirstlane_b32 s69, v52
  s_mov_b32 m0, s70
  s_mov_b32 s57, s72
  buffer_load_dwordx4 v2, s[40:43], s57 offen sc1 lds
  buffer_load_dwordx4 v2, s[40:43], s57 offen offset:1024 sc1 lds
  s_mov_b32 s56, -1
  s_mov_b32 s65, 0
  s_lshl_b32 s61, s45, 12
  s_lshl_b32 s68, s44, 10
  s_sub_u32 s61, s61, s68
  s_add_u32 s61, s61, 0x7fc0000
  s_max_i32 s93, s56, 0
  s_add_u32 s56, s56, 1
  s_xor_b32 s65, s65, 1
  s_add_u32 s58, s57, 0x1000000
  s_add_u32 s68, s56, 1
  s_min_u32 s68, s68, 63
  s_lshl_b32 s68, s68, 13
  s_add_u32 s57, s72, s68
  s_add_u32 s59, s57, s73
  s_add_u32 s68, s56, 2
  s_min_u32 s68, s68, 63
  s_lshr_b32 s68, s68, 3
  s_lshl2_add_u32 s60, s68, s92
  s_add_u32 s61, s61, 0x20000
  s_xor_b32 s70, s70, 0x2000
  ds_read_b128 v[76:79], v3 offset:0
  ds_read_b128 v[80:83], v3 offset:1024
  ds_read_b128 v[84:87], v3 offset:2048
  ds_read_b128 v[88:91], v3 offset:3072
  ds_read_b128 v[92:95], v3 offset:16384
  ds_read_b128 v[96:99], v3 offset:17408
  ds_read_b128 v[100:103], v3 offset:18432
  ds_read_b128 v[104:107], v3 offset:19456
  v_xor_b32 v3, 0x8000, v3
  ds_read_b128 v[108:111], v3 offset:0
  ds_read_b128 v[112:115], v3 offset:1024
  ds_read_b128 v[116:119], v3 offset:2048
  ds_read_b128 v[120:123], v3 offset:3072
  v_mov_b64 v[52:53], 0
  v_mov_b64 v[54:55], 0
  v_mov_b64 v[56:57], 0
  v_mov_b64 v[58:59], 0
  v_mov_b64 v[60:61], 0
  v_mov_b64 v[62:63], 0
  v_mov_b64 v[64:65], 0
  v_mov_b64 v[66:67], 0
  v_mov_b64 v[68:69], 0
  v_mov_b64 v[70:71], 0
  v_mov_b64 v[72:73], 0
  v_mov_b64 v[74:75], 0
  s_waitcnt vmcnt(0) lgkmcnt(0)
  v_xor_b32 v32, 2048, v11
  v_xor_b32 v40, 4096, v11
  v_xor_b32 v48, 6144, v11
  s_bcnt1_i32_b32 s69, s69
  s_cmp_eq_u32 s69, 1
  s_cbranch_scc0 L_entry_x
  s_branch L_entry_f
L_poll2_f:
  buffer_load_dwordx4 v[20:23], v11, s[40:43], s63 offen sc1
  buffer_load_dwordx4 v[24:27], v11, s[40:43], s63 offen offset:1024 sc1
  s_add_u32 s67, s67, 1
  s_cmp_gt_u32 s67, 1048576
  s_cbranch_scc1 L_exit
  s_nop 15
  s_nop 3
  buffer_load_dwordx4 v[28:31], v11, s[40:43], s63 offen sc1
  buffer_load_dwordx4 v[36:39], v11, s[40:43], s63 offen offset:1024 sc1
L_entry_f:
  s_waitcnt vmcnt(3)
  ds_write_b128 v11, v[20:23]
  v_smfmac_f32_16x16x64_bf16 v[52:55], v[20:23], a[0:7], v1
  s_waitcnt vmcnt(2)
  ds_write_b128 v11, v[24:27] offset:1024
  v_max3_u32 v44, v20, v21, v22
  v_smfmac_f32_16x16x64_bf16 v[56:59], v[20:23], a[64:71], v1
  v_max3_u32 v45, v23, v24, v25
  v_max3_u32 v44, v44, v26, v27
  v_smfmac_f32_16x16x64_bf16 v[52:55], v[24:27], a[8:15], v1
  v_max_u32 v44, v44, v45
  v_cmp_eq_u32 vcc, -1, v44
  v_smfmac_f32_16x16x64_bf16 v[56:59], v[24:27], a[72:79], v1
  s_mov_b32 m0, s71
  v_lshlrev_b32 v4, 1, v2
  v_smfmac_f32_16x16x64_bf16 v[60:63], v[20:23], a[128:135], v1
  s_cbranch_vccnz L_retry2_f
  s_waitcnt vmcnt(0)
  v_smfmac_f32_16x16x64_bf16 v[64:67], v[20:23], a[192:199], v1
  buffer_load_dwordx4 v2, s[40:43], s58 offen offset:0 sc1 lds
  v_smfmac_f32_16x16x64_bf16 v[60:63], v[24:27], a[136:143], v1
  s_waitcnt lgkmcnt(0)
  s_barrier
  ds_read_b128 v[28:31], v32 offset:0
  v_smfmac_f32_16x16x64_bf16 v[64:67], v[24:27], a[200:207], v1
  ds_read_b128 v[32:35], v32 offset:1024
  ds_read_b128 v[36:39], v40 offset:0
  v_smfmac_f32_16x16x64_bf16 v[68:71], v[20:23], v[76:83], v1
  ds_read_b128 v[40:43], v40 offset:1024
  ds_read_b128 v[44:47], v48 offset:0
  v_smfmac_f32_16x16x64_bf16 v[72:75], v[20:23], v[84:91], v1
  ds_read_b128 v[48:51], v48 offset:1024
  v_smfmac_f32_16x16x64_bf16 v[68:71], v[24:27], v[92:99], v1
  buffer_load_dwordx4 v2, s[40:43], s58 offen offset:1024 sc1 lds
  v_mov_b32 v16, s93
  v_smfmac_f32_16x16x64_bf16 v[72:75], v[24:27], v[100:107], v1
  s_waitcnt lgkmcnt(5)
  ds_read_b128 v[76:79], v3 offset:16384
  v_smfmac_f32_16x16x64_bf16 v[52:55], v[28:31], a[16:23], v1
  s_waitcnt lgkmcnt(5)
  ds_read_b128 v[80:83], v3 offset:17408
  v_smfmac_f32_16x16x64_bf16 v[52:55], v[32:35], a[24:31], v1
  s_waitcnt lgkmcnt(5)
  ds_read_b128 v[84:87], v3 offset:18432
  v_smfmac_f32_16x16x64_bf16 v[52:55], v[36:39], a[32:39], v1
  s_waitcnt lgkmcnt(5)
  ds_read_b128 v[88:91], v3 offset:19456
  v_xor_b32 v3, 0x18000, v3
  v_smfmac_f32_16x16x64_bf16 v[52:55], v[40:43], a[40:47], v1
  s_waitcnt lgkmcnt(4)
  ds_read_b128 v[92:95], v0 offset:0
  buffer_load_dword v4, v4, s[40:43], s59 offen sc1
  v_smfmac_f32_16x16x64_bf16 v[52:55], v[44:47], a[48:55], v1
  ds_read_b128 v[96:99], v0 offset:2048
  v_smfmac_f32_16x16x64_bf16 v[52:55], v[48:51], a[56:63], v1
  ds_read_b128 v[100:103], v0 offset:4096
  buffer_store_dword v16, v17, s[40:43], s66 offen sc1
  v_smfmac_f32_16x16x64_bf16 v[68:71], v[28:31], v[108:115], v1
  s_mov_b32 m0, s70
  ds_read_b128 v[104:107], v0 offset:6144
  v_smfmac_f32_16x16x64_bf16 v[56:59], v[28:31], a[80:87], v1
  s_nop 0
  ds_read_b128 v[108:111], v3 offset:0
  v_add_f32 v52, v52, v53
  v_smfmac_f32_16x16x64_bf16 v[56:59], v[32:35], a[88:95], v1
  ds_read_b128 v[112:115], v3 offset:1024
  v_add_f32 v54, v54, v55
  v_smfmac_f32_16x16x64_bf16 v[72:75], v[28:31], v[116:123], v1
  ds_read_b128 v[20:23], v0 offset:1024
  v_mul_f32 v52, s88, v52
  v_smfmac_f32_16x16x64_bf16 v[56:59], v[36:39], a[96:103], v1
  ds_read_b128 v[116:119], v3 offset:2048
  v_mul_f32 v54, s88, v54
  v_smfmac_f32_16x16x64_bf16 v[56:59], v[40:43], a[104:111], v1
  ds_read_b128 v[120:123], v3 offset:3072
  v_cvt_pk_bf16_f32 v52, v52, v52
  v_smfmac_f32_16x16x64_bf16 v[56:59], v[44:47], a[112:119], v1
  ds_read_b128 v[24:27], v0 offset:3072
  v_cvt_pk_bf16_f32 v53, v54, v54
  v_smfmac_f32_16x16x64_bf16 v[56:59], v[48:51], a[120:127], v1
  s_waitcnt lgkmcnt(10)
  buffer_load_dword v4, v17, s[40:43], s60 offen sc1
  v_smfmac_f32_16x16x64_bf16 v[68:71], v[32:35], v[76:83], v1
  s_nop 0
  buffer_store_dwordx4 v[124:127], v2, s[40:43], s61 offen sc1
  v_smfmac_f32_16x16x64_bf16 v[72:75], v[32:35], v[84:91], v1
  s_nop 0
  ds_read_b128 v[76:79], v3 offset:16384
  v_add_f32 v56, v56, v57
  v_smfmac_f32_16x16x64_bf16 v[60:63], v[28:31], a[144:151], v1
  ds_read_b128 v[80:83], v3 offset:17408
  v_add_f32 v58, v58, v59
  v_smfmac_f32_16x16x64_bf16 v[60:63], v[32:35], a[152:159], v1
  s_waitcnt lgkmcnt(3)
  ds_read_b128 v[84:87], v3 offset:18432
  v_mul_f32 v56, s88, v56
  v_smfmac_f32_16x16x64_bf16 v[68:71], v[36:39], v[108:115], v1
  ds_read_b128 v[88:91], v3 offset:19456
  v_mul_f32 v58, s88, v58
  v_smfmac_f32_16x16x64_bf16 v[60:63], v[36:39], a[160:167], v1
  v_xor_b32 v3, 0x8000, v3
  v_cvt_pk_bf16_f32 v56, v56, v56
  v_smfmac_f32_16x16x64_bf16 v[72:75], v[36:39], v[116:123], v1
  ds_read_b128 v[108:111], v3 offset:0
  v_cvt_pk_bf16_f32 v57, v58, v58
  v_smfmac_f32_16x16x64_bf16 v[60:63], v[40:43], a[168:175], v1
  s_waitcnt lgkmcnt(3)
  ds_write2st64_b64 v5, v[52:53], v[56:57] offset0:0 offset1:4
  v_smfmac_f32_16x16x64_bf16 v[68:71], v[40:43], v[76:83], v1
  ds_read_b128 v[112:115], v3 offset:1024
  v_smfmac_f32_16x16x64_bf16 v[60:63], v[44:47], a[176:183], v1
  s_waitcnt lgkmcnt(3)
  ds_read_b128 v[116:119], v3 offset:16384
  v_smfmac_f32_16x16x64_bf16 v[72:75], v[40:43], v[84:91], v1
  ds_read_b128 v[120:123], v3 offset:17408
  v_smfmac_f32_16x16x64_bf16 v[60:63], v[48:51], a[184:191], v1
  v_smfmac_f32_16x16x64_bf16 v[64:67], v[28:31], a[208:215], v1
  s_waitcnt lgkmcnt(3)
  s_barrier
  v_smfmac_f32_16x16x64_bf16 v[64:67], v[32:35], a[216:223], v1
  s_waitcnt lgkmcnt(2)
  ds_read_b64_tr_b16 v[76:77], v6 offset:0
  ds_read_b64_tr_b16 v[78:79], v6 offset:2048
  v_smfmac_f32_16x16x64_bf16 v[68:71], v[44:47], v[108:115], v1
  ds_read_b64_tr_b16 v[80:81], v6 offset:512
  ds_read_b64_tr_b16 v[82:83], v6 offset:2560
  v_smfmac_f32_16x16x64_bf16 v[64:67], v[36:39], a[224:231], v1
  s_waitcnt lgkmcnt(4)
  ds_read_b64_tr_b16 v[84:85], v6 offset:1024
  ds_read_b64_tr_b16 v[86:87], v6 offset:3072
  v_smfmac_f32_16x16x64_bf16 v[68:71], v[48:51], v[116:123], v1
  ds_read_b64_tr_b16 v[88:89], v6 offset:1536
  ds_read_b64_tr_b16 v[90:91], v6 offset:3584
  v_smfmac_f32_16x16x64_bf16 v[64:67], v[40:43], a[232:239], v1
  ds_read_b128 v[28:31], v0 offset:5120
  v_add_f32 v60, v60, v61
  v_smfmac_f32_16x16x64_bf16 v[64:67], v[44:47], a[240:247], v1
  ds_read_b128 v[32:35], v0 offset:7168
  v_add_f32 v62, v62, v63
  v_smfmac_f32_16x16x64_bf16 v[64:67], v[48:51], a[248:255], v1
  s_waitcnt lgkmcnt(8)
  ds_read_b128 v[108:111], v3 offset:2048
  v_cvt_pk_bf16_f32 v124, v60, v62
  v_mfma_f32_16x16x32_bf16 v[52:55], v[92:95], v[76:79], 0
  s_waitcnt lgkmcnt(3)
  ds_read_b128 v[112:115], v3 offset:3072
  buffer_load_dwordx4 v2, s[40:43], s57 offen offset:0 sc1 lds
  v_mfma_f32_16x16x32_bf16 v[52:55], v[96:99], v[80:83], v[52:55]
  v_add_f32 v64, v64, v65
  v_add_f32 v66, v66, v67
  v_mfma_f32_16x16x32_bf16 v[52:55], v[100:103], v[84:87], v[52:55]
  ds_read_b128 v[116:119], v3 offset:18432
  v_cvt_pk_bf16_f32 v125, v64, v66
  v_mfma_f32_16x16x32_bf16 v[52:55], v[104:107], v[88:91], v[52:55]
  ds_write2st64_b32 v5, v124, v125 offset0:16 offset1:24
  v_add_f32 v68, v68, v69
  v_mfma_f32_16x16x32_bf16 v[56:59], v[20:23], v[76:79], 0
  s_waitcnt lgkmcnt(4)
  ds_read_b128 v[120:123], v3 offset:19456
  v_add_f32 v70, v70, v71
  v_mfma_f32_16x16x32_bf16 v[56:59], v[24:27], v[80:83], v[56:59]
  s_nop 0
  v_exp_f32 v20, v52
  v_mfma_f32_16x16x32_bf16 v[56:59], v[28:31], v[84:87], v[56:59]
  s_waitcnt vmcnt(5)
  v_exp_f32 v21, v53
  v_mfma_f32_16x16x32_bf16 v[56:59], v[32:35], v[88:91], v[56:59]
  s_waitcnt lgkmcnt(1)
  s_barrier
  ds_read_b64_tr_b16 v[92:93], v6 offset:4096
  ds_read_b64_tr_b16 v[94:95], v6 offset:6144
  ds_read_b64_tr_b16 v[96:97], v6 offset:4608
  ds_read_b64_tr_b16 v[98:99], v6 offset:6656
  v_smfmac_f32_16x16x64_bf16 v[72:75], v[44:47], v[108:115], v1
  s_waitcnt lgkmcnt(4)
  ds_read_b64_tr_b16 v[100:101], v6 offset:5120
  ds_read_b64_tr_b16 v[102:103], v6 offset:7168
  v_smfmac_f32_16x16x64_bf16 v[72:75], v[48:51], v[116:123], v1
  ds_read_b64_tr_b16 v[104:105], v6 offset:5632
  ds_read_b64_tr_b16 v[106:107], v6 offset:7680
  v_exp_f32 v22, v54
  v_exp_f32 v23, v55
  v_cvt_pk_bf16_f32 v24, v20, v21
  v_exp_f32 v20, v56
  s_waitcnt lgkmcnt(4)
  v_mfma_f32_16x16x32_bf16 v[60:63], v[92:95], v[76:79], 0
  ds_read_b128 v[36:39], v2 offset:8192
  ds_read_b128 v[40:43], v2 offset:9216
  v_mfma_f32_16x16x32_bf16 v[60:63], v[96:99], v[80:83], v[60:63]
  s_waitcnt lgkmcnt(2)
  v_cvt_pk_bf16_f32 v25, v22, v23
  v_exp_f32 v21, v57
  v_mfma_f32_16x16x32_bf16 v[60:63], v[100:103], v[84:87], v[60:63]
  v_exp_f32 v22, v58
  v_mfma_f32_16x16x32_bf16 v[60:63], v[104:107], v[88:91], v[60:63]
  s_cmp_eq_u32 s56, 63
  v_exp_f32 v23, v59
  v_cvt_pk_bf16_f32 v26, v20, v21
  v_cvt_pk_bf16_f32 v27, v22, v23
  v_add_f32 v72, v72, v73
  v_add_f32 v74, v74, v75
  v_mfma_f32_16x16x32_bf16 v[64:67], v[12:15], v[24:27], 0
  s_waitcnt lgkmcnt(0)
  v_exp_f32 v20, v60
  v_mfma_f32_16x16x32_bf16 v[80:83], v[36:39], v[24:27], 0
  v_exp_f32 v21, v61
  v_mfma_f32_16x16x32_bf16 v[84:87], v[40:43], v[24:27], 0
  v_cvt_pk_bf16_f32 v16, v20, v21
  v_cvt_pk_bf16_f32 v126, v68, v70
  v_cvt_pk_bf16_f32 v127, v72, v74
  v_mfma_f32_16x16x16_bf16 v[64:67], v[12:13], v[16:17], v[64:67]
  s_cbranch_scc1 L_team_last
  v_cvt_pk_bf16_f32 v19, v20, v21
  v_xor_b32 v3, 0x18000, v3
  v_mfma_f32_16x16x16_bf16 v[80:83], v[126:127], v[16:17], v[80:83]
  buffer_load_dwordx4 v2, s[40:43], s57 offen offset:1024 sc1 lds
  v_mov_b64 v[44:45], 0
  v_mov_b64 v[46:47], 0
  v_mfma_f32_16x16x16_bf16 v[84:87], v[126:127], v[18:19], v[84:87]
  v_rcp_f32 v65, v64
  v_subrev_u32 v66, s89, v64
  v_cmp_le_u32 vcc, s91, v66
  v_mov_b64 v[48:49], 0
L_smback_f:
  v_mul_f32 v80, v80, v65
  v_mul_f32 v81, v81, v65
  v_mul_f32 v82, v82, v65
  v_mul_f32 v83, v83, v65
  v_cvt_pk_bf16_f32 v88, v80, v81
  v_cvt_pk_bf16_f32 v89, v82, v83
  v_mul_f32 v84, v84, v65
  v_mul_f32 v85, v85, v65
  v_mul_f32 v86, v86, v65
  v_mul_f32 v87, v87, v65
  v_cvt_pk_bf16_f32 v90, v84, v85
  v_cvt_pk_bf16_f32 v91, v86, v87
  s_cbranch_vccnz L_smslow_f
  ds_write_b128 v7, v[88:91]
  v_mov_b64 v[50:51], 0
  v_mov_b64 v[36:37], 0
  v_mov_b64 v[38:39], 0
  v_mov_b64 v[40:41], 0
  v_mov_b64 v[42:43], 0
  v_xor_b32 v96, 512, v7
  v_xor_b32 v100, 1024, v7
  v_xor_b32 v104, 1536, v7
  v_lshrrev_b32 v24, 16, v12
  v_cndmask_b32 v24, v24, 1.0, s[94:95]
  s_waitcnt lgkmcnt(0)
  s_barrier
  ds_read_b128 v[96:99], v96
  ds_read_b128 v[100:103], v100
  ds_read_b128 v[104:107], v104
  v_smfmac_f32_16x16x64_bf16 v[36:39], v[88:91], v[128:135], v1
  v_cndmask_b32 v20, 0, v24, s[80:81]
  v_smfmac_f32_16x16x64_bf16 v[40:43], v[88:91], v[160:167], v1
  v_cndmask_b32 v21, 0, v24, s[82:83]
  v_smfmac_f32_16x16x64_bf16 v[44:47], v[88:91], v[192:199], v1
  v_cndmask_b32 v22, 0, v24, s[84:85]
  v_smfmac_f32_16x16x64_bf16 v[48:51], v[88:91], v[224:231], v1
  v_cndmask_b32 v23, 0, v24, s[86:87]
  s_waitcnt lgkmcnt(2)
  v_smfmac_f32_16x16x64_bf16 v[36:39], v[96:99], v[136:143], v1
  s_waitcnt lgkmcnt(1)
  v_mov_b64 v[52:53], 0
  v_smfmac_f32_16x16x64_bf16 v[36:39], v[100:103], v[144:151], v1
  s_waitcnt lgkmcnt(0)
  v_mov_b64 v[54:55], 0
  v_smfmac_f32_16x16x64_bf16 v[36:39], v[104:107], v[152:159], v1
  s_nop 1
  v_mov_b64 v[56:57], 0
  v_smfmac_f32_16x16x64_bf16 v[40:43], v[96:99], v[168:175], v1
  s_nop 1
  v_mov_b64 v[58:59], 0
  v_smfmac_f32_16x16x64_bf16 v[40:43], v[100:103], v[176:183], v1
  v_cvt_pk_bf16_f32 v36, v36, v37
  v_smfmac_f32_16x16x64_bf16 v[40:43], v[104:107], v[184:191], v1
  s_nop 1
  v_cvt_pk_bf16_f32 v37, v38, v39
  v_smfmac_f32_16x16x64_bf16 v[44:47], v[96:99], v[200:207], v1
  s_nop 1
  v_and_or_b32 v36, v36, -2, s65
  v_smfmac_f32_16x16x64_bf16 v[44:47], v[100:103], v[208:215], v1
  buffer_store_dwordx2 v[36:37], v8, s[40:43], s74 offen
  v_cvt_pk_bf16_f32 v40, v40, v41
  v_smfmac_f32_16x16x64_bf16 v[44:47], v[104:107], v[216:223], v1
  s_nop 1
  v_cvt_pk_bf16_f32 v41, v42, v43
  v_smfmac_f32_16x16x64_bf16 v[48:51], v[96:99], v[232:239], v1
  s_nop 1
  v_and_or_b32 v40, v40, -2, s65
  v_smfmac_f32_16x16x64_bf16 v[48:51], v[100:103], v[240:247], v1
  buffer_store_dwordx2 v[40:41], v8, s[40:43], s75 offen
  v_cvt_pk_bf16_f32 v44, v44, v45
  v_smfmac_f32_16x16x64_bf16 v[48:51], v[104:107], v[248:255], v1
  s_nop 1
  v_cvt_pk_bf16_f32 v45, v46, v47
  v_and_or_b32 v44, v44, -2, s65
  buffer_store_dwordx2 v[44:45], v8, s[40:43], s76 offen
  s_nop 2
  v_cvt_pk_bf16_f32 v48, v48, v49
  v_cvt_pk_bf16_f32 v49, v50, v51
  v_and_or_b32 v48, v48, -2, s65
  buffer_store_dwordx2 v[48:49], v8, s[40:43], s77 offen
  s_nop 15
  s_nop 9
  s_cmp_lt_u32 s44, 1
  s_cbranch_scc1 L_poll1_f
  s_nop 9
  s_cmp_lt_u32 s44, 2
  s_cbranch_scc1 L_poll1_f
  s_nop 9
  s_cmp_lt_u32 s44, 3
  s_cbranch_scc1 L_poll1_f
  s_nop 9
L_poll1_f:
  buffer_load_dwordx4 v[28:31], v9, s[40:43], s62 offen sc1
  buffer_load_dwordx4 v[32:35], v9, s[40:43], s62 offen offset:1024 sc1
  v_mov_b64 v[60:61], 0
  v_mov_b64 v[62:63], 0
  v_mov_b64 v[64:65], 0
  v_mov_b64 v[66:67], 0
  v_mov_b64 v[68:69], 0
  v_mov_b64 v[70:71], 0
  v_mov_b64 v[72:73], 0
  v_mov_b64 v[74:75], 0
  s_nop 15
  s_nop 3
  buffer_load_dwordx4 v[36:39], v9, s[40:43], s62 offen sc1
  buffer_load_dwordx4 v[40:43], v9, s[40:43], s62 offen offset:1024 sc1
L_poll1b_f:
  s_waitcnt vmcnt(3)
  v_mfma_f32_16x16x32_bf16 v[24:27], v[28:31], v[20:23], 0
  v_bitop3_b32 v44, v28, v30, s65 bitop3:0x7e
  s_waitcnt vmcnt(2)
  v_mfma_f32_16x16x32_bf16 v[24:27], v[32:35], v[20:23], v[24:27]
  v_bitop3_b32 v45, v32, v34, s65 bitop3:0x7e
  v_or_b32 v44, v44, v45
  v_and_b32 v44, 1, v44
  v_cmp_ne_u32 vcc, 0, v44
  s_nop 2
  s_cbranch_vccnz L_retry1_f
L_got1_f:
  v_add_f32 v24, v24, v25
  v_add_f32 v26, v26, v27
  s_nop 1
  v_permlane16_swap_b32 v24, v26
  v_add_f32 v24, v24, v26
  v_cvt_pk_bf16_f32 v24, v24, v17
  v_min_u32 v24, s90, v24
  v_cndmask_b32 v24, v24, -1, s[78:79]
  buffer_store_short v24, v10, s[40:43], s64 offen
  ds_read_b128 v[76:79], v3 offset:0
  ds_read_b128 v[80:83], v3 offset:1024
  ds_read_b128 v[84:87], v3 offset:2048
  ds_read_b128 v[88:91], v3 offset:3072
  ds_read_b128 v[92:95], v3 offset:16384
  ds_read_b128 v[96:99], v3 offset:17408
  ds_read_b128 v[100:103], v3 offset:18432
  ds_read_b128 v[104:107], v3 offset:19456
  v_xor_b32 v3, 0x8000, v3
  ds_read_b128 v[108:111], v3 offset:0
  ds_read_b128 v[112:115], v3 offset:1024
  ds_read_b128 v[116:119], v3 offset:2048
  ds_read_b128 v[120:123], v3 offset:3072
  v_cmp_ne_u32 vcc, 4, v4
  v_xor_b32 v10, 0x2000, v10
  v_xor_b32 v11, 0x2000, v11
  v_xor_b32 v0, 0x2000, v0
  s_waitcnt vmcnt(1)
  v_xor_b32 v32, 2048, v11
  v_xor_b32 v40, 4096, v11
  v_xor_b32 v48, 6144, v11
  s_cbranch_vccnz L_fs_f
L_fsback_f:
  s_max_i32 s93, s56, 0
  s_add_u32 s56, s56, 1
  s_xor_b32 s65, s65, 1
  s_add_u32 s58, s57, 0x1000000
  s_add_u32 s68, s56, 1
  s_min_u32 s68, s68, 63
  s_lshl_b32 s68, s68, 13
  s_add_u32 s57, s72, s68
  s_add_u32 s59, s57, s73
  s_add_u32 s68, s56, 2
  s_min_u32 s68, s68, 63
  s_lshr_b32 s68, s68, 3
  s_lshl2_add_u32 s60, s68, s92
  s_add_u32 s61, s61, 0x20000
  s_xor_b32 s70, s70, 0x2000
  s_nop 9
  s_branch L_poll2_f
L_retry2_f:
  s_waitcnt vmcnt(0)
  v_max3_u32 v44, v28, v29, v30
  v_max3_u32 v45, v31, v36, v37
  v_max3_u32 v44, v44, v38, v39
  v_max_u32 v44, v44, v45
  v_cmp_eq_u32 vcc, -1, v44
  v_mov_b64 v[20:21], v[28:29]
  v_mov_b64 v[22:23], v[30:31]
  v_mov_b64 v[24:25], v[36:37]
  v_mov_b64 v[26:27], v[38:39]
  v_mov_b64 v[52:53], 0
  v_mov_b64 v[54:55], 0
  v_mov_b64 v[56:57], 0
  v_mov_b64 v[58:59], 0
  v_mov_b64 v[60:61], 0
  v_mov_b64 v[62:63], 0
  s_cbranch_vccnz L_poll2_f
  s_branch L_entry_f
L_retry1_f:
  buffer_load_dwordx4 v[28:31], v9, s[40:43], s62 offen sc1
  buffer_load_dwordx4 v[32:35], v9, s[40:43], s62 offen offset:1024 sc1
  s_add_u32 s67, s67, 1
  s_cmp_gt_u32 s67, 1048576
  s_cbranch_scc1 L_exit
  s_waitcnt vmcnt(3)
  v_mfma_f32_16x16x32_bf16 v[24:27], v[36:39], v[20:23], 0
  v_bitop3_b32 v44, v36, v38, s65 bitop3:0x7e
  s_waitcnt vmcnt(2)
  v_mfma_f32_16x16x32_bf16 v[24:27], v[40:43], v[20:23], v[24:27]
  v_bitop3_b32 v45, v40, v42, s65 bitop3:0x7e
  v_or_b32 v44, v44, v45
  v_and_b32 v44, 1, v44
  v_cmp_ne_u32 vcc, 0, v44
  s_nop 2
  s_cbranch_vccz L_got1_f
  buffer_load_dwordx4 v[36:39], v9, s[40:43], s62 offen sc1
  buffer_load_dwordx4 v[40:43], v9, s[40:43], s62 offen offset:1024 sc1
  s_branch L_poll1b_f
L_smslow_f:
  v_max3_f32 v22, v52, v53, v54
  v_max3_f32 v22, v22, v55, v56
  v_max3_f32 v22, v22, v57, v58
  v_max3_f32 v22, v22, v59, v60
  v_max_f32 v22, v22, v61
  v_mov_b32 v20, v22
  s_nop 1
  v_permlane32_swap_b32 v20, v22
  v_max_f32 v22, v22, v20
  v_mov_b32 v20, v22
  s_nop 1
  v_permlane16_swap_b32 v20, v22
  v_max_f32 v22, v22, v20
  v_sub_f32 v20, v52, v22
  v_sub_f32 v21, v53, v22
  v_exp_f32 v20, v20
  v_exp_f32 v21, v21
  s_nop 0
  v_cvt_pk_bf16_f32 v24, v20, v21
  v_sub_f32 v20, v54, v22
  v_sub_f32 v21, v55, v22
  v_exp_f32 v20, v20
  v_exp_f32 v21, v21
  s_nop 0
  v_cvt_pk_bf16_f32 v25, v20, v21
  v_sub_f32 v20, v56, v22
  v_sub_f32 v21, v57, v22
  v_exp_f32 v20, v20
  v_exp_f32 v21, v21
  s_nop 0
  v_cvt_pk_bf16_f32 v26, v20, v21
  v_sub_f32 v20, v58, v22
  v_sub_f32 v21, v59, v22
  v_exp_f32 v20, v20
  v_exp_f32 v21, v21
  s_nop 0
  v_cvt_pk_bf16_f32 v27, v20, v21
  v_sub_f32 v20, v60, v22
  v_sub_f32 v21, v61, v22
  v_exp_f32 v20, v20
  v_exp_f32 v21, v21
  s_nop 0
  v_cvt_pk_bf16_f32 v16, v20, v21
  v_cvt_pk_bf16_f32 v19, v20, v21
  s_nop 1
  v_mfma_f32_16x16x32_bf16 v[64:67], v[12:15], v[24:27], 0
  v_mfma_f32_16x16x32_bf16 v[80:83], v[36:39], v[24:27], 0
  v_mfma_f32_16x16x32_bf16 v[84:87], v[40:43], v[24:27], 0
  s_nop 3
  v_mfma_f32_16x16x16_bf16 v[64:67], v[12:13], v[16:17], v[64:67]
  v_mfma_f32_16x16x16_bf16 v[80:83], v[126:127], v[16:17], v[80:83]
  v_mfma_f32_16x16x16_bf16 v[84:87], v[126:127], v[18:19], v[84:87]
  s_nop 7
  v_rcp_f32 v65, v64
  s_mov_b64 vcc, 0
  s_branch L_smback_f
L_fs_f:
  buffer_load_dword v4, v17, s[40:43], s60 offen sc1
  s_add_u32 s67, s67, 1
  s_cmp_gt_u32 s67, 1048576
  s_cbranch_scc1 L_exit
  s_waitcnt vmcnt(0)
  v_cmp_ne_u32 vcc, 4, v4
  s_cbranch_vccnz L_fs_f
  s_branch L_fsback_f
L_poll2_x:
  buffer_load_dwordx4 v[20:23], v11, s[40:43], s63 offen sc1
  buffer_load_dwordx4 v[24:27], v11, s[40:43], s63 offen offset:1024 sc1
  s_add_u32 s67, s67, 1
  s_cmp_gt_u32 s67, 1048576
  s_cbranch_scc1 L_exit
  s_nop 15
  s_nop 3
  buffer_load_dwordx4 v[28:31], v11, s[40:43], s63 offen sc1
  buffer_load_dwordx4 v[36:39], v11, s[40:43], s63 offen offset:1024 sc1
L_entry_x:
  s_waitcnt vmcnt(3)
  ds_write_b128 v11, v[20:23]
  v_smfmac_f32_16x16x64_bf16 v[52:55], v[20:23], a[0:7], v1
  s_waitcnt vmcnt(2)
  ds_write_b128 v11, v[24:27] offset:1024
  v_max3_u32 v44, v20, v21, v22
  v_smfmac_f32_16x16x64_bf16 v[56:59], v[20:23], a[64:71], v1
  v_max3_u32 v45, v23, v24, v25
  v_max3_u32 v44, v44, v26, v27
  v_smfmac_f32_16x16x64_bf16 v[52:55], v[24:27], a[8:15], v1
  v_max_u32 v44, v44, v45
  v_cmp_eq_u32 vcc, -1, v44
  v_smfmac_f32_16x16x64_bf16 v[56:59], v[24:27], a[72:79], v1
  s_mov_b32 m0, s71
  v_lshlrev_b32 v4, 1, v2
  v_smfmac_f32_16x16x64_bf16 v[60:63], v[20:23], a[128:135], v1
  s_cbranch_vccnz L_retry2_x
  s_waitcnt vmcnt(0)
  v_smfmac_f32_16x16x64_bf16 v[64:67], v[20:23], a[192:199], v1
  buffer_load_dwordx4 v2, s[40:43], s58 offen offset:0 sc1 lds
  v_smfmac_f32_16x16x64_bf16 v[60:63], v[24:27], a[136:143], v1
  s_waitcnt lgkmcnt(0)
  s_barrier
  ds_read_b128 v[28:31], v32 offset:0
  v_smfmac_f32_16x16x64_bf16 v[64:67], v[24:27], a[200:207], v1
  ds_read_b128 v[32:35], v32 offset:1024
  ds_read_b128 v[36:39], v40 offset:0
  v_smfmac_f32_16x16x64_bf16 v[68:71], v[20:23], v[76:83], v1
  ds_read_b128 v[40:43], v40 offset:1024
  ds_read_b128 v[44:47], v48 offset:0
  v_smfmac_f32_16x16x64_bf16 v[72:75], v[20:23], v[84:91], v1
  ds_read_b128 v[48:51], v48 offset:1024
  v_smfmac_f32_16x16x64_bf16 v[68:71], v[24:27], v[92:99], v1
  buffer_load_dwordx4 v2, s[40:43], s58 offen offset:1024 sc1 lds
  v_mov_b32 v16, s93
  v_smfmac_f32_16x16x64_bf16 v[72:75], v[24:27], v[100:107], v1
  s_waitcnt lgkmcnt(5)
  ds_read_b128 v[76:79], v3 offset:16384
  v_smfmac_f32_16x16x64_bf16 v[52:55], v[28:31], a[16:23], v1
  s_waitcnt lgkmcnt(5)
  ds_read_b128 v[80:83], v3 offset:17408
  v_smfmac_f32_16x16x64_bf16 v[52:55], v[32:35], a[24:31], v1
  s_waitcnt lgkmcnt(5)
  ds_read_b128 v[84:87], v3 offset:18432
  v_smfmac_f32_16x16x64_bf16 v[52:55], v[36:39], a[32:39], v1
  s_waitcnt lgkmcnt(5)
  ds_read_b128 v[88:91], v3 offset:19456
  v_xor_b32 v3, 0x18000, v3
  v_smfmac_f32_16x16x64_bf16 v[52:55], v[40:43], a[40:47], v1
  s_waitcnt lgkmcnt(4)
  ds_read_b128 v[92:95], v0 offset:0
  buffer_load_dword v4, v4, s[40:43], s59 offen sc1
  v_smfmac_f32_16x16x64_bf16 v[52:55], v[44:47], a[48:55], v1
  ds_read_b128 v[96:99], v0 offset:2048
  v_smfmac_f32_16x16x64_bf16 v[52:55], v[48:51], a[56:63], v1
  ds_read_b128 v[100:103], v0 offset:4096
  buffer_store_dword v16, v17, s[40:43], s66 offen sc1
  v_smfmac_f32_16x16x64_bf16 v[68:71], v[28:31], v[108:115], v1
  s_mov_b32 m0, s70
  ds_read_b128 v[104:107], v0 offset:6144
  v_smfmac_f32_16x16x64_bf16 v[56:59], v[28:31], a[80:87], v1
  s_nop 0
  ds_read_b128 v[108:111], v3 offset:0
  v_add_f32 v52, v52, v53
  v_smfmac_f32_16x16x64_bf16 v[56:59], v[32:35], a[88:95], v1
  ds_read_b128 v[112:115], v3 offset:1024
  v_add_f32 v54, v54, v55
  v_smfmac_f32_16x16x64_bf16 v[72:75], v[28:31], v[116:123], v1
  ds_read_b128 v[20:23], v0 offset:1024
  v_mul_f32 v52, s88, v52
  v_smfmac_f32_16x16x64_bf16 v[56:59], v[36:39], a[96:103], v1
  ds_read_b128 v[116:119], v3 offset:2048
  v_mul_f32 v54, s88, v54
  v_smfmac_f32_16x16x64_bf16 v[56:59], v[40:43], a[104:111], v1
  ds_read_b128 v[120:123], v3 offset:3072
  v_cvt_pk_bf16_f32 v52, v52, v52
  v_smfmac_f32_16x16x64_bf16 v[56:59], v[44:47], a[112:119], v1
  ds_read_b128 v[24:27], v0 offset:3072
  v_cvt_pk_bf16_f32 v53, v54, v54
  v_smfmac_f32_16x16x64_bf16 v[56:59], v[48:51], a[120:127], v1
  s_waitcnt lgkmcnt(10)
  buffer_load_dword v4, v17, s[40:43], s60 offen sc1
  v_smfmac_f32_16x16x64_bf16 v[68:71], v[32:35], v[76:83], v1
  s_nop 0
  buffer_store_dwordx4 v[124:127], v2, s[40:43], s61 offen sc1
  v_smfmac_f32_16x16x64_bf16 v[72:75], v[32:35], v[84:91], v1
  s_nop 0
  ds_read_b128 v[76:79], v3 offset:16384
  v_add_f32 v56, v56, v57
  v_smfmac_f32_16x16x64_bf16 v[60:63], v[28:31], a[144:151], v1
  ds_read_b128 v[80:83], v3 offset:17408
  v_add_f32 v58, v58, v59
  v_smfmac_f32_16x16x64_bf16 v[60:63], v[32:35], a[152:159], v1
  s_waitcnt lgkmcnt(3)
  ds_read_b128 v[84:87], v3 offset:18432
  v_mul_f32 v56, s88, v56
  v_smfmac_f32_16x16x64_bf16 v[68:71], v[36:39], v[108:115], v1
  ds_read_b128 v[88:91], v3 offset:19456
  v_mul_f32 v58, s88, v58
  v_smfmac_f32_16x16x64_bf16 v[60:63], v[36:39], a[160:167], v1
  v_xor_b32 v3, 0x8000, v3
  v_cvt_pk_bf16_f32 v56, v56, v56
  v_smfmac_f32_16x16x64_bf16 v[72:75], v[36:39], v[116:123], v1
  ds_read_b128 v[108:111], v3 offset:0
  v_cvt_pk_bf16_f32 v57, v58, v58
  v_smfmac_f32_16x16x64_bf16 v[60:63], v[40:43], a[168:175], v1
  s_waitcnt lgkmcnt(3)
  ds_write2st64_b64 v5, v[52:53], v[56:57] offset0:0 offset1:4
  v_smfmac_f32_16x16x64_bf16 v[68:71], v[40:43], v[76:83], v1
  ds_read_b128 v[112:115], v3 offset:1024
  v_smfmac_f32_16x16x64_bf16 v[60:63], v[44:47], a[176:183], v1
  s_waitcnt lgkmcnt(3)
  ds_read_b128 v[116:119], v3 offset:16384
  v_smfmac_f32_16x16x64_bf16 v[72:75], v[40:43], v[84:91], v1
  ds_read_b128 v[120:123], v3 offset:17408
  v_smfmac_f32_16x16x64_bf16 v[60:63], v[48:51], a[184:191], v1
  v_smfmac_f32_16x16x64_bf16 v[64:67], v[28:31], a[208:215], v1
  s_waitcnt lgkmcnt(3)
  s_barrier
  v_smfmac_f32_16x16x64_bf16 v[64:67], v[32:35], a[216:223], v1
  s_waitcnt lgkmcnt(2)
  ds_read_b64_tr_b16 v[76:77], v6 offset:0
  ds_read_b64_tr_b16 v[78:79], v6 offset:2048
  v_smfmac_f32_16x16x64_bf16 v[68:71], v[44:47], v[108:115], v1
  ds_read_b64_tr_b16 v[80:81], v6 offset:512
  ds_read_b64_tr_b16 v[82:83], v6 offset:2560
  v_smfmac_f32_16x16x64_bf16 v[64:67], v[36:39], a[224:231], v1
  s_waitcnt lgkmcnt(4)
  ds_read_b64_tr_b16 v[84:85], v6 offset:1024
  ds_read_b64_tr_b16 v[86:87], v6 offset:3072
  v_smfmac_f32_16x16x64_bf16 v[68:71], v[48:51], v[116:123], v1
  ds_read_b64_tr_b16 v[88:89], v6 offset:1536
  ds_read_b64_tr_b16 v[90:91], v6 offset:3584
  v_smfmac_f32_16x16x64_bf16 v[64:67], v[40:43], a[232:239], v1
  ds_read_b128 v[28:31], v0 offset:5120
  v_add_f32 v60, v60, v61
  v_smfmac_f32_16x16x64_bf16 v[64:67], v[44:47], a[240:247], v1
  ds_read_b128 v[32:35], v0 offset:7168
  v_add_f32 v62, v62, v63
  v_smfmac_f32_16x16x64_bf16 v[64:67], v[48:51], a[248:255], v1
  s_waitcnt lgkmcnt(8)
  ds_read_b128 v[108:111], v3 offset:2048
  v_cvt_pk_bf16_f32 v124, v60, v62
  v_mfma_f32_16x16x32_bf16 v[52:55], v[92:95], v[76:79], 0
  s_waitcnt lgkmcnt(3)
  ds_read_b128 v[112:115], v3 offset:3072
  buffer_load_dwordx4 v2, s[40:43], s57 offen offset:0 sc1 lds
  v_mfma_f32_16x16x32_bf16 v[52:55], v[96:99], v[80:83], v[52:55]
  v_add_f32 v64, v64, v65
  v_add_f32 v66, v66, v67
  v_mfma_f32_16x16x32_bf16 v[52:55], v[100:103], v[84:87], v[52:55]
  ds_read_b128 v[116:119], v3 offset:18432
  v_cvt_pk_bf16_f32 v125, v64, v66
  v_mfma_f32_16x16x32_bf16 v[52:55], v[104:107], v[88:91], v[52:55]
  ds_write2st64_b32 v5, v124, v125 offset0:16 offset1:24
  v_add_f32 v68, v68, v69
  v_mfma_f32_16x16x32_bf16 v[56:59], v[20:23], v[76:79], 0
  s_waitcnt lgkmcnt(4)
  ds_read_b128 v[120:123], v3 offset:19456
  v_add_f32 v70, v70, v71
  v_mfma_f32_16x16x32_bf16 v[56:59], v[24:27], v[80:83], v[56:59]
  s_nop 0
  v_exp_f32 v20, v52
  v_mfma_f32_16x16x32_bf16 v[56:59], v[28:31], v[84:87], v[56:59]
  s_waitcnt vmcnt(5)
  v_exp_f32 v21, v53
  v_mfma_f32_16x16x32_bf16 v[56:59], v[32:35], v[88:91], v[56:59]
  s_waitcnt lgkmcnt(1)
  s_barrier
  ds_read_b64_tr_b16 v[92:93], v6 offset:4096
  ds_read_b64_tr_b16 v[94:95], v6 offset:6144
  ds_read_b64_tr_b16 v[96:97], v6 offset:4608
  ds_read_b64_tr_b16 v[98:99], v6 offset:6656
  v_smfmac_f32_16x16x64_bf16 v[72:75], v[44:47], v[108:115], v1
  s_waitcnt lgkmcnt(4)
  ds_read_b64_tr_b16 v[100:101], v6 offset:5120
  ds_read_b64_tr_b16 v[102:103], v6 offset:7168
  v_smfmac_f32_16x16x64_bf16 v[72:75], v[48:51], v[116:123], v1
  ds_read_b64_tr_b16 v[104:105], v6 offset:5632
  ds_read_b64_tr_b16 v[106:107], v6 offset:7680
  v_exp_f32 v22, v54
  v_exp_f32 v23, v55
  v_cvt_pk_bf16_f32 v24, v20, v21
  v_exp_f32 v20, v56
  s_waitcnt lgkmcnt(4)
  v_mfma_f32_16x16x32_bf16 v[60:63], v[92:95], v[76:79], 0
  ds_read_b128 v[36:39], v2 offset:8192
  ds_read_b128 v[40:43], v2 offset:9216
  v_mfma_f32_16x16x32_bf16 v[60:63], v[96:99], v[80:83], v[60:63]
  s_waitcnt lgkmcnt(2)
  v_cvt_pk_bf16_f32 v25, v22, v23
  v_exp_f32 v21, v57
  v_mfma_f32_16x16x32_bf16 v[60:63], v[100:103], v[84:87], v[60:63]
  v_exp_f32 v22, v58
  v_mfma_f32_16x16x32_bf16 v[60:63], v[104:107], v[88:91], v[60:63]
  s_cmp_eq_u32 s56, 63
  v_exp_f32 v23, v59
  v_cvt_pk_bf16_f32 v26, v20, v21
  v_cvt_pk_bf16_f32 v27, v22, v23
  v_add_f32 v72, v72, v73
  v_add_f32 v74, v74, v75
  v_mfma_f32_16x16x32_bf16 v[64:67], v[12:15], v[24:27], 0
  s_waitcnt lgkmcnt(0)
  v_exp_f32 v20, v60
  v_mfma_f32_16x16x32_bf16 v[80:83], v[36:39], v[24:27], 0
  v_exp_f32 v21, v61
  v_mfma_f32_16x16x32_bf16 v[84:87], v[40:43], v[24:27], 0
  v_cvt_pk_bf16_f32 v16, v20, v21
  v_cvt_pk_bf16_f32 v126, v68, v70
  v_cvt_pk_bf16_f32 v127, v72, v74
  v_mfma_f32_16x16x16_bf16 v[64:67], v[12:13], v[16:17], v[64:67]
  s_cbranch_scc1 L_team_last
  v_cvt_pk_bf16_f32 v19, v20, v21
  v_xor_b32 v3, 0x18000, v3
  v_mfma_f32_16x16x16_bf16 v[80:83], v[126:127], v[16:17], v[80:83]
  buffer_load_dwordx4 v2, s[40:43], s57 offen offset:1024 sc1 lds
  v_mov_b64 v[44:45], 0
  v_mov_b64 v[46:47], 0
  v_mfma_f32_16x16x16_bf16 v[84:87], v[126:127], v[18:19], v[84:87]
  v_rcp_f32 v65, v64
  v_subrev_u32 v66, s89, v64
  v_cmp_le_u32 vcc, s91, v66
  v_mov_b64 v[48:49], 0
L_smback_x:
  v_mul_f32 v80, v80, v65
  v_mul_f32 v81, v81, v65
  v_mul_f32 v82, v82, v65
  v_mul_f32 v83, v83, v65
  v_cvt_pk_bf16_f32 v88, v80, v81
  v_cvt_pk_bf16_f32 v89, v82, v83
  v_mul_f32 v84, v84, v65
  v_mul_f32 v85, v85, v65
  v_mul_f32 v86, v86, v65
  v_mul_f32 v87, v87, v65
  v_cvt_pk_bf16_f32 v90, v84, v85
  v_cvt_pk_bf16_f32 v91, v86, v87
  s_cbranch_vccnz L_smslow_x
  ds_write_b128 v7, v[88:91]
  v_mov_b64 v[50:51], 0
  v_mov_b64 v[36:37], 0
  v_mov_b64 v[38:39], 0
  v_mov_b64 v[40:41], 0
  v_mov_b64 v[42:43], 0
  v_xor_b32 v96, 512, v7
  v_xor_b32 v100, 1024, v7
  v_xor_b32 v104, 1536, v7
  v_lshrrev_b32 v24, 16, v12
  v_cndmask_b32 v24, v24, 1.0, s[94:95]
  s_waitcnt lgkmcnt(0)
  s_barrier
  ds_read_b128 v[96:99], v96
  ds_read_b128 v[100:103], v100
  ds_read_b128 v[104:107], v104
  v_smfmac_f32_16x16x64_bf16 v[36:39], v[88:91], v[128:135], v1
  v_cndmask_b32 v20, 0, v24, s[80:81]
  v_smfmac_f32_16x16x64_bf16 v[40:43], v[88:91], v[160:167], v1
  v_cndmask_b32 v21, 0, v24, s[82:83]
  v_smfmac_f32_16x16x64_bf16 v[44:47], v[88:91], v[192:199], v1
  v_cndmask_b32 v22, 0, v24, s[84:85]
  v_smfmac_f32_16x16x64_bf16 v[48:51], v[88:91], v[224:231], v1
  v_cndmask_b32 v23, 0, v24, s[86:87]
  s_waitcnt lgkmcnt(2)
  v_smfmac_f32_16x16x64_bf16 v[36:39], v[96:99], v[136:143], v1
  s_waitcnt lgkmcnt(1)
  v_mov_b64 v[52:53], 0
  v_smfmac_f32_16x16x64_bf16 v[36:39], v[100:103], v[144:151], v1
  s_waitcnt lgkmcnt(0)
  v_mov_b64 v[54:55], 0
  v_smfmac_f32_16x16x64_bf16 v[36:39], v[104:107], v[152:159], v1
  s_nop 1
  v_mov_b64 v[56:57], 0
  v_smfmac_f32_16x16x64_bf16 v[40:43], v[96:99], v[168:175], v1
  s_nop 1
  v_mov_b64 v[58:59], 0
  v_smfmac_f32_16x16x64_bf16 v[40:43], v[100:103], v[176:183], v1
  v_cvt_pk_bf16_f32 v36, v36, v37
  v_smfmac_f32_16x16x64_bf16 v[40:43], v[104:107], v[184:191], v1
  s_nop 1
  v_cvt_pk_bf16_f32 v37, v38, v39
  v_smfmac_f32_16x16x64_bf16 v[44:47], v[96:99], v[200:207], v1
  s_nop 1
  v_and_or_b32 v36, v36, -2, s65
  v_smfmac_f32_16x16x64_bf16 v[44:47], v[100:103], v[208:215], v1
  buffer_store_dwordx2 v[36:37], v8, s[40:43], s74 offen sc1
  v_cvt_pk_bf16_f32 v40, v40, v41
  v_smfmac_f32_16x16x64_bf16 v[44:47], v[104:107], v[216:223], v1
  s_nop 1
  v_cvt_pk_bf16_f32 v41, v42, v43
  v_smfmac_f32_16x16x64_bf16 v[48:51], v[96:99], v[232:239], v1
  s_nop 1
  v_and_or_b32 v40, v40, -2, s65
  v_smfmac_f32_16x16x64_bf16 v[48:51], v[100:103], v[240:247], v1
  buffer_store_dwordx2 v[40:41], v8, s[40:43], s75 offen sc1
  v_cvt_pk_bf16_f32 v44, v44, v45
  v_smfmac_f32_16x16x64_bf16 v[48:51], v[104:107], v[248:255], v1
  s_nop 1
  v_cvt_pk_bf16_f32 v45, v46, v47
  v_and_or_b32 v44, v44, -2, s65
  buffer_store_dwordx2 v[44:45], v8, s[40:43], s76 offen sc1
  s_nop 2
  v_cvt_pk_bf16_f32 v48, v48, v49
  v_cvt_pk_bf16_f32 v49, v50, v51
  v_and_or_b32 v48, v48, -2, s65
  buffer_store_dwordx2 v[48:49], v8, s[40:43], s77 offen sc1
  s_nop 15
  s_nop 9
  s_cmp_lt_u32 s44, 1
  s_cbranch_scc1 L_poll1_x
  s_nop 9
  s_cmp_lt_u32 s44, 2
  s_cbranch_scc1 L_poll1_x
  s_nop 9
  s_cmp_lt_u32 s44, 3
  s_cbranch_scc1 L_poll1_x
  s_nop 9
L_poll1_x:
  buffer_load_dwordx4 v[28:31], v9, s[40:43], s62 offen sc1
  buffer_load_dwordx4 v[32:35], v9, s[40:43], s62 offen offset:1024 sc1
  v_mov_b64 v[60:61], 0
  v_mov_b64 v[62:63], 0
  v_mov_b64 v[64:65], 0
  v_mov_b64 v[66:67], 0
  v_mov_b64 v[68:69], 0
  v_mov_b64 v[70:71], 0
  v_mov_b64 v[72:73], 0
  v_mov_b64 v[74:75], 0
  s_nop 15
  s_nop 3
  buffer_load_dwordx4 v[36:39], v9, s[40:43], s62 offen sc1
  buffer_load_dwordx4 v[40:43], v9, s[40:43], s62 offen offset:1024 sc1
L_poll1b_x:
  s_waitcnt vmcnt(3)
  v_mfma_f32_16x16x32_bf16 v[24:27], v[28:31], v[20:23], 0
  v_bitop3_b32 v44, v28, v30, s65 bitop3:0x7e
  s_waitcnt vmcnt(2)
  v_mfma_f32_16x16x32_bf16 v[24:27], v[32:35], v[20:23], v[24:27]
  v_bitop3_b32 v45, v32, v34, s65 bitop3:0x7e
  v_or_b32 v44, v44, v45
  v_and_b32 v44, 1, v44
  v_cmp_ne_u32 vcc, 0, v44
  s_nop 2
  s_cbranch_vccnz L_retry1_x
L_got1_x:
  v_add_f32 v24, v24, v25
  v_add_f32 v26, v26, v27
  s_nop 1
  v_permlane16_swap_b32 v24, v26
  v_add_f32 v24, v24, v26
  v_cvt_pk_bf16_f32 v24, v24, v17
  v_min_u32 v24, s90, v24
  v_cndmask_b32 v24, v24, -1, s[78:79]
  buffer_store_short v24, v10, s[40:43], s64 offen sc1
  ds_read_b128 v[76:79], v3 offset:0
  ds_read_b128 v[80:83], v3 offset:1024
  ds_read_b128 v[84:87], v3 offset:2048
  ds_read_b128 v[88:91], v3 offset:3072
  ds_read_b128 v[92:95], v3 offset:16384
  ds_read_b128 v[96:99], v3 offset:17408
  ds_read_b128 v[100:103], v3 offset:18432
  ds_read_b128 v[104:107], v3 offset:19456
  v_xor_b32 v3, 0x8000, v3
  ds_read_b128 v[108:111], v3 offset:0
  ds_read_b128 v[112:115], v3 offset:1024
  ds_read_b128 v[116:119], v3 offset:2048
  ds_read_b128 v[120:123], v3 offset:3072
  v_cmp_ne_u32 vcc, 4, v4
  v_xor_b32 v10, 0x2000, v10
  v_xor_b32 v11, 0x2000, v11
  v_xor_b32 v0, 0x2000, v0
  s_waitcnt vmcnt(1)
  v_xor_b32 v32, 2048, v11
  v_xor_b32 v40, 4096, v11
  v_xor_b32 v48, 6144, v11
  s_cbranch_vccnz L_fs_x
L_fsback_x:
  s_max_i32 s93, s56, 0
  s_add_u32 s56, s56, 1
  s_xor_b32 s65, s65, 1
  s_add_u32 s58, s57, 0x1000000
  s_add_u32 s68, s56, 1
  s_min_u32 s68, s68, 63
  s_lshl_b32 s68, s68, 13
  s_add_u32 s57, s72, s68
  s_add_u32 s59, s57, s73
  s_add_u32 s68, s56, 2
  s_min_u32 s68, s68, 63
  s_lshr_b32 s68, s68, 3
  s_lshl2_add_u32 s60, s68, s92
  s_add_u32 s61, s61, 0x20000
  s_xor_b32 s70, s70, 0x2000
  s_nop 9
  s_branch L_poll2_x
L_retry2_x:
  s_waitcnt vmcnt(0)
  v_max3_u32 v44, v28, v29, v30
  v_max3_u32 v45, v31, v36, v37
  v_max3_u32 v44, v44, v38, v39
  v_max_u32 v44, v44, v45
  v_cmp_eq_u32 vcc, -1, v44
  v_mov_b64 v[20:21], v[28:29]
  v_mov_b64 v[22:23], v[30:31]
  v_mov_b64 v[24:25], v[36:37]
  v_mov_b64 v[26:27], v[38:39]
  v_mov_b64 v[52:53], 0
  v_mov_b64 v[54:55], 0
  v_mov_b64 v[56:57], 0
  v_mov_b64 v[58:59], 0
  v_mov_b64 v[60:61], 0
  v_mov_b64 v[62:63], 0
  s_cbranch_vccnz L_poll2_x
  s_branch L_entry_x
L_retry1_x:
  buffer_load_dwordx4 v[28:31], v9, s[40:43], s62 offen sc1
  buffer_load_dwordx4 v[32:35], v9, s[40:43], s62 offen offset:1024 sc1
  s_add_u32 s67, s67, 1
  s_cmp_gt_u32 s67, 1048576
  s_cbranch_scc1 L_exit
  s_waitcnt vmcnt(3)
  v_mfma_f32_16x16x32_bf16 v[24:27], v[36:39], v[20:23], 0
  v_bitop3_b32 v44, v36, v38, s65 bitop3:0x7e
  s_waitcnt vmcnt(2)
  v_mfma_f32_16x16x32_bf16 v[24:27], v[40:43], v[20:23], v[24:27]
  v_bitop3_b32 v45, v40, v42, s65 bitop3:0x7e
  v_or_b32 v44, v44, v45
  v_and_b32 v44, 1, v44
  v_cmp_ne_u32 vcc, 0, v44
  s_nop 2
  s_cbranch_vccz L_got1_x
  buffer_load_dwordx4 v[36:39], v9, s[40:43], s62 offen sc1
  buffer_load_dwordx4 v[40:43], v9, s[40:43], s62 offen offset:1024 sc1
  s_branch L_poll1b_x
L_smslow_x:
  v_max3_f32 v22, v52, v53, v54
  v_max3_f32 v22, v22, v55, v56
  v_max3_f32 v22, v22, v57, v58
  v_max3_f32 v22, v22, v59, v60
  v_max_f32 v22, v22, v61
  v_mov_b32 v20, v22
  s_nop 1
  v_permlane32_swap_b32 v20, v22
  v_max_f32 v22, v22, v20
  v_mov_b32 v20, v22
  s_nop 1
  v_permlane16_swap_b32 v20, v22
  v_max_f32 v22, v22, v20
  v_sub_f32 v20, v52, v22
  v_sub_f32 v21, v53, v22
  v_exp_f32 v20, v20
  v_exp_f32 v21, v21
  s_nop 0
  v_cvt_pk_bf16_f32 v24, v20, v21
  v_sub_f32 v20, v54, v22
  v_sub_f32 v21, v55, v22
  v_exp_f32 v20, v20
  v_exp_f32 v21, v21
  s_nop 0
  v_cvt_pk_bf16_f32 v25, v20, v21
  v_sub_f32 v20, v56, v22
  v_sub_f32 v21, v57, v22
  v_exp_f32 v20, v20
  v_exp_f32 v21, v21
  s_nop 0
  v_cvt_pk_bf16_f32 v26, v20, v21
  v_sub_f32 v20, v58, v22
  v_sub_f32 v21, v59, v22
  v_exp_f32 v20, v20
  v_exp_f32 v21, v21
  s_nop 0
  v_cvt_pk_bf16_f32 v27, v20, v21
  v_sub_f32 v20, v60, v22
  v_sub_f32 v21, v61, v22
  v_exp_f32 v20, v20
  v_exp_f32 v21, v21
  s_nop 0
  v_cvt_pk_bf16_f32 v16, v20, v21
  v_cvt_pk_bf16_f32 v19, v20, v21
  s_nop 1
  v_mfma_f32_16x16x32_bf16 v[64:67], v[12:15], v[24:27], 0
  v_mfma_f32_16x16x32_bf16 v[80:83], v[36:39], v[24:27], 0
  v_mfma_f32_16x16x32_bf16 v[84:87], v[40:43], v[24:27], 0
  s_nop 3
  v_mfma_f32_16x16x16_bf16 v[64:67], v[12:13], v[16:17], v[64:67]
  v_mfma_f32_16x16x16_bf16 v[80:83], v[126:127], v[16:17], v[80:83]
  v_mfma_f32_16x16x16_bf16 v[84:87], v[126:127], v[18:19], v[84:87]
  s_nop 7
  v_rcp_f32 v65, v64
  s_mov_b64 vcc, 0
  s_branch L_smback_x
L_fs_x:
  buffer_load_dword v4, v17, s[40:43], s60 offen sc1
  s_add_u32 s67, s67, 1
  s_cmp_gt_u32 s67, 1048576
  s_cbranch_scc1 L_exit
  s_waitcnt vmcnt(0)
  v_cmp_ne_u32 vcc, 4, v4
  s_cbranch_vccnz L_fs_x
  s_branch L_fsback_x
L_team_last:
  s_waitcnt vmcnt(0)
  s_add_u32 s61, s61, 0x20000
  v_mov_b32 v4, 64
  buffer_store_dwordx4 v[124:127], v2, s[40:43], s61 offen sc1
  s_waitcnt vmcnt(0)
  s_barrier
  buffer_store_dword v4, v17, s[40:43], s66 offen sc1
  s_waitcnt vmcnt(0)
  s_endpgm
L_exit:
  s_endpgm
.p2align 8
.type L_ptab,@object
L_ptab:
.long 0x4000020,0x5201021,0x5480021,0x4701020,0x4980020,0x5b81021,0x5e00021,0x101012,0x600012,0xa81012,0xf80012,0x3401032,0x3900032,0x3d81032,0x4,0x4,0x4,0x4,0x4,0x4,0x4,0x4,0x4,0x4,0x4,0x4,0x4,0x4,0x4,0x4,0x4,0x4,0x71,0x182,0x0,0x0,0x0,0x0,0x0,0x0,0x0,0x0,0x0,0x0,0x0,0x0,0x0,0x0,0x0,0x0,0x0,0x0,0x0,0x0,0x0,0x0,0x0,0x0,0x0,0x0,0x0,0x0,0x0,0x0
.long 0x4001020,0x4280020,0x5481021,0x5700021,0x4981020,0x4c00020,0x5e01021,0x180012,0x601012,0xb00012,0xf81012,0x3480032,0x3901032,0x3e00032,0x4,0x4,0x4,0x4,0x4,0x4,0x4,0x4,0x4,0x4,0x4,0x4,0x4,0x4,0x4,0x4,0x4,0x4,0x61,0x142,0x0,0x0,0x0,0x0,0x0,0x0,0x0,0x0,0x0,0x0,0x0,0x0,0x0,0x0,0x0,0x0,0x0,0x0,0x0,0x0,0x0,0x0,0x0,0x0,0x0,0x0,0x0,0x0,0x0,0x0
.long 0x5000021,0x4281020,0x4500020,0x5701021,0x5980021,0x4c01020,0x4e80020,0x181012,0x680012,0xb01012,0x3000032,0x3481032,0x3980032,0x3e01032,0x4,0x4,0x4,0x4,0x4,0x4,0x4,0x4,0x4,0x4,0x4,0x4,0x4,0x4,0x4,0x4,0x4,0x4,0x51,0x102,0x0,0x0,0x0,0x0,0x0,0x0,0x0,0x0,0x0,0x0,0x0,0x0,0x0,0x0,0x0,0x0,0x0,0x0,0x0,0x0,0x0,0x0,0x0,0x0,0x0,0x0,0x0,0x0,0x0,0x0
.long 0x5001021,0x5280021,0x4501020,0x4780020,0x5981021,0x5c00021,0x4e81020,0x200012,0x681012,0xb80012,0x3001032,0x3500032,0x3981032,0x3e80032,0x4,0x4,0x4,0x4,0x4,0x4,0x4,0x4,0x4,0x4,0x4,0x4,0x4,0x4,0x4,0x4,0x4,0x4,0x41,0xc6,0x0,0x0,0x0,0x0,0x0,0x0,0x0,0x0,0x0,0x0,0x0,0x0,0x0,0x0,0x0,0x0,0x0,0x0,0x0,0x0,0x0,0x0,0x0,0x0,0x0,0x0,0x0,0x0,0x0,0x0
.long 0x4080020,0x5281021,0x5500021,0x4781020,0x4a00020,0x5c01021,0x5e80021,0x201012,0x700012,0xb81012,0x3080032,0x3501032,0x3a00032,0x3e81032,0x4,0x4,0x4,0x4,0x4,0x4,0x4,0x4,0x4,0x4,0x4,0x4,0x4,0x4,0x4,0x4,0x4,0x4,0x31,0x86,0x0,0x0,0x0,0x0,0x0,0x0,0x0,0x0,0x0,0x0,0x0,0x0,0x0,0x0,0x0,0x0,0x0,0x0,0x0,0x0,0x0,0x0,0x0,0x0,0x0,0x0,0x0,0x0,0x0,0x0
.long 0x4081020,0x4300020,0x5501021,0x5780021,0x4a01020,0x4c80020,0x5e81021,0x280012,0x701012,0xc00012,0x3081032,0x3580032,0x3a01032,0x3f00032,0x4,0x4,0x4,0x4,0x4,0x4,0x4,0x4,0x4,0x4,0x4,0x4,0x4,0x4,0x4,0x4,0x4,0x4,0x21,0x46,0x1c2,0x0,0x0,0x0,0x0,0x0,0x0,0x0,0x0,0x0,0x0,0x0,0x0,0x0,0x0,0x0,0x0,0x0,0x0,0x0,0x0,0x0,0x0,0x0,0x0,0x0,0x0,0x0,0x0,0x0
.long 0x5080021,0x4301020,0x4580020,0x5781021,0x5a00021,0x4c81020,0x4f00020,0x281012,0x780012,0xc01012,0x3100032,0x3581032,0x3a80032,0x3f01032,0x4,0x4,0x4,0x4,0x4,0x4,0x4,0x4,0x4,0x4,0x4,0x4,0x4,0x4,0x4,0x4,0x4,0x4,0x11,0x1,0x6,0x0,0x0,0x0,0x0,0x0,0x0,0x0,0x0,0x0,0x0,0x0,0x0,0x0,0x0,0x0,0x0,0x0,0x0,0x0,0x0,0x0,0x0,0x0,0x0,0x0,0x0,0x0,0x0,0x0
.long 0x5081021,0x5300021,0x4581020,0x4800020,0x5a01021,0x5c80021,0x4f01020,0x300012,0x781012,0xc80012,0x3101032,0x3600032,0x3a81032,0x3f80032,0x4,0x4,0x4,0x4,0x4,0x4,0x4,0x4,0x4,0x4,0x4,0x4,0x4,0x4,0x4,0x4,0x4,0x4,0x75,0x192,0x0,0x0,0x0,0x0,0x0,0x0,0x0,0x0,0x0,0x0,0x0,0x0,0x0,0x0,0x0,0x0,0x0,0x0,0x0,0x0,0x0,0x0,0x0,0x0,0x0,0x0,0x0,0x0,0x0,0x0
.long 0x4100020,0x5301021,0x5580021,0x4801020,0x4a80020,0x5c81021,0x5f00021,0x301012,0x800012,0xc81012,0x3180032,0x3601032,0x3b00032,0x3f81032,0x4,0x4,0x4,0x4,0x4,0x4,0x4,0x4,0x4,0x4,0x4,0x4,0x4,0x4,0x4,0x4,0x4,0x4,0x65,0x152,0x0,0x0,0x0,0x0,0x0,0x0,0x0,0x0,0x0,0x0,0x0,0x0,0x0,0x0,0x0,0x0,0x0,0x0,0x0,0x0,0x0,0x0,0x0,0x0,0x0,0x0,0x0,0x0,0x0,0x0
.long 0x4101020,0x4380020,0x5581021,0x5800021,0x4a81020,0x4d00020,0x5f01021,0x380012,0x801012,0xd00012,0x3181032,0x3680032,0x3b01032,0x4,0x4,0x4,0x4,0x4,0x4,0x4,0x4,0x4,0x4,0x4,0x4,0x4,0x4,0x4,0x4,0x4,0x4,0x4,0x55,0x112,0x0,0x0,0x0,0x0,0x0,0x0,0x0,0x0,0x0,0x0,0x0,0x0,0x0,0x0,0x0,0x0,0x0,0x0,0x0,0x0,0x0,0x0,0x0,0x0,0x0,0x0,0x0,0x0,0x0,0x0
.long 0x5100021,0x4381020,0x4600020,0x5801021,0x5a80021,0x4d01020,0x4f80020,0x381012,0x880012,0xd01012,0x3200032,0x3681032,0x3b80032,0x4,0x4,0x4,0x4,0x4,0x4,0x4,0x4,0x4,0x4,0x4,0x4,0x4,0x4,0x4,0x4,0x4,0x4,0x4,0x45,0xd6,0x0,0x0,0x0,0x0,0x0,0x0,0x0,0x0,0x0,0x0,0x0,0x0,0x0,0x0,0x0,0x0,0x0,0x0,0x0,0x0,0x0,0x0,0x0,0x0,0x0,0x0,0x0,0x0,0x0,0x0
.long 0x5101021,0x5380021,0x4601020,0x4880020,0x5a81021,0x5d00021,0x4f81020,0x400012,0x881012,0xd80012,0x3201032,0x3700032,0x3b81032,0x4,0x4,0x4,0x4,0x4,0x4,0x4,0x4,0x4,0x4,0x4,0x4,0x4,0x4,0x4,0x4,0x4,0x4,0x4,0x35,0x96,0x0,0x0,0x0,0x0,0x0,0x0,0x0,0x0,0x0,0x0,0x0,0x0,0x0,0x0,0x0,0x0,0x0,0x0,0x0,0x0,0x0,0x0,0x0,0x0,0x0,0x0,0x0,0x0,0x0,0x0
.long 0x4180020,0x5381021,0x5600021,0x4881020,0x4b00020,0x5d01021,0x5f80021,0x401012,0x900012,0xd81012,0x3280032,0x3701032,0x3c00032,0x4,0x4,0x4,0x4,0x4,0x4,0x4,0x4,0x4,0x4,0x4,0x4,0x4,0x4,0x4,0x4,0x4,0x4,0x4,0x25,0x56,0x1d2,0x0,0x0,0x0,0x0,0x0,0x0,0x0,0x0,0x0,0x0,0x0,0x0,0x0,0x0,0x0,0x0,0x0,0x0,0x0,0x0,0x0,0x0,0x0,0x0,0x0,0x0,0x0,0x0,0x0
.long 0x4181020,0x4400020,0x5601021,0x5880021,0x4b01020,0x4d80020,0x5f81021,0x480012,0x901012,0xe00012,0x3281032,0x3780032,0x3c01032,0x4,0x4,0x4,0x4,0x4,0x4,0x4,0x4,0x4,0x4,0x4,0x4,0x4,0x4,0x4,0x4,0x4,0x4,0x4,0x15,0x5,0x16,0x0,0x0,0x0,0x0,0x0,0x0,0x0,0x0,0x0,0x0,0x0,0x0,0x0,0x0,0x0,0x0,0x0,0x0,0x0,0x0,0x0,0x0,0x0,0x0,0x0,0x0,0x0,0x0,0x0
.long 0x5180021,0x4401020,0x4680020,0x5881021,0x5b00021,0x4d81020,0x12,0x481012,0x980012,0xe01012,0x3300032,0x3781032,0x3c80032,0x4,0x4,0x4,0x4,0x4,0x4,0x4,0x4,0x4,0x4,0x4,0x4,0x4,0x4,0x4,0x4,0x4,0x4,0x4,0x79,0x1a2,0x0,0x0,0x0,0x0,0x0,0x0,0x0,0x0,0x0,0x0,0x0,0x0,0x0,0x0,0x0,0x0,0x0,0x0,0x0,0x0,0x0,0x0,0x0,0x0,0x0,0x0,0x0,0x0,0x0,0x0
.long 0x5181021,0x5400021,0x4681020,0x4900020,0x5b01021,0x5d80021,0x1012,0x500012,0x981012,0xe80012,0x3301032,0x3800032,0x3c81032,0x4,0x4,0x4,0x4,0x4,0x4,0x4,0x4,0x4,0x4,0x4,0x4,0x4,0x4,0x4,0x4,0x4,0x4,0x4,0x69,0x162,0x0,0x0,0x0,0x0,0x0,0x0,0x0,0x0,0x0,0x0,0x0,0x0,0x0,0x0,0x0,0x0,0x0,0x0,0x0,0x0,0x0,0x0,0x0,0x0,0x0,0x0,0x0,0x0,0x0,0x0
.long 0x4200020,0x5401021,0x5680021,0x4901020,0x4b80020,0x5d81021,0x80012,0x501012,0xa00012,0xe81012,0x3380032,0x3801032,0x3d00032,0x4,0x4,0x4,0x4,0x4,0x4,0x4,0x4,0x4,0x4,0x4,0x4,0x4,0x4,0x4,0x4,0x4,0x4,0x4,0x59,0x122,0x0,0x0,0x0,0x0,0x0,0x0,0x0,0x0,0x0,0x0,0x0,0x0,0x0,0x0,0x0,0x0,0x0,0x0,0x0,0x0,0x0,0x0,0x0,0x0,0x0,0x0,0x0,0x0,0x0,0x0
.long 0x4201020,0x4480020,0x5681021,0x5900021,0x4b81020,0x4e00020,0x81012,0x580012,0xa01012,0xf00012,0x3381032,0x3880032,0x3d01032,0x4,0x4,0x4,0x4,0x4,0x4,0x4,0x4,0x4,0x4,0x4,0x4,0x4,0x4,0x4,0x4,0x4,0x4,0x4,0x49,0xe6,0x0,0x0,0x0,0x0,0x0,0x0,0x0,0x0,0x0,0x0,0x0,0x0,0x0,0x0,0x0,0x0,0x0,0x0,0x0,0x0,0x0,0x0,0x0,0x0,0x0,0x0,0x0,0x0,0x0,0x0
.long 0x5200021,0x4481020,0x4700020,0x5901021,0x5b80021,0x4e01020,0x100012,0x581012,0xa80012,0xf01012,0x3400032,0x3881032,0x3d80032,0x4,0x4,0x4,0x4,0x4,0x4,0x4,0x4,0x4,0x4,0x4,0x4,0x4,0x4,0x4,0x4,0x4,0x4,0x4,0x39,0xa6,0x0,0x0,0x0,0x0,0x0,0x0,0x0,0x0,0x0,0x0,0x0,0x0,0x0,0x0,0x0,0x0,0x0,0x0,0x0,0x0,0x0,0x0,0x0,0x0,0x0,0x0,0x0,0x0,0x0,0x2
.long 0x1000000,0x1101000,0x2200001,0x2301001,0x1480000,0x1581000,0x2680001,0x2781001,0x1900000,0x1a01000,0x2b00001,0x2c01001,0x1d80000,0x1e81000,0x2f80001,0x4,0x4,0x4,0x4,0x4,0x4,0x4,0x4,0x4,0x4,0x4,0x4,0x4,0x4,0x4,0x4,0x4,0x29,0x66,0x1e2,0x0,0x0,0x0,0x0,0x0,0x0,0x0,0x0,0x0,0x0,0x0,0x0,0x0,0x0,0x0,0x0,0x0,0x0,0x0,0x0,0x0,0x0,0x0,0x0,0x0,0x0,0x0,0x0,0x1
.long 0x1001000,0x2100001,0x2201001,0x1380000,0x1481000,0x2580001,0x2681001,0x1800000,0x1901000,0x2a00001,0x2b01001,0x1c80000,0x1d81000,0x2e80001,0x2f81001,0x4,0x4,0x4,0x4,0x4,0x4,0x4,0x4,0x4,0x4,0x4,0x4,0x4,0x4,0x4,0x4,0x4,0x19,0x9,0x26,0x0,0x0,0x0,0x0,0x0,0x0,0x0,0x0,0x0,0x0,0x0,0x0,0x0,0x0,0x0,0x0,0x0,0x0,0x0,0x0,0x0,0x0,0x0,0x0,0x0,0x0,0x0,0x0,0x1
.long 0x2000001,0x2101001,0x1280000,0x1381000,0x2480001,0x2581001,0x1700000,0x1801000,0x2900001,0x2a01001,0x1b80000,0x1c81000,0x2d80001,0x2e81001,0x4,0x4,0x4,0x4,0x4,0x4,0x4,0x4,0x4,0x4,0x4,0x4,0x4,0x4,0x4,0x4,0x4,0x4,0x7d,0x1b2,0x0,0x0,0x0,0x0,0x0,0x0,0x0,0x0,0x0,0x0,0x0,0x0,0x0,0x0,0x0,0x0,0x0,0x0,0x0,0x0,0x0,0x0,0x0,0x0,0x0,0x0,0x0,0x0,0x0,0x1
.long 0x2001001,0x1180000,0x1281000,0x2380001,0x2481001,0x1600000,0x1701000,0x2800001,0x2901001,0x1a80000,0x1b81000,0x2c80001,0x2d81001,0x1f00000,0x4,0x4,0x4,0x4,0x4,0x4,0x4,0x4,0x4,0x4,0x4,0x4,0x4,0x4,0x4,0x4,0x4,0x4,0x6d,0x172,0x0,0x0,0x0,0x0,0x0,0x0,0x0,0x0,0x0,0x0,0x0,0x0,0x0,0x0,0x0,0x0,0x0,0x0,0x0,0x0,0x0,0x0,0x0,0x0,0x0,0x0,0x0,0x0,0x0,0x1
.long 0x1080000,0x1181000,0x2280001,0x2381001,0x1500000,0x1601000,0x2700001,0x2801001,0x1980000,0x1a81000,0x2b80001,0x2c81001,0x1e00000,0x1f01000,0x4,0x4,0x4,0x4,0x4,0x4,0x4,0x4,0x4,0x4,0x4,0x4,0x4,0x4,0x4,0x4,0x4,0x4,0x5d,0x132,0x0,0x0,0x0,0x0,0x0,0x0,0x0,0x0,0x0,0x0,0x0,0x0,0x0,0x0,0x0,0x0,0x0,0x0,0x0,0x0,0x0,0x0,0x0,0x0,0x0,0x0,0x0,0x0,0x0,0x1
.long 0x1081000,0x2180001,0x2281001,0x1400000,0x1501000,0x2600001,0x2701001,0x1880000,0x1981000,0x2a80001,0x2b81001,0x1d00000,0x1e01000,0x2f00001,0x4,0x4,0x4,0x4,0x4,0x4,0x4,0x4,0x4,0x4,0x4,0x4,0x4,0x4,0x4,0x4,0x4,0x4,0x4d,0xf6,0x0,0x0,0x0,0x0,0x0,0x0,0x0,0x0,0x0,0x0,0x0,0x0,0x0,0x0,0x0,0x0,0x0,0x0,0x0,0x0,0x0,0x0,0x0,0x0,0x0,0x0,0x0,0x0,0x0,0x1
.long 0x2080001,0x2181001,0x1300000,0x1401000,0x2500001,0x2601001,0x1780000,0x1881000,0x2980001,0x2a81001,0x1c00000,0x1d01000,0x2e00001,0x2f01001,0x4,0x4,0x4,0x4,0x4,0x4,0x4,0x4,0x4,0x4,0x4,0x4,0x4,0x4,0x4,0x4,0x4,0x4,0x3d,0xb6,0x0,0x0,0x0,0x0,0x0,0x0,0x0,0x0,0x0,0x0,0x0,0x0,0x0,0x0,0x0,0x0,0x0,0x0,0x0,0x0,0x0,0x0,0x0,0x0,0x0,0x0,0x0,0x0,0x0,0x1
.long 0x2081001,0x1200000,0x1301000,0x2400001,0x2501001,0x1680000,0x1781000,0x2880001,0x2981001,0x1b00000,0x1c01000,0x2d00001,0x2e01001,0x1f80000,0x4,0x4,0x4,0x4,0x4,0x4,0x4,0x4,0x4,0x4,0x4,0x4,0x4,0x4,0x4,0x4,0x4,0x4,0x2d,0x76,0x1f2,0x0,0x0,0x0,0x0,0x0,0x0,0x0,0x0,0x0,0x0,0x0,0x0,0x0,0x0,0x0,0x0,0x0,0x0,0x0,0x0,0x0,0x0,0x0,0x0,0x0,0x0,0x0,0x0,0x1
.long 0x1100000,0x1201000,0x2300001,0x2401001,0x1580000,0x1681000,0x2780001,0x2881001,0x1a00000,0x1b01000,0x2c00001,0x2d01001,0x1e80000,0x1f81000,0x4,0x4,0x4,0x4,0x4,0x4,0x4,0x4,0x4,0x4,0x4,0x4,0x4,0x4,0x4,0x4,0x4,0x4,0x1d,0xd,0x36,0x0,0x0,0x0,0x0,0x0,0x0,0x0,0x0,0x0,0x0,0x0,0x0,0x0,0x0,0x0,0x0,0x0,0x0,0x0,0x0,0x0,0x0,0x0,0x0,0x0,0x0,0x0,0x0,0x1
.section .rodata,"a"
.p2align 6
.amdhsa_kernel gated_mix__compressed_kv_cla__memory_aug_recurrent_mem_tr__prompt_kernel
  .amdhsa_next_free_vgpr 512
  .amdhsa_next_free_sgpr 102
  .amdhsa_accum_offset 256
  .amdhsa_group_segment_fixed_size 0
  .amdhsa_kernarg_size 136
  .amdhsa_user_sgpr_count 2
  .amdhsa_user_sgpr_kernarg_segment_ptr 1
  .amdhsa_system_sgpr_workgroup_id_x 1
  .amdhsa_float_denorm_mode_32 3
.end_amdhsa_kernel
```

```asm
; @launch grid=(256,1,1) block=(256,1,1) lds=163840
.amdgcn_target "amdgcn-amd-amdhsa--gfx950"
.text
.globl gated_mix__compressed_kv_cla__memory_aug_recurrent_mem_tr__prompt_kernel
.p2align 8
.type gated_mix__compressed_kv_cla__memory_aug_recurrent_mem_tr__prompt_kernel,@function
gated_mix__compressed_kv_cla__memory_aug_recurrent_mem_tr__prompt_kernel:
  s_cmp_ge_u32 s2, 256
  s_cbranch_scc1 L_exit
  s_load_dwordx16 s[8:23], s[0:1], 0
  s_load_dwordx16 s[24:39], s[0:1], 64
  s_load_dwordx2 s[40:41], s[0:1], 128
  s_getreg_b32 s46, hwreg(HW_REG_XCC_ID, 0, 4)
  v_lshrrev_b32 v1, 6, v0
  v_and_b32 v0, 63, v0
  v_readfirstlane_b32 s44, v1
  s_and_b32 s46, s46, 7
  s_waitcnt lgkmcnt(0)
  s_and_b32 s41, s41, 0xffff
  s_mov_b32 s42, 0x10000000
  s_mov_b32 s43, 0x20000
  s_and_b32 s47, s2, 7
  s_lshr_b32 s45, s2, 3
  s_cmp_eq_u32 s47, 0
  s_cbranch_scc1 L_team
  s_sub_u32 s3, s47, 1
  s_lshl_b32 s3, s3, 5
  s_add_u32 s3, s3, s45
  s_getpc_b64 s[4:5]
L_pc0:
  s_add_u32 s4, s4, L_ptab-L_pc0
  s_addc_u32 s5, s5, 0
  s_lshl_b32 s3, s3, 7
  v_and_b32 v2, 31, v0
  v_lshl_add_u32 v2, v2, 2, s3
  global_load_dword v1, v2, s[4:5]
  s_mov_b32 s95, 0
  s_waitcnt vmcnt(0)
L_next:
  v_readlane_b32 s3, v1, s95
  s_add_u32 s95, s95, 1
  s_nop 0
  s_and_b32 s4, s3, 3
  s_cmp_eq_u32 s4, 0
  s_cbranch_scc1 L_after_p
  s_cmp_eq_u32 s4, 1
  s_cbranch_scc1 L_go_att
  s_cmp_eq_u32 s4, 2
  s_cbranch_scc1 L_go_outx
  s_bfe_u32 s6, s3, 0x10004
  s_bfe_u32 s7, s3, 0x10005
  s_bfe_u32 s70, s3, 0x30008
L_p_start:
  s_cmp_eq_u32 s6, 0
  s_cselect_b64 s[52:53], s[8:9], s[10:11]
  s_and_b32 s53, s53, 0xffff
  s_mov_b32 s54, 0x200000
  s_mov_b32 s55, 0x20000
  s_mov_b32 s50, 0x400000
  s_mov_b32 s51, 0x20000
  s_lshl_b32 s64, s44, 12
  v_readlane_b32 s57, v1, s95
  s_add_u32 s56, s95, 1
  v_readlane_b32 s58, v1, s56
  s_mov_b32 s60, 4
  s_mov_b32 s61, 4
  s_add_u32 s56, s95, 2
  v_lshrrev_b32 v12, 3, v0
  v_lshlrev_b32 v2, 13, v12
  v_and_b32 v12, 7, v0
  v_lshrrev_b32 v13, 3, v0
  v_and_b32 v13, 2, v13
  v_xor_b32 v12, v12, v13
  v_lshl_add_u32 v2, v12, 4, v2
  s_lshl_b32 s67, s44, 18
  v_add_u32 v2, s67, v2
  v_xor_b32 v3, 64, v2
  s_lshl_b32 s67, s70, 8
  s_lshl_b32 s68, s44, 6
  s_add_u32 s67, s67, s68
  v_and_b32 v15, 31, v0
  v_add_u32 v15, s67, v15
  v_lshlrev_b32 v15, 2, v15
  s_lshl_b32 s71, s67, 10
  s_lshl_b32 s72, s44, 15
  s_add_u32 s72, s72, 0x8000
  v_lshlrev_b32 v14, 4, v0
  v_xor_b32 v32, 0, v14
  v_xor_b32 v33, 16, v14
  v_xor_b32 v34, 32, v14
  v_xor_b32 v35, 48, v14
  v_xor_b32 v36, 64, v14
  v_xor_b32 v37, 80, v14
  v_xor_b32 v38, 96, v14
  v_xor_b32 v39, 112, v14
  v_xor_b32 v40, 128, v14
  v_xor_b32 v41, 144, v14
  v_xor_b32 v42, 160, v14
  v_xor_b32 v43, 176, v14
  v_xor_b32 v44, 192, v14
  v_xor_b32 v45, 208, v14
  v_xor_b32 v46, 224, v14
  v_xor_b32 v47, 240, v14
  s_add_u32 m0, s72, 0
  s_add_u32 s63, s71, 0
  buffer_load_dwordx4 v32, s[52:55], s63 offen lds
  s_add_u32 m0, s72, 1024
  s_add_u32 s63, s71, 1024
  buffer_load_dwordx4 v33, s[52:55], s63 offen lds
  s_add_u32 m0, s72, 2048
  s_add_u32 s63, s71, 2048
  buffer_load_dwordx4 v34, s[52:55], s63 offen lds
  s_add_u32 m0, s72, 3072
  s_add_u32 s63, s71, 3072
  buffer_load_dwordx4 v35, s[52:55], s63 offen lds
  s_add_u32 m0, s72, 4096
  s_add_u32 s63, s71, 4096
  buffer_load_dwordx4 v36, s[52:55], s63 offen lds
  s_add_u32 m0, s72, 5120
  s_add_u32 s63, s71, 5120
  buffer_load_dwordx4 v37, s[52:55], s63 offen lds
  s_add_u32 m0, s72, 6144
  s_add_u32 s63, s71, 6144
  buffer_load_dwordx4 v38, s[52:55], s63 offen lds
  s_add_u32 m0, s72, 7168
  s_add_u32 s63, s71, 7168
  buffer_load_dwordx4 v39, s[52:55], s63 offen lds
  s_add_u32 m0, s72, 8192
  s_add_u32 s63, s71, 8192
  buffer_load_dwordx4 v40, s[52:55], s63 offen lds
  s_add_u32 m0, s72, 9216
  s_add_u32 s63, s71, 9216
  buffer_load_dwordx4 v41, s[52:55], s63 offen lds
  s_add_u32 m0, s72, 10240
  s_add_u32 s63, s71, 10240
  buffer_load_dwordx4 v42, s[52:55], s63 offen lds
  s_add_u32 m0, s72, 11264
  s_add_u32 s63, s71, 11264
  buffer_load_dwordx4 v43, s[52:55], s63 offen lds
  s_add_u32 m0, s72, 12288
  s_add_u32 s63, s71, 12288
  buffer_load_dwordx4 v44, s[52:55], s63 offen lds
  s_add_u32 m0, s72, 13312
  s_add_u32 s63, s71, 13312
  buffer_load_dwordx4 v45, s[52:55], s63 offen lds
  s_add_u32 m0, s72, 14336
  s_add_u32 s63, s71, 14336
  buffer_load_dwordx4 v46, s[52:55], s63 offen lds
  s_add_u32 m0, s72, 15360
  s_add_u32 s63, s71, 15360
  buffer_load_dwordx4 v47, s[52:55], s63 offen lds
  s_add_u32 m0, s72, 16384
  s_add_u32 s63, s71, 16384
  buffer_load_dwordx4 v32, s[52:55], s63 offen lds
  s_add_u32 m0, s72, 17408
  s_add_u32 s63, s71, 17408
  buffer_load_dwordx4 v33, s[52:55], s63 offen lds
  s_add_u32 m0, s72, 18432
  s_add_u32 s63, s71, 18432
  buffer_load_dwordx4 v34, s[52:55], s63 offen lds
  s_add_u32 m0, s72, 19456
  s_add_u32 s63, s71, 19456
  buffer_load_dwordx4 v35, s[52:55], s63 offen lds
  s_add_u32 m0, s72, 20480
  s_add_u32 s63, s71, 20480
  buffer_load_dwordx4 v36, s[52:55], s63 offen lds
  s_add_u32 m0, s72, 21504
  s_add_u32 s63, s71, 21504
  buffer_load_dwordx4 v37, s[52:55], s63 offen lds
  s_add_u32 m0, s72, 22528
  s_add_u32 s63, s71, 22528
  buffer_load_dwordx4 v38, s[52:55], s63 offen lds
  s_add_u32 m0, s72, 23552
  s_add_u32 s63, s71, 23552
  buffer_load_dwordx4 v39, s[52:55], s63 offen lds
  s_add_u32 m0, s72, 24576
  s_add_u32 s63, s71, 24576
  buffer_load_dwordx4 v40, s[52:55], s63 offen lds
  s_add_u32 m0, s72, 25600
  s_add_u32 s63, s71, 25600
  buffer_load_dwordx4 v41, s[52:55], s63 offen lds
  s_add_u32 m0, s72, 26624
  s_add_u32 s63, s71, 26624
  buffer_load_dwordx4 v42, s[52:55], s63 offen lds
  s_add_u32 m0, s72, 27648
  s_add_u32 s63, s71, 27648
  buffer_load_dwordx4 v43, s[52:55], s63 offen lds
  s_add_u32 m0, s72, 28672
  s_add_u32 s63, s71, 28672
  buffer_load_dwordx4 v44, s[52:55], s63 offen lds
  s_add_u32 m0, s72, 29696
  s_add_u32 s63, s71, 29696
  buffer_load_dwordx4 v45, s[52:55], s63 offen lds
  s_add_u32 m0, s72, 30720
  s_add_u32 s63, s71, 30720
  buffer_load_dwordx4 v46, s[52:55], s63 offen lds
  s_add_u32 m0, s72, 31744
  s_add_u32 s63, s71, 31744
  buffer_load_dwordx4 v47, s[52:55], s63 offen lds
  s_bfe_u32 s67, s57, 0x30018
  s_mov_b64 s[48:49], s[12:13]
  s_cmp_eq_u32 s67, 1
  s_cselect_b64 s[48:49], s[14:15], s[48:49]
  s_cmp_eq_u32 s67, 2
  s_cselect_b64 s[48:49], s[16:17], s[48:49]
  s_cmp_eq_u32 s67, 3
  s_cselect_b64 s[48:49], s[24:25], s[48:49]
  s_cmp_eq_u32 s67, 4
  s_cselect_b64 s[48:49], s[26:27], s[48:49]
  s_cmp_eq_u32 s67, 5
  s_cselect_b64 s[48:49], s[28:29], s[48:49]
  s_and_b32 s49, s49, 0xffff
  s_bfe_u32 s67, s57, 0x50013
  s_lshl_b32 s67, s67, 8
  s_bfe_u32 s68, s57, 0x1000c
  s_lshl_b32 s68, s68, 7
  s_or_b32 s62, s67, s68
  s_bitcmp1_b32 s57, 2
  s_cselect_b32 s62, 0x40000000, s62
  s_add_u32 m0, s64, 0
  s_add_u32 s63, s62, 0
  buffer_load_dwordx4 v2, s[48:51], s63 offen lds
  s_add_u32 m0, s64, 1024
  s_add_u32 s63, s62, 65536
  buffer_load_dwordx4 v3, s[48:51], s63 offen lds
  s_add_u32 m0, s64, 2048
  s_add_u32 s63, s62, 131072
  buffer_load_dwordx4 v2, s[48:51], s63 offen lds
  s_add_u32 m0, s64, 3072
  s_add_u32 s63, s62, 196608
  buffer_load_dwordx4 v3, s[48:51], s63 offen lds
  s_add_u32 m0, s64, 16384
  s_add_u32 s63, s62, 1048576
  buffer_load_dwordx4 v2, s[48:51], s63 offen lds
  s_add_u32 m0, s64, 17408
  s_add_u32 s63, s62, 1114112
  buffer_load_dwordx4 v3, s[48:51], s63 offen lds
  s_add_u32 m0, s64, 18432
  s_add_u32 s63, s62, 1179648
  buffer_load_dwordx4 v2, s[48:51], s63 offen lds
  s_add_u32 m0, s64, 19456
  s_add_u32 s63, s62, 1245184
  buffer_load_dwordx4 v3, s[48:51], s63 offen lds
  v_and_b32 v12, 15, v0
  v_lshrrev_b32 v13, 4, v0
  v_xor_b32 v13, v13, v12
  v_lshlrev_b32 v13, 4, v13
  v_lshl_add_u32 v12, v12, 10, v13
  v_add_u32 v64, s72, v12
  v_xor_b32 v65, 64, v64
  v_xor_b32 v66, 128, v64
  v_xor_b32 v67, 192, v64
  s_waitcnt vmcnt(8)
  ds_read_b128 a[0:3], v64 offset:0
  ds_read_b128 a[4:7], v65 offset:0
  ds_read_b128 a[8:11], v66 offset:0
  ds_read_b128 a[12:15], v67 offset:0
  ds_read_b128 a[16:19], v64 offset:256
  ds_read_b128 a[20:23], v65 offset:256
  ds_read_b128 a[24:27], v66 offset:256
  ds_read_b128 a[28:31], v67 offset:256
  ds_read_b128 a[32:35], v64 offset:512
  ds_read_b128 a[36:39], v65 offset:512
  ds_read_b128 a[40:43], v66 offset:512
  ds_read_b128 a[44:47], v67 offset:512
  ds_read_b128 a[48:51], v64 offset:768
  ds_read_b128 a[52:55], v65 offset:768
  ds_read_b128 a[56:59], v66 offset:768
  ds_read_b128 a[60:63], v67 offset:768
  ds_read_b128 a[64:67], v64 offset:16384
  ds_read_b128 a[68:71], v65 offset:16384
  ds_read_b128 a[72:75], v66 offset:16384
  ds_read_b128 a[76:79], v67 offset:16384
  ds_read_b128 a[80:83], v64 offset:16640
  ds_read_b128 a[84:87], v65 offset:16640
  ds_read_b128 a[88:91], v66 offset:16640
  ds_read_b128 a[92:95], v67 offset:16640
  ds_read_b128 a[96:99], v64 offset:16896
  ds_read_b128 a[100:103], v65 offset:16896
  ds_read_b128 a[104:107], v66 offset:16896
  ds_read_b128 a[108:111], v67 offset:16896
  ds_read_b128 a[112:115], v64 offset:17152
  ds_read_b128 a[116:119], v65 offset:17152
  ds_read_b128 a[120:123], v66 offset:17152
  ds_read_b128 a[124:127], v67 offset:17152
  s_waitcnt lgkmcnt(0)
  s_add_u32 m0, s72, 0
  s_add_u32 s63, s71, 32768
  buffer_load_dwordx4 v32, s[52:55], s63 offen lds
  s_add_u32 m0, s72, 1024
  s_add_u32 s63, s71, 33792
  buffer_load_dwordx4 v33, s[52:55], s63 offen lds
  s_add_u32 m0, s72, 2048
  s_add_u32 s63, s71, 34816
  buffer_load_dwordx4 v34, s[52:55], s63 offen lds
  s_add_u32 m0, s72, 3072
  s_add_u32 s63, s71, 35840
  buffer_load_dwordx4 v35, s[52:55], s63 offen lds
  s_add_u32 m0, s72, 4096
  s_add_u32 s63, s71, 36864
  buffer_load_dwordx4 v36, s[52:55], s63 offen lds
  s_add_u32 m0, s72, 5120
  s_add_u32 s63, s71, 37888
  buffer_load_dwordx4 v37, s[52:55], s63 offen lds
  s_add_u32 m0, s72, 6144
  s_add_u32 s63, s71, 38912
  buffer_load_dwordx4 v38, s[52:55], s63 offen lds
  s_add_u32 m0, s72, 7168
  s_add_u32 s63, s71, 39936
  buffer_load_dwordx4 v39, s[52:55], s63 offen lds
  s_add_u32 m0, s72, 8192
  s_add_u32 s63, s71, 40960
  buffer_load_dwordx4 v40, s[52:55], s63 offen lds
  s_add_u32 m0, s72, 9216
  s_add_u32 s63, s71, 41984
  buffer_load_dwordx4 v41, s[52:55], s63 offen lds
  s_add_u32 m0, s72, 10240
  s_add_u32 s63, s71, 43008
  buffer_load_dwordx4 v42, s[52:55], s63 offen lds
  s_add_u32 m0, s72, 11264
  s_add_u32 s63, s71, 44032
  buffer_load_dwordx4 v43, s[52:55], s63 offen lds
  s_add_u32 m0, s72, 12288
  s_add_u32 s63, s71, 45056
  buffer_load_dwordx4 v44, s[52:55], s63 offen lds
  s_add_u32 m0, s72, 13312
  s_add_u32 s63, s71, 46080
  buffer_load_dwordx4 v45, s[52:55], s63 offen lds
  s_add_u32 m0, s72, 14336
  s_add_u32 s63, s71, 47104
  buffer_load_dwordx4 v46, s[52:55], s63 offen lds
  s_add_u32 m0, s72, 15360
  s_add_u32 s63, s71, 48128
  buffer_load_dwordx4 v47, s[52:55], s63 offen lds
  s_add_u32 m0, s72, 16384
  s_add_u32 s63, s71, 49152
  buffer_load_dwordx4 v32, s[52:55], s63 offen lds
  s_add_u32 m0, s72, 17408
  s_add_u32 s63, s71, 50176
  buffer_load_dwordx4 v33, s[52:55], s63 offen lds
  s_add_u32 m0, s72, 18432
  s_add_u32 s63, s71, 51200
  buffer_load_dwordx4 v34, s[52:55], s63 offen lds
  s_add_u32 m0, s72, 19456
  s_add_u32 s63, s71, 52224
  buffer_load_dwordx4 v35, s[52:55], s63 offen lds
  s_add_u32 m0, s72, 20480
  s_add_u32 s63, s71, 53248
  buffer_load_dwordx4 v36, s[52:55], s63 offen lds
  s_add_u32 m0, s72, 21504
  s_add_u32 s63, s71, 54272
  buffer_load_dwordx4 v37, s[52:55], s63 offen lds
  s_add_u32 m0, s72, 22528
  s_add_u32 s63, s71, 55296
  buffer_load_dwordx4 v38, s[52:55], s63 offen lds
  s_add_u32 m0, s72, 23552
  s_add_u32 s63, s71, 56320
  buffer_load_dwordx4 v39, s[52:55], s63 offen lds
  s_add_u32 m0, s72, 24576
  s_add_u32 s63, s71, 57344
  buffer_load_dwordx4 v40, s[52:55], s63 offen lds
  s_add_u32 m0, s72, 25600
  s_add_u32 s63, s71, 58368
  buffer_load_dwordx4 v41, s[52:55], s63 offen lds
  s_add_u32 m0, s72, 26624
  s_add_u32 s63, s71, 59392
  buffer_load_dwordx4 v42, s[52:55], s63 offen lds
  s_add_u32 m0, s72, 27648
  s_add_u32 s63, s71, 60416
  buffer_load_dwordx4 v43, s[52:55], s63 offen lds
  s_add_u32 m0, s72, 28672
  s_add_u32 s63, s71, 61440
  buffer_load_dwordx4 v44, s[52:55], s63 offen lds
  s_add_u32 m0, s72, 29696
  s_add_u32 s63, s71, 62464
  buffer_load_dwordx4 v45, s[52:55], s63 offen lds
  s_add_u32 m0, s72, 30720
  s_add_u32 s63, s71, 63488
  buffer_load_dwordx4 v46, s[52:55], s63 offen lds
  s_add_u32 m0, s72, 31744
  s_add_u32 s63, s71, 64512
  buffer_load_dwordx4 v47, s[52:55], s63 offen lds
  v_lshrrev_b32 v12, 4, v0
  v_lshlrev_b32 v16, 10, v12
  v_bfe_u32 v12, v0, 2, 2
  v_lshl_add_u32 v16, v12, 7, v16
  v_bfe_u32 v12, v0, 3, 2
  v_lshl_add_u32 v16, v12, 5, v16
  v_and_b32 v12, 3, v0
  v_lshl_add_u32 v16, v12, 3, v16
  v_xor_b32 v17, 32, v16
  v_xor_b32 v18, 64, v16
  v_xor_b32 v19, 96, v16
  v_add_u32 v20, 0x10000, v16
  v_add_u32 v21, 0x10000, v17
  v_add_u32 v22, 0x10000, v18
  v_add_u32 v23, 0x10000, v19
  s_lshl_b32 s67, s70, 3
  s_lshl_b32 s68, s44, 1
  s_add_u32 s67, s67, s68
  s_lshl_b32 s67, s67, 13
  v_lshl_add_u32 v8, v0, 4, s67
  v_add_u32 v9, 0x2000, v8
  s_lshl_b32 s67, s70, 2
  s_add_u32 s67, s67, 0xd080000
  s_cmp_eq_u32 s44, 0
  s_cselect_b32 s67, s67, 0x40000000
  v_mov_b32 v10, 0x40000000
  v_mov_b32 v11, 1
  v_writelane_b32 v10, s67, 0
  s_waitcnt vmcnt(0)
  ds_read_b128 a[128:131], v64 offset:0
  ds_read_b128 a[132:135], v65 offset:0
  ds_read_b128 a[136:139], v66 offset:0
  ds_read_b128 a[140:143], v67 offset:0
  ds_read_b128 a[144:147], v64 offset:256
  ds_read_b128 a[148:151], v65 offset:256
  ds_read_b128 a[152:155], v66 offset:256
  ds_read_b128 a[156:159], v67 offset:256
  ds_read_b128 a[160:163], v64 offset:512
  ds_read_b128 a[164:167], v65 offset:512
  ds_read_b128 a[168:171], v66 offset:512
  ds_read_b128 a[172:175], v67 offset:512
  ds_read_b128 a[176:179], v64 offset:768
  ds_read_b128 a[180:183], v65 offset:768
  ds_read_b128 a[184:187], v66 offset:768
  ds_read_b128 a[188:191], v67 offset:768
  ds_read_b128 a[192:195], v64 offset:16384
  ds_read_b128 a[196:199], v65 offset:16384
  ds_read_b128 a[200:203], v66 offset:16384
  ds_read_b128 a[204:207], v67 offset:16384
  ds_read_b128 a[208:211], v64 offset:16640
  ds_read_b128 a[212:215], v65 offset:16640
  ds_read_b128 a[216:219], v66 offset:16640
  ds_read_b128 a[220:223], v67 offset:16640
  ds_read_b128 a[224:227], v64 offset:16896
  ds_read_b128 a[228:231], v65 offset:16896
  ds_read_b128 a[232:235], v66 offset:16896
  ds_read_b128 a[236:239], v67 offset:16896
  ds_read_b128 a[240:243], v64 offset:17152
  ds_read_b128 a[244:247], v65 offset:17152
  ds_read_b128 a[248:251], v66 offset:17152
  ds_read_b128 a[252:255], v67 offset:17152
  s_waitcnt lgkmcnt(0)
  s_barrier
  s_add_u32 m0, s64, 32768
  s_add_u32 s63, s62, 2097152
  buffer_load_dwordx4 v2, s[48:51], s63 offen lds
  s_add_u32 m0, s64, 33792
  s_add_u32 s63, s62, 2162688
  buffer_load_dwordx4 v3, s[48:51], s63 offen lds
  s_add_u32 m0, s64, 34816
  s_add_u32 s63, s62, 2228224
  buffer_load_dwordx4 v2, s[48:51], s63 offen lds
  s_add_u32 m0, s64, 35840
  s_add_u32 s63, s62, 2293760
  buffer_load_dwordx4 v3, s[48:51], s63 offen lds
  s_add_u32 m0, s64, 49152
  s_add_u32 s63, s62, 3145728
  buffer_load_dwordx4 v2, s[48:51], s63 offen lds
  s_add_u32 m0, s64, 50176
  s_add_u32 s63, s62, 3211264
  buffer_load_dwordx4 v3, s[48:51], s63 offen lds
  s_add_u32 m0, s64, 51200
  s_add_u32 s63, s62, 3276800
  buffer_load_dwordx4 v2, s[48:51], s63 offen lds
  s_add_u32 m0, s64, 52224
  s_add_u32 s63, s62, 3342336
  buffer_load_dwordx4 v3, s[48:51], s63 offen lds
  s_bfe_u32 s67, s58, 0x30018
  s_mov_b64 s[48:49], s[12:13]
  s_cmp_eq_u32 s67, 1
  s_cselect_b64 s[48:49], s[14:15], s[48:49]
  s_cmp_eq_u32 s67, 2
  s_cselect_b64 s[48:49], s[16:17], s[48:49]
  s_cmp_eq_u32 s67, 3
  s_cselect_b64 s[48:49], s[24:25], s[48:49]
  s_cmp_eq_u32 s67, 4
  s_cselect_b64 s[48:49], s[26:27], s[48:49]
  s_cmp_eq_u32 s67, 5
  s_cselect_b64 s[48:49], s[28:29], s[48:49]
  s_and_b32 s49, s49, 0xffff
  s_bfe_u32 s67, s58, 0x50013
  s_lshl_b32 s67, s67, 8
  s_bfe_u32 s68, s58, 0x1000c
  s_lshl_b32 s68, s68, 7
  s_or_b32 s62, s67, s68
  s_bitcmp1_b32 s58, 2
  s_cselect_b32 s62, 0x40000000, s62
  s_add_u32 m0, s64, 65536
  s_add_u32 s63, s62, 0
  buffer_load_dwordx4 v2, s[48:51], s63 offen lds
  s_add_u32 m0, s64, 66560
  s_add_u32 s63, s62, 65536
  buffer_load_dwordx4 v3, s[48:51], s63 offen lds
  s_add_u32 m0, s64, 67584
  s_add_u32 s63, s62, 131072
  buffer_load_dwordx4 v2, s[48:51], s63 offen lds
  s_add_u32 m0, s64, 68608
  s_add_u32 s63, s62, 196608
  buffer_load_dwordx4 v3, s[48:51], s63 offen lds
  s_add_u32 m0, s64, 81920
  s_add_u32 s63, s62, 1048576
  buffer_load_dwordx4 v2, s[48:51], s63 offen lds
  s_add_u32 m0, s64, 82944
  s_add_u32 s63, s62, 1114112
  buffer_load_dwordx4 v3, s[48:51], s63 offen lds
  s_add_u32 m0, s64, 83968
  s_add_u32 s63, s62, 1179648
  buffer_load_dwordx4 v2, s[48:51], s63 offen lds
  s_add_u32 m0, s64, 84992
  s_add_u32 s63, s62, 1245184
  buffer_load_dwordx4 v3, s[48:51], s63 offen lds
  s_cmp_eq_u32 s7, 0
  s_cbranch_scc1 L_p_nogate
  s_mov_b32 s52, s34
  s_and_b32 s53, s35, 0xffff
  s_mov_b32 s54, 0x400
  s_mov_b32 s55, 0x20000
  v_lshrrev_b32 v12, 4, v0
  v_lshlrev_b32 v12, 4, v12
  buffer_load_dwordx4 v[128:131], v12, s[52:55], 0 offen offset:0
  buffer_load_dwordx4 v[132:135], v12, s[52:55], 0 offen offset:64
  buffer_load_dwordx4 v[136:139], v12, s[52:55], 0 offen offset:128
  buffer_load_dwordx4 v[140:143], v12, s[52:55], 0 offen offset:192
  buffer_load_dwordx4 v[144:147], v12, s[52:55], 0 offen offset:256
  buffer_load_dwordx4 v[148:151], v12, s[52:55], 0 offen offset:320
  buffer_load_dwordx4 v[152:155], v12, s[52:55], 0 offen offset:384
  buffer_load_dwordx4 v[156:159], v12, s[52:55], 0 offen offset:448
  buffer_load_dwordx4 v[160:163], v12, s[52:55], 0 offen offset:512
  buffer_load_dwordx4 v[164:167], v12, s[52:55], 0 offen offset:576
  buffer_load_dwordx4 v[168:171], v12, s[52:55], 0 offen offset:640
  buffer_load_dwordx4 v[172:175], v12, s[52:55], 0 offen offset:704
  buffer_load_dwordx4 v[176:179], v12, s[52:55], 0 offen offset:768
  buffer_load_dwordx4 v[180:183], v12, s[52:55], 0 offen offset:832
  buffer_load_dwordx4 v[184:187], v12, s[52:55], 0 offen offset:896
  buffer_load_dwordx4 v[188:191], v12, s[52:55], 0 offen offset:960
  v_and_b32 v15, 0xffffffbf, v15
  s_waitcnt vmcnt(0)
  v_mfma_f32_16x16x32_bf16 v[80:83], v[128:131], a[0:3], 0
  v_mfma_f32_16x16x32_bf16 v[84:87], v[128:131], a[64:67], 0
  v_mfma_f32_16x16x32_bf16 v[88:91], v[128:131], a[128:131], 0
  v_mfma_f32_16x16x32_bf16 v[92:95], v[128:131], a[192:195], 0
  v_mfma_f32_16x16x32_bf16 v[80:83], v[132:135], a[4:7], v[80:83]
  v_mfma_f32_16x16x32_bf16 v[84:87], v[132:135], a[68:71], v[84:87]
  v_mfma_f32_16x16x32_bf16 v[88:91], v[132:135], a[132:135], v[88:91]
  v_mfma_f32_16x16x32_bf16 v[92:95], v[132:135], a[196:199], v[92:95]
  v_mfma_f32_16x16x32_bf16 v[80:83], v[136:139], a[8:11], v[80:83]
  v_mfma_f32_16x16x32_bf16 v[84:87], v[136:139], a[72:75], v[84:87]
  v_mfma_f32_16x16x32_bf16 v[88:91], v[136:139], a[136:139], v[88:91]
  v_mfma_f32_16x16x32_bf16 v[92:95], v[136:139], a[200:203], v[92:95]
  v_mfma_f32_16x16x32_bf16 v[80:83], v[140:143], a[12:15], v[80:83]
  v_mfma_f32_16x16x32_bf16 v[84:87], v[140:143], a[76:79], v[84:87]
  v_mfma_f32_16x16x32_bf16 v[88:91], v[140:143], a[140:143], v[88:91]
  v_mfma_f32_16x16x32_bf16 v[92:95], v[140:143], a[204:207], v[92:95]
  v_mfma_f32_16x16x32_bf16 v[80:83], v[144:147], a[16:19], v[80:83]
  v_mfma_f32_16x16x32_bf16 v[84:87], v[144:147], a[80:83], v[84:87]
  v_mfma_f32_16x16x32_bf16 v[88:91], v[144:147], a[144:147], v[88:91]
  v_mfma_f32_16x16x32_bf16 v[92:95], v[144:147], a[208:211], v[92:95]
  v_mfma_f32_16x16x32_bf16 v[80:83], v[148:151], a[20:23], v[80:83]
  v_mfma_f32_16x16x32_bf16 v[84:87], v[148:151], a[84:87], v[84:87]
  v_mfma_f32_16x16x32_bf16 v[88:91], v[148:151], a[148:151], v[88:91]
  v_mfma_f32_16x16x32_bf16 v[92:95], v[148:151], a[212:215], v[92:95]
  v_mfma_f32_16x16x32_bf16 v[80:83], v[152:155], a[24:27], v[80:83]
  v_mfma_f32_16x16x32_bf16 v[84:87], v[152:155], a[88:91], v[84:87]
  v_mfma_f32_16x16x32_bf16 v[88:91], v[152:155], a[152:155], v[88:91]
  v_mfma_f32_16x16x32_bf16 v[92:95], v[152:155], a[216:219], v[92:95]
  v_mfma_f32_16x16x32_bf16 v[80:83], v[156:159], a[28:31], v[80:83]
  v_mfma_f32_16x16x32_bf16 v[84:87], v[156:159], a[92:95], v[84:87]
  v_mfma_f32_16x16x32_bf16 v[88:91], v[156:159], a[156:159], v[88:91]
  v_mfma_f32_16x16x32_bf16 v[92:95], v[156:159], a[220:223], v[92:95]
  v_mfma_f32_16x16x32_bf16 v[80:83], v[160:163], a[32:35], v[80:83]
  v_mfma_f32_16x16x32_bf16 v[84:87], v[160:163], a[96:99], v[84:87]
  v_mfma_f32_16x16x32_bf16 v[88:91], v[160:163], a[160:163], v[88:91]
  v_mfma_f32_16x16x32_bf16 v[92:95], v[160:163], a[224:227], v[92:95]
  v_mfma_f32_16x16x32_bf16 v[80:83], v[164:167], a[36:39], v[80:83]
  v_mfma_f32_16x16x32_bf16 v[84:87], v[164:167], a[100:103], v[84:87]
  v_mfma_f32_16x16x32_bf16 v[88:91], v[164:167], a[164:167], v[88:91]
  v_mfma_f32_16x16x32_bf16 v[92:95], v[164:167], a[228:231], v[92:95]
  v_mfma_f32_16x16x32_bf16 v[80:83], v[168:171], a[40:43], v[80:83]
  v_mfma_f32_16x16x32_bf16 v[84:87], v[168:171], a[104:107], v[84:87]
  v_mfma_f32_16x16x32_bf16 v[88:91], v[168:171], a[168:171], v[88:91]
  v_mfma_f32_16x16x32_bf16 v[92:95], v[168:171], a[232:235], v[92:95]
  v_mfma_f32_16x16x32_bf16 v[80:83], v[172:175], a[44:47], v[80:83]
  v_mfma_f32_16x16x32_bf16 v[84:87], v[172:175], a[108:111], v[84:87]
  v_mfma_f32_16x16x32_bf16 v[88:91], v[172:175], a[172:175], v[88:91]
  v_mfma_f32_16x16x32_bf16 v[92:95], v[172:175], a[236:239], v[92:95]
  v_mfma_f32_16x16x32_bf16 v[80:83], v[176:179], a[48:51], v[80:83]
  v_mfma_f32_16x16x32_bf16 v[84:87], v[176:179], a[112:115], v[84:87]
  v_mfma_f32_16x16x32_bf16 v[88:91], v[176:179], a[176:179], v[88:91]
  v_mfma_f32_16x16x32_bf16 v[92:95], v[176:179], a[240:243], v[92:95]
  v_mfma_f32_16x16x32_bf16 v[80:83], v[180:183], a[52:55], v[80:83]
  v_mfma_f32_16x16x32_bf16 v[84:87], v[180:183], a[116:119], v[84:87]
  v_mfma_f32_16x16x32_bf16 v[88:91], v[180:183], a[180:183], v[88:91]
  v_mfma_f32_16x16x32_bf16 v[92:95], v[180:183], a[244:247], v[92:95]
  v_mfma_f32_16x16x32_bf16 v[80:83], v[184:187], a[56:59], v[80:83]
  v_mfma_f32_16x16x32_bf16 v[84:87], v[184:187], a[120:123], v[84:87]
  v_mfma_f32_16x16x32_bf16 v[88:91], v[184:187], a[184:187], v[88:91]
  v_mfma_f32_16x16x32_bf16 v[92:95], v[184:187], a[248:251], v[92:95]
  v_mfma_f32_16x16x32_bf16 v[80:83], v[188:191], a[60:63], v[80:83]
  v_mfma_f32_16x16x32_bf16 v[84:87], v[188:191], a[124:127], v[84:87]
  v_mfma_f32_16x16x32_bf16 v[88:91], v[188:191], a[188:191], v[88:91]
  v_mfma_f32_16x16x32_bf16 v[92:95], v[188:191], a[252:255], v[92:95]
  s_nop 15
  s_mov_b32 s67, 0xd0c0000
  v_mul_f32 v80, 0xbfb8aa3b, v80
  v_exp_f32 v80, v80
  s_nop 0
  v_add_f32 v80, 1.0, v80
  v_rcp_f32 v80, v80
  s_nop 0
  buffer_store_dword v80, v15, s[40:43], s67 offen offset:0 sc1
  v_mul_f32 v84, 0xbfb8aa3b, v84
  v_exp_f32 v84, v84
  s_nop 0
  v_add_f32 v84, 1.0, v84
  v_rcp_f32 v84, v84
  s_nop 0
  buffer_store_dword v84, v15, s[40:43], s67 offen offset:64 sc1
  v_mul_f32 v88, 0xbfb8aa3b, v88
  v_exp_f32 v88, v88
  s_nop 0
  v_add_f32 v88, 1.0, v88
  v_rcp_f32 v88, v88
  s_nop 0
  buffer_store_dword v88, v15, s[40:43], s67 offen offset:128 sc1
  v_mul_f32 v92, 0xbfb8aa3b, v92
  v_exp_f32 v92, v92
  s_nop 0
  v_add_f32 v92, 1.0, v92
  v_rcp_f32 v92, v92
  s_nop 0
  buffer_store_dword v92, v15, s[40:43], s67 offen offset:192 sc1
L_p_nogate:
  s_mov_b32 s52, s38
  s_and_b32 s53, s39, 0xffff
  s_mov_b32 s54, 0x100
  s_mov_b32 s55, 0x20000
  v_mov_b32 v12, 0
  s_mov_b32 s67, 0
L_p_init:
  buffer_load_dword v13, v12, s[52:55], 0 offen sc1
  s_add_u32 s67, s67, 1
  s_cmp_gt_u32 s67, 1048576
  s_cbranch_scc1 L_exit
  s_waitcnt vmcnt(0)
  v_cmp_gt_u32 vcc, 32, v13
  s_cbranch_vccnz L_p_init
  s_barrier
  s_mul_i32 s69, s70, 124
  s_add_u32 s69, s69, 0x6400
  s_cmp_eq_u32 s7, 0
  s_cselect_b32 s69, 0x40000000, s69
  buffer_atomic_add v11, v10, s[40:43], s69 offen
  ds_read_b64_tr_b16 v[32:33], v16 offset:0
  ds_read_b64_tr_b16 v[34:35], v16 offset:512
  ds_read_b64_tr_b16 v[36:37], v17 offset:0
  ds_read_b64_tr_b16 v[38:39], v17 offset:512
  ds_read_b64_tr_b16 v[40:41], v18 offset:0
  ds_read_b64_tr_b16 v[42:43], v18 offset:512
  ds_read_b64_tr_b16 v[44:45], v19 offset:0
  ds_read_b64_tr_b16 v[46:47], v19 offset:512
  s_waitcnt lgkmcnt(4)
  s_bitcmp1_b32 s57, 0
  s_cbranch_scc1 L_p_body_0_1
L_p_body_0_0:
  v_mfma_f32_16x16x32_bf16 v[128:131], v[32:35], a[0:3], 0
  s_add_u32 m0, s64, 98304
  ds_read_b64_tr_b16 v[48:49], v16 offset:4096
  v_mfma_f32_16x16x32_bf16 v[136:139], v[32:35], a[64:67], 0
  v_mfma_f32_16x16x32_bf16 v[160:163], v[32:35], a[128:131], 0
  s_add_u32 s63, s62, 2097152
  ds_read_b64_tr_b16 v[50:51], v16 offset:4608
  v_mfma_f32_16x16x32_bf16 v[168:171], v[32:35], a[192:195], 0
  buffer_load_dwordx4 v2, s[48:51], s63 offen lds
  v_mfma_f32_16x16x32_bf16 v[132:135], v[36:39], a[0:3], 0
  s_and_b32 s65, s60, 0x7fff000
  s_bitcmp1_b32 s60, 2
  s_cselect_b32 s65, 0x40000000, s65
  ds_read_b64_tr_b16 v[52:53], v17 offset:4096
  v_mfma_f32_16x16x32_bf16 v[140:143], v[36:39], a[64:67], 0
  s_bitcmp1_b32 s60, 1
  s_cselect_b32 s66, 0x3e0293ee, 1.0
  v_mfma_f32_16x16x32_bf16 v[164:167], v[36:39], a[128:131], 0
  s_waitcnt lgkmcnt(3)
  ds_read_b64_tr_b16 v[54:55], v17 offset:4608
  v_mfma_f32_16x16x32_bf16 v[172:175], v[36:39], a[192:195], 0
  v_mfma_f32_16x16x32_bf16 v[144:147], v[40:43], a[0:3], 0
  s_add_u32 m0, s64, 99328
  ds_read_b64_tr_b16 v[56:57], v18 offset:4096
  v_mfma_f32_16x16x32_bf16 v[152:155], v[40:43], a[64:67], 0
  v_mfma_f32_16x16x32_bf16 v[176:179], v[40:43], a[128:131], 0
  s_add_u32 s63, s62, 2162688
  ds_read_b64_tr_b16 v[58:59], v18 offset:4608
  v_mul_f32 v192, s66, v192
  v_mfma_f32_16x16x32_bf16 v[184:187], v[40:43], a[192:195], 0
  buffer_load_dwordx4 v3, s[48:51], s63 offen lds
  v_mul_f32 v193, s66, v193
  v_cvt_pk_bf16_f32 v64, v192, v193
  v_mfma_f32_16x16x32_bf16 v[148:151], v[44:47], a[0:3], 0
  ds_read_b64_tr_b16 v[60:61], v19 offset:4096
  v_mul_f32 v194, s66, v194
  v_mfma_f32_16x16x32_bf16 v[156:159], v[44:47], a[64:67], 0
  v_mul_f32 v195, s66, v195
  v_cvt_pk_bf16_f32 v65, v194, v195
  v_mfma_f32_16x16x32_bf16 v[180:183], v[44:47], a[128:131], 0
  s_waitcnt lgkmcnt(3)
  ds_read_b64_tr_b16 v[62:63], v19 offset:4608
  v_mul_f32 v196, s66, v196
  v_mfma_f32_16x16x32_bf16 v[188:191], v[44:47], a[192:195], 0
  v_mul_f32 v197, s66, v197
  v_cvt_pk_bf16_f32 v66, v196, v197
  v_mfma_f32_16x16x32_bf16 v[128:131], v[48:51], a[4:7], v[128:131]
  s_add_u32 m0, s64, 100352
  ds_read_b64_tr_b16 v[32:33], v16 offset:8192
  v_readlane_b32 s59, v1, s56
  v_mfma_f32_16x16x32_bf16 v[136:139], v[48:51], a[68:71], v[136:139]
  v_mul_f32 v198, s66, v198
  v_mul_f32 v199, s66, v199
  v_cvt_pk_bf16_f32 v67, v198, v199
  v_mfma_f32_16x16x32_bf16 v[160:163], v[48:51], a[132:135], v[160:163]
  s_add_u32 s63, s62, 2228224
  ds_read_b64_tr_b16 v[34:35], v16 offset:8704
  v_mfma_f32_16x16x32_bf16 v[168:171], v[48:51], a[196:199], v[168:171]
  buffer_load_dwordx4 v2, s[48:51], s63 offen lds
  v_mfma_f32_16x16x32_bf16 v[132:135], v[52:55], a[4:7], v[132:135]
  ds_read_b64_tr_b16 v[36:37], v17 offset:8192
  v_mul_f32 v200, s66, v200
  v_mfma_f32_16x16x32_bf16 v[140:143], v[52:55], a[68:71], v[140:143]
  buffer_store_dwordx4 v[64:67], v8, s[40:43], s65 offen offset:0 sc1
  v_mul_f32 v201, s66, v201
  v_cvt_pk_bf16_f32 v68, v200, v201
  v_mfma_f32_16x16x32_bf16 v[164:167], v[52:55], a[132:135], v[164:167]
  s_waitcnt lgkmcnt(3)
  ds_read_b64_tr_b16 v[38:39], v17 offset:8704
  v_mul_f32 v202, s66, v202
  v_mfma_f32_16x16x32_bf16 v[172:175], v[52:55], a[196:199], v[172:175]
  v_mul_f32 v203, s66, v203
  v_cvt_pk_bf16_f32 v69, v202, v203
  v_mfma_f32_16x16x32_bf16 v[144:147], v[56:59], a[4:7], v[144:147]
  s_add_u32 m0, s64, 101376
  ds_read_b64_tr_b16 v[40:41], v18 offset:8192
  v_mul_f32 v204, s66, v204
  v_mfma_f32_16x16x32_bf16 v[152:155], v[56:59], a[68:71], v[152:155]
  v_mul_f32 v205, s66, v205
  v_cvt_pk_bf16_f32 v70, v204, v205
  v_mfma_f32_16x16x32_bf16 v[176:179], v[56:59], a[132:135], v[176:179]
  s_add_u32 s63, s62, 2293760
  ds_read_b64_tr_b16 v[42:43], v18 offset:8704
  v_mul_f32 v206, s66, v206
  v_mfma_f32_16x16x32_bf16 v[184:187], v[56:59], a[196:199], v[184:187]
  buffer_load_dwordx4 v3, s[48:51], s63 offen lds
  v_mul_f32 v207, s66, v207
  v_cvt_pk_bf16_f32 v71, v206, v207
  v_mfma_f32_16x16x32_bf16 v[148:151], v[60:63], a[4:7], v[148:151]
  ds_read_b64_tr_b16 v[44:45], v19 offset:8192
  v_mfma_f32_16x16x32_bf16 v[156:159], v[60:63], a[68:71], v[156:159]
  v_mfma_f32_16x16x32_bf16 v[180:183], v[60:63], a[132:135], v[180:183]
  s_waitcnt lgkmcnt(3)
  ds_read_b64_tr_b16 v[46:47], v19 offset:8704
  v_mfma_f32_16x16x32_bf16 v[188:191], v[60:63], a[196:199], v[188:191]
  buffer_store_dwordx4 v[68:71], v8, s[40:43], s65 offen offset:1024 sc1
  v_mfma_f32_16x16x32_bf16 v[128:131], v[32:35], a[8:11], v[128:131]
  s_bfe_u32 s67, s61, 0x50013
  ds_read_b64_tr_b16 v[48:49], v16 offset:12288
  v_mfma_f32_16x16x32_bf16 v[136:139], v[32:35], a[72:75], v[136:139]
  s_lshl_b32 s67, s67, 7
  v_mfma_f32_16x16x32_bf16 v[160:163], v[32:35], a[136:139], v[160:163]
  s_bfe_u32 s68, s61, 0x20004
  ds_read_b64_tr_b16 v[50:51], v16 offset:12800
  v_mfma_f32_16x16x32_bf16 v[168:171], v[32:35], a[200:203], v[168:171]
  s_lshl_b32 s68, s68, 5
  v_mfma_f32_16x16x32_bf16 v[132:135], v[36:39], a[8:11], v[132:135]
  s_or_b32 s69, s67, s68
  ds_read_b64_tr_b16 v[52:53], v17 offset:12288
  v_mfma_f32_16x16x32_bf16 v[140:143], v[36:39], a[72:75], v[140:143]
  s_bitcmp1_b32 s61, 2
  v_mfma_f32_16x16x32_bf16 v[164:167], v[36:39], a[136:139], v[164:167]
  s_waitcnt lgkmcnt(3)
  ds_read_b64_tr_b16 v[54:55], v17 offset:12800
  v_mul_f32 v208, s66, v208
  v_mfma_f32_16x16x32_bf16 v[172:175], v[36:39], a[200:203], v[172:175]
  s_cselect_b32 s69, 0x40000000, s69
  v_mul_f32 v209, s66, v209
  v_cvt_pk_bf16_f32 v72, v208, v209
  v_mfma_f32_16x16x32_bf16 v[144:147], v[40:43], a[8:11], v[144:147]
  ds_read_b64_tr_b16 v[56:57], v18 offset:12288
  v_mul_f32 v210, s66, v210
  v_mfma_f32_16x16x32_bf16 v[152:155], v[40:43], a[72:75], v[152:155]
  v_mul_f32 v211, s66, v211
  v_cvt_pk_bf16_f32 v73, v210, v211
  v_mfma_f32_16x16x32_bf16 v[176:179], v[40:43], a[136:139], v[176:179]
  ds_read_b64_tr_b16 v[58:59], v18 offset:12800
  v_mul_f32 v212, s66, v212
  v_mfma_f32_16x16x32_bf16 v[184:187], v[40:43], a[200:203], v[184:187]
  v_mul_f32 v213, s66, v213
  v_cvt_pk_bf16_f32 v74, v212, v213
  v_mfma_f32_16x16x32_bf16 v[148:151], v[44:47], a[8:11], v[148:151]
  s_waitcnt vmcnt(14)
  ds_read_b64_tr_b16 v[60:61], v19 offset:12288
  v_mul_f32 v214, s66, v214
  v_mfma_f32_16x16x32_bf16 v[156:159], v[44:47], a[72:75], v[156:159]
  s_barrier
  v_mul_f32 v215, s66, v215
  v_cvt_pk_bf16_f32 v75, v214, v215
  v_mfma_f32_16x16x32_bf16 v[180:183], v[44:47], a[136:139], v[180:183]
  s_waitcnt lgkmcnt(3)
  ds_read_b64_tr_b16 v[62:63], v19 offset:12800
  v_mfma_f32_16x16x32_bf16 v[188:191], v[44:47], a[200:203], v[188:191]
  buffer_atomic_add v11, v10, s[40:43], s69 offen
  v_mfma_f32_16x16x32_bf16 v[128:131], v[48:51], a[12:15], v[128:131]
  ds_read_b64_tr_b16 v[32:33], v16 offset:16384
  v_mul_f32 v216, s66, v216
  v_mfma_f32_16x16x32_bf16 v[136:139], v[48:51], a[76:79], v[136:139]
  buffer_store_dwordx4 v[72:75], v8, s[40:43], s65 offen offset:2048 sc1
  v_mul_f32 v217, s66, v217
  v_cvt_pk_bf16_f32 v76, v216, v217
  v_mfma_f32_16x16x32_bf16 v[160:163], v[48:51], a[140:143], v[160:163]
  ds_read_b64_tr_b16 v[34:35], v16 offset:16896
  v_mul_f32 v218, s66, v218
  v_mfma_f32_16x16x32_bf16 v[168:171], v[48:51], a[204:207], v[168:171]
  v_mul_f32 v219, s66, v219
  v_cvt_pk_bf16_f32 v77, v218, v219
  v_mfma_f32_16x16x32_bf16 v[132:135], v[52:55], a[12:15], v[132:135]
  ds_read_b64_tr_b16 v[36:37], v17 offset:16384
  v_mul_f32 v220, s66, v220
  v_mfma_f32_16x16x32_bf16 v[140:143], v[52:55], a[76:79], v[140:143]
  v_mul_f32 v221, s66, v221
  v_cvt_pk_bf16_f32 v78, v220, v221
  v_mfma_f32_16x16x32_bf16 v[164:167], v[52:55], a[140:143], v[164:167]
  s_waitcnt lgkmcnt(3)
  ds_read_b64_tr_b16 v[38:39], v17 offset:16896
  v_mul_f32 v222, s66, v222
  v_mfma_f32_16x16x32_bf16 v[172:175], v[52:55], a[204:207], v[172:175]
  v_mul_f32 v223, s66, v223
  v_cvt_pk_bf16_f32 v79, v222, v223
  v_mfma_f32_16x16x32_bf16 v[144:147], v[56:59], a[12:15], v[144:147]
  ds_read_b64_tr_b16 v[40:41], v18 offset:16384
  v_mfma_f32_16x16x32_bf16 v[152:155], v[56:59], a[76:79], v[152:155]
  v_mfma_f32_16x16x32_bf16 v[176:179], v[56:59], a[140:143], v[176:179]
  ds_read_b64_tr_b16 v[42:43], v18 offset:16896
  v_mfma_f32_16x16x32_bf16 v[184:187], v[56:59], a[204:207], v[184:187]
  buffer_store_dwordx4 v[76:79], v8, s[40:43], s65 offen offset:3072 sc1
  v_mfma_f32_16x16x32_bf16 v[148:151], v[60:63], a[12:15], v[148:151]
  ds_read_b64_tr_b16 v[44:45], v19 offset:16384
  v_mfma_f32_16x16x32_bf16 v[156:159], v[60:63], a[76:79], v[156:159]
  v_mfma_f32_16x16x32_bf16 v[180:183], v[60:63], a[140:143], v[180:183]
  s_waitcnt lgkmcnt(3)
  ds_read_b64_tr_b16 v[46:47], v19 offset:16896
  v_mfma_f32_16x16x32_bf16 v[188:191], v[60:63], a[204:207], v[188:191]
  v_mfma_f32_16x16x32_bf16 v[128:131], v[32:35], a[16:19], v[128:131]
  s_add_u32 m0, s64, 114688
  ds_read_b64_tr_b16 v[48:49], v16 offset:20480
  v_mfma_f32_16x16x32_bf16 v[136:139], v[32:35], a[80:83], v[136:139]
  v_mfma_f32_16x16x32_bf16 v[160:163], v[32:35], a[144:147], v[160:163]
  s_add_u32 s63, s62, 3145728
  ds_read_b64_tr_b16 v[50:51], v16 offset:20992
  v_mul_f32 v224, s66, v224
  v_mfma_f32_16x16x32_bf16 v[168:171], v[32:35], a[208:211], v[168:171]
  buffer_load_dwordx4 v2, s[48:51], s63 offen lds
  v_mul_f32 v225, s66, v225
  v_cvt_pk_bf16_f32 v64, v224, v225
  v_mfma_f32_16x16x32_bf16 v[132:135], v[36:39], a[16:19], v[132:135]
  ds_read_b64_tr_b16 v[52:53], v17 offset:20480
  v_mul_f32 v226, s66, v226
  v_mfma_f32_16x16x32_bf16 v[140:143], v[36:39], a[80:83], v[140:143]
  v_mul_f32 v227, s66, v227
  v_cvt_pk_bf16_f32 v65, v226, v227
  v_mfma_f32_16x16x32_bf16 v[164:167], v[36:39], a[144:147], v[164:167]
  s_waitcnt lgkmcnt(3)
  ds_read_b64_tr_b16 v[54:55], v17 offset:20992
  v_mul_f32 v228, s66, v228
  v_mfma_f32_16x16x32_bf16 v[172:175], v[36:39], a[208:211], v[172:175]
  v_mul_f32 v229, s66, v229
  v_cvt_pk_bf16_f32 v66, v228, v229
  v_mfma_f32_16x16x32_bf16 v[144:147], v[40:43], a[16:19], v[144:147]
  s_add_u32 m0, s64, 115712
  ds_read_b64_tr_b16 v[56:57], v18 offset:20480
  v_mul_f32 v230, s66, v230
  v_mfma_f32_16x16x32_bf16 v[152:155], v[40:43], a[80:83], v[152:155]
  v_mul_f32 v231, s66, v231
  v_cvt_pk_bf16_f32 v67, v230, v231
  v_mfma_f32_16x16x32_bf16 v[176:179], v[40:43], a[144:147], v[176:179]
  s_add_u32 s63, s62, 3211264
  ds_read_b64_tr_b16 v[58:59], v18 offset:20992
  v_mfma_f32_16x16x32_bf16 v[184:187], v[40:43], a[208:211], v[184:187]
  buffer_load_dwordx4 v3, s[48:51], s63 offen lds
  v_mfma_f32_16x16x32_bf16 v[148:151], v[44:47], a[16:19], v[148:151]
  ds_read_b64_tr_b16 v[60:61], v19 offset:20480
  v_mul_f32 v232, s66, v232
  v_mfma_f32_16x16x32_bf16 v[156:159], v[44:47], a[80:83], v[156:159]
  buffer_store_dwordx4 v[64:67], v9, s[40:43], s65 offen offset:0 sc1
  v_mul_f32 v233, s66, v233
  v_cvt_pk_bf16_f32 v68, v232, v233
  v_mfma_f32_16x16x32_bf16 v[180:183], v[44:47], a[144:147], v[180:183]
  s_waitcnt lgkmcnt(3)
  ds_read_b64_tr_b16 v[62:63], v19 offset:20992
  v_mul_f32 v234, s66, v234
  v_mfma_f32_16x16x32_bf16 v[188:191], v[44:47], a[208:211], v[188:191]
  v_mul_f32 v235, s66, v235
  v_cvt_pk_bf16_f32 v69, v234, v235
  v_mfma_f32_16x16x32_bf16 v[128:131], v[48:51], a[20:23], v[128:131]
  s_add_u32 m0, s64, 116736
  ds_read_b64_tr_b16 v[32:33], v16 offset:24576
  v_mul_f32 v236, s66, v236
  v_mfma_f32_16x16x32_bf16 v[136:139], v[48:51], a[84:87], v[136:139]
  v_mul_f32 v237, s66, v237
  v_cvt_pk_bf16_f32 v70, v236, v237
  v_mfma_f32_16x16x32_bf16 v[160:163], v[48:51], a[148:151], v[160:163]
  s_add_u32 s63, s62, 3276800
  ds_read_b64_tr_b16 v[34:35], v16 offset:25088
  v_mul_f32 v238, s66, v238
  v_mfma_f32_16x16x32_bf16 v[168:171], v[48:51], a[212:215], v[168:171]
  buffer_load_dwordx4 v2, s[48:51], s63 offen lds
  v_mul_f32 v239, s66, v239
  v_cvt_pk_bf16_f32 v71, v238, v239
  v_mfma_f32_16x16x32_bf16 v[132:135], v[52:55], a[20:23], v[132:135]
  ds_read_b64_tr_b16 v[36:37], v17 offset:24576
  v_mfma_f32_16x16x32_bf16 v[140:143], v[52:55], a[84:87], v[140:143]
  v_mfma_f32_16x16x32_bf16 v[164:167], v[52:55], a[148:151], v[164:167]
  s_waitcnt lgkmcnt(3)
  ds_read_b64_tr_b16 v[38:39], v17 offset:25088
  v_mfma_f32_16x16x32_bf16 v[172:175], v[52:55], a[212:215], v[172:175]
  buffer_store_dwordx4 v[68:71], v9, s[40:43], s65 offen offset:1024 sc1
  v_mfma_f32_16x16x32_bf16 v[144:147], v[56:59], a[20:23], v[144:147]
  s_add_u32 m0, s64, 117760
  ds_read_b64_tr_b16 v[40:41], v18 offset:24576
  v_mfma_f32_16x16x32_bf16 v[152:155], v[56:59], a[84:87], v[152:155]
  v_mfma_f32_16x16x32_bf16 v[176:179], v[56:59], a[148:151], v[176:179]
  s_add_u32 s63, s62, 3342336
  ds_read_b64_tr_b16 v[42:43], v18 offset:25088
  v_mfma_f32_16x16x32_bf16 v[184:187], v[56:59], a[212:215], v[184:187]
  buffer_load_dwordx4 v3, s[48:51], s63 offen lds
  v_mfma_f32_16x16x32_bf16 v[148:151], v[60:63], a[20:23], v[148:151]
  ds_read_b64_tr_b16 v[44:45], v19 offset:24576
  v_mfma_f32_16x16x32_bf16 v[156:159], v[60:63], a[84:87], v[156:159]
  v_mfma_f32_16x16x32_bf16 v[180:183], v[60:63], a[148:151], v[180:183]
  s_waitcnt lgkmcnt(3)
  ds_read_b64_tr_b16 v[46:47], v19 offset:25088
  v_mul_f32 v240, s66, v240
  v_mfma_f32_16x16x32_bf16 v[188:191], v[60:63], a[212:215], v[188:191]
  v_mul_f32 v241, s66, v241
  v_cvt_pk_bf16_f32 v72, v240, v241
  v_mfma_f32_16x16x32_bf16 v[128:131], v[32:35], a[24:27], v[128:131]
  ds_read_b64_tr_b16 v[48:49], v16 offset:28672
  v_mul_f32 v242, s66, v242
  v_mfma_f32_16x16x32_bf16 v[136:139], v[32:35], a[88:91], v[136:139]
  v_mul_f32 v243, s66, v243
  v_cvt_pk_bf16_f32 v73, v242, v243
  v_mfma_f32_16x16x32_bf16 v[160:163], v[32:35], a[152:155], v[160:163]
  ds_read_b64_tr_b16 v[50:51], v16 offset:29184
  v_mul_f32 v244, s66, v244
  v_mfma_f32_16x16x32_bf16 v[168:171], v[32:35], a[216:219], v[168:171]
  v_mul_f32 v245, s66, v245
  v_cvt_pk_bf16_f32 v74, v244, v245
  v_mfma_f32_16x16x32_bf16 v[132:135], v[36:39], a[24:27], v[132:135]
  s_bfe_u32 s67, s59, 0x30018
  ds_read_b64_tr_b16 v[52:53], v17 offset:28672
  v_mul_f32 v246, s66, v246
  v_mfma_f32_16x16x32_bf16 v[140:143], v[36:39], a[88:91], v[140:143]
  s_mov_b64 s[48:49], s[12:13]
  v_mul_f32 v247, s66, v247
  v_cvt_pk_bf16_f32 v75, v246, v247
  v_mfma_f32_16x16x32_bf16 v[164:167], v[36:39], a[152:155], v[164:167]
  s_waitcnt lgkmcnt(3)
  s_cmp_eq_u32 s67, 1
  ds_read_b64_tr_b16 v[54:55], v17 offset:29184
  v_mfma_f32_16x16x32_bf16 v[172:175], v[36:39], a[216:219], v[172:175]
  s_cselect_b64 s[48:49], s[14:15], s[48:49]
  v_mfma_f32_16x16x32_bf16 v[144:147], v[40:43], a[24:27], v[144:147]
  s_cmp_eq_u32 s67, 2
  ds_read_b64_tr_b16 v[56:57], v18 offset:28672
  v_mul_f32 v248, s66, v248
  v_mfma_f32_16x16x32_bf16 v[152:155], v[40:43], a[88:91], v[152:155]
  s_cselect_b64 s[48:49], s[16:17], s[48:49]
  buffer_store_dwordx4 v[72:75], v9, s[40:43], s65 offen offset:2048 sc1
  v_mul_f32 v249, s66, v249
  v_cvt_pk_bf16_f32 v76, v248, v249
  v_mfma_f32_16x16x32_bf16 v[176:179], v[40:43], a[152:155], v[176:179]
  s_cmp_eq_u32 s67, 3
  ds_read_b64_tr_b16 v[58:59], v18 offset:29184
  v_mul_f32 v250, s66, v250
  v_mfma_f32_16x16x32_bf16 v[184:187], v[40:43], a[216:219], v[184:187]
  s_cselect_b64 s[48:49], s[24:25], s[48:49]
  v_mul_f32 v251, s66, v251
  v_cvt_pk_bf16_f32 v77, v250, v251
  v_mfma_f32_16x16x32_bf16 v[148:151], v[44:47], a[24:27], v[148:151]
  s_waitcnt vmcnt(28)
  s_barrier
  ds_read_b64_tr_b16 v[60:61], v19 offset:28672
  v_mul_f32 v252, s66, v252
  v_mfma_f32_16x16x32_bf16 v[156:159], v[44:47], a[88:91], v[156:159]
  s_cmp_eq_u32 s67, 4
  s_cselect_b64 s[48:49], s[26:27], s[48:49]
  v_mul_f32 v253, s66, v253
  v_cvt_pk_bf16_f32 v78, v252, v253
  v_mfma_f32_16x16x32_bf16 v[180:183], v[44:47], a[152:155], v[180:183]
  s_waitcnt lgkmcnt(3)
  s_cmp_eq_u32 s67, 5
  ds_read_b64_tr_b16 v[62:63], v19 offset:29184
  v_mul_f32 v254, s66, v254
  v_mfma_f32_16x16x32_bf16 v[188:191], v[44:47], a[216:219], v[188:191]
  s_cselect_b64 s[48:49], s[28:29], s[48:49]
  v_mul_f32 v255, s66, v255
  v_cvt_pk_bf16_f32 v79, v254, v255
  v_mfma_f32_16x16x32_bf16 v[128:131], v[48:51], a[28:31], v[128:131]
  s_and_b32 s49, s49, 0xffff
  ds_read_b64_tr_b16 v[32:33], v16 offset:32768
  v_mfma_f32_16x16x32_bf16 v[136:139], v[48:51], a[92:95], v[136:139]
  s_bfe_u32 s67, s59, 0x50013
  v_mfma_f32_16x16x32_bf16 v[160:163], v[48:51], a[156:159], v[160:163]
  s_lshl_b32 s67, s67, 8
  ds_read_b64_tr_b16 v[34:35], v16 offset:33280
  v_mfma_f32_16x16x32_bf16 v[168:171], v[48:51], a[220:223], v[168:171]
  s_bfe_u32 s68, s59, 0x1000c
  buffer_store_dwordx4 v[76:79], v9, s[40:43], s65 offen offset:3072 sc1
  v_mfma_f32_16x16x32_bf16 v[132:135], v[52:55], a[28:31], v[132:135]
  s_lshl_b32 s68, s68, 7
  ds_read_b64_tr_b16 v[36:37], v17 offset:32768
  v_mfma_f32_16x16x32_bf16 v[140:143], v[52:55], a[92:95], v[140:143]
  s_or_b32 s62, s67, s68
  v_mfma_f32_16x16x32_bf16 v[164:167], v[52:55], a[156:159], v[164:167]
  s_waitcnt lgkmcnt(3)
  s_bitcmp1_b32 s59, 2
  ds_read_b64_tr_b16 v[38:39], v17 offset:33280
  v_mfma_f32_16x16x32_bf16 v[172:175], v[52:55], a[220:223], v[172:175]
  s_cselect_b32 s62, 0x40000000, s62
  v_mfma_f32_16x16x32_bf16 v[144:147], v[56:59], a[28:31], v[144:147]
  ds_read_b64_tr_b16 v[40:41], v18 offset:32768
  v_mfma_f32_16x16x32_bf16 v[152:155], v[56:59], a[92:95], v[152:155]
  v_mfma_f32_16x16x32_bf16 v[176:179], v[56:59], a[156:159], v[176:179]
  ds_read_b64_tr_b16 v[42:43], v18 offset:33280
  v_mfma_f32_16x16x32_bf16 v[184:187], v[56:59], a[220:223], v[184:187]
  v_mfma_f32_16x16x32_bf16 v[148:151], v[60:63], a[28:31], v[148:151]
  ds_read_b64_tr_b16 v[44:45], v19 offset:32768
  v_mfma_f32_16x16x32_bf16 v[156:159], v[60:63], a[92:95], v[156:159]
  v_mfma_f32_16x16x32_bf16 v[180:183], v[60:63], a[156:159], v[180:183]
  s_waitcnt lgkmcnt(3)
  ds_read_b64_tr_b16 v[46:47], v19 offset:33280
  v_mfma_f32_16x16x32_bf16 v[188:191], v[60:63], a[220:223], v[188:191]
  v_mfma_f32_16x16x32_bf16 v[128:131], v[32:35], a[32:35], v[128:131]
  s_add_u32 m0, s64, 0
  ds_read_b64_tr_b16 v[48:49], v16 offset:36864
  v_mfma_f32_16x16x32_bf16 v[136:139], v[32:35], a[96:99], v[136:139]
  v_mfma_f32_16x16x32_bf16 v[160:163], v[32:35], a[160:163], v[160:163]
  s_add_u32 s63, s62, 0
  ds_read_b64_tr_b16 v[50:51], v16 offset:37376
  v_mfma_f32_16x16x32_bf16 v[168:171], v[32:35], a[224:227], v[168:171]
  buffer_load_dwordx4 v2, s[48:51], s63 offen lds
  v_mfma_f32_16x16x32_bf16 v[132:135], v[36:39], a[32:35], v[132:135]
  ds_read_b64_tr_b16 v[52:53], v17 offset:36864
  v_mfma_f32_16x16x32_bf16 v[140:143], v[36:39], a[96:99], v[140:143]
  v_mfma_f32_16x16x32_bf16 v[164:167], v[36:39], a[160:163], v[164:167]
  s_waitcnt lgkmcnt(3)
  ds_read_b64_tr_b16 v[54:55], v17 offset:37376
  v_mfma_f32_16x16x32_bf16 v[172:175], v[36:39], a[224:227], v[172:175]
  v_mfma_f32_16x16x32_bf16 v[144:147], v[40:43], a[32:35], v[144:147]
  s_add_u32 m0, s64, 1024
  ds_read_b64_tr_b16 v[56:57], v18 offset:36864
  v_mfma_f32_16x16x32_bf16 v[152:155], v[40:43], a[96:99], v[152:155]
  v_mfma_f32_16x16x32_bf16 v[176:179], v[40:43], a[160:163], v[176:179]
  s_add_u32 s63, s62, 65536
  ds_read_b64_tr_b16 v[58:59], v18 offset:37376
  v_mfma_f32_16x16x32_bf16 v[184:187], v[40:43], a[224:227], v[184:187]
  buffer_load_dwordx4 v3, s[48:51], s63 offen lds
  v_mfma_f32_16x16x32_bf16 v[148:151], v[44:47], a[32:35], v[148:151]
  ds_read_b64_tr_b16 v[60:61], v19 offset:36864
  v_mfma_f32_16x16x32_bf16 v[156:159], v[44:47], a[96:99], v[156:159]
  v_mfma_f32_16x16x32_bf16 v[180:183], v[44:47], a[160:163], v[180:183]
  s_waitcnt lgkmcnt(3)
  ds_read_b64_tr_b16 v[62:63], v19 offset:37376
  v_mfma_f32_16x16x32_bf16 v[188:191], v[44:47], a[224:227], v[188:191]
  v_mfma_f32_16x16x32_bf16 v[128:131], v[48:51], a[36:39], v[128:131]
  s_add_u32 m0, s64, 2048
  ds_read_b64_tr_b16 v[32:33], v16 offset:40960
  v_mfma_f32_16x16x32_bf16 v[136:139], v[48:51], a[100:103], v[136:139]
  v_mfma_f32_16x16x32_bf16 v[160:163], v[48:51], a[164:167], v[160:163]
  s_add_u32 s63, s62, 131072
  ds_read_b64_tr_b16 v[34:35], v16 offset:41472
  v_mfma_f32_16x16x32_bf16 v[168:171], v[48:51], a[228:231], v[168:171]
  buffer_load_dwordx4 v2, s[48:51], s63 offen lds
  v_mfma_f32_16x16x32_bf16 v[132:135], v[52:55], a[36:39], v[132:135]
  ds_read_b64_tr_b16 v[36:37], v17 offset:40960
  v_mfma_f32_16x16x32_bf16 v[140:143], v[52:55], a[100:103], v[140:143]
  v_mfma_f32_16x16x32_bf16 v[164:167], v[52:55], a[164:167], v[164:167]
  s_waitcnt lgkmcnt(3)
  ds_read_b64_tr_b16 v[38:39], v17 offset:41472
  v_mfma_f32_16x16x32_bf16 v[172:175], v[52:55], a[228:231], v[172:175]
  v_mfma_f32_16x16x32_bf16 v[144:147], v[56:59], a[36:39], v[144:147]
  s_add_u32 m0, s64, 3072
  ds_read_b64_tr_b16 v[40:41], v18 offset:40960
  v_mfma_f32_16x16x32_bf16 v[152:155], v[56:59], a[100:103], v[152:155]
  v_mfma_f32_16x16x32_bf16 v[176:179], v[56:59], a[164:167], v[176:179]
  s_add_u32 s63, s62, 196608
  ds_read_b64_tr_b16 v[42:43], v18 offset:41472
  v_mfma_f32_16x16x32_bf16 v[184:187], v[56:59], a[228:231], v[184:187]
  buffer_load_dwordx4 v3, s[48:51], s63 offen lds
  v_mfma_f32_16x16x32_bf16 v[148:151], v[60:63], a[36:39], v[148:151]
  ds_read_b64_tr_b16 v[44:45], v19 offset:40960
  v_mfma_f32_16x16x32_bf16 v[156:159], v[60:63], a[100:103], v[156:159]
  v_mfma_f32_16x16x32_bf16 v[180:183], v[60:63], a[164:167], v[180:183]
  s_waitcnt lgkmcnt(3)
  ds_read_b64_tr_b16 v[46:47], v19 offset:41472
  v_mfma_f32_16x16x32_bf16 v[188:191], v[60:63], a[228:231], v[188:191]
  v_mfma_f32_16x16x32_bf16 v[128:131], v[32:35], a[40:43], v[128:131]
  ds_read_b64_tr_b16 v[48:49], v16 offset:45056
  v_mfma_f32_16x16x32_bf16 v[136:139], v[32:35], a[104:107], v[136:139]
  v_mfma_f32_16x16x32_bf16 v[160:163], v[32:35], a[168:171], v[160:163]
  ds_read_b64_tr_b16 v[50:51], v16 offset:45568
  v_mfma_f32_16x16x32_bf16 v[168:171], v[32:35], a[232:235], v[168:171]
  v_mfma_f32_16x16x32_bf16 v[132:135], v[36:39], a[40:43], v[132:135]
  ds_read_b64_tr_b16 v[52:53], v17 offset:45056
  v_mfma_f32_16x16x32_bf16 v[140:143], v[36:39], a[104:107], v[140:143]
  v_mfma_f32_16x16x32_bf16 v[164:167], v[36:39], a[168:171], v[164:167]
  s_waitcnt lgkmcnt(3)
  ds_read_b64_tr_b16 v[54:55], v17 offset:45568
  v_mfma_f32_16x16x32_bf16 v[172:175], v[36:39], a[232:235], v[172:175]
  v_mfma_f32_16x16x32_bf16 v[144:147], v[40:43], a[40:43], v[144:147]
  ds_read_b64_tr_b16 v[56:57], v18 offset:45056
  v_mfma_f32_16x16x32_bf16 v[152:155], v[40:43], a[104:107], v[152:155]
  v_mfma_f32_16x16x32_bf16 v[176:179], v[40:43], a[168:171], v[176:179]
  ds_read_b64_tr_b16 v[58:59], v18 offset:45568
  v_mfma_f32_16x16x32_bf16 v[184:187], v[40:43], a[232:235], v[184:187]
  v_mfma_f32_16x16x32_bf16 v[148:151], v[44:47], a[40:43], v[148:151]
  s_waitcnt vmcnt(28)
  ds_read_b64_tr_b16 v[60:61], v19 offset:45056
  v_mfma_f32_16x16x32_bf16 v[156:159], v[44:47], a[104:107], v[156:159]
  s_barrier
  v_mfma_f32_16x16x32_bf16 v[180:183], v[44:47], a[168:171], v[180:183]
  s_waitcnt lgkmcnt(3)
  ds_read_b64_tr_b16 v[62:63], v19 offset:45568
  v_mfma_f32_16x16x32_bf16 v[188:191], v[44:47], a[232:235], v[188:191]
  v_mfma_f32_16x16x32_bf16 v[128:131], v[48:51], a[44:47], v[128:131]
  ds_read_b64_tr_b16 v[32:33], v16 offset:49152
  v_mfma_f32_16x16x32_bf16 v[136:139], v[48:51], a[108:111], v[136:139]
  v_mfma_f32_16x16x32_bf16 v[160:163], v[48:51], a[172:175], v[160:163]
  ds_read_b64_tr_b16 v[34:35], v16 offset:49664
  v_mfma_f32_16x16x32_bf16 v[168:171], v[48:51], a[236:239], v[168:171]
  v_mfma_f32_16x16x32_bf16 v[132:135], v[52:55], a[44:47], v[132:135]
  ds_read_b64_tr_b16 v[36:37], v17 offset:49152
  v_mfma_f32_16x16x32_bf16 v[140:143], v[52:55], a[108:111], v[140:143]
  v_mfma_f32_16x16x32_bf16 v[164:167], v[52:55], a[172:175], v[164:167]
  s_waitcnt lgkmcnt(3)
  ds_read_b64_tr_b16 v[38:39], v17 offset:49664
  v_mfma_f32_16x16x32_bf16 v[172:175], v[52:55], a[236:239], v[172:175]
  v_mfma_f32_16x16x32_bf16 v[144:147], v[56:59], a[44:47], v[144:147]
  ds_read_b64_tr_b16 v[40:41], v18 offset:49152
  v_mfma_f32_16x16x32_bf16 v[152:155], v[56:59], a[108:111], v[152:155]
  v_mfma_f32_16x16x32_bf16 v[176:179], v[56:59], a[172:175], v[176:179]
  ds_read_b64_tr_b16 v[42:43], v18 offset:49664
  v_mfma_f32_16x16x32_bf16 v[184:187], v[56:59], a[236:239], v[184:187]
  v_mfma_f32_16x16x32_bf16 v[148:151], v[60:63], a[44:47], v[148:151]
  ds_read_b64_tr_b16 v[44:45], v19 offset:49152
  v_mfma_f32_16x16x32_bf16 v[156:159], v[60:63], a[108:111], v[156:159]
  v_mfma_f32_16x16x32_bf16 v[180:183], v[60:63], a[172:175], v[180:183]
  s_waitcnt lgkmcnt(3)
  ds_read_b64_tr_b16 v[46:47], v19 offset:49664
  v_mfma_f32_16x16x32_bf16 v[188:191], v[60:63], a[236:239], v[188:191]
  v_mfma_f32_16x16x32_bf16 v[128:131], v[32:35], a[48:51], v[128:131]
  s_add_u32 m0, s64, 16384
  ds_read_b64_tr_b16 v[48:49], v16 offset:53248
  v_mfma_f32_16x16x32_bf16 v[136:139], v[32:35], a[112:115], v[136:139]
  v_mfma_f32_16x16x32_bf16 v[160:163], v[32:35], a[176:179], v[160:163]
  s_add_u32 s63, s62, 1048576
  ds_read_b64_tr_b16 v[50:51], v16 offset:53760
  v_mfma_f32_16x16x32_bf16 v[168:171], v[32:35], a[240:243], v[168:171]
  buffer_load_dwordx4 v2, s[48:51], s63 offen lds
  v_mfma_f32_16x16x32_bf16 v[132:135], v[36:39], a[48:51], v[132:135]
  ds_read_b64_tr_b16 v[52:53], v17 offset:53248
  v_mfma_f32_16x16x32_bf16 v[140:143], v[36:39], a[112:115], v[140:143]
  v_mfma_f32_16x16x32_bf16 v[164:167], v[36:39], a[176:179], v[164:167]
  s_waitcnt lgkmcnt(3)
  ds_read_b64_tr_b16 v[54:55], v17 offset:53760
  v_mfma_f32_16x16x32_bf16 v[172:175], v[36:39], a[240:243], v[172:175]
  v_mfma_f32_16x16x32_bf16 v[144:147], v[40:43], a[48:51], v[144:147]
  s_add_u32 m0, s64, 17408
  ds_read_b64_tr_b16 v[56:57], v18 offset:53248
  v_mfma_f32_16x16x32_bf16 v[152:155], v[40:43], a[112:115], v[152:155]
  v_mfma_f32_16x16x32_bf16 v[176:179], v[40:43], a[176:179], v[176:179]
  s_add_u32 s63, s62, 1114112
  ds_read_b64_tr_b16 v[58:59], v18 offset:53760
  v_mfma_f32_16x16x32_bf16 v[184:187], v[40:43], a[240:243], v[184:187]
  buffer_load_dwordx4 v3, s[48:51], s63 offen lds
  v_mfma_f32_16x16x32_bf16 v[148:151], v[44:47], a[48:51], v[148:151]
  ds_read_b64_tr_b16 v[60:61], v19 offset:53248
  v_mfma_f32_16x16x32_bf16 v[156:159], v[44:47], a[112:115], v[156:159]
  v_mfma_f32_16x16x32_bf16 v[180:183], v[44:47], a[176:179], v[180:183]
  s_waitcnt lgkmcnt(3)
  ds_read_b64_tr_b16 v[62:63], v19 offset:53760
  v_mfma_f32_16x16x32_bf16 v[188:191], v[44:47], a[240:243], v[188:191]
  v_mfma_f32_16x16x32_bf16 v[128:131], v[48:51], a[52:55], v[128:131]
  s_add_u32 m0, s64, 18432
  ds_read_b64_tr_b16 v[32:33], v16 offset:57344
  v_mfma_f32_16x16x32_bf16 v[136:139], v[48:51], a[116:119], v[136:139]
  v_mfma_f32_16x16x32_bf16 v[160:163], v[48:51], a[180:183], v[160:163]
  s_add_u32 s63, s62, 1179648
  ds_read_b64_tr_b16 v[34:35], v16 offset:57856
  v_mfma_f32_16x16x32_bf16 v[168:171], v[48:51], a[244:247], v[168:171]
  buffer_load_dwordx4 v2, s[48:51], s63 offen lds
  v_mfma_f32_16x16x32_bf16 v[132:135], v[52:55], a[52:55], v[132:135]
  ds_read_b64_tr_b16 v[36:37], v17 offset:57344
  v_mfma_f32_16x16x32_bf16 v[140:143], v[52:55], a[116:119], v[140:143]
  v_mfma_f32_16x16x32_bf16 v[164:167], v[52:55], a[180:183], v[164:167]
  s_waitcnt lgkmcnt(3)
  ds_read_b64_tr_b16 v[38:39], v17 offset:57856
  v_mfma_f32_16x16x32_bf16 v[172:175], v[52:55], a[244:247], v[172:175]
  v_mfma_f32_16x16x32_bf16 v[144:147], v[56:59], a[52:55], v[144:147]
  s_add_u32 m0, s64, 19456
  ds_read_b64_tr_b16 v[40:41], v18 offset:57344
  v_mfma_f32_16x16x32_bf16 v[152:155], v[56:59], a[116:119], v[152:155]
  v_mfma_f32_16x16x32_bf16 v[176:179], v[56:59], a[180:183], v[176:179]
  s_add_u32 s63, s62, 1245184
  ds_read_b64_tr_b16 v[42:43], v18 offset:57856
  v_mfma_f32_16x16x32_bf16 v[184:187], v[56:59], a[244:247], v[184:187]
  buffer_load_dwordx4 v3, s[48:51], s63 offen lds
  v_mfma_f32_16x16x32_bf16 v[148:151], v[60:63], a[52:55], v[148:151]
  ds_read_b64_tr_b16 v[44:45], v19 offset:57344
  v_mfma_f32_16x16x32_bf16 v[156:159], v[60:63], a[116:119], v[156:159]
  v_mfma_f32_16x16x32_bf16 v[180:183], v[60:63], a[180:183], v[180:183]
  s_waitcnt lgkmcnt(3)
  ds_read_b64_tr_b16 v[46:47], v19 offset:57856
  v_mfma_f32_16x16x32_bf16 v[188:191], v[60:63], a[244:247], v[188:191]
  v_mfma_f32_16x16x32_bf16 v[128:131], v[32:35], a[56:59], v[128:131]
  ds_read_b64_tr_b16 v[48:49], v16 offset:61440
  v_mfma_f32_16x16x32_bf16 v[136:139], v[32:35], a[120:123], v[136:139]
  v_mfma_f32_16x16x32_bf16 v[160:163], v[32:35], a[184:187], v[160:163]
  ds_read_b64_tr_b16 v[50:51], v16 offset:61952
  v_mfma_f32_16x16x32_bf16 v[168:171], v[32:35], a[248:251], v[168:171]
  v_mfma_f32_16x16x32_bf16 v[132:135], v[36:39], a[56:59], v[132:135]
  ds_read_b64_tr_b16 v[52:53], v17 offset:61440
  v_mfma_f32_16x16x32_bf16 v[140:143], v[36:39], a[120:123], v[140:143]
  v_mfma_f32_16x16x32_bf16 v[164:167], v[36:39], a[184:187], v[164:167]
  s_waitcnt lgkmcnt(3)
  ds_read_b64_tr_b16 v[54:55], v17 offset:61952
  v_mfma_f32_16x16x32_bf16 v[172:175], v[36:39], a[248:251], v[172:175]
  v_mfma_f32_16x16x32_bf16 v[144:147], v[40:43], a[56:59], v[144:147]
  ds_read_b64_tr_b16 v[56:57], v18 offset:61440
  v_mfma_f32_16x16x32_bf16 v[152:155], v[40:43], a[120:123], v[152:155]
  v_mfma_f32_16x16x32_bf16 v[176:179], v[40:43], a[184:187], v[176:179]
  ds_read_b64_tr_b16 v[58:59], v18 offset:61952
  v_mfma_f32_16x16x32_bf16 v[184:187], v[40:43], a[248:251], v[184:187]
  v_mfma_f32_16x16x32_bf16 v[148:151], v[44:47], a[56:59], v[148:151]
  s_waitcnt vmcnt(28)
  ds_read_b64_tr_b16 v[60:61], v19 offset:61440
  v_mfma_f32_16x16x32_bf16 v[156:159], v[44:47], a[120:123], v[156:159]
  s_barrier
  v_mfma_f32_16x16x32_bf16 v[180:183], v[44:47], a[184:187], v[180:183]
  s_waitcnt lgkmcnt(3)
  ds_read_b64_tr_b16 v[62:63], v19 offset:61952
  v_mfma_f32_16x16x32_bf16 v[188:191], v[44:47], a[248:251], v[188:191]
  v_mfma_f32_16x16x32_bf16 v[128:131], v[48:51], a[60:63], v[128:131]
  s_mov_b32 s61, s60
  ds_read_b64_tr_b16 v[32:33], v20 offset:0
  v_mfma_f32_16x16x32_bf16 v[136:139], v[48:51], a[124:127], v[136:139]
  s_mov_b32 s60, s57
  v_mfma_f32_16x16x32_bf16 v[160:163], v[48:51], a[188:191], v[160:163]
  s_mov_b32 s57, s58
  ds_read_b64_tr_b16 v[34:35], v20 offset:512
  v_mfma_f32_16x16x32_bf16 v[168:171], v[48:51], a[252:255], v[168:171]
  s_mov_b32 s58, s59
  v_mfma_f32_16x16x32_bf16 v[132:135], v[52:55], a[60:63], v[132:135]
  s_add_u32 s56, s56, 1
  ds_read_b64_tr_b16 v[36:37], v21 offset:0
  v_mfma_f32_16x16x32_bf16 v[140:143], v[52:55], a[124:127], v[140:143]
  v_mfma_f32_16x16x32_bf16 v[164:167], v[52:55], a[188:191], v[164:167]
  s_waitcnt lgkmcnt(3)
  ds_read_b64_tr_b16 v[38:39], v21 offset:512
  v_mfma_f32_16x16x32_bf16 v[172:175], v[52:55], a[252:255], v[172:175]
  v_mfma_f32_16x16x32_bf16 v[144:147], v[56:59], a[60:63], v[144:147]
  ds_read_b64_tr_b16 v[40:41], v22 offset:0
  v_mfma_f32_16x16x32_bf16 v[152:155], v[56:59], a[124:127], v[152:155]
  v_mfma_f32_16x16x32_bf16 v[176:179], v[56:59], a[188:191], v[176:179]
  ds_read_b64_tr_b16 v[42:43], v22 offset:512
  v_mfma_f32_16x16x32_bf16 v[184:187], v[56:59], a[252:255], v[184:187]
  v_mfma_f32_16x16x32_bf16 v[148:151], v[60:63], a[60:63], v[148:151]
  ds_read_b64_tr_b16 v[44:45], v23 offset:0
  v_mfma_f32_16x16x32_bf16 v[156:159], v[60:63], a[124:127], v[156:159]
  v_mfma_f32_16x16x32_bf16 v[180:183], v[60:63], a[188:191], v[180:183]
  s_waitcnt lgkmcnt(3)
  ds_read_b64_tr_b16 v[46:47], v23 offset:512
  v_mfma_f32_16x16x32_bf16 v[188:191], v[60:63], a[252:255], v[188:191]
  s_bitcmp1_b32 s57, 2
  s_cbranch_scc1 L_p_done_0
  s_bitcmp1_b32 s57, 0
  s_cbranch_scc1 L_p_body_1_1
  s_branch L_p_body_1_0
L_p_body_0_1:
  v_mfma_f32_16x16x32_bf16 v[128:131], a[0:3], v[32:35], 0
  s_add_u32 m0, s64, 98304
  ds_read_b64_tr_b16 v[48:49], v16 offset:4096
  v_mfma_f32_16x16x32_bf16 v[132:135], a[64:67], v[32:35], 0
  v_mfma_f32_16x16x32_bf16 v[160:163], a[128:131], v[32:35], 0
  s_add_u32 s63, s62, 2097152
  ds_read_b64_tr_b16 v[50:51], v16 offset:4608
  v_mfma_f32_16x16x32_bf16 v[164:167], a[192:195], v[32:35], 0
  buffer_load_dwordx4 v2, s[48:51], s63 offen lds
  v_mfma_f32_16x16x32_bf16 v[136:139], a[0:3], v[36:39], 0
  s_and_b32 s65, s60, 0x7fff000
  s_bitcmp1_b32 s60, 2
  s_cselect_b32 s65, 0x40000000, s65
  ds_read_b64_tr_b16 v[52:53], v17 offset:4096
  v_mfma_f32_16x16x32_bf16 v[140:143], a[64:67], v[36:39], 0
  s_bitcmp1_b32 s60, 1
  s_cselect_b32 s66, 0x3e0293ee, 1.0
  v_mfma_f32_16x16x32_bf16 v[168:171], a[128:131], v[36:39], 0
  s_waitcnt lgkmcnt(3)
  ds_read_b64_tr_b16 v[54:55], v17 offset:4608
  v_mfma_f32_16x16x32_bf16 v[172:175], a[192:195], v[36:39], 0
  v_mfma_f32_16x16x32_bf16 v[144:147], a[0:3], v[40:43], 0
  s_add_u32 m0, s64, 99328
  ds_read_b64_tr_b16 v[56:57], v18 offset:4096
  v_mfma_f32_16x16x32_bf16 v[148:151], a[64:67], v[40:43], 0
  v_mfma_f32_16x16x32_bf16 v[176:179], a[128:131], v[40:43], 0
  s_add_u32 s63, s62, 2162688
  ds_read_b64_tr_b16 v[58:59], v18 offset:4608
  v_mul_f32 v192, s66, v192
  v_mfma_f32_16x16x32_bf16 v[180:183], a[192:195], v[40:43], 0
  buffer_load_dwordx4 v3, s[48:51], s63 offen lds
  v_mul_f32 v193, s66, v193
  v_cvt_pk_bf16_f32 v64, v192, v193
  v_mfma_f32_16x16x32_bf16 v[152:155], a[0:3], v[44:47], 0
  ds_read_b64_tr_b16 v[60:61], v19 offset:4096
  v_mul_f32 v194, s66, v194
  v_mfma_f32_16x16x32_bf16 v[156:159], a[64:67], v[44:47], 0
  v_mul_f32 v195, s66, v195
  v_cvt_pk_bf16_f32 v65, v194, v195
  v_mfma_f32_16x16x32_bf16 v[184:187], a[128:131], v[44:47], 0
  s_waitcnt lgkmcnt(3)
  ds_read_b64_tr_b16 v[62:63], v19 offset:4608
  v_mul_f32 v196, s66, v196
  v_mfma_f32_16x16x32_bf16 v[188:191], a[192:195], v[44:47], 0
  v_mul_f32 v197, s66, v197
  v_cvt_pk_bf16_f32 v66, v196, v197
  v_mfma_f32_16x16x32_bf16 v[128:131], a[4:7], v[48:51], v[128:131]
  s_add_u32 m0, s64, 100352
  ds_read_b64_tr_b16 v[32:33], v16 offset:8192
  v_readlane_b32 s59, v1, s56
  v_mfma_f32_16x16x32_bf16 v[132:135], a[68:71], v[48:51], v[132:135]
  v_mul_f32 v198, s66, v198
  v_mul_f32 v199, s66, v199
  v_cvt_pk_bf16_f32 v67, v198, v199
  v_mfma_f32_16x16x32_bf16 v[160:163], a[132:135], v[48:51], v[160:163]
  s_add_u32 s63, s62, 2228224
  ds_read_b64_tr_b16 v[34:35], v16 offset:8704
  v_mfma_f32_16x16x32_bf16 v[164:167], a[196:199], v[48:51], v[164:167]
  buffer_load_dwordx4 v2, s[48:51], s63 offen lds
  v_mfma_f32_16x16x32_bf16 v[136:139], a[4:7], v[52:55], v[136:139]
  ds_read_b64_tr_b16 v[36:37], v17 offset:8192
  v_mul_f32 v200, s66, v200
  v_mfma_f32_16x16x32_bf16 v[140:143], a[68:71], v[52:55], v[140:143]
  buffer_store_dwordx4 v[64:67], v8, s[40:43], s65 offen offset:0 sc1
  v_mul_f32 v201, s66, v201
  v_cvt_pk_bf16_f32 v68, v200, v201
  v_mfma_f32_16x16x32_bf16 v[168:171], a[132:135], v[52:55], v[168:171]
  s_waitcnt lgkmcnt(3)
  ds_read_b64_tr_b16 v[38:39], v17 offset:8704
  v_mul_f32 v202, s66, v202
  v_mfma_f32_16x16x32_bf16 v[172:175], a[196:199], v[52:55], v[172:175]
  v_mul_f32 v203, s66, v203
  v_cvt_pk_bf16_f32 v69, v202, v203
  v_mfma_f32_16x16x32_bf16 v[144:147], a[4:7], v[56:59], v[144:147]
  s_add_u32 m0, s64, 101376
  ds_read_b64_tr_b16 v[40:41], v18 offset:8192
  v_mul_f32 v204, s66, v204
  v_mfma_f32_16x16x32_bf16 v[148:151], a[68:71], v[56:59], v[148:151]
  v_mul_f32 v205, s66, v205
  v_cvt_pk_bf16_f32 v70, v204, v205
  v_mfma_f32_16x16x32_bf16 v[176:179], a[132:135], v[56:59], v[176:179]
  s_add_u32 s63, s62, 2293760
  ds_read_b64_tr_b16 v[42:43], v18 offset:8704
  v_mul_f32 v206, s66, v206
  v_mfma_f32_16x16x32_bf16 v[180:183], a[196:199], v[56:59], v[180:183]
  buffer_load_dwordx4 v3, s[48:51], s63 offen lds
  v_mul_f32 v207, s66, v207
  v_cvt_pk_bf16_f32 v71, v206, v207
  v_mfma_f32_16x16x32_bf16 v[152:155], a[4:7], v[60:63], v[152:155]
  ds_read_b64_tr_b16 v[44:45], v19 offset:8192
  v_mfma_f32_16x16x32_bf16 v[156:159], a[68:71], v[60:63], v[156:159]
  v_mfma_f32_16x16x32_bf16 v[184:187], a[132:135], v[60:63], v[184:187]
  s_waitcnt lgkmcnt(3)
  ds_read_b64_tr_b16 v[46:47], v19 offset:8704
  v_mfma_f32_16x16x32_bf16 v[188:191], a[196:199], v[60:63], v[188:191]
  buffer_store_dwordx4 v[68:71], v8, s[40:43], s65 offen offset:1024 sc1
  v_mfma_f32_16x16x32_bf16 v[128:131], a[8:11], v[32:35], v[128:131]
  s_bfe_u32 s67, s61, 0x50013
  ds_read_b64_tr_b16 v[48:49], v16 offset:12288
  v_mfma_f32_16x16x32_bf16 v[132:135], a[72:75], v[32:35], v[132:135]
  s_lshl_b32 s67, s67, 7
  v_mfma_f32_16x16x32_bf16 v[160:163], a[136:139], v[32:35], v[160:163]
  s_bfe_u32 s68, s61, 0x20004
  ds_read_b64_tr_b16 v[50:51], v16 offset:12800
  v_mfma_f32_16x16x32_bf16 v[164:167], a[200:203], v[32:35], v[164:167]
  s_lshl_b32 s68, s68, 5
  v_mfma_f32_16x16x32_bf16 v[136:139], a[8:11], v[36:39], v[136:139]
  s_or_b32 s69, s67, s68
  ds_read_b64_tr_b16 v[52:53], v17 offset:12288
  v_mfma_f32_16x16x32_bf16 v[140:143], a[72:75], v[36:39], v[140:143]
  s_bitcmp1_b32 s61, 2
  v_mfma_f32_16x16x32_bf16 v[168:171], a[136:139], v[36:39], v[168:171]
  s_waitcnt lgkmcnt(3)
  ds_read_b64_tr_b16 v[54:55], v17 offset:12800
  v_mul_f32 v208, s66, v208
  v_mfma_f32_16x16x32_bf16 v[172:175], a[200:203], v[36:39], v[172:175]
  s_cselect_b32 s69, 0x40000000, s69
  v_mul_f32 v209, s66, v209
  v_cvt_pk_bf16_f32 v72, v208, v209
  v_mfma_f32_16x16x32_bf16 v[144:147], a[8:11], v[40:43], v[144:147]
  ds_read_b64_tr_b16 v[56:57], v18 offset:12288
  v_mul_f32 v210, s66, v210
  v_mfma_f32_16x16x32_bf16 v[148:151], a[72:75], v[40:43], v[148:151]
  v_mul_f32 v211, s66, v211
  v_cvt_pk_bf16_f32 v73, v210, v211
  v_mfma_f32_16x16x32_bf16 v[176:179], a[136:139], v[40:43], v[176:179]
  ds_read_b64_tr_b16 v[58:59], v18 offset:12800
  v_mul_f32 v212, s66, v212
  v_mfma_f32_16x16x32_bf16 v[180:183], a[200:203], v[40:43], v[180:183]
  v_mul_f32 v213, s66, v213
  v_cvt_pk_bf16_f32 v74, v212, v213
  v_mfma_f32_16x16x32_bf16 v[152:155], a[8:11], v[44:47], v[152:155]
  s_waitcnt vmcnt(14)
  ds_read_b64_tr_b16 v[60:61], v19 offset:12288
  v_mul_f32 v214, s66, v214
  v_mfma_f32_16x16x32_bf16 v[156:159], a[72:75], v[44:47], v[156:159]
  s_barrier
  v_mul_f32 v215, s66, v215
  v_cvt_pk_bf16_f32 v75, v214, v215
  v_mfma_f32_16x16x32_bf16 v[184:187], a[136:139], v[44:47], v[184:187]
  s_waitcnt lgkmcnt(3)
  ds_read_b64_tr_b16 v[62:63], v19 offset:12800
  v_mfma_f32_16x16x32_bf16 v[188:191], a[200:203], v[44:47], v[188:191]
  buffer_atomic_add v11, v10, s[40:43], s69 offen
  v_mfma_f32_16x16x32_bf16 v[128:131], a[12:15], v[48:51], v[128:131]
  ds_read_b64_tr_b16 v[32:33], v16 offset:16384
  v_mul_f32 v216, s66, v216
  v_mfma_f32_16x16x32_bf16 v[132:135], a[76:79], v[48:51], v[132:135]
  buffer_store_dwordx4 v[72:75], v8, s[40:43], s65 offen offset:2048 sc1
  v_mul_f32 v217, s66, v217
  v_cvt_pk_bf16_f32 v76, v216, v217
  v_mfma_f32_16x16x32_bf16 v[160:163], a[140:143], v[48:51], v[160:163]
  ds_read_b64_tr_b16 v[34:35], v16 offset:16896
  v_mul_f32 v218, s66, v218
  v_mfma_f32_16x16x32_bf16 v[164:167], a[204:207], v[48:51], v[164:167]
  v_mul_f32 v219, s66, v219
  v_cvt_pk_bf16_f32 v77, v218, v219
  v_mfma_f32_16x16x32_bf16 v[136:139], a[12:15], v[52:55], v[136:139]
  ds_read_b64_tr_b16 v[36:37], v17 offset:16384
  v_mul_f32 v220, s66, v220
  v_mfma_f32_16x16x32_bf16 v[140:143], a[76:79], v[52:55], v[140:143]
  v_mul_f32 v221, s66, v221
  v_cvt_pk_bf16_f32 v78, v220, v221
  v_mfma_f32_16x16x32_bf16 v[168:171], a[140:143], v[52:55], v[168:171]
  s_waitcnt lgkmcnt(3)
  ds_read_b64_tr_b16 v[38:39], v17 offset:16896
  v_mul_f32 v222, s66, v222
  v_mfma_f32_16x16x32_bf16 v[172:175], a[204:207], v[52:55], v[172:175]
  v_mul_f32 v223, s66, v223
  v_cvt_pk_bf16_f32 v79, v222, v223
  v_mfma_f32_16x16x32_bf16 v[144:147], a[12:15], v[56:59], v[144:147]
  ds_read_b64_tr_b16 v[40:41], v18 offset:16384
  v_mfma_f32_16x16x32_bf16 v[148:151], a[76:79], v[56:59], v[148:151]
  v_mfma_f32_16x16x32_bf16 v[176:179], a[140:143], v[56:59], v[176:179]
  ds_read_b64_tr_b16 v[42:43], v18 offset:16896
  v_mfma_f32_16x16x32_bf16 v[180:183], a[204:207], v[56:59], v[180:183]
  buffer_store_dwordx4 v[76:79], v8, s[40:43], s65 offen offset:3072 sc1
  v_mfma_f32_16x16x32_bf16 v[152:155], a[12:15], v[60:63], v[152:155]
  ds_read_b64_tr_b16 v[44:45], v19 offset:16384
  v_mfma_f32_16x16x32_bf16 v[156:159], a[76:79], v[60:63], v[156:159]
  v_mfma_f32_16x16x32_bf16 v[184:187], a[140:143], v[60:63], v[184:187]
  s_waitcnt lgkmcnt(3)
  ds_read_b64_tr_b16 v[46:47], v19 offset:16896
  v_mfma_f32_16x16x32_bf16 v[188:191], a[204:207], v[60:63], v[188:191]
  v_mfma_f32_16x16x32_bf16 v[128:131], a[16:19], v[32:35], v[128:131]
  s_add_u32 m0, s64, 114688
  ds_read_b64_tr_b16 v[48:49], v16 offset:20480
  v_mfma_f32_16x16x32_bf16 v[132:135], a[80:83], v[32:35], v[132:135]
  v_mfma_f32_16x16x32_bf16 v[160:163], a[144:147], v[32:35], v[160:163]
  s_add_u32 s63, s62, 3145728
  ds_read_b64_tr_b16 v[50:51], v16 offset:20992
  v_mul_f32 v224, s66, v224
  v_mfma_f32_16x16x32_bf16 v[164:167], a[208:211], v[32:35], v[164:167]
  buffer_load_dwordx4 v2, s[48:51], s63 offen lds
  v_mul_f32 v225, s66, v225
  v_cvt_pk_bf16_f32 v64, v224, v225
  v_mfma_f32_16x16x32_bf16 v[136:139], a[16:19], v[36:39], v[136:139]
  ds_read_b64_tr_b16 v[52:53], v17 offset:20480
  v_mul_f32 v226, s66, v226
  v_mfma_f32_16x16x32_bf16 v[140:143], a[80:83], v[36:39], v[140:143]
  v_mul_f32 v227, s66, v227
  v_cvt_pk_bf16_f32 v65, v226, v227
  v_mfma_f32_16x16x32_bf16 v[168:171], a[144:147], v[36:39], v[168:171]
  s_waitcnt lgkmcnt(3)
  ds_read_b64_tr_b16 v[54:55], v17 offset:20992
  v_mul_f32 v228, s66, v228
  v_mfma_f32_16x16x32_bf16 v[172:175], a[208:211], v[36:39], v[172:175]
  v_mul_f32 v229, s66, v229
  v_cvt_pk_bf16_f32 v66, v228, v229
  v_mfma_f32_16x16x32_bf16 v[144:147], a[16:19], v[40:43], v[144:147]
  s_add_u32 m0, s64, 115712
  ds_read_b64_tr_b16 v[56:57], v18 offset:20480
  v_mul_f32 v230, s66, v230
  v_mfma_f32_16x16x32_bf16 v[148:151], a[80:83], v[40:43], v[148:151]
  v_mul_f32 v231, s66, v231
  v_cvt_pk_bf16_f32 v67, v230, v231
  v_mfma_f32_16x16x32_bf16 v[176:179], a[144:147], v[40:43], v[176:179]
  s_add_u32 s63, s62, 3211264
  ds_read_b64_tr_b16 v[58:59], v18 offset:20992
  v_mfma_f32_16x16x32_bf16 v[180:183], a[208:211], v[40:43], v[180:183]
  buffer_load_dwordx4 v3, s[48:51], s63 offen lds
  v_mfma_f32_16x16x32_bf16 v[152:155], a[16:19], v[44:47], v[152:155]
  ds_read_b64_tr_b16 v[60:61], v19 offset:20480
  v_mul_f32 v232, s66, v232
  v_mfma_f32_16x16x32_bf16 v[156:159], a[80:83], v[44:47], v[156:159]
  buffer_store_dwordx4 v[64:67], v9, s[40:43], s65 offen offset:0 sc1
  v_mul_f32 v233, s66, v233
  v_cvt_pk_bf16_f32 v68, v232, v233
  v_mfma_f32_16x16x32_bf16 v[184:187], a[144:147], v[44:47], v[184:187]
  s_waitcnt lgkmcnt(3)
  ds_read_b64_tr_b16 v[62:63], v19 offset:20992
  v_mul_f32 v234, s66, v234
  v_mfma_f32_16x16x32_bf16 v[188:191], a[208:211], v[44:47], v[188:191]
  v_mul_f32 v235, s66, v235
  v_cvt_pk_bf16_f32 v69, v234, v235
  v_mfma_f32_16x16x32_bf16 v[128:131], a[20:23], v[48:51], v[128:131]
  s_add_u32 m0, s64, 116736
  ds_read_b64_tr_b16 v[32:33], v16 offset:24576
  v_mul_f32 v236, s66, v236
  v_mfma_f32_16x16x32_bf16 v[132:135], a[84:87], v[48:51], v[132:135]
  v_mul_f32 v237, s66, v237
  v_cvt_pk_bf16_f32 v70, v236, v237
  v_mfma_f32_16x16x32_bf16 v[160:163], a[148:151], v[48:51], v[160:163]
  s_add_u32 s63, s62, 3276800
  ds_read_b64_tr_b16 v[34:35], v16 offset:25088
  v_mul_f32 v238, s66, v238
  v_mfma_f32_16x16x32_bf16 v[164:167], a[212:215], v[48:51], v[164:167]
  buffer_load_dwordx4 v2, s[48:51], s63 offen lds
  v_mul_f32 v239, s66, v239
  v_cvt_pk_bf16_f32 v71, v238, v239
  v_mfma_f32_16x16x32_bf16 v[136:139], a[20:23], v[52:55], v[136:139]
  ds_read_b64_tr_b16 v[36:37], v17 offset:24576
  v_mfma_f32_16x16x32_bf16 v[140:143], a[84:87], v[52:55], v[140:143]
  v_mfma_f32_16x16x32_bf16 v[168:171], a[148:151], v[52:55], v[168:171]
  s_waitcnt lgkmcnt(3)
  ds_read_b64_tr_b16 v[38:39], v17 offset:25088
  v_mfma_f32_16x16x32_bf16 v[172:175], a[212:215], v[52:55], v[172:175]
  buffer_store_dwordx4 v[68:71], v9, s[40:43], s65 offen offset:1024 sc1
  v_mfma_f32_16x16x32_bf16 v[144:147], a[20:23], v[56:59], v[144:147]
  s_add_u32 m0, s64, 117760
  ds_read_b64_tr_b16 v[40:41], v18 offset:24576
  v_mfma_f32_16x16x32_bf16 v[148:151], a[84:87], v[56:59], v[148:151]
  v_mfma_f32_16x16x32_bf16 v[176:179], a[148:151], v[56:59], v[176:179]
  s_add_u32 s63, s62, 3342336
  ds_read_b64_tr_b16 v[42:43], v18 offset:25088
  v_mfma_f32_16x16x32_bf16 v[180:183], a[212:215], v[56:59], v[180:183]
  buffer_load_dwordx4 v3, s[48:51], s63 offen lds
  v_mfma_f32_16x16x32_bf16 v[152:155], a[20:23], v[60:63], v[152:155]
  ds_read_b64_tr_b16 v[44:45], v19 offset:24576
  v_mfma_f32_16x16x32_bf16 v[156:159], a[84:87], v[60:63], v[156:159]
  v_mfma_f32_16x16x32_bf16 v[184:187], a[148:151], v[60:63], v[184:187]
  s_waitcnt lgkmcnt(3)
  ds_read_b64_tr_b16 v[46:47], v19 offset:25088
  v_mul_f32 v240, s66, v240
  v_mfma_f32_16x16x32_bf16 v[188:191], a[212:215], v[60:63], v[188:191]
  v_mul_f32 v241, s66, v241
  v_cvt_pk_bf16_f32 v72, v240, v241
  v_mfma_f32_16x16x32_bf16 v[128:131], a[24:27], v[32:35], v[128:131]
  ds_read_b64_tr_b16 v[48:49], v16 offset:28672
  v_mul_f32 v242, s66, v242
  v_mfma_f32_16x16x32_bf16 v[132:135], a[88:91], v[32:35], v[132:135]
  v_mul_f32 v243, s66, v243
  v_cvt_pk_bf16_f32 v73, v242, v243
  v_mfma_f32_16x16x32_bf16 v[160:163], a[152:155], v[32:35], v[160:163]
  ds_read_b64_tr_b16 v[50:51], v16 offset:29184
  v_mul_f32 v244, s66, v244
  v_mfma_f32_16x16x32_bf16 v[164:167], a[216:219], v[32:35], v[164:167]
  v_mul_f32 v245, s66, v245
  v_cvt_pk_bf16_f32 v74, v244, v245
  v_mfma_f32_16x16x32_bf16 v[136:139], a[24:27], v[36:39], v[136:139]
  s_bfe_u32 s67, s59, 0x30018
  ds_read_b64_tr_b16 v[52:53], v17 offset:28672
  v_mul_f32 v246, s66, v246
  v_mfma_f32_16x16x32_bf16 v[140:143], a[88:91], v[36:39], v[140:143]
  s_mov_b64 s[48:49], s[12:13]
  v_mul_f32 v247, s66, v247
  v_cvt_pk_bf16_f32 v75, v246, v247
  v_mfma_f32_16x16x32_bf16 v[168:171], a[152:155], v[36:39], v[168:171]
  s_waitcnt lgkmcnt(3)
  s_cmp_eq_u32 s67, 1
  ds_read_b64_tr_b16 v[54:55], v17 offset:29184
  v_mfma_f32_16x16x32_bf16 v[172:175], a[216:219], v[36:39], v[172:175]
  s_cselect_b64 s[48:49], s[14:15], s[48:49]
  v_mfma_f32_16x16x32_bf16 v[144:147], a[24:27], v[40:43], v[144:147]
  s_cmp_eq_u32 s67, 2
  ds_read_b64_tr_b16 v[56:57], v18 offset:28672
  v_mul_f32 v248, s66, v248
  v_mfma_f32_16x16x32_bf16 v[148:151], a[88:91], v[40:43], v[148:151]
  s_cselect_b64 s[48:49], s[16:17], s[48:49]
  buffer_store_dwordx4 v[72:75], v9, s[40:43], s65 offen offset:2048 sc1
  v_mul_f32 v249, s66, v249
  v_cvt_pk_bf16_f32 v76, v248, v249
  v_mfma_f32_16x16x32_bf16 v[176:179], a[152:155], v[40:43], v[176:179]
  s_cmp_eq_u32 s67, 3
  ds_read_b64_tr_b16 v[58:59], v18 offset:29184
  v_mul_f32 v250, s66, v250
  v_mfma_f32_16x16x32_bf16 v[180:183], a[216:219], v[40:43], v[180:183]
  s_cselect_b64 s[48:49], s[24:25], s[48:49]
  v_mul_f32 v251, s66, v251
  v_cvt_pk_bf16_f32 v77, v250, v251
  v_mfma_f32_16x16x32_bf16 v[152:155], a[24:27], v[44:47], v[152:155]
  s_waitcnt vmcnt(28)
  s_barrier
  ds_read_b64_tr_b16 v[60:61], v19 offset:28672
  v_mul_f32 v252, s66, v252
  v_mfma_f32_16x16x32_bf16 v[156:159], a[88:91], v[44:47], v[156:159]
  s_cmp_eq_u32 s67, 4
  s_cselect_b64 s[48:49], s[26:27], s[48:49]
  v_mul_f32 v253, s66, v253
  v_cvt_pk_bf16_f32 v78, v252, v253
  v_mfma_f32_16x16x32_bf16 v[184:187], a[152:155], v[44:47], v[184:187]
  s_waitcnt lgkmcnt(3)
  s_cmp_eq_u32 s67, 5
  ds_read_b64_tr_b16 v[62:63], v19 offset:29184
  v_mul_f32 v254, s66, v254
  v_mfma_f32_16x16x32_bf16 v[188:191], a[216:219], v[44:47], v[188:191]
  s_cselect_b64 s[48:49], s[28:29], s[48:49]
  v_mul_f32 v255, s66, v255
  v_cvt_pk_bf16_f32 v79, v254, v255
  v_mfma_f32_16x16x32_bf16 v[128:131], a[28:31], v[48:51], v[128:131]
  s_and_b32 s49, s49, 0xffff
  ds_read_b64_tr_b16 v[32:33], v16 offset:32768
  v_mfma_f32_16x16x32_bf16 v[132:135], a[92:95], v[48:51], v[132:135]
  s_bfe_u32 s67, s59, 0x50013
  v_mfma_f32_16x16x32_bf16 v[160:163], a[156:159], v[48:51], v[160:163]
  s_lshl_b32 s67, s67, 8
  ds_read_b64_tr_b16 v[34:35], v16 offset:33280
  v_mfma_f32_16x16x32_bf16 v[164:167], a[220:223], v[48:51], v[164:167]
  s_bfe_u32 s68, s59, 0x1000c
  buffer_store_dwordx4 v[76:79], v9, s[40:43], s65 offen offset:3072 sc1
  v_mfma_f32_16x16x32_bf16 v[136:139], a[28:31], v[52:55], v[136:139]
  s_lshl_b32 s68, s68, 7
  ds_read_b64_tr_b16 v[36:37], v17 offset:32768
  v_mfma_f32_16x16x32_bf16 v[140:143], a[92:95], v[52:55], v[140:143]
  s_or_b32 s62, s67, s68
  v_mfma_f32_16x16x32_bf16 v[168:171], a[156:159], v[52:55], v[168:171]
  s_waitcnt lgkmcnt(3)
  s_bitcmp1_b32 s59, 2
  ds_read_b64_tr_b16 v[38:39], v17 offset:33280
  v_mfma_f32_16x16x32_bf16 v[172:175], a[220:223], v[52:55], v[172:175]
  s_cselect_b32 s62, 0x40000000, s62
  v_mfma_f32_16x16x32_bf16 v[144:147], a[28:31], v[56:59], v[144:147]
  ds_read_b64_tr_b16 v[40:41], v18 offset:32768
  v_mfma_f32_16x16x32_bf16 v[148:151], a[92:95], v[56:59], v[148:151]
  v_mfma_f32_16x16x32_bf16 v[176:179], a[156:159], v[56:59], v[176:179]
  ds_read_b64_tr_b16 v[42:43], v18 offset:33280
  v_mfma_f32_16x16x32_bf16 v[180:183], a[220:223], v[56:59], v[180:183]
  v_mfma_f32_16x16x32_bf16 v[152:155], a[28:31], v[60:63], v[152:155]
  ds_read_b64_tr_b16 v[44:45], v19 offset:32768
  v_mfma_f32_16x16x32_bf16 v[156:159], a[92:95], v[60:63], v[156:159]
  v_mfma_f32_16x16x32_bf16 v[184:187], a[156:159], v[60:63], v[184:187]
  s_waitcnt lgkmcnt(3)
  ds_read_b64_tr_b16 v[46:47], v19 offset:33280
  v_mfma_f32_16x16x32_bf16 v[188:191], a[220:223], v[60:63], v[188:191]
  v_mfma_f32_16x16x32_bf16 v[128:131], a[32:35], v[32:35], v[128:131]
  s_add_u32 m0, s64, 0
  ds_read_b64_tr_b16 v[48:49], v16 offset:36864
  v_mfma_f32_16x16x32_bf16 v[132:135], a[96:99], v[32:35], v[132:135]
  v_mfma_f32_16x16x32_bf16 v[160:163], a[160:163], v[32:35], v[160:163]
  s_add_u32 s63, s62, 0
  ds_read_b64_tr_b16 v[50:51], v16 offset:37376
  v_mfma_f32_16x16x32_bf16 v[164:167], a[224:227], v[32:35], v[164:167]
  buffer_load_dwordx4 v2, s[48:51], s63 offen lds
  v_mfma_f32_16x16x32_bf16 v[136:139], a[32:35], v[36:39], v[136:139]
  ds_read_b64_tr_b16 v[52:53], v17 offset:36864
  v_mfma_f32_16x16x32_bf16 v[140:143], a[96:99], v[36:39], v[140:143]
  v_mfma_f32_16x16x32_bf16 v[168:171], a[160:163], v[36:39], v[168:171]
  s_waitcnt lgkmcnt(3)
  ds_read_b64_tr_b16 v[54:55], v17 offset:37376
  v_mfma_f32_16x16x32_bf16 v[172:175], a[224:227], v[36:39], v[172:175]
  v_mfma_f32_16x16x32_bf16 v[144:147], a[32:35], v[40:43], v[144:147]
  s_add_u32 m0, s64, 1024
  ds_read_b64_tr_b16 v[56:57], v18 offset:36864
  v_mfma_f32_16x16x32_bf16 v[148:151], a[96:99], v[40:43], v[148:151]
  v_mfma_f32_16x16x32_bf16 v[176:179], a[160:163], v[40:43], v[176:179]
  s_add_u32 s63, s62, 65536
  ds_read_b64_tr_b16 v[58:59], v18 offset:37376
  v_mfma_f32_16x16x32_bf16 v[180:183], a[224:227], v[40:43], v[180:183]
  buffer_load_dwordx4 v3, s[48:51], s63 offen lds
  v_mfma_f32_16x16x32_bf16 v[152:155], a[32:35], v[44:47], v[152:155]
  ds_read_b64_tr_b16 v[60:61], v19 offset:36864
  v_mfma_f32_16x16x32_bf16 v[156:159], a[96:99], v[44:47], v[156:159]
  v_mfma_f32_16x16x32_bf16 v[184:187], a[160:163], v[44:47], v[184:187]
  s_waitcnt lgkmcnt(3)
  ds_read_b64_tr_b16 v[62:63], v19 offset:37376
  v_mfma_f32_16x16x32_bf16 v[188:191], a[224:227], v[44:47], v[188:191]
  v_mfma_f32_16x16x32_bf16 v[128:131], a[36:39], v[48:51], v[128:131]
  s_add_u32 m0, s64, 2048
  ds_read_b64_tr_b16 v[32:33], v16 offset:40960
  v_mfma_f32_16x16x32_bf16 v[132:135], a[100:103], v[48:51], v[132:135]
  v_mfma_f32_16x16x32_bf16 v[160:163], a[164:167], v[48:51], v[160:163]
  s_add_u32 s63, s62, 131072
  ds_read_b64_tr_b16 v[34:35], v16 offset:41472
  v_mfma_f32_16x16x32_bf16 v[164:167], a[228:231], v[48:51], v[164:167]
  buffer_load_dwordx4 v2, s[48:51], s63 offen lds
  v_mfma_f32_16x16x32_bf16 v[136:139], a[36:39], v[52:55], v[136:139]
  ds_read_b64_tr_b16 v[36:37], v17 offset:40960
  v_mfma_f32_16x16x32_bf16 v[140:143], a[100:103], v[52:55], v[140:143]
  v_mfma_f32_16x16x32_bf16 v[168:171], a[164:167], v[52:55], v[168:171]
  s_waitcnt lgkmcnt(3)
  ds_read_b64_tr_b16 v[38:39], v17 offset:41472
  v_mfma_f32_16x16x32_bf16 v[172:175], a[228:231], v[52:55], v[172:175]
  v_mfma_f32_16x16x32_bf16 v[144:147], a[36:39], v[56:59], v[144:147]
  s_add_u32 m0, s64, 3072
  ds_read_b64_tr_b16 v[40:41], v18 offset:40960
  v_mfma_f32_16x16x32_bf16 v[148:151], a[100:103], v[56:59], v[148:151]
  v_mfma_f32_16x16x32_bf16 v[176:179], a[164:167], v[56:59], v[176:179]
  s_add_u32 s63, s62, 196608
  ds_read_b64_tr_b16 v[42:43], v18 offset:41472
  v_mfma_f32_16x16x32_bf16 v[180:183], a[228:231], v[56:59], v[180:183]
  buffer_load_dwordx4 v3, s[48:51], s63 offen lds
  v_mfma_f32_16x16x32_bf16 v[152:155], a[36:39], v[60:63], v[152:155]
  ds_read_b64_tr_b16 v[44:45], v19 offset:40960
  v_mfma_f32_16x16x32_bf16 v[156:159], a[100:103], v[60:63], v[156:159]
  v_mfma_f32_16x16x32_bf16 v[184:187], a[164:167], v[60:63], v[184:187]
  s_waitcnt lgkmcnt(3)
  ds_read_b64_tr_b16 v[46:47], v19 offset:41472
  v_mfma_f32_16x16x32_bf16 v[188:191], a[228:231], v[60:63], v[188:191]
  v_mfma_f32_16x16x32_bf16 v[128:131], a[40:43], v[32:35], v[128:131]
  ds_read_b64_tr_b16 v[48:49], v16 offset:45056
  v_mfma_f32_16x16x32_bf16 v[132:135], a[104:107], v[32:35], v[132:135]
  v_mfma_f32_16x16x32_bf16 v[160:163], a[168:171], v[32:35], v[160:163]
  ds_read_b64_tr_b16 v[50:51], v16 offset:45568
  v_mfma_f32_16x16x32_bf16 v[164:167], a[232:235], v[32:35], v[164:167]
  v_mfma_f32_16x16x32_bf16 v[136:139], a[40:43], v[36:39], v[136:139]
  ds_read_b64_tr_b16 v[52:53], v17 offset:45056
  v_mfma_f32_16x16x32_bf16 v[140:143], a[104:107], v[36:39], v[140:143]
  v_mfma_f32_16x16x32_bf16 v[168:171], a[168:171], v[36:39], v[168:171]
  s_waitcnt lgkmcnt(3)
  ds_read_b64_tr_b16 v[54:55], v17 offset:45568
  v_mfma_f32_16x16x32_bf16 v[172:175], a[232:235], v[36:39], v[172:175]
  v_mfma_f32_16x16x32_bf16 v[144:147], a[40:43], v[40:43], v[144:147]
  ds_read_b64_tr_b16 v[56:57], v18 offset:45056
  v_mfma_f32_16x16x32_bf16 v[148:151], a[104:107], v[40:43], v[148:151]
  v_mfma_f32_16x16x32_bf16 v[176:179], a[168:171], v[40:43], v[176:179]
  ds_read_b64_tr_b16 v[58:59], v18 offset:45568
  v_mfma_f32_16x16x32_bf16 v[180:183], a[232:235], v[40:43], v[180:183]
  v_mfma_f32_16x16x32_bf16 v[152:155], a[40:43], v[44:47], v[152:155]
  s_waitcnt vmcnt(28)
  ds_read_b64_tr_b16 v[60:61], v19 offset:45056
  v_mfma_f32_16x16x32_bf16 v[156:159], a[104:107], v[44:47], v[156:159]
  s_barrier
  v_mfma_f32_16x16x32_bf16 v[184:187], a[168:171], v[44:47], v[184:187]
  s_waitcnt lgkmcnt(3)
  ds_read_b64_tr_b16 v[62:63], v19 offset:45568
  v_mfma_f32_16x16x32_bf16 v[188:191], a[232:235], v[44:47], v[188:191]
  v_mfma_f32_16x16x32_bf16 v[128:131], a[44:47], v[48:51], v[128:131]
  ds_read_b64_tr_b16 v[32:33], v16 offset:49152
  v_mfma_f32_16x16x32_bf16 v[132:135], a[108:111], v[48:51], v[132:135]
  v_mfma_f32_16x16x32_bf16 v[160:163], a[172:175], v[48:51], v[160:163]
  ds_read_b64_tr_b16 v[34:35], v16 offset:49664
  v_mfma_f32_16x16x32_bf16 v[164:167], a[236:239], v[48:51], v[164:167]
  v_mfma_f32_16x16x32_bf16 v[136:139], a[44:47], v[52:55], v[136:139]
  ds_read_b64_tr_b16 v[36:37], v17 offset:49152
  v_mfma_f32_16x16x32_bf16 v[140:143], a[108:111], v[52:55], v[140:143]
  v_mfma_f32_16x16x32_bf16 v[168:171], a[172:175], v[52:55], v[168:171]
  s_waitcnt lgkmcnt(3)
  ds_read_b64_tr_b16 v[38:39], v17 offset:49664
  v_mfma_f32_16x16x32_bf16 v[172:175], a[236:239], v[52:55], v[172:175]
  v_mfma_f32_16x16x32_bf16 v[144:147], a[44:47], v[56:59], v[144:147]
  ds_read_b64_tr_b16 v[40:41], v18 offset:49152
  v_mfma_f32_16x16x32_bf16 v[148:151], a[108:111], v[56:59], v[148:151]
  v_mfma_f32_16x16x32_bf16 v[176:179], a[172:175], v[56:59], v[176:179]
  ds_read_b64_tr_b16 v[42:43], v18 offset:49664
  v_mfma_f32_16x16x32_bf16 v[180:183], a[236:239], v[56:59], v[180:183]
  v_mfma_f32_16x16x32_bf16 v[152:155], a[44:47], v[60:63], v[152:155]
  ds_read_b64_tr_b16 v[44:45], v19 offset:49152
  v_mfma_f32_16x16x32_bf16 v[156:159], a[108:111], v[60:63], v[156:159]
  v_mfma_f32_16x16x32_bf16 v[184:187], a[172:175], v[60:63], v[184:187]
  s_waitcnt lgkmcnt(3)
  ds_read_b64_tr_b16 v[46:47], v19 offset:49664
  v_mfma_f32_16x16x32_bf16 v[188:191], a[236:239], v[60:63], v[188:191]
  v_mfma_f32_16x16x32_bf16 v[128:131], a[48:51], v[32:35], v[128:131]
  s_add_u32 m0, s64, 16384
  ds_read_b64_tr_b16 v[48:49], v16 offset:53248
  v_mfma_f32_16x16x32_bf16 v[132:135], a[112:115], v[32:35], v[132:135]
  v_mfma_f32_16x16x32_bf16 v[160:163], a[176:179], v[32:35], v[160:163]
  s_add_u32 s63, s62, 1048576
  ds_read_b64_tr_b16 v[50:51], v16 offset:53760
  v_mfma_f32_16x16x32_bf16 v[164:167], a[240:243], v[32:35], v[164:167]
  buffer_load_dwordx4 v2, s[48:51], s63 offen lds
  v_mfma_f32_16x16x32_bf16 v[136:139], a[48:51], v[36:39], v[136:139]
  ds_read_b64_tr_b16 v[52:53], v17 offset:53248
  v_mfma_f32_16x16x32_bf16 v[140:143], a[112:115], v[36:39], v[140:143]
  v_mfma_f32_16x16x32_bf16 v[168:171], a[176:179], v[36:39], v[168:171]
  s_waitcnt lgkmcnt(3)
  ds_read_b64_tr_b16 v[54:55], v17 offset:53760
  v_mfma_f32_16x16x32_bf16 v[172:175], a[240:243], v[36:39], v[172:175]
  v_mfma_f32_16x16x32_bf16 v[144:147], a[48:51], v[40:43], v[144:147]
  s_add_u32 m0, s64, 17408
  ds_read_b64_tr_b16 v[56:57], v18 offset:53248
  v_mfma_f32_16x16x32_bf16 v[148:151], a[112:115], v[40:43], v[148:151]
  v_mfma_f32_16x16x32_bf16 v[176:179], a[176:179], v[40:43], v[176:179]
  s_add_u32 s63, s62, 1114112
  ds_read_b64_tr_b16 v[58:59], v18 offset:53760
  v_mfma_f32_16x16x32_bf16 v[180:183], a[240:243], v[40:43], v[180:183]
  buffer_load_dwordx4 v3, s[48:51], s63 offen lds
  v_mfma_f32_16x16x32_bf16 v[152:155], a[48:51], v[44:47], v[152:155]
  ds_read_b64_tr_b16 v[60:61], v19 offset:53248
  v_mfma_f32_16x16x32_bf16 v[156:159], a[112:115], v[44:47], v[156:159]
  v_mfma_f32_16x16x32_bf16 v[184:187], a[176:179], v[44:47], v[184:187]
  s_waitcnt lgkmcnt(3)
  ds_read_b64_tr_b16 v[62:63], v19 offset:53760
  v_mfma_f32_16x16x32_bf16 v[188:191], a[240:243], v[44:47], v[188:191]
  v_mfma_f32_16x16x32_bf16 v[128:131], a[52:55], v[48:51], v[128:131]
  s_add_u32 m0, s64, 18432
  ds_read_b64_tr_b16 v[32:33], v16 offset:57344
  v_mfma_f32_16x16x32_bf16 v[132:135], a[116:119], v[48:51], v[132:135]
  v_mfma_f32_16x16x32_bf16 v[160:163], a[180:183], v[48:51], v[160:163]
  s_add_u32 s63, s62, 1179648
  ds_read_b64_tr_b16 v[34:35], v16 offset:57856
  v_mfma_f32_16x16x32_bf16 v[164:167], a[244:247], v[48:51], v[164:167]
  buffer_load_dwordx4 v2, s[48:51], s63 offen lds
  v_mfma_f32_16x16x32_bf16 v[136:139], a[52:55], v[52:55], v[136:139]
  ds_read_b64_tr_b16 v[36:37], v17 offset:57344
  v_mfma_f32_16x16x32_bf16 v[140:143], a[116:119], v[52:55], v[140:143]
  v_mfma_f32_16x16x32_bf16 v[168:171], a[180:183], v[52:55], v[168:171]
  s_waitcnt lgkmcnt(3)
  ds_read_b64_tr_b16 v[38:39], v17 offset:57856
  v_mfma_f32_16x16x32_bf16 v[172:175], a[244:247], v[52:55], v[172:175]
  v_mfma_f32_16x16x32_bf16 v[144:147], a[52:55], v[56:59], v[144:147]
  s_add_u32 m0, s64, 19456
  ds_read_b64_tr_b16 v[40:41], v18 offset:57344
  v_mfma_f32_16x16x32_bf16 v[148:151], a[116:119], v[56:59], v[148:151]
  v_mfma_f32_16x16x32_bf16 v[176:179], a[180:183], v[56:59], v[176:179]
  s_add_u32 s63, s62, 1245184
  ds_read_b64_tr_b16 v[42:43], v18 offset:57856
  v_mfma_f32_16x16x32_bf16 v[180:183], a[244:247], v[56:59], v[180:183]
  buffer_load_dwordx4 v3, s[48:51], s63 offen lds
  v_mfma_f32_16x16x32_bf16 v[152:155], a[52:55], v[60:63], v[152:155]
  ds_read_b64_tr_b16 v[44:45], v19 offset:57344
  v_mfma_f32_16x16x32_bf16 v[156:159], a[116:119], v[60:63], v[156:159]
  v_mfma_f32_16x16x32_bf16 v[184:187], a[180:183], v[60:63], v[184:187]
  s_waitcnt lgkmcnt(3)
  ds_read_b64_tr_b16 v[46:47], v19 offset:57856
  v_mfma_f32_16x16x32_bf16 v[188:191], a[244:247], v[60:63], v[188:191]
  v_mfma_f32_16x16x32_bf16 v[128:131], a[56:59], v[32:35], v[128:131]
  ds_read_b64_tr_b16 v[48:49], v16 offset:61440
  v_mfma_f32_16x16x32_bf16 v[132:135], a[120:123], v[32:35], v[132:135]
  v_mfma_f32_16x16x32_bf16 v[160:163], a[184:187], v[32:35], v[160:163]
  ds_read_b64_tr_b16 v[50:51], v16 offset:61952
  v_mfma_f32_16x16x32_bf16 v[164:167], a[248:251], v[32:35], v[164:167]
  v_mfma_f32_16x16x32_bf16 v[136:139], a[56:59], v[36:39], v[136:139]
  ds_read_b64_tr_b16 v[52:53], v17 offset:61440
  v_mfma_f32_16x16x32_bf16 v[140:143], a[120:123], v[36:39], v[140:143]
  v_mfma_f32_16x16x32_bf16 v[168:171], a[184:187], v[36:39], v[168:171]
  s_waitcnt lgkmcnt(3)
  ds_read_b64_tr_b16 v[54:55], v17 offset:61952
  v_mfma_f32_16x16x32_bf16 v[172:175], a[248:251], v[36:39], v[172:175]
  v_mfma_f32_16x16x32_bf16 v[144:147], a[56:59], v[40:43], v[144:147]
  ds_read_b64_tr_b16 v[56:57], v18 offset:61440
  v_mfma_f32_16x16x32_bf16 v[148:151], a[120:123], v[40:43], v[148:151]
  v_mfma_f32_16x16x32_bf16 v[176:179], a[184:187], v[40:43], v[176:179]
  ds_read_b64_tr_b16 v[58:59], v18 offset:61952
  v_mfma_f32_16x16x32_bf16 v[180:183], a[248:251], v[40:43], v[180:183]
  v_mfma_f32_16x16x32_bf16 v[152:155], a[56:59], v[44:47], v[152:155]
  s_waitcnt vmcnt(28)
  ds_read_b64_tr_b16 v[60:61], v19 offset:61440
  v_mfma_f32_16x16x32_bf16 v[156:159], a[120:123], v[44:47], v[156:159]
  s_barrier
  v_mfma_f32_16x16x32_bf16 v[184:187], a[184:187], v[44:47], v[184:187]
  s_waitcnt lgkmcnt(3)
  ds_read_b64_tr_b16 v[62:63], v19 offset:61952
  v_mfma_f32_16x16x32_bf16 v[188:191], a[248:251], v[44:47], v[188:191]
  v_mfma_f32_16x16x32_bf16 v[128:131], a[60:63], v[48:51], v[128:131]
  s_mov_b32 s61, s60
  ds_read_b64_tr_b16 v[32:33], v20 offset:0
  v_mfma_f32_16x16x32_bf16 v[132:135], a[124:127], v[48:51], v[132:135]
  s_mov_b32 s60, s57
  v_mfma_f32_16x16x32_bf16 v[160:163], a[188:191], v[48:51], v[160:163]
  s_mov_b32 s57, s58
  ds_read_b64_tr_b16 v[34:35], v20 offset:512
  v_mfma_f32_16x16x32_bf16 v[164:167], a[252:255], v[48:51], v[164:167]
  s_mov_b32 s58, s59
  v_mfma_f32_16x16x32_bf16 v[136:139], a[60:63], v[52:55], v[136:139]
  s_add_u32 s56, s56, 1
  ds_read_b64_tr_b16 v[36:37], v21 offset:0
  v_mfma_f32_16x16x32_bf16 v[140:143], a[124:127], v[52:55], v[140:143]
  v_mfma_f32_16x16x32_bf16 v[168:171], a[188:191], v[52:55], v[168:171]
  s_waitcnt lgkmcnt(3)
  ds_read_b64_tr_b16 v[38:39], v21 offset:512
  v_mfma_f32_16x16x32_bf16 v[172:175], a[252:255], v[52:55], v[172:175]
  v_mfma_f32_16x16x32_bf16 v[144:147], a[60:63], v[56:59], v[144:147]
  ds_read_b64_tr_b16 v[40:41], v22 offset:0
  v_mfma_f32_16x16x32_bf16 v[148:151], a[124:127], v[56:59], v[148:151]
  v_mfma_f32_16x16x32_bf16 v[176:179], a[188:191], v[56:59], v[176:179]
  ds_read_b64_tr_b16 v[42:43], v22 offset:512
  v_mfma_f32_16x16x32_bf16 v[180:183], a[252:255], v[56:59], v[180:183]
  v_mfma_f32_16x16x32_bf16 v[152:155], a[60:63], v[60:63], v[152:155]
  ds_read_b64_tr_b16 v[44:45], v23 offset:0
  v_mfma_f32_16x16x32_bf16 v[156:159], a[124:127], v[60:63], v[156:159]
  v_mfma_f32_16x16x32_bf16 v[184:187], a[188:191], v[60:63], v[184:187]
  s_waitcnt lgkmcnt(3)
  ds_read_b64_tr_b16 v[46:47], v23 offset:512
  v_mfma_f32_16x16x32_bf16 v[188:191], a[252:255], v[60:63], v[188:191]
  s_bitcmp1_b32 s57, 2
  s_cbranch_scc1 L_p_done_0
  s_bitcmp1_b32 s57, 0
  s_cbranch_scc1 L_p_body_1_1
  s_branch L_p_body_1_0
L_p_body_1_0:
  v_mfma_f32_16x16x32_bf16 v[192:195], v[32:35], a[0:3], 0
  s_add_u32 m0, s64, 32768
  ds_read_b64_tr_b16 v[48:49], v20 offset:4096
  v_mfma_f32_16x16x32_bf16 v[200:203], v[32:35], a[64:67], 0
  v_mfma_f32_16x16x32_bf16 v[224:227], v[32:35], a[128:131], 0
  s_add_u32 s63, s62, 2097152
  ds_read_b64_tr_b16 v[50:51], v20 offset:4608
  v_mfma_f32_16x16x32_bf16 v[232:235], v[32:35], a[192:195], 0
  buffer_load_dwordx4 v2, s[48:51], s63 offen lds
  v_mfma_f32_16x16x32_bf16 v[196:199], v[36:39], a[0:3], 0
  s_and_b32 s65, s60, 0x7fff000
  s_bitcmp1_b32 s60, 2
  s_cselect_b32 s65, 0x40000000, s65
  ds_read_b64_tr_b16 v[52:53], v21 offset:4096
  v_mfma_f32_16x16x32_bf16 v[204:207], v[36:39], a[64:67], 0
  s_bitcmp1_b32 s60, 1
  s_cselect_b32 s66, 0x3e0293ee, 1.0
  v_mfma_f32_16x16x32_bf16 v[228:231], v[36:39], a[128:131], 0
  s_waitcnt lgkmcnt(3)
  ds_read_b64_tr_b16 v[54:55], v21 offset:4608
  v_mfma_f32_16x16x32_bf16 v[236:239], v[36:39], a[192:195], 0
  v_mfma_f32_16x16x32_bf16 v[208:211], v[40:43], a[0:3], 0
  s_add_u32 m0, s64, 33792
  ds_read_b64_tr_b16 v[56:57], v22 offset:4096
  v_mfma_f32_16x16x32_bf16 v[216:219], v[40:43], a[64:67], 0
  v_mfma_f32_16x16x32_bf16 v[240:243], v[40:43], a[128:131], 0
  s_add_u32 s63, s62, 2162688
  ds_read_b64_tr_b16 v[58:59], v22 offset:4608
  v_mul_f32 v128, s66, v128
  v_mfma_f32_16x16x32_bf16 v[248:251], v[40:43], a[192:195], 0
  buffer_load_dwordx4 v3, s[48:51], s63 offen lds
  v_mul_f32 v129, s66, v129
  v_cvt_pk_bf16_f32 v64, v128, v129
  v_mfma_f32_16x16x32_bf16 v[212:215], v[44:47], a[0:3], 0
  ds_read_b64_tr_b16 v[60:61], v23 offset:4096
  v_mul_f32 v130, s66, v130
  v_mfma_f32_16x16x32_bf16 v[220:223], v[44:47], a[64:67], 0
  v_mul_f32 v131, s66, v131
  v_cvt_pk_bf16_f32 v65, v130, v131
  v_mfma_f32_16x16x32_bf16 v[244:247], v[44:47], a[128:131], 0
  s_waitcnt lgkmcnt(3)
  ds_read_b64_tr_b16 v[62:63], v23 offset:4608
  v_mul_f32 v132, s66, v132
  v_mfma_f32_16x16x32_bf16 v[252:255], v[44:47], a[192:195], 0
  v_mul_f32 v133, s66, v133
  v_cvt_pk_bf16_f32 v66, v132, v133
  v_mfma_f32_16x16x32_bf16 v[192:195], v[48:51], a[4:7], v[192:195]
  s_add_u32 m0, s64, 34816
  ds_read_b64_tr_b16 v[32:33], v20 offset:8192
  v_readlane_b32 s59, v1, s56
  v_mfma_f32_16x16x32_bf16 v[200:203], v[48:51], a[68:71], v[200:203]
  v_mul_f32 v134, s66, v134
  v_mul_f32 v135, s66, v135
  v_cvt_pk_bf16_f32 v67, v134, v135
  v_mfma_f32_16x16x32_bf16 v[224:227], v[48:51], a[132:135], v[224:227]
  s_add_u32 s63, s62, 2228224
  ds_read_b64_tr_b16 v[34:35], v20 offset:8704
  v_mfma_f32_16x16x32_bf16 v[232:235], v[48:51], a[196:199], v[232:235]
  buffer_load_dwordx4 v2, s[48:51], s63 offen lds
  v_mfma_f32_16x16x32_bf16 v[196:199], v[52:55], a[4:7], v[196:199]
  ds_read_b64_tr_b16 v[36:37], v21 offset:8192
  v_mul_f32 v136, s66, v136
  v_mfma_f32_16x16x32_bf16 v[204:207], v[52:55], a[68:71], v[204:207]
  buffer_store_dwordx4 v[64:67], v8, s[40:43], s65 offen offset:0 sc1
  v_mul_f32 v137, s66, v137
  v_cvt_pk_bf16_f32 v68, v136, v137
  v_mfma_f32_16x16x32_bf16 v[228:231], v[52:55], a[132:135], v[228:231]
  s_waitcnt lgkmcnt(3)
  ds_read_b64_tr_b16 v[38:39], v21 offset:8704
  v_mul_f32 v138, s66, v138
  v_mfma_f32_16x16x32_bf16 v[236:239], v[52:55], a[196:199], v[236:239]
  v_mul_f32 v139, s66, v139
  v_cvt_pk_bf16_f32 v69, v138, v139
  v_mfma_f32_16x16x32_bf16 v[208:211], v[56:59], a[4:7], v[208:211]
  s_add_u32 m0, s64, 35840
  ds_read_b64_tr_b16 v[40:41], v22 offset:8192
  v_mul_f32 v140, s66, v140
  v_mfma_f32_16x16x32_bf16 v[216:219], v[56:59], a[68:71], v[216:219]
  v_mul_f32 v141, s66, v141
  v_cvt_pk_bf16_f32 v70, v140, v141
  v_mfma_f32_16x16x32_bf16 v[240:243], v[56:59], a[132:135], v[240:243]
  s_add_u32 s63, s62, 2293760
  ds_read_b64_tr_b16 v[42:43], v22 offset:8704
  v_mul_f32 v142, s66, v142
  v_mfma_f32_16x16x32_bf16 v[248:251], v[56:59], a[196:199], v[248:251]
  buffer_load_dwordx4 v3, s[48:51], s63 offen lds
  v_mul_f32 v143, s66, v143
  v_cvt_pk_bf16_f32 v71, v142, v143
  v_mfma_f32_16x16x32_bf16 v[212:215], v[60:63], a[4:7], v[212:215]
  ds_read_b64_tr_b16 v[44:45], v23 offset:8192
  v_mfma_f32_16x16x32_bf16 v[220:223], v[60:63], a[68:71], v[220:223]
  v_mfma_f32_16x16x32_bf16 v[244:247], v[60:63], a[132:135], v[244:247]
  s_waitcnt lgkmcnt(3)
  ds_read_b64_tr_b16 v[46:47], v23 offset:8704
  v_mfma_f32_16x16x32_bf16 v[252:255], v[60:63], a[196:199], v[252:255]
  buffer_store_dwordx4 v[68:71], v8, s[40:43], s65 offen offset:1024 sc1
  v_mfma_f32_16x16x32_bf16 v[192:195], v[32:35], a[8:11], v[192:195]
  s_bfe_u32 s67, s61, 0x50013
  ds_read_b64_tr_b16 v[48:49], v20 offset:12288
  v_mfma_f32_16x16x32_bf16 v[200:203], v[32:35], a[72:75], v[200:203]
  s_lshl_b32 s67, s67, 7
  v_mfma_f32_16x16x32_bf16 v[224:227], v[32:35], a[136:139], v[224:227]
  s_bfe_u32 s68, s61, 0x20004
  ds_read_b64_tr_b16 v[50:51], v20 offset:12800
  v_mfma_f32_16x16x32_bf16 v[232:235], v[32:35], a[200:203], v[232:235]
  s_lshl_b32 s68, s68, 5
  v_mfma_f32_16x16x32_bf16 v[196:199], v[36:39], a[8:11], v[196:199]
  s_or_b32 s69, s67, s68
  ds_read_b64_tr_b16 v[52:53], v21 offset:12288
  v_mfma_f32_16x16x32_bf16 v[204:207], v[36:39], a[72:75], v[204:207]
  s_bitcmp1_b32 s61, 2
  v_mfma_f32_16x16x32_bf16 v[228:231], v[36:39], a[136:139], v[228:231]
  s_waitcnt lgkmcnt(3)
  ds_read_b64_tr_b16 v[54:55], v21 offset:12800
  v_mul_f32 v144, s66, v144
  v_mfma_f32_16x16x32_bf16 v[236:239], v[36:39], a[200:203], v[236:239]
  s_cselect_b32 s69, 0x40000000, s69
  v_mul_f32 v145, s66, v145
  v_cvt_pk_bf16_f32 v72, v144, v145
  v_mfma_f32_16x16x32_bf16 v[208:211], v[40:43], a[8:11], v[208:211]
  ds_read_b64_tr_b16 v[56:57], v22 offset:12288
  v_mul_f32 v146, s66, v146
  v_mfma_f32_16x16x32_bf16 v[216:219], v[40:43], a[72:75], v[216:219]
  v_mul_f32 v147, s66, v147
  v_cvt_pk_bf16_f32 v73, v146, v147
  v_mfma_f32_16x16x32_bf16 v[240:243], v[40:43], a[136:139], v[240:243]
  ds_read_b64_tr_b16 v[58:59], v22 offset:12800
  v_mul_f32 v148, s66, v148
  v_mfma_f32_16x16x32_bf16 v[248:251], v[40:43], a[200:203], v[248:251]
  v_mul_f32 v149, s66, v149
  v_cvt_pk_bf16_f32 v74, v148, v149
  v_mfma_f32_16x16x32_bf16 v[212:215], v[44:47], a[8:11], v[212:215]
  s_waitcnt vmcnt(14)
  ds_read_b64_tr_b16 v[60:61], v23 offset:12288
  v_mul_f32 v150, s66, v150
  v_mfma_f32_16x16x32_bf16 v[220:223], v[44:47], a[72:75], v[220:223]
  s_barrier
  v_mul_f32 v151, s66, v151
  v_cvt_pk_bf16_f32 v75, v150, v151
  v_mfma_f32_16x16x32_bf16 v[244:247], v[44:47], a[136:139], v[244:247]
  s_waitcnt lgkmcnt(3)
  ds_read_b64_tr_b16 v[62:63], v23 offset:12800
  v_mfma_f32_16x16x32_bf16 v[252:255], v[44:47], a[200:203], v[252:255]
  buffer_atomic_add v11, v10, s[40:43], s69 offen
  v_mfma_f32_16x16x32_bf16 v[192:195], v[48:51], a[12:15], v[192:195]
  ds_read_b64_tr_b16 v[32:33], v20 offset:16384
  v_mul_f32 v152, s66, v152
  v_mfma_f32_16x16x32_bf16 v[200:203], v[48:51], a[76:79], v[200:203]
  buffer_store_dwordx4 v[72:75], v8, s[40:43], s65 offen offset:2048 sc1
  v_mul_f32 v153, s66, v153
  v_cvt_pk_bf16_f32 v76, v152, v153
  v_mfma_f32_16x16x32_bf16 v[224:227], v[48:51], a[140:143], v[224:227]
  ds_read_b64_tr_b16 v[34:35], v20 offset:16896
  v_mul_f32 v154, s66, v154
  v_mfma_f32_16x16x32_bf16 v[232:235], v[48:51], a[204:207], v[232:235]
  v_mul_f32 v155, s66, v155
  v_cvt_pk_bf16_f32 v77, v154, v155
  v_mfma_f32_16x16x32_bf16 v[196:199], v[52:55], a[12:15], v[196:199]
  ds_read_b64_tr_b16 v[36:37], v21 offset:16384
  v_mul_f32 v156, s66, v156
  v_mfma_f32_16x16x32_bf16 v[204:207], v[52:55], a[76:79], v[204:207]
  v_mul_f32 v157, s66, v157
  v_cvt_pk_bf16_f32 v78, v156, v157
  v_mfma_f32_16x16x32_bf16 v[228:231], v[52:55], a[140:143], v[228:231]
  s_waitcnt lgkmcnt(3)
  ds_read_b64_tr_b16 v[38:39], v21 offset:16896
  v_mul_f32 v158, s66, v158
  v_mfma_f32_16x16x32_bf16 v[236:239], v[52:55], a[204:207], v[236:239]
  v_mul_f32 v159, s66, v159
  v_cvt_pk_bf16_f32 v79, v158, v159
  v_mfma_f32_16x16x32_bf16 v[208:211], v[56:59], a[12:15], v[208:211]
  ds_read_b64_tr_b16 v[40:41], v22 offset:16384
  v_mfma_f32_16x16x32_bf16 v[216:219], v[56:59], a[76:79], v[216:219]
  v_mfma_f32_16x16x32_bf16 v[240:243], v[56:59], a[140:143], v[240:243]
  ds_read_b64_tr_b16 v[42:43], v22 offset:16896
  v_mfma_f32_16x16x32_bf16 v[248:251], v[56:59], a[204:207], v[248:251]
  buffer_store_dwordx4 v[76:79], v8, s[40:43], s65 offen offset:3072 sc1
  v_mfma_f32_16x16x32_bf16 v[212:215], v[60:63], a[12:15], v[212:215]
  ds_read_b64_tr_b16 v[44:45], v23 offset:16384
  v_mfma_f32_16x16x32_bf16 v[220:223], v[60:63], a[76:79], v[220:223]
  v_mfma_f32_16x16x32_bf16 v[244:247], v[60:63], a[140:143], v[244:247]
  s_waitcnt lgkmcnt(3)
  ds_read_b64_tr_b16 v[46:47], v23 offset:16896
  v_mfma_f32_16x16x32_bf16 v[252:255], v[60:63], a[204:207], v[252:255]
  v_mfma_f32_16x16x32_bf16 v[192:195], v[32:35], a[16:19], v[192:195]
  s_add_u32 m0, s64, 49152
  ds_read_b64_tr_b16 v[48:49], v20 offset:20480
  v_mfma_f32_16x16x32_bf16 v[200:203], v[32:35], a[80:83], v[200:203]
  v_mfma_f32_16x16x32_bf16 v[224:227], v[32:35], a[144:147], v[224:227]
  s_add_u32 s63, s62, 3145728
  ds_read_b64_tr_b16 v[50:51], v20 offset:20992
  v_mul_f32 v160, s66, v160
  v_mfma_f32_16x16x32_bf16 v[232:235], v[32:35], a[208:211], v[232:235]
  buffer_load_dwordx4 v2, s[48:51], s63 offen lds
  v_mul_f32 v161, s66, v161
  v_cvt_pk_bf16_f32 v64, v160, v161
  v_mfma_f32_16x16x32_bf16 v[196:199], v[36:39], a[16:19], v[196:199]
  ds_read_b64_tr_b16 v[52:53], v21 offset:20480
  v_mul_f32 v162, s66, v162
  v_mfma_f32_16x16x32_bf16 v[204:207], v[36:39], a[80:83], v[204:207]
  v_mul_f32 v163, s66, v163
  v_cvt_pk_bf16_f32 v65, v162, v163
  v_mfma_f32_16x16x32_bf16 v[228:231], v[36:39], a[144:147], v[228:231]
  s_waitcnt lgkmcnt(3)
  ds_read_b64_tr_b16 v[54:55], v21 offset:20992
  v_mul_f32 v164, s66, v164
  v_mfma_f32_16x16x32_bf16 v[236:239], v[36:39], a[208:211], v[236:239]
  v_mul_f32 v165, s66, v165
  v_cvt_pk_bf16_f32 v66, v164, v165
  v_mfma_f32_16x16x32_bf16 v[208:211], v[40:43], a[16:19], v[208:211]
  s_add_u32 m0, s64, 50176
  ds_read_b64_tr_b16 v[56:57], v22 offset:20480
  v_mul_f32 v166, s66, v166
  v_mfma_f32_16x16x32_bf16 v[216:219], v[40:43], a[80:83], v[216:219]
  v_mul_f32 v167, s66, v167
  v_cvt_pk_bf16_f32 v67, v166, v167
  v_mfma_f32_16x16x32_bf16 v[240:243], v[40:43], a[144:147], v[240:243]
  s_add_u32 s63, s62, 3211264
  ds_read_b64_tr_b16 v[58:59], v22 offset:20992
  v_mfma_f32_16x16x32_bf16 v[248:251], v[40:43], a[208:211], v[248:251]
  buffer_load_dwordx4 v3, s[48:51], s63 offen lds
  v_mfma_f32_16x16x32_bf16 v[212:215], v[44:47], a[16:19], v[212:215]
  ds_read_b64_tr_b16 v[60:61], v23 offset:20480
  v_mul_f32 v168, s66, v168
  v_mfma_f32_16x16x32_bf16 v[220:223], v[44:47], a[80:83], v[220:223]
  buffer_store_dwordx4 v[64:67], v9, s[40:43], s65 offen offset:0 sc1
  v_mul_f32 v169, s66, v169
  v_cvt_pk_bf16_f32 v68, v168, v169
  v_mfma_f32_16x16x32_bf16 v[244:247], v[44:47], a[144:147], v[244:247]
  s_waitcnt lgkmcnt(3)
  ds_read_b64_tr_b16 v[62:63], v23 offset:20992
  v_mul_f32 v170, s66, v170
  v_mfma_f32_16x16x32_bf16 v[252:255], v[44:47], a[208:211], v[252:255]
  v_mul_f32 v171, s66, v171
  v_cvt_pk_bf16_f32 v69, v170, v171
  v_mfma_f32_16x16x32_bf16 v[192:195], v[48:51], a[20:23], v[192:195]
  s_add_u32 m0, s64, 51200
  ds_read_b64_tr_b16 v[32:33], v20 offset:24576
  v_mul_f32 v172, s66, v172
  v_mfma_f32_16x16x32_bf16 v[200:203], v[48:51], a[84:87], v[200:203]
  v_mul_f32 v173, s66, v173
  v_cvt_pk_bf16_f32 v70, v172, v173
  v_mfma_f32_16x16x32_bf16 v[224:227], v[48:51], a[148:151], v[224:227]
  s_add_u32 s63, s62, 3276800
  ds_read_b64_tr_b16 v[34:35], v20 offset:25088
  v_mul_f32 v174, s66, v174
  v_mfma_f32_16x16x32_bf16 v[232:235], v[48:51], a[212:215], v[232:235]
  buffer_load_dwordx4 v2, s[48:51], s63 offen lds
  v_mul_f32 v175, s66, v175
  v_cvt_pk_bf16_f32 v71, v174, v175
  v_mfma_f32_16x16x32_bf16 v[196:199], v[52:55], a[20:23], v[196:199]
  ds_read_b64_tr_b16 v[36:37], v21 offset:24576
  v_mfma_f32_16x16x32_bf16 v[204:207], v[52:55], a[84:87], v[204:207]
  v_mfma_f32_16x16x32_bf16 v[228:231], v[52:55], a[148:151], v[228:231]
  s_waitcnt lgkmcnt(3)
  ds_read_b64_tr_b16 v[38:39], v21 offset:25088
  v_mfma_f32_16x16x32_bf16 v[236:239], v[52:55], a[212:215], v[236:239]
  buffer_store_dwordx4 v[68:71], v9, s[40:43], s65 offen offset:1024 sc1
  v_mfma_f32_16x16x32_bf16 v[208:211], v[56:59], a[20:23], v[208:211]
  s_add_u32 m0, s64, 52224
  ds_read_b64_tr_b16 v[40:41], v22 offset:24576
  v_mfma_f32_16x16x32_bf16 v[216:219], v[56:59], a[84:87], v[216:219]
  v_mfma_f32_16x16x32_bf16 v[240:243], v[56:59], a[148:151], v[240:243]
  s_add_u32 s63, s62, 3342336
  ds_read_b64_tr_b16 v[42:43], v22 offset:25088
  v_mfma_f32_16x16x32_bf16 v[248:251], v[56:59], a[212:215], v[248:251]
  buffer_load_dwordx4 v3, s[48:51], s63 offen lds
  v_mfma_f32_16x16x32_bf16 v[212:215], v[60:63], a[20:23], v[212:215]
  ds_read_b64_tr_b16 v[44:45], v23 offset:24576
  v_mfma_f32_16x16x32_bf16 v[220:223], v[60:63], a[84:87], v[220:223]
  v_mfma_f32_16x16x32_bf16 v[244:247], v[60:63], a[148:151], v[244:247]
  s_waitcnt lgkmcnt(3)
  ds_read_b64_tr_b16 v[46:47], v23 offset:25088
  v_mul_f32 v176, s66, v176
  v_mfma_f32_16x16x32_bf16 v[252:255], v[60:63], a[212:215], v[252:255]
  v_mul_f32 v177, s66, v177
  v_cvt_pk_bf16_f32 v72, v176, v177
  v_mfma_f32_16x16x32_bf16 v[192:195], v[32:35], a[24:27], v[192:195]
  ds_read_b64_tr_b16 v[48:49], v20 offset:28672
  v_mul_f32 v178, s66, v178
  v_mfma_f32_16x16x32_bf16 v[200:203], v[32:35], a[88:91], v[200:203]
  v_mul_f32 v179, s66, v179
  v_cvt_pk_bf16_f32 v73, v178, v179
  v_mfma_f32_16x16x32_bf16 v[224:227], v[32:35], a[152:155], v[224:227]
  ds_read_b64_tr_b16 v[50:51], v20 offset:29184
  v_mul_f32 v180, s66, v180
  v_mfma_f32_16x16x32_bf16 v[232:235], v[32:35], a[216:219], v[232:235]
  v_mul_f32 v181, s66, v181
  v_cvt_pk_bf16_f32 v74, v180, v181
  v_mfma_f32_16x16x32_bf16 v[196:199], v[36:39], a[24:27], v[196:199]
  s_bfe_u32 s67, s59, 0x30018
  ds_read_b64_tr_b16 v[52:53], v21 offset:28672
  v_mul_f32 v182, s66, v182
  v_mfma_f32_16x16x32_bf16 v[204:207], v[36:39], a[88:91], v[204:207]
  s_mov_b64 s[48:49], s[12:13]
  v_mul_f32 v183, s66, v183
  v_cvt_pk_bf16_f32 v75, v182, v183
  v_mfma_f32_16x16x32_bf16 v[228:231], v[36:39], a[152:155], v[228:231]
  s_waitcnt lgkmcnt(3)
  s_cmp_eq_u32 s67, 1
  ds_read_b64_tr_b16 v[54:55], v21 offset:29184
  v_mfma_f32_16x16x32_bf16 v[236:239], v[36:39], a[216:219], v[236:239]
  s_cselect_b64 s[48:49], s[14:15], s[48:49]
  v_mfma_f32_16x16x32_bf16 v[208:211], v[40:43], a[24:27], v[208:211]
  s_cmp_eq_u32 s67, 2
  ds_read_b64_tr_b16 v[56:57], v22 offset:28672
  v_mul_f32 v184, s66, v184
  v_mfma_f32_16x16x32_bf16 v[216:219], v[40:43], a[88:91], v[216:219]
  s_cselect_b64 s[48:49], s[16:17], s[48:49]
  buffer_store_dwordx4 v[72:75], v9, s[40:43], s65 offen offset:2048 sc1
  v_mul_f32 v185, s66, v185
  v_cvt_pk_bf16_f32 v76, v184, v185
  v_mfma_f32_16x16x32_bf16 v[240:243], v[40:43], a[152:155], v[240:243]
  s_cmp_eq_u32 s67, 3
  ds_read_b64_tr_b16 v[58:59], v22 offset:29184
  v_mul_f32 v186, s66, v186
  v_mfma_f32_16x16x32_bf16 v[248:251], v[40:43], a[216:219], v[248:251]
  s_cselect_b64 s[48:49], s[24:25], s[48:49]
  v_mul_f32 v187, s66, v187
  v_cvt_pk_bf16_f32 v77, v186, v187
  v_mfma_f32_16x16x32_bf16 v[212:215], v[44:47], a[24:27], v[212:215]
  s_waitcnt vmcnt(28)
  s_barrier
  ds_read_b64_tr_b16 v[60:61], v23 offset:28672
  v_mul_f32 v188, s66, v188
  v_mfma_f32_16x16x32_bf16 v[220:223], v[44:47], a[88:91], v[220:223]
  s_cmp_eq_u32 s67, 4
  s_cselect_b64 s[48:49], s[26:27], s[48:49]
  v_mul_f32 v189, s66, v189
  v_cvt_pk_bf16_f32 v78, v188, v189
  v_mfma_f32_16x16x32_bf16 v[244:247], v[44:47], a[152:155], v[244:247]
  s_waitcnt lgkmcnt(3)
  s_cmp_eq_u32 s67, 5
  ds_read_b64_tr_b16 v[62:63], v23 offset:29184
  v_mul_f32 v190, s66, v190
  v_mfma_f32_16x16x32_bf16 v[252:255], v[44:47], a[216:219], v[252:255]
  s_cselect_b64 s[48:49], s[28:29], s[48:49]
  v_mul_f32 v191, s66, v191
  v_cvt_pk_bf16_f32 v79, v190, v191
  v_mfma_f32_16x16x32_bf16 v[192:195], v[48:51], a[28:31], v[192:195]
  s_and_b32 s49, s49, 0xffff
  ds_read_b64_tr_b16 v[32:33], v20 offset:32768
  v_mfma_f32_16x16x32_bf16 v[200:203], v[48:51], a[92:95], v[200:203]
  s_bfe_u32 s67, s59, 0x50013
  v_mfma_f32_16x16x32_bf16 v[224:227], v[48:51], a[156:159], v[224:227]
  s_lshl_b32 s67, s67, 8
  ds_read_b64_tr_b16 v[34:35], v20 offset:33280
  v_mfma_f32_16x16x32_bf16 v[232:235], v[48:51], a[220:223], v[232:235]
  s_bfe_u32 s68, s59, 0x1000c
  buffer_store_dwordx4 v[76:79], v9, s[40:43], s65 offen offset:3072 sc1
  v_mfma_f32_16x16x32_bf16 v[196:199], v[52:55], a[28:31], v[196:199]
  s_lshl_b32 s68, s68, 7
  ds_read_b64_tr_b16 v[36:37], v21 offset:32768
  v_mfma_f32_16x16x32_bf16 v[204:207], v[52:55], a[92:95], v[204:207]
  s_or_b32 s62, s67, s68
  v_mfma_f32_16x16x32_bf16 v[228:231], v[52:55], a[156:159], v[228:231]
  s_waitcnt lgkmcnt(3)
  s_bitcmp1_b32 s59, 2
  ds_read_b64_tr_b16 v[38:39], v21 offset:33280
  v_mfma_f32_16x16x32_bf16 v[236:239], v[52:55], a[220:223], v[236:239]
  s_cselect_b32 s62, 0x40000000, s62
  v_mfma_f32_16x16x32_bf16 v[208:211], v[56:59], a[28:31], v[208:211]
  ds_read_b64_tr_b16 v[40:41], v22 offset:32768
  v_mfma_f32_16x16x32_bf16 v[216:219], v[56:59], a[92:95], v[216:219]
  v_mfma_f32_16x16x32_bf16 v[240:243], v[56:59], a[156:159], v[240:243]
  ds_read_b64_tr_b16 v[42:43], v22 offset:33280
  v_mfma_f32_16x16x32_bf16 v[248:251], v[56:59], a[220:223], v[248:251]
  v_mfma_f32_16x16x32_bf16 v[212:215], v[60:63], a[28:31], v[212:215]
  ds_read_b64_tr_b16 v[44:45], v23 offset:32768
  v_mfma_f32_16x16x32_bf16 v[220:223], v[60:63], a[92:95], v[220:223]
  v_mfma_f32_16x16x32_bf16 v[244:247], v[60:63], a[156:159], v[244:247]
  s_waitcnt lgkmcnt(3)
  ds_read_b64_tr_b16 v[46:47], v23 offset:33280
  v_mfma_f32_16x16x32_bf16 v[252:255], v[60:63], a[220:223], v[252:255]
  v_mfma_f32_16x16x32_bf16 v[192:195], v[32:35], a[32:35], v[192:195]
  s_add_u32 m0, s64, 65536
  ds_read_b64_tr_b16 v[48:49], v20 offset:36864
  v_mfma_f32_16x16x32_bf16 v[200:203], v[32:35], a[96:99], v[200:203]
  v_mfma_f32_16x16x32_bf16 v[224:227], v[32:35], a[160:163], v[224:227]
  s_add_u32 s63, s62, 0
  ds_read_b64_tr_b16 v[50:51], v20 offset:37376
  v_mfma_f32_16x16x32_bf16 v[232:235], v[32:35], a[224:227], v[232:235]
  buffer_load_dwordx4 v2, s[48:51], s63 offen lds
  v_mfma_f32_16x16x32_bf16 v[196:199], v[36:39], a[32:35], v[196:199]
  ds_read_b64_tr_b16 v[52:53], v21 offset:36864
  v_mfma_f32_16x16x32_bf16 v[204:207], v[36:39], a[96:99], v[204:207]
  v_mfma_f32_16x16x32_bf16 v[228:231], v[36:39], a[160:163], v[228:231]
  s_waitcnt lgkmcnt(3)
  ds_read_b64_tr_b16 v[54:55], v21 offset:37376
  v_mfma_f32_16x16x32_bf16 v[236:239], v[36:39], a[224:227], v[236:239]
  v_mfma_f32_16x16x32_bf16 v[208:211], v[40:43], a[32:35], v[208:211]
  s_add_u32 m0, s64, 66560
  ds_read_b64_tr_b16 v[56:57], v22 offset:36864
  v_mfma_f32_16x16x32_bf16 v[216:219], v[40:43], a[96:99], v[216:219]
  v_mfma_f32_16x16x32_bf16 v[240:243], v[40:43], a[160:163], v[240:243]
  s_add_u32 s63, s62, 65536
  ds_read_b64_tr_b16 v[58:59], v22 offset:37376
  v_mfma_f32_16x16x32_bf16 v[248:251], v[40:43], a[224:227], v[248:251]
  buffer_load_dwordx4 v3, s[48:51], s63 offen lds
  v_mfma_f32_16x16x32_bf16 v[212:215], v[44:47], a[32:35], v[212:215]
  ds_read_b64_tr_b16 v[60:61], v23 offset:36864
  v_mfma_f32_16x16x32_bf16 v[220:223], v[44:47], a[96:99], v[220:223]
  v_mfma_f32_16x16x32_bf16 v[244:247], v[44:47], a[160:163], v[244:247]
  s_waitcnt lgkmcnt(3)
  ds_read_b64_tr_b16 v[62:63], v23 offset:37376
  v_mfma_f32_16x16x32_bf16 v[252:255], v[44:47], a[224:227], v[252:255]
  v_mfma_f32_16x16x32_bf16 v[192:195], v[48:51], a[36:39], v[192:195]
  s_add_u32 m0, s64, 67584
  ds_read_b64_tr_b16 v[32:33], v20 offset:40960
  v_mfma_f32_16x16x32_bf16 v[200:203], v[48:51], a[100:103], v[200:203]
  v_mfma_f32_16x16x32_bf16 v[224:227], v[48:51], a[164:167], v[224:227]
  s_add_u32 s63, s62, 131072
  ds_read_b64_tr_b16 v[34:35], v20 offset:41472
  v_mfma_f32_16x16x32_bf16 v[232:235], v[48:51], a[228:231], v[232:235]
  buffer_load_dwordx4 v2, s[48:51], s63 offen lds
  v_mfma_f32_16x16x32_bf16 v[196:199], v[52:55], a[36:39], v[196:199]
  ds_read_b64_tr_b16 v[36:37], v21 offset:40960
  v_mfma_f32_16x16x32_bf16 v[204:207], v[52:55], a[100:103], v[204:207]
  v_mfma_f32_16x16x32_bf16 v[228:231], v[52:55], a[164:167], v[228:231]
  s_waitcnt lgkmcnt(3)
  ds_read_b64_tr_b16 v[38:39], v21 offset:41472
  v_mfma_f32_16x16x32_bf16 v[236:239], v[52:55], a[228:231], v[236:239]
  v_mfma_f32_16x16x32_bf16 v[208:211], v[56:59], a[36:39], v[208:211]
  s_add_u32 m0, s64, 68608
  ds_read_b64_tr_b16 v[40:41], v22 offset:40960
  v_mfma_f32_16x16x32_bf16 v[216:219], v[56:59], a[100:103], v[216:219]
  v_mfma_f32_16x16x32_bf16 v[240:243], v[56:59], a[164:167], v[240:243]
  s_add_u32 s63, s62, 196608
  ds_read_b64_tr_b16 v[42:43], v22 offset:41472
  v_mfma_f32_16x16x32_bf16 v[248:251], v[56:59], a[228:231], v[248:251]
  buffer_load_dwordx4 v3, s[48:51], s63 offen lds
  v_mfma_f32_16x16x32_bf16 v[212:215], v[60:63], a[36:39], v[212:215]
  ds_read_b64_tr_b16 v[44:45], v23 offset:40960
  v_mfma_f32_16x16x32_bf16 v[220:223], v[60:63], a[100:103], v[220:223]
  v_mfma_f32_16x16x32_bf16 v[244:247], v[60:63], a[164:167], v[244:247]
  s_waitcnt lgkmcnt(3)
  ds_read_b64_tr_b16 v[46:47], v23 offset:41472
  v_mfma_f32_16x16x32_bf16 v[252:255], v[60:63], a[228:231], v[252:255]
  v_mfma_f32_16x16x32_bf16 v[192:195], v[32:35], a[40:43], v[192:195]
  ds_read_b64_tr_b16 v[48:49], v20 offset:45056
  v_mfma_f32_16x16x32_bf16 v[200:203], v[32:35], a[104:107], v[200:203]
  v_mfma_f32_16x16x32_bf16 v[224:227], v[32:35], a[168:171], v[224:227]
  ds_read_b64_tr_b16 v[50:51], v20 offset:45568
  v_mfma_f32_16x16x32_bf16 v[232:235], v[32:35], a[232:235], v[232:235]
  v_mfma_f32_16x16x32_bf16 v[196:199], v[36:39], a[40:43], v[196:199]
  ds_read_b64_tr_b16 v[52:53], v21 offset:45056
  v_mfma_f32_16x16x32_bf16 v[204:207], v[36:39], a[104:107], v[204:207]
  v_mfma_f32_16x16x32_bf16 v[228:231], v[36:39], a[168:171], v[228:231]
  s_waitcnt lgkmcnt(3)
  ds_read_b64_tr_b16 v[54:55], v21 offset:45568
  v_mfma_f32_16x16x32_bf16 v[236:239], v[36:39], a[232:235], v[236:239]
  v_mfma_f32_16x16x32_bf16 v[208:211], v[40:43], a[40:43], v[208:211]
  ds_read_b64_tr_b16 v[56:57], v22 offset:45056
  v_mfma_f32_16x16x32_bf16 v[216:219], v[40:43], a[104:107], v[216:219]
  v_mfma_f32_16x16x32_bf16 v[240:243], v[40:43], a[168:171], v[240:243]
  ds_read_b64_tr_b16 v[58:59], v22 offset:45568
  v_mfma_f32_16x16x32_bf16 v[248:251], v[40:43], a[232:235], v[248:251]
  v_mfma_f32_16x16x32_bf16 v[212:215], v[44:47], a[40:43], v[212:215]
  s_waitcnt vmcnt(28)
  ds_read_b64_tr_b16 v[60:61], v23 offset:45056
  v_mfma_f32_16x16x32_bf16 v[220:223], v[44:47], a[104:107], v[220:223]
  s_barrier
  v_mfma_f32_16x16x32_bf16 v[244:247], v[44:47], a[168:171], v[244:247]
  s_waitcnt lgkmcnt(3)
  ds_read_b64_tr_b16 v[62:63], v23 offset:45568
  v_mfma_f32_16x16x32_bf16 v[252:255], v[44:47], a[232:235], v[252:255]
  v_mfma_f32_16x16x32_bf16 v[192:195], v[48:51], a[44:47], v[192:195]
  ds_read_b64_tr_b16 v[32:33], v20 offset:49152
  v_mfma_f32_16x16x32_bf16 v[200:203], v[48:51], a[108:111], v[200:203]
  v_mfma_f32_16x16x32_bf16 v[224:227], v[48:51], a[172:175], v[224:227]
  ds_read_b64_tr_b16 v[34:35], v20 offset:49664
  v_mfma_f32_16x16x32_bf16 v[232:235], v[48:51], a[236:239], v[232:235]
  v_mfma_f32_16x16x32_bf16 v[196:199], v[52:55], a[44:47], v[196:199]
  ds_read_b64_tr_b16 v[36:37], v21 offset:49152
  v_mfma_f32_16x16x32_bf16 v[204:207], v[52:55], a[108:111], v[204:207]
  v_mfma_f32_16x16x32_bf16 v[228:231], v[52:55], a[172:175], v[228:231]
  s_waitcnt lgkmcnt(3)
  ds_read_b64_tr_b16 v[38:39], v21 offset:49664
  v_mfma_f32_16x16x32_bf16 v[236:239], v[52:55], a[236:239], v[236:239]
  v_mfma_f32_16x16x32_bf16 v[208:211], v[56:59], a[44:47], v[208:211]
  ds_read_b64_tr_b16 v[40:41], v22 offset:49152
  v_mfma_f32_16x16x32_bf16 v[216:219], v[56:59], a[108:111], v[216:219]
  v_mfma_f32_16x16x32_bf16 v[240:243], v[56:59], a[172:175], v[240:243]
  ds_read_b64_tr_b16 v[42:43], v22 offset:49664
  v_mfma_f32_16x16x32_bf16 v[248:251], v[56:59], a[236:239], v[248:251]
  v_mfma_f32_16x16x32_bf16 v[212:215], v[60:63], a[44:47], v[212:215]
  ds_read_b64_tr_b16 v[44:45], v23 offset:49152
  v_mfma_f32_16x16x32_bf16 v[220:223], v[60:63], a[108:111], v[220:223]
  v_mfma_f32_16x16x32_bf16 v[244:247], v[60:63], a[172:175], v[244:247]
  s_waitcnt lgkmcnt(3)
  ds_read_b64_tr_b16 v[46:47], v23 offset:49664
  v_mfma_f32_16x16x32_bf16 v[252:255], v[60:63], a[236:239], v[252:255]
  v_mfma_f32_16x16x32_bf16 v[192:195], v[32:35], a[48:51], v[192:195]
  s_add_u32 m0, s64, 81920
  ds_read_b64_tr_b16 v[48:49], v20 offset:53248
  v_mfma_f32_16x16x32_bf16 v[200:203], v[32:35], a[112:115], v[200:203]
  v_mfma_f32_16x16x32_bf16 v[224:227], v[32:35], a[176:179], v[224:227]
  s_add_u32 s63, s62, 1048576
  ds_read_b64_tr_b16 v[50:51], v20 offset:53760
  v_mfma_f32_16x16x32_bf16 v[232:235], v[32:35], a[240:243], v[232:235]
  buffer_load_dwordx4 v2, s[48:51], s63 offen lds
  v_mfma_f32_16x16x32_bf16 v[196:199], v[36:39], a[48:51], v[196:199]
  ds_read_b64_tr_b16 v[52:53], v21 offset:53248
  v_mfma_f32_16x16x32_bf16 v[204:207], v[36:39], a[112:115], v[204:207]
  v_mfma_f32_16x16x32_bf16 v[228:231], v[36:39], a[176:179], v[228:231]
  s_waitcnt lgkmcnt(3)
  ds_read_b64_tr_b16 v[54:55], v21 offset:53760
  v_mfma_f32_16x16x32_bf16 v[236:239], v[36:39], a[240:243], v[236:239]
  v_mfma_f32_16x16x32_bf16 v[208:211], v[40:43], a[48:51], v[208:211]
  s_add_u32 m0, s64, 82944
  ds_read_b64_tr_b16 v[56:57], v22 offset:53248
  v_mfma_f32_16x16x32_bf16 v[216:219], v[40:43], a[112:115], v[216:219]
  v_mfma_f32_16x16x32_bf16 v[240:243], v[40:43], a[176:179], v[240:243]
  s_add_u32 s63, s62, 1114112
  ds_read_b64_tr_b16 v[58:59], v22 offset:53760
  v_mfma_f32_16x16x32_bf16 v[248:251], v[40:43], a[240:243], v[248:251]
  buffer_load_dwordx4 v3, s[48:51], s63 offen lds
  v_mfma_f32_16x16x32_bf16 v[212:215], v[44:47], a[48:51], v[212:215]
  ds_read_b64_tr_b16 v[60:61], v23 offset:53248
  v_mfma_f32_16x16x32_bf16 v[220:223], v[44:47], a[112:115], v[220:223]
  v_mfma_f32_16x16x32_bf16 v[244:247], v[44:47], a[176:179], v[244:247]
  s_waitcnt lgkmcnt(3)
  ds_read_b64_tr_b16 v[62:63], v23 offset:53760
  v_mfma_f32_16x16x32_bf16 v[252:255], v[44:47], a[240:243], v[252:255]
  v_mfma_f32_16x16x32_bf16 v[192:195], v[48:51], a[52:55], v[192:195]
  s_add_u32 m0, s64, 83968
  ds_read_b64_tr_b16 v[32:33], v20 offset:57344
  v_mfma_f32_16x16x32_bf16 v[200:203], v[48:51], a[116:119], v[200:203]
  v_mfma_f32_16x16x32_bf16 v[224:227], v[48:51], a[180:183], v[224:227]
  s_add_u32 s63, s62, 1179648
  ds_read_b64_tr_b16 v[34:35], v20 offset:57856
  v_mfma_f32_16x16x32_bf16 v[232:235], v[48:51], a[244:247], v[232:235]
  buffer_load_dwordx4 v2, s[48:51], s63 offen lds
  v_mfma_f32_16x16x32_bf16 v[196:199], v[52:55], a[52:55], v[196:199]
  ds_read_b64_tr_b16 v[36:37], v21 offset:57344
  v_mfma_f32_16x16x32_bf16 v[204:207], v[52:55], a[116:119], v[204:207]
  v_mfma_f32_16x16x32_bf16 v[228:231], v[52:55], a[180:183], v[228:231]
  s_waitcnt lgkmcnt(3)
  ds_read_b64_tr_b16 v[38:39], v21 offset:57856
  v_mfma_f32_16x16x32_bf16 v[236:239], v[52:55], a[244:247], v[236:239]
  v_mfma_f32_16x16x32_bf16 v[208:211], v[56:59], a[52:55], v[208:211]
  s_add_u32 m0, s64, 84992
  ds_read_b64_tr_b16 v[40:41], v22 offset:57344
  v_mfma_f32_16x16x32_bf16 v[216:219], v[56:59], a[116:119], v[216:219]
  v_mfma_f32_16x16x32_bf16 v[240:243], v[56:59], a[180:183], v[240:243]
  s_add_u32 s63, s62, 1245184
  ds_read_b64_tr_b16 v[42:43], v22 offset:57856
  v_mfma_f32_16x16x32_bf16 v[248:251], v[56:59], a[244:247], v[248:251]
  buffer_load_dwordx4 v3, s[48:51], s63 offen lds
  v_mfma_f32_16x16x32_bf16 v[212:215], v[60:63], a[52:55], v[212:215]
  ds_read_b64_tr_b16 v[44:45], v23 offset:57344
  v_mfma_f32_16x16x32_bf16 v[220:223], v[60:63], a[116:119], v[220:223]
  v_mfma_f32_16x16x32_bf16 v[244:247], v[60:63], a[180:183], v[244:247]
  s_waitcnt lgkmcnt(3)
  ds_read_b64_tr_b16 v[46:47], v23 offset:57856
  v_mfma_f32_16x16x32_bf16 v[252:255], v[60:63], a[244:247], v[252:255]
  v_mfma_f32_16x16x32_bf16 v[192:195], v[32:35], a[56:59], v[192:195]
  ds_read_b64_tr_b16 v[48:49], v20 offset:61440
  v_mfma_f32_16x16x32_bf16 v[200:203], v[32:35], a[120:123], v[200:203]
  v_mfma_f32_16x16x32_bf16 v[224:227], v[32:35], a[184:187], v[224:227]
  ds_read_b64_tr_b16 v[50:51], v20 offset:61952
  v_mfma_f32_16x16x32_bf16 v[232:235], v[32:35], a[248:251], v[232:235]
  v_mfma_f32_16x16x32_bf16 v[196:199], v[36:39], a[56:59], v[196:199]
  ds_read_b64_tr_b16 v[52:53], v21 offset:61440
  v_mfma_f32_16x16x32_bf16 v[204:207], v[36:39], a[120:123], v[204:207]
  v_mfma_f32_16x16x32_bf16 v[228:231], v[36:39], a[184:187], v[228:231]
  s_waitcnt lgkmcnt(3)
  ds_read_b64_tr_b16 v[54:55], v21 offset:61952
  v_mfma_f32_16x16x32_bf16 v[236:239], v[36:39], a[248:251], v[236:239]
  v_mfma_f32_16x16x32_bf16 v[208:211], v[40:43], a[56:59], v[208:211]
  ds_read_b64_tr_b16 v[56:57], v22 offset:61440
  v_mfma_f32_16x16x32_bf16 v[216:219], v[40:43], a[120:123], v[216:219]
  v_mfma_f32_16x16x32_bf16 v[240:243], v[40:43], a[184:187], v[240:243]
  ds_read_b64_tr_b16 v[58:59], v22 offset:61952
  v_mfma_f32_16x16x32_bf16 v[248:251], v[40:43], a[248:251], v[248:251]
  v_mfma_f32_16x16x32_bf16 v[212:215], v[44:47], a[56:59], v[212:215]
  s_waitcnt vmcnt(28)
  ds_read_b64_tr_b16 v[60:61], v23 offset:61440
  v_mfma_f32_16x16x32_bf16 v[220:223], v[44:47], a[120:123], v[220:223]
  s_barrier
  v_mfma_f32_16x16x32_bf16 v[244:247], v[44:47], a[184:187], v[244:247]
  s_waitcnt lgkmcnt(3)
  ds_read_b64_tr_b16 v[62:63], v23 offset:61952
  v_mfma_f32_16x16x32_bf16 v[252:255], v[44:47], a[248:251], v[252:255]
  v_mfma_f32_16x16x32_bf16 v[192:195], v[48:51], a[60:63], v[192:195]
  s_mov_b32 s61, s60
  ds_read_b64_tr_b16 v[32:33], v16 offset:0
  v_mfma_f32_16x16x32_bf16 v[200:203], v[48:51], a[124:127], v[200:203]
  s_mov_b32 s60, s57
  v_mfma_f32_16x16x32_bf16 v[224:227], v[48:51], a[188:191], v[224:227]
  s_mov_b32 s57, s58
  ds_read_b64_tr_b16 v[34:35], v16 offset:512
  v_mfma_f32_16x16x32_bf16 v[232:235], v[48:51], a[252:255], v[232:235]
  s_mov_b32 s58, s59
  v_mfma_f32_16x16x32_bf16 v[196:199], v[52:55], a[60:63], v[196:199]
  s_add_u32 s56, s56, 1
  ds_read_b64_tr_b16 v[36:37], v17 offset:0
  v_mfma_f32_16x16x32_bf16 v[204:207], v[52:55], a[124:127], v[204:207]
  v_mfma_f32_16x16x32_bf16 v[228:231], v[52:55], a[188:191], v[228:231]
  s_waitcnt lgkmcnt(3)
  ds_read_b64_tr_b16 v[38:39], v17 offset:512
  v_mfma_f32_16x16x32_bf16 v[236:239], v[52:55], a[252:255], v[236:239]
  v_mfma_f32_16x16x32_bf16 v[208:211], v[56:59], a[60:63], v[208:211]
  ds_read_b64_tr_b16 v[40:41], v18 offset:0
  v_mfma_f32_16x16x32_bf16 v[216:219], v[56:59], a[124:127], v[216:219]
  v_mfma_f32_16x16x32_bf16 v[240:243], v[56:59], a[188:191], v[240:243]
  ds_read_b64_tr_b16 v[42:43], v18 offset:512
  v_mfma_f32_16x16x32_bf16 v[248:251], v[56:59], a[252:255], v[248:251]
  v_mfma_f32_16x16x32_bf16 v[212:215], v[60:63], a[60:63], v[212:215]
  ds_read_b64_tr_b16 v[44:45], v19 offset:0
  v_mfma_f32_16x16x32_bf16 v[220:223], v[60:63], a[124:127], v[220:223]
  v_mfma_f32_16x16x32_bf16 v[244:247], v[60:63], a[188:191], v[244:247]
  s_waitcnt lgkmcnt(3)
  ds_read_b64_tr_b16 v[46:47], v19 offset:512
  v_mfma_f32_16x16x32_bf16 v[252:255], v[60:63], a[252:255], v[252:255]
  s_bitcmp1_b32 s57, 2
  s_cbranch_scc1 L_p_done_1
  s_bitcmp1_b32 s57, 0
  s_cbranch_scc1 L_p_body_0_1
  s_branch L_p_body_0_0
L_p_body_1_1:
  v_mfma_f32_16x16x32_bf16 v[192:195], a[0:3], v[32:35], 0
  s_add_u32 m0, s64, 32768
  ds_read_b64_tr_b16 v[48:49], v20 offset:4096
  v_mfma_f32_16x16x32_bf16 v[196:199], a[64:67], v[32:35], 0
  v_mfma_f32_16x16x32_bf16 v[224:227], a[128:131], v[32:35], 0
  s_add_u32 s63, s62, 2097152
  ds_read_b64_tr_b16 v[50:51], v20 offset:4608
  v_mfma_f32_16x16x32_bf16 v[228:231], a[192:195], v[32:35], 0
  buffer_load_dwordx4 v2, s[48:51], s63 offen lds
  v_mfma_f32_16x16x32_bf16 v[200:203], a[0:3], v[36:39], 0
  s_and_b32 s65, s60, 0x7fff000
  s_bitcmp1_b32 s60, 2
  s_cselect_b32 s65, 0x40000000, s65
  ds_read_b64_tr_b16 v[52:53], v21 offset:4096
  v_mfma_f32_16x16x32_bf16 v[204:207], a[64:67], v[36:39], 0
  s_bitcmp1_b32 s60, 1
  s_cselect_b32 s66, 0x3e0293ee, 1.0
  v_mfma_f32_16x16x32_bf16 v[232:235], a[128:131], v[36:39], 0
  s_waitcnt lgkmcnt(3)
  ds_read_b64_tr_b16 v[54:55], v21 offset:4608
  v_mfma_f32_16x16x32_bf16 v[236:239], a[192:195], v[36:39], 0
  v_mfma_f32_16x16x32_bf16 v[208:211], a[0:3], v[40:43], 0
  s_add_u32 m0, s64, 33792
  ds_read_b64_tr_b16 v[56:57], v22 offset:4096
  v_mfma_f32_16x16x32_bf16 v[212:215], a[64:67], v[40:43], 0
  v_mfma_f32_16x16x32_bf16 v[240:243], a[128:131], v[40:43], 0
  s_add_u32 s63, s62, 2162688
  ds_read_b64_tr_b16 v[58:59], v22 offset:4608
  v_mul_f32 v128, s66, v128
  v_mfma_f32_16x16x32_bf16 v[244:247], a[192:195], v[40:43], 0
  buffer_load_dwordx4 v3, s[48:51], s63 offen lds
  v_mul_f32 v129, s66, v129
  v_cvt_pk_bf16_f32 v64, v128, v129
  v_mfma_f32_16x16x32_bf16 v[216:219], a[0:3], v[44:47], 0
  ds_read_b64_tr_b16 v[60:61], v23 offset:4096
  v_mul_f32 v130, s66, v130
  v_mfma_f32_16x16x32_bf16 v[220:223], a[64:67], v[44:47], 0
  v_mul_f32 v131, s66, v131
  v_cvt_pk_bf16_f32 v65, v130, v131
  v_mfma_f32_16x16x32_bf16 v[248:251], a[128:131], v[44:47], 0
  s_waitcnt lgkmcnt(3)
  ds_read_b64_tr_b16 v[62:63], v23 offset:4608
  v_mul_f32 v132, s66, v132
  v_mfma_f32_16x16x32_bf16 v[252:255], a[192:195], v[44:47], 0
  v_mul_f32 v133, s66, v133
  v_cvt_pk_bf16_f32 v66, v132, v133
  v_mfma_f32_16x16x32_bf16 v[192:195], a[4:7], v[48:51], v[192:195]
  s_add_u32 m0, s64, 34816
  ds_read_b64_tr_b16 v[32:33], v20 offset:8192
  v_readlane_b32 s59, v1, s56
  v_mfma_f32_16x16x32_bf16 v[196:199], a[68:71], v[48:51], v[196:199]
  v_mul_f32 v134, s66, v134
  v_mul_f32 v135, s66, v135
  v_cvt_pk_bf16_f32 v67, v134, v135
  v_mfma_f32_16x16x32_bf16 v[224:227], a[132:135], v[48:51], v[224:227]
  s_add_u32 s63, s62, 2228224
  ds_read_b64_tr_b16 v[34:35], v20 offset:8704
  v_mfma_f32_16x16x32_bf16 v[228:231], a[196:199], v[48:51], v[228:231]
  buffer_load_dwordx4 v2, s[48:51], s63 offen lds
  v_mfma_f32_16x16x32_bf16 v[200:203], a[4:7], v[52:55], v[200:203]
  ds_read_b64_tr_b16 v[36:37], v21 offset:8192
  v_mul_f32 v136, s66, v136
  v_mfma_f32_16x16x32_bf16 v[204:207], a[68:71], v[52:55], v[204:207]
  buffer_store_dwordx4 v[64:67], v8, s[40:43], s65 offen offset:0 sc1
  v_mul_f32 v137, s66, v137
  v_cvt_pk_bf16_f32 v68, v136, v137
  v_mfma_f32_16x16x32_bf16 v[232:235], a[132:135], v[52:55], v[232:235]
  s_waitcnt lgkmcnt(3)
  ds_read_b64_tr_b16 v[38:39], v21 offset:8704
  v_mul_f32 v138, s66, v138
  v_mfma_f32_16x16x32_bf16 v[236:239], a[196:199], v[52:55], v[236:239]
  v_mul_f32 v139, s66, v139
  v_cvt_pk_bf16_f32 v69, v138, v139
  v_mfma_f32_16x16x32_bf16 v[208:211], a[4:7], v[56:59], v[208:211]
  s_add_u32 m0, s64, 35840
  ds_read_b64_tr_b16 v[40:41], v22 offset:8192
  v_mul_f32 v140, s66, v140
  v_mfma_f32_16x16x32_bf16 v[212:215], a[68:71], v[56:59], v[212:215]
  v_mul_f32 v141, s66, v141
  v_cvt_pk_bf16_f32 v70, v140, v141
  v_mfma_f32_16x16x32_bf16 v[240:243], a[132:135], v[56:59], v[240:243]
  s_add_u32 s63, s62, 2293760
  ds_read_b64_tr_b16 v[42:43], v22 offset:8704
  v_mul_f32 v142, s66, v142
  v_mfma_f32_16x16x32_bf16 v[244:247], a[196:199], v[56:59], v[244:247]
  buffer_load_dwordx4 v3, s[48:51], s63 offen lds
  v_mul_f32 v143, s66, v143
  v_cvt_pk_bf16_f32 v71, v142, v143
  v_mfma_f32_16x16x32_bf16 v[216:219], a[4:7], v[60:63], v[216:219]
  ds_read_b64_tr_b16 v[44:45], v23 offset:8192
  v_mfma_f32_16x16x32_bf16 v[220:223], a[68:71], v[60:63], v[220:223]
  v_mfma_f32_16x16x32_bf16 v[248:251], a[132:135], v[60:63], v[248:251]
  s_waitcnt lgkmcnt(3)
  ds_read_b64_tr_b16 v[46:47], v23 offset:8704
  v_mfma_f32_16x16x32_bf16 v[252:255], a[196:199], v[60:63], v[252:255]
  buffer_store_dwordx4 v[68:71], v8, s[40:43], s65 offen offset:1024 sc1
  v_mfma_f32_16x16x32_bf16 v[192:195], a[8:11], v[32:35], v[192:195]
  s_bfe_u32 s67, s61, 0x50013
  ds_read_b64_tr_b16 v[48:49], v20 offset:12288
  v_mfma_f32_16x16x32_bf16 v[196:199], a[72:75], v[32:35], v[196:199]
  s_lshl_b32 s67, s67, 7
  v_mfma_f32_16x16x32_bf16 v[224:227], a[136:139], v[32:35], v[224:227]
  s_bfe_u32 s68, s61, 0x20004
  ds_read_b64_tr_b16 v[50:51], v20 offset:12800
  v_mfma_f32_16x16x32_bf16 v[228:231], a[200:203], v[32:35], v[228:231]
  s_lshl_b32 s68, s68, 5
  v_mfma_f32_16x16x32_bf16 v[200:203], a[8:11], v[36:39], v[200:203]
  s_or_b32 s69, s67, s68
  ds_read_b64_tr_b16 v[52:53], v21 offset:12288
  v_mfma_f32_16x16x32_bf16 v[204:207], a[72:75], v[36:39], v[204:207]
  s_bitcmp1_b32 s61, 2
  v_mfma_f32_16x16x32_bf16 v[232:235], a[136:139], v[36:39], v[232:235]
  s_waitcnt lgkmcnt(3)
  ds_read_b64_tr_b16 v[54:55], v21 offset:12800
  v_mul_f32 v144, s66, v144
  v_mfma_f32_16x16x32_bf16 v[236:239], a[200:203], v[36:39], v[236:239]
  s_cselect_b32 s69, 0x40000000, s69
  v_mul_f32 v145, s66, v145
  v_cvt_pk_bf16_f32 v72, v144, v145
  v_mfma_f32_16x16x32_bf16 v[208:211], a[8:11], v[40:43], v[208:211]
  ds_read_b64_tr_b16 v[56:57], v22 offset:12288
  v_mul_f32 v146, s66, v146
  v_mfma_f32_16x16x32_bf16 v[212:215], a[72:75], v[40:43], v[212:215]
  v_mul_f32 v147, s66, v147
  v_cvt_pk_bf16_f32 v73, v146, v147
  v_mfma_f32_16x16x32_bf16 v[240:243], a[136:139], v[40:43], v[240:243]
  ds_read_b64_tr_b16 v[58:59], v22 offset:12800
  v_mul_f32 v148, s66, v148
  v_mfma_f32_16x16x32_bf16 v[244:247], a[200:203], v[40:43], v[244:247]
  v_mul_f32 v149, s66, v149
  v_cvt_pk_bf16_f32 v74, v148, v149
  v_mfma_f32_16x16x32_bf16 v[216:219], a[8:11], v[44:47], v[216:219]
  s_waitcnt vmcnt(14)
  ds_read_b64_tr_b16 v[60:61], v23 offset:12288
  v_mul_f32 v150, s66, v150
  v_mfma_f32_16x16x32_bf16 v[220:223], a[72:75], v[44:47], v[220:223]
  s_barrier
  v_mul_f32 v151, s66, v151
  v_cvt_pk_bf16_f32 v75, v150, v151
  v_mfma_f32_16x16x32_bf16 v[248:251], a[136:139], v[44:47], v[248:251]
  s_waitcnt lgkmcnt(3)
  ds_read_b64_tr_b16 v[62:63], v23 offset:12800
  v_mfma_f32_16x16x32_bf16 v[252:255], a[200:203], v[44:47], v[252:255]
  buffer_atomic_add v11, v10, s[40:43], s69 offen
  v_mfma_f32_16x16x32_bf16 v[192:195], a[12:15], v[48:51], v[192:195]
  ds_read_b64_tr_b16 v[32:33], v20 offset:16384
  v_mul_f32 v152, s66, v152
  v_mfma_f32_16x16x32_bf16 v[196:199], a[76:79], v[48:51], v[196:199]
  buffer_store_dwordx4 v[72:75], v8, s[40:43], s65 offen offset:2048 sc1
  v_mul_f32 v153, s66, v153
  v_cvt_pk_bf16_f32 v76, v152, v153
  v_mfma_f32_16x16x32_bf16 v[224:227], a[140:143], v[48:51], v[224:227]
  ds_read_b64_tr_b16 v[34:35], v20 offset:16896
  v_mul_f32 v154, s66, v154
  v_mfma_f32_16x16x32_bf16 v[228:231], a[204:207], v[48:51], v[228:231]
  v_mul_f32 v155, s66, v155
  v_cvt_pk_bf16_f32 v77, v154, v155
  v_mfma_f32_16x16x32_bf16 v[200:203], a[12:15], v[52:55], v[200:203]
  ds_read_b64_tr_b16 v[36:37], v21 offset:16384
  v_mul_f32 v156, s66, v156
  v_mfma_f32_16x16x32_bf16 v[204:207], a[76:79], v[52:55], v[204:207]
  v_mul_f32 v157, s66, v157
  v_cvt_pk_bf16_f32 v78, v156, v157
  v_mfma_f32_16x16x32_bf16 v[232:235], a[140:143], v[52:55], v[232:235]
  s_waitcnt lgkmcnt(3)
  ds_read_b64_tr_b16 v[38:39], v21 offset:16896
  v_mul_f32 v158, s66, v158
  v_mfma_f32_16x16x32_bf16 v[236:239], a[204:207], v[52:55], v[236:239]
  v_mul_f32 v159, s66, v159
  v_cvt_pk_bf16_f32 v79, v158, v159
  v_mfma_f32_16x16x32_bf16 v[208:211], a[12:15], v[56:59], v[208:211]
  ds_read_b64_tr_b16 v[40:41], v22 offset:16384
  v_mfma_f32_16x16x32_bf16 v[212:215], a[76:79], v[56:59], v[212:215]
  v_mfma_f32_16x16x32_bf16 v[240:243], a[140:143], v[56:59], v[240:243]
  ds_read_b64_tr_b16 v[42:43], v22 offset:16896
  v_mfma_f32_16x16x32_bf16 v[244:247], a[204:207], v[56:59], v[244:247]
  buffer_store_dwordx4 v[76:79], v8, s[40:43], s65 offen offset:3072 sc1
  v_mfma_f32_16x16x32_bf16 v[216:219], a[12:15], v[60:63], v[216:219]
  ds_read_b64_tr_b16 v[44:45], v23 offset:16384
  v_mfma_f32_16x16x32_bf16 v[220:223], a[76:79], v[60:63], v[220:223]
  v_mfma_f32_16x16x32_bf16 v[248:251], a[140:143], v[60:63], v[248:251]
  s_waitcnt lgkmcnt(3)
  ds_read_b64_tr_b16 v[46:47], v23 offset:16896
  v_mfma_f32_16x16x32_bf16 v[252:255], a[204:207], v[60:63], v[252:255]
  v_mfma_f32_16x16x32_bf16 v[192:195], a[16:19], v[32:35], v[192:195]
  s_add_u32 m0, s64, 49152
  ds_read_b64_tr_b16 v[48:49], v20 offset:20480
  v_mfma_f32_16x16x32_bf16 v[196:199], a[80:83], v[32:35], v[196:199]
  v_mfma_f32_16x16x32_bf16 v[224:227], a[144:147], v[32:35], v[224:227]
  s_add_u32 s63, s62, 3145728
  ds_read_b64_tr_b16 v[50:51], v20 offset:20992
  v_mul_f32 v160, s66, v160
  v_mfma_f32_16x16x32_bf16 v[228:231], a[208:211], v[32:35], v[228:231]
  buffer_load_dwordx4 v2, s[48:51], s63 offen lds
  v_mul_f32 v161, s66, v161
  v_cvt_pk_bf16_f32 v64, v160, v161
  v_mfma_f32_16x16x32_bf16 v[200:203], a[16:19], v[36:39], v[200:203]
  ds_read_b64_tr_b16 v[52:53], v21 offset:20480
  v_mul_f32 v162, s66, v162
  v_mfma_f32_16x16x32_bf16 v[204:207], a[80:83], v[36:39], v[204:207]
  v_mul_f32 v163, s66, v163
  v_cvt_pk_bf16_f32 v65, v162, v163
  v_mfma_f32_16x16x32_bf16 v[232:235], a[144:147], v[36:39], v[232:235]
  s_waitcnt lgkmcnt(3)
  ds_read_b64_tr_b16 v[54:55], v21 offset:20992
  v_mul_f32 v164, s66, v164
  v_mfma_f32_16x16x32_bf16 v[236:239], a[208:211], v[36:39], v[236:239]
  v_mul_f32 v165, s66, v165
  v_cvt_pk_bf16_f32 v66, v164, v165
  v_mfma_f32_16x16x32_bf16 v[208:211], a[16:19], v[40:43], v[208:211]
  s_add_u32 m0, s64, 50176
  ds_read_b64_tr_b16 v[56:57], v22 offset:20480
  v_mul_f32 v166, s66, v166
  v_mfma_f32_16x16x32_bf16 v[212:215], a[80:83], v[40:43], v[212:215]
  v_mul_f32 v167, s66, v167
  v_cvt_pk_bf16_f32 v67, v166, v167
  v_mfma_f32_16x16x32_bf16 v[240:243], a[144:147], v[40:43], v[240:243]
  s_add_u32 s63, s62, 3211264
  ds_read_b64_tr_b16 v[58:59], v22 offset:20992
  v_mfma_f32_16x16x32_bf16 v[244:247], a[208:211], v[40:43], v[244:247]
  buffer_load_dwordx4 v3, s[48:51], s63 offen lds
  v_mfma_f32_16x16x32_bf16 v[216:219], a[16:19], v[44:47], v[216:219]
  ds_read_b64_tr_b16 v[60:61], v23 offset:20480
  v_mul_f32 v168, s66, v168
  v_mfma_f32_16x16x32_bf16 v[220:223], a[80:83], v[44:47], v[220:223]
  buffer_store_dwordx4 v[64:67], v9, s[40:43], s65 offen offset:0 sc1
  v_mul_f32 v169, s66, v169
  v_cvt_pk_bf16_f32 v68, v168, v169
  v_mfma_f32_16x16x32_bf16 v[248:251], a[144:147], v[44:47], v[248:251]
  s_waitcnt lgkmcnt(3)
  ds_read_b64_tr_b16 v[62:63], v23 offset:20992
  v_mul_f32 v170, s66, v170
  v_mfma_f32_16x16x32_bf16 v[252:255], a[208:211], v[44:47], v[252:255]
  v_mul_f32 v171, s66, v171
  v_cvt_pk_bf16_f32 v69, v170, v171
  v_mfma_f32_16x16x32_bf16 v[192:195], a[20:23], v[48:51], v[192:195]
  s_add_u32 m0, s64, 51200
  ds_read_b64_tr_b16 v[32:33], v20 offset:24576
  v_mul_f32 v172, s66, v172
  v_mfma_f32_16x16x32_bf16 v[196:199], a[84:87], v[48:51], v[196:199]
  v_mul_f32 v173, s66, v173
  v_cvt_pk_bf16_f32 v70, v172, v173
  v_mfma_f32_16x16x32_bf16 v[224:227], a[148:151], v[48:51], v[224:227]
  s_add_u32 s63, s62, 3276800
  ds_read_b64_tr_b16 v[34:35], v20 offset:25088
  v_mul_f32 v174, s66, v174
  v_mfma_f32_16x16x32_bf16 v[228:231], a[212:215], v[48:51], v[228:231]
  buffer_load_dwordx4 v2, s[48:51], s63 offen lds
  v_mul_f32 v175, s66, v175
  v_cvt_pk_bf16_f32 v71, v174, v175
  v_mfma_f32_16x16x32_bf16 v[200:203], a[20:23], v[52:55], v[200:203]
  ds_read_b64_tr_b16 v[36:37], v21 offset:24576
  v_mfma_f32_16x16x32_bf16 v[204:207], a[84:87], v[52:55], v[204:207]
  v_mfma_f32_16x16x32_bf16 v[232:235], a[148:151], v[52:55], v[232:235]
  s_waitcnt lgkmcnt(3)
  ds_read_b64_tr_b16 v[38:39], v21 offset:25088
  v_mfma_f32_16x16x32_bf16 v[236:239], a[212:215], v[52:55], v[236:239]
  buffer_store_dwordx4 v[68:71], v9, s[40:43], s65 offen offset:1024 sc1
  v_mfma_f32_16x16x32_bf16 v[208:211], a[20:23], v[56:59], v[208:211]
  s_add_u32 m0, s64, 52224
  ds_read_b64_tr_b16 v[40:41], v22 offset:24576
  v_mfma_f32_16x16x32_bf16 v[212:215], a[84:87], v[56:59], v[212:215]
  v_mfma_f32_16x16x32_bf16 v[240:243], a[148:151], v[56:59], v[240:243]
  s_add_u32 s63, s62, 3342336
  ds_read_b64_tr_b16 v[42:43], v22 offset:25088
  v_mfma_f32_16x16x32_bf16 v[244:247], a[212:215], v[56:59], v[244:247]
  buffer_load_dwordx4 v3, s[48:51], s63 offen lds
  v_mfma_f32_16x16x32_bf16 v[216:219], a[20:23], v[60:63], v[216:219]
  ds_read_b64_tr_b16 v[44:45], v23 offset:24576
  v_mfma_f32_16x16x32_bf16 v[220:223], a[84:87], v[60:63], v[220:223]
  v_mfma_f32_16x16x32_bf16 v[248:251], a[148:151], v[60:63], v[248:251]
  s_waitcnt lgkmcnt(3)
  ds_read_b64_tr_b16 v[46:47], v23 offset:25088
  v_mul_f32 v176, s66, v176
  v_mfma_f32_16x16x32_bf16 v[252:255], a[212:215], v[60:63], v[252:255]
  v_mul_f32 v177, s66, v177
  v_cvt_pk_bf16_f32 v72, v176, v177
  v_mfma_f32_16x16x32_bf16 v[192:195], a[24:27], v[32:35], v[192:195]
  ds_read_b64_tr_b16 v[48:49], v20 offset:28672
  v_mul_f32 v178, s66, v178
  v_mfma_f32_16x16x32_bf16 v[196:199], a[88:91], v[32:35], v[196:199]
  v_mul_f32 v179, s66, v179
  v_cvt_pk_bf16_f32 v73, v178, v179
  v_mfma_f32_16x16x32_bf16 v[224:227], a[152:155], v[32:35], v[224:227]
  ds_read_b64_tr_b16 v[50:51], v20 offset:29184
  v_mul_f32 v180, s66, v180
  v_mfma_f32_16x16x32_bf16 v[228:231], a[216:219], v[32:35], v[228:231]
  v_mul_f32 v181, s66, v181
  v_cvt_pk_bf16_f32 v74, v180, v181
  v_mfma_f32_16x16x32_bf16 v[200:203], a[24:27], v[36:39], v[200:203]
  s_bfe_u32 s67, s59, 0x30018
  ds_read_b64_tr_b16 v[52:53], v21 offset:28672
  v_mul_f32 v182, s66, v182
  v_mfma_f32_16x16x32_bf16 v[204:207], a[88:91], v[36:39], v[204:207]
  s_mov_b64 s[48:49], s[12:13]
  v_mul_f32 v183, s66, v183
  v_cvt_pk_bf16_f32 v75, v182, v183
  v_mfma_f32_16x16x32_bf16 v[232:235], a[152:155], v[36:39], v[232:235]
  s_waitcnt lgkmcnt(3)
  s_cmp_eq_u32 s67, 1
  ds_read_b64_tr_b16 v[54:55], v21 offset:29184
  v_mfma_f32_16x16x32_bf16 v[236:239], a[216:219], v[36:39], v[236:239]
  s_cselect_b64 s[48:49], s[14:15], s[48:49]
  v_mfma_f32_16x16x32_bf16 v[208:211], a[24:27], v[40:43], v[208:211]
  s_cmp_eq_u32 s67, 2
  ds_read_b64_tr_b16 v[56:57], v22 offset:28672
  v_mul_f32 v184, s66, v184
  v_mfma_f32_16x16x32_bf16 v[212:215], a[88:91], v[40:43], v[212:215]
  s_cselect_b64 s[48:49], s[16:17], s[48:49]
  buffer_store_dwordx4 v[72:75], v9, s[40:43], s65 offen offset:2048 sc1
  v_mul_f32 v185, s66, v185
  v_cvt_pk_bf16_f32 v76, v184, v185
  v_mfma_f32_16x16x32_bf16 v[240:243], a[152:155], v[40:43], v[240:243]
  s_cmp_eq_u32 s67, 3
  ds_read_b64_tr_b16 v[58:59], v22 offset:29184
  v_mul_f32 v186, s66, v186
  v_mfma_f32_16x16x32_bf16 v[244:247], a[216:219], v[40:43], v[244:247]
  s_cselect_b64 s[48:49], s[24:25], s[48:49]
  v_mul_f32 v187, s66, v187
  v_cvt_pk_bf16_f32 v77, v186, v187
  v_mfma_f32_16x16x32_bf16 v[216:219], a[24:27], v[44:47], v[216:219]
  s_waitcnt vmcnt(28)
  s_barrier
  ds_read_b64_tr_b16 v[60:61], v23 offset:28672
  v_mul_f32 v188, s66, v188
  v_mfma_f32_16x16x32_bf16 v[220:223], a[88:91], v[44:47], v[220:223]
  s_cmp_eq_u32 s67, 4
  s_cselect_b64 s[48:49], s[26:27], s[48:49]
  v_mul_f32 v189, s66, v189
  v_cvt_pk_bf16_f32 v78, v188, v189
  v_mfma_f32_16x16x32_bf16 v[248:251], a[152:155], v[44:47], v[248:251]
  s_waitcnt lgkmcnt(3)
  s_cmp_eq_u32 s67, 5
  ds_read_b64_tr_b16 v[62:63], v23 offset:29184
  v_mul_f32 v190, s66, v190
  v_mfma_f32_16x16x32_bf16 v[252:255], a[216:219], v[44:47], v[252:255]
  s_cselect_b64 s[48:49], s[28:29], s[48:49]
  v_mul_f32 v191, s66, v191
  v_cvt_pk_bf16_f32 v79, v190, v191
  v_mfma_f32_16x16x32_bf16 v[192:195], a[28:31], v[48:51], v[192:195]
  s_and_b32 s49, s49, 0xffff
  ds_read_b64_tr_b16 v[32:33], v20 offset:32768
  v_mfma_f32_16x16x32_bf16 v[196:199], a[92:95], v[48:51], v[196:199]
  s_bfe_u32 s67, s59, 0x50013
  v_mfma_f32_16x16x32_bf16 v[224:227], a[156:159], v[48:51], v[224:227]
  s_lshl_b32 s67, s67, 8
  ds_read_b64_tr_b16 v[34:35], v20 offset:33280
  v_mfma_f32_16x16x32_bf16 v[228:231], a[220:223], v[48:51], v[228:231]
  s_bfe_u32 s68, s59, 0x1000c
  buffer_store_dwordx4 v[76:79], v9, s[40:43], s65 offen offset:3072 sc1
  v_mfma_f32_16x16x32_bf16 v[200:203], a[28:31], v[52:55], v[200:203]
  s_lshl_b32 s68, s68, 7
  ds_read_b64_tr_b16 v[36:37], v21 offset:32768
  v_mfma_f32_16x16x32_bf16 v[204:207], a[92:95], v[52:55], v[204:207]
  s_or_b32 s62, s67, s68
  v_mfma_f32_16x16x32_bf16 v[232:235], a[156:159], v[52:55], v[232:235]
  s_waitcnt lgkmcnt(3)
  s_bitcmp1_b32 s59, 2
  ds_read_b64_tr_b16 v[38:39], v21 offset:33280
  v_mfma_f32_16x16x32_bf16 v[236:239], a[220:223], v[52:55], v[236:239]
  s_cselect_b32 s62, 0x40000000, s62
  v_mfma_f32_16x16x32_bf16 v[208:211], a[28:31], v[56:59], v[208:211]
  ds_read_b64_tr_b16 v[40:41], v22 offset:32768
  v_mfma_f32_16x16x32_bf16 v[212:215], a[92:95], v[56:59], v[212:215]
  v_mfma_f32_16x16x32_bf16 v[240:243], a[156:159], v[56:59], v[240:243]
  ds_read_b64_tr_b16 v[42:43], v22 offset:33280
  v_mfma_f32_16x16x32_bf16 v[244:247], a[220:223], v[56:59], v[244:247]
  v_mfma_f32_16x16x32_bf16 v[216:219], a[28:31], v[60:63], v[216:219]
  ds_read_b64_tr_b16 v[44:45], v23 offset:32768
  v_mfma_f32_16x16x32_bf16 v[220:223], a[92:95], v[60:63], v[220:223]
  v_mfma_f32_16x16x32_bf16 v[248:251], a[156:159], v[60:63], v[248:251]
  s_waitcnt lgkmcnt(3)
  ds_read_b64_tr_b16 v[46:47], v23 offset:33280
  v_mfma_f32_16x16x32_bf16 v[252:255], a[220:223], v[60:63], v[252:255]
  v_mfma_f32_16x16x32_bf16 v[192:195], a[32:35], v[32:35], v[192:195]
  s_add_u32 m0, s64, 65536
  ds_read_b64_tr_b16 v[48:49], v20 offset:36864
  v_mfma_f32_16x16x32_bf16 v[196:199], a[96:99], v[32:35], v[196:199]
  v_mfma_f32_16x16x32_bf16 v[224:227], a[160:163], v[32:35], v[224:227]
  s_add_u32 s63, s62, 0
  ds_read_b64_tr_b16 v[50:51], v20 offset:37376
  v_mfma_f32_16x16x32_bf16 v[228:231], a[224:227], v[32:35], v[228:231]
  buffer_load_dwordx4 v2, s[48:51], s63 offen lds
  v_mfma_f32_16x16x32_bf16 v[200:203], a[32:35], v[36:39], v[200:203]
  ds_read_b64_tr_b16 v[52:53], v21 offset:36864
  v_mfma_f32_16x16x32_bf16 v[204:207], a[96:99], v[36:39], v[204:207]
  v_mfma_f32_16x16x32_bf16 v[232:235], a[160:163], v[36:39], v[232:235]
  s_waitcnt lgkmcnt(3)
  ds_read_b64_tr_b16 v[54:55], v21 offset:37376
  v_mfma_f32_16x16x32_bf16 v[236:239], a[224:227], v[36:39], v[236:239]
  v_mfma_f32_16x16x32_bf16 v[208:211], a[32:35], v[40:43], v[208:211]
  s_add_u32 m0, s64, 66560
  ds_read_b64_tr_b16 v[56:57], v22 offset:36864
  v_mfma_f32_16x16x32_bf16 v[212:215], a[96:99], v[40:43], v[212:215]
  v_mfma_f32_16x16x32_bf16 v[240:243], a[160:163], v[40:43], v[240:243]
  s_add_u32 s63, s62, 65536
  ds_read_b64_tr_b16 v[58:59], v22 offset:37376
  v_mfma_f32_16x16x32_bf16 v[244:247], a[224:227], v[40:43], v[244:247]
  buffer_load_dwordx4 v3, s[48:51], s63 offen lds
  v_mfma_f32_16x16x32_bf16 v[216:219], a[32:35], v[44:47], v[216:219]
  ds_read_b64_tr_b16 v[60:61], v23 offset:36864
  v_mfma_f32_16x16x32_bf16 v[220:223], a[96:99], v[44:47], v[220:223]
  v_mfma_f32_16x16x32_bf16 v[248:251], a[160:163], v[44:47], v[248:251]
  s_waitcnt lgkmcnt(3)
  ds_read_b64_tr_b16 v[62:63], v23 offset:37376
  v_mfma_f32_16x16x32_bf16 v[252:255], a[224:227], v[44:47], v[252:255]
  v_mfma_f32_16x16x32_bf16 v[192:195], a[36:39], v[48:51], v[192:195]
  s_add_u32 m0, s64, 67584
  ds_read_b64_tr_b16 v[32:33], v20 offset:40960
  v_mfma_f32_16x16x32_bf16 v[196:199], a[100:103], v[48:51], v[196:199]
  v_mfma_f32_16x16x32_bf16 v[224:227], a[164:167], v[48:51], v[224:227]
  s_add_u32 s63, s62, 131072
  ds_read_b64_tr_b16 v[34:35], v20 offset:41472
  v_mfma_f32_16x16x32_bf16 v[228:231], a[228:231], v[48:51], v[228:231]
  buffer_load_dwordx4 v2, s[48:51], s63 offen lds
  v_mfma_f32_16x16x32_bf16 v[200:203], a[36:39], v[52:55], v[200:203]
  ds_read_b64_tr_b16 v[36:37], v21 offset:40960
  v_mfma_f32_16x16x32_bf16 v[204:207], a[100:103], v[52:55], v[204:207]
  v_mfma_f32_16x16x32_bf16 v[232:235], a[164:167], v[52:55], v[232:235]
  s_waitcnt lgkmcnt(3)
  ds_read_b64_tr_b16 v[38:39], v21 offset:41472
  v_mfma_f32_16x16x32_bf16 v[236:239], a[228:231], v[52:55], v[236:239]
  v_mfma_f32_16x16x32_bf16 v[208:211], a[36:39], v[56:59], v[208:211]
  s_add_u32 m0, s64, 68608
  ds_read_b64_tr_b16 v[40:41], v22 offset:40960
  v_mfma_f32_16x16x32_bf16 v[212:215], a[100:103], v[56:59], v[212:215]
  v_mfma_f32_16x16x32_bf16 v[240:243], a[164:167], v[56:59], v[240:243]
  s_add_u32 s63, s62, 196608
  ds_read_b64_tr_b16 v[42:43], v22 offset:41472
  v_mfma_f32_16x16x32_bf16 v[244:247], a[228:231], v[56:59], v[244:247]
  buffer_load_dwordx4 v3, s[48:51], s63 offen lds
  v_mfma_f32_16x16x32_bf16 v[216:219], a[36:39], v[60:63], v[216:219]
  ds_read_b64_tr_b16 v[44:45], v23 offset:40960
  v_mfma_f32_16x16x32_bf16 v[220:223], a[100:103], v[60:63], v[220:223]
  v_mfma_f32_16x16x32_bf16 v[248:251], a[164:167], v[60:63], v[248:251]
  s_waitcnt lgkmcnt(3)
  ds_read_b64_tr_b16 v[46:47], v23 offset:41472
  v_mfma_f32_16x16x32_bf16 v[252:255], a[228:231], v[60:63], v[252:255]
  v_mfma_f32_16x16x32_bf16 v[192:195], a[40:43], v[32:35], v[192:195]
  ds_read_b64_tr_b16 v[48:49], v20 offset:45056
  v_mfma_f32_16x16x32_bf16 v[196:199], a[104:107], v[32:35], v[196:199]
  v_mfma_f32_16x16x32_bf16 v[224:227], a[168:171], v[32:35], v[224:227]
  ds_read_b64_tr_b16 v[50:51], v20 offset:45568
  v_mfma_f32_16x16x32_bf16 v[228:231], a[232:235], v[32:35], v[228:231]
  v_mfma_f32_16x16x32_bf16 v[200:203], a[40:43], v[36:39], v[200:203]
  ds_read_b64_tr_b16 v[52:53], v21 offset:45056
  v_mfma_f32_16x16x32_bf16 v[204:207], a[104:107], v[36:39], v[204:207]
  v_mfma_f32_16x16x32_bf16 v[232:235], a[168:171], v[36:39], v[232:235]
  s_waitcnt lgkmcnt(3)
  ds_read_b64_tr_b16 v[54:55], v21 offset:45568
  v_mfma_f32_16x16x32_bf16 v[236:239], a[232:235], v[36:39], v[236:239]
  v_mfma_f32_16x16x32_bf16 v[208:211], a[40:43], v[40:43], v[208:211]
  ds_read_b64_tr_b16 v[56:57], v22 offset:45056
  v_mfma_f32_16x16x32_bf16 v[212:215], a[104:107], v[40:43], v[212:215]
  v_mfma_f32_16x16x32_bf16 v[240:243], a[168:171], v[40:43], v[240:243]
  ds_read_b64_tr_b16 v[58:59], v22 offset:45568
  v_mfma_f32_16x16x32_bf16 v[244:247], a[232:235], v[40:43], v[244:247]
  v_mfma_f32_16x16x32_bf16 v[216:219], a[40:43], v[44:47], v[216:219]
  s_waitcnt vmcnt(28)
  ds_read_b64_tr_b16 v[60:61], v23 offset:45056
  v_mfma_f32_16x16x32_bf16 v[220:223], a[104:107], v[44:47], v[220:223]
  s_barrier
  v_mfma_f32_16x16x32_bf16 v[248:251], a[168:171], v[44:47], v[248:251]
  s_waitcnt lgkmcnt(3)
  ds_read_b64_tr_b16 v[62:63], v23 offset:45568
  v_mfma_f32_16x16x32_bf16 v[252:255], a[232:235], v[44:47], v[252:255]
  v_mfma_f32_16x16x32_bf16 v[192:195], a[44:47], v[48:51], v[192:195]
  ds_read_b64_tr_b16 v[32:33], v20 offset:49152
  v_mfma_f32_16x16x32_bf16 v[196:199], a[108:111], v[48:51], v[196:199]
  v_mfma_f32_16x16x32_bf16 v[224:227], a[172:175], v[48:51], v[224:227]
  ds_read_b64_tr_b16 v[34:35], v20 offset:49664
  v_mfma_f32_16x16x32_bf16 v[228:231], a[236:239], v[48:51], v[228:231]
  v_mfma_f32_16x16x32_bf16 v[200:203], a[44:47], v[52:55], v[200:203]
  ds_read_b64_tr_b16 v[36:37], v21 offset:49152
  v_mfma_f32_16x16x32_bf16 v[204:207], a[108:111], v[52:55], v[204:207]
  v_mfma_f32_16x16x32_bf16 v[232:235], a[172:175], v[52:55], v[232:235]
  s_waitcnt lgkmcnt(3)
  ds_read_b64_tr_b16 v[38:39], v21 offset:49664
  v_mfma_f32_16x16x32_bf16 v[236:239], a[236:239], v[52:55], v[236:239]
  v_mfma_f32_16x16x32_bf16 v[208:211], a[44:47], v[56:59], v[208:211]
  ds_read_b64_tr_b16 v[40:41], v22 offset:49152
  v_mfma_f32_16x16x32_bf16 v[212:215], a[108:111], v[56:59], v[212:215]
  v_mfma_f32_16x16x32_bf16 v[240:243], a[172:175], v[56:59], v[240:243]
  ds_read_b64_tr_b16 v[42:43], v22 offset:49664
  v_mfma_f32_16x16x32_bf16 v[244:247], a[236:239], v[56:59], v[244:247]
  v_mfma_f32_16x16x32_bf16 v[216:219], a[44:47], v[60:63], v[216:219]
  ds_read_b64_tr_b16 v[44:45], v23 offset:49152
  v_mfma_f32_16x16x32_bf16 v[220:223], a[108:111], v[60:63], v[220:223]
  v_mfma_f32_16x16x32_bf16 v[248:251], a[172:175], v[60:63], v[248:251]
  s_waitcnt lgkmcnt(3)
  ds_read_b64_tr_b16 v[46:47], v23 offset:49664
  v_mfma_f32_16x16x32_bf16 v[252:255], a[236:239], v[60:63], v[252:255]
  v_mfma_f32_16x16x32_bf16 v[192:195], a[48:51], v[32:35], v[192:195]
  s_add_u32 m0, s64, 81920
  ds_read_b64_tr_b16 v[48:49], v20 offset:53248
  v_mfma_f32_16x16x32_bf16 v[196:199], a[112:115], v[32:35], v[196:199]
  v_mfma_f32_16x16x32_bf16 v[224:227], a[176:179], v[32:35], v[224:227]
  s_add_u32 s63, s62, 1048576
  ds_read_b64_tr_b16 v[50:51], v20 offset:53760
  v_mfma_f32_16x16x32_bf16 v[228:231], a[240:243], v[32:35], v[228:231]
  buffer_load_dwordx4 v2, s[48:51], s63 offen lds
  v_mfma_f32_16x16x32_bf16 v[200:203], a[48:51], v[36:39], v[200:203]
  ds_read_b64_tr_b16 v[52:53], v21 offset:53248
  v_mfma_f32_16x16x32_bf16 v[204:207], a[112:115], v[36:39], v[204:207]
  v_mfma_f32_16x16x32_bf16 v[232:235], a[176:179], v[36:39], v[232:235]
  s_waitcnt lgkmcnt(3)
  ds_read_b64_tr_b16 v[54:55], v21 offset:53760
  v_mfma_f32_16x16x32_bf16 v[236:239], a[240:243], v[36:39], v[236:239]
  v_mfma_f32_16x16x32_bf16 v[208:211], a[48:51], v[40:43], v[208:211]
  s_add_u32 m0, s64, 82944
  ds_read_b64_tr_b16 v[56:57], v22 offset:53248
  v_mfma_f32_16x16x32_bf16 v[212:215], a[112:115], v[40:43], v[212:215]
  v_mfma_f32_16x16x32_bf16 v[240:243], a[176:179], v[40:43], v[240:243]
  s_add_u32 s63, s62, 1114112
  ds_read_b64_tr_b16 v[58:59], v22 offset:53760
  v_mfma_f32_16x16x32_bf16 v[244:247], a[240:243], v[40:43], v[244:247]
  buffer_load_dwordx4 v3, s[48:51], s63 offen lds
  v_mfma_f32_16x16x32_bf16 v[216:219], a[48:51], v[44:47], v[216:219]
  ds_read_b64_tr_b16 v[60:61], v23 offset:53248
  v_mfma_f32_16x16x32_bf16 v[220:223], a[112:115], v[44:47], v[220:223]
  v_mfma_f32_16x16x32_bf16 v[248:251], a[176:179], v[44:47], v[248:251]
  s_waitcnt lgkmcnt(3)
  ds_read_b64_tr_b16 v[62:63], v23 offset:53760
  v_mfma_f32_16x16x32_bf16 v[252:255], a[240:243], v[44:47], v[252:255]
  v_mfma_f32_16x16x32_bf16 v[192:195], a[52:55], v[48:51], v[192:195]
  s_add_u32 m0, s64, 83968
  ds_read_b64_tr_b16 v[32:33], v20 offset:57344
  v_mfma_f32_16x16x32_bf16 v[196:199], a[116:119], v[48:51], v[196:199]
  v_mfma_f32_16x16x32_bf16 v[224:227], a[180:183], v[48:51], v[224:227]
  s_add_u32 s63, s62, 1179648
  ds_read_b64_tr_b16 v[34:35], v20 offset:57856
  v_mfma_f32_16x16x32_bf16 v[228:231], a[244:247], v[48:51], v[228:231]
  buffer_load_dwordx4 v2, s[48:51], s63 offen lds
  v_mfma_f32_16x16x32_bf16 v[200:203], a[52:55], v[52:55], v[200:203]
  ds_read_b64_tr_b16 v[36:37], v21 offset:57344
  v_mfma_f32_16x16x32_bf16 v[204:207], a[116:119], v[52:55], v[204:207]
  v_mfma_f32_16x16x32_bf16 v[232:235], a[180:183], v[52:55], v[232:235]
  s_waitcnt lgkmcnt(3)
  ds_read_b64_tr_b16 v[38:39], v21 offset:57856
  v_mfma_f32_16x16x32_bf16 v[236:239], a[244:247], v[52:55], v[236:239]
  v_mfma_f32_16x16x32_bf16 v[208:211], a[52:55], v[56:59], v[208:211]
  s_add_u32 m0, s64, 84992
  ds_read_b64_tr_b16 v[40:41], v22 offset:57344
  v_mfma_f32_16x16x32_bf16 v[212:215], a[116:119], v[56:59], v[212:215]
  v_mfma_f32_16x16x32_bf16 v[240:243], a[180:183], v[56:59], v[240:243]
  s_add_u32 s63, s62, 1245184
  ds_read_b64_tr_b16 v[42:43], v22 offset:57856
  v_mfma_f32_16x16x32_bf16 v[244:247], a[244:247], v[56:59], v[244:247]
  buffer_load_dwordx4 v3, s[48:51], s63 offen lds
  v_mfma_f32_16x16x32_bf16 v[216:219], a[52:55], v[60:63], v[216:219]
  ds_read_b64_tr_b16 v[44:45], v23 offset:57344
  v_mfma_f32_16x16x32_bf16 v[220:223], a[116:119], v[60:63], v[220:223]
  v_mfma_f32_16x16x32_bf16 v[248:251], a[180:183], v[60:63], v[248:251]
  s_waitcnt lgkmcnt(3)
  ds_read_b64_tr_b16 v[46:47], v23 offset:57856
  v_mfma_f32_16x16x32_bf16 v[252:255], a[244:247], v[60:63], v[252:255]
  v_mfma_f32_16x16x32_bf16 v[192:195], a[56:59], v[32:35], v[192:195]
  ds_read_b64_tr_b16 v[48:49], v20 offset:61440
  v_mfma_f32_16x16x32_bf16 v[196:199], a[120:123], v[32:35], v[196:199]
  v_mfma_f32_16x16x32_bf16 v[224:227], a[184:187], v[32:35], v[224:227]
  ds_read_b64_tr_b16 v[50:51], v20 offset:61952
  v_mfma_f32_16x16x32_bf16 v[228:231], a[248:251], v[32:35], v[228:231]
  v_mfma_f32_16x16x32_bf16 v[200:203], a[56:59], v[36:39], v[200:203]
  ds_read_b64_tr_b16 v[52:53], v21 offset:61440
  v_mfma_f32_16x16x32_bf16 v[204:207], a[120:123], v[36:39], v[204:207]
  v_mfma_f32_16x16x32_bf16 v[232:235], a[184:187], v[36:39], v[232:235]
  s_waitcnt lgkmcnt(3)
  ds_read_b64_tr_b16 v[54:55], v21 offset:61952
  v_mfma_f32_16x16x32_bf16 v[236:239], a[248:251], v[36:39], v[236:239]
  v_mfma_f32_16x16x32_bf16 v[208:211], a[56:59], v[40:43], v[208:211]
  ds_read_b64_tr_b16 v[56:57], v22 offset:61440
  v_mfma_f32_16x16x32_bf16 v[212:215], a[120:123], v[40:43], v[212:215]
  v_mfma_f32_16x16x32_bf16 v[240:243], a[184:187], v[40:43], v[240:243]
  ds_read_b64_tr_b16 v[58:59], v22 offset:61952
  v_mfma_f32_16x16x32_bf16 v[244:247], a[248:251], v[40:43], v[244:247]
  v_mfma_f32_16x16x32_bf16 v[216:219], a[56:59], v[44:47], v[216:219]
  s_waitcnt vmcnt(28)
  ds_read_b64_tr_b16 v[60:61], v23 offset:61440
  v_mfma_f32_16x16x32_bf16 v[220:223], a[120:123], v[44:47], v[220:223]
  s_barrier
  v_mfma_f32_16x16x32_bf16 v[248:251], a[184:187], v[44:47], v[248:251]
  s_waitcnt lgkmcnt(3)
  ds_read_b64_tr_b16 v[62:63], v23 offset:61952
  v_mfma_f32_16x16x32_bf16 v[252:255], a[248:251], v[44:47], v[252:255]
  v_mfma_f32_16x16x32_bf16 v[192:195], a[60:63], v[48:51], v[192:195]
  s_mov_b32 s61, s60
  ds_read_b64_tr_b16 v[32:33], v16 offset:0
  v_mfma_f32_16x16x32_bf16 v[196:199], a[124:127], v[48:51], v[196:199]
  s_mov_b32 s60, s57
  v_mfma_f32_16x16x32_bf16 v[224:227], a[188:191], v[48:51], v[224:227]
  s_mov_b32 s57, s58
  ds_read_b64_tr_b16 v[34:35], v16 offset:512
  v_mfma_f32_16x16x32_bf16 v[228:231], a[252:255], v[48:51], v[228:231]
  s_mov_b32 s58, s59
  v_mfma_f32_16x16x32_bf16 v[200:203], a[60:63], v[52:55], v[200:203]
  s_add_u32 s56, s56, 1
  ds_read_b64_tr_b16 v[36:37], v17 offset:0
  v_mfma_f32_16x16x32_bf16 v[204:207], a[124:127], v[52:55], v[204:207]
  v_mfma_f32_16x16x32_bf16 v[232:235], a[188:191], v[52:55], v[232:235]
  s_waitcnt lgkmcnt(3)
  ds_read_b64_tr_b16 v[38:39], v17 offset:512
  v_mfma_f32_16x16x32_bf16 v[236:239], a[252:255], v[52:55], v[236:239]
  v_mfma_f32_16x16x32_bf16 v[208:211], a[60:63], v[56:59], v[208:211]
  ds_read_b64_tr_b16 v[40:41], v18 offset:0
  v_mfma_f32_16x16x32_bf16 v[212:215], a[124:127], v[56:59], v[212:215]
  v_mfma_f32_16x16x32_bf16 v[240:243], a[188:191], v[56:59], v[240:243]
  ds_read_b64_tr_b16 v[42:43], v18 offset:512
  v_mfma_f32_16x16x32_bf16 v[244:247], a[252:255], v[56:59], v[244:247]
  v_mfma_f32_16x16x32_bf16 v[216:219], a[60:63], v[60:63], v[216:219]
  ds_read_b64_tr_b16 v[44:45], v19 offset:0
  v_mfma_f32_16x16x32_bf16 v[220:223], a[124:127], v[60:63], v[220:223]
  v_mfma_f32_16x16x32_bf16 v[248:251], a[188:191], v[60:63], v[248:251]
  s_waitcnt lgkmcnt(3)
  ds_read_b64_tr_b16 v[46:47], v19 offset:512
  v_mfma_f32_16x16x32_bf16 v[252:255], a[252:255], v[60:63], v[252:255]
  s_bitcmp1_b32 s57, 2
  s_cbranch_scc1 L_p_done_1
  s_bitcmp1_b32 s57, 0
  s_cbranch_scc1 L_p_body_0_1
  s_branch L_p_body_0_0
L_p_done_0:
  s_and_b32 s65, s60, 0x7fff000
  s_bitcmp1_b32 s60, 2
  s_cselect_b32 s65, 0x40000000, s65
  s_bitcmp1_b32 s60, 1
  s_cselect_b32 s66, 0x3e0293ee, 1.0
  s_nop 7
  v_mul_f32 v128, s66, v128
  v_mul_f32 v129, s66, v129
  v_cvt_pk_bf16_f32 v64, v128, v129
  v_mul_f32 v130, s66, v130
  v_mul_f32 v131, s66, v131
  v_cvt_pk_bf16_f32 v65, v130, v131
  v_mul_f32 v132, s66, v132
  v_mul_f32 v133, s66, v133
  v_cvt_pk_bf16_f32 v66, v132, v133
  v_mul_f32 v134, s66, v134
  v_mul_f32 v135, s66, v135
  v_cvt_pk_bf16_f32 v67, v134, v135
  buffer_store_dwordx4 v[64:67], v8, s[40:43], s65 offen offset:0 sc1
  v_mul_f32 v136, s66, v136
  v_mul_f32 v137, s66, v137
  v_cvt_pk_bf16_f32 v68, v136, v137
  v_mul_f32 v138, s66, v138
  v_mul_f32 v139, s66, v139
  v_cvt_pk_bf16_f32 v69, v138, v139
  v_mul_f32 v140, s66, v140
  v_mul_f32 v141, s66, v141
  v_cvt_pk_bf16_f32 v70, v140, v141
  v_mul_f32 v142, s66, v142
  v_mul_f32 v143, s66, v143
  v_cvt_pk_bf16_f32 v71, v142, v143
  buffer_store_dwordx4 v[68:71], v8, s[40:43], s65 offen offset:1024 sc1
  v_mul_f32 v144, s66, v144
  v_mul_f32 v145, s66, v145
  v_cvt_pk_bf16_f32 v72, v144, v145
  v_mul_f32 v146, s66, v146
  v_mul_f32 v147, s66, v147
  v_cvt_pk_bf16_f32 v73, v146, v147
  v_mul_f32 v148, s66, v148
  v_mul_f32 v149, s66, v149
  v_cvt_pk_bf16_f32 v74, v148, v149
  v_mul_f32 v150, s66, v150
  v_mul_f32 v151, s66, v151
  v_cvt_pk_bf16_f32 v75, v150, v151
  buffer_store_dwordx4 v[72:75], v8, s[40:43], s65 offen offset:2048 sc1
  v_mul_f32 v152, s66, v152
  v_mul_f32 v153, s66, v153
  v_cvt_pk_bf16_f32 v76, v152, v153
  v_mul_f32 v154, s66, v154
  v_mul_f32 v155, s66, v155
  v_cvt_pk_bf16_f32 v77, v154, v155
  v_mul_f32 v156, s66, v156
  v_mul_f32 v157, s66, v157
  v_cvt_pk_bf16_f32 v78, v156, v157
  v_mul_f32 v158, s66, v158
  v_mul_f32 v159, s66, v159
  v_cvt_pk_bf16_f32 v79, v158, v159
  buffer_store_dwordx4 v[76:79], v8, s[40:43], s65 offen offset:3072 sc1
  v_mul_f32 v160, s66, v160
  v_mul_f32 v161, s66, v161
  v_cvt_pk_bf16_f32 v64, v160, v161
  v_mul_f32 v162, s66, v162
  v_mul_f32 v163, s66, v163
  v_cvt_pk_bf16_f32 v65, v162, v163
  v_mul_f32 v164, s66, v164
  v_mul_f32 v165, s66, v165
  v_cvt_pk_bf16_f32 v66, v164, v165
  v_mul_f32 v166, s66, v166
  v_mul_f32 v167, s66, v167
  v_cvt_pk_bf16_f32 v67, v166, v167
  buffer_store_dwordx4 v[64:67], v9, s[40:43], s65 offen offset:0 sc1
  v_mul_f32 v168, s66, v168
  v_mul_f32 v169, s66, v169
  v_cvt_pk_bf16_f32 v68, v168, v169
  v_mul_f32 v170, s66, v170
  v_mul_f32 v171, s66, v171
  v_cvt_pk_bf16_f32 v69, v170, v171
  v_mul_f32 v172, s66, v172
  v_mul_f32 v173, s66, v173
  v_cvt_pk_bf16_f32 v70, v172, v173
  v_mul_f32 v174, s66, v174
  v_mul_f32 v175, s66, v175
  v_cvt_pk_bf16_f32 v71, v174, v175
  buffer_store_dwordx4 v[68:71], v9, s[40:43], s65 offen offset:1024 sc1
  v_mul_f32 v176, s66, v176
  v_mul_f32 v177, s66, v177
  v_cvt_pk_bf16_f32 v72, v176, v177
  v_mul_f32 v178, s66, v178
  v_mul_f32 v179, s66, v179
  v_cvt_pk_bf16_f32 v73, v178, v179
  v_mul_f32 v180, s66, v180
  v_mul_f32 v181, s66, v181
  v_cvt_pk_bf16_f32 v74, v180, v181
  v_mul_f32 v182, s66, v182
  v_mul_f32 v183, s66, v183
  v_cvt_pk_bf16_f32 v75, v182, v183
  buffer_store_dwordx4 v[72:75], v9, s[40:43], s65 offen offset:2048 sc1
  v_mul_f32 v184, s66, v184
  v_mul_f32 v185, s66, v185
  v_cvt_pk_bf16_f32 v76, v184, v185
  v_mul_f32 v186, s66, v186
  v_mul_f32 v187, s66, v187
  v_cvt_pk_bf16_f32 v77, v186, v187
  v_mul_f32 v188, s66, v188
  v_mul_f32 v189, s66, v189
  v_cvt_pk_bf16_f32 v78, v188, v189
  v_mul_f32 v190, s66, v190
  v_mul_f32 v191, s66, v191
  v_cvt_pk_bf16_f32 v79, v190, v191
  buffer_store_dwordx4 v[76:79], v9, s[40:43], s65 offen offset:3072 sc1
  s_branch L_p_fin
L_p_done_1:
  s_and_b32 s65, s60, 0x7fff000
  s_bitcmp1_b32 s60, 2
  s_cselect_b32 s65, 0x40000000, s65
  s_bitcmp1_b32 s60, 1
  s_cselect_b32 s66, 0x3e0293ee, 1.0
  s_nop 7
  v_mul_f32 v192, s66, v192
  v_mul_f32 v193, s66, v193
  v_cvt_pk_bf16_f32 v64, v192, v193
  v_mul_f32 v194, s66, v194
  v_mul_f32 v195, s66, v195
  v_cvt_pk_bf16_f32 v65, v194, v195
  v_mul_f32 v196, s66, v196
  v_mul_f32 v197, s66, v197
  v_cvt_pk_bf16_f32 v66, v196, v197
  v_mul_f32 v198, s66, v198
  v_mul_f32 v199, s66, v199
  v_cvt_pk_bf16_f32 v67, v198, v199
  buffer_store_dwordx4 v[64:67], v8, s[40:43], s65 offen offset:0 sc1
  v_mul_f32 v200, s66, v200
  v_mul_f32 v201, s66, v201
  v_cvt_pk_bf16_f32 v68, v200, v201
  v_mul_f32 v202, s66, v202
  v_mul_f32 v203, s66, v203
  v_cvt_pk_bf16_f32 v69, v202, v203
  v_mul_f32 v204, s66, v204
  v_mul_f32 v205, s66, v205
  v_cvt_pk_bf16_f32 v70, v204, v205
  v_mul_f32 v206, s66, v206
  v_mul_f32 v207, s66, v207
  v_cvt_pk_bf16_f32 v71, v206, v207
  buffer_store_dwordx4 v[68:71], v8, s[40:43], s65 offen offset:1024 sc1
  v_mul_f32 v208, s66, v208
  v_mul_f32 v209, s66, v209
  v_cvt_pk_bf16_f32 v72, v208, v209
  v_mul_f32 v210, s66, v210
  v_mul_f32 v211, s66, v211
  v_cvt_pk_bf16_f32 v73, v210, v211
  v_mul_f32 v212, s66, v212
  v_mul_f32 v213, s66, v213
  v_cvt_pk_bf16_f32 v74, v212, v213
  v_mul_f32 v214, s66, v214
  v_mul_f32 v215, s66, v215
  v_cvt_pk_bf16_f32 v75, v214, v215
  buffer_store_dwordx4 v[72:75], v8, s[40:43], s65 offen offset:2048 sc1
  v_mul_f32 v216, s66, v216
  v_mul_f32 v217, s66, v217
  v_cvt_pk_bf16_f32 v76, v216, v217
  v_mul_f32 v218, s66, v218
  v_mul_f32 v219, s66, v219
  v_cvt_pk_bf16_f32 v77, v218, v219
  v_mul_f32 v220, s66, v220
  v_mul_f32 v221, s66, v221
  v_cvt_pk_bf16_f32 v78, v220, v221
  v_mul_f32 v222, s66, v222
  v_mul_f32 v223, s66, v223
  v_cvt_pk_bf16_f32 v79, v222, v223
  buffer_store_dwordx4 v[76:79], v8, s[40:43], s65 offen offset:3072 sc1
  v_mul_f32 v224, s66, v224
  v_mul_f32 v225, s66, v225
  v_cvt_pk_bf16_f32 v64, v224, v225
  v_mul_f32 v226, s66, v226
  v_mul_f32 v227, s66, v227
  v_cvt_pk_bf16_f32 v65, v226, v227
  v_mul_f32 v228, s66, v228
  v_mul_f32 v229, s66, v229
  v_cvt_pk_bf16_f32 v66, v228, v229
  v_mul_f32 v230, s66, v230
  v_mul_f32 v231, s66, v231
  v_cvt_pk_bf16_f32 v67, v230, v231
  buffer_store_dwordx4 v[64:67], v9, s[40:43], s65 offen offset:0 sc1
  v_mul_f32 v232, s66, v232
  v_mul_f32 v233, s66, v233
  v_cvt_pk_bf16_f32 v68, v232, v233
  v_mul_f32 v234, s66, v234
  v_mul_f32 v235, s66, v235
  v_cvt_pk_bf16_f32 v69, v234, v235
  v_mul_f32 v236, s66, v236
  v_mul_f32 v237, s66, v237
  v_cvt_pk_bf16_f32 v70, v236, v237
  v_mul_f32 v238, s66, v238
  v_mul_f32 v239, s66, v239
  v_cvt_pk_bf16_f32 v71, v238, v239
  buffer_store_dwordx4 v[68:71], v9, s[40:43], s65 offen offset:1024 sc1
  v_mul_f32 v240, s66, v240
  v_mul_f32 v241, s66, v241
  v_cvt_pk_bf16_f32 v72, v240, v241
  v_mul_f32 v242, s66, v242
  v_mul_f32 v243, s66, v243
  v_cvt_pk_bf16_f32 v73, v242, v243
  v_mul_f32 v244, s66, v244
  v_mul_f32 v245, s66, v245
  v_cvt_pk_bf16_f32 v74, v244, v245
  v_mul_f32 v246, s66, v246
  v_mul_f32 v247, s66, v247
  v_cvt_pk_bf16_f32 v75, v246, v247
  buffer_store_dwordx4 v[72:75], v9, s[40:43], s65 offen offset:2048 sc1
  v_mul_f32 v248, s66, v248
  v_mul_f32 v249, s66, v249
  v_cvt_pk_bf16_f32 v76, v248, v249
  v_mul_f32 v250, s66, v250
  v_mul_f32 v251, s66, v251
  v_cvt_pk_bf16_f32 v77, v250, v251
  v_mul_f32 v252, s66, v252
  v_mul_f32 v253, s66, v253
  v_cvt_pk_bf16_f32 v78, v252, v253
  v_mul_f32 v254, s66, v254
  v_mul_f32 v255, s66, v255
  v_cvt_pk_bf16_f32 v79, v254, v255
  buffer_store_dwordx4 v[76:79], v9, s[40:43], s65 offen offset:3072 sc1
L_p_fin:
  s_waitcnt vmcnt(0) lgkmcnt(0)
  s_barrier
  s_bfe_u32 s67, s61, 0x50013
  s_lshl_b32 s67, s67, 7
  s_bfe_u32 s68, s61, 0x20004
  s_lshl_b32 s68, s68, 5
  s_or_b32 s69, s67, s68
  s_bitcmp1_b32 s61, 2
  s_cselect_b32 s69, 0x40000000, s69
  buffer_atomic_add v11, v10, s[40:43], s69 offen
  s_bfe_u32 s67, s60, 0x50013
  s_lshl_b32 s67, s67, 7
  s_bfe_u32 s68, s60, 0x20004
  s_lshl_b32 s68, s68, 5
  s_or_b32 s69, s67, s68
  s_bitcmp1_b32 s60, 2
  s_cselect_b32 s69, 0x40000000, s69
  buffer_atomic_add v11, v10, s[40:43], s69 offen
  s_sub_u32 s95, s56, 2
  s_branch L_p_end
L_p_end:
  s_branch L_next
L_go_att:
  s_bfe_u32 s56, s3, 0x50004
  s_bfe_u32 s57, s3, 0x3000c
L_att:
  v_lshlrev_b32 v2, 4, v0
  s_lshl_b32 s65, s44, 11
  v_add_u32 v3, s65, v2
  s_mov_b32 s74, 0
  v_and_b32 v6, 7, v0
  v_min_u32 v6, s57, v6
  v_mov_b32 v7, s57
  v_add_u32 v7, 8, v7
  v_cmp_gt_u32 vcc, 8, v0
  s_lshl_b32 s66, s56, 7
  s_add_u32 s66, s66, 0xd080000
  v_cndmask_b32 v6, v7, v6, vcc
  v_cndmask_b32 v7, 2, 4, vcc
  v_lshl_add_u32 v6, v6, 2, s66
  s_lshl_b32 s66, s57, 7
  s_add_u32 s66, s66, 0xd086400
  v_writelane_b32 v6, s66, 63
  v_writelane_b32 v7, 1, 63
  buffer_load_dword v24, v6, s[40:43], 0 offen sc1
  v_mov_b64 v[128:129], 0
  v_mov_b64 v[130:131], 0
  v_mov_b64 v[132:133], 0
  v_mov_b64 v[134:135], 0
  v_mov_b64 v[136:137], 0
  v_mov_b64 v[138:139], 0
  v_mov_b64 v[140:141], 0
  v_mov_b64 v[142:143], 0
  v_mov_b64 v[144:145], 0
  v_mov_b64 v[146:147], 0
  v_mov_b64 v[148:149], 0
  v_mov_b64 v[150:151], 0
  v_mov_b64 v[152:153], 0
  v_mov_b64 v[154:155], 0
  v_mov_b64 v[156:157], 0
  v_mov_b64 v[158:159], 0
  v_mov_b64 v[160:161], 0
  v_mov_b64 v[162:163], 0
  v_mov_b64 v[164:165], 0
  v_mov_b64 v[166:167], 0
  v_mov_b64 v[168:169], 0
  v_mov_b64 v[170:171], 0
  v_mov_b64 v[172:173], 0
  v_mov_b64 v[174:175], 0
  v_mov_b64 v[176:177], 0
  v_mov_b64 v[178:179], 0
  v_mov_b64 v[180:181], 0
  v_mov_b64 v[182:183], 0
  v_mov_b64 v[184:185], 0
  v_mov_b64 v[186:187], 0
  v_mov_b64 v[188:189], 0
  v_mov_b64 v[190:191], 0
  v_mov_b64 v[192:193], 0
  v_mov_b64 v[194:195], 0
  v_mov_b64 v[196:197], 0
  v_mov_b64 v[198:199], 0
  v_mov_b64 v[200:201], 0
  v_mov_b64 v[202:203], 0
  v_mov_b64 v[204:205], 0
  v_mov_b64 v[206:207], 0
  v_mov_b64 v[208:209], 0
  v_mov_b64 v[210:211], 0
  v_mov_b64 v[212:213], 0
  v_mov_b64 v[214:215], 0
  v_mov_b64 v[216:217], 0
  v_mov_b64 v[218:219], 0
  v_mov_b64 v[220:221], 0
  v_mov_b64 v[222:223], 0
  v_mov_b64 v[224:225], 0
  v_mov_b64 v[226:227], 0
  v_mov_b64 v[228:229], 0
  v_mov_b64 v[230:231], 0
  v_mov_b64 v[232:233], 0
  v_mov_b64 v[234:235], 0
  v_mov_b64 v[236:237], 0
  v_mov_b64 v[238:239], 0
  v_mov_b64 v[240:241], 0
  v_mov_b64 v[242:243], 0
  v_mov_b64 v[244:245], 0
  v_mov_b64 v[246:247], 0
  v_mov_b64 v[248:249], 0
  v_mov_b64 v[250:251], 0
  v_mov_b64 v[252:253], 0
  v_mov_b64 v[254:255], 0
  v_mov_b64 v[96:97], 0
  v_accvgpr_write_b32 a128, 0
  v_mov_b64 v[98:99], 0
  v_accvgpr_write_b32 a129, 0
  v_mov_b64 v[100:101], 0
  v_accvgpr_write_b32 a130, 0
  v_mov_b64 v[102:103], 0
  v_accvgpr_write_b32 a131, 0
  v_mov_b64 v[104:105], 0
  v_accvgpr_write_b32 a132, 0
  v_mov_b64 v[106:107], 0
  v_accvgpr_write_b32 a133, 0
  v_mov_b64 v[108:109], 0
  v_accvgpr_write_b32 a134, 0
  v_mov_b64 v[110:111], 0
  v_accvgpr_write_b32 a135, 0
  v_mov_b64 v[112:113], 0
  v_accvgpr_write_b32 a136, 0
  v_mov_b64 v[114:115], 0
  v_accvgpr_write_b32 a137, 0
  v_mov_b64 v[116:117], 0
  v_accvgpr_write_b32 a138, 0
  v_mov_b64 v[118:119], 0
  v_accvgpr_write_b32 a139, 0
  v_mov_b64 v[120:121], 0
  v_accvgpr_write_b32 a140, 0
  v_mov_b64 v[122:123], 0
  v_accvgpr_write_b32 a141, 0
  v_mov_b64 v[124:125], 0
  v_accvgpr_write_b32 a142, 0
  v_mov_b64 v[126:127], 0
  v_accvgpr_write_b32 a143, 0
  v_mov_b32 v16, 0x3f803f80
  v_mov_b32 v17, 0x3f803f80
  v_mov_b32 v18, 0x3f803f80
  v_mov_b32 v19, 0x3f803f80
  s_mov_b32 s48, s18
  s_and_b32 s49, s19, 0xffff
  s_mov_b32 s50, 0x400000
  s_mov_b32 s51, 0x20000
  s_lshl_b32 s66, s56, 19
  s_add_u32 s60, s66, 0x1000000
  s_add_u32 s61, s66, 0x2000000
  s_lshl_b32 s59, s57, 3
  s_lshr_b32 s67, s44, 1
  s_add_u32 s67, s67, s59
  s_lshl_b32 s68, s67, 13
  s_add_u32 s68, s68, s66
  s_and_b32 s67, s44, 1
  s_lshl_b32 s67, s67, 10
  s_add_u32 s68, s68, s67
  s_lshl4_add_u32 s69, s57, s44
  s_add_u32 s63, s59, 7
  s_lshl_b32 s63, s63, 13
  s_add_u32 s63, s63, s60
  s_sub_u32 s59, s59, 1
  s_add_u32 s62, s60, 0x4000
  s_mov_b32 s64, 0
  s_mov_b32 s70, 0x40004000
  s_lshl_b32 s73, s44, 12
  s_lshl_b32 s72, s56, 17
  s_lshl_b32 s67, s44, 15
  s_add_u32 s72, s72, s67
  v_lshrrev_b32 v8, 4, v0
  v_and_b32 v9, 15, v0
  s_lshl_b32 s67, s44, 4
  v_add_u32 v25, s67, v9
  v_lshlrev_b32 v10, 2, v8
  v_sub_u32 v25, v25, v10
  v_lshlrev_b32 v8, 1, v8
  v_and_b32 v10, 7, v0
  v_xor_b32 v8, v8, v10
  v_lshlrev_b32 v8, 4, v8
  v_lshrrev_b32 v10, 3, v0
  v_lshl_add_u32 v26, v10, 10, v8
  v_lshlrev_b32 v9, 2, v9
  v_add_u32 v4, 122880, v2
L_a_wait:
  s_waitcnt vmcnt(0)
  v_cmp_ne_u32 vcc, v7, v24
  s_cbranch_vccz L_a_go
  buffer_load_dword v24, v6, s[40:43], 0 offen sc1
  s_add_u32 s74, s74, 1
  s_cmp_gt_u32 s74, 1048576
  s_cbranch_scc1 L_exit
  s_branch L_a_wait
L_a_go:
  s_add_u32 m0, s65, 131072
  s_add_u32 s66, s60, 0x2000
  buffer_load_dwordx4 v3, s[40:43], s60 offen sc1 lds
  buffer_load_dwordx4 v3, s[40:43], s60 offen offset:1024 sc1 lds
  s_add_u32 m0, s65, 139264
  s_lshl_b32 s67, s69, 6
  buffer_load_dwordx4 v3, s[40:43], s66 offen sc1 lds
  buffer_load_dwordx4 v3, s[40:43], s66 offen offset:1024 sc1 lds
  s_add_u32 s67, s67, 0xd0c0000
  s_add_u32 s58, s68, 0x1000
  buffer_load_dwordx4 a[0:3], v2, s[40:43], s68 offen offset:0 sc1
  buffer_load_dwordx4 a[4:7], v2, s[40:43], s68 offen offset:2048 sc1
  buffer_load_dwordx4 a[8:11], v2, s[40:43], s58 offen offset:0 sc1
  buffer_load_dwordx4 a[12:15], v2, s[40:43], s58 offen offset:2048 sc1
  s_add_u32 s68, s68, 0x4000
  s_add_u32 s58, s68, 0x1000
  buffer_load_dwordx4 a[16:19], v2, s[40:43], s68 offen offset:0 sc1
  buffer_load_dwordx4 a[20:23], v2, s[40:43], s68 offen offset:2048 sc1
  buffer_load_dwordx4 a[24:27], v2, s[40:43], s58 offen offset:0 sc1
  buffer_load_dwordx4 a[28:31], v2, s[40:43], s58 offen offset:2048 sc1
  s_add_u32 s68, s68, 0x4000
  s_add_u32 s58, s68, 0x1000
  buffer_load_dwordx4 a[32:35], v2, s[40:43], s68 offen offset:0 sc1
  buffer_load_dwordx4 a[36:39], v2, s[40:43], s68 offen offset:2048 sc1
  buffer_load_dwordx4 a[40:43], v2, s[40:43], s58 offen offset:0 sc1
  buffer_load_dwordx4 a[44:47], v2, s[40:43], s58 offen offset:2048 sc1
  s_add_u32 s68, s68, 0x4000
  s_add_u32 s58, s68, 0x1000
  buffer_load_dwordx4 a[48:51], v2, s[40:43], s68 offen offset:0 sc1
  buffer_load_dwordx4 a[52:55], v2, s[40:43], s68 offen offset:2048 sc1
  buffer_load_dwordx4 a[56:59], v2, s[40:43], s58 offen offset:0 sc1
  buffer_load_dwordx4 a[60:63], v2, s[40:43], s58 offen offset:2048 sc1
  s_add_u32 s68, s68, 0x4000
  buffer_load_dword v20, v9, s[40:43], s67 offen offset:0 sc1
  buffer_load_dword v21, v9, s[40:43], s67 offen offset:256 sc1
  buffer_load_dword v22, v9, s[40:43], s67 offen offset:512 sc1
  buffer_load_dword v23, v9, s[40:43], s67 offen offset:768 sc1
  s_add_u32 m0, s64, s65
  s_nop 0
  buffer_load_dwordx4 v3, s[40:43], s61 offen sc1 lds
  s_min_u32 s66, s62, s63
  s_nop 0
  buffer_load_dwordx4 v3, s[40:43], s61 offen offset:1024 sc1 lds
  s_add_u32 m0, m0, 0x2000
  s_nop 0
  buffer_load_dwordx4 v3, s[40:43], s66 offen sc1 lds
  s_add_u32 s61, s61, 0x2000
  s_nop 0
  buffer_load_dwordx4 v3, s[40:43], s66 offen offset:1024 sc1 lds
  s_add_u32 s62, s62, 0x2000
  s_add_u32 s64, s64, 0x4000
  s_and_b32 s64, s64, 0x1ffff
  s_add_u32 m0, s64, s65
  s_nop 0
  buffer_load_dwordx4 v3, s[40:43], s61 offen sc1 lds
  s_min_u32 s66, s62, s63
  s_nop 0
  buffer_load_dwordx4 v3, s[40:43], s61 offen offset:1024 sc1 lds
  s_add_u32 m0, m0, 0x2000
  s_nop 0
  buffer_load_dwordx4 v3, s[40:43], s66 offen sc1 lds
  s_add_u32 s61, s61, 0x2000
  s_nop 0
  buffer_load_dwordx4 v3, s[40:43], s66 offen offset:1024 sc1 lds
  s_add_u32 s62, s62, 0x2000
  s_add_u32 s64, s64, 0x4000
  s_and_b32 s64, s64, 0x1ffff
  s_mul_i32 s69, s69, 786432
  s_lshl_b32 s67, s56, 14
  s_add_u32 s69, s69, s67
  s_add_u32 s76, s69, 0x6000000
  s_add_u32 s77, s69, 0x6300000
  s_add_u32 s78, s69, 0x6600000
  s_add_u32 s79, s69, 0x6900000
  v_mov_b32 v24, 0xff800000
  s_cmp_lg_u32 s57, 0
  s_cbranch_scc1 L_a_nomask0
  v_cmp_gt_i32 s[80:81], 0, v25
  v_cmp_gt_i32 s[82:83], 1, v25
  v_cmp_gt_i32 s[84:85], 2, v25
  v_cmp_gt_i32 s[86:87], 3, v25
  v_cndmask_b32 v96, v96, v24, s[80:81]
  v_cndmask_b32 v97, v97, v24, s[82:83]
  v_cndmask_b32 v98, v98, v24, s[84:85]
  v_cndmask_b32 v99, v99, v24, s[86:87]
  v_cmp_gt_i32 s[80:81], 16, v25
  v_cmp_gt_i32 s[82:83], 17, v25
  v_cmp_gt_i32 s[84:85], 18, v25
  v_cmp_gt_i32 s[86:87], 19, v25
  v_cndmask_b32 v100, v100, v24, s[80:81]
  v_cndmask_b32 v101, v101, v24, s[82:83]
  v_cndmask_b32 v102, v102, v24, s[84:85]
  v_cndmask_b32 v103, v103, v24, s[86:87]
L_a_nomask0:
  s_waitcnt vmcnt(28)
  s_barrier
  ds_read_b128 a[64:67], v4 offset:8192
  ds_read_b128 a[68:71], v4 offset:9216
  ds_read_b128 a[72:75], v4 offset:10240
  ds_read_b128 a[76:79], v4 offset:11264
  ds_read_b128 a[80:83], v4 offset:12288
  ds_read_b128 a[84:87], v4 offset:13312
  ds_read_b128 a[88:91], v4 offset:14336
  ds_read_b128 a[92:95], v4 offset:15360
  v_add_u32 v4, 0x2000, v4
  s_waitcnt vmcnt(24) lgkmcnt(0)
  v_mfma_f32_16x16x32_bf16 v[32:35], a[64:67], a[0:3], v[96:99]
  v_mfma_f32_16x16x32_bf16 v[32:35], a[72:75], a[4:7], v[32:35]
  v_mfma_f32_16x16x32_bf16 v[32:35], a[80:83], a[8:11], v[32:35]
  v_mfma_f32_16x16x32_bf16 v[32:35], a[88:91], a[12:15], v[32:35]
  v_mfma_f32_16x16x32_bf16 v[36:39], a[68:71], a[0:3], v[100:103]
  v_mfma_f32_16x16x32_bf16 v[36:39], a[76:79], a[4:7], v[36:39]
  v_mfma_f32_16x16x32_bf16 v[36:39], a[84:87], a[8:11], v[36:39]
  v_mfma_f32_16x16x32_bf16 v[36:39], a[92:95], a[12:15], v[36:39]
  s_waitcnt vmcnt(20) lgkmcnt(0)
  v_mfma_f32_16x16x32_bf16 v[40:43], a[64:67], a[16:19], v[104:107]
  v_mfma_f32_16x16x32_bf16 v[40:43], a[72:75], a[20:23], v[40:43]
  v_mfma_f32_16x16x32_bf16 v[40:43], a[80:83], a[24:27], v[40:43]
  v_mfma_f32_16x16x32_bf16 v[40:43], a[88:91], a[28:31], v[40:43]
  v_mfma_f32_16x16x32_bf16 v[44:47], a[68:71], a[16:19], v[108:111]
  v_mfma_f32_16x16x32_bf16 v[44:47], a[76:79], a[20:23], v[44:47]
  v_mfma_f32_16x16x32_bf16 v[44:47], a[84:87], a[24:27], v[44:47]
  v_mfma_f32_16x16x32_bf16 v[44:47], a[92:95], a[28:31], v[44:47]
  s_waitcnt vmcnt(16) lgkmcnt(0)
  v_mfma_f32_16x16x32_bf16 v[48:51], a[64:67], a[32:35], v[112:115]
  v_mfma_f32_16x16x32_bf16 v[48:51], a[72:75], a[36:39], v[48:51]
  v_mfma_f32_16x16x32_bf16 v[48:51], a[80:83], a[40:43], v[48:51]
  v_mfma_f32_16x16x32_bf16 v[48:51], a[88:91], a[44:47], v[48:51]
  v_mfma_f32_16x16x32_bf16 v[52:55], a[68:71], a[32:35], v[116:119]
  v_mfma_f32_16x16x32_bf16 v[52:55], a[76:79], a[36:39], v[52:55]
  v_mfma_f32_16x16x32_bf16 v[52:55], a[84:87], a[40:43], v[52:55]
  v_mfma_f32_16x16x32_bf16 v[52:55], a[92:95], a[44:47], v[52:55]
  s_waitcnt vmcnt(12) lgkmcnt(0)
  v_mfma_f32_16x16x32_bf16 v[56:59], a[64:67], a[48:51], v[120:123]
  v_mfma_f32_16x16x32_bf16 v[56:59], a[72:75], a[52:55], v[56:59]
  v_mfma_f32_16x16x32_bf16 v[56:59], a[80:83], a[56:59], v[56:59]
  v_mfma_f32_16x16x32_bf16 v[56:59], a[88:91], a[60:63], v[56:59]
  v_mfma_f32_16x16x32_bf16 v[60:63], a[68:71], a[48:51], v[124:127]
  v_mfma_f32_16x16x32_bf16 v[60:63], a[76:79], a[52:55], v[60:63]
  v_mfma_f32_16x16x32_bf16 v[60:63], a[84:87], a[56:59], v[60:63]
  v_mfma_f32_16x16x32_bf16 v[60:63], a[92:95], a[60:63], v[60:63]
  ds_read_b128 a[64:67], v4 offset:8192
  ds_read_b128 a[68:71], v4 offset:9216
  ds_read_b128 a[72:75], v4 offset:10240
  ds_read_b128 a[76:79], v4 offset:11264
  ds_read_b128 a[80:83], v4 offset:12288
  ds_read_b128 a[84:87], v4 offset:13312
  ds_read_b128 a[88:91], v4 offset:14336
  ds_read_b128 a[92:95], v4 offset:15360
  v_mov_b32 v4, v2
  s_add_u32 m0, s64, s65
  s_nop 0
  buffer_load_dwordx4 v3, s[40:43], s61 offen sc1 lds
  s_min_u32 s66, s62, s63
  s_nop 0
  buffer_load_dwordx4 v3, s[40:43], s61 offen offset:1024 sc1 lds
  s_add_u32 m0, m0, 0x2000
  s_nop 0
  buffer_load_dwordx4 v3, s[40:43], s66 offen sc1 lds
  s_add_u32 s61, s61, 0x2000
  s_nop 0
  buffer_load_dwordx4 v3, s[40:43], s66 offen offset:1024 sc1 lds
  s_add_u32 s62, s62, 0x2000
  s_add_u32 s64, s64, 0x4000
  s_and_b32 s64, s64, 0x1ffff
  v_max3_f32 v6, v32, v33, v34
  v_max3_f32 v7, v35, v36, v37
  v_max3_f32 v6, v6, v38, v39
  v_max_f32 v6, v6, v7
  v_mov_b32 v7, v6
  s_nop 1
  v_permlane32_swap_b32 v7, v6
  v_max_f32 v6, v6, v7
  v_mov_b32 v7, v6
  s_nop 1
  v_permlane16_swap_b32 v7, v6
  v_max_f32 v6, v6, v7
  v_add_f32 v6, 0x41800000, v6
  v_sub_f32 v96, v96, v6
  v_sub_f32 v97, v97, v6
  v_sub_f32 v98, v98, v6
  v_sub_f32 v99, v99, v6
  v_sub_f32 v100, v100, v6
  v_sub_f32 v101, v101, v6
  v_sub_f32 v102, v102, v6
  v_sub_f32 v103, v103, v6
  v_sub_f32 v8, v32, v6
  v_sub_f32 v9, v33, v6
  v_sub_f32 v10, v34, v6
  v_sub_f32 v11, v35, v6
  v_sub_f32 v12, v36, v6
  v_sub_f32 v13, v37, v6
  v_sub_f32 v14, v38, v6
  v_sub_f32 v15, v39, v6
  v_exp_f32 v8, v8
  v_exp_f32 v9, v9
  v_exp_f32 v10, v10
  v_exp_f32 v11, v11
  v_exp_f32 v12, v12
  v_exp_f32 v13, v13
  v_exp_f32 v14, v14
  v_exp_f32 v15, v15
  v_cvt_pk_bf16_f32 v64, v8, v9
  v_cvt_pk_bf16_f32 v65, v10, v11
  v_cvt_pk_bf16_f32 v66, v12, v13
  v_cvt_pk_bf16_f32 v67, v14, v15
  s_add_u32 m0, s64, s65
  s_nop 0
  buffer_load_dwordx4 v3, s[40:43], s61 offen sc1 lds
  s_min_u32 s66, s62, s63
  s_nop 0
  buffer_load_dwordx4 v3, s[40:43], s61 offen offset:1024 sc1 lds
  s_add_u32 m0, m0, 0x2000
  s_nop 0
  buffer_load_dwordx4 v3, s[40:43], s66 offen sc1 lds
  s_add_u32 s61, s61, 0x2000
  s_nop 0
  buffer_load_dwordx4 v3, s[40:43], s66 offen offset:1024 sc1 lds
  s_add_u32 s62, s62, 0x2000
  s_add_u32 s64, s64, 0x4000
  s_and_b32 s64, s64, 0x1ffff
  v_max3_f32 v6, v40, v41, v42
  v_max3_f32 v7, v43, v44, v45
  v_max3_f32 v6, v6, v46, v47
  v_max_f32 v6, v6, v7
  v_mov_b32 v7, v6
  s_nop 1
  v_permlane32_swap_b32 v7, v6
  v_max_f32 v6, v6, v7
  v_mov_b32 v7, v6
  s_nop 1
  v_permlane16_swap_b32 v7, v6
  v_max_f32 v6, v6, v7
  v_add_f32 v6, 0x41800000, v6
  v_sub_f32 v104, v104, v6
  v_sub_f32 v105, v105, v6
  v_sub_f32 v106, v106, v6
  v_sub_f32 v107, v107, v6
  v_sub_f32 v108, v108, v6
  v_sub_f32 v109, v109, v6
  v_sub_f32 v110, v110, v6
  v_sub_f32 v111, v111, v6
  v_sub_f32 v8, v40, v6
  v_sub_f32 v9, v41, v6
  v_sub_f32 v10, v42, v6
  v_sub_f32 v11, v43, v6
  v_sub_f32 v12, v44, v6
  v_sub_f32 v13, v45, v6
  v_sub_f32 v14, v46, v6
  v_sub_f32 v15, v47, v6
  v_exp_f32 v8, v8
  v_exp_f32 v9, v9
  v_exp_f32 v10, v10
  v_exp_f32 v11, v11
  v_exp_f32 v12, v12
  v_exp_f32 v13, v13
  v_exp_f32 v14, v14
  v_exp_f32 v15, v15
  v_cvt_pk_bf16_f32 v68, v8, v9
  v_cvt_pk_bf16_f32 v69, v10, v11
  v_cvt_pk_bf16_f32 v70, v12, v13
  v_cvt_pk_bf16_f32 v71, v14, v15
  s_add_u32 m0, s64, s65
  s_nop 0
  buffer_load_dwordx4 v3, s[40:43], s61 offen sc1 lds
  s_min_u32 s66, s62, s63
  s_nop 0
  buffer_load_dwordx4 v3, s[40:43], s61 offen offset:1024 sc1 lds
  s_add_u32 m0, m0, 0x2000
  s_nop 0
  buffer_load_dwordx4 v3, s[40:43], s66 offen sc1 lds
  s_add_u32 s61, s61, 0x2000
  s_nop 0
  buffer_load_dwordx4 v3, s[40:43], s66 offen offset:1024 sc1 lds
  s_add_u32 s62, s62, 0x2000
  s_add_u32 s64, s64, 0x4000
  s_and_b32 s64, s64, 0x1ffff
  v_max3_f32 v6, v48, v49, v50
  v_max3_f32 v7, v51, v52, v53
  v_max3_f32 v6, v6, v54, v55
  v_max_f32 v6, v6, v7
  v_mov_b32 v7, v6
  s_nop 1
  v_permlane32_swap_b32 v7, v6
  v_max_f32 v6, v6, v7
  v_mov_b32 v7, v6
  s_nop 1
  v_permlane16_swap_b32 v7, v6
  v_max_f32 v6, v6, v7
  v_add_f32 v6, 0x41800000, v6
  v_sub_f32 v112, v112, v6
  v_sub_f32 v113, v113, v6
  v_sub_f32 v114, v114, v6
  v_sub_f32 v115, v115, v6
  v_sub_f32 v116, v116, v6
  v_sub_f32 v117, v117, v6
  v_sub_f32 v118, v118, v6
  v_sub_f32 v119, v119, v6
  v_sub_f32 v8, v48, v6
  v_sub_f32 v9, v49, v6
  v_sub_f32 v10, v50, v6
  v_sub_f32 v11, v51, v6
  v_sub_f32 v12, v52, v6
  v_sub_f32 v13, v53, v6
  v_sub_f32 v14, v54, v6
  v_sub_f32 v15, v55, v6
  v_exp_f32 v8, v8
  v_exp_f32 v9, v9
  v_exp_f32 v10, v10
  v_exp_f32 v11, v11
  v_exp_f32 v12, v12
  v_exp_f32 v13, v13
  v_exp_f32 v14, v14
  v_exp_f32 v15, v15
  v_cvt_pk_bf16_f32 v72, v8, v9
  v_cvt_pk_bf16_f32 v73, v10, v11
  v_cvt_pk_bf16_f32 v74, v12, v13
  v_cvt_pk_bf16_f32 v75, v14, v15
  s_add_u32 m0, s64, s65
  s_nop 0
  buffer_load_dwordx4 v3, s[40:43], s61 offen sc1 lds
  s_min_u32 s66, s62, s63
  s_nop 0
  buffer_load_dwordx4 v3, s[40:43], s61 offen offset:1024 sc1 lds
  s_add_u32 m0, m0, 0x2000
  s_nop 0
  buffer_load_dwordx4 v3, s[40:43], s66 offen sc1 lds
  s_add_u32 s61, s61, 0x2000
  s_nop 0
  buffer_load_dwordx4 v3, s[40:43], s66 offen offset:1024 sc1 lds
  s_add_u32 s62, s62, 0x2000
  s_add_u32 s64, s64, 0x4000
  s_and_b32 s64, s64, 0x1ffff
  v_max3_f32 v6, v56, v57, v58
  v_max3_f32 v7, v59, v60, v61
  v_max3_f32 v6, v6, v62, v63
  v_max_f32 v6, v6, v7
  v_mov_b32 v7, v6
  s_nop 1
  v_permlane32_swap_b32 v7, v6
  v_max_f32 v6, v6, v7
  v_mov_b32 v7, v6
  s_nop 1
  v_permlane16_swap_b32 v7, v6
  v_max_f32 v6, v6, v7
  v_add_f32 v6, 0x41800000, v6
  v_sub_f32 v120, v120, v6
  v_sub_f32 v121, v121, v6
  v_sub_f32 v122, v122, v6
  v_sub_f32 v123, v123, v6
  v_sub_f32 v124, v124, v6
  v_sub_f32 v125, v125, v6
  v_sub_f32 v126, v126, v6
  v_sub_f32 v127, v127, v6
  v_sub_f32 v8, v56, v6
  v_sub_f32 v9, v57, v6
  v_sub_f32 v10, v58, v6
  v_sub_f32 v11, v59, v6
  v_sub_f32 v12, v60, v6
  v_sub_f32 v13, v61, v6
  v_sub_f32 v14, v62, v6
  v_sub_f32 v15, v63, v6
  v_exp_f32 v8, v8
  v_exp_f32 v9, v9
  v_exp_f32 v10, v10
  v_exp_f32 v11, v11
  v_exp_f32 v12, v12
  v_exp_f32 v13, v13
  v_exp_f32 v14, v14
  v_exp_f32 v15, v15
  v_cvt_pk_bf16_f32 v76, v8, v9
  v_cvt_pk_bf16_f32 v77, v10, v11
  v_cvt_pk_bf16_f32 v78, v12, v13
  v_cvt_pk_bf16_f32 v79, v14, v15
  s_add_u32 m0, s64, s65
  s_nop 0
  buffer_load_dwordx4 v3, s[40:43], s61 offen sc1 lds
  s_min_u32 s66, s62, s63
  s_nop 0
  buffer_load_dwordx4 v3, s[40:43], s61 offen offset:1024 sc1 lds
  s_add_u32 m0, m0, 0x2000
  s_nop 0
  buffer_load_dwordx4 v3, s[40:43], s66 offen sc1 lds
  s_add_u32 s61, s61, 0x2000
  s_nop 0
  buffer_load_dwordx4 v3, s[40:43], s66 offen offset:1024 sc1 lds
  s_add_u32 s62, s62, 0x2000
  s_add_u32 s64, s64, 0x4000
  s_and_b32 s64, s64, 0x1ffff
  s_mov_b32 s58, 0
  s_cmp_lg_u32 s57, 0
  s_cbranch_scc1 L_a_s0
  v_cmp_gt_i32 s[80:81], 32, v25
  v_cmp_gt_i32 s[82:83], 33, v25
  v_cmp_gt_i32 s[84:85], 34, v25
  v_cmp_gt_i32 s[86:87], 35, v25
  v_cndmask_b32 v96, v96, v24, s[80:81]
  v_cndmask_b32 v97, v97, v24, s[82:83]
  v_cndmask_b32 v98, v98, v24, s[84:85]
  v_cndmask_b32 v99, v99, v24, s[86:87]
  v_cmp_gt_i32 s[80:81], 48, v25
  v_cmp_gt_i32 s[82:83], 49, v25
  v_cmp_gt_i32 s[84:85], 50, v25
  v_cmp_gt_i32 s[86:87], 51, v25
  v_cndmask_b32 v100, v100, v24, s[80:81]
  v_cndmask_b32 v101, v101, v24, s[82:83]
  v_cndmask_b32 v102, v102, v24, s[84:85]
  v_cndmask_b32 v103, v103, v24, s[86:87]
  s_branch L_a_d1
L_a_s1:
  s_waitcnt vmcnt(24) lgkmcnt(0)
  v_mfma_f32_16x16x32_bf16 v[32:35], a[64:67], a[0:3], v[96:99]
  s_barrier
  ds_read_b128 a[96:99], v4 offset:0
  v_mfma_f32_16x16x32_bf16 v[32:35], a[72:75], a[4:7], v[32:35]
  s_nop 0
  ds_read_b128 a[100:103], v4 offset:1024
  v_mfma_f32_16x16x32_bf16 v[32:35], a[80:83], a[8:11], v[32:35]
  s_nop 0
  ds_read_b128 a[104:107], v4 offset:2048
  v_mfma_f32_16x16x32_bf16 v[32:35], a[88:91], a[12:15], v[32:35]
  s_nop 0
  ds_read_b128 a[108:111], v4 offset:3072
  v_mfma_f32_16x16x32_bf16 v[36:39], a[68:71], a[0:3], v[100:103]
  s_nop 0
  ds_read_b128 a[112:115], v4 offset:4096
  v_mfma_f32_16x16x32_bf16 v[36:39], a[76:79], a[4:7], v[36:39]
  s_nop 0
  ds_read_b128 a[116:119], v4 offset:5120
  v_mfma_f32_16x16x32_bf16 v[36:39], a[84:87], a[8:11], v[36:39]
  s_nop 0
  ds_read_b128 a[120:123], v4 offset:6144
  v_mfma_f32_16x16x32_bf16 v[36:39], a[92:95], a[12:15], v[36:39]
  s_nop 0
  ds_read_b128 a[124:127], v4 offset:7168
  v_mfma_f32_16x16x32_bf16 v[40:43], a[64:67], a[16:19], v[104:107]
  s_nop 0
  v_exp_f32 v8, v32
  v_mfma_f32_16x16x32_bf16 v[40:43], a[72:75], a[20:23], v[40:43]
  s_nop 0
  v_exp_f32 v9, v33
  v_mfma_f32_16x16x32_bf16 v[40:43], a[80:83], a[24:27], v[40:43]
  s_nop 0
  v_exp_f32 v10, v34
  v_mfma_f32_16x16x32_bf16 v[40:43], a[88:91], a[28:31], v[40:43]
  s_nop 0
  v_exp_f32 v11, v35
  v_mfma_f32_16x16x32_bf16 v[44:47], a[68:71], a[16:19], v[108:111]
  s_nop 0
  v_cvt_pk_bf16_f32 v64, v8, v9
  v_cvt_pk_bf16_f32 v65, v10, v11
  v_mfma_f32_16x16x32_bf16 v[44:47], a[76:79], a[20:23], v[44:47]
  s_nop 0
  v_or_b32 v5, v64, v65
  v_mfma_f32_16x16x32_bf16 v[44:47], a[84:87], a[24:27], v[44:47]
  s_nop 0
  v_exp_f32 v12, v36
  v_mfma_f32_16x16x32_bf16 v[44:47], a[92:95], a[28:31], v[44:47]
  s_nop 0
  v_exp_f32 v13, v37
  v_mfma_f32_16x16x32_bf16 v[48:51], a[64:67], a[32:35], v[112:115]
  s_nop 0
  v_exp_f32 v14, v38
  v_mfma_f32_16x16x32_bf16 v[48:51], a[72:75], a[36:39], v[48:51]
  s_nop 0
  v_exp_f32 v15, v39
  v_mfma_f32_16x16x32_bf16 v[48:51], a[80:83], a[40:43], v[48:51]
  s_nop 0
  v_cvt_pk_bf16_f32 v66, v12, v13
  v_cvt_pk_bf16_f32 v67, v14, v15
  v_mfma_f32_16x16x32_bf16 v[48:51], a[88:91], a[44:47], v[48:51]
  s_add_u32 m0, s64, s65
  s_nop 0
  buffer_load_dwordx4 v3, s[40:43], s61 offen sc1 lds
  v_or3_b32 v5, v5, v66, v67
  v_mfma_f32_16x16x32_bf16 v[52:55], a[68:71], a[32:35], v[116:119]
  s_nop 0
  v_exp_f32 v8, v40
  v_mfma_f32_16x16x32_bf16 v[52:55], a[76:79], a[36:39], v[52:55]
  s_nop 0
  v_exp_f32 v9, v41
  v_mfma_f32_16x16x32_bf16 v[52:55], a[84:87], a[40:43], v[52:55]
  s_min_u32 s66, s62, s63
  buffer_load_dwordx4 v3, s[40:43], s61 offen offset:1024 sc1 lds
  v_mfma_f32_16x16x32_bf16 v[52:55], a[92:95], a[44:47], v[52:55]
  s_nop 0
  v_exp_f32 v10, v42
  v_mfma_f32_16x16x32_bf16 v[56:59], a[64:67], a[48:51], v[120:123]
  s_nop 0
  v_exp_f32 v11, v43
  v_mfma_f32_16x16x32_bf16 v[56:59], a[72:75], a[52:55], v[56:59]
  s_add_u32 m0, m0, 0x2000
  s_nop 0
  buffer_load_dwordx4 v3, s[40:43], s66 offen sc1 lds
  v_cvt_pk_bf16_f32 v68, v8, v9
  v_mfma_f32_16x16x32_bf16 v[56:59], a[80:83], a[56:59], v[56:59]
  s_nop 0
  v_cvt_pk_bf16_f32 v69, v10, v11
  v_or3_b32 v5, v5, v68, v69
  v_mfma_f32_16x16x32_bf16 v[56:59], a[88:91], a[60:63], v[56:59]
  s_nop 0
  v_exp_f32 v12, v44
  v_mfma_f32_16x16x32_bf16 v[60:63], a[68:71], a[48:51], v[124:127]
  s_add_u32 s61, s61, 0x2000
  buffer_load_dwordx4 v3, s[40:43], s66 offen offset:1024 sc1 lds
  v_mfma_f32_16x16x32_bf16 v[60:63], a[76:79], a[52:55], v[60:63]
  s_add_u32 s62, s62, 0x2000
  v_exp_f32 v13, v45
  v_mfma_f32_16x16x32_bf16 v[60:63], a[84:87], a[56:59], v[60:63]
  s_add_u32 s64, s64, 0x4000
  v_exp_f32 v14, v46
  v_mfma_f32_16x16x32_bf16 v[60:63], a[92:95], a[60:63], v[60:63]
  s_and_b32 s64, s64, 0x1ffff
  v_exp_f32 v15, v47
  v_mfma_f32_16x16x32_bf16 a[128:131], v[16:19], v[80:83], a[128:131]
  s_add_u32 s58, s58, 1
  v_cvt_pk_bf16_f32 v70, v12, v13
  v_cvt_pk_bf16_f32 v71, v14, v15
  v_mfma_f32_16x16x32_bf16 a[132:135], v[16:19], v[84:87], a[132:135]
  s_nop 0
  ds_read_b128 a[64:67], v4 offset:8192
  v_or3_b32 v5, v5, v70, v71
  v_mfma_f32_16x16x32_bf16 a[136:139], v[16:19], v[88:91], a[136:139]
  s_nop 0
  v_exp_f32 v8, v48
  v_mfma_f32_16x16x32_bf16 a[140:143], v[16:19], v[92:95], a[140:143]
  s_nop 0
  v_exp_f32 v9, v49
  s_waitcnt lgkmcnt(1)
  v_mfma_f32_16x16x32_bf16 v[128:131], a[96:99], v[80:83], v[128:131]
  ds_read_b128 a[68:71], v4 offset:9216
  v_mfma_f32_16x16x32_bf16 v[160:163], a[96:99], v[84:87], v[160:163]
  v_exp_f32 v10, v50
  v_mfma_f32_16x16x32_bf16 v[192:195], a[96:99], v[88:91], v[192:195]
  v_exp_f32 v11, v51
  v_mfma_f32_16x16x32_bf16 v[224:227], a[96:99], v[92:95], v[224:227]
  ds_read_b128 a[72:75], v4 offset:10240
  v_cvt_pk_bf16_f32 v72, v8, v9
  v_mfma_f32_16x16x32_bf16 v[132:135], a[100:103], v[80:83], v[132:135]
  v_cvt_pk_bf16_f32 v73, v10, v11
  v_or3_b32 v5, v5, v72, v73
  v_mfma_f32_16x16x32_bf16 v[164:167], a[100:103], v[84:87], v[164:167]
  v_exp_f32 v12, v52
  v_mfma_f32_16x16x32_bf16 v[196:199], a[100:103], v[88:91], v[196:199]
  ds_read_b128 a[76:79], v4 offset:11264
  v_mfma_f32_16x16x32_bf16 v[228:231], a[100:103], v[92:95], v[228:231]
  v_exp_f32 v13, v53
  v_mfma_f32_16x16x32_bf16 v[136:139], a[104:107], v[80:83], v[136:139]
  v_exp_f32 v14, v54
  v_mfma_f32_16x16x32_bf16 v[168:171], a[104:107], v[84:87], v[168:171]
  ds_read_b128 a[80:83], v4 offset:12288
  v_mfma_f32_16x16x32_bf16 v[200:203], a[104:107], v[88:91], v[200:203]
  v_exp_f32 v15, v55
  v_mfma_f32_16x16x32_bf16 v[232:235], a[104:107], v[92:95], v[232:235]
  v_cvt_pk_bf16_f32 v74, v12, v13
  v_cvt_pk_bf16_f32 v75, v14, v15
  v_mfma_f32_16x16x32_bf16 v[140:143], a[108:111], v[80:83], v[140:143]
  ds_read_b128 a[84:87], v4 offset:13312
  v_or3_b32 v5, v5, v74, v75
  v_mfma_f32_16x16x32_bf16 v[172:175], a[108:111], v[84:87], v[172:175]
  v_exp_f32 v8, v56
  v_mfma_f32_16x16x32_bf16 v[204:207], a[108:111], v[88:91], v[204:207]
  v_exp_f32 v9, v57
  v_mfma_f32_16x16x32_bf16 v[236:239], a[108:111], v[92:95], v[236:239]
  ds_read_b128 a[88:91], v4 offset:14336
  v_mfma_f32_16x16x32_bf16 v[144:147], a[112:115], v[80:83], v[144:147]
  v_exp_f32 v10, v58
  v_mfma_f32_16x16x32_bf16 v[176:179], a[112:115], v[84:87], v[176:179]
  v_exp_f32 v11, v59
  v_mfma_f32_16x16x32_bf16 v[208:211], a[112:115], v[88:91], v[208:211]
  ds_read_b128 a[92:95], v4 offset:15360
  v_cvt_pk_bf16_f32 v76, v8, v9
  v_mfma_f32_16x16x32_bf16 v[240:243], a[112:115], v[92:95], v[240:243]
  v_cvt_pk_bf16_f32 v77, v10, v11
  v_or3_b32 v5, v5, v76, v77
  v_mfma_f32_16x16x32_bf16 v[148:151], a[116:119], v[80:83], v[148:151]
  v_exp_f32 v12, v60
  v_mfma_f32_16x16x32_bf16 v[180:183], a[116:119], v[84:87], v[180:183]
  v_exp_f32 v13, v61
  v_mfma_f32_16x16x32_bf16 v[212:215], a[116:119], v[88:91], v[212:215]
  v_exp_f32 v14, v62
  v_mfma_f32_16x16x32_bf16 v[244:247], a[116:119], v[92:95], v[244:247]
  v_exp_f32 v15, v63
  v_mfma_f32_16x16x32_bf16 v[152:155], a[120:123], v[80:83], v[152:155]
  v_cvt_pk_bf16_f32 v78, v12, v13
  v_cvt_pk_bf16_f32 v79, v14, v15
  v_mfma_f32_16x16x32_bf16 v[184:187], a[120:123], v[84:87], v[184:187]
  v_or3_b32 v5, v5, v78, v79
  v_and_b32 v5, s70, v5
  v_mfma_f32_16x16x32_bf16 v[216:219], a[120:123], v[88:91], v[216:219]
  v_cmp_ne_u32 vcc, 0, v5
  v_add_u32 v4, 0x4000, v4
  v_mfma_f32_16x16x32_bf16 v[248:251], a[120:123], v[92:95], v[248:251]
  v_and_b32 v4, 0x1ffff, v4
  v_mfma_f32_16x16x32_bf16 v[156:159], a[124:127], v[80:83], v[156:159]
  v_mfma_f32_16x16x32_bf16 v[188:191], a[124:127], v[84:87], v[188:191]
  v_mfma_f32_16x16x32_bf16 v[220:223], a[124:127], v[88:91], v[220:223]
  v_mfma_f32_16x16x32_bf16 v[252:255], a[124:127], v[92:95], v[252:255]
  s_cbranch_vccnz L_a_s1_t
L_a_s1_r:
L_a_s0:
  s_waitcnt vmcnt(24) lgkmcnt(0)
  v_mfma_f32_16x16x32_bf16 v[32:35], a[64:67], a[0:3], v[96:99]
  s_barrier
  ds_read_b128 a[96:99], v4 offset:0
  v_mfma_f32_16x16x32_bf16 v[32:35], a[72:75], a[4:7], v[32:35]
  s_nop 0
  ds_read_b128 a[100:103], v4 offset:1024
  v_mfma_f32_16x16x32_bf16 v[32:35], a[80:83], a[8:11], v[32:35]
  s_nop 0
  ds_read_b128 a[104:107], v4 offset:2048
  v_mfma_f32_16x16x32_bf16 v[32:35], a[88:91], a[12:15], v[32:35]
  s_nop 0
  ds_read_b128 a[108:111], v4 offset:3072
  v_mfma_f32_16x16x32_bf16 v[36:39], a[68:71], a[0:3], v[100:103]
  s_nop 0
  ds_read_b128 a[112:115], v4 offset:4096
  v_mfma_f32_16x16x32_bf16 v[36:39], a[76:79], a[4:7], v[36:39]
  s_nop 0
  ds_read_b128 a[116:119], v4 offset:5120
  v_mfma_f32_16x16x32_bf16 v[36:39], a[84:87], a[8:11], v[36:39]
  s_nop 0
  ds_read_b128 a[120:123], v4 offset:6144
  v_mfma_f32_16x16x32_bf16 v[36:39], a[92:95], a[12:15], v[36:39]
  s_nop 0
  ds_read_b128 a[124:127], v4 offset:7168
  v_mfma_f32_16x16x32_bf16 v[40:43], a[64:67], a[16:19], v[104:107]
  s_nop 0
  v_exp_f32 v8, v32
  v_mfma_f32_16x16x32_bf16 v[40:43], a[72:75], a[20:23], v[40:43]
  s_nop 0
  v_exp_f32 v9, v33
  v_mfma_f32_16x16x32_bf16 v[40:43], a[80:83], a[24:27], v[40:43]
  s_nop 0
  v_exp_f32 v10, v34
  v_mfma_f32_16x16x32_bf16 v[40:43], a[88:91], a[28:31], v[40:43]
  s_nop 0
  v_exp_f32 v11, v35
  v_mfma_f32_16x16x32_bf16 v[44:47], a[68:71], a[16:19], v[108:111]
  s_nop 0
  v_cvt_pk_bf16_f32 v80, v8, v9
  v_cvt_pk_bf16_f32 v81, v10, v11
  v_mfma_f32_16x16x32_bf16 v[44:47], a[76:79], a[20:23], v[44:47]
  s_nop 0
  v_or_b32 v5, v80, v81
  v_mfma_f32_16x16x32_bf16 v[44:47], a[84:87], a[24:27], v[44:47]
  s_nop 0
  v_exp_f32 v12, v36
  v_mfma_f32_16x16x32_bf16 v[44:47], a[92:95], a[28:31], v[44:47]
  s_nop 0
  v_exp_f32 v13, v37
  v_mfma_f32_16x16x32_bf16 v[48:51], a[64:67], a[32:35], v[112:115]
  s_nop 0
  v_exp_f32 v14, v38
  v_mfma_f32_16x16x32_bf16 v[48:51], a[72:75], a[36:39], v[48:51]
  s_nop 0
  v_exp_f32 v15, v39
  v_mfma_f32_16x16x32_bf16 v[48:51], a[80:83], a[40:43], v[48:51]
  s_nop 0
  v_cvt_pk_bf16_f32 v82, v12, v13
  v_cvt_pk_bf16_f32 v83, v14, v15
  v_mfma_f32_16x16x32_bf16 v[48:51], a[88:91], a[44:47], v[48:51]
  s_add_u32 m0, s64, s65
  s_nop 0
  buffer_load_dwordx4 v3, s[40:43], s61 offen sc1 lds
  v_or3_b32 v5, v5, v82, v83
  v_mfma_f32_16x16x32_bf16 v[52:55], a[68:71], a[32:35], v[116:119]
  s_nop 0
  v_exp_f32 v8, v40
  v_mfma_f32_16x16x32_bf16 v[52:55], a[76:79], a[36:39], v[52:55]
  s_nop 0
  v_exp_f32 v9, v41
  v_mfma_f32_16x16x32_bf16 v[52:55], a[84:87], a[40:43], v[52:55]
  s_min_u32 s66, s62, s63
  buffer_load_dwordx4 v3, s[40:43], s61 offen offset:1024 sc1 lds
  v_mfma_f32_16x16x32_bf16 v[52:55], a[92:95], a[44:47], v[52:55]
  s_nop 0
  v_exp_f32 v10, v42
  v_mfma_f32_16x16x32_bf16 v[56:59], a[64:67], a[48:51], v[120:123]
  s_nop 0
  v_exp_f32 v11, v43
  v_mfma_f32_16x16x32_bf16 v[56:59], a[72:75], a[52:55], v[56:59]
  s_add_u32 m0, m0, 0x2000
  s_nop 0
  buffer_load_dwordx4 v3, s[40:43], s66 offen sc1 lds
  v_cvt_pk_bf16_f32 v84, v8, v9
  v_mfma_f32_16x16x32_bf16 v[56:59], a[80:83], a[56:59], v[56:59]
  s_nop 0
  v_cvt_pk_bf16_f32 v85, v10, v11
  v_or3_b32 v5, v5, v84, v85
  v_mfma_f32_16x16x32_bf16 v[56:59], a[88:91], a[60:63], v[56:59]
  s_nop 0
  v_exp_f32 v12, v44
  v_mfma_f32_16x16x32_bf16 v[60:63], a[68:71], a[48:51], v[124:127]
  s_add_u32 s61, s61, 0x2000
  buffer_load_dwordx4 v3, s[40:43], s66 offen offset:1024 sc1 lds
  v_mfma_f32_16x16x32_bf16 v[60:63], a[76:79], a[52:55], v[60:63]
  s_add_u32 s62, s62, 0x2000
  v_exp_f32 v13, v45
  v_mfma_f32_16x16x32_bf16 v[60:63], a[84:87], a[56:59], v[60:63]
  s_add_u32 s64, s64, 0x4000
  v_exp_f32 v14, v46
  v_mfma_f32_16x16x32_bf16 v[60:63], a[92:95], a[60:63], v[60:63]
  s_and_b32 s64, s64, 0x1ffff
  v_exp_f32 v15, v47
  v_mfma_f32_16x16x32_bf16 a[128:131], v[16:19], v[64:67], a[128:131]
  s_add_u32 s58, s58, 1
  v_cvt_pk_bf16_f32 v86, v12, v13
  v_cvt_pk_bf16_f32 v87, v14, v15
  v_mfma_f32_16x16x32_bf16 a[132:135], v[16:19], v[68:71], a[132:135]
  s_nop 0
  ds_read_b128 a[64:67], v4 offset:8192
  v_or3_b32 v5, v5, v86, v87
  v_mfma_f32_16x16x32_bf16 a[136:139], v[16:19], v[72:75], a[136:139]
  s_nop 0
  v_exp_f32 v8, v48
  v_mfma_f32_16x16x32_bf16 a[140:143], v[16:19], v[76:79], a[140:143]
  s_nop 0
  v_exp_f32 v9, v49
  s_waitcnt lgkmcnt(1)
  v_mfma_f32_16x16x32_bf16 v[128:131], a[96:99], v[64:67], v[128:131]
  ds_read_b128 a[68:71], v4 offset:9216
  v_mfma_f32_16x16x32_bf16 v[160:163], a[96:99], v[68:71], v[160:163]
  v_exp_f32 v10, v50
  v_mfma_f32_16x16x32_bf16 v[192:195], a[96:99], v[72:75], v[192:195]
  v_exp_f32 v11, v51
  v_mfma_f32_16x16x32_bf16 v[224:227], a[96:99], v[76:79], v[224:227]
  ds_read_b128 a[72:75], v4 offset:10240
  v_cvt_pk_bf16_f32 v88, v8, v9
  v_mfma_f32_16x16x32_bf16 v[132:135], a[100:103], v[64:67], v[132:135]
  v_cvt_pk_bf16_f32 v89, v10, v11
  v_or3_b32 v5, v5, v88, v89
  v_mfma_f32_16x16x32_bf16 v[164:167], a[100:103], v[68:71], v[164:167]
  v_exp_f32 v12, v52
  v_mfma_f32_16x16x32_bf16 v[196:199], a[100:103], v[72:75], v[196:199]
  ds_read_b128 a[76:79], v4 offset:11264
  v_mfma_f32_16x16x32_bf16 v[228:231], a[100:103], v[76:79], v[228:231]
  v_exp_f32 v13, v53
  v_mfma_f32_16x16x32_bf16 v[136:139], a[104:107], v[64:67], v[136:139]
  v_exp_f32 v14, v54
  v_mfma_f32_16x16x32_bf16 v[168:171], a[104:107], v[68:71], v[168:171]
  ds_read_b128 a[80:83], v4 offset:12288
  v_mfma_f32_16x16x32_bf16 v[200:203], a[104:107], v[72:75], v[200:203]
  v_exp_f32 v15, v55
  v_mfma_f32_16x16x32_bf16 v[232:235], a[104:107], v[76:79], v[232:235]
  v_cvt_pk_bf16_f32 v90, v12, v13
  v_cvt_pk_bf16_f32 v91, v14, v15
  v_mfma_f32_16x16x32_bf16 v[140:143], a[108:111], v[64:67], v[140:143]
  ds_read_b128 a[84:87], v4 offset:13312
  v_or3_b32 v5, v5, v90, v91
  v_mfma_f32_16x16x32_bf16 v[172:175], a[108:111], v[68:71], v[172:175]
  v_exp_f32 v8, v56
  v_mfma_f32_16x16x32_bf16 v[204:207], a[108:111], v[72:75], v[204:207]
  v_exp_f32 v9, v57
  v_mfma_f32_16x16x32_bf16 v[236:239], a[108:111], v[76:79], v[236:239]
  ds_read_b128 a[88:91], v4 offset:14336
  v_mfma_f32_16x16x32_bf16 v[144:147], a[112:115], v[64:67], v[144:147]
  v_exp_f32 v10, v58
  v_mfma_f32_16x16x32_bf16 v[176:179], a[112:115], v[68:71], v[176:179]
  v_exp_f32 v11, v59
  v_mfma_f32_16x16x32_bf16 v[208:211], a[112:115], v[72:75], v[208:211]
  ds_read_b128 a[92:95], v4 offset:15360
  v_cvt_pk_bf16_f32 v92, v8, v9
  v_mfma_f32_16x16x32_bf16 v[240:243], a[112:115], v[76:79], v[240:243]
  v_cvt_pk_bf16_f32 v93, v10, v11
  v_or3_b32 v5, v5, v92, v93
  v_mfma_f32_16x16x32_bf16 v[148:151], a[116:119], v[64:67], v[148:151]
  v_exp_f32 v12, v60
  v_mfma_f32_16x16x32_bf16 v[180:183], a[116:119], v[68:71], v[180:183]
  v_exp_f32 v13, v61
  v_mfma_f32_16x16x32_bf16 v[212:215], a[116:119], v[72:75], v[212:215]
  v_exp_f32 v14, v62
  v_mfma_f32_16x16x32_bf16 v[244:247], a[116:119], v[76:79], v[244:247]
  v_exp_f32 v15, v63
  v_mfma_f32_16x16x32_bf16 v[152:155], a[120:123], v[64:67], v[152:155]
  v_cvt_pk_bf16_f32 v94, v12, v13
  v_cvt_pk_bf16_f32 v95, v14, v15
  v_mfma_f32_16x16x32_bf16 v[184:187], a[120:123], v[68:71], v[184:187]
  v_or3_b32 v5, v5, v94, v95
  v_and_b32 v5, s70, v5
  v_mfma_f32_16x16x32_bf16 v[216:219], a[120:123], v[72:75], v[216:219]
  v_cmp_ne_u32 vcc, 0, v5
  v_add_u32 v4, 0x4000, v4
  v_mfma_f32_16x16x32_bf16 v[248:251], a[120:123], v[76:79], v[248:251]
  v_and_b32 v4, 0x1ffff, v4
  v_mfma_f32_16x16x32_bf16 v[156:159], a[124:127], v[64:67], v[156:159]
  v_mfma_f32_16x16x32_bf16 v[188:191], a[124:127], v[68:71], v[188:191]
  v_mfma_f32_16x16x32_bf16 v[220:223], a[124:127], v[72:75], v[220:223]
  v_mfma_f32_16x16x32_bf16 v[252:255], a[124:127], v[76:79], v[252:255]
  s_cbranch_vccnz L_a_s0_t
L_a_s0_r:
  s_cmp_eq_u32 s58, s59
  s_cbranch_scc0 L_a_s1
  v_cmp_gt_i32 s[80:81], 0, v25
  v_cmp_gt_i32 s[82:83], 1, v25
  v_cmp_gt_i32 s[84:85], 2, v25
  v_cmp_gt_i32 s[86:87], 3, v25
  v_cndmask_b32 v96, v96, v24, s[80:81]
  v_cndmask_b32 v97, v97, v24, s[82:83]
  v_cndmask_b32 v98, v98, v24, s[84:85]
  v_cndmask_b32 v99, v99, v24, s[86:87]
  v_cmp_gt_i32 s[80:81], 16, v25
  v_cmp_gt_i32 s[82:83], 17, v25
  v_cmp_gt_i32 s[84:85], 18, v25
  v_cmp_gt_i32 s[86:87], 19, v25
  v_cndmask_b32 v100, v100, v24, s[80:81]
  v_cndmask_b32 v101, v101, v24, s[82:83]
  v_cndmask_b32 v102, v102, v24, s[84:85]
  v_cndmask_b32 v103, v103, v24, s[86:87]
  s_nop 0
L_a_d0:
  s_waitcnt vmcnt(24) lgkmcnt(0)
  v_mfma_f32_16x16x32_bf16 v[32:35], a[64:67], a[0:3], v[96:99]
  s_barrier
  ds_read_b128 a[96:99], v4 offset:0
  v_mfma_f32_16x16x32_bf16 v[32:35], a[72:75], a[4:7], v[32:35]
  s_nop 0
  ds_read_b128 a[100:103], v4 offset:1024
  v_mfma_f32_16x16x32_bf16 v[32:35], a[80:83], a[8:11], v[32:35]
  s_nop 0
  ds_read_b128 a[104:107], v4 offset:2048
  v_mfma_f32_16x16x32_bf16 v[32:35], a[88:91], a[12:15], v[32:35]
  s_nop 0
  ds_read_b128 a[108:111], v4 offset:3072
  v_mfma_f32_16x16x32_bf16 v[36:39], a[68:71], a[0:3], v[100:103]
  s_nop 0
  ds_read_b128 a[112:115], v4 offset:4096
  v_mfma_f32_16x16x32_bf16 v[36:39], a[76:79], a[4:7], v[36:39]
  s_nop 0
  ds_read_b128 a[116:119], v4 offset:5120
  v_mfma_f32_16x16x32_bf16 v[36:39], a[84:87], a[8:11], v[36:39]
  s_nop 0
  ds_read_b128 a[120:123], v4 offset:6144
  v_mfma_f32_16x16x32_bf16 v[36:39], a[92:95], a[12:15], v[36:39]
  s_nop 0
  ds_read_b128 a[124:127], v4 offset:7168
  v_mfma_f32_16x16x32_bf16 v[40:43], a[64:67], a[16:19], v[104:107]
  s_nop 0
  v_exp_f32 v8, v32
  v_mfma_f32_16x16x32_bf16 v[40:43], a[72:75], a[20:23], v[40:43]
  s_nop 0
  v_exp_f32 v9, v33
  v_mfma_f32_16x16x32_bf16 v[40:43], a[80:83], a[24:27], v[40:43]
  s_nop 0
  v_exp_f32 v10, v34
  v_mfma_f32_16x16x32_bf16 v[40:43], a[88:91], a[28:31], v[40:43]
  s_nop 0
  v_exp_f32 v11, v35
  v_mfma_f32_16x16x32_bf16 v[44:47], a[68:71], a[16:19], v[108:111]
  s_nop 0
  v_cvt_pk_bf16_f32 v64, v8, v9
  v_cvt_pk_bf16_f32 v65, v10, v11
  v_mfma_f32_16x16x32_bf16 v[44:47], a[76:79], a[20:23], v[44:47]
  s_nop 0
  v_or_b32 v5, v64, v65
  v_mfma_f32_16x16x32_bf16 v[44:47], a[84:87], a[24:27], v[44:47]
  s_nop 0
  v_exp_f32 v12, v36
  v_mfma_f32_16x16x32_bf16 v[44:47], a[92:95], a[28:31], v[44:47]
  s_nop 0
  v_exp_f32 v13, v37
  v_mfma_f32_16x16x32_bf16 v[48:51], a[64:67], a[32:35], v[112:115]
  s_nop 0
  v_exp_f32 v14, v38
  v_mfma_f32_16x16x32_bf16 v[48:51], a[72:75], a[36:39], v[48:51]
  s_nop 0
  v_exp_f32 v15, v39
  v_mfma_f32_16x16x32_bf16 v[48:51], a[80:83], a[40:43], v[48:51]
  s_nop 0
  v_cvt_pk_bf16_f32 v66, v12, v13
  v_cvt_pk_bf16_f32 v67, v14, v15
  v_mfma_f32_16x16x32_bf16 v[48:51], a[88:91], a[44:47], v[48:51]
  s_add_u32 m0, s64, s65
  s_nop 0
  buffer_load_dwordx4 v3, s[40:43], s61 offen sc1 lds
  v_or3_b32 v5, v5, v66, v67
  v_mfma_f32_16x16x32_bf16 v[52:55], a[68:71], a[32:35], v[116:119]
  s_nop 0
  v_exp_f32 v8, v40
  v_mfma_f32_16x16x32_bf16 v[52:55], a[76:79], a[36:39], v[52:55]
  s_nop 0
  v_exp_f32 v9, v41
  v_mfma_f32_16x16x32_bf16 v[52:55], a[84:87], a[40:43], v[52:55]
  s_min_u32 s66, s62, s63
  buffer_load_dwordx4 v3, s[40:43], s61 offen offset:1024 sc1 lds
  v_mfma_f32_16x16x32_bf16 v[52:55], a[92:95], a[44:47], v[52:55]
  s_nop 0
  v_exp_f32 v10, v42
  v_mfma_f32_16x16x32_bf16 v[56:59], a[64:67], a[48:51], v[120:123]
  s_nop 0
  v_exp_f32 v11, v43
  v_mfma_f32_16x16x32_bf16 v[56:59], a[72:75], a[52:55], v[56:59]
  s_add_u32 m0, m0, 0x2000
  s_nop 0
  buffer_load_dwordx4 v3, s[40:43], s66 offen sc1 lds
  v_cvt_pk_bf16_f32 v68, v8, v9
  v_mfma_f32_16x16x32_bf16 v[56:59], a[80:83], a[56:59], v[56:59]
  s_nop 0
  v_cvt_pk_bf16_f32 v69, v10, v11
  v_or3_b32 v5, v5, v68, v69
  v_mfma_f32_16x16x32_bf16 v[56:59], a[88:91], a[60:63], v[56:59]
  s_nop 0
  v_exp_f32 v12, v44
  v_mfma_f32_16x16x32_bf16 v[60:63], a[68:71], a[48:51], v[124:127]
  s_add_u32 s61, s61, 0x2000
  buffer_load_dwordx4 v3, s[40:43], s66 offen offset:1024 sc1 lds
  v_mfma_f32_16x16x32_bf16 v[60:63], a[76:79], a[52:55], v[60:63]
  s_add_u32 s62, s62, 0x2000
  v_exp_f32 v13, v45
  v_mfma_f32_16x16x32_bf16 v[60:63], a[84:87], a[56:59], v[60:63]
  s_add_u32 s64, s64, 0x4000
  v_exp_f32 v14, v46
  v_mfma_f32_16x16x32_bf16 v[60:63], a[92:95], a[60:63], v[60:63]
  s_and_b32 s64, s64, 0x1ffff
  v_exp_f32 v15, v47
  v_mfma_f32_16x16x32_bf16 a[128:131], v[16:19], v[80:83], a[128:131]
  s_add_u32 s58, s58, 1
  v_cvt_pk_bf16_f32 v70, v12, v13
  v_cvt_pk_bf16_f32 v71, v14, v15
  v_mfma_f32_16x16x32_bf16 a[132:135], v[16:19], v[84:87], a[132:135]
  s_nop 0
  ds_read_b128 a[64:67], v4 offset:8192
  v_or3_b32 v5, v5, v70, v71
  v_mfma_f32_16x16x32_bf16 a[136:139], v[16:19], v[88:91], a[136:139]
  s_nop 0
  v_exp_f32 v8, v48
  v_mfma_f32_16x16x32_bf16 a[140:143], v[16:19], v[92:95], a[140:143]
  s_nop 0
  v_exp_f32 v9, v49
  s_waitcnt lgkmcnt(1)
  v_mfma_f32_16x16x32_bf16 v[128:131], a[96:99], v[80:83], v[128:131]
  ds_read_b128 a[68:71], v4 offset:9216
  v_mfma_f32_16x16x32_bf16 v[160:163], a[96:99], v[84:87], v[160:163]
  v_exp_f32 v10, v50
  v_mfma_f32_16x16x32_bf16 v[192:195], a[96:99], v[88:91], v[192:195]
  v_exp_f32 v11, v51
  v_mfma_f32_16x16x32_bf16 v[224:227], a[96:99], v[92:95], v[224:227]
  ds_read_b128 a[72:75], v4 offset:10240
  v_cvt_pk_bf16_f32 v72, v8, v9
  v_mfma_f32_16x16x32_bf16 v[132:135], a[100:103], v[80:83], v[132:135]
  v_cvt_pk_bf16_f32 v73, v10, v11
  v_or3_b32 v5, v5, v72, v73
  v_mfma_f32_16x16x32_bf16 v[164:167], a[100:103], v[84:87], v[164:167]
  v_exp_f32 v12, v52
  v_mfma_f32_16x16x32_bf16 v[196:199], a[100:103], v[88:91], v[196:199]
  ds_read_b128 a[76:79], v4 offset:11264
  v_mfma_f32_16x16x32_bf16 v[228:231], a[100:103], v[92:95], v[228:231]
  v_exp_f32 v13, v53
  v_mfma_f32_16x16x32_bf16 v[136:139], a[104:107], v[80:83], v[136:139]
  v_exp_f32 v14, v54
  v_mfma_f32_16x16x32_bf16 v[168:171], a[104:107], v[84:87], v[168:171]
  ds_read_b128 a[80:83], v4 offset:12288
  v_mfma_f32_16x16x32_bf16 v[200:203], a[104:107], v[88:91], v[200:203]
  v_exp_f32 v15, v55
  v_mfma_f32_16x16x32_bf16 v[232:235], a[104:107], v[92:95], v[232:235]
  v_cvt_pk_bf16_f32 v74, v12, v13
  v_cvt_pk_bf16_f32 v75, v14, v15
  v_mfma_f32_16x16x32_bf16 v[140:143], a[108:111], v[80:83], v[140:143]
  ds_read_b128 a[84:87], v4 offset:13312
  v_or3_b32 v5, v5, v74, v75
  v_mfma_f32_16x16x32_bf16 v[172:175], a[108:111], v[84:87], v[172:175]
  v_exp_f32 v8, v56
  v_mfma_f32_16x16x32_bf16 v[204:207], a[108:111], v[88:91], v[204:207]
  v_exp_f32 v9, v57
  v_mfma_f32_16x16x32_bf16 v[236:239], a[108:111], v[92:95], v[236:239]
  ds_read_b128 a[88:91], v4 offset:14336
  v_mfma_f32_16x16x32_bf16 v[144:147], a[112:115], v[80:83], v[144:147]
  v_exp_f32 v10, v58
  v_mfma_f32_16x16x32_bf16 v[176:179], a[112:115], v[84:87], v[176:179]
  v_exp_f32 v11, v59
  v_mfma_f32_16x16x32_bf16 v[208:211], a[112:115], v[88:91], v[208:211]
  ds_read_b128 a[92:95], v4 offset:15360
  v_cvt_pk_bf16_f32 v76, v8, v9
  v_mfma_f32_16x16x32_bf16 v[240:243], a[112:115], v[92:95], v[240:243]
  v_cvt_pk_bf16_f32 v77, v10, v11
  v_or3_b32 v5, v5, v76, v77
  v_mfma_f32_16x16x32_bf16 v[148:151], a[116:119], v[80:83], v[148:151]
  v_exp_f32 v12, v60
  v_mfma_f32_16x16x32_bf16 v[180:183], a[116:119], v[84:87], v[180:183]
  v_exp_f32 v13, v61
  v_mfma_f32_16x16x32_bf16 v[212:215], a[116:119], v[88:91], v[212:215]
  v_exp_f32 v14, v62
  v_mfma_f32_16x16x32_bf16 v[244:247], a[116:119], v[92:95], v[244:247]
  v_exp_f32 v15, v63
  v_mfma_f32_16x16x32_bf16 v[152:155], a[120:123], v[80:83], v[152:155]
  v_cvt_pk_bf16_f32 v78, v12, v13
  v_cvt_pk_bf16_f32 v79, v14, v15
  v_mfma_f32_16x16x32_bf16 v[184:187], a[120:123], v[84:87], v[184:187]
  v_or3_b32 v5, v5, v78, v79
  v_and_b32 v5, s70, v5
  v_mfma_f32_16x16x32_bf16 v[216:219], a[120:123], v[88:91], v[216:219]
  v_cmp_ne_u32 vcc, 0, v5
  v_cmp_gt_i32 s[80:81], 32, v25
  v_mfma_f32_16x16x32_bf16 v[248:251], a[120:123], v[92:95], v[248:251]
  v_cmp_gt_i32 s[82:83], 33, v25
  v_cmp_gt_i32 s[84:85], 34, v25
  v_mfma_f32_16x16x32_bf16 v[156:159], a[124:127], v[80:83], v[156:159]
  v_cmp_gt_i32 s[86:87], 35, v25
  v_cndmask_b32 v96, v96, v24, s[80:81]
  v_mfma_f32_16x16x32_bf16 v[188:191], a[124:127], v[84:87], v[188:191]
  v_cndmask_b32 v97, v97, v24, s[82:83]
  v_cndmask_b32 v98, v98, v24, s[84:85]
  v_mfma_f32_16x16x32_bf16 v[220:223], a[124:127], v[88:91], v[220:223]
  v_cndmask_b32 v99, v99, v24, s[86:87]
  v_cmp_gt_i32 s[80:81], 48, v25
  v_mfma_f32_16x16x32_bf16 v[252:255], a[124:127], v[92:95], v[252:255]
  v_cmp_gt_i32 s[82:83], 49, v25
  v_cmp_gt_i32 s[84:85], 50, v25
  v_cmp_gt_i32 s[86:87], 51, v25
  v_cndmask_b32 v100, v100, v24, s[80:81]
  v_cndmask_b32 v101, v101, v24, s[82:83]
  v_cndmask_b32 v102, v102, v24, s[84:85]
  v_cndmask_b32 v103, v103, v24, s[86:87]
  v_add_u32 v4, 0x4000, v4
  v_and_b32 v4, 0x1ffff, v4
  s_cbranch_vccnz L_a_d0_t
L_a_d0_r:
L_a_d1:
  s_waitcnt vmcnt(24) lgkmcnt(0)
  v_mfma_f32_16x16x32_bf16 v[32:35], a[64:67], a[0:3], v[96:99]
  s_barrier
  ds_read_b128 a[96:99], v4 offset:0
  v_mfma_f32_16x16x32_bf16 v[32:35], a[72:75], a[4:7], v[32:35]
  s_nop 0
  ds_read_b128 a[100:103], v4 offset:1024
  v_mfma_f32_16x16x32_bf16 v[32:35], a[80:83], a[8:11], v[32:35]
  s_nop 0
  ds_read_b128 a[104:107], v4 offset:2048
  v_mfma_f32_16x16x32_bf16 v[32:35], a[88:91], a[12:15], v[32:35]
  s_nop 0
  ds_read_b128 a[108:111], v4 offset:3072
  v_mfma_f32_16x16x32_bf16 v[36:39], a[68:71], a[0:3], v[100:103]
  s_nop 0
  ds_read_b128 a[112:115], v4 offset:4096
  v_mfma_f32_16x16x32_bf16 v[36:39], a[76:79], a[4:7], v[36:39]
  s_nop 0
  ds_read_b128 a[116:119], v4 offset:5120
  v_mfma_f32_16x16x32_bf16 v[36:39], a[84:87], a[8:11], v[36:39]
  s_nop 0
  ds_read_b128 a[120:123], v4 offset:6144
  v_mfma_f32_16x16x32_bf16 v[36:39], a[92:95], a[12:15], v[36:39]
  s_nop 0
  ds_read_b128 a[124:127], v4 offset:7168
  v_mfma_f32_16x16x32_bf16 v[40:43], a[64:67], a[16:19], v[104:107]
  s_nop 0
  v_exp_f32 v8, v32
  v_mfma_f32_16x16x32_bf16 v[40:43], a[72:75], a[20:23], v[40:43]
  s_nop 0
  v_exp_f32 v9, v33
  v_mfma_f32_16x16x32_bf16 v[40:43], a[80:83], a[24:27], v[40:43]
  s_nop 0
  v_exp_f32 v10, v34
  v_mfma_f32_16x16x32_bf16 v[40:43], a[88:91], a[28:31], v[40:43]
  s_nop 0
  v_exp_f32 v11, v35
  v_mfma_f32_16x16x32_bf16 v[44:47], a[68:71], a[16:19], v[108:111]
  s_nop 0
  v_cvt_pk_bf16_f32 v80, v8, v9
  v_cvt_pk_bf16_f32 v81, v10, v11
  v_mfma_f32_16x16x32_bf16 v[44:47], a[76:79], a[20:23], v[44:47]
  s_nop 0
  v_or_b32 v5, v80, v81
  v_mfma_f32_16x16x32_bf16 v[44:47], a[84:87], a[24:27], v[44:47]
  s_nop 0
  v_exp_f32 v12, v36
  v_mfma_f32_16x16x32_bf16 v[44:47], a[92:95], a[28:31], v[44:47]
  s_nop 0
  v_exp_f32 v13, v37
  v_mfma_f32_16x16x32_bf16 v[48:51], a[64:67], a[32:35], v[112:115]
  s_nop 0
  v_exp_f32 v14, v38
  v_mfma_f32_16x16x32_bf16 v[48:51], a[72:75], a[36:39], v[48:51]
  s_nop 0
  v_exp_f32 v15, v39
  v_mfma_f32_16x16x32_bf16 v[48:51], a[80:83], a[40:43], v[48:51]
  s_nop 0
  v_cvt_pk_bf16_f32 v82, v12, v13
  v_cvt_pk_bf16_f32 v83, v14, v15
  v_mfma_f32_16x16x32_bf16 v[48:51], a[88:91], a[44:47], v[48:51]
  s_add_u32 m0, s64, s65
  s_nop 0
  buffer_load_dwordx4 v3, s[40:43], s61 offen sc1 lds
  v_or3_b32 v5, v5, v82, v83
  v_mfma_f32_16x16x32_bf16 v[52:55], a[68:71], a[32:35], v[116:119]
  s_nop 0
  v_exp_f32 v8, v40
  v_mfma_f32_16x16x32_bf16 v[52:55], a[76:79], a[36:39], v[52:55]
  s_nop 0
  v_exp_f32 v9, v41
  v_mfma_f32_16x16x32_bf16 v[52:55], a[84:87], a[40:43], v[52:55]
  s_min_u32 s66, s62, s63
  buffer_load_dwordx4 v3, s[40:43], s61 offen offset:1024 sc1 lds
  v_mfma_f32_16x16x32_bf16 v[52:55], a[92:95], a[44:47], v[52:55]
  s_nop 0
  v_exp_f32 v10, v42
  v_mfma_f32_16x16x32_bf16 v[56:59], a[64:67], a[48:51], v[120:123]
  s_nop 0
  v_exp_f32 v11, v43
  v_mfma_f32_16x16x32_bf16 v[56:59], a[72:75], a[52:55], v[56:59]
  s_add_u32 m0, m0, 0x2000
  s_nop 0
  buffer_load_dwordx4 v3, s[40:43], s66 offen sc1 lds
  v_cvt_pk_bf16_f32 v84, v8, v9
  v_mfma_f32_16x16x32_bf16 v[56:59], a[80:83], a[56:59], v[56:59]
  s_nop 0
  v_cvt_pk_bf16_f32 v85, v10, v11
  v_or3_b32 v5, v5, v84, v85
  v_mfma_f32_16x16x32_bf16 v[56:59], a[88:91], a[60:63], v[56:59]
  s_nop 0
  v_exp_f32 v12, v44
  v_mfma_f32_16x16x32_bf16 v[60:63], a[68:71], a[48:51], v[124:127]
  s_add_u32 s61, s61, 0x2000
  buffer_load_dwordx4 v3, s[40:43], s66 offen offset:1024 sc1 lds
  v_mfma_f32_16x16x32_bf16 v[60:63], a[76:79], a[52:55], v[60:63]
  s_add_u32 s62, s62, 0x2000
  v_exp_f32 v13, v45
  v_mfma_f32_16x16x32_bf16 v[60:63], a[84:87], a[56:59], v[60:63]
  s_add_u32 s64, s64, 0x4000
  v_exp_f32 v14, v46
  v_mfma_f32_16x16x32_bf16 v[60:63], a[92:95], a[60:63], v[60:63]
  s_and_b32 s64, s64, 0x1ffff
  v_exp_f32 v15, v47
  v_mfma_f32_16x16x32_bf16 a[128:131], v[16:19], v[64:67], a[128:131]
  s_add_u32 s58, s58, 1
  v_cvt_pk_bf16_f32 v86, v12, v13
  v_cvt_pk_bf16_f32 v87, v14, v15
  v_mfma_f32_16x16x32_bf16 a[132:135], v[16:19], v[68:71], a[132:135]
  s_nop 0
  ds_read_b128 a[64:67], v4 offset:8192
  v_or3_b32 v5, v5, v86, v87
  v_mfma_f32_16x16x32_bf16 a[136:139], v[16:19], v[72:75], a[136:139]
  s_nop 0
  v_exp_f32 v8, v48
  v_mfma_f32_16x16x32_bf16 a[140:143], v[16:19], v[76:79], a[140:143]
  s_nop 0
  v_exp_f32 v9, v49
  s_waitcnt lgkmcnt(1)
  v_mfma_f32_16x16x32_bf16 v[128:131], a[96:99], v[64:67], v[128:131]
  ds_read_b128 a[68:71], v4 offset:9216
  v_mfma_f32_16x16x32_bf16 v[160:163], a[96:99], v[68:71], v[160:163]
  v_exp_f32 v10, v50
  v_mfma_f32_16x16x32_bf16 v[192:195], a[96:99], v[72:75], v[192:195]
  v_exp_f32 v11, v51
  v_mfma_f32_16x16x32_bf16 v[224:227], a[96:99], v[76:79], v[224:227]
  ds_read_b128 a[72:75], v4 offset:10240
  v_cvt_pk_bf16_f32 v88, v8, v9
  v_mfma_f32_16x16x32_bf16 v[132:135], a[100:103], v[64:67], v[132:135]
  v_cvt_pk_bf16_f32 v89, v10, v11
  v_or3_b32 v5, v5, v88, v89
  v_mfma_f32_16x16x32_bf16 v[164:167], a[100:103], v[68:71], v[164:167]
  v_exp_f32 v12, v52
  v_mfma_f32_16x16x32_bf16 v[196:199], a[100:103], v[72:75], v[196:199]
  ds_read_b128 a[76:79], v4 offset:11264
  v_mfma_f32_16x16x32_bf16 v[228:231], a[100:103], v[76:79], v[228:231]
  v_exp_f32 v13, v53
  v_mfma_f32_16x16x32_bf16 v[136:139], a[104:107], v[64:67], v[136:139]
  v_exp_f32 v14, v54
  v_mfma_f32_16x16x32_bf16 v[168:171], a[104:107], v[68:71], v[168:171]
  ds_read_b128 a[80:83], v4 offset:12288
  v_mfma_f32_16x16x32_bf16 v[200:203], a[104:107], v[72:75], v[200:203]
  v_exp_f32 v15, v55
  v_mfma_f32_16x16x32_bf16 v[232:235], a[104:107], v[76:79], v[232:235]
  v_cvt_pk_bf16_f32 v90, v12, v13
  v_cvt_pk_bf16_f32 v91, v14, v15
  v_mfma_f32_16x16x32_bf16 v[140:143], a[108:111], v[64:67], v[140:143]
  ds_read_b128 a[84:87], v4 offset:13312
  v_or3_b32 v5, v5, v90, v91
  v_mfma_f32_16x16x32_bf16 v[172:175], a[108:111], v[68:71], v[172:175]
  v_exp_f32 v8, v56
  v_mfma_f32_16x16x32_bf16 v[204:207], a[108:111], v[72:75], v[204:207]
  v_exp_f32 v9, v57
  v_mfma_f32_16x16x32_bf16 v[236:239], a[108:111], v[76:79], v[236:239]
  ds_read_b128 a[88:91], v4 offset:14336
  v_mfma_f32_16x16x32_bf16 v[144:147], a[112:115], v[64:67], v[144:147]
  v_exp_f32 v10, v58
  v_mfma_f32_16x16x32_bf16 v[176:179], a[112:115], v[68:71], v[176:179]
  v_exp_f32 v11, v59
  v_mfma_f32_16x16x32_bf16 v[208:211], a[112:115], v[72:75], v[208:211]
  ds_read_b128 a[92:95], v4 offset:15360
  v_cvt_pk_bf16_f32 v92, v8, v9
  v_mfma_f32_16x16x32_bf16 v[240:243], a[112:115], v[76:79], v[240:243]
  v_cvt_pk_bf16_f32 v93, v10, v11
  v_or3_b32 v5, v5, v92, v93
  v_mfma_f32_16x16x32_bf16 v[148:151], a[116:119], v[64:67], v[148:151]
  v_exp_f32 v12, v60
  v_mfma_f32_16x16x32_bf16 v[180:183], a[116:119], v[68:71], v[180:183]
  v_exp_f32 v13, v61
  v_mfma_f32_16x16x32_bf16 v[212:215], a[116:119], v[72:75], v[212:215]
  v_exp_f32 v14, v62
  v_mfma_f32_16x16x32_bf16 v[244:247], a[116:119], v[76:79], v[244:247]
  v_exp_f32 v15, v63
  v_mfma_f32_16x16x32_bf16 v[152:155], a[120:123], v[64:67], v[152:155]
  v_cvt_pk_bf16_f32 v94, v12, v13
  v_cvt_pk_bf16_f32 v95, v14, v15
  v_mfma_f32_16x16x32_bf16 v[184:187], a[120:123], v[68:71], v[184:187]
  v_or3_b32 v5, v5, v94, v95
  v_and_b32 v5, s70, v5
  v_mfma_f32_16x16x32_bf16 v[216:219], a[120:123], v[72:75], v[216:219]
  v_cmp_ne_u32 vcc, 0, v5
  v_cmp_gt_i32 s[80:81], 0, v25
  v_mfma_f32_16x16x32_bf16 v[248:251], a[120:123], v[76:79], v[248:251]
  v_cmp_gt_i32 s[82:83], 1, v25
  v_cmp_gt_i32 s[84:85], 2, v25
  v_mfma_f32_16x16x32_bf16 v[156:159], a[124:127], v[64:67], v[156:159]
  v_cmp_gt_i32 s[86:87], 3, v25
  v_cndmask_b32 v104, v104, v24, s[80:81]
  v_mfma_f32_16x16x32_bf16 v[188:191], a[124:127], v[68:71], v[188:191]
  v_cndmask_b32 v105, v105, v24, s[82:83]
  v_cndmask_b32 v106, v106, v24, s[84:85]
  v_mfma_f32_16x16x32_bf16 v[220:223], a[124:127], v[72:75], v[220:223]
  v_cndmask_b32 v107, v107, v24, s[86:87]
  v_cmp_gt_i32 s[80:81], 16, v25
  v_mfma_f32_16x16x32_bf16 v[252:255], a[124:127], v[76:79], v[252:255]
  v_cmp_gt_i32 s[82:83], 17, v25
  v_cmp_gt_i32 s[84:85], 18, v25
  v_cmp_gt_i32 s[86:87], 19, v25
  v_cndmask_b32 v108, v108, v24, s[80:81]
  v_cndmask_b32 v109, v109, v24, s[82:83]
  v_cndmask_b32 v110, v110, v24, s[84:85]
  v_cndmask_b32 v111, v111, v24, s[86:87]
  v_add_u32 v4, 0x4000, v4
  v_and_b32 v4, 0x1ffff, v4
  s_cbranch_vccnz L_a_d1_t
L_a_d1_r:
L_a_d2:
  s_waitcnt vmcnt(24) lgkmcnt(0)
  v_mfma_f32_16x16x32_bf16 v[40:43], a[64:67], a[16:19], v[104:107]
  s_barrier
  ds_read_b128 a[96:99], v4 offset:0
  v_mfma_f32_16x16x32_bf16 v[40:43], a[72:75], a[20:23], v[40:43]
  s_nop 0
  ds_read_b128 a[100:103], v4 offset:1024
  v_mfma_f32_16x16x32_bf16 v[40:43], a[80:83], a[24:27], v[40:43]
  s_nop 0
  ds_read_b128 a[104:107], v4 offset:2048
  v_mfma_f32_16x16x32_bf16 v[40:43], a[88:91], a[28:31], v[40:43]
  s_nop 0
  ds_read_b128 a[108:111], v4 offset:3072
  v_mfma_f32_16x16x32_bf16 v[44:47], a[68:71], a[16:19], v[108:111]
  s_nop 0
  ds_read_b128 a[112:115], v4 offset:4096
  v_mfma_f32_16x16x32_bf16 v[44:47], a[76:79], a[20:23], v[44:47]
  s_nop 0
  ds_read_b128 a[116:119], v4 offset:5120
  v_mfma_f32_16x16x32_bf16 v[44:47], a[84:87], a[24:27], v[44:47]
  s_nop 0
  ds_read_b128 a[120:123], v4 offset:6144
  v_mfma_f32_16x16x32_bf16 v[44:47], a[92:95], a[28:31], v[44:47]
  s_nop 0
  ds_read_b128 a[124:127], v4 offset:7168
  v_mfma_f32_16x16x32_bf16 v[48:51], a[64:67], a[32:35], v[112:115]
  s_add_u32 m0, s73, 0
  s_add_u32 s66, s72, 0
  buffer_load_dwordx4 v26, s[48:51], s66 offen lds
  v_mfma_f32_16x16x32_bf16 v[48:51], a[72:75], a[36:39], v[48:51]
  s_add_u32 m0, s73, 1024
  s_add_u32 s66, s72, 8192
  buffer_load_dwordx4 v26, s[48:51], s66 offen lds
  v_mfma_f32_16x16x32_bf16 v[48:51], a[80:83], a[40:43], v[48:51]
  s_add_u32 m0, s73, 2048
  s_add_u32 s66, s72, 16384
  buffer_load_dwordx4 v26, s[48:51], s66 offen lds
  v_mfma_f32_16x16x32_bf16 v[48:51], a[88:91], a[44:47], v[48:51]
  s_add_u32 m0, s73, 3072
  s_add_u32 s66, s72, 24576
  buffer_load_dwordx4 v26, s[48:51], s66 offen lds
  v_mfma_f32_16x16x32_bf16 v[52:55], a[68:71], a[32:35], v[116:119]
  s_add_u32 s58, s58, 1
  v_exp_f32 v8, v40
  v_mfma_f32_16x16x32_bf16 v[52:55], a[76:79], a[36:39], v[52:55]
  s_nop 0
  v_exp_f32 v9, v41
  v_mfma_f32_16x16x32_bf16 v[52:55], a[84:87], a[40:43], v[52:55]
  s_nop 0
  v_exp_f32 v10, v42
  v_mfma_f32_16x16x32_bf16 v[52:55], a[92:95], a[44:47], v[52:55]
  s_nop 0
  v_exp_f32 v11, v43
  v_mfma_f32_16x16x32_bf16 v[56:59], a[64:67], a[48:51], v[120:123]
  s_nop 0
  v_cvt_pk_bf16_f32 v68, v8, v9
  v_cvt_pk_bf16_f32 v69, v10, v11
  v_mfma_f32_16x16x32_bf16 v[56:59], a[72:75], a[52:55], v[56:59]
  s_nop 0
  v_or_b32 v5, v68, v69
  v_mfma_f32_16x16x32_bf16 v[56:59], a[80:83], a[56:59], v[56:59]
  s_nop 0
  v_exp_f32 v12, v44
  v_mfma_f32_16x16x32_bf16 v[56:59], a[88:91], a[60:63], v[56:59]
  s_nop 0
  v_exp_f32 v13, v45
  v_mfma_f32_16x16x32_bf16 v[60:63], a[68:71], a[48:51], v[124:127]
  s_nop 0
  v_exp_f32 v14, v46
  v_mfma_f32_16x16x32_bf16 v[60:63], a[76:79], a[52:55], v[60:63]
  s_nop 0
  v_exp_f32 v15, v47
  v_mfma_f32_16x16x32_bf16 v[60:63], a[84:87], a[56:59], v[60:63]
  s_nop 0
  v_cvt_pk_bf16_f32 v70, v12, v13
  v_cvt_pk_bf16_f32 v71, v14, v15
  v_mfma_f32_16x16x32_bf16 v[60:63], a[92:95], a[60:63], v[60:63]
  s_nop 0
  v_or3_b32 v5, v5, v70, v71
  v_mfma_f32_16x16x32_bf16 a[128:131], v[16:19], v[80:83], a[128:131]
  s_nop 0
  v_exp_f32 v8, v48
  v_mfma_f32_16x16x32_bf16 a[132:135], v[16:19], v[84:87], a[132:135]
  s_nop 0
  ds_read_b128 a[64:67], v4 offset:8192
  v_mfma_f32_16x16x32_bf16 a[136:139], v[16:19], v[88:91], a[136:139]
  s_nop 0
  v_exp_f32 v9, v49
  v_mfma_f32_16x16x32_bf16 a[140:143], v[16:19], v[92:95], a[140:143]
  s_nop 0
  v_exp_f32 v10, v50
  s_waitcnt lgkmcnt(1)
  v_mfma_f32_16x16x32_bf16 v[128:131], a[96:99], v[80:83], v[128:131]
  ds_read_b128 a[68:71], v4 offset:9216
  v_mfma_f32_16x16x32_bf16 v[160:163], a[96:99], v[84:87], v[160:163]
  v_exp_f32 v11, v51
  v_mfma_f32_16x16x32_bf16 v[192:195], a[96:99], v[88:91], v[192:195]
  v_cvt_pk_bf16_f32 v72, v8, v9
  v_cvt_pk_bf16_f32 v73, v10, v11
  v_mfma_f32_16x16x32_bf16 v[224:227], a[96:99], v[92:95], v[224:227]
  ds_read_b128 a[72:75], v4 offset:10240
  v_or3_b32 v5, v5, v72, v73
  v_mfma_f32_16x16x32_bf16 v[132:135], a[100:103], v[80:83], v[132:135]
  v_exp_f32 v12, v52
  v_mfma_f32_16x16x32_bf16 v[164:167], a[100:103], v[84:87], v[164:167]
  v_exp_f32 v13, v53
  v_mfma_f32_16x16x32_bf16 v[196:199], a[100:103], v[88:91], v[196:199]
  ds_read_b128 a[76:79], v4 offset:11264
  v_mfma_f32_16x16x32_bf16 v[228:231], a[100:103], v[92:95], v[228:231]
  v_exp_f32 v14, v54
  v_mfma_f32_16x16x32_bf16 v[136:139], a[104:107], v[80:83], v[136:139]
  v_exp_f32 v15, v55
  v_mfma_f32_16x16x32_bf16 v[168:171], a[104:107], v[84:87], v[168:171]
  ds_read_b128 a[80:83], v4 offset:12288
  v_cvt_pk_bf16_f32 v74, v12, v13
  v_mfma_f32_16x16x32_bf16 v[200:203], a[104:107], v[88:91], v[200:203]
  v_cvt_pk_bf16_f32 v75, v14, v15
  v_or3_b32 v5, v5, v74, v75
  v_mfma_f32_16x16x32_bf16 v[232:235], a[104:107], v[92:95], v[232:235]
  v_exp_f32 v8, v56
  v_mfma_f32_16x16x32_bf16 v[140:143], a[108:111], v[80:83], v[140:143]
  ds_read_b128 a[84:87], v4 offset:13312
  v_mfma_f32_16x16x32_bf16 v[172:175], a[108:111], v[84:87], v[172:175]
  v_exp_f32 v9, v57
  v_mfma_f32_16x16x32_bf16 v[204:207], a[108:111], v[88:91], v[204:207]
  v_exp_f32 v10, v58
  v_mfma_f32_16x16x32_bf16 v[236:239], a[108:111], v[92:95], v[236:239]
  ds_read_b128 a[88:91], v4 offset:14336
  v_mfma_f32_16x16x32_bf16 v[144:147], a[112:115], v[80:83], v[144:147]
  v_exp_f32 v11, v59
  v_mfma_f32_16x16x32_bf16 v[176:179], a[112:115], v[84:87], v[176:179]
  v_cvt_pk_bf16_f32 v76, v8, v9
  v_cvt_pk_bf16_f32 v77, v10, v11
  v_mfma_f32_16x16x32_bf16 v[208:211], a[112:115], v[88:91], v[208:211]
  ds_read_b128 a[92:95], v4 offset:15360
  v_or3_b32 v5, v5, v76, v77
  v_mfma_f32_16x16x32_bf16 v[240:243], a[112:115], v[92:95], v[240:243]
  v_exp_f32 v12, v60
  v_mfma_f32_16x16x32_bf16 v[148:151], a[116:119], v[80:83], v[148:151]
  v_exp_f32 v13, v61
  v_mfma_f32_16x16x32_bf16 v[180:183], a[116:119], v[84:87], v[180:183]
  v_exp_f32 v14, v62
  v_mfma_f32_16x16x32_bf16 v[212:215], a[116:119], v[88:91], v[212:215]
  v_exp_f32 v15, v63
  v_mfma_f32_16x16x32_bf16 v[244:247], a[116:119], v[92:95], v[244:247]
  v_cvt_pk_bf16_f32 v78, v12, v13
  v_cvt_pk_bf16_f32 v79, v14, v15
  v_mfma_f32_16x16x32_bf16 v[152:155], a[120:123], v[80:83], v[152:155]
  v_or3_b32 v5, v5, v78, v79
  v_and_b32 v5, s70, v5
  v_mfma_f32_16x16x32_bf16 v[184:187], a[120:123], v[84:87], v[184:187]
  v_cmp_ne_u32 vcc, 0, v5
  v_cmp_gt_i32 s[80:81], 32, v25
  v_mfma_f32_16x16x32_bf16 v[216:219], a[120:123], v[88:91], v[216:219]
  v_cmp_gt_i32 s[82:83], 33, v25
  v_cmp_gt_i32 s[84:85], 34, v25
  v_mfma_f32_16x16x32_bf16 v[248:251], a[120:123], v[92:95], v[248:251]
  v_cmp_gt_i32 s[86:87], 35, v25
  v_cndmask_b32 v104, v104, v24, s[80:81]
  v_mfma_f32_16x16x32_bf16 v[156:159], a[124:127], v[80:83], v[156:159]
  v_cndmask_b32 v105, v105, v24, s[82:83]
  v_cndmask_b32 v106, v106, v24, s[84:85]
  v_mfma_f32_16x16x32_bf16 v[188:191], a[124:127], v[84:87], v[188:191]
  v_cndmask_b32 v107, v107, v24, s[86:87]
  v_cmp_gt_i32 s[80:81], 48, v25
  v_mfma_f32_16x16x32_bf16 v[220:223], a[124:127], v[88:91], v[220:223]
  v_cmp_gt_i32 s[82:83], 49, v25
  v_cmp_gt_i32 s[84:85], 50, v25
  v_mfma_f32_16x16x32_bf16 v[252:255], a[124:127], v[92:95], v[252:255]
  v_cmp_gt_i32 s[86:87], 51, v25
  v_cndmask_b32 v108, v108, v24, s[80:81]
  v_cndmask_b32 v109, v109, v24, s[82:83]
  v_cndmask_b32 v110, v110, v24, s[84:85]
  v_cndmask_b32 v111, v111, v24, s[86:87]
  v_add_u32 v4, 0x4000, v4
  v_and_b32 v4, 0x1ffff, v4
  s_cbranch_vccnz L_a_d2_t
L_a_d2_r:
L_a_d3:
  s_waitcnt vmcnt(24) lgkmcnt(0)
  v_mfma_f32_16x16x32_bf16 v[40:43], a[64:67], a[16:19], v[104:107]
  s_barrier
  ds_read_b128 a[96:99], v4 offset:0
  v_mfma_f32_16x16x32_bf16 v[40:43], a[72:75], a[20:23], v[40:43]
  s_nop 0
  ds_read_b128 a[100:103], v4 offset:1024
  v_mfma_f32_16x16x32_bf16 v[40:43], a[80:83], a[24:27], v[40:43]
  s_nop 0
  ds_read_b128 a[104:107], v4 offset:2048
  v_mfma_f32_16x16x32_bf16 v[40:43], a[88:91], a[28:31], v[40:43]
  s_nop 0
  ds_read_b128 a[108:111], v4 offset:3072
  v_mfma_f32_16x16x32_bf16 v[44:47], a[68:71], a[16:19], v[108:111]
  s_nop 0
  ds_read_b128 a[112:115], v4 offset:4096
  v_mfma_f32_16x16x32_bf16 v[44:47], a[76:79], a[20:23], v[44:47]
  s_nop 0
  ds_read_b128 a[116:119], v4 offset:5120
  v_mfma_f32_16x16x32_bf16 v[44:47], a[84:87], a[24:27], v[44:47]
  s_nop 0
  ds_read_b128 a[120:123], v4 offset:6144
  v_mfma_f32_16x16x32_bf16 v[44:47], a[92:95], a[28:31], v[44:47]
  s_nop 0
  ds_read_b128 a[124:127], v4 offset:7168
  v_mfma_f32_16x16x32_bf16 v[48:51], a[64:67], a[32:35], v[112:115]
  s_add_u32 m0, s73, 16384
  s_add_u32 s66, s72, 128
  buffer_load_dwordx4 v26, s[48:51], s66 offen lds
  v_mfma_f32_16x16x32_bf16 v[48:51], a[72:75], a[36:39], v[48:51]
  s_add_u32 m0, s73, 17408
  s_add_u32 s66, s72, 8320
  buffer_load_dwordx4 v26, s[48:51], s66 offen lds
  v_mfma_f32_16x16x32_bf16 v[48:51], a[80:83], a[40:43], v[48:51]
  s_add_u32 m0, s73, 18432
  s_add_u32 s66, s72, 16512
  buffer_load_dwordx4 v26, s[48:51], s66 offen lds
  v_mfma_f32_16x16x32_bf16 v[48:51], a[88:91], a[44:47], v[48:51]
  s_add_u32 m0, s73, 19456
  s_add_u32 s66, s72, 24704
  buffer_load_dwordx4 v26, s[48:51], s66 offen lds
  v_mfma_f32_16x16x32_bf16 v[52:55], a[68:71], a[32:35], v[116:119]
  s_add_u32 s58, s58, 1
  v_exp_f32 v8, v40
  v_mfma_f32_16x16x32_bf16 v[52:55], a[76:79], a[36:39], v[52:55]
  s_nop 0
  v_exp_f32 v9, v41
  v_mfma_f32_16x16x32_bf16 v[52:55], a[84:87], a[40:43], v[52:55]
  s_nop 0
  v_exp_f32 v10, v42
  v_mfma_f32_16x16x32_bf16 v[52:55], a[92:95], a[44:47], v[52:55]
  s_nop 0
  v_exp_f32 v11, v43
  v_mfma_f32_16x16x32_bf16 v[56:59], a[64:67], a[48:51], v[120:123]
  s_nop 0
  v_cvt_pk_bf16_f32 v84, v8, v9
  v_cvt_pk_bf16_f32 v85, v10, v11
  v_mfma_f32_16x16x32_bf16 v[56:59], a[72:75], a[52:55], v[56:59]
  s_nop 0
  v_or_b32 v5, v84, v85
  v_mfma_f32_16x16x32_bf16 v[56:59], a[80:83], a[56:59], v[56:59]
  s_nop 0
  v_exp_f32 v12, v44
  v_mfma_f32_16x16x32_bf16 v[56:59], a[88:91], a[60:63], v[56:59]
  s_nop 0
  v_exp_f32 v13, v45
  v_mfma_f32_16x16x32_bf16 v[60:63], a[68:71], a[48:51], v[124:127]
  s_nop 0
  v_exp_f32 v14, v46
  v_mfma_f32_16x16x32_bf16 v[60:63], a[76:79], a[52:55], v[60:63]
  s_nop 0
  v_exp_f32 v15, v47
  v_mfma_f32_16x16x32_bf16 v[60:63], a[84:87], a[56:59], v[60:63]
  s_nop 0
  v_cvt_pk_bf16_f32 v86, v12, v13
  v_cvt_pk_bf16_f32 v87, v14, v15
  v_mfma_f32_16x16x32_bf16 v[60:63], a[92:95], a[60:63], v[60:63]
  s_nop 0
  v_or3_b32 v5, v5, v86, v87
  v_mfma_f32_16x16x32_bf16 a[132:135], v[16:19], v[68:71], a[132:135]
  s_nop 0
  ds_read_b128 a[64:67], v4 offset:8192
  v_mfma_f32_16x16x32_bf16 a[136:139], v[16:19], v[72:75], a[136:139]
  s_nop 0
  ds_read_b128 a[68:71], v4 offset:9216
  v_mfma_f32_16x16x32_bf16 a[140:143], v[16:19], v[76:79], a[140:143]
  s_nop 0
  ds_read_b128 a[72:75], v4 offset:10240
  s_waitcnt lgkmcnt(3)
  v_mfma_f32_16x16x32_bf16 v[160:163], a[96:99], v[68:71], v[160:163]
  s_nop 0
  ds_read_b128 a[76:79], v4 offset:11264
  v_mfma_f32_16x16x32_bf16 v[192:195], a[96:99], v[72:75], v[192:195]
  ds_read_b128 a[80:83], v4 offset:12288
  v_mfma_f32_16x16x32_bf16 v[224:227], a[96:99], v[76:79], v[224:227]
  ds_read_b128 a[84:87], v4 offset:13312
  v_mfma_f32_16x16x32_bf16 v[164:167], a[100:103], v[68:71], v[164:167]
  ds_read_b128 a[88:91], v4 offset:14336
  v_mfma_f32_16x16x32_bf16 v[196:199], a[100:103], v[72:75], v[196:199]
  ds_read_b128 a[92:95], v4 offset:15360
  v_mfma_f32_16x16x32_bf16 v[228:231], a[100:103], v[76:79], v[228:231]
  v_exp_f32 v8, v48
  v_mfma_f32_16x16x32_bf16 v[168:171], a[104:107], v[68:71], v[168:171]
  v_exp_f32 v9, v49
  v_mfma_f32_16x16x32_bf16 v[200:203], a[104:107], v[72:75], v[200:203]
  v_exp_f32 v10, v50
  v_mfma_f32_16x16x32_bf16 v[232:235], a[104:107], v[76:79], v[232:235]
  v_exp_f32 v11, v51
  v_mfma_f32_16x16x32_bf16 v[172:175], a[108:111], v[68:71], v[172:175]
  v_cvt_pk_bf16_f32 v88, v8, v9
  v_cvt_pk_bf16_f32 v89, v10, v11
  v_mfma_f32_16x16x32_bf16 v[204:207], a[108:111], v[72:75], v[204:207]
  v_or3_b32 v5, v5, v88, v89
  v_mfma_f32_16x16x32_bf16 v[236:239], a[108:111], v[76:79], v[236:239]
  v_exp_f32 v12, v52
  v_mfma_f32_16x16x32_bf16 v[176:179], a[112:115], v[68:71], v[176:179]
  v_exp_f32 v13, v53
  v_mfma_f32_16x16x32_bf16 v[208:211], a[112:115], v[72:75], v[208:211]
  v_exp_f32 v14, v54
  v_mfma_f32_16x16x32_bf16 v[240:243], a[112:115], v[76:79], v[240:243]
  v_exp_f32 v15, v55
  v_mfma_f32_16x16x32_bf16 v[180:183], a[116:119], v[68:71], v[180:183]
  v_cvt_pk_bf16_f32 v90, v12, v13
  v_cvt_pk_bf16_f32 v91, v14, v15
  v_mfma_f32_16x16x32_bf16 v[212:215], a[116:119], v[72:75], v[212:215]
  v_or3_b32 v5, v5, v90, v91
  v_mfma_f32_16x16x32_bf16 v[244:247], a[116:119], v[76:79], v[244:247]
  v_exp_f32 v8, v56
  v_mfma_f32_16x16x32_bf16 v[184:187], a[120:123], v[68:71], v[184:187]
  v_exp_f32 v9, v57
  v_mfma_f32_16x16x32_bf16 v[216:219], a[120:123], v[72:75], v[216:219]
  v_exp_f32 v10, v58
  v_mfma_f32_16x16x32_bf16 v[248:251], a[120:123], v[76:79], v[248:251]
  v_exp_f32 v11, v59
  v_mfma_f32_16x16x32_bf16 v[188:191], a[124:127], v[68:71], v[188:191]
  v_cvt_pk_bf16_f32 v92, v8, v9
  v_cvt_pk_bf16_f32 v93, v10, v11
  v_mfma_f32_16x16x32_bf16 v[220:223], a[124:127], v[72:75], v[220:223]
  v_or3_b32 v5, v5, v92, v93
  v_mfma_f32_16x16x32_bf16 v[252:255], a[124:127], v[76:79], v[252:255]
  v_exp_f32 v12, v60
  v_exp_f32 v13, v61
  v_exp_f32 v14, v62
  v_exp_f32 v15, v63
  s_nop 0
  v_cvt_pk_bf16_f32 v94, v12, v13
  v_cvt_pk_bf16_f32 v95, v14, v15
  v_or3_b32 v5, v5, v94, v95
  v_and_b32 v5, s70, v5
  v_cmp_ne_u32 vcc, 0, v5
  v_cmp_gt_i32 s[80:81], 0, v25
  v_cmp_gt_i32 s[82:83], 1, v25
  v_cmp_gt_i32 s[84:85], 2, v25
  v_cmp_gt_i32 s[86:87], 3, v25
  v_cndmask_b32 v112, v112, v24, s[80:81]
  v_cndmask_b32 v113, v113, v24, s[82:83]
  v_cndmask_b32 v114, v114, v24, s[84:85]
  v_cndmask_b32 v115, v115, v24, s[86:87]
  v_cmp_gt_i32 s[80:81], 16, v25
  v_cmp_gt_i32 s[82:83], 17, v25
  v_cmp_gt_i32 s[84:85], 18, v25
  v_cmp_gt_i32 s[86:87], 19, v25
  v_cndmask_b32 v116, v116, v24, s[80:81]
  v_cndmask_b32 v117, v117, v24, s[82:83]
  v_cndmask_b32 v118, v118, v24, s[84:85]
  v_cndmask_b32 v119, v119, v24, s[86:87]
  v_add_u32 v4, 0x4000, v4
  v_and_b32 v4, 0x1ffff, v4
  s_cbranch_vccnz L_a_d3_t
L_a_d3_r:
L_a_d4:
  s_waitcnt vmcnt(24) lgkmcnt(0)
  v_mfma_f32_16x16x32_bf16 v[48:51], a[64:67], a[32:35], v[112:115]
  s_barrier
  ds_read_b128 a[96:99], v4 offset:0
  v_mfma_f32_16x16x32_bf16 v[48:51], a[72:75], a[36:39], v[48:51]
  s_nop 0
  ds_read_b128 a[100:103], v4 offset:1024
  v_mfma_f32_16x16x32_bf16 v[48:51], a[80:83], a[40:43], v[48:51]
  s_nop 0
  ds_read_b128 a[104:107], v4 offset:2048
  v_mfma_f32_16x16x32_bf16 v[48:51], a[88:91], a[44:47], v[48:51]
  s_nop 0
  ds_read_b128 a[108:111], v4 offset:3072
  v_mfma_f32_16x16x32_bf16 v[52:55], a[68:71], a[32:35], v[116:119]
  s_nop 0
  ds_read_b128 a[112:115], v4 offset:4096
  v_mfma_f32_16x16x32_bf16 v[52:55], a[76:79], a[36:39], v[52:55]
  s_nop 0
  ds_read_b128 a[116:119], v4 offset:5120
  v_mfma_f32_16x16x32_bf16 v[52:55], a[84:87], a[40:43], v[52:55]
  s_nop 0
  ds_read_b128 a[120:123], v4 offset:6144
  v_mfma_f32_16x16x32_bf16 v[52:55], a[92:95], a[44:47], v[52:55]
  s_nop 0
  ds_read_b128 a[124:127], v4 offset:7168
  v_mfma_f32_16x16x32_bf16 v[56:59], a[64:67], a[48:51], v[120:123]
  s_add_u32 m0, s73, 32768
  s_add_u32 s66, s72, 256
  buffer_load_dwordx4 v26, s[48:51], s66 offen lds
  v_mfma_f32_16x16x32_bf16 v[56:59], a[72:75], a[52:55], v[56:59]
  s_add_u32 m0, s73, 33792
  s_add_u32 s66, s72, 8448
  buffer_load_dwordx4 v26, s[48:51], s66 offen lds
  v_mfma_f32_16x16x32_bf16 v[56:59], a[80:83], a[56:59], v[56:59]
  s_add_u32 m0, s73, 34816
  s_add_u32 s66, s72, 16640
  buffer_load_dwordx4 v26, s[48:51], s66 offen lds
  v_mfma_f32_16x16x32_bf16 v[56:59], a[88:91], a[60:63], v[56:59]
  s_add_u32 m0, s73, 35840
  s_add_u32 s66, s72, 24832
  buffer_load_dwordx4 v26, s[48:51], s66 offen lds
  v_mfma_f32_16x16x32_bf16 v[60:63], a[68:71], a[48:51], v[124:127]
  s_add_u32 s58, s58, 1
  v_exp_f32 v8, v48
  v_mfma_f32_16x16x32_bf16 v[60:63], a[76:79], a[52:55], v[60:63]
  s_nop 0
  v_exp_f32 v9, v49
  v_mfma_f32_16x16x32_bf16 v[60:63], a[84:87], a[56:59], v[60:63]
  s_nop 0
  v_exp_f32 v10, v50
  v_mfma_f32_16x16x32_bf16 v[60:63], a[92:95], a[60:63], v[60:63]
  s_nop 0
  v_exp_f32 v11, v51
  v_mfma_f32_16x16x32_bf16 a[132:135], v[16:19], v[84:87], a[132:135]
  s_nop 0
  ds_read_b128 a[64:67], v4 offset:8192
  v_cvt_pk_bf16_f32 v72, v8, v9
  v_mfma_f32_16x16x32_bf16 a[136:139], v[16:19], v[88:91], a[136:139]
  s_nop 0
  ds_read_b128 a[68:71], v4 offset:9216
  v_cvt_pk_bf16_f32 v73, v10, v11
  v_mfma_f32_16x16x32_bf16 a[140:143], v[16:19], v[92:95], a[140:143]
  s_nop 0
  ds_read_b128 a[72:75], v4 offset:10240
  v_or_b32 v5, v72, v73
  s_waitcnt lgkmcnt(3)
  v_mfma_f32_16x16x32_bf16 v[160:163], a[96:99], v[84:87], v[160:163]
  s_nop 0
  ds_read_b128 a[76:79], v4 offset:11264
  v_mfma_f32_16x16x32_bf16 v[192:195], a[96:99], v[88:91], v[192:195]
  ds_read_b128 a[80:83], v4 offset:12288
  v_mfma_f32_16x16x32_bf16 v[224:227], a[96:99], v[92:95], v[224:227]
  ds_read_b128 a[84:87], v4 offset:13312
  v_mfma_f32_16x16x32_bf16 v[164:167], a[100:103], v[84:87], v[164:167]
  ds_read_b128 a[88:91], v4 offset:14336
  v_mfma_f32_16x16x32_bf16 v[196:199], a[100:103], v[88:91], v[196:199]
  ds_read_b128 a[92:95], v4 offset:15360
  v_mfma_f32_16x16x32_bf16 v[228:231], a[100:103], v[92:95], v[228:231]
  v_exp_f32 v12, v52
  v_mfma_f32_16x16x32_bf16 v[168:171], a[104:107], v[84:87], v[168:171]
  v_exp_f32 v13, v53
  v_mfma_f32_16x16x32_bf16 v[200:203], a[104:107], v[88:91], v[200:203]
  v_exp_f32 v14, v54
  v_mfma_f32_16x16x32_bf16 v[232:235], a[104:107], v[92:95], v[232:235]
  v_exp_f32 v15, v55
  v_mfma_f32_16x16x32_bf16 v[172:175], a[108:111], v[84:87], v[172:175]
  v_cvt_pk_bf16_f32 v74, v12, v13
  v_cvt_pk_bf16_f32 v75, v14, v15
  v_mfma_f32_16x16x32_bf16 v[204:207], a[108:111], v[88:91], v[204:207]
  v_or3_b32 v5, v5, v74, v75
  v_mfma_f32_16x16x32_bf16 v[236:239], a[108:111], v[92:95], v[236:239]
  v_exp_f32 v8, v56
  v_mfma_f32_16x16x32_bf16 v[176:179], a[112:115], v[84:87], v[176:179]
  v_exp_f32 v9, v57
  v_mfma_f32_16x16x32_bf16 v[208:211], a[112:115], v[88:91], v[208:211]
  v_exp_f32 v10, v58
  v_mfma_f32_16x16x32_bf16 v[240:243], a[112:115], v[92:95], v[240:243]
  v_exp_f32 v11, v59
  v_mfma_f32_16x16x32_bf16 v[180:183], a[116:119], v[84:87], v[180:183]
  v_cvt_pk_bf16_f32 v76, v8, v9
  v_cvt_pk_bf16_f32 v77, v10, v11
  v_mfma_f32_16x16x32_bf16 v[212:215], a[116:119], v[88:91], v[212:215]
  v_or3_b32 v5, v5, v76, v77
  v_mfma_f32_16x16x32_bf16 v[244:247], a[116:119], v[92:95], v[244:247]
  v_exp_f32 v12, v60
  v_mfma_f32_16x16x32_bf16 v[184:187], a[120:123], v[84:87], v[184:187]
  v_exp_f32 v13, v61
  v_mfma_f32_16x16x32_bf16 v[216:219], a[120:123], v[88:91], v[216:219]
  v_exp_f32 v14, v62
  v_mfma_f32_16x16x32_bf16 v[248:251], a[120:123], v[92:95], v[248:251]
  v_exp_f32 v15, v63
  v_mfma_f32_16x16x32_bf16 v[188:191], a[124:127], v[84:87], v[188:191]
  v_cvt_pk_bf16_f32 v78, v12, v13
  v_cvt_pk_bf16_f32 v79, v14, v15
  v_mfma_f32_16x16x32_bf16 v[220:223], a[124:127], v[88:91], v[220:223]
  v_or3_b32 v5, v5, v78, v79
  v_and_b32 v5, s70, v5
  v_mfma_f32_16x16x32_bf16 v[252:255], a[124:127], v[92:95], v[252:255]
  v_cmp_ne_u32 vcc, 0, v5
  v_cmp_gt_i32 s[80:81], 32, v25
  v_cmp_gt_i32 s[82:83], 33, v25
  v_cmp_gt_i32 s[84:85], 34, v25
  v_cmp_gt_i32 s[86:87], 35, v25
  v_cndmask_b32 v112, v112, v24, s[80:81]
  v_cndmask_b32 v113, v113, v24, s[82:83]
  v_cndmask_b32 v114, v114, v24, s[84:85]
  v_cndmask_b32 v115, v115, v24, s[86:87]
  v_cmp_gt_i32 s[80:81], 48, v25
  v_cmp_gt_i32 s[82:83], 49, v25
  v_cmp_gt_i32 s[84:85], 50, v25
  v_cmp_gt_i32 s[86:87], 51, v25
  v_cndmask_b32 v116, v116, v24, s[80:81]
  v_cndmask_b32 v117, v117, v24, s[82:83]
  v_cndmask_b32 v118, v118, v24, s[84:85]
  v_cndmask_b32 v119, v119, v24, s[86:87]
  v_add_u32 v4, 0x4000, v4
  v_and_b32 v4, 0x1ffff, v4
  s_cbranch_vccnz L_a_d4_t
L_a_d4_r:
L_a_d5:
  s_waitcnt vmcnt(24) lgkmcnt(0)
  v_mfma_f32_16x16x32_bf16 v[48:51], a[64:67], a[32:35], v[112:115]
  s_barrier
  ds_read_b128 a[96:99], v4 offset:0
  v_mfma_f32_16x16x32_bf16 v[48:51], a[72:75], a[36:39], v[48:51]
  s_nop 0
  ds_read_b128 a[100:103], v4 offset:1024
  v_mfma_f32_16x16x32_bf16 v[48:51], a[80:83], a[40:43], v[48:51]
  s_nop 0
  ds_read_b128 a[104:107], v4 offset:2048
  v_mfma_f32_16x16x32_bf16 v[48:51], a[88:91], a[44:47], v[48:51]
  s_nop 0
  ds_read_b128 a[108:111], v4 offset:3072
  v_mfma_f32_16x16x32_bf16 v[52:55], a[68:71], a[32:35], v[116:119]
  s_nop 0
  ds_read_b128 a[112:115], v4 offset:4096
  v_mfma_f32_16x16x32_bf16 v[52:55], a[76:79], a[36:39], v[52:55]
  s_nop 0
  ds_read_b128 a[116:119], v4 offset:5120
  v_mfma_f32_16x16x32_bf16 v[52:55], a[84:87], a[40:43], v[52:55]
  s_nop 0
  ds_read_b128 a[120:123], v4 offset:6144
  v_mfma_f32_16x16x32_bf16 v[52:55], a[92:95], a[44:47], v[52:55]
  s_nop 0
  ds_read_b128 a[124:127], v4 offset:7168
  v_mfma_f32_16x16x32_bf16 v[56:59], a[64:67], a[48:51], v[120:123]
  s_add_u32 m0, s73, 49152
  s_add_u32 s66, s72, 384
  buffer_load_dwordx4 v26, s[48:51], s66 offen lds
  v_mfma_f32_16x16x32_bf16 v[56:59], a[72:75], a[52:55], v[56:59]
  s_add_u32 m0, s73, 50176
  s_add_u32 s66, s72, 8576
  buffer_load_dwordx4 v26, s[48:51], s66 offen lds
  v_mfma_f32_16x16x32_bf16 v[56:59], a[80:83], a[56:59], v[56:59]
  s_add_u32 m0, s73, 51200
  s_add_u32 s66, s72, 16768
  buffer_load_dwordx4 v26, s[48:51], s66 offen lds
  v_mfma_f32_16x16x32_bf16 v[56:59], a[88:91], a[60:63], v[56:59]
  s_add_u32 m0, s73, 52224
  s_add_u32 s66, s72, 24960
  buffer_load_dwordx4 v26, s[48:51], s66 offen lds
  v_mfma_f32_16x16x32_bf16 v[60:63], a[68:71], a[48:51], v[124:127]
  s_add_u32 s58, s58, 1
  v_exp_f32 v8, v48
  v_mfma_f32_16x16x32_bf16 v[60:63], a[76:79], a[52:55], v[60:63]
  s_nop 0
  v_exp_f32 v9, v49
  v_mfma_f32_16x16x32_bf16 v[60:63], a[84:87], a[56:59], v[60:63]
  s_nop 0
  v_exp_f32 v10, v50
  v_mfma_f32_16x16x32_bf16 v[60:63], a[92:95], a[60:63], v[60:63]
  s_nop 0
  v_exp_f32 v11, v51
  v_mfma_f32_16x16x32_bf16 a[136:139], v[16:19], v[72:75], a[136:139]
  s_nop 0
  ds_read_b128 a[64:67], v4 offset:8192
  v_cvt_pk_bf16_f32 v88, v8, v9
  v_mfma_f32_16x16x32_bf16 a[140:143], v[16:19], v[76:79], a[140:143]
  s_nop 0
  ds_read_b128 a[68:71], v4 offset:9216
  v_cvt_pk_bf16_f32 v89, v10, v11
  s_waitcnt lgkmcnt(2)
  v_mfma_f32_16x16x32_bf16 v[192:195], a[96:99], v[72:75], v[192:195]
  s_nop 0
  ds_read_b128 a[72:75], v4 offset:10240
  v_or_b32 v5, v88, v89
  v_mfma_f32_16x16x32_bf16 v[224:227], a[96:99], v[76:79], v[224:227]
  s_nop 0
  ds_read_b128 a[76:79], v4 offset:11264
  v_mfma_f32_16x16x32_bf16 v[196:199], a[100:103], v[72:75], v[196:199]
  ds_read_b128 a[80:83], v4 offset:12288
  v_mfma_f32_16x16x32_bf16 v[228:231], a[100:103], v[76:79], v[228:231]
  ds_read_b128 a[84:87], v4 offset:13312
  v_mfma_f32_16x16x32_bf16 v[200:203], a[104:107], v[72:75], v[200:203]
  ds_read_b128 a[88:91], v4 offset:14336
  v_mfma_f32_16x16x32_bf16 v[232:235], a[104:107], v[76:79], v[232:235]
  ds_read_b128 a[92:95], v4 offset:15360
  v_mfma_f32_16x16x32_bf16 v[204:207], a[108:111], v[72:75], v[204:207]
  v_exp_f32 v12, v52
  v_mfma_f32_16x16x32_bf16 v[236:239], a[108:111], v[76:79], v[236:239]
  v_exp_f32 v13, v53
  v_mfma_f32_16x16x32_bf16 v[208:211], a[112:115], v[72:75], v[208:211]
  v_exp_f32 v14, v54
  v_mfma_f32_16x16x32_bf16 v[240:243], a[112:115], v[76:79], v[240:243]
  v_exp_f32 v15, v55
  v_mfma_f32_16x16x32_bf16 v[212:215], a[116:119], v[72:75], v[212:215]
  v_cvt_pk_bf16_f32 v90, v12, v13
  v_cvt_pk_bf16_f32 v91, v14, v15
  v_mfma_f32_16x16x32_bf16 v[244:247], a[116:119], v[76:79], v[244:247]
  v_or3_b32 v5, v5, v90, v91
  v_mfma_f32_16x16x32_bf16 v[216:219], a[120:123], v[72:75], v[216:219]
  v_exp_f32 v8, v56
  v_mfma_f32_16x16x32_bf16 v[248:251], a[120:123], v[76:79], v[248:251]
  v_exp_f32 v9, v57
  v_mfma_f32_16x16x32_bf16 v[220:223], a[124:127], v[72:75], v[220:223]
  v_exp_f32 v10, v58
  v_mfma_f32_16x16x32_bf16 v[252:255], a[124:127], v[76:79], v[252:255]
  v_exp_f32 v11, v59
  s_nop 0
  v_cvt_pk_bf16_f32 v92, v8, v9
  v_cvt_pk_bf16_f32 v93, v10, v11
  v_or3_b32 v5, v5, v92, v93
  v_exp_f32 v12, v60
  v_exp_f32 v13, v61
  v_exp_f32 v14, v62
  v_exp_f32 v15, v63
  s_nop 0
  v_cvt_pk_bf16_f32 v94, v12, v13
  v_cvt_pk_bf16_f32 v95, v14, v15
  v_or3_b32 v5, v5, v94, v95
  v_and_b32 v5, s70, v5
  v_cmp_ne_u32 vcc, 0, v5
  v_cmp_gt_i32 s[80:81], 0, v25
  v_cmp_gt_i32 s[82:83], 1, v25
  v_cmp_gt_i32 s[84:85], 2, v25
  v_cmp_gt_i32 s[86:87], 3, v25
  v_cndmask_b32 v120, v120, v24, s[80:81]
  v_cndmask_b32 v121, v121, v24, s[82:83]
  v_cndmask_b32 v122, v122, v24, s[84:85]
  v_cndmask_b32 v123, v123, v24, s[86:87]
  v_cmp_gt_i32 s[80:81], 16, v25
  v_cmp_gt_i32 s[82:83], 17, v25
  v_cmp_gt_i32 s[84:85], 18, v25
  v_cmp_gt_i32 s[86:87], 19, v25
  v_cndmask_b32 v124, v124, v24, s[80:81]
  v_cndmask_b32 v125, v125, v24, s[82:83]
  v_cndmask_b32 v126, v126, v24, s[84:85]
  v_cndmask_b32 v127, v127, v24, s[86:87]
  v_add_u32 v4, 0x4000, v4
  v_and_b32 v4, 0x1ffff, v4
  s_cbranch_vccnz L_a_d5_t
L_a_d5_r:
L_a_d6:
  s_waitcnt vmcnt(24) lgkmcnt(0)
  v_mfma_f32_16x16x32_bf16 v[56:59], a[64:67], a[48:51], v[120:123]
  s_barrier
  ds_read_b128 a[96:99], v4 offset:0
  v_mfma_f32_16x16x32_bf16 v[56:59], a[72:75], a[52:55], v[56:59]
  s_nop 0
  ds_read_b128 a[100:103], v4 offset:1024
  v_mfma_f32_16x16x32_bf16 v[56:59], a[80:83], a[56:59], v[56:59]
  s_nop 0
  ds_read_b128 a[104:107], v4 offset:2048
  v_mfma_f32_16x16x32_bf16 v[56:59], a[88:91], a[60:63], v[56:59]
  s_nop 0
  ds_read_b128 a[108:111], v4 offset:3072
  v_mfma_f32_16x16x32_bf16 v[60:63], a[68:71], a[48:51], v[124:127]
  s_nop 0
  ds_read_b128 a[112:115], v4 offset:4096
  v_mfma_f32_16x16x32_bf16 v[60:63], a[76:79], a[52:55], v[60:63]
  s_nop 0
  ds_read_b128 a[116:119], v4 offset:5120
  v_mfma_f32_16x16x32_bf16 v[60:63], a[84:87], a[56:59], v[60:63]
  s_nop 0
  ds_read_b128 a[120:123], v4 offset:6144
  v_mfma_f32_16x16x32_bf16 v[60:63], a[92:95], a[60:63], v[60:63]
  s_nop 0
  ds_read_b128 a[124:127], v4 offset:7168
  v_mfma_f32_16x16x32_bf16 a[136:139], v[16:19], v[88:91], a[136:139]
  s_add_u32 m0, s73, 65536
  s_add_u32 s66, s72, 512
  buffer_load_dwordx4 v26, s[48:51], s66 offen lds
  v_mfma_f32_16x16x32_bf16 a[140:143], v[16:19], v[92:95], a[140:143]
  s_add_u32 m0, s73, 66560
  s_add_u32 s66, s72, 8704
  buffer_load_dwordx4 v26, s[48:51], s66 offen lds
  s_waitcnt lgkmcnt(0)
  v_mfma_f32_16x16x32_bf16 v[192:195], a[96:99], v[88:91], v[192:195]
  s_add_u32 m0, s73, 67584
  s_add_u32 s66, s72, 16896
  buffer_load_dwordx4 v26, s[48:51], s66 offen lds
  v_mfma_f32_16x16x32_bf16 v[224:227], a[96:99], v[92:95], v[224:227]
  s_add_u32 m0, s73, 68608
  s_add_u32 s66, s72, 25088
  buffer_load_dwordx4 v26, s[48:51], s66 offen lds
  v_mfma_f32_16x16x32_bf16 v[196:199], a[100:103], v[88:91], v[196:199]
  s_add_u32 s58, s58, 1
  ds_read_b128 a[64:67], v4 offset:8192
  v_mfma_f32_16x16x32_bf16 v[228:231], a[100:103], v[92:95], v[228:231]
  ds_read_b128 a[68:71], v4 offset:9216
  v_mfma_f32_16x16x32_bf16 v[200:203], a[104:107], v[88:91], v[200:203]
  ds_read_b128 a[72:75], v4 offset:10240
  v_mfma_f32_16x16x32_bf16 v[232:235], a[104:107], v[92:95], v[232:235]
  ds_read_b128 a[76:79], v4 offset:11264
  v_mfma_f32_16x16x32_bf16 v[204:207], a[108:111], v[88:91], v[204:207]
  ds_read_b128 a[80:83], v4 offset:12288
  v_mfma_f32_16x16x32_bf16 v[236:239], a[108:111], v[92:95], v[236:239]
  ds_read_b128 a[84:87], v4 offset:13312
  v_mfma_f32_16x16x32_bf16 v[208:211], a[112:115], v[88:91], v[208:211]
  ds_read_b128 a[88:91], v4 offset:14336
  v_mfma_f32_16x16x32_bf16 v[240:243], a[112:115], v[92:95], v[240:243]
  ds_read_b128 a[92:95], v4 offset:15360
  v_mfma_f32_16x16x32_bf16 v[212:215], a[116:119], v[88:91], v[212:215]
  v_exp_f32 v8, v56
  v_mfma_f32_16x16x32_bf16 v[244:247], a[116:119], v[92:95], v[244:247]
  v_exp_f32 v9, v57
  v_mfma_f32_16x16x32_bf16 v[216:219], a[120:123], v[88:91], v[216:219]
  v_exp_f32 v10, v58
  v_mfma_f32_16x16x32_bf16 v[248:251], a[120:123], v[92:95], v[248:251]
  v_exp_f32 v11, v59
  v_mfma_f32_16x16x32_bf16 v[220:223], a[124:127], v[88:91], v[220:223]
  v_cvt_pk_bf16_f32 v76, v8, v9
  v_cvt_pk_bf16_f32 v77, v10, v11
  v_mfma_f32_16x16x32_bf16 v[252:255], a[124:127], v[92:95], v[252:255]
  v_or_b32 v5, v76, v77
  v_exp_f32 v12, v60
  v_exp_f32 v13, v61
  v_exp_f32 v14, v62
  v_exp_f32 v15, v63
  s_nop 0
  v_cvt_pk_bf16_f32 v78, v12, v13
  v_cvt_pk_bf16_f32 v79, v14, v15
  v_or3_b32 v5, v5, v78, v79
  v_and_b32 v5, s70, v5
  v_cmp_ne_u32 vcc, 0, v5
  v_cmp_gt_i32 s[80:81], 32, v25
  v_cmp_gt_i32 s[82:83], 33, v25
  v_cmp_gt_i32 s[84:85], 34, v25
  v_cmp_gt_i32 s[86:87], 35, v25
  v_cndmask_b32 v120, v120, v24, s[80:81]
  v_cndmask_b32 v121, v121, v24, s[82:83]
  v_cndmask_b32 v122, v122, v24, s[84:85]
  v_cndmask_b32 v123, v123, v24, s[86:87]
  v_cmp_gt_i32 s[80:81], 48, v25
  v_cmp_gt_i32 s[82:83], 49, v25
  v_cmp_gt_i32 s[84:85], 50, v25
  v_cmp_gt_i32 s[86:87], 51, v25
  v_cndmask_b32 v124, v124, v24, s[80:81]
  v_cndmask_b32 v125, v125, v24, s[82:83]
  v_cndmask_b32 v126, v126, v24, s[84:85]
  v_cndmask_b32 v127, v127, v24, s[86:87]
  v_add_u32 v4, 0x4000, v4
  v_and_b32 v4, 0x1ffff, v4
  s_cbranch_vccnz L_a_d6_t
L_a_d6_r:
L_a_d7:
  s_waitcnt vmcnt(24) lgkmcnt(0)
  v_mfma_f32_16x16x32_bf16 v[56:59], a[64:67], a[48:51], v[120:123]
  s_barrier
  ds_read_b128 a[96:99], v4 offset:0
  v_mfma_f32_16x16x32_bf16 v[56:59], a[72:75], a[52:55], v[56:59]
  s_nop 0
  ds_read_b128 a[100:103], v4 offset:1024
  v_mfma_f32_16x16x32_bf16 v[56:59], a[80:83], a[56:59], v[56:59]
  s_nop 0
  ds_read_b128 a[104:107], v4 offset:2048
  v_mfma_f32_16x16x32_bf16 v[56:59], a[88:91], a[60:63], v[56:59]
  s_nop 0
  ds_read_b128 a[108:111], v4 offset:3072
  v_mfma_f32_16x16x32_bf16 v[60:63], a[68:71], a[48:51], v[124:127]
  s_nop 0
  ds_read_b128 a[112:115], v4 offset:4096
  v_mfma_f32_16x16x32_bf16 v[60:63], a[76:79], a[52:55], v[60:63]
  s_nop 0
  ds_read_b128 a[116:119], v4 offset:5120
  v_mfma_f32_16x16x32_bf16 v[60:63], a[84:87], a[56:59], v[60:63]
  s_nop 0
  ds_read_b128 a[120:123], v4 offset:6144
  v_mfma_f32_16x16x32_bf16 v[60:63], a[92:95], a[60:63], v[60:63]
  s_nop 0
  ds_read_b128 a[124:127], v4 offset:7168
  v_mfma_f32_16x16x32_bf16 a[140:143], v[16:19], v[76:79], a[140:143]
  s_add_u32 m0, s73, 81920
  s_add_u32 s66, s72, 640
  buffer_load_dwordx4 v26, s[48:51], s66 offen lds
  s_waitcnt lgkmcnt(0)
  v_mfma_f32_16x16x32_bf16 v[224:227], a[96:99], v[76:79], v[224:227]
  s_add_u32 m0, s73, 82944
  s_add_u32 s66, s72, 8832
  buffer_load_dwordx4 v26, s[48:51], s66 offen lds
  v_mfma_f32_16x16x32_bf16 v[228:231], a[100:103], v[76:79], v[228:231]
  s_add_u32 m0, s73, 83968
  s_add_u32 s66, s72, 17024
  buffer_load_dwordx4 v26, s[48:51], s66 offen lds
  v_mfma_f32_16x16x32_bf16 v[232:235], a[104:107], v[76:79], v[232:235]
  s_add_u32 m0, s73, 84992
  s_add_u32 s66, s72, 25216
  buffer_load_dwordx4 v26, s[48:51], s66 offen lds
  v_mfma_f32_16x16x32_bf16 v[236:239], a[108:111], v[76:79], v[236:239]
  s_add_u32 s58, s58, 1
  v_exp_f32 v8, v56
  v_mfma_f32_16x16x32_bf16 v[240:243], a[112:115], v[76:79], v[240:243]
  v_exp_f32 v9, v57
  v_mfma_f32_16x16x32_bf16 v[244:247], a[116:119], v[76:79], v[244:247]
  v_exp_f32 v10, v58
  v_mfma_f32_16x16x32_bf16 v[248:251], a[120:123], v[76:79], v[248:251]
  v_exp_f32 v11, v59
  v_mfma_f32_16x16x32_bf16 v[252:255], a[124:127], v[76:79], v[252:255]
  v_cvt_pk_bf16_f32 v92, v8, v9
  v_cvt_pk_bf16_f32 v93, v10, v11
  v_or_b32 v5, v92, v93
  v_exp_f32 v12, v60
  v_exp_f32 v13, v61
  v_exp_f32 v14, v62
  v_exp_f32 v15, v63
  s_nop 0
  v_cvt_pk_bf16_f32 v94, v12, v13
  v_cvt_pk_bf16_f32 v95, v14, v15
  v_or3_b32 v5, v5, v94, v95
  v_and_b32 v5, s70, v5
  v_cmp_ne_u32 vcc, 0, v5
  v_add_u32 v4, 0x4000, v4
  v_and_b32 v4, 0x1ffff, v4
  s_cbranch_vccnz L_a_d7_t
L_a_d7_r:
  s_waitcnt vmcnt(24)
  s_barrier
  ds_read_b128 a[96:99], v4 offset:0
  ds_read_b128 a[100:103], v4 offset:1024
  ds_read_b128 a[104:107], v4 offset:2048
  ds_read_b128 a[108:111], v4 offset:3072
  ds_read_b128 a[112:115], v4 offset:4096
  ds_read_b128 a[116:119], v4 offset:5120
  ds_read_b128 a[120:123], v4 offset:6144
  ds_read_b128 a[124:127], v4 offset:7168
  s_add_u32 m0, s73, 98304
  s_add_u32 s66, s72, 768
  buffer_load_dwordx4 v26, s[48:51], s66 offen lds
  s_add_u32 m0, s73, 99328
  s_add_u32 s66, s72, 8960
  buffer_load_dwordx4 v26, s[48:51], s66 offen lds
  s_add_u32 m0, s73, 100352
  s_add_u32 s66, s72, 17152
  buffer_load_dwordx4 v26, s[48:51], s66 offen lds
  s_add_u32 m0, s73, 101376
  s_add_u32 s66, s72, 25344
  buffer_load_dwordx4 v26, s[48:51], s66 offen lds
  v_mfma_f32_16x16x32_bf16 a[140:143], v[16:19], v[92:95], a[140:143]
  s_waitcnt lgkmcnt(7)
  v_mfma_f32_16x16x32_bf16 v[224:227], a[96:99], v[92:95], v[224:227]
  s_waitcnt lgkmcnt(6)
  v_mfma_f32_16x16x32_bf16 v[228:231], a[100:103], v[92:95], v[228:231]
  s_waitcnt lgkmcnt(5)
  v_mfma_f32_16x16x32_bf16 v[232:235], a[104:107], v[92:95], v[232:235]
  s_waitcnt lgkmcnt(4)
  v_mfma_f32_16x16x32_bf16 v[236:239], a[108:111], v[92:95], v[236:239]
  s_waitcnt lgkmcnt(3)
  v_mfma_f32_16x16x32_bf16 v[240:243], a[112:115], v[92:95], v[240:243]
  s_waitcnt lgkmcnt(2)
  v_mfma_f32_16x16x32_bf16 v[244:247], a[116:119], v[92:95], v[244:247]
  s_waitcnt lgkmcnt(1)
  v_mfma_f32_16x16x32_bf16 v[248:251], a[120:123], v[92:95], v[248:251]
  s_waitcnt lgkmcnt(0)
  v_mfma_f32_16x16x32_bf16 v[252:255], a[124:127], v[92:95], v[252:255]
  s_barrier
  s_add_u32 m0, s73, 114688
  s_add_u32 s66, s72, 896
  buffer_load_dwordx4 v26, s[48:51], s66 offen lds
  s_add_u32 m0, s73, 115712
  s_add_u32 s66, s72, 9088
  buffer_load_dwordx4 v26, s[48:51], s66 offen lds
  s_add_u32 m0, s73, 116736
  s_add_u32 s66, s72, 17280
  buffer_load_dwordx4 v26, s[48:51], s66 offen lds
  s_add_u32 m0, s73, 117760
  s_add_u32 s66, s72, 25472
  buffer_load_dwordx4 v26, s[48:51], s66 offen lds
  v_accvgpr_read_b32 v6, a128
  v_rcp_f32 v6, v6
  s_nop 0
  v_mul_f32 v20, v20, v6
  v_accvgpr_read_b32 v6, a132
  v_rcp_f32 v6, v6
  s_nop 0
  v_mul_f32 v21, v21, v6
  v_accvgpr_read_b32 v6, a136
  v_rcp_f32 v6, v6
  s_nop 0
  v_mul_f32 v22, v22, v6
  v_accvgpr_read_b32 v6, a140
  v_rcp_f32 v6, v6
  s_nop 0
  v_mul_f32 v23, v23, v6
  v_mul_f32 v128, v128, v20
  v_mul_f32 v129, v129, v20
  v_mul_f32 v130, v130, v20
  v_mul_f32 v131, v131, v20
  v_mul_f32 v132, v132, v20
  v_mul_f32 v133, v133, v20
  v_mul_f32 v134, v134, v20
  v_mul_f32 v135, v135, v20
  v_cvt_pk_bf16_f32 v32, v128, v129
  v_cvt_pk_bf16_f32 v33, v130, v131
  v_cvt_pk_bf16_f32 v34, v132, v133
  v_cvt_pk_bf16_f32 v35, v134, v135
  v_mul_f32 v136, v136, v20
  v_mul_f32 v137, v137, v20
  v_mul_f32 v138, v138, v20
  v_mul_f32 v139, v139, v20
  v_mul_f32 v140, v140, v20
  v_mul_f32 v141, v141, v20
  v_mul_f32 v142, v142, v20
  v_mul_f32 v143, v143, v20
  v_cvt_pk_bf16_f32 v36, v136, v137
  v_cvt_pk_bf16_f32 v37, v138, v139
  v_cvt_pk_bf16_f32 v38, v140, v141
  v_cvt_pk_bf16_f32 v39, v142, v143
  v_mul_f32 v144, v144, v20
  v_mul_f32 v145, v145, v20
  v_mul_f32 v146, v146, v20
  v_mul_f32 v147, v147, v20
  v_mul_f32 v148, v148, v20
  v_mul_f32 v149, v149, v20
  v_mul_f32 v150, v150, v20
  v_mul_f32 v151, v151, v20
  v_cvt_pk_bf16_f32 v40, v144, v145
  v_cvt_pk_bf16_f32 v41, v146, v147
  v_cvt_pk_bf16_f32 v42, v148, v149
  v_cvt_pk_bf16_f32 v43, v150, v151
  v_mul_f32 v152, v152, v20
  v_mul_f32 v153, v153, v20
  v_mul_f32 v154, v154, v20
  v_mul_f32 v155, v155, v20
  v_mul_f32 v156, v156, v20
  v_mul_f32 v157, v157, v20
  v_mul_f32 v158, v158, v20
  v_mul_f32 v159, v159, v20
  v_cvt_pk_bf16_f32 v44, v152, v153
  v_cvt_pk_bf16_f32 v45, v154, v155
  v_cvt_pk_bf16_f32 v46, v156, v157
  v_cvt_pk_bf16_f32 v47, v158, v159
  v_mul_f32 v160, v160, v21
  v_mul_f32 v161, v161, v21
  v_mul_f32 v162, v162, v21
  v_mul_f32 v163, v163, v21
  v_mul_f32 v164, v164, v21
  v_mul_f32 v165, v165, v21
  v_mul_f32 v166, v166, v21
  v_mul_f32 v167, v167, v21
  v_cvt_pk_bf16_f32 v48, v160, v161
  v_cvt_pk_bf16_f32 v49, v162, v163
  v_cvt_pk_bf16_f32 v50, v164, v165
  v_cvt_pk_bf16_f32 v51, v166, v167
  v_mul_f32 v168, v168, v21
  v_mul_f32 v169, v169, v21
  v_mul_f32 v170, v170, v21
  v_mul_f32 v171, v171, v21
  v_mul_f32 v172, v172, v21
  v_mul_f32 v173, v173, v21
  v_mul_f32 v174, v174, v21
  v_mul_f32 v175, v175, v21
  v_cvt_pk_bf16_f32 v52, v168, v169
  v_cvt_pk_bf16_f32 v53, v170, v171
  v_cvt_pk_bf16_f32 v54, v172, v173
  v_cvt_pk_bf16_f32 v55, v174, v175
  v_mul_f32 v176, v176, v21
  v_mul_f32 v177, v177, v21
  v_mul_f32 v178, v178, v21
  v_mul_f32 v179, v179, v21
  v_mul_f32 v180, v180, v21
  v_mul_f32 v181, v181, v21
  v_mul_f32 v182, v182, v21
  v_mul_f32 v183, v183, v21
  v_cvt_pk_bf16_f32 v56, v176, v177
  v_cvt_pk_bf16_f32 v57, v178, v179
  v_cvt_pk_bf16_f32 v58, v180, v181
  v_cvt_pk_bf16_f32 v59, v182, v183
  v_mul_f32 v184, v184, v21
  v_mul_f32 v185, v185, v21
  v_mul_f32 v186, v186, v21
  v_mul_f32 v187, v187, v21
  v_mul_f32 v188, v188, v21
  v_mul_f32 v189, v189, v21
  v_mul_f32 v190, v190, v21
  v_mul_f32 v191, v191, v21
  v_cvt_pk_bf16_f32 v60, v184, v185
  v_cvt_pk_bf16_f32 v61, v186, v187
  v_cvt_pk_bf16_f32 v62, v188, v189
  v_cvt_pk_bf16_f32 v63, v190, v191
  v_mul_f32 v192, v192, v22
  v_mul_f32 v193, v193, v22
  v_mul_f32 v194, v194, v22
  v_mul_f32 v195, v195, v22
  v_mul_f32 v196, v196, v22
  v_mul_f32 v197, v197, v22
  v_mul_f32 v198, v198, v22
  v_mul_f32 v199, v199, v22
  v_cvt_pk_bf16_f32 v64, v192, v193
  v_cvt_pk_bf16_f32 v65, v194, v195
  v_cvt_pk_bf16_f32 v66, v196, v197
  v_cvt_pk_bf16_f32 v67, v198, v199
  v_mul_f32 v200, v200, v22
  v_mul_f32 v201, v201, v22
  v_mul_f32 v202, v202, v22
  v_mul_f32 v203, v203, v22
  v_mul_f32 v204, v204, v22
  v_mul_f32 v205, v205, v22
  v_mul_f32 v206, v206, v22
  v_mul_f32 v207, v207, v22
  v_cvt_pk_bf16_f32 v68, v200, v201
  v_cvt_pk_bf16_f32 v69, v202, v203
  v_cvt_pk_bf16_f32 v70, v204, v205
  v_cvt_pk_bf16_f32 v71, v206, v207
  v_mul_f32 v208, v208, v22
  v_mul_f32 v209, v209, v22
  v_mul_f32 v210, v210, v22
  v_mul_f32 v211, v211, v22
  v_mul_f32 v212, v212, v22
  v_mul_f32 v213, v213, v22
  v_mul_f32 v214, v214, v22
  v_mul_f32 v215, v215, v22
  v_cvt_pk_bf16_f32 v72, v208, v209
  v_cvt_pk_bf16_f32 v73, v210, v211
  v_cvt_pk_bf16_f32 v74, v212, v213
  v_cvt_pk_bf16_f32 v75, v214, v215
  v_mul_f32 v216, v216, v22
  v_mul_f32 v217, v217, v22
  v_mul_f32 v218, v218, v22
  v_mul_f32 v219, v219, v22
  v_mul_f32 v220, v220, v22
  v_mul_f32 v221, v221, v22
  v_mul_f32 v222, v222, v22
  v_mul_f32 v223, v223, v22
  v_cvt_pk_bf16_f32 v76, v216, v217
  v_cvt_pk_bf16_f32 v77, v218, v219
  v_cvt_pk_bf16_f32 v78, v220, v221
  v_cvt_pk_bf16_f32 v79, v222, v223
  v_mul_f32 v224, v224, v23
  v_mul_f32 v225, v225, v23
  v_mul_f32 v226, v226, v23
  v_mul_f32 v227, v227, v23
  v_mul_f32 v228, v228, v23
  v_mul_f32 v229, v229, v23
  v_mul_f32 v230, v230, v23
  v_mul_f32 v231, v231, v23
  v_cvt_pk_bf16_f32 v80, v224, v225
  v_cvt_pk_bf16_f32 v81, v226, v227
  v_cvt_pk_bf16_f32 v82, v228, v229
  v_cvt_pk_bf16_f32 v83, v230, v231
  v_mul_f32 v232, v232, v23
  v_mul_f32 v233, v233, v23
  v_mul_f32 v234, v234, v23
  v_mul_f32 v235, v235, v23
  v_mul_f32 v236, v236, v23
  v_mul_f32 v237, v237, v23
  v_mul_f32 v238, v238, v23
  v_mul_f32 v239, v239, v23
  v_cvt_pk_bf16_f32 v84, v232, v233
  v_cvt_pk_bf16_f32 v85, v234, v235
  v_cvt_pk_bf16_f32 v86, v236, v237
  v_cvt_pk_bf16_f32 v87, v238, v239
  v_mul_f32 v240, v240, v23
  v_mul_f32 v241, v241, v23
  v_mul_f32 v242, v242, v23
  v_mul_f32 v243, v243, v23
  v_mul_f32 v244, v244, v23
  v_mul_f32 v245, v245, v23
  v_mul_f32 v246, v246, v23
  v_mul_f32 v247, v247, v23
  v_cvt_pk_bf16_f32 v88, v240, v241
  v_cvt_pk_bf16_f32 v89, v242, v243
  v_cvt_pk_bf16_f32 v90, v244, v245
  v_cvt_pk_bf16_f32 v91, v246, v247
  v_mul_f32 v248, v248, v23
  v_mul_f32 v249, v249, v23
  v_mul_f32 v250, v250, v23
  v_mul_f32 v251, v251, v23
  v_mul_f32 v252, v252, v23
  v_mul_f32 v253, v253, v23
  v_mul_f32 v254, v254, v23
  v_mul_f32 v255, v255, v23
  v_cvt_pk_bf16_f32 v92, v248, v249
  v_cvt_pk_bf16_f32 v93, v250, v251
  v_cvt_pk_bf16_f32 v94, v252, v253
  v_cvt_pk_bf16_f32 v95, v254, v255
  v_lshrrev_b32 v6, 2, v0
  v_lshlrev_b32 v8, 7, v6
  v_bfe_u32 v6, v0, 3, 2
  v_lshl_add_u32 v8, v6, 5, v8
  v_and_b32 v6, 3, v0
  v_lshl_add_u32 v8, v6, 3, v8
  v_xor_b32 v9, 32, v8
  v_xor_b32 v10, 64, v8
  v_xor_b32 v11, 96, v8
  v_add_u32 v12, 0x10000, v8
  v_add_u32 v13, 0x10000, v9
  v_add_u32 v14, 0x10000, v10
  v_add_u32 v15, 0x10000, v11
  s_waitcnt vmcnt(4)
  s_barrier
  ds_read_b64_tr_b16 a[64:65], v8 offset:0
  ds_read_b64_tr_b16 a[66:67], v8 offset:2048
  ds_read_b64_tr_b16 a[68:69], v8 offset:4096
  ds_read_b64_tr_b16 a[70:71], v8 offset:6144
  ds_read_b64_tr_b16 a[72:73], v8 offset:8192
  ds_read_b64_tr_b16 a[74:75], v8 offset:10240
  ds_read_b64_tr_b16 a[76:77], v8 offset:12288
  ds_read_b64_tr_b16 a[78:79], v8 offset:14336
  ds_read_b64_tr_b16 a[80:81], v9 offset:0
  ds_read_b64_tr_b16 a[82:83], v9 offset:2048
  ds_read_b64_tr_b16 a[84:85], v9 offset:4096
  ds_read_b64_tr_b16 a[86:87], v9 offset:6144
  ds_read_b64_tr_b16 a[88:89], v9 offset:8192
  ds_read_b64_tr_b16 a[90:91], v9 offset:10240
  ds_read_b64_tr_b16 a[92:93], v9 offset:12288
  ds_read_b64_tr_b16 a[94:95], v9 offset:14336
  s_waitcnt lgkmcnt(8)
  v_mfma_f32_16x16x32_bf16 v[128:131], a[64:67], v[32:35], 0
  ds_read_b64_tr_b16 a[96:97], v10 offset:0
  v_mfma_f32_16x16x32_bf16 v[128:131], a[68:71], v[36:39], v[128:131]
  v_mfma_f32_16x16x32_bf16 v[128:131], a[72:75], v[40:43], v[128:131]
  ds_read_b64_tr_b16 a[98:99], v10 offset:2048
  v_mfma_f32_16x16x32_bf16 v[128:131], a[76:79], v[44:47], v[128:131]
  v_mfma_f32_16x16x32_bf16 v[136:139], a[64:67], v[48:51], 0
  ds_read_b64_tr_b16 a[100:101], v10 offset:4096
  v_mfma_f32_16x16x32_bf16 v[136:139], a[68:71], v[52:55], v[136:139]
  v_mfma_f32_16x16x32_bf16 v[136:139], a[72:75], v[56:59], v[136:139]
  ds_read_b64_tr_b16 a[102:103], v10 offset:6144
  v_mfma_f32_16x16x32_bf16 v[136:139], a[76:79], v[60:63], v[136:139]
  v_mfma_f32_16x16x32_bf16 v[144:147], a[64:67], v[64:67], 0
  ds_read_b64_tr_b16 a[104:105], v10 offset:8192
  v_mfma_f32_16x16x32_bf16 v[144:147], a[68:71], v[68:71], v[144:147]
  v_mfma_f32_16x16x32_bf16 v[144:147], a[72:75], v[72:75], v[144:147]
  ds_read_b64_tr_b16 a[106:107], v10 offset:10240
  v_mfma_f32_16x16x32_bf16 v[144:147], a[76:79], v[76:79], v[144:147]
  v_mfma_f32_16x16x32_bf16 v[152:155], a[64:67], v[80:83], 0
  ds_read_b64_tr_b16 a[108:109], v10 offset:12288
  v_mfma_f32_16x16x32_bf16 v[152:155], a[68:71], v[84:87], v[152:155]
  v_mfma_f32_16x16x32_bf16 v[152:155], a[72:75], v[88:91], v[152:155]
  ds_read_b64_tr_b16 a[110:111], v10 offset:14336
  v_mfma_f32_16x16x32_bf16 v[152:155], a[76:79], v[92:95], v[152:155]
  s_waitcnt lgkmcnt(8)
  v_mfma_f32_16x16x32_bf16 v[132:135], a[80:83], v[32:35], 0
  ds_read_b64_tr_b16 a[112:113], v11 offset:0
  v_mfma_f32_16x16x32_bf16 v[132:135], a[84:87], v[36:39], v[132:135]
  v_mfma_f32_16x16x32_bf16 v[132:135], a[88:91], v[40:43], v[132:135]
  ds_read_b64_tr_b16 a[114:115], v11 offset:2048
  v_mfma_f32_16x16x32_bf16 v[132:135], a[92:95], v[44:47], v[132:135]
  v_mfma_f32_16x16x32_bf16 v[140:143], a[80:83], v[48:51], 0
  ds_read_b64_tr_b16 a[116:117], v11 offset:4096
  v_mfma_f32_16x16x32_bf16 v[140:143], a[84:87], v[52:55], v[140:143]
  v_mfma_f32_16x16x32_bf16 v[140:143], a[88:91], v[56:59], v[140:143]
  ds_read_b64_tr_b16 a[118:119], v11 offset:6144
  v_mfma_f32_16x16x32_bf16 v[140:143], a[92:95], v[60:63], v[140:143]
  v_mfma_f32_16x16x32_bf16 v[148:151], a[80:83], v[64:67], 0
  ds_read_b64_tr_b16 a[120:121], v11 offset:8192
  v_mfma_f32_16x16x32_bf16 v[148:151], a[84:87], v[68:71], v[148:151]
  v_mfma_f32_16x16x32_bf16 v[148:151], a[88:91], v[72:75], v[148:151]
  ds_read_b64_tr_b16 a[122:123], v11 offset:10240
  v_mfma_f32_16x16x32_bf16 v[148:151], a[92:95], v[76:79], v[148:151]
  v_mfma_f32_16x16x32_bf16 v[156:159], a[80:83], v[80:83], 0
  ds_read_b64_tr_b16 a[124:125], v11 offset:12288
  v_mfma_f32_16x16x32_bf16 v[156:159], a[84:87], v[84:87], v[156:159]
  v_mfma_f32_16x16x32_bf16 v[156:159], a[88:91], v[88:91], v[156:159]
  ds_read_b64_tr_b16 a[126:127], v11 offset:14336
  v_mfma_f32_16x16x32_bf16 v[156:159], a[92:95], v[92:95], v[156:159]
  s_waitcnt lgkmcnt(8)
  v_mfma_f32_16x16x32_bf16 v[160:163], a[96:99], v[32:35], 0
  ds_read_b64_tr_b16 a[64:65], v8 offset:16384
  v_mfma_f32_16x16x32_bf16 v[160:163], a[100:103], v[36:39], v[160:163]
  s_nop 1
  v_mfma_f32_16x16x32_bf16 v[160:163], a[104:107], v[40:43], v[160:163]
  ds_read_b64_tr_b16 a[66:67], v8 offset:18432
  v_mfma_f32_16x16x32_bf16 v[160:163], a[108:111], v[44:47], v[160:163]
  v_cvt_pk_bf16_f32 v96, v128, v129
  v_cvt_pk_bf16_f32 v97, v130, v131
  v_mfma_f32_16x16x32_bf16 v[168:171], a[96:99], v[48:51], 0
  ds_read_b64_tr_b16 a[68:69], v8 offset:20480
  v_mfma_f32_16x16x32_bf16 v[168:171], a[100:103], v[52:55], v[168:171]
  v_cvt_pk_bf16_f32 v98, v132, v133
  v_cvt_pk_bf16_f32 v99, v134, v135
  v_mfma_f32_16x16x32_bf16 v[168:171], a[104:107], v[56:59], v[168:171]
  ds_read_b64_tr_b16 a[70:71], v8 offset:22528
  v_mfma_f32_16x16x32_bf16 v[168:171], a[108:111], v[60:63], v[168:171]
  buffer_store_dwordx4 v[96:99], v2, s[40:43], s76 offen offset:0 sc1
  v_mfma_f32_16x16x32_bf16 v[176:179], a[96:99], v[64:67], 0
  ds_read_b64_tr_b16 a[72:73], v8 offset:24576
  v_mfma_f32_16x16x32_bf16 v[176:179], a[100:103], v[68:71], v[176:179]
  v_cvt_pk_bf16_f32 v100, v136, v137
  v_cvt_pk_bf16_f32 v101, v138, v139
  v_mfma_f32_16x16x32_bf16 v[176:179], a[104:107], v[72:75], v[176:179]
  ds_read_b64_tr_b16 a[74:75], v8 offset:26624
  v_mfma_f32_16x16x32_bf16 v[176:179], a[108:111], v[76:79], v[176:179]
  v_cvt_pk_bf16_f32 v102, v140, v141
  v_cvt_pk_bf16_f32 v103, v142, v143
  v_mfma_f32_16x16x32_bf16 v[184:187], a[96:99], v[80:83], 0
  ds_read_b64_tr_b16 a[76:77], v8 offset:28672
  v_mfma_f32_16x16x32_bf16 v[184:187], a[100:103], v[84:87], v[184:187]
  buffer_store_dwordx4 v[100:103], v2, s[40:43], s77 offen offset:0 sc1
  v_mfma_f32_16x16x32_bf16 v[184:187], a[104:107], v[88:91], v[184:187]
  ds_read_b64_tr_b16 a[78:79], v8 offset:30720
  v_mfma_f32_16x16x32_bf16 v[184:187], a[108:111], v[92:95], v[184:187]
  s_waitcnt lgkmcnt(8)
  v_cvt_pk_bf16_f32 v104, v144, v145
  v_cvt_pk_bf16_f32 v105, v146, v147
  v_mfma_f32_16x16x32_bf16 v[164:167], a[112:115], v[32:35], 0
  ds_read_b64_tr_b16 a[80:81], v9 offset:16384
  v_mfma_f32_16x16x32_bf16 v[164:167], a[116:119], v[36:39], v[164:167]
  v_cvt_pk_bf16_f32 v106, v148, v149
  v_cvt_pk_bf16_f32 v107, v150, v151
  v_mfma_f32_16x16x32_bf16 v[164:167], a[120:123], v[40:43], v[164:167]
  ds_read_b64_tr_b16 a[82:83], v9 offset:18432
  v_mfma_f32_16x16x32_bf16 v[164:167], a[124:127], v[44:47], v[164:167]
  buffer_store_dwordx4 v[104:107], v2, s[40:43], s78 offen offset:0 sc1
  v_mfma_f32_16x16x32_bf16 v[172:175], a[112:115], v[48:51], 0
  ds_read_b64_tr_b16 a[84:85], v9 offset:20480
  v_mfma_f32_16x16x32_bf16 v[172:175], a[116:119], v[52:55], v[172:175]
  v_cvt_pk_bf16_f32 v108, v152, v153
  v_cvt_pk_bf16_f32 v109, v154, v155
  v_mfma_f32_16x16x32_bf16 v[172:175], a[120:123], v[56:59], v[172:175]
  ds_read_b64_tr_b16 a[86:87], v9 offset:22528
  v_mfma_f32_16x16x32_bf16 v[172:175], a[124:127], v[60:63], v[172:175]
  v_cvt_pk_bf16_f32 v110, v156, v157
  v_cvt_pk_bf16_f32 v111, v158, v159
  v_mfma_f32_16x16x32_bf16 v[180:183], a[112:115], v[64:67], 0
  ds_read_b64_tr_b16 a[88:89], v9 offset:24576
  v_mfma_f32_16x16x32_bf16 v[180:183], a[116:119], v[68:71], v[180:183]
  buffer_store_dwordx4 v[108:111], v2, s[40:43], s79 offen offset:0 sc1
  v_mfma_f32_16x16x32_bf16 v[180:183], a[120:123], v[72:75], v[180:183]
  ds_read_b64_tr_b16 a[90:91], v9 offset:26624
  v_mfma_f32_16x16x32_bf16 v[180:183], a[124:127], v[76:79], v[180:183]
  v_mfma_f32_16x16x32_bf16 v[188:191], a[112:115], v[80:83], 0
  ds_read_b64_tr_b16 a[92:93], v9 offset:28672
  v_mfma_f32_16x16x32_bf16 v[188:191], a[116:119], v[84:87], v[188:191]
  v_mfma_f32_16x16x32_bf16 v[188:191], a[120:123], v[88:91], v[188:191]
  ds_read_b64_tr_b16 a[94:95], v9 offset:30720
  v_mfma_f32_16x16x32_bf16 v[188:191], a[124:127], v[92:95], v[188:191]
  s_waitcnt lgkmcnt(8)
  v_mfma_f32_16x16x32_bf16 v[128:131], a[64:67], v[32:35], 0
  ds_read_b64_tr_b16 a[96:97], v10 offset:16384
  v_mfma_f32_16x16x32_bf16 v[128:131], a[68:71], v[36:39], v[128:131]
  s_nop 1
  v_mfma_f32_16x16x32_bf16 v[128:131], a[72:75], v[40:43], v[128:131]
  ds_read_b64_tr_b16 a[98:99], v10 offset:18432
  v_mfma_f32_16x16x32_bf16 v[128:131], a[76:79], v[44:47], v[128:131]
  v_cvt_pk_bf16_f32 v112, v160, v161
  v_cvt_pk_bf16_f32 v113, v162, v163
  v_mfma_f32_16x16x32_bf16 v[136:139], a[64:67], v[48:51], 0
  ds_read_b64_tr_b16 a[100:101], v10 offset:20480
  v_mfma_f32_16x16x32_bf16 v[136:139], a[68:71], v[52:55], v[136:139]
  v_cvt_pk_bf16_f32 v114, v164, v165
  v_cvt_pk_bf16_f32 v115, v166, v167
  v_mfma_f32_16x16x32_bf16 v[136:139], a[72:75], v[56:59], v[136:139]
  ds_read_b64_tr_b16 a[102:103], v10 offset:22528
  v_mfma_f32_16x16x32_bf16 v[136:139], a[76:79], v[60:63], v[136:139]
  buffer_store_dwordx4 v[112:115], v2, s[40:43], s76 offen offset:1024 sc1
  v_mfma_f32_16x16x32_bf16 v[144:147], a[64:67], v[64:67], 0
  ds_read_b64_tr_b16 a[104:105], v10 offset:24576
  v_mfma_f32_16x16x32_bf16 v[144:147], a[68:71], v[68:71], v[144:147]
  v_cvt_pk_bf16_f32 v116, v168, v169
  v_cvt_pk_bf16_f32 v117, v170, v171
  v_mfma_f32_16x16x32_bf16 v[144:147], a[72:75], v[72:75], v[144:147]
  ds_read_b64_tr_b16 a[106:107], v10 offset:26624
  v_mfma_f32_16x16x32_bf16 v[144:147], a[76:79], v[76:79], v[144:147]
  v_cvt_pk_bf16_f32 v118, v172, v173
  v_cvt_pk_bf16_f32 v119, v174, v175
  v_mfma_f32_16x16x32_bf16 v[152:155], a[64:67], v[80:83], 0
  ds_read_b64_tr_b16 a[108:109], v10 offset:28672
  v_mfma_f32_16x16x32_bf16 v[152:155], a[68:71], v[84:87], v[152:155]
  buffer_store_dwordx4 v[116:119], v2, s[40:43], s77 offen offset:1024 sc1
  v_mfma_f32_16x16x32_bf16 v[152:155], a[72:75], v[88:91], v[152:155]
  ds_read_b64_tr_b16 a[110:111], v10 offset:30720
  v_mfma_f32_16x16x32_bf16 v[152:155], a[76:79], v[92:95], v[152:155]
  s_waitcnt lgkmcnt(8)
  v_cvt_pk_bf16_f32 v120, v176, v177
  v_cvt_pk_bf16_f32 v121, v178, v179
  v_mfma_f32_16x16x32_bf16 v[132:135], a[80:83], v[32:35], 0
  ds_read_b64_tr_b16 a[112:113], v11 offset:16384
  v_mfma_f32_16x16x32_bf16 v[132:135], a[84:87], v[36:39], v[132:135]
  v_cvt_pk_bf16_f32 v122, v180, v181
  v_cvt_pk_bf16_f32 v123, v182, v183
  v_mfma_f32_16x16x32_bf16 v[132:135], a[88:91], v[40:43], v[132:135]
  ds_read_b64_tr_b16 a[114:115], v11 offset:18432
  v_mfma_f32_16x16x32_bf16 v[132:135], a[92:95], v[44:47], v[132:135]
  buffer_store_dwordx4 v[120:123], v2, s[40:43], s78 offen offset:1024 sc1
  v_mfma_f32_16x16x32_bf16 v[140:143], a[80:83], v[48:51], 0
  ds_read_b64_tr_b16 a[116:117], v11 offset:20480
  v_mfma_f32_16x16x32_bf16 v[140:143], a[84:87], v[52:55], v[140:143]
  v_cvt_pk_bf16_f32 v124, v184, v185
  v_cvt_pk_bf16_f32 v125, v186, v187
  v_mfma_f32_16x16x32_bf16 v[140:143], a[88:91], v[56:59], v[140:143]
  ds_read_b64_tr_b16 a[118:119], v11 offset:22528
  v_mfma_f32_16x16x32_bf16 v[140:143], a[92:95], v[60:63], v[140:143]
  v_cvt_pk_bf16_f32 v126, v188, v189
  v_cvt_pk_bf16_f32 v127, v190, v191
  v_mfma_f32_16x16x32_bf16 v[148:151], a[80:83], v[64:67], 0
  ds_read_b64_tr_b16 a[120:121], v11 offset:24576
  v_mfma_f32_16x16x32_bf16 v[148:151], a[84:87], v[68:71], v[148:151]
  buffer_store_dwordx4 v[124:127], v2, s[40:43], s79 offen offset:1024 sc1
  v_mfma_f32_16x16x32_bf16 v[148:151], a[88:91], v[72:75], v[148:151]
  ds_read_b64_tr_b16 a[122:123], v11 offset:26624
  v_mfma_f32_16x16x32_bf16 v[148:151], a[92:95], v[76:79], v[148:151]
  v_mfma_f32_16x16x32_bf16 v[156:159], a[80:83], v[80:83], 0
  ds_read_b64_tr_b16 a[124:125], v11 offset:28672
  v_mfma_f32_16x16x32_bf16 v[156:159], a[84:87], v[84:87], v[156:159]
  v_mfma_f32_16x16x32_bf16 v[156:159], a[88:91], v[88:91], v[156:159]
  ds_read_b64_tr_b16 a[126:127], v11 offset:30720
  v_mfma_f32_16x16x32_bf16 v[156:159], a[92:95], v[92:95], v[156:159]
  s_waitcnt lgkmcnt(8)
  v_mfma_f32_16x16x32_bf16 v[160:163], a[96:99], v[32:35], 0
  ds_read_b64_tr_b16 a[64:65], v8 offset:32768
  v_mfma_f32_16x16x32_bf16 v[160:163], a[100:103], v[36:39], v[160:163]
  s_nop 1
  v_mfma_f32_16x16x32_bf16 v[160:163], a[104:107], v[40:43], v[160:163]
  ds_read_b64_tr_b16 a[66:67], v8 offset:34816
  v_mfma_f32_16x16x32_bf16 v[160:163], a[108:111], v[44:47], v[160:163]
  v_cvt_pk_bf16_f32 v96, v128, v129
  v_cvt_pk_bf16_f32 v97, v130, v131
  v_mfma_f32_16x16x32_bf16 v[168:171], a[96:99], v[48:51], 0
  ds_read_b64_tr_b16 a[68:69], v8 offset:36864
  v_mfma_f32_16x16x32_bf16 v[168:171], a[100:103], v[52:55], v[168:171]
  v_cvt_pk_bf16_f32 v98, v132, v133
  v_cvt_pk_bf16_f32 v99, v134, v135
  v_mfma_f32_16x16x32_bf16 v[168:171], a[104:107], v[56:59], v[168:171]
  ds_read_b64_tr_b16 a[70:71], v8 offset:38912
  v_mfma_f32_16x16x32_bf16 v[168:171], a[108:111], v[60:63], v[168:171]
  buffer_store_dwordx4 v[96:99], v2, s[40:43], s76 offen offset:2048 sc1
  v_mfma_f32_16x16x32_bf16 v[176:179], a[96:99], v[64:67], 0
  ds_read_b64_tr_b16 a[72:73], v8 offset:40960
  v_mfma_f32_16x16x32_bf16 v[176:179], a[100:103], v[68:71], v[176:179]
  v_cvt_pk_bf16_f32 v100, v136, v137
  v_cvt_pk_bf16_f32 v101, v138, v139
  v_mfma_f32_16x16x32_bf16 v[176:179], a[104:107], v[72:75], v[176:179]
  ds_read_b64_tr_b16 a[74:75], v8 offset:43008
  v_mfma_f32_16x16x32_bf16 v[176:179], a[108:111], v[76:79], v[176:179]
  v_cvt_pk_bf16_f32 v102, v140, v141
  v_cvt_pk_bf16_f32 v103, v142, v143
  v_mfma_f32_16x16x32_bf16 v[184:187], a[96:99], v[80:83], 0
  ds_read_b64_tr_b16 a[76:77], v8 offset:45056
  v_mfma_f32_16x16x32_bf16 v[184:187], a[100:103], v[84:87], v[184:187]
  buffer_store_dwordx4 v[100:103], v2, s[40:43], s77 offen offset:2048 sc1
  v_mfma_f32_16x16x32_bf16 v[184:187], a[104:107], v[88:91], v[184:187]
  ds_read_b64_tr_b16 a[78:79], v8 offset:47104
  v_mfma_f32_16x16x32_bf16 v[184:187], a[108:111], v[92:95], v[184:187]
  s_waitcnt lgkmcnt(8)
  v_cvt_pk_bf16_f32 v104, v144, v145
  v_cvt_pk_bf16_f32 v105, v146, v147
  v_mfma_f32_16x16x32_bf16 v[164:167], a[112:115], v[32:35], 0
  ds_read_b64_tr_b16 a[80:81], v9 offset:32768
  v_mfma_f32_16x16x32_bf16 v[164:167], a[116:119], v[36:39], v[164:167]
  v_cvt_pk_bf16_f32 v106, v148, v149
  v_cvt_pk_bf16_f32 v107, v150, v151
  v_mfma_f32_16x16x32_bf16 v[164:167], a[120:123], v[40:43], v[164:167]
  ds_read_b64_tr_b16 a[82:83], v9 offset:34816
  v_mfma_f32_16x16x32_bf16 v[164:167], a[124:127], v[44:47], v[164:167]
  buffer_store_dwordx4 v[104:107], v2, s[40:43], s78 offen offset:2048 sc1
  v_mfma_f32_16x16x32_bf16 v[172:175], a[112:115], v[48:51], 0
  ds_read_b64_tr_b16 a[84:85], v9 offset:36864
  v_mfma_f32_16x16x32_bf16 v[172:175], a[116:119], v[52:55], v[172:175]
  v_cvt_pk_bf16_f32 v108, v152, v153
  v_cvt_pk_bf16_f32 v109, v154, v155
  v_mfma_f32_16x16x32_bf16 v[172:175], a[120:123], v[56:59], v[172:175]
  ds_read_b64_tr_b16 a[86:87], v9 offset:38912
  v_mfma_f32_16x16x32_bf16 v[172:175], a[124:127], v[60:63], v[172:175]
  v_cvt_pk_bf16_f32 v110, v156, v157
  v_cvt_pk_bf16_f32 v111, v158, v159
  v_mfma_f32_16x16x32_bf16 v[180:183], a[112:115], v[64:67], 0
  ds_read_b64_tr_b16 a[88:89], v9 offset:40960
  v_mfma_f32_16x16x32_bf16 v[180:183], a[116:119], v[68:71], v[180:183]
  buffer_store_dwordx4 v[108:111], v2, s[40:43], s79 offen offset:2048 sc1
  v_mfma_f32_16x16x32_bf16 v[180:183], a[120:123], v[72:75], v[180:183]
  ds_read_b64_tr_b16 a[90:91], v9 offset:43008
  v_mfma_f32_16x16x32_bf16 v[180:183], a[124:127], v[76:79], v[180:183]
  v_mfma_f32_16x16x32_bf16 v[188:191], a[112:115], v[80:83], 0
  ds_read_b64_tr_b16 a[92:93], v9 offset:45056
  v_mfma_f32_16x16x32_bf16 v[188:191], a[116:119], v[84:87], v[188:191]
  v_mfma_f32_16x16x32_bf16 v[188:191], a[120:123], v[88:91], v[188:191]
  ds_read_b64_tr_b16 a[94:95], v9 offset:47104
  v_mfma_f32_16x16x32_bf16 v[188:191], a[124:127], v[92:95], v[188:191]
  s_waitcnt lgkmcnt(8)
  v_mfma_f32_16x16x32_bf16 v[128:131], a[64:67], v[32:35], 0
  ds_read_b64_tr_b16 a[96:97], v10 offset:32768
  v_mfma_f32_16x16x32_bf16 v[128:131], a[68:71], v[36:39], v[128:131]
  s_nop 1
  v_mfma_f32_16x16x32_bf16 v[128:131], a[72:75], v[40:43], v[128:131]
  ds_read_b64_tr_b16 a[98:99], v10 offset:34816
  v_mfma_f32_16x16x32_bf16 v[128:131], a[76:79], v[44:47], v[128:131]
  v_cvt_pk_bf16_f32 v112, v160, v161
  v_cvt_pk_bf16_f32 v113, v162, v163
  v_mfma_f32_16x16x32_bf16 v[136:139], a[64:67], v[48:51], 0
  ds_read_b64_tr_b16 a[100:101], v10 offset:36864
  v_mfma_f32_16x16x32_bf16 v[136:139], a[68:71], v[52:55], v[136:139]
  v_cvt_pk_bf16_f32 v114, v164, v165
  v_cvt_pk_bf16_f32 v115, v166, v167
  v_mfma_f32_16x16x32_bf16 v[136:139], a[72:75], v[56:59], v[136:139]
  ds_read_b64_tr_b16 a[102:103], v10 offset:38912
  v_mfma_f32_16x16x32_bf16 v[136:139], a[76:79], v[60:63], v[136:139]
  buffer_store_dwordx4 v[112:115], v2, s[40:43], s76 offen offset:3072 sc1
  v_mfma_f32_16x16x32_bf16 v[144:147], a[64:67], v[64:67], 0
  ds_read_b64_tr_b16 a[104:105], v10 offset:40960
  v_mfma_f32_16x16x32_bf16 v[144:147], a[68:71], v[68:71], v[144:147]
  v_cvt_pk_bf16_f32 v116, v168, v169
  v_cvt_pk_bf16_f32 v117, v170, v171
  v_mfma_f32_16x16x32_bf16 v[144:147], a[72:75], v[72:75], v[144:147]
  ds_read_b64_tr_b16 a[106:107], v10 offset:43008
  v_mfma_f32_16x16x32_bf16 v[144:147], a[76:79], v[76:79], v[144:147]
  v_cvt_pk_bf16_f32 v118, v172, v173
  v_cvt_pk_bf16_f32 v119, v174, v175
  v_mfma_f32_16x16x32_bf16 v[152:155], a[64:67], v[80:83], 0
  ds_read_b64_tr_b16 a[108:109], v10 offset:45056
  v_mfma_f32_16x16x32_bf16 v[152:155], a[68:71], v[84:87], v[152:155]
  buffer_store_dwordx4 v[116:119], v2, s[40:43], s77 offen offset:3072 sc1
  v_mfma_f32_16x16x32_bf16 v[152:155], a[72:75], v[88:91], v[152:155]
  ds_read_b64_tr_b16 a[110:111], v10 offset:47104
  v_mfma_f32_16x16x32_bf16 v[152:155], a[76:79], v[92:95], v[152:155]
  s_waitcnt lgkmcnt(8)
  v_cvt_pk_bf16_f32 v120, v176, v177
  v_cvt_pk_bf16_f32 v121, v178, v179
  v_mfma_f32_16x16x32_bf16 v[132:135], a[80:83], v[32:35], 0
  ds_read_b64_tr_b16 a[112:113], v11 offset:32768
  v_mfma_f32_16x16x32_bf16 v[132:135], a[84:87], v[36:39], v[132:135]
  v_cvt_pk_bf16_f32 v122, v180, v181
  v_cvt_pk_bf16_f32 v123, v182, v183
  v_mfma_f32_16x16x32_bf16 v[132:135], a[88:91], v[40:43], v[132:135]
  ds_read_b64_tr_b16 a[114:115], v11 offset:34816
  v_mfma_f32_16x16x32_bf16 v[132:135], a[92:95], v[44:47], v[132:135]
  buffer_store_dwordx4 v[120:123], v2, s[40:43], s78 offen offset:3072 sc1
  v_mfma_f32_16x16x32_bf16 v[140:143], a[80:83], v[48:51], 0
  ds_read_b64_tr_b16 a[116:117], v11 offset:36864
  v_mfma_f32_16x16x32_bf16 v[140:143], a[84:87], v[52:55], v[140:143]
  v_cvt_pk_bf16_f32 v124, v184, v185
  v_cvt_pk_bf16_f32 v125, v186, v187
  v_mfma_f32_16x16x32_bf16 v[140:143], a[88:91], v[56:59], v[140:143]
  ds_read_b64_tr_b16 a[118:119], v11 offset:38912
  v_mfma_f32_16x16x32_bf16 v[140:143], a[92:95], v[60:63], v[140:143]
  v_cvt_pk_bf16_f32 v126, v188, v189
  v_cvt_pk_bf16_f32 v127, v190, v191
  v_mfma_f32_16x16x32_bf16 v[148:151], a[80:83], v[64:67], 0
  ds_read_b64_tr_b16 a[120:121], v11 offset:40960
  v_mfma_f32_16x16x32_bf16 v[148:151], a[84:87], v[68:71], v[148:151]
  buffer_store_dwordx4 v[124:127], v2, s[40:43], s79 offen offset:3072 sc1
  v_mfma_f32_16x16x32_bf16 v[148:151], a[88:91], v[72:75], v[148:151]
  ds_read_b64_tr_b16 a[122:123], v11 offset:43008
  v_mfma_f32_16x16x32_bf16 v[148:151], a[92:95], v[76:79], v[148:151]
  v_mfma_f32_16x16x32_bf16 v[156:159], a[80:83], v[80:83], 0
  ds_read_b64_tr_b16 a[124:125], v11 offset:45056
  v_mfma_f32_16x16x32_bf16 v[156:159], a[84:87], v[84:87], v[156:159]
  v_mfma_f32_16x16x32_bf16 v[156:159], a[88:91], v[88:91], v[156:159]
  ds_read_b64_tr_b16 a[126:127], v11 offset:47104
  v_mfma_f32_16x16x32_bf16 v[156:159], a[92:95], v[92:95], v[156:159]
  s_waitcnt lgkmcnt(8)
  v_mfma_f32_16x16x32_bf16 v[160:163], a[96:99], v[32:35], 0
  ds_read_b64_tr_b16 a[64:65], v8 offset:49152
  v_mfma_f32_16x16x32_bf16 v[160:163], a[100:103], v[36:39], v[160:163]
  s_add_u32 s76, s76, 0x1000
  s_add_u32 s77, s77, 0x1000
  s_add_u32 s78, s78, 0x1000
  s_add_u32 s79, s79, 0x1000
  v_mfma_f32_16x16x32_bf16 v[160:163], a[104:107], v[40:43], v[160:163]
  ds_read_b64_tr_b16 a[66:67], v8 offset:51200
  v_mfma_f32_16x16x32_bf16 v[160:163], a[108:111], v[44:47], v[160:163]
  v_cvt_pk_bf16_f32 v96, v128, v129
  v_cvt_pk_bf16_f32 v97, v130, v131
  v_mfma_f32_16x16x32_bf16 v[168:171], a[96:99], v[48:51], 0
  ds_read_b64_tr_b16 a[68:69], v8 offset:53248
  v_mfma_f32_16x16x32_bf16 v[168:171], a[100:103], v[52:55], v[168:171]
  v_cvt_pk_bf16_f32 v98, v132, v133
  v_cvt_pk_bf16_f32 v99, v134, v135
  v_mfma_f32_16x16x32_bf16 v[168:171], a[104:107], v[56:59], v[168:171]
  ds_read_b64_tr_b16 a[70:71], v8 offset:55296
  v_mfma_f32_16x16x32_bf16 v[168:171], a[108:111], v[60:63], v[168:171]
  buffer_store_dwordx4 v[96:99], v2, s[40:43], s76 offen offset:0 sc1
  v_mfma_f32_16x16x32_bf16 v[176:179], a[96:99], v[64:67], 0
  ds_read_b64_tr_b16 a[72:73], v8 offset:57344
  v_mfma_f32_16x16x32_bf16 v[176:179], a[100:103], v[68:71], v[176:179]
  v_cvt_pk_bf16_f32 v100, v136, v137
  v_cvt_pk_bf16_f32 v101, v138, v139
  v_mfma_f32_16x16x32_bf16 v[176:179], a[104:107], v[72:75], v[176:179]
  ds_read_b64_tr_b16 a[74:75], v8 offset:59392
  v_mfma_f32_16x16x32_bf16 v[176:179], a[108:111], v[76:79], v[176:179]
  v_cvt_pk_bf16_f32 v102, v140, v141
  v_cvt_pk_bf16_f32 v103, v142, v143
  v_mfma_f32_16x16x32_bf16 v[184:187], a[96:99], v[80:83], 0
  ds_read_b64_tr_b16 a[76:77], v8 offset:61440
  v_mfma_f32_16x16x32_bf16 v[184:187], a[100:103], v[84:87], v[184:187]
  buffer_store_dwordx4 v[100:103], v2, s[40:43], s77 offen offset:0 sc1
  v_mfma_f32_16x16x32_bf16 v[184:187], a[104:107], v[88:91], v[184:187]
  ds_read_b64_tr_b16 a[78:79], v8 offset:63488
  v_mfma_f32_16x16x32_bf16 v[184:187], a[108:111], v[92:95], v[184:187]
  s_waitcnt lgkmcnt(8)
  v_cvt_pk_bf16_f32 v104, v144, v145
  v_cvt_pk_bf16_f32 v105, v146, v147
  v_mfma_f32_16x16x32_bf16 v[164:167], a[112:115], v[32:35], 0
  ds_read_b64_tr_b16 a[80:81], v9 offset:49152
  v_mfma_f32_16x16x32_bf16 v[164:167], a[116:119], v[36:39], v[164:167]
  v_cvt_pk_bf16_f32 v106, v148, v149
  v_cvt_pk_bf16_f32 v107, v150, v151
  v_mfma_f32_16x16x32_bf16 v[164:167], a[120:123], v[40:43], v[164:167]
  ds_read_b64_tr_b16 a[82:83], v9 offset:51200
  v_mfma_f32_16x16x32_bf16 v[164:167], a[124:127], v[44:47], v[164:167]
  buffer_store_dwordx4 v[104:107], v2, s[40:43], s78 offen offset:0 sc1
  v_mfma_f32_16x16x32_bf16 v[172:175], a[112:115], v[48:51], 0
  ds_read_b64_tr_b16 a[84:85], v9 offset:53248
  v_mfma_f32_16x16x32_bf16 v[172:175], a[116:119], v[52:55], v[172:175]
  v_cvt_pk_bf16_f32 v108, v152, v153
  v_cvt_pk_bf16_f32 v109, v154, v155
  v_mfma_f32_16x16x32_bf16 v[172:175], a[120:123], v[56:59], v[172:175]
  ds_read_b64_tr_b16 a[86:87], v9 offset:55296
  v_mfma_f32_16x16x32_bf16 v[172:175], a[124:127], v[60:63], v[172:175]
  v_cvt_pk_bf16_f32 v110, v156, v157
  v_cvt_pk_bf16_f32 v111, v158, v159
  v_mfma_f32_16x16x32_bf16 v[180:183], a[112:115], v[64:67], 0
  ds_read_b64_tr_b16 a[88:89], v9 offset:57344
  v_mfma_f32_16x16x32_bf16 v[180:183], a[116:119], v[68:71], v[180:183]
  buffer_store_dwordx4 v[108:111], v2, s[40:43], s79 offen offset:0 sc1
  v_mfma_f32_16x16x32_bf16 v[180:183], a[120:123], v[72:75], v[180:183]
  ds_read_b64_tr_b16 a[90:91], v9 offset:59392
  v_mfma_f32_16x16x32_bf16 v[180:183], a[124:127], v[76:79], v[180:183]
  v_mfma_f32_16x16x32_bf16 v[188:191], a[112:115], v[80:83], 0
  ds_read_b64_tr_b16 a[92:93], v9 offset:61440
  v_mfma_f32_16x16x32_bf16 v[188:191], a[116:119], v[84:87], v[188:191]
  v_mfma_f32_16x16x32_bf16 v[188:191], a[120:123], v[88:91], v[188:191]
  ds_read_b64_tr_b16 a[94:95], v9 offset:63488
  v_mfma_f32_16x16x32_bf16 v[188:191], a[124:127], v[92:95], v[188:191]
  s_waitcnt lgkmcnt(8)
  v_mfma_f32_16x16x32_bf16 v[128:131], a[64:67], v[32:35], 0
  ds_read_b64_tr_b16 a[96:97], v10 offset:49152
  v_mfma_f32_16x16x32_bf16 v[128:131], a[68:71], v[36:39], v[128:131]
  s_nop 1
  v_mfma_f32_16x16x32_bf16 v[128:131], a[72:75], v[40:43], v[128:131]
  ds_read_b64_tr_b16 a[98:99], v10 offset:51200
  v_mfma_f32_16x16x32_bf16 v[128:131], a[76:79], v[44:47], v[128:131]
  v_cvt_pk_bf16_f32 v112, v160, v161
  v_cvt_pk_bf16_f32 v113, v162, v163
  v_mfma_f32_16x16x32_bf16 v[136:139], a[64:67], v[48:51], 0
  ds_read_b64_tr_b16 a[100:101], v10 offset:53248
  v_mfma_f32_16x16x32_bf16 v[136:139], a[68:71], v[52:55], v[136:139]
  v_cvt_pk_bf16_f32 v114, v164, v165
  v_cvt_pk_bf16_f32 v115, v166, v167
  v_mfma_f32_16x16x32_bf16 v[136:139], a[72:75], v[56:59], v[136:139]
  ds_read_b64_tr_b16 a[102:103], v10 offset:55296
  v_mfma_f32_16x16x32_bf16 v[136:139], a[76:79], v[60:63], v[136:139]
  buffer_store_dwordx4 v[112:115], v2, s[40:43], s76 offen offset:1024 sc1
  v_mfma_f32_16x16x32_bf16 v[144:147], a[64:67], v[64:67], 0
  ds_read_b64_tr_b16 a[104:105], v10 offset:57344
  v_mfma_f32_16x16x32_bf16 v[144:147], a[68:71], v[68:71], v[144:147]
  v_cvt_pk_bf16_f32 v116, v168, v169
  v_cvt_pk_bf16_f32 v117, v170, v171
  v_mfma_f32_16x16x32_bf16 v[144:147], a[72:75], v[72:75], v[144:147]
  ds_read_b64_tr_b16 a[106:107], v10 offset:59392
  v_mfma_f32_16x16x32_bf16 v[144:147], a[76:79], v[76:79], v[144:147]
  v_cvt_pk_bf16_f32 v118, v172, v173
  v_cvt_pk_bf16_f32 v119, v174, v175
  v_mfma_f32_16x16x32_bf16 v[152:155], a[64:67], v[80:83], 0
  ds_read_b64_tr_b16 a[108:109], v10 offset:61440
  v_mfma_f32_16x16x32_bf16 v[152:155], a[68:71], v[84:87], v[152:155]
  buffer_store_dwordx4 v[116:119], v2, s[40:43], s77 offen offset:1024 sc1
  v_mfma_f32_16x16x32_bf16 v[152:155], a[72:75], v[88:91], v[152:155]
  ds_read_b64_tr_b16 a[110:111], v10 offset:63488
  v_mfma_f32_16x16x32_bf16 v[152:155], a[76:79], v[92:95], v[152:155]
  s_waitcnt lgkmcnt(8)
  v_cvt_pk_bf16_f32 v120, v176, v177
  v_cvt_pk_bf16_f32 v121, v178, v179
  v_mfma_f32_16x16x32_bf16 v[132:135], a[80:83], v[32:35], 0
  ds_read_b64_tr_b16 a[112:113], v11 offset:49152
  v_mfma_f32_16x16x32_bf16 v[132:135], a[84:87], v[36:39], v[132:135]
  v_cvt_pk_bf16_f32 v122, v180, v181
  v_cvt_pk_bf16_f32 v123, v182, v183
  v_mfma_f32_16x16x32_bf16 v[132:135], a[88:91], v[40:43], v[132:135]
  ds_read_b64_tr_b16 a[114:115], v11 offset:51200
  v_mfma_f32_16x16x32_bf16 v[132:135], a[92:95], v[44:47], v[132:135]
  buffer_store_dwordx4 v[120:123], v2, s[40:43], s78 offen offset:1024 sc1
  v_mfma_f32_16x16x32_bf16 v[140:143], a[80:83], v[48:51], 0
  ds_read_b64_tr_b16 a[116:117], v11 offset:53248
  v_mfma_f32_16x16x32_bf16 v[140:143], a[84:87], v[52:55], v[140:143]
  v_cvt_pk_bf16_f32 v124, v184, v185
  v_cvt_pk_bf16_f32 v125, v186, v187
  v_mfma_f32_16x16x32_bf16 v[140:143], a[88:91], v[56:59], v[140:143]
  ds_read_b64_tr_b16 a[118:119], v11 offset:55296
  v_mfma_f32_16x16x32_bf16 v[140:143], a[92:95], v[60:63], v[140:143]
  v_cvt_pk_bf16_f32 v126, v188, v189
  v_cvt_pk_bf16_f32 v127, v190, v191
  v_mfma_f32_16x16x32_bf16 v[148:151], a[80:83], v[64:67], 0
  ds_read_b64_tr_b16 a[120:121], v11 offset:57344
  v_mfma_f32_16x16x32_bf16 v[148:151], a[84:87], v[68:71], v[148:151]
  buffer_store_dwordx4 v[124:127], v2, s[40:43], s79 offen offset:1024 sc1
  v_mfma_f32_16x16x32_bf16 v[148:151], a[88:91], v[72:75], v[148:151]
  ds_read_b64_tr_b16 a[122:123], v11 offset:59392
  v_mfma_f32_16x16x32_bf16 v[148:151], a[92:95], v[76:79], v[148:151]
  v_mfma_f32_16x16x32_bf16 v[156:159], a[80:83], v[80:83], 0
  ds_read_b64_tr_b16 a[124:125], v11 offset:61440
  v_mfma_f32_16x16x32_bf16 v[156:159], a[84:87], v[84:87], v[156:159]
  v_mfma_f32_16x16x32_bf16 v[156:159], a[88:91], v[88:91], v[156:159]
  ds_read_b64_tr_b16 a[126:127], v11 offset:63488
  v_mfma_f32_16x16x32_bf16 v[156:159], a[92:95], v[92:95], v[156:159]
  s_waitcnt lgkmcnt(8)
  v_mfma_f32_16x16x32_bf16 v[160:163], a[96:99], v[32:35], 0
  ds_read_b64_tr_b16 a[64:65], v12 offset:0
  v_mfma_f32_16x16x32_bf16 v[160:163], a[100:103], v[36:39], v[160:163]
  s_nop 1
  v_mfma_f32_16x16x32_bf16 v[160:163], a[104:107], v[40:43], v[160:163]
  ds_read_b64_tr_b16 a[66:67], v12 offset:2048
  v_mfma_f32_16x16x32_bf16 v[160:163], a[108:111], v[44:47], v[160:163]
  v_cvt_pk_bf16_f32 v96, v128, v129
  v_cvt_pk_bf16_f32 v97, v130, v131
  v_mfma_f32_16x16x32_bf16 v[168:171], a[96:99], v[48:51], 0
  ds_read_b64_tr_b16 a[68:69], v12 offset:4096
  v_mfma_f32_16x16x32_bf16 v[168:171], a[100:103], v[52:55], v[168:171]
  v_cvt_pk_bf16_f32 v98, v132, v133
  v_cvt_pk_bf16_f32 v99, v134, v135
  v_mfma_f32_16x16x32_bf16 v[168:171], a[104:107], v[56:59], v[168:171]
  ds_read_b64_tr_b16 a[70:71], v12 offset:6144
  v_mfma_f32_16x16x32_bf16 v[168:171], a[108:111], v[60:63], v[168:171]
  buffer_store_dwordx4 v[96:99], v2, s[40:43], s76 offen offset:2048 sc1
  v_mfma_f32_16x16x32_bf16 v[176:179], a[96:99], v[64:67], 0
  ds_read_b64_tr_b16 a[72:73], v12 offset:8192
  v_mfma_f32_16x16x32_bf16 v[176:179], a[100:103], v[68:71], v[176:179]
  v_cvt_pk_bf16_f32 v100, v136, v137
  v_cvt_pk_bf16_f32 v101, v138, v139
  v_mfma_f32_16x16x32_bf16 v[176:179], a[104:107], v[72:75], v[176:179]
  ds_read_b64_tr_b16 a[74:75], v12 offset:10240
  v_mfma_f32_16x16x32_bf16 v[176:179], a[108:111], v[76:79], v[176:179]
  v_cvt_pk_bf16_f32 v102, v140, v141
  v_cvt_pk_bf16_f32 v103, v142, v143
  v_mfma_f32_16x16x32_bf16 v[184:187], a[96:99], v[80:83], 0
  ds_read_b64_tr_b16 a[76:77], v12 offset:12288
  v_mfma_f32_16x16x32_bf16 v[184:187], a[100:103], v[84:87], v[184:187]
  buffer_store_dwordx4 v[100:103], v2, s[40:43], s77 offen offset:2048 sc1
  v_mfma_f32_16x16x32_bf16 v[184:187], a[104:107], v[88:91], v[184:187]
  ds_read_b64_tr_b16 a[78:79], v12 offset:14336
  v_mfma_f32_16x16x32_bf16 v[184:187], a[108:111], v[92:95], v[184:187]
  s_waitcnt lgkmcnt(8)
  v_cvt_pk_bf16_f32 v104, v144, v145
  v_cvt_pk_bf16_f32 v105, v146, v147
  v_mfma_f32_16x16x32_bf16 v[164:167], a[112:115], v[32:35], 0
  ds_read_b64_tr_b16 a[80:81], v13 offset:0
  v_mfma_f32_16x16x32_bf16 v[164:167], a[116:119], v[36:39], v[164:167]
  v_cvt_pk_bf16_f32 v106, v148, v149
  v_cvt_pk_bf16_f32 v107, v150, v151
  v_mfma_f32_16x16x32_bf16 v[164:167], a[120:123], v[40:43], v[164:167]
  ds_read_b64_tr_b16 a[82:83], v13 offset:2048
  v_mfma_f32_16x16x32_bf16 v[164:167], a[124:127], v[44:47], v[164:167]
  buffer_store_dwordx4 v[104:107], v2, s[40:43], s78 offen offset:2048 sc1
  v_mfma_f32_16x16x32_bf16 v[172:175], a[112:115], v[48:51], 0
  ds_read_b64_tr_b16 a[84:85], v13 offset:4096
  v_mfma_f32_16x16x32_bf16 v[172:175], a[116:119], v[52:55], v[172:175]
  v_cvt_pk_bf16_f32 v108, v152, v153
  v_cvt_pk_bf16_f32 v109, v154, v155
  v_mfma_f32_16x16x32_bf16 v[172:175], a[120:123], v[56:59], v[172:175]
  ds_read_b64_tr_b16 a[86:87], v13 offset:6144
  v_mfma_f32_16x16x32_bf16 v[172:175], a[124:127], v[60:63], v[172:175]
  v_cvt_pk_bf16_f32 v110, v156, v157
  v_cvt_pk_bf16_f32 v111, v158, v159
  v_mfma_f32_16x16x32_bf16 v[180:183], a[112:115], v[64:67], 0
  ds_read_b64_tr_b16 a[88:89], v13 offset:8192
  v_mfma_f32_16x16x32_bf16 v[180:183], a[116:119], v[68:71], v[180:183]
  buffer_store_dwordx4 v[108:111], v2, s[40:43], s79 offen offset:2048 sc1
  v_mfma_f32_16x16x32_bf16 v[180:183], a[120:123], v[72:75], v[180:183]
  ds_read_b64_tr_b16 a[90:91], v13 offset:10240
  v_mfma_f32_16x16x32_bf16 v[180:183], a[124:127], v[76:79], v[180:183]
  v_mfma_f32_16x16x32_bf16 v[188:191], a[112:115], v[80:83], 0
  ds_read_b64_tr_b16 a[92:93], v13 offset:12288
  v_mfma_f32_16x16x32_bf16 v[188:191], a[116:119], v[84:87], v[188:191]
  v_mfma_f32_16x16x32_bf16 v[188:191], a[120:123], v[88:91], v[188:191]
  ds_read_b64_tr_b16 a[94:95], v13 offset:14336
  v_mfma_f32_16x16x32_bf16 v[188:191], a[124:127], v[92:95], v[188:191]
  s_waitcnt lgkmcnt(8)
  v_mfma_f32_16x16x32_bf16 v[128:131], a[64:67], v[32:35], 0
  ds_read_b64_tr_b16 a[96:97], v14 offset:0
  v_mfma_f32_16x16x32_bf16 v[128:131], a[68:71], v[36:39], v[128:131]
  s_nop 1
  v_mfma_f32_16x16x32_bf16 v[128:131], a[72:75], v[40:43], v[128:131]
  ds_read_b64_tr_b16 a[98:99], v14 offset:2048
  v_mfma_f32_16x16x32_bf16 v[128:131], a[76:79], v[44:47], v[128:131]
  v_cvt_pk_bf16_f32 v112, v160, v161
  v_cvt_pk_bf16_f32 v113, v162, v163
  v_mfma_f32_16x16x32_bf16 v[136:139], a[64:67], v[48:51], 0
  ds_read_b64_tr_b16 a[100:101], v14 offset:4096
  v_mfma_f32_16x16x32_bf16 v[136:139], a[68:71], v[52:55], v[136:139]
  v_cvt_pk_bf16_f32 v114, v164, v165
  v_cvt_pk_bf16_f32 v115, v166, v167
  v_mfma_f32_16x16x32_bf16 v[136:139], a[72:75], v[56:59], v[136:139]
  ds_read_b64_tr_b16 a[102:103], v14 offset:6144
  v_mfma_f32_16x16x32_bf16 v[136:139], a[76:79], v[60:63], v[136:139]
  buffer_store_dwordx4 v[112:115], v2, s[40:43], s76 offen offset:3072 sc1
  v_mfma_f32_16x16x32_bf16 v[144:147], a[64:67], v[64:67], 0
  ds_read_b64_tr_b16 a[104:105], v14 offset:8192
  v_mfma_f32_16x16x32_bf16 v[144:147], a[68:71], v[68:71], v[144:147]
  v_cvt_pk_bf16_f32 v116, v168, v169
  v_cvt_pk_bf16_f32 v117, v170, v171
  v_mfma_f32_16x16x32_bf16 v[144:147], a[72:75], v[72:75], v[144:147]
  ds_read_b64_tr_b16 a[106:107], v14 offset:10240
  v_mfma_f32_16x16x32_bf16 v[144:147], a[76:79], v[76:79], v[144:147]
  v_cvt_pk_bf16_f32 v118, v172, v173
  v_cvt_pk_bf16_f32 v119, v174, v175
  v_mfma_f32_16x16x32_bf16 v[152:155], a[64:67], v[80:83], 0
  ds_read_b64_tr_b16 a[108:109], v14 offset:12288
  v_mfma_f32_16x16x32_bf16 v[152:155], a[68:71], v[84:87], v[152:155]
  buffer_store_dwordx4 v[116:119], v2, s[40:43], s77 offen offset:3072 sc1
  v_mfma_f32_16x16x32_bf16 v[152:155], a[72:75], v[88:91], v[152:155]
  ds_read_b64_tr_b16 a[110:111], v14 offset:14336
  v_mfma_f32_16x16x32_bf16 v[152:155], a[76:79], v[92:95], v[152:155]
  s_waitcnt lgkmcnt(8)
  v_cvt_pk_bf16_f32 v120, v176, v177
  v_cvt_pk_bf16_f32 v121, v178, v179
  v_mfma_f32_16x16x32_bf16 v[132:135], a[80:83], v[32:35], 0
  ds_read_b64_tr_b16 a[112:113], v15 offset:0
  v_mfma_f32_16x16x32_bf16 v[132:135], a[84:87], v[36:39], v[132:135]
  v_cvt_pk_bf16_f32 v122, v180, v181
  v_cvt_pk_bf16_f32 v123, v182, v183
  v_mfma_f32_16x16x32_bf16 v[132:135], a[88:91], v[40:43], v[132:135]
  ds_read_b64_tr_b16 a[114:115], v15 offset:2048
  v_mfma_f32_16x16x32_bf16 v[132:135], a[92:95], v[44:47], v[132:135]
  buffer_store_dwordx4 v[120:123], v2, s[40:43], s78 offen offset:3072 sc1
  v_mfma_f32_16x16x32_bf16 v[140:143], a[80:83], v[48:51], 0
  ds_read_b64_tr_b16 a[116:117], v15 offset:4096
  v_mfma_f32_16x16x32_bf16 v[140:143], a[84:87], v[52:55], v[140:143]
  v_cvt_pk_bf16_f32 v124, v184, v185
  v_cvt_pk_bf16_f32 v125, v186, v187
  v_mfma_f32_16x16x32_bf16 v[140:143], a[88:91], v[56:59], v[140:143]
  ds_read_b64_tr_b16 a[118:119], v15 offset:6144
  v_mfma_f32_16x16x32_bf16 v[140:143], a[92:95], v[60:63], v[140:143]
  v_cvt_pk_bf16_f32 v126, v188, v189
  v_cvt_pk_bf16_f32 v127, v190, v191
  v_mfma_f32_16x16x32_bf16 v[148:151], a[80:83], v[64:67], 0
  ds_read_b64_tr_b16 a[120:121], v15 offset:8192
  v_mfma_f32_16x16x32_bf16 v[148:151], a[84:87], v[68:71], v[148:151]
  buffer_store_dwordx4 v[124:127], v2, s[40:43], s79 offen offset:3072 sc1
  v_mfma_f32_16x16x32_bf16 v[148:151], a[88:91], v[72:75], v[148:151]
  ds_read_b64_tr_b16 a[122:123], v15 offset:10240
  v_mfma_f32_16x16x32_bf16 v[148:151], a[92:95], v[76:79], v[148:151]
  v_mfma_f32_16x16x32_bf16 v[156:159], a[80:83], v[80:83], 0
  ds_read_b64_tr_b16 a[124:125], v15 offset:12288
  v_mfma_f32_16x16x32_bf16 v[156:159], a[84:87], v[84:87], v[156:159]
  v_mfma_f32_16x16x32_bf16 v[156:159], a[88:91], v[88:91], v[156:159]
  ds_read_b64_tr_b16 a[126:127], v15 offset:14336
  v_mfma_f32_16x16x32_bf16 v[156:159], a[92:95], v[92:95], v[156:159]
  s_waitcnt lgkmcnt(8)
  v_mfma_f32_16x16x32_bf16 v[160:163], a[96:99], v[32:35], 0
  ds_read_b64_tr_b16 a[64:65], v12 offset:16384
  v_mfma_f32_16x16x32_bf16 v[160:163], a[100:103], v[36:39], v[160:163]
  s_add_u32 s76, s76, 0x1000
  s_add_u32 s77, s77, 0x1000
  s_add_u32 s78, s78, 0x1000
  s_add_u32 s79, s79, 0x1000
  v_mfma_f32_16x16x32_bf16 v[160:163], a[104:107], v[40:43], v[160:163]
  ds_read_b64_tr_b16 a[66:67], v12 offset:18432
  v_mfma_f32_16x16x32_bf16 v[160:163], a[108:111], v[44:47], v[160:163]
  v_cvt_pk_bf16_f32 v96, v128, v129
  v_cvt_pk_bf16_f32 v97, v130, v131
  v_mfma_f32_16x16x32_bf16 v[168:171], a[96:99], v[48:51], 0
  ds_read_b64_tr_b16 a[68:69], v12 offset:20480
  v_mfma_f32_16x16x32_bf16 v[168:171], a[100:103], v[52:55], v[168:171]
  v_cvt_pk_bf16_f32 v98, v132, v133
  v_cvt_pk_bf16_f32 v99, v134, v135
  v_mfma_f32_16x16x32_bf16 v[168:171], a[104:107], v[56:59], v[168:171]
  ds_read_b64_tr_b16 a[70:71], v12 offset:22528
  v_mfma_f32_16x16x32_bf16 v[168:171], a[108:111], v[60:63], v[168:171]
  buffer_store_dwordx4 v[96:99], v2, s[40:43], s76 offen offset:0 sc1
  v_mfma_f32_16x16x32_bf16 v[176:179], a[96:99], v[64:67], 0
  ds_read_b64_tr_b16 a[72:73], v12 offset:24576
  v_mfma_f32_16x16x32_bf16 v[176:179], a[100:103], v[68:71], v[176:179]
  v_cvt_pk_bf16_f32 v100, v136, v137
  v_cvt_pk_bf16_f32 v101, v138, v139
  v_mfma_f32_16x16x32_bf16 v[176:179], a[104:107], v[72:75], v[176:179]
  ds_read_b64_tr_b16 a[74:75], v12 offset:26624
  v_mfma_f32_16x16x32_bf16 v[176:179], a[108:111], v[76:79], v[176:179]
  v_cvt_pk_bf16_f32 v102, v140, v141
  v_cvt_pk_bf16_f32 v103, v142, v143
  v_mfma_f32_16x16x32_bf16 v[184:187], a[96:99], v[80:83], 0
  ds_read_b64_tr_b16 a[76:77], v12 offset:28672
  v_mfma_f32_16x16x32_bf16 v[184:187], a[100:103], v[84:87], v[184:187]
  buffer_store_dwordx4 v[100:103], v2, s[40:43], s77 offen offset:0 sc1
  v_mfma_f32_16x16x32_bf16 v[184:187], a[104:107], v[88:91], v[184:187]
  ds_read_b64_tr_b16 a[78:79], v12 offset:30720
  v_mfma_f32_16x16x32_bf16 v[184:187], a[108:111], v[92:95], v[184:187]
  s_waitcnt lgkmcnt(8)
  v_cvt_pk_bf16_f32 v104, v144, v145
  v_cvt_pk_bf16_f32 v105, v146, v147
  v_mfma_f32_16x16x32_bf16 v[164:167], a[112:115], v[32:35], 0
  ds_read_b64_tr_b16 a[80:81], v13 offset:16384
  v_mfma_f32_16x16x32_bf16 v[164:167], a[116:119], v[36:39], v[164:167]
  v_cvt_pk_bf16_f32 v106, v148, v149
  v_cvt_pk_bf16_f32 v107, v150, v151
  v_mfma_f32_16x16x32_bf16 v[164:167], a[120:123], v[40:43], v[164:167]
  ds_read_b64_tr_b16 a[82:83], v13 offset:18432
  v_mfma_f32_16x16x32_bf16 v[164:167], a[124:127], v[44:47], v[164:167]
  buffer_store_dwordx4 v[104:107], v2, s[40:43], s78 offen offset:0 sc1
  v_mfma_f32_16x16x32_bf16 v[172:175], a[112:115], v[48:51], 0
  ds_read_b64_tr_b16 a[84:85], v13 offset:20480
  v_mfma_f32_16x16x32_bf16 v[172:175], a[116:119], v[52:55], v[172:175]
  v_cvt_pk_bf16_f32 v108, v152, v153
  v_cvt_pk_bf16_f32 v109, v154, v155
  v_mfma_f32_16x16x32_bf16 v[172:175], a[120:123], v[56:59], v[172:175]
  ds_read_b64_tr_b16 a[86:87], v13 offset:22528
  v_mfma_f32_16x16x32_bf16 v[172:175], a[124:127], v[60:63], v[172:175]
  v_cvt_pk_bf16_f32 v110, v156, v157
  v_cvt_pk_bf16_f32 v111, v158, v159
  v_mfma_f32_16x16x32_bf16 v[180:183], a[112:115], v[64:67], 0
  ds_read_b64_tr_b16 a[88:89], v13 offset:24576
  v_mfma_f32_16x16x32_bf16 v[180:183], a[116:119], v[68:71], v[180:183]
  buffer_store_dwordx4 v[108:111], v2, s[40:43], s79 offen offset:0 sc1
  v_mfma_f32_16x16x32_bf16 v[180:183], a[120:123], v[72:75], v[180:183]
  ds_read_b64_tr_b16 a[90:91], v13 offset:26624
  v_mfma_f32_16x16x32_bf16 v[180:183], a[124:127], v[76:79], v[180:183]
  v_mfma_f32_16x16x32_bf16 v[188:191], a[112:115], v[80:83], 0
  ds_read_b64_tr_b16 a[92:93], v13 offset:28672
  v_mfma_f32_16x16x32_bf16 v[188:191], a[116:119], v[84:87], v[188:191]
  v_mfma_f32_16x16x32_bf16 v[188:191], a[120:123], v[88:91], v[188:191]
  ds_read_b64_tr_b16 a[94:95], v13 offset:30720
  v_mfma_f32_16x16x32_bf16 v[188:191], a[124:127], v[92:95], v[188:191]
  s_waitcnt lgkmcnt(8)
  v_mfma_f32_16x16x32_bf16 v[128:131], a[64:67], v[32:35], 0
  ds_read_b64_tr_b16 a[96:97], v14 offset:16384
  v_mfma_f32_16x16x32_bf16 v[128:131], a[68:71], v[36:39], v[128:131]
  s_nop 1
  v_mfma_f32_16x16x32_bf16 v[128:131], a[72:75], v[40:43], v[128:131]
  ds_read_b64_tr_b16 a[98:99], v14 offset:18432
  v_mfma_f32_16x16x32_bf16 v[128:131], a[76:79], v[44:47], v[128:131]
  v_cvt_pk_bf16_f32 v112, v160, v161
  v_cvt_pk_bf16_f32 v113, v162, v163
  v_mfma_f32_16x16x32_bf16 v[136:139], a[64:67], v[48:51], 0
  ds_read_b64_tr_b16 a[100:101], v14 offset:20480
  v_mfma_f32_16x16x32_bf16 v[136:139], a[68:71], v[52:55], v[136:139]
  v_cvt_pk_bf16_f32 v114, v164, v165
  v_cvt_pk_bf16_f32 v115, v166, v167
  v_mfma_f32_16x16x32_bf16 v[136:139], a[72:75], v[56:59], v[136:139]
  ds_read_b64_tr_b16 a[102:103], v14 offset:22528
  v_mfma_f32_16x16x32_bf16 v[136:139], a[76:79], v[60:63], v[136:139]
  buffer_store_dwordx4 v[112:115], v2, s[40:43], s76 offen offset:1024 sc1
  v_mfma_f32_16x16x32_bf16 v[144:147], a[64:67], v[64:67], 0
  ds_read_b64_tr_b16 a[104:105], v14 offset:24576
  v_mfma_f32_16x16x32_bf16 v[144:147], a[68:71], v[68:71], v[144:147]
  v_cvt_pk_bf16_f32 v116, v168, v169
  v_cvt_pk_bf16_f32 v117, v170, v171
  v_mfma_f32_16x16x32_bf16 v[144:147], a[72:75], v[72:75], v[144:147]
  ds_read_b64_tr_b16 a[106:107], v14 offset:26624
  v_mfma_f32_16x16x32_bf16 v[144:147], a[76:79], v[76:79], v[144:147]
  v_cvt_pk_bf16_f32 v118, v172, v173
  v_cvt_pk_bf16_f32 v119, v174, v175
  v_mfma_f32_16x16x32_bf16 v[152:155], a[64:67], v[80:83], 0
  ds_read_b64_tr_b16 a[108:109], v14 offset:28672
  v_mfma_f32_16x16x32_bf16 v[152:155], a[68:71], v[84:87], v[152:155]
  buffer_store_dwordx4 v[116:119], v2, s[40:43], s77 offen offset:1024 sc1
  v_mfma_f32_16x16x32_bf16 v[152:155], a[72:75], v[88:91], v[152:155]
  ds_read_b64_tr_b16 a[110:111], v14 offset:30720
  v_mfma_f32_16x16x32_bf16 v[152:155], a[76:79], v[92:95], v[152:155]
  s_waitcnt lgkmcnt(8)
  v_cvt_pk_bf16_f32 v120, v176, v177
  v_cvt_pk_bf16_f32 v121, v178, v179
  v_mfma_f32_16x16x32_bf16 v[132:135], a[80:83], v[32:35], 0
  ds_read_b64_tr_b16 a[112:113], v15 offset:16384
  v_mfma_f32_16x16x32_bf16 v[132:135], a[84:87], v[36:39], v[132:135]
  v_cvt_pk_bf16_f32 v122, v180, v181
  v_cvt_pk_bf16_f32 v123, v182, v183
  v_mfma_f32_16x16x32_bf16 v[132:135], a[88:91], v[40:43], v[132:135]
  ds_read_b64_tr_b16 a[114:115], v15 offset:18432
  v_mfma_f32_16x16x32_bf16 v[132:135], a[92:95], v[44:47], v[132:135]
  buffer_store_dwordx4 v[120:123], v2, s[40:43], s78 offen offset:1024 sc1
  v_mfma_f32_16x16x32_bf16 v[140:143], a[80:83], v[48:51], 0
  ds_read_b64_tr_b16 a[116:117], v15 offset:20480
  v_mfma_f32_16x16x32_bf16 v[140:143], a[84:87], v[52:55], v[140:143]
  v_cvt_pk_bf16_f32 v124, v184, v185
  v_cvt_pk_bf16_f32 v125, v186, v187
  v_mfma_f32_16x16x32_bf16 v[140:143], a[88:91], v[56:59], v[140:143]
  ds_read_b64_tr_b16 a[118:119], v15 offset:22528
  v_mfma_f32_16x16x32_bf16 v[140:143], a[92:95], v[60:63], v[140:143]
  v_cvt_pk_bf16_f32 v126, v188, v189
  v_cvt_pk_bf16_f32 v127, v190, v191
  v_mfma_f32_16x16x32_bf16 v[148:151], a[80:83], v[64:67], 0
  ds_read_b64_tr_b16 a[120:121], v15 offset:24576
  v_mfma_f32_16x16x32_bf16 v[148:151], a[84:87], v[68:71], v[148:151]
  buffer_store_dwordx4 v[124:127], v2, s[40:43], s79 offen offset:1024 sc1
  v_mfma_f32_16x16x32_bf16 v[148:151], a[88:91], v[72:75], v[148:151]
  ds_read_b64_tr_b16 a[122:123], v15 offset:26624
  v_mfma_f32_16x16x32_bf16 v[148:151], a[92:95], v[76:79], v[148:151]
  v_mfma_f32_16x16x32_bf16 v[156:159], a[80:83], v[80:83], 0
  ds_read_b64_tr_b16 a[124:125], v15 offset:28672
  v_mfma_f32_16x16x32_bf16 v[156:159], a[84:87], v[84:87], v[156:159]
  v_mfma_f32_16x16x32_bf16 v[156:159], a[88:91], v[88:91], v[156:159]
  ds_read_b64_tr_b16 a[126:127], v15 offset:30720
  v_mfma_f32_16x16x32_bf16 v[156:159], a[92:95], v[92:95], v[156:159]
  s_waitcnt lgkmcnt(8)
  v_mfma_f32_16x16x32_bf16 v[160:163], a[96:99], v[32:35], 0
  ds_read_b64_tr_b16 a[64:65], v12 offset:32768
  v_mfma_f32_16x16x32_bf16 v[160:163], a[100:103], v[36:39], v[160:163]
  s_nop 1
  v_mfma_f32_16x16x32_bf16 v[160:163], a[104:107], v[40:43], v[160:163]
  ds_read_b64_tr_b16 a[66:67], v12 offset:34816
  v_mfma_f32_16x16x32_bf16 v[160:163], a[108:111], v[44:47], v[160:163]
  v_cvt_pk_bf16_f32 v96, v128, v129
  v_cvt_pk_bf16_f32 v97, v130, v131
  v_mfma_f32_16x16x32_bf16 v[168:171], a[96:99], v[48:51], 0
  ds_read_b64_tr_b16 a[68:69], v12 offset:36864
  v_mfma_f32_16x16x32_bf16 v[168:171], a[100:103], v[52:55], v[168:171]
  v_cvt_pk_bf16_f32 v98, v132, v133
  v_cvt_pk_bf16_f32 v99, v134, v135
  v_mfma_f32_16x16x32_bf16 v[168:171], a[104:107], v[56:59], v[168:171]
  ds_read_b64_tr_b16 a[70:71], v12 offset:38912
  v_mfma_f32_16x16x32_bf16 v[168:171], a[108:111], v[60:63], v[168:171]
  buffer_store_dwordx4 v[96:99], v2, s[40:43], s76 offen offset:2048 sc1
  v_mfma_f32_16x16x32_bf16 v[176:179], a[96:99], v[64:67], 0
  ds_read_b64_tr_b16 a[72:73], v12 offset:40960
  v_mfma_f32_16x16x32_bf16 v[176:179], a[100:103], v[68:71], v[176:179]
  v_cvt_pk_bf16_f32 v100, v136, v137
  v_cvt_pk_bf16_f32 v101, v138, v139
  v_mfma_f32_16x16x32_bf16 v[176:179], a[104:107], v[72:75], v[176:179]
  ds_read_b64_tr_b16 a[74:75], v12 offset:43008
  v_mfma_f32_16x16x32_bf16 v[176:179], a[108:111], v[76:79], v[176:179]
  v_cvt_pk_bf16_f32 v102, v140, v141
  v_cvt_pk_bf16_f32 v103, v142, v143
  v_mfma_f32_16x16x32_bf16 v[184:187], a[96:99], v[80:83], 0
  ds_read_b64_tr_b16 a[76:77], v12 offset:45056
  v_mfma_f32_16x16x32_bf16 v[184:187], a[100:103], v[84:87], v[184:187]
  buffer_store_dwordx4 v[100:103], v2, s[40:43], s77 offen offset:2048 sc1
  v_mfma_f32_16x16x32_bf16 v[184:187], a[104:107], v[88:91], v[184:187]
  ds_read_b64_tr_b16 a[78:79], v12 offset:47104
  v_mfma_f32_16x16x32_bf16 v[184:187], a[108:111], v[92:95], v[184:187]
  s_waitcnt lgkmcnt(8)
  v_cvt_pk_bf16_f32 v104, v144, v145
  v_cvt_pk_bf16_f32 v105, v146, v147
  v_mfma_f32_16x16x32_bf16 v[164:167], a[112:115], v[32:35], 0
  ds_read_b64_tr_b16 a[80:81], v13 offset:32768
  v_mfma_f32_16x16x32_bf16 v[164:167], a[116:119], v[36:39], v[164:167]
  v_cvt_pk_bf16_f32 v106, v148, v149
  v_cvt_pk_bf16_f32 v107, v150, v151
  v_mfma_f32_16x16x32_bf16 v[164:167], a[120:123], v[40:43], v[164:167]
  ds_read_b64_tr_b16 a[82:83], v13 offset:34816
  v_mfma_f32_16x16x32_bf16 v[164:167], a[124:127], v[44:47], v[164:167]
  buffer_store_dwordx4 v[104:107], v2, s[40:43], s78 offen offset:2048 sc1
  v_mfma_f32_16x16x32_bf16 v[172:175], a[112:115], v[48:51], 0
  ds_read_b64_tr_b16 a[84:85], v13 offset:36864
  v_mfma_f32_16x16x32_bf16 v[172:175], a[116:119], v[52:55], v[172:175]
  v_cvt_pk_bf16_f32 v108, v152, v153
  v_cvt_pk_bf16_f32 v109, v154, v155
  v_mfma_f32_16x16x32_bf16 v[172:175], a[120:123], v[56:59], v[172:175]
  ds_read_b64_tr_b16 a[86:87], v13 offset:38912
  v_mfma_f32_16x16x32_bf16 v[172:175], a[124:127], v[60:63], v[172:175]
  v_cvt_pk_bf16_f32 v110, v156, v157
  v_cvt_pk_bf16_f32 v111, v158, v159
  v_mfma_f32_16x16x32_bf16 v[180:183], a[112:115], v[64:67], 0
  ds_read_b64_tr_b16 a[88:89], v13 offset:40960
  v_mfma_f32_16x16x32_bf16 v[180:183], a[116:119], v[68:71], v[180:183]
  buffer_store_dwordx4 v[108:111], v2, s[40:43], s79 offen offset:2048 sc1
  v_mfma_f32_16x16x32_bf16 v[180:183], a[120:123], v[72:75], v[180:183]
  ds_read_b64_tr_b16 a[90:91], v13 offset:43008
  v_mfma_f32_16x16x32_bf16 v[180:183], a[124:127], v[76:79], v[180:183]
  v_mfma_f32_16x16x32_bf16 v[188:191], a[112:115], v[80:83], 0
  ds_read_b64_tr_b16 a[92:93], v13 offset:45056
  v_mfma_f32_16x16x32_bf16 v[188:191], a[116:119], v[84:87], v[188:191]
  v_mfma_f32_16x16x32_bf16 v[188:191], a[120:123], v[88:91], v[188:191]
  ds_read_b64_tr_b16 a[94:95], v13 offset:47104
  v_mfma_f32_16x16x32_bf16 v[188:191], a[124:127], v[92:95], v[188:191]
  s_waitcnt lgkmcnt(8)
  v_mfma_f32_16x16x32_bf16 v[128:131], a[64:67], v[32:35], 0
  ds_read_b64_tr_b16 a[96:97], v14 offset:32768
  v_mfma_f32_16x16x32_bf16 v[128:131], a[68:71], v[36:39], v[128:131]
  s_nop 1
  v_mfma_f32_16x16x32_bf16 v[128:131], a[72:75], v[40:43], v[128:131]
  ds_read_b64_tr_b16 a[98:99], v14 offset:34816
  v_mfma_f32_16x16x32_bf16 v[128:131], a[76:79], v[44:47], v[128:131]
  v_cvt_pk_bf16_f32 v112, v160, v161
  v_cvt_pk_bf16_f32 v113, v162, v163
  v_mfma_f32_16x16x32_bf16 v[136:139], a[64:67], v[48:51], 0
  ds_read_b64_tr_b16 a[100:101], v14 offset:36864
  v_mfma_f32_16x16x32_bf16 v[136:139], a[68:71], v[52:55], v[136:139]
  v_cvt_pk_bf16_f32 v114, v164, v165
  v_cvt_pk_bf16_f32 v115, v166, v167
  v_mfma_f32_16x16x32_bf16 v[136:139], a[72:75], v[56:59], v[136:139]
  ds_read_b64_tr_b16 a[102:103], v14 offset:38912
  v_mfma_f32_16x16x32_bf16 v[136:139], a[76:79], v[60:63], v[136:139]
  buffer_store_dwordx4 v[112:115], v2, s[40:43], s76 offen offset:3072 sc1
  v_mfma_f32_16x16x32_bf16 v[144:147], a[64:67], v[64:67], 0
  ds_read_b64_tr_b16 a[104:105], v14 offset:40960
  v_mfma_f32_16x16x32_bf16 v[144:147], a[68:71], v[68:71], v[144:147]
  v_cvt_pk_bf16_f32 v116, v168, v169
  v_cvt_pk_bf16_f32 v117, v170, v171
  v_mfma_f32_16x16x32_bf16 v[144:147], a[72:75], v[72:75], v[144:147]
  ds_read_b64_tr_b16 a[106:107], v14 offset:43008
  v_mfma_f32_16x16x32_bf16 v[144:147], a[76:79], v[76:79], v[144:147]
  v_cvt_pk_bf16_f32 v118, v172, v173
  v_cvt_pk_bf16_f32 v119, v174, v175
  v_mfma_f32_16x16x32_bf16 v[152:155], a[64:67], v[80:83], 0
  ds_read_b64_tr_b16 a[108:109], v14 offset:45056
  v_mfma_f32_16x16x32_bf16 v[152:155], a[68:71], v[84:87], v[152:155]
  buffer_store_dwordx4 v[116:119], v2, s[40:43], s77 offen offset:3072 sc1
  v_mfma_f32_16x16x32_bf16 v[152:155], a[72:75], v[88:91], v[152:155]
  ds_read_b64_tr_b16 a[110:111], v14 offset:47104
  v_mfma_f32_16x16x32_bf16 v[152:155], a[76:79], v[92:95], v[152:155]
  s_waitcnt lgkmcnt(8)
  v_cvt_pk_bf16_f32 v120, v176, v177
  v_cvt_pk_bf16_f32 v121, v178, v179
  v_mfma_f32_16x16x32_bf16 v[132:135], a[80:83], v[32:35], 0
  ds_read_b64_tr_b16 a[112:113], v15 offset:32768
  v_mfma_f32_16x16x32_bf16 v[132:135], a[84:87], v[36:39], v[132:135]
  v_cvt_pk_bf16_f32 v122, v180, v181
  v_cvt_pk_bf16_f32 v123, v182, v183
  v_mfma_f32_16x16x32_bf16 v[132:135], a[88:91], v[40:43], v[132:135]
  ds_read_b64_tr_b16 a[114:115], v15 offset:34816
  v_mfma_f32_16x16x32_bf16 v[132:135], a[92:95], v[44:47], v[132:135]
  buffer_store_dwordx4 v[120:123], v2, s[40:43], s78 offen offset:3072 sc1
  v_mfma_f32_16x16x32_bf16 v[140:143], a[80:83], v[48:51], 0
  ds_read_b64_tr_b16 a[116:117], v15 offset:36864
  v_mfma_f32_16x16x32_bf16 v[140:143], a[84:87], v[52:55], v[140:143]
  v_cvt_pk_bf16_f32 v124, v184, v185
  v_cvt_pk_bf16_f32 v125, v186, v187
  v_mfma_f32_16x16x32_bf16 v[140:143], a[88:91], v[56:59], v[140:143]
  ds_read_b64_tr_b16 a[118:119], v15 offset:38912
  v_mfma_f32_16x16x32_bf16 v[140:143], a[92:95], v[60:63], v[140:143]
  v_cvt_pk_bf16_f32 v126, v188, v189
  v_cvt_pk_bf16_f32 v127, v190, v191
  v_mfma_f32_16x16x32_bf16 v[148:151], a[80:83], v[64:67], 0
  ds_read_b64_tr_b16 a[120:121], v15 offset:40960
  v_mfma_f32_16x16x32_bf16 v[148:151], a[84:87], v[68:71], v[148:151]
  buffer_store_dwordx4 v[124:127], v2, s[40:43], s79 offen offset:3072 sc1
  v_mfma_f32_16x16x32_bf16 v[148:151], a[88:91], v[72:75], v[148:151]
  ds_read_b64_tr_b16 a[122:123], v15 offset:43008
  v_mfma_f32_16x16x32_bf16 v[148:151], a[92:95], v[76:79], v[148:151]
  v_mfma_f32_16x16x32_bf16 v[156:159], a[80:83], v[80:83], 0
  ds_read_b64_tr_b16 a[124:125], v15 offset:45056
  v_mfma_f32_16x16x32_bf16 v[156:159], a[84:87], v[84:87], v[156:159]
  v_mfma_f32_16x16x32_bf16 v[156:159], a[88:91], v[88:91], v[156:159]
  s_waitcnt vmcnt(32)
  s_barrier
  ds_read_b64_tr_b16 a[126:127], v15 offset:47104
  v_mfma_f32_16x16x32_bf16 v[156:159], a[92:95], v[92:95], v[156:159]
  s_waitcnt lgkmcnt(8)
  v_mfma_f32_16x16x32_bf16 v[160:163], a[96:99], v[32:35], 0
  ds_read_b64_tr_b16 a[64:65], v12 offset:49152
  v_mfma_f32_16x16x32_bf16 v[160:163], a[100:103], v[36:39], v[160:163]
  s_add_u32 s76, s76, 0x1000
  s_add_u32 s77, s77, 0x1000
  s_add_u32 s78, s78, 0x1000
  s_add_u32 s79, s79, 0x1000
  v_mfma_f32_16x16x32_bf16 v[160:163], a[104:107], v[40:43], v[160:163]
  ds_read_b64_tr_b16 a[66:67], v12 offset:51200
  v_mfma_f32_16x16x32_bf16 v[160:163], a[108:111], v[44:47], v[160:163]
  v_cvt_pk_bf16_f32 v96, v128, v129
  v_cvt_pk_bf16_f32 v97, v130, v131
  v_mfma_f32_16x16x32_bf16 v[168:171], a[96:99], v[48:51], 0
  ds_read_b64_tr_b16 a[68:69], v12 offset:53248
  v_mfma_f32_16x16x32_bf16 v[168:171], a[100:103], v[52:55], v[168:171]
  v_cvt_pk_bf16_f32 v98, v132, v133
  v_cvt_pk_bf16_f32 v99, v134, v135
  v_mfma_f32_16x16x32_bf16 v[168:171], a[104:107], v[56:59], v[168:171]
  ds_read_b64_tr_b16 a[70:71], v12 offset:55296
  v_mfma_f32_16x16x32_bf16 v[168:171], a[108:111], v[60:63], v[168:171]
  buffer_store_dwordx4 v[96:99], v2, s[40:43], s76 offen offset:0 sc1
  v_mfma_f32_16x16x32_bf16 v[176:179], a[96:99], v[64:67], 0
  ds_read_b64_tr_b16 a[72:73], v12 offset:57344
  v_mfma_f32_16x16x32_bf16 v[176:179], a[100:103], v[68:71], v[176:179]
  v_cvt_pk_bf16_f32 v100, v136, v137
  v_cvt_pk_bf16_f32 v101, v138, v139
  v_mfma_f32_16x16x32_bf16 v[176:179], a[104:107], v[72:75], v[176:179]
  ds_read_b64_tr_b16 a[74:75], v12 offset:59392
  v_mfma_f32_16x16x32_bf16 v[176:179], a[108:111], v[76:79], v[176:179]
  v_cvt_pk_bf16_f32 v102, v140, v141
  v_cvt_pk_bf16_f32 v103, v142, v143
  v_mfma_f32_16x16x32_bf16 v[184:187], a[96:99], v[80:83], 0
  ds_read_b64_tr_b16 a[76:77], v12 offset:61440
  v_mfma_f32_16x16x32_bf16 v[184:187], a[100:103], v[84:87], v[184:187]
  buffer_store_dwordx4 v[100:103], v2, s[40:43], s77 offen offset:0 sc1
  v_mfma_f32_16x16x32_bf16 v[184:187], a[104:107], v[88:91], v[184:187]
  ds_read_b64_tr_b16 a[78:79], v12 offset:63488
  v_mfma_f32_16x16x32_bf16 v[184:187], a[108:111], v[92:95], v[184:187]
  s_waitcnt lgkmcnt(8)
  v_cvt_pk_bf16_f32 v104, v144, v145
  v_cvt_pk_bf16_f32 v105, v146, v147
  v_mfma_f32_16x16x32_bf16 v[164:167], a[112:115], v[32:35], 0
  ds_read_b64_tr_b16 a[80:81], v13 offset:49152
  v_mfma_f32_16x16x32_bf16 v[164:167], a[116:119], v[36:39], v[164:167]
  v_cvt_pk_bf16_f32 v106, v148, v149
  v_cvt_pk_bf16_f32 v107, v150, v151
  v_mfma_f32_16x16x32_bf16 v[164:167], a[120:123], v[40:43], v[164:167]
  ds_read_b64_tr_b16 a[82:83], v13 offset:51200
  v_mfma_f32_16x16x32_bf16 v[164:167], a[124:127], v[44:47], v[164:167]
  buffer_store_dwordx4 v[104:107], v2, s[40:43], s78 offen offset:0 sc1
  v_mfma_f32_16x16x32_bf16 v[172:175], a[112:115], v[48:51], 0
  ds_read_b64_tr_b16 a[84:85], v13 offset:53248
  v_mfma_f32_16x16x32_bf16 v[172:175], a[116:119], v[52:55], v[172:175]
  v_cvt_pk_bf16_f32 v108, v152, v153
  v_cvt_pk_bf16_f32 v109, v154, v155
  v_mfma_f32_16x16x32_bf16 v[172:175], a[120:123], v[56:59], v[172:175]
  ds_read_b64_tr_b16 a[86:87], v13 offset:55296
  v_mfma_f32_16x16x32_bf16 v[172:175], a[124:127], v[60:63], v[172:175]
  v_cvt_pk_bf16_f32 v110, v156, v157
  v_cvt_pk_bf16_f32 v111, v158, v159
  v_mfma_f32_16x16x32_bf16 v[180:183], a[112:115], v[64:67], 0
  ds_read_b64_tr_b16 a[88:89], v13 offset:57344
  v_mfma_f32_16x16x32_bf16 v[180:183], a[116:119], v[68:71], v[180:183]
  buffer_store_dwordx4 v[108:111], v2, s[40:43], s79 offen offset:0 sc1
  v_mfma_f32_16x16x32_bf16 v[180:183], a[120:123], v[72:75], v[180:183]
  ds_read_b64_tr_b16 a[90:91], v13 offset:59392
  v_mfma_f32_16x16x32_bf16 v[180:183], a[124:127], v[76:79], v[180:183]
  v_mfma_f32_16x16x32_bf16 v[188:191], a[112:115], v[80:83], 0
  ds_read_b64_tr_b16 a[92:93], v13 offset:61440
  v_mfma_f32_16x16x32_bf16 v[188:191], a[116:119], v[84:87], v[188:191]
  v_mfma_f32_16x16x32_bf16 v[188:191], a[120:123], v[88:91], v[188:191]
  ds_read_b64_tr_b16 a[94:95], v13 offset:63488
  v_mfma_f32_16x16x32_bf16 v[188:191], a[124:127], v[92:95], v[188:191]
  s_waitcnt lgkmcnt(8)
  v_mfma_f32_16x16x32_bf16 v[128:131], a[64:67], v[32:35], 0
  ds_read_b64_tr_b16 a[96:97], v14 offset:49152
  v_mfma_f32_16x16x32_bf16 v[128:131], a[68:71], v[36:39], v[128:131]
  s_nop 1
  v_mfma_f32_16x16x32_bf16 v[128:131], a[72:75], v[40:43], v[128:131]
  ds_read_b64_tr_b16 a[98:99], v14 offset:51200
  v_mfma_f32_16x16x32_bf16 v[128:131], a[76:79], v[44:47], v[128:131]
  v_cvt_pk_bf16_f32 v112, v160, v161
  v_cvt_pk_bf16_f32 v113, v162, v163
  v_mfma_f32_16x16x32_bf16 v[136:139], a[64:67], v[48:51], 0
  ds_read_b64_tr_b16 a[100:101], v14 offset:53248
  v_mfma_f32_16x16x32_bf16 v[136:139], a[68:71], v[52:55], v[136:139]
  v_cvt_pk_bf16_f32 v114, v164, v165
  v_cvt_pk_bf16_f32 v115, v166, v167
  v_mfma_f32_16x16x32_bf16 v[136:139], a[72:75], v[56:59], v[136:139]
  ds_read_b64_tr_b16 a[102:103], v14 offset:55296
  v_mfma_f32_16x16x32_bf16 v[136:139], a[76:79], v[60:63], v[136:139]
  buffer_store_dwordx4 v[112:115], v2, s[40:43], s76 offen offset:1024 sc1
  v_mfma_f32_16x16x32_bf16 v[144:147], a[64:67], v[64:67], 0
  ds_read_b64_tr_b16 a[104:105], v14 offset:57344
  v_mfma_f32_16x16x32_bf16 v[144:147], a[68:71], v[68:71], v[144:147]
  v_cvt_pk_bf16_f32 v116, v168, v169
  v_cvt_pk_bf16_f32 v117, v170, v171
  v_mfma_f32_16x16x32_bf16 v[144:147], a[72:75], v[72:75], v[144:147]
  ds_read_b64_tr_b16 a[106:107], v14 offset:59392
  v_mfma_f32_16x16x32_bf16 v[144:147], a[76:79], v[76:79], v[144:147]
  v_cvt_pk_bf16_f32 v118, v172, v173
  v_cvt_pk_bf16_f32 v119, v174, v175
  v_mfma_f32_16x16x32_bf16 v[152:155], a[64:67], v[80:83], 0
  ds_read_b64_tr_b16 a[108:109], v14 offset:61440
  v_mfma_f32_16x16x32_bf16 v[152:155], a[68:71], v[84:87], v[152:155]
  buffer_store_dwordx4 v[116:119], v2, s[40:43], s77 offen offset:1024 sc1
  v_mfma_f32_16x16x32_bf16 v[152:155], a[72:75], v[88:91], v[152:155]
  ds_read_b64_tr_b16 a[110:111], v14 offset:63488
  v_mfma_f32_16x16x32_bf16 v[152:155], a[76:79], v[92:95], v[152:155]
  s_waitcnt lgkmcnt(8)
  v_cvt_pk_bf16_f32 v120, v176, v177
  v_cvt_pk_bf16_f32 v121, v178, v179
  v_mfma_f32_16x16x32_bf16 v[132:135], a[80:83], v[32:35], 0
  ds_read_b64_tr_b16 a[112:113], v15 offset:49152
  v_mfma_f32_16x16x32_bf16 v[132:135], a[84:87], v[36:39], v[132:135]
  v_cvt_pk_bf16_f32 v122, v180, v181
  v_cvt_pk_bf16_f32 v123, v182, v183
  v_mfma_f32_16x16x32_bf16 v[132:135], a[88:91], v[40:43], v[132:135]
  ds_read_b64_tr_b16 a[114:115], v15 offset:51200
  v_mfma_f32_16x16x32_bf16 v[132:135], a[92:95], v[44:47], v[132:135]
  buffer_store_dwordx4 v[120:123], v2, s[40:43], s78 offen offset:1024 sc1
  v_mfma_f32_16x16x32_bf16 v[140:143], a[80:83], v[48:51], 0
  ds_read_b64_tr_b16 a[116:117], v15 offset:53248
  v_mfma_f32_16x16x32_bf16 v[140:143], a[84:87], v[52:55], v[140:143]
  v_cvt_pk_bf16_f32 v124, v184, v185
  v_cvt_pk_bf16_f32 v125, v186, v187
  v_mfma_f32_16x16x32_bf16 v[140:143], a[88:91], v[56:59], v[140:143]
  ds_read_b64_tr_b16 a[118:119], v15 offset:55296
  v_mfma_f32_16x16x32_bf16 v[140:143], a[92:95], v[60:63], v[140:143]
  v_cvt_pk_bf16_f32 v126, v188, v189
  v_cvt_pk_bf16_f32 v127, v190, v191
  v_mfma_f32_16x16x32_bf16 v[148:151], a[80:83], v[64:67], 0
  ds_read_b64_tr_b16 a[120:121], v15 offset:57344
  v_mfma_f32_16x16x32_bf16 v[148:151], a[84:87], v[68:71], v[148:151]
  buffer_store_dwordx4 v[124:127], v2, s[40:43], s79 offen offset:1024 sc1
  v_mfma_f32_16x16x32_bf16 v[148:151], a[88:91], v[72:75], v[148:151]
  ds_read_b64_tr_b16 a[122:123], v15 offset:59392
  v_mfma_f32_16x16x32_bf16 v[148:151], a[92:95], v[76:79], v[148:151]
  v_mfma_f32_16x16x32_bf16 v[156:159], a[80:83], v[80:83], 0
  ds_read_b64_tr_b16 a[124:125], v15 offset:61440
  v_mfma_f32_16x16x32_bf16 v[156:159], a[84:87], v[84:87], v[156:159]
  v_mfma_f32_16x16x32_bf16 v[156:159], a[88:91], v[88:91], v[156:159]
  ds_read_b64_tr_b16 a[126:127], v15 offset:63488
  v_mfma_f32_16x16x32_bf16 v[156:159], a[92:95], v[92:95], v[156:159]
  s_waitcnt lgkmcnt(8)
  v_mfma_f32_16x16x32_bf16 v[160:163], a[96:99], v[32:35], 0
  v_mfma_f32_16x16x32_bf16 v[160:163], a[100:103], v[36:39], v[160:163]
  s_nop 1
  v_mfma_f32_16x16x32_bf16 v[160:163], a[104:107], v[40:43], v[160:163]
  v_mfma_f32_16x16x32_bf16 v[160:163], a[108:111], v[44:47], v[160:163]
  v_cvt_pk_bf16_f32 v96, v128, v129
  v_cvt_pk_bf16_f32 v97, v130, v131
  v_mfma_f32_16x16x32_bf16 v[168:171], a[96:99], v[48:51], 0
  v_mfma_f32_16x16x32_bf16 v[168:171], a[100:103], v[52:55], v[168:171]
  v_cvt_pk_bf16_f32 v98, v132, v133
  v_cvt_pk_bf16_f32 v99, v134, v135
  v_mfma_f32_16x16x32_bf16 v[168:171], a[104:107], v[56:59], v[168:171]
  v_mfma_f32_16x16x32_bf16 v[168:171], a[108:111], v[60:63], v[168:171]
  buffer_store_dwordx4 v[96:99], v2, s[40:43], s76 offen offset:2048 sc1
  v_mfma_f32_16x16x32_bf16 v[176:179], a[96:99], v[64:67], 0
  v_mfma_f32_16x16x32_bf16 v[176:179], a[100:103], v[68:71], v[176:179]
  v_cvt_pk_bf16_f32 v100, v136, v137
  v_cvt_pk_bf16_f32 v101, v138, v139
  v_mfma_f32_16x16x32_bf16 v[176:179], a[104:107], v[72:75], v[176:179]
  v_mfma_f32_16x16x32_bf16 v[176:179], a[108:111], v[76:79], v[176:179]
  v_cvt_pk_bf16_f32 v102, v140, v141
  v_cvt_pk_bf16_f32 v103, v142, v143
  v_mfma_f32_16x16x32_bf16 v[184:187], a[96:99], v[80:83], 0
  v_mfma_f32_16x16x32_bf16 v[184:187], a[100:103], v[84:87], v[184:187]
  buffer_store_dwordx4 v[100:103], v2, s[40:43], s77 offen offset:2048 sc1
  v_mfma_f32_16x16x32_bf16 v[184:187], a[104:107], v[88:91], v[184:187]
  v_mfma_f32_16x16x32_bf16 v[184:187], a[108:111], v[92:95], v[184:187]
  s_waitcnt lgkmcnt(0)
  v_cvt_pk_bf16_f32 v104, v144, v145
  v_cvt_pk_bf16_f32 v105, v146, v147
  v_mfma_f32_16x16x32_bf16 v[164:167], a[112:115], v[32:35], 0
  v_mfma_f32_16x16x32_bf16 v[164:167], a[116:119], v[36:39], v[164:167]
  v_cvt_pk_bf16_f32 v106, v148, v149
  v_cvt_pk_bf16_f32 v107, v150, v151
  v_mfma_f32_16x16x32_bf16 v[164:167], a[120:123], v[40:43], v[164:167]
  v_mfma_f32_16x16x32_bf16 v[164:167], a[124:127], v[44:47], v[164:167]
  buffer_store_dwordx4 v[104:107], v2, s[40:43], s78 offen offset:2048 sc1
  v_mfma_f32_16x16x32_bf16 v[172:175], a[112:115], v[48:51], 0
  v_mfma_f32_16x16x32_bf16 v[172:175], a[116:119], v[52:55], v[172:175]
  v_cvt_pk_bf16_f32 v108, v152, v153
  v_cvt_pk_bf16_f32 v109, v154, v155
  v_mfma_f32_16x16x32_bf16 v[172:175], a[120:123], v[56:59], v[172:175]
  v_mfma_f32_16x16x32_bf16 v[172:175], a[124:127], v[60:63], v[172:175]
  v_cvt_pk_bf16_f32 v110, v156, v157
  v_cvt_pk_bf16_f32 v111, v158, v159
  v_mfma_f32_16x16x32_bf16 v[180:183], a[112:115], v[64:67], 0
  v_mfma_f32_16x16x32_bf16 v[180:183], a[116:119], v[68:71], v[180:183]
  buffer_store_dwordx4 v[108:111], v2, s[40:43], s79 offen offset:2048 sc1
  v_mfma_f32_16x16x32_bf16 v[180:183], a[120:123], v[72:75], v[180:183]
  v_mfma_f32_16x16x32_bf16 v[180:183], a[124:127], v[76:79], v[180:183]
  v_mfma_f32_16x16x32_bf16 v[188:191], a[112:115], v[80:83], 0
  v_mfma_f32_16x16x32_bf16 v[188:191], a[116:119], v[84:87], v[188:191]
  v_mfma_f32_16x16x32_bf16 v[188:191], a[120:123], v[88:91], v[188:191]
  v_mfma_f32_16x16x32_bf16 v[188:191], a[124:127], v[92:95], v[188:191]
  s_nop 7
  v_cvt_pk_bf16_f32 v112, v160, v161
  v_cvt_pk_bf16_f32 v113, v162, v163
  v_cvt_pk_bf16_f32 v114, v164, v165
  v_cvt_pk_bf16_f32 v115, v166, v167
  buffer_store_dwordx4 v[112:115], v2, s[40:43], s76 offen offset:3072 sc1
  v_cvt_pk_bf16_f32 v116, v168, v169
  v_cvt_pk_bf16_f32 v117, v170, v171
  v_cvt_pk_bf16_f32 v118, v172, v173
  v_cvt_pk_bf16_f32 v119, v174, v175
  buffer_store_dwordx4 v[116:119], v2, s[40:43], s77 offen offset:3072 sc1
  v_cvt_pk_bf16_f32 v120, v176, v177
  v_cvt_pk_bf16_f32 v121, v178, v179
  v_cvt_pk_bf16_f32 v122, v180, v181
  v_cvt_pk_bf16_f32 v123, v182, v183
  buffer_store_dwordx4 v[120:123], v2, s[40:43], s78 offen offset:3072 sc1
  v_cvt_pk_bf16_f32 v124, v184, v185
  v_cvt_pk_bf16_f32 v125, v186, v187
  v_cvt_pk_bf16_f32 v126, v188, v189
  v_cvt_pk_bf16_f32 v127, v190, v191
  buffer_store_dwordx4 v[124:127], v2, s[40:43], s79 offen offset:3072 sc1
  s_lshl_b32 s66, s57, 7
  s_add_u32 s66, s66, 0xd086000
  s_cmp_eq_u32 s44, 0
  s_cselect_b32 s66, s66, 0x40000000
  v_mov_b32 v6, 1
  s_waitcnt vmcnt(0)
  s_barrier
  s_mov_b64 exec, 1
  buffer_atomic_add v6, v2, s[40:43], s66 offen
  s_mov_b64 exec, -1
  s_branch L_att_end
L_a_s1_t:
  s_mov_b32 s71, 0
  s_nop 6
  s_branch L_a_slow0_0
L_a_s0_t:
  s_mov_b32 s71, 1
  s_nop 6
  s_branch L_a_slow1_0
L_a_d0_t:
  s_mov_b32 s71, 2
  s_nop 6
  s_branch L_a_slow0_0
L_a_d1_t:
  s_mov_b32 s71, 3
  s_nop 6
  s_branch L_a_slow1_0
L_a_d2_t:
  s_mov_b32 s71, 4
  s_nop 6
  s_branch L_a_slow0_1
L_a_d3_t:
  s_mov_b32 s71, 5
  s_nop 6
  s_branch L_a_slow1_1
L_a_d4_t:
  s_mov_b32 s71, 6
  s_nop 6
  s_branch L_a_slow0_2
L_a_d5_t:
  s_mov_b32 s71, 7
  s_nop 6
  s_branch L_a_slow1_2
L_a_d6_t:
  s_mov_b32 s71, 8
  s_nop 6
  s_branch L_a_slow0_3
L_a_d7_t:
  s_mov_b32 s71, 9
  s_nop 6
  s_branch L_a_slow1_3
L_a_slow0_0:
  v_max3_f32 v6, v32, v33, v34
  v_max3_f32 v7, v35, v36, v37
  v_max3_f32 v6, v6, v38, v39
  v_max_f32 v6, v6, v7
  v_mov_b32 v7, v6
  s_nop 1
  v_permlane32_swap_b32 v7, v6
  v_max_f32 v6, v6, v7
  v_mov_b32 v7, v6
  s_nop 1
  v_permlane16_swap_b32 v7, v6
  v_max_f32 v6, v6, v7
  v_add_f32 v6, 0x41800000, v6
  v_max_f32 v6, 0, v6
  v_exp_f32 v7, -v6
  v_sub_f32 v96, v96, v6
  v_sub_f32 v97, v97, v6
  v_sub_f32 v98, v98, v6
  v_sub_f32 v99, v99, v6
  v_sub_f32 v100, v100, v6
  v_sub_f32 v101, v101, v6
  v_sub_f32 v102, v102, v6
  v_sub_f32 v103, v103, v6
  v_mul_f32 v128, v128, v7
  v_mul_f32 v129, v129, v7
  v_mul_f32 v130, v130, v7
  v_mul_f32 v131, v131, v7
  v_mul_f32 v132, v132, v7
  v_mul_f32 v133, v133, v7
  v_mul_f32 v134, v134, v7
  v_mul_f32 v135, v135, v7
  v_mul_f32 v136, v136, v7
  v_mul_f32 v137, v137, v7
  v_mul_f32 v138, v138, v7
  v_mul_f32 v139, v139, v7
  v_mul_f32 v140, v140, v7
  v_mul_f32 v141, v141, v7
  v_mul_f32 v142, v142, v7
  v_mul_f32 v143, v143, v7
  v_mul_f32 v144, v144, v7
  v_mul_f32 v145, v145, v7
  v_mul_f32 v146, v146, v7
  v_mul_f32 v147, v147, v7
  v_mul_f32 v148, v148, v7
  v_mul_f32 v149, v149, v7
  v_mul_f32 v150, v150, v7
  v_mul_f32 v151, v151, v7
  v_mul_f32 v152, v152, v7
  v_mul_f32 v153, v153, v7
  v_mul_f32 v154, v154, v7
  v_mul_f32 v155, v155, v7
  v_mul_f32 v156, v156, v7
  v_mul_f32 v157, v157, v7
  v_mul_f32 v158, v158, v7
  v_mul_f32 v159, v159, v7
  v_accvgpr_read_b32 v8, a128
  v_mul_f32 v8, v8, v7
  v_accvgpr_write_b32 a128, v8
  v_accvgpr_read_b32 v8, a129
  v_mul_f32 v8, v8, v7
  v_accvgpr_write_b32 a129, v8
  v_accvgpr_read_b32 v8, a130
  v_mul_f32 v8, v8, v7
  v_accvgpr_write_b32 a130, v8
  v_accvgpr_read_b32 v8, a131
  v_mul_f32 v8, v8, v7
  v_accvgpr_write_b32 a131, v8
  v_sub_f32 v8, v32, v6
  v_sub_f32 v9, v33, v6
  v_sub_f32 v10, v34, v6
  v_sub_f32 v11, v35, v6
  v_sub_f32 v12, v36, v6
  v_sub_f32 v13, v37, v6
  v_sub_f32 v14, v38, v6
  v_sub_f32 v15, v39, v6
  v_exp_f32 v8, v8
  v_exp_f32 v9, v9
  v_exp_f32 v10, v10
  v_exp_f32 v11, v11
  v_exp_f32 v12, v12
  v_exp_f32 v13, v13
  v_exp_f32 v14, v14
  v_exp_f32 v15, v15
  v_cvt_pk_bf16_f32 v64, v8, v9
  v_cvt_pk_bf16_f32 v65, v10, v11
  v_cvt_pk_bf16_f32 v66, v12, v13
  v_cvt_pk_bf16_f32 v67, v14, v15
L_a_slow0_1:
  v_max3_f32 v6, v40, v41, v42
  v_max3_f32 v7, v43, v44, v45
  v_max3_f32 v6, v6, v46, v47
  v_max_f32 v6, v6, v7
  v_mov_b32 v7, v6
  s_nop 1
  v_permlane32_swap_b32 v7, v6
  v_max_f32 v6, v6, v7
  v_mov_b32 v7, v6
  s_nop 1
  v_permlane16_swap_b32 v7, v6
  v_max_f32 v6, v6, v7
  v_add_f32 v6, 0x41800000, v6
  v_max_f32 v6, 0, v6
  v_exp_f32 v7, -v6
  v_sub_f32 v104, v104, v6
  v_sub_f32 v105, v105, v6
  v_sub_f32 v106, v106, v6
  v_sub_f32 v107, v107, v6
  v_sub_f32 v108, v108, v6
  v_sub_f32 v109, v109, v6
  v_sub_f32 v110, v110, v6
  v_sub_f32 v111, v111, v6
  v_mul_f32 v160, v160, v7
  v_mul_f32 v161, v161, v7
  v_mul_f32 v162, v162, v7
  v_mul_f32 v163, v163, v7
  v_mul_f32 v164, v164, v7
  v_mul_f32 v165, v165, v7
  v_mul_f32 v166, v166, v7
  v_mul_f32 v167, v167, v7
  v_mul_f32 v168, v168, v7
  v_mul_f32 v169, v169, v7
  v_mul_f32 v170, v170, v7
  v_mul_f32 v171, v171, v7
  v_mul_f32 v172, v172, v7
  v_mul_f32 v173, v173, v7
  v_mul_f32 v174, v174, v7
  v_mul_f32 v175, v175, v7
  v_mul_f32 v176, v176, v7
  v_mul_f32 v177, v177, v7
  v_mul_f32 v178, v178, v7
  v_mul_f32 v179, v179, v7
  v_mul_f32 v180, v180, v7
  v_mul_f32 v181, v181, v7
  v_mul_f32 v182, v182, v7
  v_mul_f32 v183, v183, v7
  v_mul_f32 v184, v184, v7
  v_mul_f32 v185, v185, v7
  v_mul_f32 v186, v186, v7
  v_mul_f32 v187, v187, v7
  v_mul_f32 v188, v188, v7
  v_mul_f32 v189, v189, v7
  v_mul_f32 v190, v190, v7
  v_mul_f32 v191, v191, v7
  v_accvgpr_read_b32 v8, a132
  v_mul_f32 v8, v8, v7
  v_accvgpr_write_b32 a132, v8
  v_accvgpr_read_b32 v8, a133
  v_mul_f32 v8, v8, v7
  v_accvgpr_write_b32 a133, v8
  v_accvgpr_read_b32 v8, a134
  v_mul_f32 v8, v8, v7
  v_accvgpr_write_b32 a134, v8
  v_accvgpr_read_b32 v8, a135
  v_mul_f32 v8, v8, v7
  v_accvgpr_write_b32 a135, v8
  v_sub_f32 v8, v40, v6
  v_sub_f32 v9, v41, v6
  v_sub_f32 v10, v42, v6
  v_sub_f32 v11, v43, v6
  v_sub_f32 v12, v44, v6
  v_sub_f32 v13, v45, v6
  v_sub_f32 v14, v46, v6
  v_sub_f32 v15, v47, v6
  v_exp_f32 v8, v8
  v_exp_f32 v9, v9
  v_exp_f32 v10, v10
  v_exp_f32 v11, v11
  v_exp_f32 v12, v12
  v_exp_f32 v13, v13
  v_exp_f32 v14, v14
  v_exp_f32 v15, v15
  v_cvt_pk_bf16_f32 v68, v8, v9
  v_cvt_pk_bf16_f32 v69, v10, v11
  v_cvt_pk_bf16_f32 v70, v12, v13
  v_cvt_pk_bf16_f32 v71, v14, v15
L_a_slow0_2:
  v_max3_f32 v6, v48, v49, v50
  v_max3_f32 v7, v51, v52, v53
  v_max3_f32 v6, v6, v54, v55
  v_max_f32 v6, v6, v7
  v_mov_b32 v7, v6
  s_nop 1
  v_permlane32_swap_b32 v7, v6
  v_max_f32 v6, v6, v7
  v_mov_b32 v7, v6
  s_nop 1
  v_permlane16_swap_b32 v7, v6
  v_max_f32 v6, v6, v7
  v_add_f32 v6, 0x41800000, v6
  v_max_f32 v6, 0, v6
  v_exp_f32 v7, -v6
  v_sub_f32 v112, v112, v6
  v_sub_f32 v113, v113, v6
  v_sub_f32 v114, v114, v6
  v_sub_f32 v115, v115, v6
  v_sub_f32 v116, v116, v6
  v_sub_f32 v117, v117, v6
  v_sub_f32 v118, v118, v6
  v_sub_f32 v119, v119, v6
  v_mul_f32 v192, v192, v7
  v_mul_f32 v193, v193, v7
  v_mul_f32 v194, v194, v7
  v_mul_f32 v195, v195, v7
  v_mul_f32 v196, v196, v7
  v_mul_f32 v197, v197, v7
  v_mul_f32 v198, v198, v7
  v_mul_f32 v199, v199, v7
  v_mul_f32 v200, v200, v7
  v_mul_f32 v201, v201, v7
  v_mul_f32 v202, v202, v7
  v_mul_f32 v203, v203, v7
  v_mul_f32 v204, v204, v7
  v_mul_f32 v205, v205, v7
  v_mul_f32 v206, v206, v7
  v_mul_f32 v207, v207, v7
  v_mul_f32 v208, v208, v7
  v_mul_f32 v209, v209, v7
  v_mul_f32 v210, v210, v7
  v_mul_f32 v211, v211, v7
  v_mul_f32 v212, v212, v7
  v_mul_f32 v213, v213, v7
  v_mul_f32 v214, v214, v7
  v_mul_f32 v215, v215, v7
  v_mul_f32 v216, v216, v7
  v_mul_f32 v217, v217, v7
  v_mul_f32 v218, v218, v7
  v_mul_f32 v219, v219, v7
  v_mul_f32 v220, v220, v7
  v_mul_f32 v221, v221, v7
  v_mul_f32 v222, v222, v7
  v_mul_f32 v223, v223, v7
  v_accvgpr_read_b32 v8, a136
  v_mul_f32 v8, v8, v7
  v_accvgpr_write_b32 a136, v8
  v_accvgpr_read_b32 v8, a137
  v_mul_f32 v8, v8, v7
  v_accvgpr_write_b32 a137, v8
  v_accvgpr_read_b32 v8, a138
  v_mul_f32 v8, v8, v7
  v_accvgpr_write_b32 a138, v8
  v_accvgpr_read_b32 v8, a139
  v_mul_f32 v8, v8, v7
  v_accvgpr_write_b32 a139, v8
  v_sub_f32 v8, v48, v6
  v_sub_f32 v9, v49, v6
  v_sub_f32 v10, v50, v6
  v_sub_f32 v11, v51, v6
  v_sub_f32 v12, v52, v6
  v_sub_f32 v13, v53, v6
  v_sub_f32 v14, v54, v6
  v_sub_f32 v15, v55, v6
  v_exp_f32 v8, v8
  v_exp_f32 v9, v9
  v_exp_f32 v10, v10
  v_exp_f32 v11, v11
  v_exp_f32 v12, v12
  v_exp_f32 v13, v13
  v_exp_f32 v14, v14
  v_exp_f32 v15, v15
  v_cvt_pk_bf16_f32 v72, v8, v9
  v_cvt_pk_bf16_f32 v73, v10, v11
  v_cvt_pk_bf16_f32 v74, v12, v13
  v_cvt_pk_bf16_f32 v75, v14, v15
L_a_slow0_3:
  v_max3_f32 v6, v56, v57, v58
  v_max3_f32 v7, v59, v60, v61
  v_max3_f32 v6, v6, v62, v63
  v_max_f32 v6, v6, v7
  v_mov_b32 v7, v6
  s_nop 1
  v_permlane32_swap_b32 v7, v6
  v_max_f32 v6, v6, v7
  v_mov_b32 v7, v6
  s_nop 1
  v_permlane16_swap_b32 v7, v6
  v_max_f32 v6, v6, v7
  v_add_f32 v6, 0x41800000, v6
  v_max_f32 v6, 0, v6
  v_exp_f32 v7, -v6
  v_sub_f32 v120, v120, v6
  v_sub_f32 v121, v121, v6
  v_sub_f32 v122, v122, v6
  v_sub_f32 v123, v123, v6
  v_sub_f32 v124, v124, v6
  v_sub_f32 v125, v125, v6
  v_sub_f32 v126, v126, v6
  v_sub_f32 v127, v127, v6
  v_mul_f32 v224, v224, v7
  v_mul_f32 v225, v225, v7
  v_mul_f32 v226, v226, v7
  v_mul_f32 v227, v227, v7
  v_mul_f32 v228, v228, v7
  v_mul_f32 v229, v229, v7
  v_mul_f32 v230, v230, v7
  v_mul_f32 v231, v231, v7
  v_mul_f32 v232, v232, v7
  v_mul_f32 v233, v233, v7
  v_mul_f32 v234, v234, v7
  v_mul_f32 v235, v235, v7
  v_mul_f32 v236, v236, v7
  v_mul_f32 v237, v237, v7
  v_mul_f32 v238, v238, v7
  v_mul_f32 v239, v239, v7
  v_mul_f32 v240, v240, v7
  v_mul_f32 v241, v241, v7
  v_mul_f32 v242, v242, v7
  v_mul_f32 v243, v243, v7
  v_mul_f32 v244, v244, v7
  v_mul_f32 v245, v245, v7
  v_mul_f32 v246, v246, v7
  v_mul_f32 v247, v247, v7
  v_mul_f32 v248, v248, v7
  v_mul_f32 v249, v249, v7
  v_mul_f32 v250, v250, v7
  v_mul_f32 v251, v251, v7
  v_mul_f32 v252, v252, v7
  v_mul_f32 v253, v253, v7
  v_mul_f32 v254, v254, v7
  v_mul_f32 v255, v255, v7
  v_accvgpr_read_b32 v8, a140
  v_mul_f32 v8, v8, v7
  v_accvgpr_write_b32 a140, v8
  v_accvgpr_read_b32 v8, a141
  v_mul_f32 v8, v8, v7
  v_accvgpr_write_b32 a141, v8
  v_accvgpr_read_b32 v8, a142
  v_mul_f32 v8, v8, v7
  v_accvgpr_write_b32 a142, v8
  v_accvgpr_read_b32 v8, a143
  v_mul_f32 v8, v8, v7
  v_accvgpr_write_b32 a143, v8
  v_sub_f32 v8, v56, v6
  v_sub_f32 v9, v57, v6
  v_sub_f32 v10, v58, v6
  v_sub_f32 v11, v59, v6
  v_sub_f32 v12, v60, v6
  v_sub_f32 v13, v61, v6
  v_sub_f32 v14, v62, v6
  v_sub_f32 v15, v63, v6
  v_exp_f32 v8, v8
  v_exp_f32 v9, v9
  v_exp_f32 v10, v10
  v_exp_f32 v11, v11
  v_exp_f32 v12, v12
  v_exp_f32 v13, v13
  v_exp_f32 v14, v14
  v_exp_f32 v15, v15
  v_cvt_pk_bf16_f32 v76, v8, v9
  v_cvt_pk_bf16_f32 v77, v10, v11
  v_cvt_pk_bf16_f32 v78, v12, v13
  v_cvt_pk_bf16_f32 v79, v14, v15
  s_cmp_eq_u32 s71, 0
  s_cbranch_scc1 L_a_s1_r
  s_cmp_eq_u32 s71, 2
  s_cbranch_scc1 L_a_d0_r
  s_cmp_eq_u32 s71, 4
  s_cbranch_scc1 L_a_d2_r
  s_cmp_eq_u32 s71, 6
  s_cbranch_scc1 L_a_d4_r
  s_branch L_a_d6_r
L_a_slow1_0:
  v_max3_f32 v6, v32, v33, v34
  v_max3_f32 v7, v35, v36, v37
  v_max3_f32 v6, v6, v38, v39
  v_max_f32 v6, v6, v7
  v_mov_b32 v7, v6
  s_nop 1
  v_permlane32_swap_b32 v7, v6
  v_max_f32 v6, v6, v7
  v_mov_b32 v7, v6
  s_nop 1
  v_permlane16_swap_b32 v7, v6
  v_max_f32 v6, v6, v7
  v_add_f32 v6, 0x41800000, v6
  v_max_f32 v6, 0, v6
  v_exp_f32 v7, -v6
  v_sub_f32 v96, v96, v6
  v_sub_f32 v97, v97, v6
  v_sub_f32 v98, v98, v6
  v_sub_f32 v99, v99, v6
  v_sub_f32 v100, v100, v6
  v_sub_f32 v101, v101, v6
  v_sub_f32 v102, v102, v6
  v_sub_f32 v103, v103, v6
  v_mul_f32 v128, v128, v7
  v_mul_f32 v129, v129, v7
  v_mul_f32 v130, v130, v7
  v_mul_f32 v131, v131, v7
  v_mul_f32 v132, v132, v7
  v_mul_f32 v133, v133, v7
  v_mul_f32 v134, v134, v7
  v_mul_f32 v135, v135, v7
  v_mul_f32 v136, v136, v7
  v_mul_f32 v137, v137, v7
  v_mul_f32 v138, v138, v7
  v_mul_f32 v139, v139, v7
  v_mul_f32 v140, v140, v7
  v_mul_f32 v141, v141, v7
  v_mul_f32 v142, v142, v7
  v_mul_f32 v143, v143, v7
  v_mul_f32 v144, v144, v7
  v_mul_f32 v145, v145, v7
  v_mul_f32 v146, v146, v7
  v_mul_f32 v147, v147, v7
  v_mul_f32 v148, v148, v7
  v_mul_f32 v149, v149, v7
  v_mul_f32 v150, v150, v7
  v_mul_f32 v151, v151, v7
  v_mul_f32 v152, v152, v7
  v_mul_f32 v153, v153, v7
  v_mul_f32 v154, v154, v7
  v_mul_f32 v155, v155, v7
  v_mul_f32 v156, v156, v7
  v_mul_f32 v157, v157, v7
  v_mul_f32 v158, v158, v7
  v_mul_f32 v159, v159, v7
  v_accvgpr_read_b32 v8, a128
  v_mul_f32 v8, v8, v7
  v_accvgpr_write_b32 a128, v8
  v_accvgpr_read_b32 v8, a129
  v_mul_f32 v8, v8, v7
  v_accvgpr_write_b32 a129, v8
  v_accvgpr_read_b32 v8, a130
  v_mul_f32 v8, v8, v7
  v_accvgpr_write_b32 a130, v8
  v_accvgpr_read_b32 v8, a131
  v_mul_f32 v8, v8, v7
  v_accvgpr_write_b32 a131, v8
  v_sub_f32 v8, v32, v6
  v_sub_f32 v9, v33, v6
  v_sub_f32 v10, v34, v6
  v_sub_f32 v11, v35, v6
  v_sub_f32 v12, v36, v6
  v_sub_f32 v13, v37, v6
  v_sub_f32 v14, v38, v6
  v_sub_f32 v15, v39, v6
  v_exp_f32 v8, v8
  v_exp_f32 v9, v9
  v_exp_f32 v10, v10
  v_exp_f32 v11, v11
  v_exp_f32 v12, v12
  v_exp_f32 v13, v13
  v_exp_f32 v14, v14
  v_exp_f32 v15, v15
  v_cvt_pk_bf16_f32 v80, v8, v9
  v_cvt_pk_bf16_f32 v81, v10, v11
  v_cvt_pk_bf16_f32 v82, v12, v13
  v_cvt_pk_bf16_f32 v83, v14, v15
L_a_slow1_1:
  v_max3_f32 v6, v40, v41, v42
  v_max3_f32 v7, v43, v44, v45
  v_max3_f32 v6, v6, v46, v47
  v_max_f32 v6, v6, v7
  v_mov_b32 v7, v6
  s_nop 1
  v_permlane32_swap_b32 v7, v6
  v_max_f32 v6, v6, v7
  v_mov_b32 v7, v6
  s_nop 1
  v_permlane16_swap_b32 v7, v6
  v_max_f32 v6, v6, v7
  v_add_f32 v6, 0x41800000, v6
  v_max_f32 v6, 0, v6
  v_exp_f32 v7, -v6
  v_sub_f32 v104, v104, v6
  v_sub_f32 v105, v105, v6
  v_sub_f32 v106, v106, v6
  v_sub_f32 v107, v107, v6
  v_sub_f32 v108, v108, v6
  v_sub_f32 v109, v109, v6
  v_sub_f32 v110, v110, v6
  v_sub_f32 v111, v111, v6
  v_mul_f32 v160, v160, v7
  v_mul_f32 v161, v161, v7
  v_mul_f32 v162, v162, v7
  v_mul_f32 v163, v163, v7
  v_mul_f32 v164, v164, v7
  v_mul_f32 v165, v165, v7
  v_mul_f32 v166, v166, v7
  v_mul_f32 v167, v167, v7
  v_mul_f32 v168, v168, v7
  v_mul_f32 v169, v169, v7
  v_mul_f32 v170, v170, v7
  v_mul_f32 v171, v171, v7
  v_mul_f32 v172, v172, v7
  v_mul_f32 v173, v173, v7
  v_mul_f32 v174, v174, v7
  v_mul_f32 v175, v175, v7
  v_mul_f32 v176, v176, v7
  v_mul_f32 v177, v177, v7
  v_mul_f32 v178, v178, v7
  v_mul_f32 v179, v179, v7
  v_mul_f32 v180, v180, v7
  v_mul_f32 v181, v181, v7
  v_mul_f32 v182, v182, v7
  v_mul_f32 v183, v183, v7
  v_mul_f32 v184, v184, v7
  v_mul_f32 v185, v185, v7
  v_mul_f32 v186, v186, v7
  v_mul_f32 v187, v187, v7
  v_mul_f32 v188, v188, v7
  v_mul_f32 v189, v189, v7
  v_mul_f32 v190, v190, v7
  v_mul_f32 v191, v191, v7
  v_accvgpr_read_b32 v8, a132
  v_mul_f32 v8, v8, v7
  v_accvgpr_write_b32 a132, v8
  v_accvgpr_read_b32 v8, a133
  v_mul_f32 v8, v8, v7
  v_accvgpr_write_b32 a133, v8
  v_accvgpr_read_b32 v8, a134
  v_mul_f32 v8, v8, v7
  v_accvgpr_write_b32 a134, v8
  v_accvgpr_read_b32 v8, a135
  v_mul_f32 v8, v8, v7
  v_accvgpr_write_b32 a135, v8
  v_sub_f32 v8, v40, v6
  v_sub_f32 v9, v41, v6
  v_sub_f32 v10, v42, v6
  v_sub_f32 v11, v43, v6
  v_sub_f32 v12, v44, v6
  v_sub_f32 v13, v45, v6
  v_sub_f32 v14, v46, v6
  v_sub_f32 v15, v47, v6
  v_exp_f32 v8, v8
  v_exp_f32 v9, v9
  v_exp_f32 v10, v10
  v_exp_f32 v11, v11
  v_exp_f32 v12, v12
  v_exp_f32 v13, v13
  v_exp_f32 v14, v14
  v_exp_f32 v15, v15
  v_cvt_pk_bf16_f32 v84, v8, v9
  v_cvt_pk_bf16_f32 v85, v10, v11
  v_cvt_pk_bf16_f32 v86, v12, v13
  v_cvt_pk_bf16_f32 v87, v14, v15
L_a_slow1_2:
  v_max3_f32 v6, v48, v49, v50
  v_max3_f32 v7, v51, v52, v53
  v_max3_f32 v6, v6, v54, v55
  v_max_f32 v6, v6, v7
  v_mov_b32 v7, v6
  s_nop 1
  v_permlane32_swap_b32 v7, v6
  v_max_f32 v6, v6, v7
  v_mov_b32 v7, v6
  s_nop 1
  v_permlane16_swap_b32 v7, v6
  v_max_f32 v6, v6, v7
  v_add_f32 v6, 0x41800000, v6
  v_max_f32 v6, 0, v6
  v_exp_f32 v7, -v6
  v_sub_f32 v112, v112, v6
  v_sub_f32 v113, v113, v6
  v_sub_f32 v114, v114, v6
  v_sub_f32 v115, v115, v6
  v_sub_f32 v116, v116, v6
  v_sub_f32 v117, v117, v6
  v_sub_f32 v118, v118, v6
  v_sub_f32 v119, v119, v6
  v_mul_f32 v192, v192, v7
  v_mul_f32 v193, v193, v7
  v_mul_f32 v194, v194, v7
  v_mul_f32 v195, v195, v7
  v_mul_f32 v196, v196, v7
  v_mul_f32 v197, v197, v7
  v_mul_f32 v198, v198, v7
  v_mul_f32 v199, v199, v7
  v_mul_f32 v200, v200, v7
  v_mul_f32 v201, v201, v7
  v_mul_f32 v202, v202, v7
  v_mul_f32 v203, v203, v7
  v_mul_f32 v204, v204, v7
  v_mul_f32 v205, v205, v7
  v_mul_f32 v206, v206, v7
  v_mul_f32 v207, v207, v7
  v_mul_f32 v208, v208, v7
  v_mul_f32 v209, v209, v7
  v_mul_f32 v210, v210, v7
  v_mul_f32 v211, v211, v7
  v_mul_f32 v212, v212, v7
  v_mul_f32 v213, v213, v7
  v_mul_f32 v214, v214, v7
  v_mul_f32 v215, v215, v7
  v_mul_f32 v216, v216, v7
  v_mul_f32 v217, v217, v7
  v_mul_f32 v218, v218, v7
  v_mul_f32 v219, v219, v7
  v_mul_f32 v220, v220, v7
  v_mul_f32 v221, v221, v7
  v_mul_f32 v222, v222, v7
  v_mul_f32 v223, v223, v7
  v_accvgpr_read_b32 v8, a136
  v_mul_f32 v8, v8, v7
  v_accvgpr_write_b32 a136, v8
  v_accvgpr_read_b32 v8, a137
  v_mul_f32 v8, v8, v7
  v_accvgpr_write_b32 a137, v8
  v_accvgpr_read_b32 v8, a138
  v_mul_f32 v8, v8, v7
  v_accvgpr_write_b32 a138, v8
  v_accvgpr_read_b32 v8, a139
  v_mul_f32 v8, v8, v7
  v_accvgpr_write_b32 a139, v8
  v_sub_f32 v8, v48, v6
  v_sub_f32 v9, v49, v6
  v_sub_f32 v10, v50, v6
  v_sub_f32 v11, v51, v6
  v_sub_f32 v12, v52, v6
  v_sub_f32 v13, v53, v6
  v_sub_f32 v14, v54, v6
  v_sub_f32 v15, v55, v6
  v_exp_f32 v8, v8
  v_exp_f32 v9, v9
  v_exp_f32 v10, v10
  v_exp_f32 v11, v11
  v_exp_f32 v12, v12
  v_exp_f32 v13, v13
  v_exp_f32 v14, v14
  v_exp_f32 v15, v15
  v_cvt_pk_bf16_f32 v88, v8, v9
  v_cvt_pk_bf16_f32 v89, v10, v11
  v_cvt_pk_bf16_f32 v90, v12, v13
  v_cvt_pk_bf16_f32 v91, v14, v15
L_a_slow1_3:
  v_max3_f32 v6, v56, v57, v58
  v_max3_f32 v7, v59, v60, v61
  v_max3_f32 v6, v6, v62, v63
  v_max_f32 v6, v6, v7
  v_mov_b32 v7, v6
  s_nop 1
  v_permlane32_swap_b32 v7, v6
  v_max_f32 v6, v6, v7
  v_mov_b32 v7, v6
  s_nop 1
  v_permlane16_swap_b32 v7, v6
  v_max_f32 v6, v6, v7
  v_add_f32 v6, 0x41800000, v6
  v_max_f32 v6, 0, v6
  v_exp_f32 v7, -v6
  v_sub_f32 v120, v120, v6
  v_sub_f32 v121, v121, v6
  v_sub_f32 v122, v122, v6
  v_sub_f32 v123, v123, v6
  v_sub_f32 v124, v124, v6
  v_sub_f32 v125, v125, v6
  v_sub_f32 v126, v126, v6
  v_sub_f32 v127, v127, v6
  v_mul_f32 v224, v224, v7
  v_mul_f32 v225, v225, v7
  v_mul_f32 v226, v226, v7
  v_mul_f32 v227, v227, v7
  v_mul_f32 v228, v228, v7
  v_mul_f32 v229, v229, v7
  v_mul_f32 v230, v230, v7
  v_mul_f32 v231, v231, v7
  v_mul_f32 v232, v232, v7
  v_mul_f32 v233, v233, v7
  v_mul_f32 v234, v234, v7
  v_mul_f32 v235, v235, v7
  v_mul_f32 v236, v236, v7
  v_mul_f32 v237, v237, v7
  v_mul_f32 v238, v238, v7
  v_mul_f32 v239, v239, v7
  v_mul_f32 v240, v240, v7
  v_mul_f32 v241, v241, v7
  v_mul_f32 v242, v242, v7
  v_mul_f32 v243, v243, v7
  v_mul_f32 v244, v244, v7
  v_mul_f32 v245, v245, v7
  v_mul_f32 v246, v246, v7
  v_mul_f32 v247, v247, v7
  v_mul_f32 v248, v248, v7
  v_mul_f32 v249, v249, v7
  v_mul_f32 v250, v250, v7
  v_mul_f32 v251, v251, v7
  v_mul_f32 v252, v252, v7
  v_mul_f32 v253, v253, v7
  v_mul_f32 v254, v254, v7
  v_mul_f32 v255, v255, v7
  v_accvgpr_read_b32 v8, a140
  v_mul_f32 v8, v8, v7
  v_accvgpr_write_b32 a140, v8
  v_accvgpr_read_b32 v8, a141
  v_mul_f32 v8, v8, v7
  v_accvgpr_write_b32 a141, v8
  v_accvgpr_read_b32 v8, a142
  v_mul_f32 v8, v8, v7
  v_accvgpr_write_b32 a142, v8
  v_accvgpr_read_b32 v8, a143
  v_mul_f32 v8, v8, v7
  v_accvgpr_write_b32 a143, v8
  v_sub_f32 v8, v56, v6
  v_sub_f32 v9, v57, v6
  v_sub_f32 v10, v58, v6
  v_sub_f32 v11, v59, v6
  v_sub_f32 v12, v60, v6
  v_sub_f32 v13, v61, v6
  v_sub_f32 v14, v62, v6
  v_sub_f32 v15, v63, v6
  v_exp_f32 v8, v8
  v_exp_f32 v9, v9
  v_exp_f32 v10, v10
  v_exp_f32 v11, v11
  v_exp_f32 v12, v12
  v_exp_f32 v13, v13
  v_exp_f32 v14, v14
  v_exp_f32 v15, v15
  v_cvt_pk_bf16_f32 v92, v8, v9
  v_cvt_pk_bf16_f32 v93, v10, v11
  v_cvt_pk_bf16_f32 v94, v12, v13
  v_cvt_pk_bf16_f32 v95, v14, v15
  s_cmp_eq_u32 s71, 1
  s_cbranch_scc1 L_a_s0_r
  s_cmp_eq_u32 s71, 3
  s_cbranch_scc1 L_a_d1_r
  s_cmp_eq_u32 s71, 5
  s_cbranch_scc1 L_a_d3_r
  s_cmp_eq_u32 s71, 7
  s_cbranch_scc1 L_a_d5_r
  s_branch L_a_d7_r
L_att_end:
  s_branch L_next
L_go_outx:
  s_bfe_u32 s56, s3, 0x40004
  s_bfe_u32 s62, s3, 0x10004
  s_bitcmp1_b32 s3, 3
  s_cbranch_scc1 L_red
L_barr:
  s_mov_b32 s48, s30
  s_and_b32 s49, s31, 0xffff
  s_mov_b32 s50, 0x400000
  s_mov_b32 s51, 0x20000
  v_lshlrev_b32 v2, 4, v0
  v_mov_b32 v7, 0
  s_mov_b32 s57, 0
  v_lshrrev_b32 v3, 4, v0
  v_and_b32 v4, 15, v0
  v_lshlrev_b32 v5, 1, v3
  v_xor_b32 v5, v5, v4
  v_lshlrev_b32 v5, 4, v5
  v_lshl_add_u32 v88, v3, 10, v5
  v_xor_b32 v89, 128, v88
  s_lshl_b32 s66, s44, 15
  s_lshl_b32 s60, s56, 18
  s_lshl_b32 s58, s44, 8
  s_add_u32 s60, s60, s58
  s_add_u32 m0, s66, 0
  s_add_u32 s58, s60, 0
  buffer_load_dwordx4 v88, s[48:51], s58 offen lds
  s_add_u32 m0, s66, 1024
  s_add_u32 s58, s60, 4096
  buffer_load_dwordx4 v89, s[48:51], s58 offen lds
  s_add_u32 m0, s66, 2048
  s_add_u32 s58, s60, 8192
  buffer_load_dwordx4 v88, s[48:51], s58 offen lds
  s_add_u32 m0, s66, 3072
  s_add_u32 s58, s60, 12288
  buffer_load_dwordx4 v89, s[48:51], s58 offen lds
  s_add_u32 m0, s66, 4096
  s_add_u32 s58, s60, 16384
  buffer_load_dwordx4 v88, s[48:51], s58 offen lds
  s_add_u32 m0, s66, 5120
  s_add_u32 s58, s60, 20480
  buffer_load_dwordx4 v89, s[48:51], s58 offen lds
  s_add_u32 m0, s66, 6144
  s_add_u32 s58, s60, 24576
  buffer_load_dwordx4 v88, s[48:51], s58 offen lds
  s_add_u32 m0, s66, 7168
  s_add_u32 s58, s60, 28672
  buffer_load_dwordx4 v89, s[48:51], s58 offen lds
  s_add_u32 m0, s66, 8192
  s_add_u32 s58, s60, 32768
  buffer_load_dwordx4 v88, s[48:51], s58 offen lds
  s_add_u32 m0, s66, 9216
  s_add_u32 s58, s60, 36864
  buffer_load_dwordx4 v89, s[48:51], s58 offen lds
  s_add_u32 m0, s66, 10240
  s_add_u32 s58, s60, 40960
  buffer_load_dwordx4 v88, s[48:51], s58 offen lds
  s_add_u32 m0, s66, 11264
  s_add_u32 s58, s60, 45056
  buffer_load_dwordx4 v89, s[48:51], s58 offen lds
  s_add_u32 m0, s66, 12288
  s_add_u32 s58, s60, 49152
  buffer_load_dwordx4 v88, s[48:51], s58 offen lds
  s_add_u32 m0, s66, 13312
  s_add_u32 s58, s60, 53248
  buffer_load_dwordx4 v89, s[48:51], s58 offen lds
  s_add_u32 m0, s66, 14336
  s_add_u32 s58, s60, 57344
  buffer_load_dwordx4 v88, s[48:51], s58 offen lds
  s_add_u32 m0, s66, 15360
  s_add_u32 s58, s60, 61440
  buffer_load_dwordx4 v89, s[48:51], s58 offen lds
  s_add_u32 m0, s66, 16384
  s_add_u32 s58, s60, 65536
  buffer_load_dwordx4 v88, s[48:51], s58 offen lds
  s_add_u32 m0, s66, 17408
  s_add_u32 s58, s60, 69632
  buffer_load_dwordx4 v89, s[48:51], s58 offen lds
  s_add_u32 m0, s66, 18432
  s_add_u32 s58, s60, 73728
  buffer_load_dwordx4 v88, s[48:51], s58 offen lds
  s_add_u32 m0, s66, 19456
  s_add_u32 s58, s60, 77824
  buffer_load_dwordx4 v89, s[48:51], s58 offen lds
  s_add_u32 m0, s66, 20480
  s_add_u32 s58, s60, 81920
  buffer_load_dwordx4 v88, s[48:51], s58 offen lds
  s_add_u32 m0, s66, 21504
  s_add_u32 s58, s60, 86016
  buffer_load_dwordx4 v89, s[48:51], s58 offen lds
  s_add_u32 m0, s66, 22528
  s_add_u32 s58, s60, 90112
  buffer_load_dwordx4 v88, s[48:51], s58 offen lds
  s_add_u32 m0, s66, 23552
  s_add_u32 s58, s60, 94208
  buffer_load_dwordx4 v89, s[48:51], s58 offen lds
  s_add_u32 m0, s66, 24576
  s_add_u32 s58, s60, 98304
  buffer_load_dwordx4 v88, s[48:51], s58 offen lds
  s_add_u32 m0, s66, 25600
  s_add_u32 s58, s60, 102400
  buffer_load_dwordx4 v89, s[48:51], s58 offen lds
  s_add_u32 m0, s66, 26624
  s_add_u32 s58, s60, 106496
  buffer_load_dwordx4 v88, s[48:51], s58 offen lds
  s_add_u32 m0, s66, 27648
  s_add_u32 s58, s60, 110592
  buffer_load_dwordx4 v89, s[48:51], s58 offen lds
  s_add_u32 m0, s66, 28672
  s_add_u32 s58, s60, 114688
  buffer_load_dwordx4 v88, s[48:51], s58 offen lds
  s_add_u32 m0, s66, 29696
  s_add_u32 s58, s60, 118784
  buffer_load_dwordx4 v89, s[48:51], s58 offen lds
  s_add_u32 m0, s66, 30720
  s_add_u32 s58, s60, 122880
  buffer_load_dwordx4 v88, s[48:51], s58 offen lds
  s_add_u32 m0, s66, 31744
  s_add_u32 s58, s60, 126976
  buffer_load_dwordx4 v89, s[48:51], s58 offen lds
  v_lshrrev_b32 v5, 2, v0
  v_lshl_add_u32 v104, v5, 8, s66
  v_and_b32 v5, 7, v5
  v_lshl_add_u32 v104, v5, 5, v104
  v_and_b32 v5, 3, v0
  v_lshl_add_u32 v104, v5, 3, v104
  v_xor_b32 v105, 32, v104
  v_xor_b32 v106, 64, v104
  v_xor_b32 v107, 96, v104
  v_xor_b32 v108, 128, v104
  v_xor_b32 v109, 160, v104
  v_xor_b32 v110, 192, v104
  v_xor_b32 v111, 224, v104
  s_waitcnt vmcnt(24)
  ds_read_b64_tr_b16 a[0:1], v104 offset:0
  ds_read_b64_tr_b16 a[2:3], v104 offset:4096
  ds_read_b64_tr_b16 a[32:33], v105 offset:0
  ds_read_b64_tr_b16 a[34:35], v105 offset:4096
  ds_read_b64_tr_b16 a[64:65], v106 offset:0
  ds_read_b64_tr_b16 a[66:67], v106 offset:4096
  ds_read_b64_tr_b16 a[96:97], v107 offset:0
  ds_read_b64_tr_b16 a[98:99], v107 offset:4096
  ds_read_b64_tr_b16 a[128:129], v108 offset:0
  ds_read_b64_tr_b16 a[130:131], v108 offset:4096
  ds_read_b64_tr_b16 a[160:161], v109 offset:0
  ds_read_b64_tr_b16 a[162:163], v109 offset:4096
  ds_read_b64_tr_b16 a[192:193], v110 offset:0
  ds_read_b64_tr_b16 a[194:195], v110 offset:4096
  ds_read_b64_tr_b16 a[224:225], v111 offset:0
  ds_read_b64_tr_b16 a[226:227], v111 offset:4096
  s_waitcnt vmcnt(16)
  ds_read_b64_tr_b16 a[4:5], v104 offset:8192
  ds_read_b64_tr_b16 a[6:7], v104 offset:12288
  ds_read_b64_tr_b16 a[36:37], v105 offset:8192
  ds_read_b64_tr_b16 a[38:39], v105 offset:12288
  ds_read_b64_tr_b16 a[68:69], v106 offset:8192
  ds_read_b64_tr_b16 a[70:71], v106 offset:12288
  ds_read_b64_tr_b16 a[100:101], v107 offset:8192
  ds_read_b64_tr_b16 a[102:103], v107 offset:12288
  ds_read_b64_tr_b16 a[132:133], v108 offset:8192
  ds_read_b64_tr_b16 a[134:135], v108 offset:12288
  ds_read_b64_tr_b16 a[164:165], v109 offset:8192
  ds_read_b64_tr_b16 a[166:167], v109 offset:12288
  ds_read_b64_tr_b16 a[196:197], v110 offset:8192
  ds_read_b64_tr_b16 a[198:199], v110 offset:12288
  ds_read_b64_tr_b16 a[228:229], v111 offset:8192
  ds_read_b64_tr_b16 a[230:231], v111 offset:12288
  s_waitcnt vmcnt(8)
  ds_read_b64_tr_b16 a[8:9], v104 offset:16384
  ds_read_b64_tr_b16 a[10:11], v104 offset:20480
  ds_read_b64_tr_b16 a[40:41], v105 offset:16384
  ds_read_b64_tr_b16 a[42:43], v105 offset:20480
  ds_read_b64_tr_b16 a[72:73], v106 offset:16384
  ds_read_b64_tr_b16 a[74:75], v106 offset:20480
  ds_read_b64_tr_b16 a[104:105], v107 offset:16384
  ds_read_b64_tr_b16 a[106:107], v107 offset:20480
  ds_read_b64_tr_b16 a[136:137], v108 offset:16384
  ds_read_b64_tr_b16 a[138:139], v108 offset:20480
  ds_read_b64_tr_b16 a[168:169], v109 offset:16384
  ds_read_b64_tr_b16 a[170:171], v109 offset:20480
  ds_read_b64_tr_b16 a[200:201], v110 offset:16384
  ds_read_b64_tr_b16 a[202:203], v110 offset:20480
  ds_read_b64_tr_b16 a[232:233], v111 offset:16384
  ds_read_b64_tr_b16 a[234:235], v111 offset:20480
  s_waitcnt vmcnt(0)
  ds_read_b64_tr_b16 a[12:13], v104 offset:24576
  ds_read_b64_tr_b16 a[14:15], v104 offset:28672
  ds_read_b64_tr_b16 a[44:45], v105 offset:24576
  ds_read_b64_tr_b16 a[46:47], v105 offset:28672
  ds_read_b64_tr_b16 a[76:77], v106 offset:24576
  ds_read_b64_tr_b16 a[78:79], v106 offset:28672
  ds_read_b64_tr_b16 a[108:109], v107 offset:24576
  ds_read_b64_tr_b16 a[110:111], v107 offset:28672
  ds_read_b64_tr_b16 a[140:141], v108 offset:24576
  ds_read_b64_tr_b16 a[142:143], v108 offset:28672
  ds_read_b64_tr_b16 a[172:173], v109 offset:24576
  ds_read_b64_tr_b16 a[174:175], v109 offset:28672
  ds_read_b64_tr_b16 a[204:205], v110 offset:24576
  ds_read_b64_tr_b16 a[206:207], v110 offset:28672
  ds_read_b64_tr_b16 a[236:237], v111 offset:24576
  ds_read_b64_tr_b16 a[238:239], v111 offset:28672
  s_waitcnt lgkmcnt(0)
  s_add_u32 m0, s66, 0
  s_add_u32 s58, s60, 131072
  buffer_load_dwordx4 v88, s[48:51], s58 offen lds
  s_add_u32 m0, s66, 1024
  s_add_u32 s58, s60, 135168
  buffer_load_dwordx4 v89, s[48:51], s58 offen lds
  s_add_u32 m0, s66, 2048
  s_add_u32 s58, s60, 139264
  buffer_load_dwordx4 v88, s[48:51], s58 offen lds
  s_add_u32 m0, s66, 3072
  s_add_u32 s58, s60, 143360
  buffer_load_dwordx4 v89, s[48:51], s58 offen lds
  s_add_u32 m0, s66, 4096
  s_add_u32 s58, s60, 147456
  buffer_load_dwordx4 v88, s[48:51], s58 offen lds
  s_add_u32 m0, s66, 5120
  s_add_u32 s58, s60, 151552
  buffer_load_dwordx4 v89, s[48:51], s58 offen lds
  s_add_u32 m0, s66, 6144
  s_add_u32 s58, s60, 155648
  buffer_load_dwordx4 v88, s[48:51], s58 offen lds
  s_add_u32 m0, s66, 7168
  s_add_u32 s58, s60, 159744
  buffer_load_dwordx4 v89, s[48:51], s58 offen lds
  s_add_u32 m0, s66, 8192
  s_add_u32 s58, s60, 163840
  buffer_load_dwordx4 v88, s[48:51], s58 offen lds
  s_add_u32 m0, s66, 9216
  s_add_u32 s58, s60, 167936
  buffer_load_dwordx4 v89, s[48:51], s58 offen lds
  s_add_u32 m0, s66, 10240
  s_add_u32 s58, s60, 172032
  buffer_load_dwordx4 v88, s[48:51], s58 offen lds
  s_add_u32 m0, s66, 11264
  s_add_u32 s58, s60, 176128
  buffer_load_dwordx4 v89, s[48:51], s58 offen lds
  s_add_u32 m0, s66, 12288
  s_add_u32 s58, s60, 180224
  buffer_load_dwordx4 v88, s[48:51], s58 offen lds
  s_add_u32 m0, s66, 13312
  s_add_u32 s58, s60, 184320
  buffer_load_dwordx4 v89, s[48:51], s58 offen lds
  s_add_u32 m0, s66, 14336
  s_add_u32 s58, s60, 188416
  buffer_load_dwordx4 v88, s[48:51], s58 offen lds
  s_add_u32 m0, s66, 15360
  s_add_u32 s58, s60, 192512
  buffer_load_dwordx4 v89, s[48:51], s58 offen lds
  s_add_u32 m0, s66, 16384
  s_add_u32 s58, s60, 196608
  buffer_load_dwordx4 v88, s[48:51], s58 offen lds
  s_add_u32 m0, s66, 17408
  s_add_u32 s58, s60, 200704
  buffer_load_dwordx4 v89, s[48:51], s58 offen lds
  s_add_u32 m0, s66, 18432
  s_add_u32 s58, s60, 204800
  buffer_load_dwordx4 v88, s[48:51], s58 offen lds
  s_add_u32 m0, s66, 19456
  s_add_u32 s58, s60, 208896
  buffer_load_dwordx4 v89, s[48:51], s58 offen lds
  s_add_u32 m0, s66, 20480
  s_add_u32 s58, s60, 212992
  buffer_load_dwordx4 v88, s[48:51], s58 offen lds
  s_add_u32 m0, s66, 21504
  s_add_u32 s58, s60, 217088
  buffer_load_dwordx4 v89, s[48:51], s58 offen lds
  s_add_u32 m0, s66, 22528
  s_add_u32 s58, s60, 221184
  buffer_load_dwordx4 v88, s[48:51], s58 offen lds
  s_add_u32 m0, s66, 23552
  s_add_u32 s58, s60, 225280
  buffer_load_dwordx4 v89, s[48:51], s58 offen lds
  s_add_u32 m0, s66, 24576
  s_add_u32 s58, s60, 229376
  buffer_load_dwordx4 v88, s[48:51], s58 offen lds
  s_add_u32 m0, s66, 25600
  s_add_u32 s58, s60, 233472
  buffer_load_dwordx4 v89, s[48:51], s58 offen lds
  s_add_u32 m0, s66, 26624
  s_add_u32 s58, s60, 237568
  buffer_load_dwordx4 v88, s[48:51], s58 offen lds
  s_add_u32 m0, s66, 27648
  s_add_u32 s58, s60, 241664
  buffer_load_dwordx4 v89, s[48:51], s58 offen lds
  s_add_u32 m0, s66, 28672
  s_add_u32 s58, s60, 245760
  buffer_load_dwordx4 v88, s[48:51], s58 offen lds
  s_add_u32 m0, s66, 29696
  s_add_u32 s58, s60, 249856
  buffer_load_dwordx4 v89, s[48:51], s58 offen lds
  s_add_u32 m0, s66, 30720
  s_add_u32 s58, s60, 253952
  buffer_load_dwordx4 v88, s[48:51], s58 offen lds
  s_add_u32 m0, s66, 31744
  s_add_u32 s58, s60, 258048
  buffer_load_dwordx4 v89, s[48:51], s58 offen lds
  s_lshr_b32 s58, s44, 1
  s_lshl1_add_u32 s61, s56, s58
  s_and_b32 s59, s44, 1
  s_lshl_b32 s60, s44, 12
  s_add_u32 s60, s60, 131072
  v_bfe_u32 v6, v0, 3, 1
  v_lshl_add_u32 v8, v6, 8, s60
  v_lshl_add_u32 v8, v3, 6, v8
  v_and_b32 v6, 7, v0
  v_lshl_add_u32 v8, v6, 3, v8
  v_lshrrev_b32 v6, 5, v0
  v_lshl_add_u32 v9, v6, 8, s60
  v_and_b32 v6, 3, v0
  v_lshl_add_u32 v9, v6, 6, v9
  v_bfe_u32 v6, v0, 2, 3
  v_lshl_add_u32 v9, v6, 3, v9
  s_mul_i32 s60, s58, 24576
  v_add_u32 v12, s60, v2
  s_lshl_b32 s66, s59, 12
  s_lshl_b32 s67, s61, 19
  s_add_u32 s67, s67, s66
  s_add_u32 s67, s67, 0x3000000
  s_add_u32 s66, s66, s60
  s_lshl1_add_u32 s60, s59, s58
  s_lshl_b32 s60, s60, 12
  s_add_u32 s60, s60, 98304
  v_add_u32 v13, s60, v2
  v_add_u32 v14, 98304, v2
  s_lshl_b32 s60, s59, 4
  v_add_u32 v4, s60, v4
  v_lshlrev_b32 v31, 2, v4
  v_add_u32 v31, 0xd0c0000, v31
  v_lshlrev_b32 v3, 2, v3
  v_sub_u32 v4, v4, v3
  v_mov_b32 v6, 0xff800000
  s_lshl_b32 s68, s61, 7
  s_add_u32 s68, s68, 0xd084000
  s_lshl_b32 s69, s61, 12
  s_add_u32 s69, s69, 0xc020000
  s_lshl2_add_u32 s70, s56, s44
  s_lshl_b32 s70, s70, 12
  s_add_u32 s70, s70, 0x6080000
  s_cmp_eq_u32 s44, 0
  s_mov_b32 s72, 0x40000000
  s_cmov_b32 s72, 0xd087000
  v_cmp_gt_i32 vcc, 0, v4
  v_mov_b32 v16, 0x3f803f80
  s_nop 0
  v_cndmask_b32 v20, 0, v6, vcc
  v_cmp_gt_i32 vcc, 1, v4
  v_mov_b32 v17, 0x3f803f80
  s_nop 0
  v_cndmask_b32 v21, 0, v6, vcc
  v_cmp_gt_i32 vcc, 2, v4
  v_mov_b32 v18, 0x3f803f80
  s_nop 0
  v_cndmask_b32 v22, 0, v6, vcc
  v_cmp_gt_i32 vcc, 3, v4
  v_mov_b32 v19, 0x3f803f80
  s_nop 0
  v_cndmask_b32 v23, 0, v6, vcc
  v_cmp_gt_i32 vcc, 16, v4
  v_mov_b32 v16, 0x3f803f80
  s_nop 0
  v_cndmask_b32 v24, 0, v6, vcc
  v_cmp_gt_i32 vcc, 17, v4
  v_mov_b32 v17, 0x3f803f80
  s_nop 0
  v_cndmask_b32 v25, 0, v6, vcc
  v_cmp_gt_i32 vcc, 18, v4
  v_mov_b32 v18, 0x3f803f80
  s_nop 0
  v_cndmask_b32 v26, 0, v6, vcc
  v_cmp_gt_i32 vcc, 19, v4
  v_mov_b32 v19, 0x3f803f80
  s_nop 0
  v_cndmask_b32 v27, 0, v6, vcc
  v_mov_b32 v33, 0
  v_mov_b32 v34, 0
  s_waitcnt vmcnt(24)
  ds_read_b64_tr_b16 a[16:17], v104 offset:0
  ds_read_b64_tr_b16 a[18:19], v104 offset:4096
  ds_read_b64_tr_b16 a[48:49], v105 offset:0
  ds_read_b64_tr_b16 a[50:51], v105 offset:4096
  ds_read_b64_tr_b16 a[80:81], v106 offset:0
  ds_read_b64_tr_b16 a[82:83], v106 offset:4096
  ds_read_b64_tr_b16 a[112:113], v107 offset:0
  ds_read_b64_tr_b16 a[114:115], v107 offset:4096
  ds_read_b64_tr_b16 a[144:145], v108 offset:0
  ds_read_b64_tr_b16 a[146:147], v108 offset:4096
  ds_read_b64_tr_b16 a[176:177], v109 offset:0
  ds_read_b64_tr_b16 a[178:179], v109 offset:4096
  ds_read_b64_tr_b16 a[208:209], v110 offset:0
  ds_read_b64_tr_b16 a[210:211], v110 offset:4096
  ds_read_b64_tr_b16 a[240:241], v111 offset:0
  ds_read_b64_tr_b16 a[242:243], v111 offset:4096
  s_waitcnt vmcnt(16)
  ds_read_b64_tr_b16 a[20:21], v104 offset:8192
  ds_read_b64_tr_b16 a[22:23], v104 offset:12288
  ds_read_b64_tr_b16 a[52:53], v105 offset:8192
  ds_read_b64_tr_b16 a[54:55], v105 offset:12288
  ds_read_b64_tr_b16 a[84:85], v106 offset:8192
  ds_read_b64_tr_b16 a[86:87], v106 offset:12288
  ds_read_b64_tr_b16 a[116:117], v107 offset:8192
  ds_read_b64_tr_b16 a[118:119], v107 offset:12288
  ds_read_b64_tr_b16 a[148:149], v108 offset:8192
  ds_read_b64_tr_b16 a[150:151], v108 offset:12288
  ds_read_b64_tr_b16 a[180:181], v109 offset:8192
  ds_read_b64_tr_b16 a[182:183], v109 offset:12288
  ds_read_b64_tr_b16 a[212:213], v110 offset:8192
  ds_read_b64_tr_b16 a[214:215], v110 offset:12288
  ds_read_b64_tr_b16 a[244:245], v111 offset:8192
  ds_read_b64_tr_b16 a[246:247], v111 offset:12288
  s_waitcnt vmcnt(8)
  ds_read_b64_tr_b16 a[24:25], v104 offset:16384
  ds_read_b64_tr_b16 a[26:27], v104 offset:20480
  ds_read_b64_tr_b16 a[56:57], v105 offset:16384
  ds_read_b64_tr_b16 a[58:59], v105 offset:20480
  ds_read_b64_tr_b16 a[88:89], v106 offset:16384
  ds_read_b64_tr_b16 a[90:91], v106 offset:20480
  ds_read_b64_tr_b16 a[120:121], v107 offset:16384
  ds_read_b64_tr_b16 a[122:123], v107 offset:20480
  ds_read_b64_tr_b16 a[152:153], v108 offset:16384
  ds_read_b64_tr_b16 a[154:155], v108 offset:20480
  ds_read_b64_tr_b16 a[184:185], v109 offset:16384
  ds_read_b64_tr_b16 a[186:187], v109 offset:20480
  ds_read_b64_tr_b16 a[216:217], v110 offset:16384
  ds_read_b64_tr_b16 a[218:219], v110 offset:20480
  ds_read_b64_tr_b16 a[248:249], v111 offset:16384
  ds_read_b64_tr_b16 a[250:251], v111 offset:20480
  s_waitcnt vmcnt(0)
  ds_read_b64_tr_b16 a[28:29], v104 offset:24576
  ds_read_b64_tr_b16 a[30:31], v104 offset:28672
  ds_read_b64_tr_b16 a[60:61], v105 offset:24576
  ds_read_b64_tr_b16 a[62:63], v105 offset:28672
  ds_read_b64_tr_b16 a[92:93], v106 offset:24576
  ds_read_b64_tr_b16 a[94:95], v106 offset:28672
  ds_read_b64_tr_b16 a[124:125], v107 offset:24576
  ds_read_b64_tr_b16 a[126:127], v107 offset:28672
  ds_read_b64_tr_b16 a[156:157], v108 offset:24576
  ds_read_b64_tr_b16 a[158:159], v108 offset:28672
  ds_read_b64_tr_b16 a[188:189], v109 offset:24576
  ds_read_b64_tr_b16 a[190:191], v109 offset:28672
  ds_read_b64_tr_b16 a[220:221], v110 offset:24576
  ds_read_b64_tr_b16 a[222:223], v110 offset:28672
  ds_read_b64_tr_b16 a[252:253], v111 offset:24576
  ds_read_b64_tr_b16 a[254:255], v111 offset:28672
  s_waitcnt lgkmcnt(0)
  s_lshl_b32 s58, s61, 7
  s_add_u32 s58, s58, 0xd080040
  v_lshl_add_u32 v3, v0, 2, s58
  v_and_b32 v4, 7, v0
  v_lshlrev_b32 v4, 7, v4
  v_add_u32 v4, 0xd086400, v4
  v_cmp_gt_u32 vcc, 16, v0
  v_lshrrev_b32 v5, 3, v0
  v_min_u32 v5, 2, v5
  v_cndmask_b32 v3, v4, v3, vcc
  v_lshrrev_b32 v4, v5, 4
L_b_w0:
  buffer_load_dword v5, v3, s[40:43], 0 offen sc1
  s_add_u32 s57, s57, 1
  s_cmp_gt_u32 s57, 1048576
  s_cbranch_scc1 L_exit
  s_waitcnt vmcnt(0)
  v_cmp_ne_u32 vcc, v4, v5
  s_cbranch_vccnz L_b_w0
  v_readlane_b32 s63, v1, s95
  s_mov_b32 s62, 4
  s_mov_b32 s65, 0
  s_barrier
  s_bitcmp1_b32 s63, 2
  s_cbranch_scc1 L_b_nodma_1
  s_lshl_b32 s58, s63, 9
  s_add_u32 s58, s58, s67
  s_add_u32 m0, s66, 0
  s_add_u32 s59, s58, 0x0
  buffer_load_dwordx4 v2, s[40:43], s59 offen offset:0 sc1 lds
  buffer_load_dwordx4 v2, s[40:43], s59 offen offset:1024 sc1 lds
  buffer_load_dwordx4 v2, s[40:43], s59 offen offset:2048 sc1 lds
  buffer_load_dwordx4 v2, s[40:43], s59 offen offset:3072 sc1 lds
  s_add_u32 m0, s66, 8192
  s_add_u32 s59, s58, 0x1000000
  buffer_load_dwordx4 v2, s[40:43], s59 offen offset:0 sc1 lds
  buffer_load_dwordx4 v2, s[40:43], s59 offen offset:1024 sc1 lds
  buffer_load_dwordx4 v2, s[40:43], s59 offen offset:2048 sc1 lds
  buffer_load_dwordx4 v2, s[40:43], s59 offen offset:3072 sc1 lds
  s_add_u32 m0, s66, 16384
  s_add_u32 s59, s58, 0x2000000
  buffer_load_dwordx4 v2, s[40:43], s59 offen offset:0 sc1 lds
  buffer_load_dwordx4 v2, s[40:43], s59 offen offset:1024 sc1 lds
  buffer_load_dwordx4 v2, s[40:43], s59 offen offset:2048 sc1 lds
  buffer_load_dwordx4 v2, s[40:43], s59 offen offset:3072 sc1 lds
  s_lshl_b32 s58, s63, 3
  buffer_load_dword v11, v31, s[40:43], s58 offen sc1
L_b_nodma_1:
L_b_round:
  s_mov_b32 s64, s62
  s_mov_b32 s62, s63
  s_add_u32 s95, s95, 1
  v_readlane_b32 s63, v1, s95
  s_cmp_ge_u32 s66, 49152
  s_mov_b32 s60, 49152
  s_cmov_b32 s60, -49152
  s_add_u32 s66, s66, s60
  s_waitcnt vmcnt(0)
  s_barrier
  v_sub_f32 v10, 1.0, v11
  s_and_b32 s59, s44, 1
  s_lshl_b32 s59, s59, 10
  v_add_u32 v4, s59, v12
  ds_read_b128 v[88:91], v4 offset:0
  ds_read_b128 v[104:107], v12 offset:8192
  ds_read_b128 v[108:111], v12 offset:9216
  ds_read_b128 v[92:95], v4 offset:2048
  ds_read_b128 v[112:115], v12 offset:10240
  ds_read_b128 v[116:119], v12 offset:11264
  ds_read_b128 v[96:99], v4 offset:4096
  ds_read_b128 v[120:123], v12 offset:12288
  ds_read_b128 v[124:127], v12 offset:13312
  ds_read_b128 v[100:103], v4 offset:6144
  ds_read_b128 v[128:131], v12 offset:14336
  ds_read_b128 v[132:135], v12 offset:15360
  s_lshl_b32 s58, s64, 2
  s_add_u32 s58, s58, s72
  s_bitcmp1_b32 s64, 2
  s_cselect_b32 s58, 0x40000000, s58
  v_mov_b32 v3, 1
  s_mov_b64 exec, 1
  buffer_atomic_add v3, v7, s[40:43], s58 offen
  s_mov_b64 exec, -1
  s_cmp_eq_u32 s65, 0
  s_cbranch_scc1 L_b_late
L_b_have:
  ds_write2st64_b32 v8, v56, v57 offset0:0 offset1:8
  ds_write2st64_b32 v8, v60, v61 offset0:2 offset1:10
  ds_write2st64_b32 v8, v64, v65 offset0:4 offset1:12
  ds_write2st64_b32 v8, v68, v69 offset0:6 offset1:14
  s_waitcnt lgkmcnt(4)
  v_mfma_f32_16x16x32_bf16 v[40:43], v[104:107], v[88:91], v[20:23]
  ds_read_b64_tr_b16 v[72:73], v9 offset:0
  v_mfma_f32_16x16x32_bf16 v[44:47], v[108:111], v[88:91], v[24:27]
  ds_read_b64_tr_b16 v[74:75], v9 offset:2048
  v_mfma_f32_16x16x32_bf16 v[40:43], v[112:115], v[92:95], v[40:43]
  ds_read_b64_tr_b16 v[76:77], v9 offset:512
  v_mfma_f32_16x16x32_bf16 v[44:47], v[116:119], v[92:95], v[44:47]
  ds_read_b64_tr_b16 v[78:79], v9 offset:2560
  v_mfma_f32_16x16x32_bf16 v[40:43], v[120:123], v[96:99], v[40:43]
  ds_read_b64_tr_b16 v[80:81], v9 offset:1024
  v_mfma_f32_16x16x32_bf16 v[44:47], v[124:127], v[96:99], v[44:47]
  ds_read_b64_tr_b16 v[82:83], v9 offset:3072
  v_mfma_f32_16x16x32_bf16 v[40:43], v[128:131], v[100:103], v[40:43]
  ds_read_b64_tr_b16 v[84:85], v9 offset:1536
  v_mfma_f32_16x16x32_bf16 v[44:47], v[132:135], v[100:103], v[44:47]
  ds_read_b64_tr_b16 v[86:87], v9 offset:3584
  ds_read_b128 v[136:139], v12 offset:16384
  ds_read_b128 v[140:143], v12 offset:17408
  ds_read_b128 v[144:147], v12 offset:18432
  ds_read_b128 v[148:151], v12 offset:19456
  ds_read_b128 v[152:155], v12 offset:20480
  ds_read_b128 v[156:159], v12 offset:21504
  s_bitcmp1_b32 s63, 2
  s_cbranch_scc1 L_b_nodma_2
  s_lshl_b32 s58, s63, 9
  s_add_u32 s58, s58, s67
  s_add_u32 m0, s66, 0
  s_add_u32 s59, s58, 0x0
  buffer_load_dwordx4 v2, s[40:43], s59 offen offset:0 sc1 lds
  buffer_load_dwordx4 v2, s[40:43], s59 offen offset:1024 sc1 lds
  buffer_load_dwordx4 v2, s[40:43], s59 offen offset:2048 sc1 lds
  buffer_load_dwordx4 v2, s[40:43], s59 offen offset:3072 sc1 lds
  s_add_u32 m0, s66, 8192
  s_add_u32 s59, s58, 0x1000000
  buffer_load_dwordx4 v2, s[40:43], s59 offen offset:0 sc1 lds
  buffer_load_dwordx4 v2, s[40:43], s59 offen offset:1024 sc1 lds
  buffer_load_dwordx4 v2, s[40:43], s59 offen offset:2048 sc1 lds
  buffer_load_dwordx4 v2, s[40:43], s59 offen offset:3072 sc1 lds
  s_add_u32 m0, s66, 16384
  s_add_u32 s59, s58, 0x2000000
  buffer_load_dwordx4 v2, s[40:43], s59 offen offset:0 sc1 lds
  buffer_load_dwordx4 v2, s[40:43], s59 offen offset:1024 sc1 lds
  buffer_load_dwordx4 v2, s[40:43], s59 offen offset:2048 sc1 lds
  buffer_load_dwordx4 v2, s[40:43], s59 offen offset:3072 sc1 lds
  s_lshl_b32 s58, s63, 3
  buffer_load_dword v11, v31, s[40:43], s58 offen sc1
L_b_nodma_2:
  s_waitcnt lgkmcnt(6)
  v_mfma_f32_16x16x32_bf16 v[48:51], v[72:75], v[88:91], 0
  ds_read_b128 v[160:163], v12 offset:22528
  v_mfma_f32_16x16x32_bf16 v[48:51], v[76:79], v[92:95], v[48:51]
  ds_read_b128 v[164:167], v12 offset:23552
  v_mfma_f32_16x16x32_bf16 v[48:51], v[80:83], v[96:99], v[48:51]
  v_mfma_f32_16x16x32_bf16 v[48:51], v[84:87], v[100:103], v[48:51]
  v_add_u32 v12, s60, v12
  v_max_f32 v3, v40, v41
  v_max3_f32 v3, v3, v42, v43
  v_max3_f32 v3, v3, v44, v45
  v_max3_f32 v3, v3, v46, v47
  s_nop 2
  v_max3_f32 v3, v3, v48, v49
  v_mov_b32 v4, v3
  s_nop 1
  v_permlane32_swap_b32 v4, v3
  v_max_f32 v3, v3, v4
  v_mov_b32 v4, v3
  s_nop 1
  v_permlane16_swap_b32 v4, v3
  v_max_f32 v3, v3, v4
  v_sub_f32 v40, v40, v3
  v_sub_f32 v41, v41, v3
  v_sub_f32 v42, v42, v3
  v_sub_f32 v43, v43, v3
  v_sub_f32 v44, v44, v3
  v_sub_f32 v45, v45, v3
  v_sub_f32 v46, v46, v3
  v_sub_f32 v47, v47, v3
  v_sub_f32 v48, v48, v3
  v_sub_f32 v49, v49, v3
  v_exp_f32 v40, v40
  v_exp_f32 v41, v41
  v_exp_f32 v42, v42
  v_exp_f32 v43, v43
  v_exp_f32 v44, v44
  v_exp_f32 v45, v45
  v_exp_f32 v46, v46
  v_exp_f32 v47, v47
  v_exp_f32 v48, v48
  v_exp_f32 v49, v49
  v_cvt_pk_bf16_f32 v36, v40, v41
  v_cvt_pk_bf16_f32 v37, v42, v43
  v_cvt_pk_bf16_f32 v38, v44, v45
  v_cvt_pk_bf16_f32 v39, v46, v47
  v_cvt_pk_bf16_f32 v32, v48, v49
  v_cvt_pk_bf16_f32 v35, v48, v49
  s_waitcnt lgkmcnt(0)
  v_mfma_f32_16x16x32_bf16 v[52:55], v[16:19], v[36:39], 0
  v_mfma_f32_16x16x32_bf16 v[168:171], v[136:139], v[36:39], 0
  v_mfma_f32_16x16x32_bf16 v[172:175], v[140:143], v[36:39], 0
  v_mfma_f32_16x16x32_bf16 v[176:179], v[144:147], v[36:39], 0
  v_mfma_f32_16x16x32_bf16 v[180:183], v[148:151], v[36:39], 0
  v_mfma_f32_16x16x32_bf16 v[184:187], v[152:155], v[36:39], 0
  v_mfma_f32_16x16x32_bf16 v[188:191], v[156:159], v[36:39], 0
  v_mfma_f32_16x16x16_bf16 v[52:55], v[16:17], v[32:33], v[52:55]
  v_mfma_f32_16x16x32_bf16 v[192:195], v[160:163], v[36:39], 0
  v_mfma_f32_16x16x32_bf16 v[196:199], v[164:167], v[36:39], 0
  v_mfma_f32_16x16x16_bf16 v[168:171], v[58:59], v[32:33], v[168:171]
  v_mfma_f32_16x16x16_bf16 v[172:175], v[58:59], v[34:35], v[172:175]
  v_mfma_f32_16x16x16_bf16 v[176:179], v[62:63], v[32:33], v[176:179]
  v_mfma_f32_16x16x16_bf16 v[180:183], v[62:63], v[34:35], v[180:183]
  v_mfma_f32_16x16x16_bf16 v[184:187], v[66:67], v[32:33], v[184:187]
  v_mfma_f32_16x16x16_bf16 v[188:191], v[66:67], v[34:35], v[188:191]
  v_rcp_f32 v3, v52
  v_mfma_f32_16x16x16_bf16 v[192:195], v[70:71], v[32:33], v[192:195]
  v_mul_f32 v3, v3, v10
  v_mfma_f32_16x16x16_bf16 v[196:199], v[70:71], v[34:35], v[196:199]
  v_mul_f32 v168, v168, v3
  v_mul_f32 v169, v169, v3
  v_mul_f32 v170, v170, v3
  v_mul_f32 v171, v171, v3
  v_mul_f32 v172, v172, v3
  v_mul_f32 v173, v173, v3
  v_mul_f32 v174, v174, v3
  v_mul_f32 v175, v175, v3
  v_cvt_pk_bf16_f32 v232, v168, v169
  v_cvt_pk_bf16_f32 v233, v170, v171
  v_cvt_pk_bf16_f32 v234, v172, v173
  v_cvt_pk_bf16_f32 v235, v174, v175
  ds_write_b128 v13, v[232:235] offset:0
  v_mul_f32 v176, v176, v3
  v_mul_f32 v177, v177, v3
  v_mul_f32 v178, v178, v3
  v_mul_f32 v179, v179, v3
  v_mul_f32 v180, v180, v3
  v_mul_f32 v181, v181, v3
  v_mul_f32 v182, v182, v3
  v_mul_f32 v183, v183, v3
  v_cvt_pk_bf16_f32 v236, v176, v177
  v_cvt_pk_bf16_f32 v237, v178, v179
  v_cvt_pk_bf16_f32 v238, v180, v181
  v_cvt_pk_bf16_f32 v239, v182, v183
  ds_write_b128 v13, v[236:239] offset:1024
  v_mul_f32 v184, v184, v3
  v_mul_f32 v185, v185, v3
  v_mul_f32 v186, v186, v3
  v_mul_f32 v187, v187, v3
  v_mul_f32 v188, v188, v3
  v_mul_f32 v189, v189, v3
  v_mul_f32 v190, v190, v3
  v_mul_f32 v191, v191, v3
  v_cvt_pk_bf16_f32 v240, v184, v185
  v_cvt_pk_bf16_f32 v241, v186, v187
  v_cvt_pk_bf16_f32 v242, v188, v189
  v_cvt_pk_bf16_f32 v243, v190, v191
  ds_write_b128 v13, v[240:243] offset:2048
  v_mul_f32 v192, v192, v3
  v_mul_f32 v193, v193, v3
  v_mul_f32 v194, v194, v3
  v_mul_f32 v195, v195, v3
  v_mul_f32 v196, v196, v3
  v_mul_f32 v197, v197, v3
  v_mul_f32 v198, v198, v3
  v_mul_f32 v199, v199, v3
  v_cvt_pk_bf16_f32 v244, v192, v193
  v_cvt_pk_bf16_f32 v245, v194, v195
  v_cvt_pk_bf16_f32 v246, v196, v197
  v_cvt_pk_bf16_f32 v247, v198, v199
  ds_write_b128 v13, v[244:247] offset:3072
  buffer_load_dword v15, v7, s[40:43], s68 offen sc1
  v_xor_b32 v13, 0x4000, v13
  s_mul_i32 s71, s62, 98304
  s_add_u32 s71, s71, s70
  s_waitcnt lgkmcnt(0)
  s_barrier
  ds_read_b128 v[104:107], v14 offset:0
  ds_read_b128 v[108:111], v14 offset:1024
  ds_read_b128 v[112:115], v14 offset:2048
  ds_read_b128 v[116:119], v14 offset:3072
  ds_read_b128 v[120:123], v14 offset:4096
  ds_read_b128 v[124:127], v14 offset:5120
  ds_read_b128 v[128:131], v14 offset:6144
  ds_read_b128 v[132:135], v14 offset:7168
  s_waitcnt lgkmcnt(7)
  v_mfma_f32_16x16x32_bf16 v[200:203], a[0:3], v[104:107], 0
  s_waitcnt lgkmcnt(6)
  v_mfma_f32_16x16x32_bf16 v[200:203], a[4:7], v[108:111], v[200:203]
  s_waitcnt lgkmcnt(5)
  v_mfma_f32_16x16x32_bf16 v[200:203], a[8:11], v[112:115], v[200:203]
  s_waitcnt lgkmcnt(4)
  v_mfma_f32_16x16x32_bf16 v[200:203], a[12:15], v[116:119], v[200:203]
  s_waitcnt lgkmcnt(3)
  v_mfma_f32_16x16x32_bf16 v[200:203], a[16:19], v[120:123], v[200:203]
  s_waitcnt lgkmcnt(2)
  v_mfma_f32_16x16x32_bf16 v[200:203], a[20:23], v[124:127], v[200:203]
  s_waitcnt lgkmcnt(1)
  v_mfma_f32_16x16x32_bf16 v[200:203], a[24:27], v[128:131], v[200:203]
  s_waitcnt lgkmcnt(0)
  v_mfma_f32_16x16x32_bf16 v[200:203], a[28:31], v[132:135], v[200:203]
  v_mfma_f32_16x16x32_bf16 v[204:207], a[32:35], v[104:107], 0
  ds_read_b128 v[136:139], v14 offset:8192
  v_mfma_f32_16x16x32_bf16 v[204:207], a[36:39], v[108:111], v[204:207]
  ds_read_b128 v[140:143], v14 offset:9216
  v_mfma_f32_16x16x32_bf16 v[204:207], a[40:43], v[112:115], v[204:207]
  ds_read_b128 v[144:147], v14 offset:10240
  v_mfma_f32_16x16x32_bf16 v[204:207], a[44:47], v[116:119], v[204:207]
  ds_read_b128 v[148:151], v14 offset:11264
  v_mfma_f32_16x16x32_bf16 v[204:207], a[48:51], v[120:123], v[204:207]
  ds_read_b128 v[152:155], v14 offset:12288
  v_mfma_f32_16x16x32_bf16 v[204:207], a[52:55], v[124:127], v[204:207]
  ds_read_b128 v[156:159], v14 offset:13312
  v_mfma_f32_16x16x32_bf16 v[204:207], a[56:59], v[128:131], v[204:207]
  ds_read_b128 v[160:163], v14 offset:14336
  v_mfma_f32_16x16x32_bf16 v[204:207], a[60:63], v[132:135], v[204:207]
  ds_read_b128 v[164:167], v14 offset:15360
  v_mfma_f32_16x16x32_bf16 v[208:211], a[64:67], v[104:107], 0
  v_mfma_f32_16x16x32_bf16 v[208:211], a[68:71], v[108:111], v[208:211]
  v_mfma_f32_16x16x32_bf16 v[208:211], a[72:75], v[112:115], v[208:211]
  v_mfma_f32_16x16x32_bf16 v[208:211], a[76:79], v[116:119], v[208:211]
  v_mfma_f32_16x16x32_bf16 v[208:211], a[80:83], v[120:123], v[208:211]
  v_mfma_f32_16x16x32_bf16 v[208:211], a[84:87], v[124:127], v[208:211]
  v_mfma_f32_16x16x32_bf16 v[208:211], a[88:91], v[128:131], v[208:211]
  v_mfma_f32_16x16x32_bf16 v[208:211], a[92:95], v[132:135], v[208:211]
  v_cvt_pk_bf16_f32 v232, v200, v201
  v_cvt_pk_bf16_f32 v233, v202, v203
  v_mfma_f32_16x16x32_bf16 v[212:215], a[96:99], v[104:107], 0
  v_cvt_pk_bf16_f32 v234, v204, v205
  v_cvt_pk_bf16_f32 v235, v206, v207
  v_mfma_f32_16x16x32_bf16 v[212:215], a[100:103], v[108:111], v[212:215]
  buffer_store_dwordx4 v[232:235], v2, s[40:43], s71 offen offset:0 sc1
  v_mfma_f32_16x16x32_bf16 v[212:215], a[104:107], v[112:115], v[212:215]
  v_mfma_f32_16x16x32_bf16 v[212:215], a[108:111], v[116:119], v[212:215]
  v_mfma_f32_16x16x32_bf16 v[212:215], a[112:115], v[120:123], v[212:215]
  v_mfma_f32_16x16x32_bf16 v[212:215], a[116:119], v[124:127], v[212:215]
  v_mfma_f32_16x16x32_bf16 v[212:215], a[120:123], v[128:131], v[212:215]
  v_mfma_f32_16x16x32_bf16 v[212:215], a[124:127], v[132:135], v[212:215]
  v_mfma_f32_16x16x32_bf16 v[216:219], a[128:131], v[104:107], 0
  v_mfma_f32_16x16x32_bf16 v[216:219], a[132:135], v[108:111], v[216:219]
  v_mfma_f32_16x16x32_bf16 v[216:219], a[136:139], v[112:115], v[216:219]
  v_mfma_f32_16x16x32_bf16 v[216:219], a[140:143], v[116:119], v[216:219]
  v_mfma_f32_16x16x32_bf16 v[216:219], a[144:147], v[120:123], v[216:219]
  v_mfma_f32_16x16x32_bf16 v[216:219], a[148:151], v[124:127], v[216:219]
  v_mfma_f32_16x16x32_bf16 v[216:219], a[152:155], v[128:131], v[216:219]
  v_mfma_f32_16x16x32_bf16 v[216:219], a[156:159], v[132:135], v[216:219]
  v_cvt_pk_bf16_f32 v236, v208, v209
  v_cvt_pk_bf16_f32 v237, v210, v211
  v_mfma_f32_16x16x32_bf16 v[220:223], a[160:163], v[104:107], 0
  s_waitcnt lgkmcnt(0)
  v_xor_b32 v14, 0x4000, v14
  v_cvt_pk_bf16_f32 v238, v212, v213
  v_cvt_pk_bf16_f32 v239, v214, v215
  v_mfma_f32_16x16x32_bf16 v[220:223], a[164:167], v[108:111], v[220:223]
  buffer_store_dwordx4 v[236:239], v2, s[40:43], s71 offen offset:1024 sc1
  v_mfma_f32_16x16x32_bf16 v[220:223], a[168:171], v[112:115], v[220:223]
  v_mfma_f32_16x16x32_bf16 v[220:223], a[172:175], v[116:119], v[220:223]
  v_mfma_f32_16x16x32_bf16 v[220:223], a[176:179], v[120:123], v[220:223]
  v_mfma_f32_16x16x32_bf16 v[220:223], a[180:183], v[124:127], v[220:223]
  v_mfma_f32_16x16x32_bf16 v[220:223], a[184:187], v[128:131], v[220:223]
  v_mfma_f32_16x16x32_bf16 v[220:223], a[188:191], v[132:135], v[220:223]
  v_mfma_f32_16x16x32_bf16 v[224:227], a[192:195], v[104:107], 0
  v_mfma_f32_16x16x32_bf16 v[224:227], a[196:199], v[108:111], v[224:227]
  v_mfma_f32_16x16x32_bf16 v[224:227], a[200:203], v[112:115], v[224:227]
  v_mfma_f32_16x16x32_bf16 v[224:227], a[204:207], v[116:119], v[224:227]
  v_mfma_f32_16x16x32_bf16 v[224:227], a[208:211], v[120:123], v[224:227]
  v_mfma_f32_16x16x32_bf16 v[224:227], a[212:215], v[124:127], v[224:227]
  v_mfma_f32_16x16x32_bf16 v[224:227], a[216:219], v[128:131], v[224:227]
  v_mfma_f32_16x16x32_bf16 v[224:227], a[220:223], v[132:135], v[224:227]
  v_cvt_pk_bf16_f32 v240, v216, v217
  v_cvt_pk_bf16_f32 v241, v218, v219
  v_mfma_f32_16x16x32_bf16 v[228:231], a[224:227], v[104:107], 0
  v_cvt_pk_bf16_f32 v242, v220, v221
  v_cvt_pk_bf16_f32 v243, v222, v223
  v_mfma_f32_16x16x32_bf16 v[228:231], a[228:231], v[108:111], v[228:231]
  buffer_store_dwordx4 v[240:243], v2, s[40:43], s71 offen offset:2048 sc1
  v_mfma_f32_16x16x32_bf16 v[228:231], a[232:235], v[112:115], v[228:231]
  v_mfma_f32_16x16x32_bf16 v[228:231], a[236:239], v[116:119], v[228:231]
  v_mfma_f32_16x16x32_bf16 v[228:231], a[240:243], v[120:123], v[228:231]
  s_waitcnt vmcnt(3)
  s_lshr_b32 s59, s63, 4
  v_mfma_f32_16x16x32_bf16 v[228:231], a[244:247], v[124:127], v[228:231]
  v_cmp_lt_u32 vcc, s59, v15
  v_mfma_f32_16x16x32_bf16 v[228:231], a[248:251], v[128:131], v[228:231]
  v_mfma_f32_16x16x32_bf16 v[228:231], a[252:255], v[132:135], v[228:231]
  v_mfma_f32_16x16x32_bf16 v[200:203], a[0:3], v[136:139], 0
  s_mov_b32 s65, 0
  s_cbranch_vccz L_b_nofetch
  s_lshl_b32 s58, s63, 13
  s_add_u32 s58, s58, s69
  buffer_load_dwordx4 v[56:59], v2, s[40:43], s58 offen offset:0 sc1
  buffer_load_dwordx4 v[60:63], v2, s[40:43], s58 offen offset:1024 sc1
  buffer_load_dwordx4 v[64:67], v2, s[40:43], s58 offen offset:2048 sc1
  buffer_load_dwordx4 v[68:71], v2, s[40:43], s58 offen offset:3072 sc1
  s_mov_b32 s65, 1
L_b_nofetch:
  v_mfma_f32_16x16x32_bf16 v[200:203], a[4:7], v[140:143], v[200:203]
  v_mfma_f32_16x16x32_bf16 v[200:203], a[8:11], v[144:147], v[200:203]
  v_mfma_f32_16x16x32_bf16 v[200:203], a[12:15], v[148:151], v[200:203]
  v_mfma_f32_16x16x32_bf16 v[200:203], a[16:19], v[152:155], v[200:203]
  v_mfma_f32_16x16x32_bf16 v[200:203], a[20:23], v[156:159], v[200:203]
  v_mfma_f32_16x16x32_bf16 v[200:203], a[24:27], v[160:163], v[200:203]
  v_mfma_f32_16x16x32_bf16 v[200:203], a[28:31], v[164:167], v[200:203]
  v_cvt_pk_bf16_f32 v244, v224, v225
  v_cvt_pk_bf16_f32 v245, v226, v227
  v_mfma_f32_16x16x32_bf16 v[204:207], a[32:35], v[136:139], 0
  v_cvt_pk_bf16_f32 v246, v228, v229
  v_cvt_pk_bf16_f32 v247, v230, v231
  v_mfma_f32_16x16x32_bf16 v[204:207], a[36:39], v[140:143], v[204:207]
  buffer_store_dwordx4 v[244:247], v2, s[40:43], s71 offen offset:3072 sc1
  v_mfma_f32_16x16x32_bf16 v[204:207], a[40:43], v[144:147], v[204:207]
  v_mfma_f32_16x16x32_bf16 v[204:207], a[44:47], v[148:151], v[204:207]
  v_mfma_f32_16x16x32_bf16 v[204:207], a[48:51], v[152:155], v[204:207]
  v_mfma_f32_16x16x32_bf16 v[204:207], a[52:55], v[156:159], v[204:207]
  v_mfma_f32_16x16x32_bf16 v[204:207], a[56:59], v[160:163], v[204:207]
  v_mfma_f32_16x16x32_bf16 v[204:207], a[60:63], v[164:167], v[204:207]
  v_mfma_f32_16x16x32_bf16 v[208:211], a[64:67], v[136:139], 0
  v_mfma_f32_16x16x32_bf16 v[208:211], a[68:71], v[140:143], v[208:211]
  v_mfma_f32_16x16x32_bf16 v[208:211], a[72:75], v[144:147], v[208:211]
  v_mfma_f32_16x16x32_bf16 v[208:211], a[76:79], v[148:151], v[208:211]
  v_mfma_f32_16x16x32_bf16 v[208:211], a[80:83], v[152:155], v[208:211]
  v_mfma_f32_16x16x32_bf16 v[208:211], a[84:87], v[156:159], v[208:211]
  v_mfma_f32_16x16x32_bf16 v[208:211], a[88:91], v[160:163], v[208:211]
  s_add_u32 s71, s71, 786432
  v_mfma_f32_16x16x32_bf16 v[208:211], a[92:95], v[164:167], v[208:211]
  v_cvt_pk_bf16_f32 v232, v200, v201
  v_cvt_pk_bf16_f32 v233, v202, v203
  v_mfma_f32_16x16x32_bf16 v[212:215], a[96:99], v[136:139], 0
  v_cvt_pk_bf16_f32 v234, v204, v205
  v_cvt_pk_bf16_f32 v235, v206, v207
  v_mfma_f32_16x16x32_bf16 v[212:215], a[100:103], v[140:143], v[212:215]
  buffer_store_dwordx4 v[232:235], v2, s[40:43], s71 offen offset:0 sc1
  v_mfma_f32_16x16x32_bf16 v[212:215], a[104:107], v[144:147], v[212:215]
  v_mfma_f32_16x16x32_bf16 v[212:215], a[108:111], v[148:151], v[212:215]
  v_mfma_f32_16x16x32_bf16 v[212:215], a[112:115], v[152:155], v[212:215]
  v_mfma_f32_16x16x32_bf16 v[212:215], a[116:119], v[156:159], v[212:215]
  v_mfma_f32_16x16x32_bf16 v[212:215], a[120:123], v[160:163], v[212:215]
  v_mfma_f32_16x16x32_bf16 v[212:215], a[124:127], v[164:167], v[212:215]
  v_mfma_f32_16x16x32_bf16 v[216:219], a[128:131], v[136:139], 0
  v_mfma_f32_16x16x32_bf16 v[216:219], a[132:135], v[140:143], v[216:219]
  v_mfma_f32_16x16x32_bf16 v[216:219], a[136:139], v[144:147], v[216:219]
  v_mfma_f32_16x16x32_bf16 v[216:219], a[140:143], v[148:151], v[216:219]
  v_mfma_f32_16x16x32_bf16 v[216:219], a[144:147], v[152:155], v[216:219]
  v_mfma_f32_16x16x32_bf16 v[216:219], a[148:151], v[156:159], v[216:219]
  v_mfma_f32_16x16x32_bf16 v[216:219], a[152:155], v[160:163], v[216:219]
  v_mfma_f32_16x16x32_bf16 v[216:219], a[156:159], v[164:167], v[216:219]
  v_cvt_pk_bf16_f32 v236, v208, v209
  v_cvt_pk_bf16_f32 v237, v210, v211
  v_mfma_f32_16x16x32_bf16 v[220:223], a[160:163], v[136:139], 0
  v_cvt_pk_bf16_f32 v238, v212, v213
  v_cvt_pk_bf16_f32 v239, v214, v215
  v_mfma_f32_16x16x32_bf16 v[220:223], a[164:167], v[140:143], v[220:223]
  buffer_store_dwordx4 v[236:239], v2, s[40:43], s71 offen offset:1024 sc1
  v_mfma_f32_16x16x32_bf16 v[220:223], a[168:171], v[144:147], v[220:223]
  v_mfma_f32_16x16x32_bf16 v[220:223], a[172:175], v[148:151], v[220:223]
  v_mfma_f32_16x16x32_bf16 v[220:223], a[176:179], v[152:155], v[220:223]
  v_mfma_f32_16x16x32_bf16 v[220:223], a[180:183], v[156:159], v[220:223]
  v_mfma_f32_16x16x32_bf16 v[220:223], a[184:187], v[160:163], v[220:223]
  v_mfma_f32_16x16x32_bf16 v[220:223], a[188:191], v[164:167], v[220:223]
  v_mfma_f32_16x16x32_bf16 v[224:227], a[192:195], v[136:139], 0
  v_mfma_f32_16x16x32_bf16 v[224:227], a[196:199], v[140:143], v[224:227]
  v_mfma_f32_16x16x32_bf16 v[224:227], a[200:203], v[144:147], v[224:227]
  v_mfma_f32_16x16x32_bf16 v[224:227], a[204:207], v[148:151], v[224:227]
  v_mfma_f32_16x16x32_bf16 v[224:227], a[208:211], v[152:155], v[224:227]
  v_mfma_f32_16x16x32_bf16 v[224:227], a[212:215], v[156:159], v[224:227]
  v_mfma_f32_16x16x32_bf16 v[224:227], a[216:219], v[160:163], v[224:227]
  v_mfma_f32_16x16x32_bf16 v[224:227], a[220:223], v[164:167], v[224:227]
  v_cvt_pk_bf16_f32 v240, v216, v217
  v_cvt_pk_bf16_f32 v241, v218, v219
  v_mfma_f32_16x16x32_bf16 v[228:231], a[224:227], v[136:139], 0
  v_cvt_pk_bf16_f32 v242, v220, v221
  v_cvt_pk_bf16_f32 v243, v222, v223
  v_mfma_f32_16x16x32_bf16 v[228:231], a[228:231], v[140:143], v[228:231]
  buffer_store_dwordx4 v[240:243], v2, s[40:43], s71 offen offset:2048 sc1
  v_mfma_f32_16x16x32_bf16 v[228:231], a[232:235], v[144:147], v[228:231]
  v_mfma_f32_16x16x32_bf16 v[228:231], a[236:239], v[148:151], v[228:231]
  v_mfma_f32_16x16x32_bf16 v[228:231], a[240:243], v[152:155], v[228:231]
  v_mfma_f32_16x16x32_bf16 v[228:231], a[244:247], v[156:159], v[228:231]
  v_mfma_f32_16x16x32_bf16 v[228:231], a[248:251], v[160:163], v[228:231]
  v_mfma_f32_16x16x32_bf16 v[228:231], a[252:255], v[164:167], v[228:231]
  s_nop 7
  v_cvt_pk_bf16_f32 v244, v224, v225
  v_cvt_pk_bf16_f32 v245, v226, v227
  v_cvt_pk_bf16_f32 v246, v228, v229
  v_cvt_pk_bf16_f32 v247, v230, v231
  buffer_store_dwordx4 v[244:247], v2, s[40:43], s71 offen offset:3072 sc1
  s_bitcmp1_b32 s63, 2
  s_cbranch_scc0 L_b_round
  s_mov_b32 s64, s62
  s_waitcnt vmcnt(0)
  s_barrier
  s_lshl_b32 s58, s64, 2
  s_add_u32 s58, s58, s72
  s_bitcmp1_b32 s64, 2
  s_cselect_b32 s58, 0x40000000, s58
  v_mov_b32 v3, 1
  s_mov_b64 exec, 1
  buffer_atomic_add v3, v7, s[40:43], s58 offen
  s_mov_b64 exec, -1
  s_branch L_next
L_b_late:
  s_lshr_b32 s59, s62, 4
L_b_late2:
  buffer_load_dword v15, v7, s[40:43], s68 offen sc1
  s_add_u32 s57, s57, 1
  s_cmp_gt_u32 s57, 1048576
  s_cbranch_scc1 L_exit
  s_waitcnt vmcnt(0)
  v_cmp_lt_u32 vcc, s59, v15
  s_cbranch_vccz L_b_late2
  s_lshl_b32 s58, s62, 13
  s_add_u32 s58, s58, s69
  buffer_load_dwordx4 v[56:59], v2, s[40:43], s58 offen offset:0 sc1
  buffer_load_dwordx4 v[60:63], v2, s[40:43], s58 offen offset:1024 sc1
  buffer_load_dwordx4 v[64:67], v2, s[40:43], s58 offen offset:2048 sc1
  buffer_load_dwordx4 v[68:71], v2, s[40:43], s58 offen offset:3072 sc1
  s_waitcnt vmcnt(0)
  s_branch L_b_have
L_red:
  s_mov_b32 s48, s36
  s_and_b32 s49, s37, 0xffff
  s_mov_b32 s50, 0x200000
  s_mov_b32 s51, 0x20000
  v_lshlrev_b32 v2, 4, v0
  v_mov_b32 v7, 0
  s_mov_b32 s57, 0
  v_and_b32 v3, 4, v1
  v_cmp_ne_u32 vcc, 0, v3
  v_bfe_u32 v3, v1, 4, 6
  v_lshrrev_b32 v4, 3, v3
  s_lshr_b32 s58, vcc_lo, s95
  s_ff1_i32_b32 s58, s58
  s_bfm_b32 s58, s58, s95
  s_cmp_eq_u32 s62, 0
  s_cselect_b32 s59, s58, 0
  v_lshlrev_b32 v4, 7, v4
  v_add_u32 v4, 0xd086000, v4
  v_lshlrev_b32 v3, 6, v3
  v_add_u32 v3, 0xd087000, v3
  v_cmp_gt_u32 vcc, 32, v0
  v_and_b32 v5, 15, v0
  v_lshrrev_b32 v6, 4, v0
  v_cndmask_b32 v3, v3, v4, vcc
  v_cndmask_b32 v4, 16, 32, vcc
  buffer_load_dword v16, v3, s[40:43], 0 offen sc1
  v_lshlrev_b32 v24, 10, v5
  v_lshl_add_u32 v24, v6, 4, v24
  v_bfe_u32 v17, v0, 2, 1
  v_lshlrev_b32 v17, 1, v17
  v_sub_u32 v17, v6, v17
  v_bfe_u32 v18, v0, 3, 1
  v_bfe_u32 v19, v0, 1, 1
  v_lshl_add_u32 v18, v18, 1, v19
  v_lshl_add_u32 v17, v17, 2, v18
  v_and_b32 v18, 1, v0
  v_lshlrev_b32 v18, 4, v18
  v_mov_b32 v19, 0x3f80
  v_lshlrev_b32 v18, v18, v19
  v_cmp_eq_u32 vcc, 0, v17
  s_nop 1
  v_cndmask_b32 v8, 0, v18, vcc
  v_cmp_eq_u32 vcc, 1, v17
  s_nop 1
  v_cndmask_b32 v9, 0, v18, vcc
  v_cmp_eq_u32 vcc, 2, v17
  s_nop 1
  v_cndmask_b32 v10, 0, v18, vcc
  v_cmp_eq_u32 vcc, 3, v17
  s_nop 1
  v_cndmask_b32 v11, 0, v18, vcc
  v_cmp_eq_u32 vcc, 4, v17
  s_nop 1
  v_cndmask_b32 v12, 0, v18, vcc
  v_cmp_eq_u32 vcc, 5, v17
  s_nop 1
  v_cndmask_b32 v13, 0, v18, vcc
  v_cmp_eq_u32 vcc, 6, v17
  s_nop 1
  v_cndmask_b32 v14, 0, v18, vcc
  v_cmp_eq_u32 vcc, 7, v17
  s_nop 1
  v_cndmask_b32 v15, 0, v18, vcc
  v_readlane_b32 s63, v1, s95
L_r_wait:
  s_waitcnt vmcnt(0)
  v_cmp_gt_u32 vcc, v4, v16
  s_nop 0
  s_and_b64 vcc, vcc, s[58:59]
  s_cbranch_scc0 L_r_go
  buffer_load_dword v16, v3, s[40:43], 0 offen sc1
  s_add_u32 s57, s57, 1
  s_cmp_gt_u32 s57, 1048576
  s_cbranch_scc1 L_exit
  s_branch L_r_wait
L_r_go:
  s_bfe_u32 s58, s63, 0x60004
  s_bfe_u32 s59, s63, 0x1000e
  s_lshl1_add_u32 s58, s58, s59
  s_mul_i32 s64, s58, 786432
  s_bfe_u32 s59, s63, 0x2000c
  s_lshl2_add_u32 s59, s59, s44
  s_lshl_b32 s58, s58, 14
  s_lshl_b32 s71, s59, 6
  s_add_u32 s71, s71, s58
  s_lshl_b32 s59, s59, 10
  s_add_u32 s64, s64, s59
  s_add_u32 s64, s64, 0x6000000
  s_bitcmp1_b32 s63, 2
  s_cselect_b32 s64, 0x40000000, s64
  buffer_load_dwordx4 v[64:67], v2, s[40:43], s64 offen sc1
  s_add_u32 s64, s64, 0x4000
  buffer_load_dwordx4 v[68:71], v2, s[40:43], s64 offen sc1
  s_add_u32 s64, s64, 0x4000
  buffer_load_dwordx4 v[72:75], v2, s[40:43], s64 offen sc1
  s_add_u32 s64, s64, 0x4000
  buffer_load_dwordx4 v[76:79], v2, s[40:43], s64 offen sc1
  s_add_u32 s64, s64, 0x4000
  buffer_load_dwordx4 v[80:83], v2, s[40:43], s64 offen sc1
  s_add_u32 s64, s64, 0x4000
  buffer_load_dwordx4 v[84:87], v2, s[40:43], s64 offen sc1
  s_add_u32 s64, s64, 0x4000
  buffer_load_dwordx4 v[88:91], v2, s[40:43], s64 offen sc1
  s_add_u32 s64, s64, 0x4000
  buffer_load_dwordx4 v[92:95], v2, s[40:43], s64 offen sc1
  s_add_u32 s64, s64, 0x4000
  buffer_load_dwordx4 v[96:99], v2, s[40:43], s64 offen sc1
  s_add_u32 s64, s64, 0x4000
  buffer_load_dwordx4 v[100:103], v2, s[40:43], s64 offen sc1
  s_add_u32 s64, s64, 0x4000
  buffer_load_dwordx4 v[104:107], v2, s[40:43], s64 offen sc1
  s_add_u32 s64, s64, 0x4000
  buffer_load_dwordx4 v[108:111], v2, s[40:43], s64 offen sc1
  s_add_u32 s64, s64, 0x4000
  buffer_load_dwordx4 v[112:115], v2, s[40:43], s64 offen sc1
  s_add_u32 s64, s64, 0x4000
  buffer_load_dwordx4 v[116:119], v2, s[40:43], s64 offen sc1
  s_add_u32 s64, s64, 0x4000
  buffer_load_dwordx4 v[120:123], v2, s[40:43], s64 offen sc1
  s_add_u32 s64, s64, 0x4000
L_r_loop:
  s_mov_b32 s61, s63
  s_mov_b32 s65, s71
  s_add_u32 s95, s95, 1
  s_nop 0
  v_readlane_b32 s63, v1, s95
  buffer_load_dwordx4 v[124:127], v2, s[40:43], s64 offen sc1
  s_add_u32 s64, s64, 0x4000
  s_waitcnt vmcnt(15)
  v_mfma_f32_16x16x32_bf16 v[16:19], v[8:11], v[64:67], 0
  v_mfma_f32_16x16x32_bf16 v[20:23], v[12:15], v[64:67], 0
  buffer_load_dwordx4 v[64:67], v2, s[40:43], s64 offen sc1
  s_add_u32 s64, s64, 0x4000
  s_waitcnt vmcnt(15)
  v_mfma_f32_16x16x32_bf16 v[16:19], v[8:11], v[68:71], v[16:19]
  v_mfma_f32_16x16x32_bf16 v[20:23], v[12:15], v[68:71], v[20:23]
  buffer_load_dwordx4 v[68:71], v2, s[40:43], s64 offen sc1
  s_add_u32 s64, s64, 0x4000
  s_waitcnt vmcnt(15)
  v_mfma_f32_16x16x32_bf16 v[16:19], v[8:11], v[72:75], v[16:19]
  v_mfma_f32_16x16x32_bf16 v[20:23], v[12:15], v[72:75], v[20:23]
  buffer_load_dwordx4 v[72:75], v2, s[40:43], s64 offen sc1
  s_add_u32 s64, s64, 0x4000
  s_waitcnt vmcnt(15)
  v_mfma_f32_16x16x32_bf16 v[16:19], v[8:11], v[76:79], v[16:19]
  v_mfma_f32_16x16x32_bf16 v[20:23], v[12:15], v[76:79], v[20:23]
  buffer_load_dwordx4 v[76:79], v2, s[40:43], s64 offen sc1
  s_add_u32 s64, s64, 0x4000
  s_waitcnt vmcnt(15)
  v_mfma_f32_16x16x32_bf16 v[16:19], v[8:11], v[80:83], v[16:19]
  v_mfma_f32_16x16x32_bf16 v[20:23], v[12:15], v[80:83], v[20:23]
  buffer_load_dwordx4 v[80:83], v2, s[40:43], s64 offen sc1
  s_add_u32 s64, s64, 0x4000
  s_waitcnt vmcnt(15)
  v_mfma_f32_16x16x32_bf16 v[16:19], v[8:11], v[84:87], v[16:19]
  v_mfma_f32_16x16x32_bf16 v[20:23], v[12:15], v[84:87], v[20:23]
  buffer_load_dwordx4 v[84:87], v2, s[40:43], s64 offen sc1
  s_add_u32 s64, s64, 0x4000
  s_waitcnt vmcnt(15)
  v_mfma_f32_16x16x32_bf16 v[16:19], v[8:11], v[88:91], v[16:19]
  v_mfma_f32_16x16x32_bf16 v[20:23], v[12:15], v[88:91], v[20:23]
  buffer_load_dwordx4 v[88:91], v2, s[40:43], s64 offen sc1
  s_add_u32 s64, s64, 0x4000
  s_waitcnt vmcnt(15)
  v_mfma_f32_16x16x32_bf16 v[16:19], v[8:11], v[92:95], v[16:19]
  v_mfma_f32_16x16x32_bf16 v[20:23], v[12:15], v[92:95], v[20:23]
  buffer_load_dwordx4 v[92:95], v2, s[40:43], s64 offen sc1
  s_add_u32 s64, s64, 0x4000
  s_waitcnt vmcnt(15)
  v_mfma_f32_16x16x32_bf16 v[16:19], v[8:11], v[96:99], v[16:19]
  v_mfma_f32_16x16x32_bf16 v[20:23], v[12:15], v[96:99], v[20:23]
  buffer_load_dwordx4 v[96:99], v2, s[40:43], s64 offen sc1
  s_add_u32 s64, s64, 0x4000
  s_waitcnt vmcnt(15)
  v_mfma_f32_16x16x32_bf16 v[16:19], v[8:11], v[100:103], v[16:19]
  v_mfma_f32_16x16x32_bf16 v[20:23], v[12:15], v[100:103], v[20:23]
  buffer_load_dwordx4 v[100:103], v2, s[40:43], s64 offen sc1
  s_add_u32 s64, s64, 0x4000
  s_waitcnt vmcnt(15)
  v_mfma_f32_16x16x32_bf16 v[16:19], v[8:11], v[104:107], v[16:19]
  v_mfma_f32_16x16x32_bf16 v[20:23], v[12:15], v[104:107], v[20:23]
  buffer_load_dwordx4 v[104:107], v2, s[40:43], s64 offen sc1
  s_add_u32 s64, s64, 0x4000
  s_waitcnt vmcnt(15)
  v_mfma_f32_16x16x32_bf16 v[16:19], v[8:11], v[108:111], v[16:19]
  v_mfma_f32_16x16x32_bf16 v[20:23], v[12:15], v[108:111], v[20:23]
  buffer_load_dwordx4 v[108:111], v2, s[40:43], s64 offen sc1
  s_add_u32 s64, s64, 0x4000
  s_waitcnt vmcnt(15)
  v_mfma_f32_16x16x32_bf16 v[16:19], v[8:11], v[112:115], v[16:19]
  v_mfma_f32_16x16x32_bf16 v[20:23], v[12:15], v[112:115], v[20:23]
  buffer_load_dwordx4 v[112:115], v2, s[40:43], s64 offen sc1
  s_add_u32 s64, s64, 0x4000
  s_waitcnt vmcnt(15)
  v_mfma_f32_16x16x32_bf16 v[16:19], v[8:11], v[116:119], v[16:19]
  v_mfma_f32_16x16x32_bf16 v[20:23], v[12:15], v[116:119], v[20:23]
  buffer_load_dwordx4 v[116:119], v2, s[40:43], s64 offen sc1
  s_add_u32 s64, s64, 0x4000
  s_waitcnt vmcnt(15)
  v_mfma_f32_16x16x32_bf16 v[16:19], v[8:11], v[120:123], v[16:19]
  v_mfma_f32_16x16x32_bf16 v[20:23], v[12:15], v[120:123], v[20:23]
  buffer_load_dwordx4 v[120:123], v2, s[40:43], s64 offen sc1
  s_add_u32 s64, s64, 0x4000
  s_waitcnt vmcnt(15)
  v_mfma_f32_16x16x32_bf16 v[16:19], v[8:11], v[124:127], v[16:19]
  v_mfma_f32_16x16x32_bf16 v[20:23], v[12:15], v[124:127], v[20:23]
  buffer_load_dwordx4 v[124:127], v2, s[40:43], s64 offen sc1
  s_add_u32 s64, s64, 0x4000
  s_waitcnt vmcnt(15)
  v_mfma_f32_16x16x32_bf16 v[16:19], v[8:11], v[64:67], v[16:19]
  v_mfma_f32_16x16x32_bf16 v[20:23], v[12:15], v[64:67], v[20:23]
  s_cmp_lg_u32 s62, 0
  s_cbranch_scc1 L_r_stage
L_r_stageback:
  buffer_load_dwordx4 v[64:67], v2, s[40:43], s64 offen sc1
  s_add_u32 s64, s64, 0x4000
  s_waitcnt vmcnt(15)
  v_mfma_f32_16x16x32_bf16 v[16:19], v[8:11], v[68:71], v[16:19]
  v_mfma_f32_16x16x32_bf16 v[20:23], v[12:15], v[68:71], v[20:23]
  buffer_load_dwordx4 v[68:71], v2, s[40:43], s64 offen sc1
  s_add_u32 s64, s64, 0x4000
  s_waitcnt vmcnt(15)
  v_mfma_f32_16x16x32_bf16 v[16:19], v[8:11], v[72:75], v[16:19]
  v_mfma_f32_16x16x32_bf16 v[20:23], v[12:15], v[72:75], v[20:23]
  buffer_load_dwordx4 v[72:75], v2, s[40:43], s64 offen sc1
  s_add_u32 s64, s64, 0x4000
  s_waitcnt vmcnt(15)
  v_mfma_f32_16x16x32_bf16 v[16:19], v[8:11], v[76:79], v[16:19]
  v_mfma_f32_16x16x32_bf16 v[20:23], v[12:15], v[76:79], v[20:23]
  buffer_load_dwordx4 v[76:79], v2, s[40:43], s64 offen sc1
  s_add_u32 s64, s64, 0x4000
  s_waitcnt vmcnt(15)
  v_mfma_f32_16x16x32_bf16 v[16:19], v[8:11], v[80:83], v[16:19]
  v_mfma_f32_16x16x32_bf16 v[20:23], v[12:15], v[80:83], v[20:23]
  buffer_load_dwordx4 v[80:83], v2, s[40:43], s64 offen sc1
  s_add_u32 s64, s64, 0x4000
  s_waitcnt vmcnt(15)
  v_mfma_f32_16x16x32_bf16 v[16:19], v[8:11], v[84:87], v[16:19]
  v_mfma_f32_16x16x32_bf16 v[20:23], v[12:15], v[84:87], v[20:23]
  buffer_load_dwordx4 v[84:87], v2, s[40:43], s64 offen sc1
  s_add_u32 s64, s64, 0x4000
  s_waitcnt vmcnt(15)
  v_mfma_f32_16x16x32_bf16 v[16:19], v[8:11], v[88:91], v[16:19]
  v_mfma_f32_16x16x32_bf16 v[20:23], v[12:15], v[88:91], v[20:23]
  buffer_load_dwordx4 v[88:91], v2, s[40:43], s64 offen sc1
  s_add_u32 s64, s64, 0x4000
  s_waitcnt vmcnt(15)
  v_mfma_f32_16x16x32_bf16 v[16:19], v[8:11], v[92:95], v[16:19]
  v_mfma_f32_16x16x32_bf16 v[20:23], v[12:15], v[92:95], v[20:23]
  buffer_load_dwordx4 v[92:95], v2, s[40:43], s64 offen sc1
  s_add_u32 s64, s64, 0x4000
  s_waitcnt vmcnt(15)
  v_mfma_f32_16x16x32_bf16 v[16:19], v[8:11], v[96:99], v[16:19]
  v_mfma_f32_16x16x32_bf16 v[20:23], v[12:15], v[96:99], v[20:23]
  buffer_load_dwordx4 v[96:99], v2, s[40:43], s64 offen sc1
  s_add_u32 s64, s64, 0x4000
  s_waitcnt vmcnt(15)
  v_mfma_f32_16x16x32_bf16 v[16:19], v[8:11], v[100:103], v[16:19]
  v_mfma_f32_16x16x32_bf16 v[20:23], v[12:15], v[100:103], v[20:23]
  buffer_load_dwordx4 v[100:103], v2, s[40:43], s64 offen sc1
  s_add_u32 s64, s64, 0x4000
  s_waitcnt vmcnt(15)
  v_mfma_f32_16x16x32_bf16 v[16:19], v[8:11], v[104:107], v[16:19]
  v_mfma_f32_16x16x32_bf16 v[20:23], v[12:15], v[104:107], v[20:23]
  buffer_load_dwordx4 v[104:107], v2, s[40:43], s64 offen sc1
  s_add_u32 s64, s64, 0x4000
  s_waitcnt vmcnt(15)
  v_mfma_f32_16x16x32_bf16 v[16:19], v[8:11], v[108:111], v[16:19]
  v_mfma_f32_16x16x32_bf16 v[20:23], v[12:15], v[108:111], v[20:23]
  buffer_load_dwordx4 v[108:111], v2, s[40:43], s64 offen sc1
  s_add_u32 s64, s64, 0x4000
  s_waitcnt vmcnt(15)
  v_mfma_f32_16x16x32_bf16 v[16:19], v[8:11], v[112:115], v[16:19]
  v_mfma_f32_16x16x32_bf16 v[20:23], v[12:15], v[112:115], v[20:23]
  buffer_load_dwordx4 v[112:115], v2, s[40:43], s64 offen sc1
  s_add_u32 s64, s64, 0x4000
  s_waitcnt vmcnt(15)
  v_mfma_f32_16x16x32_bf16 v[16:19], v[8:11], v[116:119], v[16:19]
  v_mfma_f32_16x16x32_bf16 v[20:23], v[12:15], v[116:119], v[20:23]
  buffer_load_dwordx4 v[116:119], v2, s[40:43], s64 offen sc1
  s_add_u32 s64, s64, 0x4000
  s_waitcnt vmcnt(15)
  v_mfma_f32_16x16x32_bf16 v[16:19], v[8:11], v[120:123], v[16:19]
  v_mfma_f32_16x16x32_bf16 v[20:23], v[12:15], v[120:123], v[20:23]
  buffer_load_dwordx4 v[120:123], v2, s[40:43], s64 offen sc1
  s_add_u32 s64, s64, 0x4000
  s_waitcnt vmcnt(15)
  v_mfma_f32_16x16x32_bf16 v[16:19], v[8:11], v[124:127], v[16:19]
  v_mfma_f32_16x16x32_bf16 v[20:23], v[12:15], v[124:127], v[20:23]
  buffer_load_dwordx4 v[124:127], v2, s[40:43], s64 offen sc1
  s_add_u32 s64, s64, 0x4000
  s_waitcnt vmcnt(15)
  v_mfma_f32_16x16x32_bf16 v[16:19], v[8:11], v[64:67], v[16:19]
  v_mfma_f32_16x16x32_bf16 v[20:23], v[12:15], v[64:67], v[20:23]
  s_bfe_u32 s58, s63, 0x60004
  s_bfe_u32 s59, s63, 0x1000e
  s_lshl1_add_u32 s58, s58, s59
  s_mul_i32 s64, s58, 786432
  s_bfe_u32 s59, s63, 0x2000c
  s_lshl2_add_u32 s59, s59, s44
  s_lshl_b32 s58, s58, 14
  s_lshl_b32 s71, s59, 6
  s_add_u32 s71, s71, s58
  s_lshl_b32 s59, s59, 10
  s_add_u32 s64, s64, s59
  s_add_u32 s64, s64, 0x6000000
  s_bitcmp1_b32 s63, 2
  s_cselect_b32 s64, 0x40000000, s64
  buffer_load_dwordx4 v[64:67], v2, s[40:43], s64 offen sc1
  s_add_u32 s64, s64, 0x4000
  s_waitcnt vmcnt(15)
  v_mfma_f32_16x16x32_bf16 v[16:19], v[8:11], v[68:71], v[16:19]
  v_mfma_f32_16x16x32_bf16 v[20:23], v[12:15], v[68:71], v[20:23]
  buffer_load_dwordx4 v[68:71], v2, s[40:43], s64 offen sc1
  s_add_u32 s64, s64, 0x4000
  s_waitcnt vmcnt(15)
  v_mfma_f32_16x16x32_bf16 v[16:19], v[8:11], v[72:75], v[16:19]
  v_mfma_f32_16x16x32_bf16 v[20:23], v[12:15], v[72:75], v[20:23]
  buffer_load_dwordx4 v[72:75], v2, s[40:43], s64 offen sc1
  s_add_u32 s64, s64, 0x4000
  s_waitcnt vmcnt(15)
  v_mfma_f32_16x16x32_bf16 v[16:19], v[8:11], v[76:79], v[16:19]
  v_mfma_f32_16x16x32_bf16 v[20:23], v[12:15], v[76:79], v[20:23]
  buffer_load_dwordx4 v[76:79], v2, s[40:43], s64 offen sc1
  s_add_u32 s64, s64, 0x4000
  s_waitcnt vmcnt(15)
  v_mfma_f32_16x16x32_bf16 v[16:19], v[8:11], v[80:83], v[16:19]
  v_mfma_f32_16x16x32_bf16 v[20:23], v[12:15], v[80:83], v[20:23]
  buffer_load_dwordx4 v[80:83], v2, s[40:43], s64 offen sc1
  s_add_u32 s64, s64, 0x4000
  s_waitcnt vmcnt(15)
  v_mfma_f32_16x16x32_bf16 v[16:19], v[8:11], v[84:87], v[16:19]
  v_mfma_f32_16x16x32_bf16 v[20:23], v[12:15], v[84:87], v[20:23]
  buffer_load_dwordx4 v[84:87], v2, s[40:43], s64 offen sc1
  s_add_u32 s64, s64, 0x4000
  s_waitcnt vmcnt(15)
  v_mfma_f32_16x16x32_bf16 v[16:19], v[8:11], v[88:91], v[16:19]
  v_mfma_f32_16x16x32_bf16 v[20:23], v[12:15], v[88:91], v[20:23]
  buffer_load_dwordx4 v[88:91], v2, s[40:43], s64 offen sc1
  s_add_u32 s64, s64, 0x4000
  s_waitcnt vmcnt(15)
  v_mfma_f32_16x16x32_bf16 v[16:19], v[8:11], v[92:95], v[16:19]
  v_mfma_f32_16x16x32_bf16 v[20:23], v[12:15], v[92:95], v[20:23]
  buffer_load_dwordx4 v[92:95], v2, s[40:43], s64 offen sc1
  s_add_u32 s64, s64, 0x4000
  s_waitcnt vmcnt(15)
  v_mfma_f32_16x16x32_bf16 v[16:19], v[8:11], v[96:99], v[16:19]
  v_mfma_f32_16x16x32_bf16 v[20:23], v[12:15], v[96:99], v[20:23]
  buffer_load_dwordx4 v[96:99], v2, s[40:43], s64 offen sc1
  s_add_u32 s64, s64, 0x4000
  s_waitcnt vmcnt(15)
  v_mfma_f32_16x16x32_bf16 v[16:19], v[8:11], v[100:103], v[16:19]
  v_mfma_f32_16x16x32_bf16 v[20:23], v[12:15], v[100:103], v[20:23]
  buffer_load_dwordx4 v[100:103], v2, s[40:43], s64 offen sc1
  s_add_u32 s64, s64, 0x4000
  s_waitcnt vmcnt(15)
  v_mfma_f32_16x16x32_bf16 v[16:19], v[8:11], v[104:107], v[16:19]
  v_mfma_f32_16x16x32_bf16 v[20:23], v[12:15], v[104:107], v[20:23]
  buffer_load_dwordx4 v[104:107], v2, s[40:43], s64 offen sc1
  s_add_u32 s64, s64, 0x4000
  s_waitcnt vmcnt(15)
  v_mfma_f32_16x16x32_bf16 v[16:19], v[8:11], v[108:111], v[16:19]
  v_mfma_f32_16x16x32_bf16 v[20:23], v[12:15], v[108:111], v[20:23]
  buffer_load_dwordx4 v[108:111], v2, s[40:43], s64 offen sc1
  s_add_u32 s64, s64, 0x4000
  s_waitcnt vmcnt(15)
  v_mfma_f32_16x16x32_bf16 v[16:19], v[8:11], v[112:115], v[16:19]
  v_mfma_f32_16x16x32_bf16 v[20:23], v[12:15], v[112:115], v[20:23]
  buffer_load_dwordx4 v[112:115], v2, s[40:43], s64 offen sc1
  s_add_u32 s64, s64, 0x4000
  s_waitcnt vmcnt(15)
  v_mfma_f32_16x16x32_bf16 v[16:19], v[8:11], v[116:119], v[16:19]
  v_mfma_f32_16x16x32_bf16 v[20:23], v[12:15], v[116:119], v[20:23]
  buffer_load_dwordx4 v[116:119], v2, s[40:43], s64 offen sc1
  s_add_u32 s64, s64, 0x4000
  s_waitcnt vmcnt(15)
  v_mfma_f32_16x16x32_bf16 v[16:19], v[8:11], v[120:123], v[16:19]
  v_mfma_f32_16x16x32_bf16 v[20:23], v[12:15], v[120:123], v[20:23]
  buffer_load_dwordx4 v[120:123], v2, s[40:43], s64 offen sc1
  s_add_u32 s64, s64, 0x4000
  s_waitcnt vmcnt(15)
  v_mfma_f32_16x16x32_bf16 v[16:19], v[8:11], v[124:127], v[16:19]
  v_mfma_f32_16x16x32_bf16 v[20:23], v[12:15], v[124:127], v[20:23]
  s_nop 6
  v_cvt_pk_bf16_f32 v32, v16, v17
  v_cvt_pk_bf16_f32 v33, v18, v19
  v_cvt_pk_bf16_f32 v34, v20, v21
  v_cvt_pk_bf16_f32 v35, v22, v23
  buffer_store_dwordx4 v[32:35], v24, s[48:51], s65 offen
  s_bitcmp1_b32 s63, 2
  s_cbranch_scc0 L_r_loop
  s_waitcnt vmcnt(1)
  s_branch L_next
L_r_stage:
  s_bfe_u32 s66, s61, 0x60004
  s_lshl_b32 s66, s66, 6
  s_add_u32 s66, s66, 0xd087000
L_r_st2:
  buffer_load_dword v3, v7, s[40:43], s66 offen sc1
  s_add_u32 s57, s57, 1
  s_cmp_gt_u32 s57, 1048576
  s_cbranch_scc1 L_exit
  s_waitcnt vmcnt(0)
  v_cmp_gt_u32 vcc, 16, v3
  s_cbranch_vccnz L_r_st2
  s_branch L_r_stageback
L_after_p:
  s_waitcnt vmcnt(0)
  s_endpgm
L_team:
  s_mov_b32 s67, 0
  v_lshrrev_b32 v20, 4, v0
  v_and_b32 v21, 15, v0
  v_and_b32 v22, 1, v0
  v_cmp_eq_u32 vcc, 1, v22
  v_mov_b32 v23, 0x44444444
  v_mov_b32 v24, 0xeeeeeeee
  v_cndmask_b32 v1, v23, v24, vcc
  s_lshl_b32 s68, s44, 11
  s_add_u32 s68, s68, 131072
  v_lshl_add_u32 v2, v0, 4, s68
  v_add_u32 v11, 24576, v2
  s_mov_b32 s73, s68
  s_lshl_b32 s68, s44, 12
  v_lshl_add_u32 v3, v0, 4, s68
  s_lshl_b32 s68, s44, 9
  s_add_u32 s68, s68, 131072
  v_bfe_u32 v22, v0, 3, 1
  v_lshl_add_u32 v5, v22, 8, s68
  v_lshl_add_u32 v5, v20, 6, v5
  v_and_b32 v22, 7, v0
  v_lshl_add_u32 v5, v22, 3, v5
  v_lshrrev_b32 v22, 5, v0
  v_lshlrev_b32 v6, 8, v22
  v_and_b32 v22, 3, v0
  v_lshl_add_u32 v6, v22, 6, v6
  v_bfe_u32 v22, v0, 2, 3
  v_lshl_add_u32 v6, v22, 3, v6
  v_add_u32 v6, 131072, v6
  s_lshl_b32 s68, s44, 9
  s_add_u32 s68, s68, 131072
  v_lshrrev_b32 v22, 1, v0
  v_lshl_add_u32 v7, v22, 4, s68
  s_lshl_b32 s68, s44, 14
  s_lshl_b32 s69, s45, 6
  s_add_u32 s68, s68, s69
  v_lshrrev_b32 v22, 3, v0
  v_lshl_add_u32 v8, v22, 11, s68
  v_and_b32 v22, 7, v0
  v_lshl_add_u32 v8, v22, 3, v8
  v_lshlrev_b32 v9, 8, v20
  v_bfe_u32 v22, v0, 2, 1
  v_lshl_add_u32 v9, v22, 7, v9
  v_and_b32 v22, 1, v0
  v_lshl_add_u32 v9, v22, 6, v9
  v_bfe_u32 v22, v0, 3, 1
  v_lshl_add_u32 v9, v22, 5, v9
  v_bfe_u32 v22, v0, 1, 1
  v_lshl_add_u32 v9, v22, 4, v9
  s_lshl_b32 s68, s44, 16
  s_lshl_b32 s69, s45, 11
  s_add_u32 s68, s68, s69
  s_add_u32 s62, s68, 0xd000000
  v_bfe_u32 v22, v0, 3, 1
  v_lshlrev_b32 v10, 13, v22
  v_lshl_add_u32 v10, v20, 3, v10
  v_bfe_u32 v22, v0, 1, 1
  v_lshl_add_u32 v10, v22, 5, v10
  v_bfe_u32 v22, v0, 2, 1
  v_lshl_add_u32 v10, v22, 2, v10
  v_and_b32 v22, 1, v0
  v_lshl_add_u32 v10, v22, 1, v10
  s_lshl_b32 s64, s44, 11
  s_lshr_b32 s68, s45, 3
  s_lshl_b32 s68, s68, 9
  s_add_u32 s64, s64, s68
  s_and_b32 s68, s45, 1
  s_lshl_b32 s68, s68, 8
  s_add_u32 s64, s64, s68
  s_bfe_u32 s68, s45, 0x20001
  s_lshl_b32 s68, s68, 6
  s_add_u32 s64, s64, s68
  s_add_u32 s64, s64, 0xd040000
  s_mov_b32 s63, 0xd01c000
  s_lshl_b32 s92, s45, 7
  s_add_u32 s92, s92, 0xd080040
  s_lshl_b32 s72, s45, 19
  s_add_u32 s72, s72, 0x3fe0000
  s_mov_b32 s94, 0xaaaaaaaa
  s_mov_b32 s95, 0xaaaaaaaa
  v_mov_b32 v17, 0
  v_mov_b32 v18, 0
  v_mov_b32 v16, 0
  v_mov_b32 v12, 0x3f803f80
  v_mov_b32 v13, 0x3f803f80
  v_mov_b32 v14, 0x3f803f80
  v_mov_b32 v15, 0x3f803f80
  s_mov_b32 s78, 0xff00ff00
  s_mov_b32 s79, 0xff00ff00
  s_mov_b32 s88, 0x3e0293ee
  s_mov_b32 s89, 0x21800000
  s_mov_b32 s91, 0x3c000000
  s_mov_b32 s90, 0xfffe
  s_lshl_b32 s68, s44, 11
  s_add_u32 s70, s68, 147456
  s_add_u32 s71, s68, 139264
  s_lshl_b32 s68, s45, 7
  s_add_u32 s68, s68, 0xd084000
  s_cmp_eq_u32 s44, 0
  s_cselect_b32 s66, s68, 0x40000000
  s_mov_b32 s80, 0x3030303
  s_mov_b32 s81, 0x3030303
  s_mov_b32 s74, 0xd000000
  s_mov_b32 s82, 0xc0c0c0c
  s_mov_b32 s83, 0xc0c0c0c
  s_mov_b32 s75, 0xd010000
  s_mov_b32 s84, 0x30303030
  s_mov_b32 s85, 0x30303030
  s_mov_b32 s76, 0xd020000
  s_mov_b32 s86, 0xc0c0c0c0
  s_mov_b32 s87, 0xc0c0c0c0
  s_mov_b32 s77, 0xd030000
  buffer_store_dwordx2 v[16:17], v8, s[40:43], s74 offen sc1
  buffer_store_dwordx2 v[16:17], v8, s[40:43], s75 offen sc1
  buffer_store_dwordx2 v[16:17], v8, s[40:43], s76 offen sc1
  buffer_store_dwordx2 v[16:17], v8, s[40:43], s77 offen sc1
  v_mov_b32 v22, 0xffff
  buffer_store_short v22, v10, s[40:43], s64 offen sc1
  s_mul_i32 s68, s44, 4
  s_lshr_b32 s68, 0x7640, s68
  s_and_b32 s68, s68, 15
  s_lshl_b32 s68, s68, 12
  s_lshl_b32 s69, s45, 7
  s_add_u32 s68, s68, s69
  s_add_u32 s68, s68, 0xd080000
  v_and_b32 v23, 31, v0
  v_lshlrev_b32 v23, 2, v23
  buffer_store_dword v17, v23, s[40:43], s68 offen sc1
  s_mov_b32 s52, s38
  s_and_b32 s53, s39, 0xffff
  s_mov_b32 s54, 0x100
  s_mov_b32 s55, 0x20000
  s_lshl_b32 s68, 1, s46
  v_mov_b32 v22, s68
  s_cmp_eq_u32 s44, 0
  s_cselect_b32 s69, 0, 0x40000000
  s_mov_b64 exec, 1
  buffer_atomic_or v22, v17, s[52:55], s69 offen offset:128
  s_mov_b64 exec, -1
  v_bfe_u32 v22, v0, 4, 1
  v_lshrrev_b32 v23, 5, v0
  s_lshl_b32 s68, s44, 1
  v_or_b32 v24, s68, v22
  v_lshlrev_b32 v24, 1, v24
  v_xor_b32 v24, v24, v21
  v_lshlrev_b32 v24, 4, v24
  v_lshl_add_u32 v25, v22, 4, v23
  v_add_u32 v25, s68, v25
  v_lshl_add_u32 v26, v25, 13, v24
  s_lshl_b32 s69, s45, 8
  v_add_u32 v26, s69, v26
  s_lshl_b32 s68, s44, 4
  v_add_u32 v25, s68, v20
  v_lshl_add_u32 v27, v25, 10, v24
  s_lshl_b32 s69, s45, 17
  v_add_u32 v27, s69, v27
  v_lshrrev_b32 v22, 5, v0
  v_lshlrev_b32 v28, 12, v22
  v_bfe_u32 v22, v0, 3, 1
  v_lshl_add_u32 v28, v22, 11, v28
  v_lshlrev_b32 v24, 2, v22
  v_bfe_u32 v22, v0, 4, 1
  v_lshl_add_u32 v28, v22, 10, v28
  v_lshl_add_u32 v24, v22, 1, v24
  v_bfe_u32 v22, v0, 2, 1
  v_lshl_add_u32 v28, v22, 8, v28
  v_add_u32 v24, v24, v22
  s_lshl_b32 s68, s44, 1
  v_xor_b32 v24, s68, v24
  v_lshl_add_u32 v28, v24, 5, v28
  v_and_b32 v22, 3, v0
  v_lshl_add_u32 v28, v22, 3, v28
  v_xor_b32 v29, 32, v28
  v_bfe_u32 v22, v0, 3, 1
  v_mul_u32_u24 v22, 2208, v22
  v_xor_b32 v32, v22, v28
  v_xor_b32 v33, 2176, v32
  s_mov_b32 s50, 0x400000
  s_mov_b32 s51, 0x20000
  s_lshl_b32 s56, s44, 10
  s_mov_b32 s48, s24
  s_and_b32 s49, s25, 0xffff
  s_add_u32 m0, s56, 0
  s_mov_b32 s68, 0
  buffer_load_dwordx4 v26, s[48:51], s68 offen lds
  s_add_u32 m0, s56, 4096
  s_mov_b32 s68, 65536
  buffer_load_dwordx4 v26, s[48:51], s68 offen lds
  s_add_u32 m0, s56, 8192
  s_mov_b32 s68, 262144
  buffer_load_dwordx4 v26, s[48:51], s68 offen lds
  s_add_u32 m0, s56, 12288
  s_mov_b32 s68, 327680
  buffer_load_dwordx4 v26, s[48:51], s68 offen lds
  s_add_u32 m0, s56, 16384
  s_mov_b32 s68, 524288
  buffer_load_dwordx4 v26, s[48:51], s68 offen lds
  s_add_u32 m0, s56, 20480
  s_mov_b32 s68, 589824
  buffer_load_dwordx4 v26, s[48:51], s68 offen lds
  s_add_u32 m0, s56, 24576
  s_mov_b32 s68, 786432
  buffer_load_dwordx4 v26, s[48:51], s68 offen lds
  s_add_u32 m0, s56, 28672
  s_mov_b32 s68, 851968
  buffer_load_dwordx4 v26, s[48:51], s68 offen lds
  s_add_u32 m0, s56, 32768
  s_mov_b32 s68, 1048576
  buffer_load_dwordx4 v26, s[48:51], s68 offen lds
  s_add_u32 m0, s56, 36864
  s_mov_b32 s68, 1114112
  buffer_load_dwordx4 v26, s[48:51], s68 offen lds
  s_add_u32 m0, s56, 40960
  s_mov_b32 s68, 1310720
  buffer_load_dwordx4 v26, s[48:51], s68 offen lds
  s_add_u32 m0, s56, 45056
  s_mov_b32 s68, 1376256
  buffer_load_dwordx4 v26, s[48:51], s68 offen lds
  s_add_u32 m0, s56, 49152
  s_mov_b32 s68, 1572864
  buffer_load_dwordx4 v26, s[48:51], s68 offen lds
  s_add_u32 m0, s56, 53248
  s_mov_b32 s68, 1638400
  buffer_load_dwordx4 v26, s[48:51], s68 offen lds
  s_add_u32 m0, s56, 57344
  s_mov_b32 s68, 1835008
  buffer_load_dwordx4 v26, s[48:51], s68 offen lds
  s_add_u32 m0, s56, 61440
  s_mov_b32 s68, 1900544
  buffer_load_dwordx4 v26, s[48:51], s68 offen lds
  s_add_u32 m0, s56, 65536
  s_mov_b32 s68, 2097152
  buffer_load_dwordx4 v26, s[48:51], s68 offen lds
  s_add_u32 m0, s56, 69632
  s_mov_b32 s68, 2162688
  buffer_load_dwordx4 v26, s[48:51], s68 offen lds
  s_add_u32 m0, s56, 73728
  s_mov_b32 s68, 2359296
  buffer_load_dwordx4 v26, s[48:51], s68 offen lds
  s_add_u32 m0, s56, 77824
  s_mov_b32 s68, 2424832
  buffer_load_dwordx4 v26, s[48:51], s68 offen lds
  s_add_u32 m0, s56, 81920
  s_mov_b32 s68, 2621440
  buffer_load_dwordx4 v26, s[48:51], s68 offen lds
  s_add_u32 m0, s56, 86016
  s_mov_b32 s68, 2686976
  buffer_load_dwordx4 v26, s[48:51], s68 offen lds
  s_add_u32 m0, s56, 90112
  s_mov_b32 s68, 2883584
  buffer_load_dwordx4 v26, s[48:51], s68 offen lds
  s_add_u32 m0, s56, 94208
  s_mov_b32 s68, 2949120
  buffer_load_dwordx4 v26, s[48:51], s68 offen lds
  s_add_u32 m0, s56, 98304
  s_mov_b32 s68, 3145728
  buffer_load_dwordx4 v26, s[48:51], s68 offen lds
  s_add_u32 m0, s56, 102400
  s_mov_b32 s68, 3211264
  buffer_load_dwordx4 v26, s[48:51], s68 offen lds
  s_add_u32 m0, s56, 106496
  s_mov_b32 s68, 3407872
  buffer_load_dwordx4 v26, s[48:51], s68 offen lds
  s_add_u32 m0, s56, 110592
  s_mov_b32 s68, 3473408
  buffer_load_dwordx4 v26, s[48:51], s68 offen lds
  s_waitcnt vmcnt(24)
  s_barrier
  v_mov_b32 v22, 1
  s_cmp_eq_u32 s44, 0
  s_cselect_b32 s69, 0, 0x40000000
  s_mov_b64 exec, 1
  buffer_atomic_add v22, v17, s[52:55], s69 offen
  s_mov_b64 exec, -1
  s_add_u32 m0, s56, 114688
  s_mov_b32 s68, 3670016
  buffer_load_dwordx4 v26, s[48:51], s68 offen lds
  s_add_u32 m0, s56, 118784
  s_mov_b32 s68, 3735552
  buffer_load_dwordx4 v26, s[48:51], s68 offen lds
  s_add_u32 m0, s56, 122880
  s_mov_b32 s68, 3932160
  buffer_load_dwordx4 v26, s[48:51], s68 offen lds
  s_add_u32 m0, s56, 126976
  s_mov_b32 s68, 3997696
  buffer_load_dwordx4 v26, s[48:51], s68 offen lds
  v_add_u32 v30, 0, v28
  v_add_u32 v31, 0, v29
  s_cmp_lg_u32 s44, 0
  s_cbranch_scc1 L_wr_0_1
  ds_read_b64_tr_b16 a[0:1], v30 offset:0
  ds_read_b64_tr_b16 a[2:3], v30 offset:512
  ds_read_b64_tr_b16 a[4:5], v30 offset:8192
  ds_read_b64_tr_b16 a[6:7], v30 offset:8704
  ds_read_b64_tr_b16 a[64:65], v31 offset:0
  ds_read_b64_tr_b16 a[66:67], v31 offset:512
  ds_read_b64_tr_b16 a[68:69], v31 offset:8192
  ds_read_b64_tr_b16 a[70:71], v31 offset:8704
  s_branch L_wr_0_e
L_wr_0_1:
  s_cmp_lg_u32 s44, 1
  s_cbranch_scc1 L_wr_0_2
  ds_read_b64_tr_b16 a[16:17], v30 offset:0
  ds_read_b64_tr_b16 a[18:19], v30 offset:512
  ds_read_b64_tr_b16 a[20:21], v30 offset:8192
  ds_read_b64_tr_b16 a[22:23], v30 offset:8704
  ds_read_b64_tr_b16 a[80:81], v31 offset:0
  ds_read_b64_tr_b16 a[82:83], v31 offset:512
  ds_read_b64_tr_b16 a[84:85], v31 offset:8192
  ds_read_b64_tr_b16 a[86:87], v31 offset:8704
  s_branch L_wr_0_e
L_wr_0_2:
  s_cmp_lg_u32 s44, 2
  s_cbranch_scc1 L_wr_0_3
  ds_read_b64_tr_b16 a[32:33], v30 offset:0
  ds_read_b64_tr_b16 a[34:35], v30 offset:512
  ds_read_b64_tr_b16 a[36:37], v30 offset:8192
  ds_read_b64_tr_b16 a[38:39], v30 offset:8704
  ds_read_b64_tr_b16 a[96:97], v31 offset:0
  ds_read_b64_tr_b16 a[98:99], v31 offset:512
  ds_read_b64_tr_b16 a[100:101], v31 offset:8192
  ds_read_b64_tr_b16 a[102:103], v31 offset:8704
  s_branch L_wr_0_e
L_wr_0_3:
  ds_read_b64_tr_b16 a[48:49], v30 offset:0
  ds_read_b64_tr_b16 a[50:51], v30 offset:512
  ds_read_b64_tr_b16 a[52:53], v30 offset:8192
  ds_read_b64_tr_b16 a[54:55], v30 offset:8704
  ds_read_b64_tr_b16 a[112:113], v31 offset:0
  ds_read_b64_tr_b16 a[114:115], v31 offset:512
  ds_read_b64_tr_b16 a[116:117], v31 offset:8192
  ds_read_b64_tr_b16 a[118:119], v31 offset:8704
L_wr_0_e:
  s_waitcnt lgkmcnt(0)
  s_waitcnt vmcnt(24)
  s_barrier
  s_mov_b32 s48, s26
  s_and_b32 s49, s27, 0xffff
  s_add_u32 m0, s56, 0
  s_mov_b32 s68, 0
  buffer_load_dwordx4 v26, s[48:51], s68 offen lds
  s_add_u32 m0, s56, 4096
  s_mov_b32 s68, 65536
  buffer_load_dwordx4 v26, s[48:51], s68 offen lds
  s_add_u32 m0, s56, 8192
  s_mov_b32 s68, 262144
  buffer_load_dwordx4 v26, s[48:51], s68 offen lds
  s_add_u32 m0, s56, 12288
  s_mov_b32 s68, 327680
  buffer_load_dwordx4 v26, s[48:51], s68 offen lds
  v_add_u32 v30, 16384, v28
  v_add_u32 v31, 16384, v29
  s_cmp_lg_u32 s44, 0
  s_cbranch_scc1 L_wr_1_1
  ds_read_b64_tr_b16 a[8:9], v30 offset:0
  ds_read_b64_tr_b16 a[10:11], v30 offset:512
  ds_read_b64_tr_b16 a[12:13], v30 offset:8192
  ds_read_b64_tr_b16 a[14:15], v30 offset:8704
  ds_read_b64_tr_b16 a[72:73], v31 offset:0
  ds_read_b64_tr_b16 a[74:75], v31 offset:512
  ds_read_b64_tr_b16 a[76:77], v31 offset:8192
  ds_read_b64_tr_b16 a[78:79], v31 offset:8704
  s_branch L_wr_1_e
L_wr_1_1:
  s_cmp_lg_u32 s44, 1
  s_cbranch_scc1 L_wr_1_2
  ds_read_b64_tr_b16 a[24:25], v30 offset:0
  ds_read_b64_tr_b16 a[26:27], v30 offset:512
  ds_read_b64_tr_b16 a[28:29], v30 offset:8192
  ds_read_b64_tr_b16 a[30:31], v30 offset:8704
  ds_read_b64_tr_b16 a[88:89], v31 offset:0
  ds_read_b64_tr_b16 a[90:91], v31 offset:512
  ds_read_b64_tr_b16 a[92:93], v31 offset:8192
  ds_read_b64_tr_b16 a[94:95], v31 offset:8704
  s_branch L_wr_1_e
L_wr_1_2:
  s_cmp_lg_u32 s44, 2
  s_cbranch_scc1 L_wr_1_3
  ds_read_b64_tr_b16 a[40:41], v30 offset:0
  ds_read_b64_tr_b16 a[42:43], v30 offset:512
  ds_read_b64_tr_b16 a[44:45], v30 offset:8192
  ds_read_b64_tr_b16 a[46:47], v30 offset:8704
  ds_read_b64_tr_b16 a[104:105], v31 offset:0
  ds_read_b64_tr_b16 a[106:107], v31 offset:512
  ds_read_b64_tr_b16 a[108:109], v31 offset:8192
  ds_read_b64_tr_b16 a[110:111], v31 offset:8704
  s_branch L_wr_1_e
L_wr_1_3:
  ds_read_b64_tr_b16 a[56:57], v30 offset:0
  ds_read_b64_tr_b16 a[58:59], v30 offset:512
  ds_read_b64_tr_b16 a[60:61], v30 offset:8192
  ds_read_b64_tr_b16 a[62:63], v30 offset:8704
  ds_read_b64_tr_b16 a[120:121], v31 offset:0
  ds_read_b64_tr_b16 a[122:123], v31 offset:512
  ds_read_b64_tr_b16 a[124:125], v31 offset:8192
  ds_read_b64_tr_b16 a[126:127], v31 offset:8704
L_wr_1_e:
  s_waitcnt lgkmcnt(0)
  s_waitcnt vmcnt(24)
  s_barrier
  s_add_u32 m0, s56, 16384
  s_mov_b32 s68, 524288
  buffer_load_dwordx4 v26, s[48:51], s68 offen lds
  s_add_u32 m0, s56, 20480
  s_mov_b32 s68, 589824
  buffer_load_dwordx4 v26, s[48:51], s68 offen lds
  s_add_u32 m0, s56, 24576
  s_mov_b32 s68, 786432
  buffer_load_dwordx4 v26, s[48:51], s68 offen lds
  s_add_u32 m0, s56, 28672
  s_mov_b32 s68, 851968
  buffer_load_dwordx4 v26, s[48:51], s68 offen lds
  v_add_u32 v30, 32768, v28
  v_add_u32 v31, 32768, v29
  s_cmp_lg_u32 s44, 0
  s_cbranch_scc1 L_wr_2_1
  ds_read_b64_tr_b16 a[16:17], v30 offset:0
  ds_read_b64_tr_b16 a[18:19], v30 offset:512
  ds_read_b64_tr_b16 a[20:21], v30 offset:8192
  ds_read_b64_tr_b16 a[22:23], v30 offset:8704
  ds_read_b64_tr_b16 a[80:81], v31 offset:0
  ds_read_b64_tr_b16 a[82:83], v31 offset:512
  ds_read_b64_tr_b16 a[84:85], v31 offset:8192
  ds_read_b64_tr_b16 a[86:87], v31 offset:8704
  s_branch L_wr_2_e
L_wr_2_1:
  s_cmp_lg_u32 s44, 1
  s_cbranch_scc1 L_wr_2_2
  ds_read_b64_tr_b16 a[0:1], v30 offset:0
  ds_read_b64_tr_b16 a[2:3], v30 offset:512
  ds_read_b64_tr_b16 a[4:5], v30 offset:8192
  ds_read_b64_tr_b16 a[6:7], v30 offset:8704
  ds_read_b64_tr_b16 a[64:65], v31 offset:0
  ds_read_b64_tr_b16 a[66:67], v31 offset:512
  ds_read_b64_tr_b16 a[68:69], v31 offset:8192
  ds_read_b64_tr_b16 a[70:71], v31 offset:8704
  s_branch L_wr_2_e
L_wr_2_2:
  s_cmp_lg_u32 s44, 2
  s_cbranch_scc1 L_wr_2_3
  ds_read_b64_tr_b16 a[48:49], v30 offset:0
  ds_read_b64_tr_b16 a[50:51], v30 offset:512
  ds_read_b64_tr_b16 a[52:53], v30 offset:8192
  ds_read_b64_tr_b16 a[54:55], v30 offset:8704
  ds_read_b64_tr_b16 a[112:113], v31 offset:0
  ds_read_b64_tr_b16 a[114:115], v31 offset:512
  ds_read_b64_tr_b16 a[116:117], v31 offset:8192
  ds_read_b64_tr_b16 a[118:119], v31 offset:8704
  s_branch L_wr_2_e
L_wr_2_3:
  ds_read_b64_tr_b16 a[32:33], v30 offset:0
  ds_read_b64_tr_b16 a[34:35], v30 offset:512
  ds_read_b64_tr_b16 a[36:37], v30 offset:8192
  ds_read_b64_tr_b16 a[38:39], v30 offset:8704
  ds_read_b64_tr_b16 a[96:97], v31 offset:0
  ds_read_b64_tr_b16 a[98:99], v31 offset:512
  ds_read_b64_tr_b16 a[100:101], v31 offset:8192
  ds_read_b64_tr_b16 a[102:103], v31 offset:8704
L_wr_2_e:
  s_waitcnt lgkmcnt(0)
  s_waitcnt vmcnt(24)
  s_barrier
  s_add_u32 m0, s56, 32768
  s_mov_b32 s68, 1048576
  buffer_load_dwordx4 v26, s[48:51], s68 offen lds
  s_add_u32 m0, s56, 36864
  s_mov_b32 s68, 1114112
  buffer_load_dwordx4 v26, s[48:51], s68 offen lds
  s_add_u32 m0, s56, 40960
  s_mov_b32 s68, 1310720
  buffer_load_dwordx4 v26, s[48:51], s68 offen lds
  s_add_u32 m0, s56, 45056
  s_mov_b32 s68, 1376256
  buffer_load_dwordx4 v26, s[48:51], s68 offen lds
  v_add_u32 v30, 49152, v28
  v_add_u32 v31, 49152, v29
  s_cmp_lg_u32 s44, 0
  s_cbranch_scc1 L_wr_3_1
  ds_read_b64_tr_b16 a[24:25], v30 offset:0
  ds_read_b64_tr_b16 a[26:27], v30 offset:512
  ds_read_b64_tr_b16 a[28:29], v30 offset:8192
  ds_read_b64_tr_b16 a[30:31], v30 offset:8704
  ds_read_b64_tr_b16 a[88:89], v31 offset:0
  ds_read_b64_tr_b16 a[90:91], v31 offset:512
  ds_read_b64_tr_b16 a[92:93], v31 offset:8192
  ds_read_b64_tr_b16 a[94:95], v31 offset:8704
  s_branch L_wr_3_e
L_wr_3_1:
  s_cmp_lg_u32 s44, 1
  s_cbranch_scc1 L_wr_3_2
  ds_read_b64_tr_b16 a[8:9], v30 offset:0
  ds_read_b64_tr_b16 a[10:11], v30 offset:512
  ds_read_b64_tr_b16 a[12:13], v30 offset:8192
  ds_read_b64_tr_b16 a[14:15], v30 offset:8704
  ds_read_b64_tr_b16 a[72:73], v31 offset:0
  ds_read_b64_tr_b16 a[74:75], v31 offset:512
  ds_read_b64_tr_b16 a[76:77], v31 offset:8192
  ds_read_b64_tr_b16 a[78:79], v31 offset:8704
  s_branch L_wr_3_e
L_wr_3_2:
  s_cmp_lg_u32 s44, 2
  s_cbranch_scc1 L_wr_3_3
  ds_read_b64_tr_b16 a[56:57], v30 offset:0
  ds_read_b64_tr_b16 a[58:59], v30 offset:512
  ds_read_b64_tr_b16 a[60:61], v30 offset:8192
  ds_read_b64_tr_b16 a[62:63], v30 offset:8704
  ds_read_b64_tr_b16 a[120:121], v31 offset:0
  ds_read_b64_tr_b16 a[122:123], v31 offset:512
  ds_read_b64_tr_b16 a[124:125], v31 offset:8192
  ds_read_b64_tr_b16 a[126:127], v31 offset:8704
  s_branch L_wr_3_e
L_wr_3_3:
  ds_read_b64_tr_b16 a[40:41], v30 offset:0
  ds_read_b64_tr_b16 a[42:43], v30 offset:512
  ds_read_b64_tr_b16 a[44:45], v30 offset:8192
  ds_read_b64_tr_b16 a[46:47], v30 offset:8704
  ds_read_b64_tr_b16 a[104:105], v31 offset:0
  ds_read_b64_tr_b16 a[106:107], v31 offset:512
  ds_read_b64_tr_b16 a[108:109], v31 offset:8192
  ds_read_b64_tr_b16 a[110:111], v31 offset:8704
L_wr_3_e:
  s_waitcnt lgkmcnt(0)
  s_waitcnt vmcnt(24)
  s_barrier
  s_add_u32 m0, s56, 49152
  s_mov_b32 s68, 1572864
  buffer_load_dwordx4 v26, s[48:51], s68 offen lds
  s_add_u32 m0, s56, 53248
  s_mov_b32 s68, 1638400
  buffer_load_dwordx4 v26, s[48:51], s68 offen lds
  s_add_u32 m0, s56, 57344
  s_mov_b32 s68, 1835008
  buffer_load_dwordx4 v26, s[48:51], s68 offen lds
  s_add_u32 m0, s56, 61440
  s_mov_b32 s68, 1900544
  buffer_load_dwordx4 v26, s[48:51], s68 offen lds
  v_add_u32 v30, 65536, v28
  v_add_u32 v31, 65536, v29
  s_cmp_lg_u32 s44, 0
  s_cbranch_scc1 L_wr_4_1
  ds_read_b64_tr_b16 a[32:33], v30 offset:0
  ds_read_b64_tr_b16 a[34:35], v30 offset:512
  ds_read_b64_tr_b16 a[36:37], v30 offset:8192
  ds_read_b64_tr_b16 a[38:39], v30 offset:8704
  ds_read_b64_tr_b16 a[96:97], v31 offset:0
  ds_read_b64_tr_b16 a[98:99], v31 offset:512
  ds_read_b64_tr_b16 a[100:101], v31 offset:8192
  ds_read_b64_tr_b16 a[102:103], v31 offset:8704
  s_branch L_wr_4_e
L_wr_4_1:
  s_cmp_lg_u32 s44, 1
  s_cbranch_scc1 L_wr_4_2
  ds_read_b64_tr_b16 a[48:49], v30 offset:0
  ds_read_b64_tr_b16 a[50:51], v30 offset:512
  ds_read_b64_tr_b16 a[52:53], v30 offset:8192
  ds_read_b64_tr_b16 a[54:55], v30 offset:8704
  ds_read_b64_tr_b16 a[112:113], v31 offset:0
  ds_read_b64_tr_b16 a[114:115], v31 offset:512
  ds_read_b64_tr_b16 a[116:117], v31 offset:8192
  ds_read_b64_tr_b16 a[118:119], v31 offset:8704
  s_branch L_wr_4_e
L_wr_4_2:
  s_cmp_lg_u32 s44, 2
  s_cbranch_scc1 L_wr_4_3
  ds_read_b64_tr_b16 a[0:1], v30 offset:0
  ds_read_b64_tr_b16 a[2:3], v30 offset:512
  ds_read_b64_tr_b16 a[4:5], v30 offset:8192
  ds_read_b64_tr_b16 a[6:7], v30 offset:8704
  ds_read_b64_tr_b16 a[64:65], v31 offset:0
  ds_read_b64_tr_b16 a[66:67], v31 offset:512
  ds_read_b64_tr_b16 a[68:69], v31 offset:8192
  ds_read_b64_tr_b16 a[70:71], v31 offset:8704
  s_branch L_wr_4_e
L_wr_4_3:
  ds_read_b64_tr_b16 a[16:17], v30 offset:0
  ds_read_b64_tr_b16 a[18:19], v30 offset:512
  ds_read_b64_tr_b16 a[20:21], v30 offset:8192
  ds_read_b64_tr_b16 a[22:23], v30 offset:8704
  ds_read_b64_tr_b16 a[80:81], v31 offset:0
  ds_read_b64_tr_b16 a[82:83], v31 offset:512
  ds_read_b64_tr_b16 a[84:85], v31 offset:8192
  ds_read_b64_tr_b16 a[86:87], v31 offset:8704
L_wr_4_e:
  s_waitcnt lgkmcnt(0)
  s_waitcnt vmcnt(24)
  s_barrier
  s_add_u32 m0, s56, 65536
  s_mov_b32 s68, 2097152
  buffer_load_dwordx4 v26, s[48:51], s68 offen lds
  s_add_u32 m0, s56, 69632
  s_mov_b32 s68, 2162688
  buffer_load_dwordx4 v26, s[48:51], s68 offen lds
  s_add_u32 m0, s56, 73728
  s_mov_b32 s68, 2359296
  buffer_load_dwordx4 v26, s[48:51], s68 offen lds
  s_add_u32 m0, s56, 77824
  s_mov_b32 s68, 2424832
  buffer_load_dwordx4 v26, s[48:51], s68 offen lds
  v_add_u32 v30, 81920, v28
  v_add_u32 v31, 81920, v29
  s_cmp_lg_u32 s44, 0
  s_cbranch_scc1 L_wr_5_1
  ds_read_b64_tr_b16 a[40:41], v30 offset:0
  ds_read_b64_tr_b16 a[42:43], v30 offset:512
  ds_read_b64_tr_b16 a[44:45], v30 offset:8192
  ds_read_b64_tr_b16 a[46:47], v30 offset:8704
  ds_read_b64_tr_b16 a[104:105], v31 offset:0
  ds_read_b64_tr_b16 a[106:107], v31 offset:512
  ds_read_b64_tr_b16 a[108:109], v31 offset:8192
  ds_read_b64_tr_b16 a[110:111], v31 offset:8704
  s_branch L_wr_5_e
L_wr_5_1:
  s_cmp_lg_u32 s44, 1
  s_cbranch_scc1 L_wr_5_2
  ds_read_b64_tr_b16 a[56:57], v30 offset:0
  ds_read_b64_tr_b16 a[58:59], v30 offset:512
  ds_read_b64_tr_b16 a[60:61], v30 offset:8192
  ds_read_b64_tr_b16 a[62:63], v30 offset:8704
  ds_read_b64_tr_b16 a[120:121], v31 offset:0
  ds_read_b64_tr_b16 a[122:123], v31 offset:512
  ds_read_b64_tr_b16 a[124:125], v31 offset:8192
  ds_read_b64_tr_b16 a[126:127], v31 offset:8704
  s_branch L_wr_5_e
L_wr_5_2:
  s_cmp_lg_u32 s44, 2
  s_cbranch_scc1 L_wr_5_3
  ds_read_b64_tr_b16 a[8:9], v30 offset:0
  ds_read_b64_tr_b16 a[10:11], v30 offset:512
  ds_read_b64_tr_b16 a[12:13], v30 offset:8192
  ds_read_b64_tr_b16 a[14:15], v30 offset:8704
  ds_read_b64_tr_b16 a[72:73], v31 offset:0
  ds_read_b64_tr_b16 a[74:75], v31 offset:512
  ds_read_b64_tr_b16 a[76:77], v31 offset:8192
  ds_read_b64_tr_b16 a[78:79], v31 offset:8704
  s_branch L_wr_5_e
L_wr_5_3:
  ds_read_b64_tr_b16 a[24:25], v30 offset:0
  ds_read_b64_tr_b16 a[26:27], v30 offset:512
  ds_read_b64_tr_b16 a[28:29], v30 offset:8192
  ds_read_b64_tr_b16 a[30:31], v30 offset:8704
  ds_read_b64_tr_b16 a[88:89], v31 offset:0
  ds_read_b64_tr_b16 a[90:91], v31 offset:512
  ds_read_b64_tr_b16 a[92:93], v31 offset:8192
  ds_read_b64_tr_b16 a[94:95], v31 offset:8704
L_wr_5_e:
  s_waitcnt lgkmcnt(0)
  s_waitcnt vmcnt(24)
  s_barrier
  s_add_u32 m0, s56, 81920
  s_mov_b32 s68, 2621440
  buffer_load_dwordx4 v26, s[48:51], s68 offen lds
  s_add_u32 m0, s56, 86016
  s_mov_b32 s68, 2686976
  buffer_load_dwordx4 v26, s[48:51], s68 offen lds
  s_add_u32 m0, s56, 90112
  s_mov_b32 s68, 2883584
  buffer_load_dwordx4 v26, s[48:51], s68 offen lds
  s_add_u32 m0, s56, 94208
  s_mov_b32 s68, 2949120
  buffer_load_dwordx4 v26, s[48:51], s68 offen lds
  v_add_u32 v30, 98304, v28
  v_add_u32 v31, 98304, v29
  s_cmp_lg_u32 s44, 0
  s_cbranch_scc1 L_wr_6_1
  ds_read_b64_tr_b16 a[48:49], v30 offset:0
  ds_read_b64_tr_b16 a[50:51], v30 offset:512
  ds_read_b64_tr_b16 a[52:53], v30 offset:8192
  ds_read_b64_tr_b16 a[54:55], v30 offset:8704
  ds_read_b64_tr_b16 a[112:113], v31 offset:0
  ds_read_b64_tr_b16 a[114:115], v31 offset:512
  ds_read_b64_tr_b16 a[116:117], v31 offset:8192
  ds_read_b64_tr_b16 a[118:119], v31 offset:8704
  s_branch L_wr_6_e
L_wr_6_1:
  s_cmp_lg_u32 s44, 1
  s_cbranch_scc1 L_wr_6_2
  ds_read_b64_tr_b16 a[32:33], v30 offset:0
  ds_read_b64_tr_b16 a[34:35], v30 offset:512
  ds_read_b64_tr_b16 a[36:37], v30 offset:8192
  ds_read_b64_tr_b16 a[38:39], v30 offset:8704
  ds_read_b64_tr_b16 a[96:97], v31 offset:0
  ds_read_b64_tr_b16 a[98:99], v31 offset:512
  ds_read_b64_tr_b16 a[100:101], v31 offset:8192
  ds_read_b64_tr_b16 a[102:103], v31 offset:8704
  s_branch L_wr_6_e
L_wr_6_2:
  s_cmp_lg_u32 s44, 2
  s_cbranch_scc1 L_wr_6_3
  ds_read_b64_tr_b16 a[16:17], v30 offset:0
  ds_read_b64_tr_b16 a[18:19], v30 offset:512
  ds_read_b64_tr_b16 a[20:21], v30 offset:8192
  ds_read_b64_tr_b16 a[22:23], v30 offset:8704
  ds_read_b64_tr_b16 a[80:81], v31 offset:0
  ds_read_b64_tr_b16 a[82:83], v31 offset:512
  ds_read_b64_tr_b16 a[84:85], v31 offset:8192
  ds_read_b64_tr_b16 a[86:87], v31 offset:8704
  s_branch L_wr_6_e
L_wr_6_3:
  ds_read_b64_tr_b16 a[0:1], v30 offset:0
  ds_read_b64_tr_b16 a[2:3], v30 offset:512
  ds_read_b64_tr_b16 a[4:5], v30 offset:8192
  ds_read_b64_tr_b16 a[6:7], v30 offset:8704
  ds_read_b64_tr_b16 a[64:65], v31 offset:0
  ds_read_b64_tr_b16 a[66:67], v31 offset:512
  ds_read_b64_tr_b16 a[68:69], v31 offset:8192
  ds_read_b64_tr_b16 a[70:71], v31 offset:8704
L_wr_6_e:
  s_waitcnt lgkmcnt(0)
  s_waitcnt vmcnt(24)
  s_barrier
  s_add_u32 m0, s56, 98304
  s_mov_b32 s68, 3145728
  buffer_load_dwordx4 v26, s[48:51], s68 offen lds
  s_add_u32 m0, s56, 102400
  s_mov_b32 s68, 3211264
  buffer_load_dwordx4 v26, s[48:51], s68 offen lds
  s_add_u32 m0, s56, 106496
  s_mov_b32 s68, 3407872
  buffer_load_dwordx4 v26, s[48:51], s68 offen lds
  s_add_u32 m0, s56, 110592
  s_mov_b32 s68, 3473408
  buffer_load_dwordx4 v26, s[48:51], s68 offen lds
  v_add_u32 v30, 114688, v28
  v_add_u32 v31, 114688, v29
  s_cmp_lg_u32 s44, 0
  s_cbranch_scc1 L_wr_7_1
  ds_read_b64_tr_b16 a[56:57], v30 offset:0
  ds_read_b64_tr_b16 a[58:59], v30 offset:512
  ds_read_b64_tr_b16 a[60:61], v30 offset:8192
  ds_read_b64_tr_b16 a[62:63], v30 offset:8704
  ds_read_b64_tr_b16 a[120:121], v31 offset:0
  ds_read_b64_tr_b16 a[122:123], v31 offset:512
  ds_read_b64_tr_b16 a[124:125], v31 offset:8192
  ds_read_b64_tr_b16 a[126:127], v31 offset:8704
  s_branch L_wr_7_e
L_wr_7_1:
  s_cmp_lg_u32 s44, 1
  s_cbranch_scc1 L_wr_7_2
  ds_read_b64_tr_b16 a[40:41], v30 offset:0
  ds_read_b64_tr_b16 a[42:43], v30 offset:512
  ds_read_b64_tr_b16 a[44:45], v30 offset:8192
  ds_read_b64_tr_b16 a[46:47], v30 offset:8704
  ds_read_b64_tr_b16 a[104:105], v31 offset:0
  ds_read_b64_tr_b16 a[106:107], v31 offset:512
  ds_read_b64_tr_b16 a[108:109], v31 offset:8192
  ds_read_b64_tr_b16 a[110:111], v31 offset:8704
  s_branch L_wr_7_e
L_wr_7_2:
  s_cmp_lg_u32 s44, 2
  s_cbranch_scc1 L_wr_7_3
  ds_read_b64_tr_b16 a[24:25], v30 offset:0
  ds_read_b64_tr_b16 a[26:27], v30 offset:512
  ds_read_b64_tr_b16 a[28:29], v30 offset:8192
  ds_read_b64_tr_b16 a[30:31], v30 offset:8704
  ds_read_b64_tr_b16 a[88:89], v31 offset:0
  ds_read_b64_tr_b16 a[90:91], v31 offset:512
  ds_read_b64_tr_b16 a[92:93], v31 offset:8192
  ds_read_b64_tr_b16 a[94:95], v31 offset:8704
  s_branch L_wr_7_e
L_wr_7_3:
  ds_read_b64_tr_b16 a[8:9], v30 offset:0
  ds_read_b64_tr_b16 a[10:11], v30 offset:512
  ds_read_b64_tr_b16 a[12:13], v30 offset:8192
  ds_read_b64_tr_b16 a[14:15], v30 offset:8704
  ds_read_b64_tr_b16 a[72:73], v31 offset:0
  ds_read_b64_tr_b16 a[74:75], v31 offset:512
  ds_read_b64_tr_b16 a[76:77], v31 offset:8192
  ds_read_b64_tr_b16 a[78:79], v31 offset:8704
L_wr_7_e:
  s_waitcnt lgkmcnt(0)
  s_waitcnt vmcnt(24)
  s_barrier
  s_add_u32 m0, s56, 114688
  s_mov_b32 s68, 3670016
  buffer_load_dwordx4 v26, s[48:51], s68 offen lds
  s_add_u32 m0, s56, 118784
  s_mov_b32 s68, 3735552
  buffer_load_dwordx4 v26, s[48:51], s68 offen lds
  s_add_u32 m0, s56, 122880
  s_mov_b32 s68, 3932160
  buffer_load_dwordx4 v26, s[48:51], s68 offen lds
  s_add_u32 m0, s56, 126976
  s_mov_b32 s68, 3997696
  buffer_load_dwordx4 v26, s[48:51], s68 offen lds
  v_add_u32 v30, 0, v28
  v_add_u32 v31, 0, v29
  s_cmp_lg_u32 s44, 0
  s_cbranch_scc1 L_wr_8_1
  ds_read_b64_tr_b16 a[128:129], v30 offset:0
  ds_read_b64_tr_b16 a[130:131], v30 offset:512
  ds_read_b64_tr_b16 a[132:133], v30 offset:8192
  ds_read_b64_tr_b16 a[134:135], v30 offset:8704
  ds_read_b64_tr_b16 a[192:193], v31 offset:0
  ds_read_b64_tr_b16 a[194:195], v31 offset:512
  ds_read_b64_tr_b16 a[196:197], v31 offset:8192
  ds_read_b64_tr_b16 a[198:199], v31 offset:8704
  s_branch L_wr_8_e
L_wr_8_1:
  s_cmp_lg_u32 s44, 1
  s_cbranch_scc1 L_wr_8_2
  ds_read_b64_tr_b16 a[144:145], v30 offset:0
  ds_read_b64_tr_b16 a[146:147], v30 offset:512
  ds_read_b64_tr_b16 a[148:149], v30 offset:8192
  ds_read_b64_tr_b16 a[150:151], v30 offset:8704
  ds_read_b64_tr_b16 a[208:209], v31 offset:0
  ds_read_b64_tr_b16 a[210:211], v31 offset:512
  ds_read_b64_tr_b16 a[212:213], v31 offset:8192
  ds_read_b64_tr_b16 a[214:215], v31 offset:8704
  s_branch L_wr_8_e
L_wr_8_2:
  s_cmp_lg_u32 s44, 2
  s_cbranch_scc1 L_wr_8_3
  ds_read_b64_tr_b16 a[160:161], v30 offset:0
  ds_read_b64_tr_b16 a[162:163], v30 offset:512
  ds_read_b64_tr_b16 a[164:165], v30 offset:8192
  ds_read_b64_tr_b16 a[166:167], v30 offset:8704
  ds_read_b64_tr_b16 a[224:225], v31 offset:0
  ds_read_b64_tr_b16 a[226:227], v31 offset:512
  ds_read_b64_tr_b16 a[228:229], v31 offset:8192
  ds_read_b64_tr_b16 a[230:231], v31 offset:8704
  s_branch L_wr_8_e
L_wr_8_3:
  ds_read_b64_tr_b16 a[176:177], v30 offset:0
  ds_read_b64_tr_b16 a[178:179], v30 offset:512
  ds_read_b64_tr_b16 a[180:181], v30 offset:8192
  ds_read_b64_tr_b16 a[182:183], v30 offset:8704
  ds_read_b64_tr_b16 a[240:241], v31 offset:0
  ds_read_b64_tr_b16 a[242:243], v31 offset:512
  ds_read_b64_tr_b16 a[244:245], v31 offset:8192
  ds_read_b64_tr_b16 a[246:247], v31 offset:8704
L_wr_8_e:
  s_waitcnt lgkmcnt(0)
  s_waitcnt vmcnt(24)
  s_barrier
  s_mov_b32 s48, s30
  s_and_b32 s49, s31, 0xffff
  s_add_u32 m0, s56, 0
  s_mov_b32 s68, 0
  buffer_load_dwordx4 v27, s[48:51], s68 offen lds
  s_add_u32 m0, s56, 4096
  s_mov_b32 s68, 4096
  buffer_load_dwordx4 v27, s[48:51], s68 offen lds
  s_add_u32 m0, s56, 8192
  s_mov_b32 s68, 8192
  buffer_load_dwordx4 v27, s[48:51], s68 offen lds
  s_add_u32 m0, s56, 12288
  s_mov_b32 s68, 12288
  buffer_load_dwordx4 v27, s[48:51], s68 offen lds
  v_add_u32 v30, 16384, v28
  v_add_u32 v31, 16384, v29
  s_cmp_lg_u32 s44, 0
  s_cbranch_scc1 L_wr_9_1
  ds_read_b64_tr_b16 a[136:137], v30 offset:0
  ds_read_b64_tr_b16 a[138:139], v30 offset:512
  ds_read_b64_tr_b16 a[140:141], v30 offset:8192
  ds_read_b64_tr_b16 a[142:143], v30 offset:8704
  ds_read_b64_tr_b16 a[200:201], v31 offset:0
  ds_read_b64_tr_b16 a[202:203], v31 offset:512
  ds_read_b64_tr_b16 a[204:205], v31 offset:8192
  ds_read_b64_tr_b16 a[206:207], v31 offset:8704
  s_branch L_wr_9_e
L_wr_9_1:
  s_cmp_lg_u32 s44, 1
  s_cbranch_scc1 L_wr_9_2
  ds_read_b64_tr_b16 a[152:153], v30 offset:0
  ds_read_b64_tr_b16 a[154:155], v30 offset:512
  ds_read_b64_tr_b16 a[156:157], v30 offset:8192
  ds_read_b64_tr_b16 a[158:159], v30 offset:8704
  ds_read_b64_tr_b16 a[216:217], v31 offset:0
  ds_read_b64_tr_b16 a[218:219], v31 offset:512
  ds_read_b64_tr_b16 a[220:221], v31 offset:8192
  ds_read_b64_tr_b16 a[222:223], v31 offset:8704
  s_branch L_wr_9_e
L_wr_9_2:
  s_cmp_lg_u32 s44, 2
  s_cbranch_scc1 L_wr_9_3
  ds_read_b64_tr_b16 a[168:169], v30 offset:0
  ds_read_b64_tr_b16 a[170:171], v30 offset:512
  ds_read_b64_tr_b16 a[172:173], v30 offset:8192
  ds_read_b64_tr_b16 a[174:175], v30 offset:8704
  ds_read_b64_tr_b16 a[232:233], v31 offset:0
  ds_read_b64_tr_b16 a[234:235], v31 offset:512
  ds_read_b64_tr_b16 a[236:237], v31 offset:8192
  ds_read_b64_tr_b16 a[238:239], v31 offset:8704
  s_branch L_wr_9_e
L_wr_9_3:
  ds_read_b64_tr_b16 a[184:185], v30 offset:0
  ds_read_b64_tr_b16 a[186:187], v30 offset:512
  ds_read_b64_tr_b16 a[188:189], v30 offset:8192
  ds_read_b64_tr_b16 a[190:191], v30 offset:8704
  ds_read_b64_tr_b16 a[248:249], v31 offset:0
  ds_read_b64_tr_b16 a[250:251], v31 offset:512
  ds_read_b64_tr_b16 a[252:253], v31 offset:8192
  ds_read_b64_tr_b16 a[254:255], v31 offset:8704
L_wr_9_e:
  s_waitcnt lgkmcnt(0)
  s_waitcnt vmcnt(24)
  s_barrier
  s_add_u32 m0, s56, 16384
  s_mov_b32 s68, 65536
  buffer_load_dwordx4 v27, s[48:51], s68 offen lds
  s_add_u32 m0, s56, 20480
  s_mov_b32 s68, 69632
  buffer_load_dwordx4 v27, s[48:51], s68 offen lds
  s_add_u32 m0, s56, 24576
  s_mov_b32 s68, 73728
  buffer_load_dwordx4 v27, s[48:51], s68 offen lds
  s_add_u32 m0, s56, 28672
  s_mov_b32 s68, 77824
  buffer_load_dwordx4 v27, s[48:51], s68 offen lds
  v_add_u32 v30, 32768, v28
  v_add_u32 v31, 32768, v29
  s_cmp_lg_u32 s44, 0
  s_cbranch_scc1 L_wr_10_1
  ds_read_b64_tr_b16 a[144:145], v30 offset:0
  ds_read_b64_tr_b16 a[146:147], v30 offset:512
  ds_read_b64_tr_b16 a[148:149], v30 offset:8192
  ds_read_b64_tr_b16 a[150:151], v30 offset:8704
  ds_read_b64_tr_b16 a[208:209], v31 offset:0
  ds_read_b64_tr_b16 a[210:211], v31 offset:512
  ds_read_b64_tr_b16 a[212:213], v31 offset:8192
  ds_read_b64_tr_b16 a[214:215], v31 offset:8704
  s_branch L_wr_10_e
L_wr_10_1:
  s_cmp_lg_u32 s44, 1
  s_cbranch_scc1 L_wr_10_2
  ds_read_b64_tr_b16 a[128:129], v30 offset:0
  ds_read_b64_tr_b16 a[130:131], v30 offset:512
  ds_read_b64_tr_b16 a[132:133], v30 offset:8192
  ds_read_b64_tr_b16 a[134:135], v30 offset:8704
  ds_read_b64_tr_b16 a[192:193], v31 offset:0
  ds_read_b64_tr_b16 a[194:195], v31 offset:512
  ds_read_b64_tr_b16 a[196:197], v31 offset:8192
  ds_read_b64_tr_b16 a[198:199], v31 offset:8704
  s_branch L_wr_10_e
L_wr_10_2:
  s_cmp_lg_u32 s44, 2
  s_cbranch_scc1 L_wr_10_3
  ds_read_b64_tr_b16 a[176:177], v30 offset:0
  ds_read_b64_tr_b16 a[178:179], v30 offset:512
  ds_read_b64_tr_b16 a[180:181], v30 offset:8192
  ds_read_b64_tr_b16 a[182:183], v30 offset:8704
  ds_read_b64_tr_b16 a[240:241], v31 offset:0
  ds_read_b64_tr_b16 a[242:243], v31 offset:512
  ds_read_b64_tr_b16 a[244:245], v31 offset:8192
  ds_read_b64_tr_b16 a[246:247], v31 offset:8704
  s_branch L_wr_10_e
L_wr_10_3:
  ds_read_b64_tr_b16 a[160:161], v30 offset:0
  ds_read_b64_tr_b16 a[162:163], v30 offset:512
  ds_read_b64_tr_b16 a[164:165], v30 offset:8192
  ds_read_b64_tr_b16 a[166:167], v30 offset:8704
  ds_read_b64_tr_b16 a[224:225], v31 offset:0
  ds_read_b64_tr_b16 a[226:227], v31 offset:512
  ds_read_b64_tr_b16 a[228:229], v31 offset:8192
  ds_read_b64_tr_b16 a[230:231], v31 offset:8704
L_wr_10_e:
  s_waitcnt lgkmcnt(0)
  s_waitcnt vmcnt(24)
  s_barrier
  s_add_u32 m0, s56, 32768
  s_mov_b32 s68, 256
  buffer_load_dwordx4 v27, s[48:51], s68 offen lds
  s_add_u32 m0, s56, 36864
  s_mov_b32 s68, 4352
  buffer_load_dwordx4 v27, s[48:51], s68 offen lds
  s_add_u32 m0, s56, 40960
  s_mov_b32 s68, 8448
  buffer_load_dwordx4 v27, s[48:51], s68 offen lds
  s_add_u32 m0, s56, 45056
  s_mov_b32 s68, 12544
  buffer_load_dwordx4 v27, s[48:51], s68 offen lds
  v_add_u32 v30, 49152, v28
  v_add_u32 v31, 49152, v29
  s_cmp_lg_u32 s44, 0
  s_cbranch_scc1 L_wr_11_1
  ds_read_b64_tr_b16 a[152:153], v30 offset:0
  ds_read_b64_tr_b16 a[154:155], v30 offset:512
  ds_read_b64_tr_b16 a[156:157], v30 offset:8192
  ds_read_b64_tr_b16 a[158:159], v30 offset:8704
  ds_read_b64_tr_b16 a[216:217], v31 offset:0
  ds_read_b64_tr_b16 a[218:219], v31 offset:512
  ds_read_b64_tr_b16 a[220:221], v31 offset:8192
  ds_read_b64_tr_b16 a[222:223], v31 offset:8704
  s_branch L_wr_11_e
L_wr_11_1:
  s_cmp_lg_u32 s44, 1
  s_cbranch_scc1 L_wr_11_2
  ds_read_b64_tr_b16 a[136:137], v30 offset:0
  ds_read_b64_tr_b16 a[138:139], v30 offset:512
  ds_read_b64_tr_b16 a[140:141], v30 offset:8192
  ds_read_b64_tr_b16 a[142:143], v30 offset:8704
  ds_read_b64_tr_b16 a[200:201], v31 offset:0
  ds_read_b64_tr_b16 a[202:203], v31 offset:512
  ds_read_b64_tr_b16 a[204:205], v31 offset:8192
  ds_read_b64_tr_b16 a[206:207], v31 offset:8704
  s_branch L_wr_11_e
L_wr_11_2:
  s_cmp_lg_u32 s44, 2
  s_cbranch_scc1 L_wr_11_3
  ds_read_b64_tr_b16 a[184:185], v30 offset:0
  ds_read_b64_tr_b16 a[186:187], v30 offset:512
  ds_read_b64_tr_b16 a[188:189], v30 offset:8192
  ds_read_b64_tr_b16 a[190:191], v30 offset:8704
  ds_read_b64_tr_b16 a[248:249], v31 offset:0
  ds_read_b64_tr_b16 a[250:251], v31 offset:512
  ds_read_b64_tr_b16 a[252:253], v31 offset:8192
  ds_read_b64_tr_b16 a[254:255], v31 offset:8704
  s_branch L_wr_11_e
L_wr_11_3:
  ds_read_b64_tr_b16 a[168:169], v30 offset:0
  ds_read_b64_tr_b16 a[170:171], v30 offset:512
  ds_read_b64_tr_b16 a[172:173], v30 offset:8192
  ds_read_b64_tr_b16 a[174:175], v30 offset:8704
  ds_read_b64_tr_b16 a[232:233], v31 offset:0
  ds_read_b64_tr_b16 a[234:235], v31 offset:512
  ds_read_b64_tr_b16 a[236:237], v31 offset:8192
  ds_read_b64_tr_b16 a[238:239], v31 offset:8704
L_wr_11_e:
  s_waitcnt lgkmcnt(0)
  s_waitcnt vmcnt(24)
  s_barrier
  s_add_u32 m0, s56, 49152
  s_mov_b32 s68, 65792
  buffer_load_dwordx4 v27, s[48:51], s68 offen lds
  s_add_u32 m0, s56, 53248
  s_mov_b32 s68, 69888
  buffer_load_dwordx4 v27, s[48:51], s68 offen lds
  s_add_u32 m0, s56, 57344
  s_mov_b32 s68, 73984
  buffer_load_dwordx4 v27, s[48:51], s68 offen lds
  s_add_u32 m0, s56, 61440
  s_mov_b32 s68, 78080
  buffer_load_dwordx4 v27, s[48:51], s68 offen lds
  v_add_u32 v30, 65536, v28
  v_add_u32 v31, 65536, v29
  s_cmp_lg_u32 s44, 0
  s_cbranch_scc1 L_wr_12_1
  ds_read_b64_tr_b16 a[160:161], v30 offset:0
  ds_read_b64_tr_b16 a[162:163], v30 offset:512
  ds_read_b64_tr_b16 a[164:165], v30 offset:8192
  ds_read_b64_tr_b16 a[166:167], v30 offset:8704
  ds_read_b64_tr_b16 a[224:225], v31 offset:0
  ds_read_b64_tr_b16 a[226:227], v31 offset:512
  ds_read_b64_tr_b16 a[228:229], v31 offset:8192
  ds_read_b64_tr_b16 a[230:231], v31 offset:8704
  s_branch L_wr_12_e
L_wr_12_1:
  s_cmp_lg_u32 s44, 1
  s_cbranch_scc1 L_wr_12_2
  ds_read_b64_tr_b16 a[176:177], v30 offset:0
  ds_read_b64_tr_b16 a[178:179], v30 offset:512
  ds_read_b64_tr_b16 a[180:181], v30 offset:8192
  ds_read_b64_tr_b16 a[182:183], v30 offset:8704
  ds_read_b64_tr_b16 a[240:241], v31 offset:0
  ds_read_b64_tr_b16 a[242:243], v31 offset:512
  ds_read_b64_tr_b16 a[244:245], v31 offset:8192
  ds_read_b64_tr_b16 a[246:247], v31 offset:8704
  s_branch L_wr_12_e
L_wr_12_2:
  s_cmp_lg_u32 s44, 2
  s_cbranch_scc1 L_wr_12_3
  ds_read_b64_tr_b16 a[128:129], v30 offset:0
  ds_read_b64_tr_b16 a[130:131], v30 offset:512
  ds_read_b64_tr_b16 a[132:133], v30 offset:8192
  ds_read_b64_tr_b16 a[134:135], v30 offset:8704
  ds_read_b64_tr_b16 a[192:193], v31 offset:0
  ds_read_b64_tr_b16 a[194:195], v31 offset:512
  ds_read_b64_tr_b16 a[196:197], v31 offset:8192
  ds_read_b64_tr_b16 a[198:199], v31 offset:8704
  s_branch L_wr_12_e
L_wr_12_3:
  ds_read_b64_tr_b16 a[144:145], v30 offset:0
  ds_read_b64_tr_b16 a[146:147], v30 offset:512
  ds_read_b64_tr_b16 a[148:149], v30 offset:8192
  ds_read_b64_tr_b16 a[150:151], v30 offset:8704
  ds_read_b64_tr_b16 a[208:209], v31 offset:0
  ds_read_b64_tr_b16 a[210:211], v31 offset:512
  ds_read_b64_tr_b16 a[212:213], v31 offset:8192
  ds_read_b64_tr_b16 a[214:215], v31 offset:8704
L_wr_12_e:
  s_waitcnt lgkmcnt(0)
  s_waitcnt vmcnt(24)
  s_barrier
  s_add_u32 m0, s56, 65536
  s_mov_b32 s68, 512
  buffer_load_dwordx4 v27, s[48:51], s68 offen lds
  s_add_u32 m0, s56, 69632
  s_mov_b32 s68, 4608
  buffer_load_dwordx4 v27, s[48:51], s68 offen lds
  s_add_u32 m0, s56, 73728
  s_mov_b32 s68, 8704
  buffer_load_dwordx4 v27, s[48:51], s68 offen lds
  s_add_u32 m0, s56, 77824
  s_mov_b32 s68, 12800
  buffer_load_dwordx4 v27, s[48:51], s68 offen lds
  v_add_u32 v30, 81920, v28
  v_add_u32 v31, 81920, v29
  s_cmp_lg_u32 s44, 0
  s_cbranch_scc1 L_wr_13_1
  ds_read_b64_tr_b16 a[168:169], v30 offset:0
  ds_read_b64_tr_b16 a[170:171], v30 offset:512
  ds_read_b64_tr_b16 a[172:173], v30 offset:8192
  ds_read_b64_tr_b16 a[174:175], v30 offset:8704
  ds_read_b64_tr_b16 a[232:233], v31 offset:0
  ds_read_b64_tr_b16 a[234:235], v31 offset:512
  ds_read_b64_tr_b16 a[236:237], v31 offset:8192
  ds_read_b64_tr_b16 a[238:239], v31 offset:8704
  s_branch L_wr_13_e
L_wr_13_1:
  s_cmp_lg_u32 s44, 1
  s_cbranch_scc1 L_wr_13_2
  ds_read_b64_tr_b16 a[184:185], v30 offset:0
  ds_read_b64_tr_b16 a[186:187], v30 offset:512
  ds_read_b64_tr_b16 a[188:189], v30 offset:8192
  ds_read_b64_tr_b16 a[190:191], v30 offset:8704
  ds_read_b64_tr_b16 a[248:249], v31 offset:0
  ds_read_b64_tr_b16 a[250:251], v31 offset:512
  ds_read_b64_tr_b16 a[252:253], v31 offset:8192
  ds_read_b64_tr_b16 a[254:255], v31 offset:8704
  s_branch L_wr_13_e
L_wr_13_2:
  s_cmp_lg_u32 s44, 2
  s_cbranch_scc1 L_wr_13_3
  ds_read_b64_tr_b16 a[136:137], v30 offset:0
  ds_read_b64_tr_b16 a[138:139], v30 offset:512
  ds_read_b64_tr_b16 a[140:141], v30 offset:8192
  ds_read_b64_tr_b16 a[142:143], v30 offset:8704
  ds_read_b64_tr_b16 a[200:201], v31 offset:0
  ds_read_b64_tr_b16 a[202:203], v31 offset:512
  ds_read_b64_tr_b16 a[204:205], v31 offset:8192
  ds_read_b64_tr_b16 a[206:207], v31 offset:8704
  s_branch L_wr_13_e
L_wr_13_3:
  ds_read_b64_tr_b16 a[152:153], v30 offset:0
  ds_read_b64_tr_b16 a[154:155], v30 offset:512
  ds_read_b64_tr_b16 a[156:157], v30 offset:8192
  ds_read_b64_tr_b16 a[158:159], v30 offset:8704
  ds_read_b64_tr_b16 a[216:217], v31 offset:0
  ds_read_b64_tr_b16 a[218:219], v31 offset:512
  ds_read_b64_tr_b16 a[220:221], v31 offset:8192
  ds_read_b64_tr_b16 a[222:223], v31 offset:8704
L_wr_13_e:
  s_waitcnt lgkmcnt(0)
  s_waitcnt vmcnt(24)
  s_barrier
  s_add_u32 m0, s56, 81920
  s_mov_b32 s68, 66048
  buffer_load_dwordx4 v27, s[48:51], s68 offen lds
  s_add_u32 m0, s56, 86016
  s_mov_b32 s68, 70144
  buffer_load_dwordx4 v27, s[48:51], s68 offen lds
  s_add_u32 m0, s56, 90112
  s_mov_b32 s68, 74240
  buffer_load_dwordx4 v27, s[48:51], s68 offen lds
  s_add_u32 m0, s56, 94208
  s_mov_b32 s68, 78336
  buffer_load_dwordx4 v27, s[48:51], s68 offen lds
  v_add_u32 v30, 98304, v28
  v_add_u32 v31, 98304, v29
  s_cmp_lg_u32 s44, 0
  s_cbranch_scc1 L_wr_14_1
  ds_read_b64_tr_b16 a[176:177], v30 offset:0
  ds_read_b64_tr_b16 a[178:179], v30 offset:512
  ds_read_b64_tr_b16 a[180:181], v30 offset:8192
  ds_read_b64_tr_b16 a[182:183], v30 offset:8704
  ds_read_b64_tr_b16 a[240:241], v31 offset:0
  ds_read_b64_tr_b16 a[242:243], v31 offset:512
  ds_read_b64_tr_b16 a[244:245], v31 offset:8192
  ds_read_b64_tr_b16 a[246:247], v31 offset:8704
  s_branch L_wr_14_e
L_wr_14_1:
  s_cmp_lg_u32 s44, 1
  s_cbranch_scc1 L_wr_14_2
  ds_read_b64_tr_b16 a[160:161], v30 offset:0
  ds_read_b64_tr_b16 a[162:163], v30 offset:512
  ds_read_b64_tr_b16 a[164:165], v30 offset:8192
  ds_read_b64_tr_b16 a[166:167], v30 offset:8704
  ds_read_b64_tr_b16 a[224:225], v31 offset:0
  ds_read_b64_tr_b16 a[226:227], v31 offset:512
  ds_read_b64_tr_b16 a[228:229], v31 offset:8192
  ds_read_b64_tr_b16 a[230:231], v31 offset:8704
  s_branch L_wr_14_e
L_wr_14_2:
  s_cmp_lg_u32 s44, 2
  s_cbranch_scc1 L_wr_14_3
  ds_read_b64_tr_b16 a[144:145], v30 offset:0
  ds_read_b64_tr_b16 a[146:147], v30 offset:512
  ds_read_b64_tr_b16 a[148:149], v30 offset:8192
  ds_read_b64_tr_b16 a[150:151], v30 offset:8704
  ds_read_b64_tr_b16 a[208:209], v31 offset:0
  ds_read_b64_tr_b16 a[210:211], v31 offset:512
  ds_read_b64_tr_b16 a[212:213], v31 offset:8192
  ds_read_b64_tr_b16 a[214:215], v31 offset:8704
  s_branch L_wr_14_e
L_wr_14_3:
  ds_read_b64_tr_b16 a[128:129], v30 offset:0
  ds_read_b64_tr_b16 a[130:131], v30 offset:512
  ds_read_b64_tr_b16 a[132:133], v30 offset:8192
  ds_read_b64_tr_b16 a[134:135], v30 offset:8704
  ds_read_b64_tr_b16 a[192:193], v31 offset:0
  ds_read_b64_tr_b16 a[194:195], v31 offset:512
  ds_read_b64_tr_b16 a[196:197], v31 offset:8192
  ds_read_b64_tr_b16 a[198:199], v31 offset:8704
L_wr_14_e:
  s_waitcnt lgkmcnt(0)
  s_waitcnt vmcnt(24)
  s_barrier
  s_add_u32 m0, s56, 98304
  s_mov_b32 s68, 768
  buffer_load_dwordx4 v27, s[48:51], s68 offen lds
  s_add_u32 m0, s56, 102400
  s_mov_b32 s68, 4864
  buffer_load_dwordx4 v27, s[48:51], s68 offen lds
  s_add_u32 m0, s56, 106496
  s_mov_b32 s68, 8960
  buffer_load_dwordx4 v27, s[48:51], s68 offen lds
  s_add_u32 m0, s56, 110592
  s_mov_b32 s68, 13056
  buffer_load_dwordx4 v27, s[48:51], s68 offen lds
  v_add_u32 v30, 114688, v28
  v_add_u32 v31, 114688, v29
  s_cmp_lg_u32 s44, 0
  s_cbranch_scc1 L_wr_15_1
  ds_read_b64_tr_b16 a[184:185], v30 offset:0
  ds_read_b64_tr_b16 a[186:187], v30 offset:512
  ds_read_b64_tr_b16 a[188:189], v30 offset:8192
  ds_read_b64_tr_b16 a[190:191], v30 offset:8704
  ds_read_b64_tr_b16 a[248:249], v31 offset:0
  ds_read_b64_tr_b16 a[250:251], v31 offset:512
  ds_read_b64_tr_b16 a[252:253], v31 offset:8192
  ds_read_b64_tr_b16 a[254:255], v31 offset:8704
  s_branch L_wr_15_e
L_wr_15_1:
  s_cmp_lg_u32 s44, 1
  s_cbranch_scc1 L_wr_15_2
  ds_read_b64_tr_b16 a[168:169], v30 offset:0
  ds_read_b64_tr_b16 a[170:171], v30 offset:512
  ds_read_b64_tr_b16 a[172:173], v30 offset:8192
  ds_read_b64_tr_b16 a[174:175], v30 offset:8704
  ds_read_b64_tr_b16 a[232:233], v31 offset:0
  ds_read_b64_tr_b16 a[234:235], v31 offset:512
  ds_read_b64_tr_b16 a[236:237], v31 offset:8192
  ds_read_b64_tr_b16 a[238:239], v31 offset:8704
  s_branch L_wr_15_e
L_wr_15_2:
  s_cmp_lg_u32 s44, 2
  s_cbranch_scc1 L_wr_15_3
  ds_read_b64_tr_b16 a[152:153], v30 offset:0
  ds_read_b64_tr_b16 a[154:155], v30 offset:512
  ds_read_b64_tr_b16 a[156:157], v30 offset:8192
  ds_read_b64_tr_b16 a[158:159], v30 offset:8704
  ds_read_b64_tr_b16 a[216:217], v31 offset:0
  ds_read_b64_tr_b16 a[218:219], v31 offset:512
  ds_read_b64_tr_b16 a[220:221], v31 offset:8192
  ds_read_b64_tr_b16 a[222:223], v31 offset:8704
  s_branch L_wr_15_e
L_wr_15_3:
  ds_read_b64_tr_b16 a[136:137], v30 offset:0
  ds_read_b64_tr_b16 a[138:139], v30 offset:512
  ds_read_b64_tr_b16 a[140:141], v30 offset:8192
  ds_read_b64_tr_b16 a[142:143], v30 offset:8704
  ds_read_b64_tr_b16 a[200:201], v31 offset:0
  ds_read_b64_tr_b16 a[202:203], v31 offset:512
  ds_read_b64_tr_b16 a[204:205], v31 offset:8192
  ds_read_b64_tr_b16 a[206:207], v31 offset:8704
L_wr_15_e:
  s_waitcnt lgkmcnt(0)
  s_waitcnt vmcnt(24)
  s_barrier
  s_add_u32 m0, s56, 114688
  s_mov_b32 s68, 66304
  buffer_load_dwordx4 v27, s[48:51], s68 offen lds
  s_add_u32 m0, s56, 118784
  s_mov_b32 s68, 70400
  buffer_load_dwordx4 v27, s[48:51], s68 offen lds
  s_add_u32 m0, s56, 122880
  s_mov_b32 s68, 74496
  buffer_load_dwordx4 v27, s[48:51], s68 offen lds
  s_add_u32 m0, s56, 126976
  s_mov_b32 s68, 78592
  buffer_load_dwordx4 v27, s[48:51], s68 offen lds
  v_add_u32 v30, 0, v32
  v_add_u32 v31, 0, v33
  s_cmp_lg_u32 s44, 0
  s_cbranch_scc1 L_wr_16_1
  ds_read_b64_tr_b16 v[128:129], v30 offset:0
  ds_read_b64_tr_b16 v[130:131], v30 offset:512
  ds_read_b64_tr_b16 v[132:133], v30 offset:8192
  ds_read_b64_tr_b16 v[134:135], v30 offset:8704
  ds_read_b64_tr_b16 v[136:137], v31 offset:0
  ds_read_b64_tr_b16 v[138:139], v31 offset:512
  ds_read_b64_tr_b16 v[140:141], v31 offset:8192
  ds_read_b64_tr_b16 v[142:143], v31 offset:8704
  s_branch L_wr_16_e
L_wr_16_1:
  s_cmp_lg_u32 s44, 1
  s_cbranch_scc1 L_wr_16_2
  ds_read_b64_tr_b16 v[136:137], v30 offset:0
  ds_read_b64_tr_b16 v[138:139], v30 offset:512
  ds_read_b64_tr_b16 v[140:141], v30 offset:8192
  ds_read_b64_tr_b16 v[142:143], v30 offset:8704
  ds_read_b64_tr_b16 v[128:129], v31 offset:0
  ds_read_b64_tr_b16 v[130:131], v31 offset:512
  ds_read_b64_tr_b16 v[132:133], v31 offset:8192
  ds_read_b64_tr_b16 v[134:135], v31 offset:8704
  s_branch L_wr_16_e
L_wr_16_2:
  s_cmp_lg_u32 s44, 2
  s_cbranch_scc1 L_wr_16_3
  ds_read_b64_tr_b16 v[144:145], v30 offset:0
  ds_read_b64_tr_b16 v[146:147], v30 offset:512
  ds_read_b64_tr_b16 v[148:149], v30 offset:8192
  ds_read_b64_tr_b16 v[150:151], v30 offset:8704
  ds_read_b64_tr_b16 v[152:153], v31 offset:0
  ds_read_b64_tr_b16 v[154:155], v31 offset:512
  ds_read_b64_tr_b16 v[156:157], v31 offset:8192
  ds_read_b64_tr_b16 v[158:159], v31 offset:8704
  s_branch L_wr_16_e
L_wr_16_3:
  ds_read_b64_tr_b16 v[152:153], v30 offset:0
  ds_read_b64_tr_b16 v[154:155], v30 offset:512
  ds_read_b64_tr_b16 v[156:157], v30 offset:8192
  ds_read_b64_tr_b16 v[158:159], v30 offset:8704
  ds_read_b64_tr_b16 v[144:145], v31 offset:0
  ds_read_b64_tr_b16 v[146:147], v31 offset:512
  ds_read_b64_tr_b16 v[148:149], v31 offset:8192
  ds_read_b64_tr_b16 v[150:151], v31 offset:8704
L_wr_16_e:
  s_waitcnt lgkmcnt(0)
  s_waitcnt vmcnt(24)
  s_barrier
  s_mov_b32 s48, s28
  s_and_b32 s49, s29, 0xffff
  s_add_u32 m0, s56, 0
  s_mov_b32 s68, 0
  buffer_load_dwordx4 v26, s[48:51], s68 offen lds
  s_add_u32 m0, s56, 4096
  s_mov_b32 s68, 65536
  buffer_load_dwordx4 v26, s[48:51], s68 offen lds
  s_add_u32 m0, s56, 8192
  s_mov_b32 s68, 262144
  buffer_load_dwordx4 v26, s[48:51], s68 offen lds
  s_add_u32 m0, s56, 12288
  s_mov_b32 s68, 327680
  buffer_load_dwordx4 v26, s[48:51], s68 offen lds
  v_add_u32 v30, 16384, v32
  v_add_u32 v31, 16384, v33
  s_cmp_lg_u32 s44, 0
  s_cbranch_scc1 L_wr_17_1
  ds_read_b64_tr_b16 v[144:145], v30 offset:0
  ds_read_b64_tr_b16 v[146:147], v30 offset:512
  ds_read_b64_tr_b16 v[148:149], v30 offset:8192
  ds_read_b64_tr_b16 v[150:151], v30 offset:8704
  ds_read_b64_tr_b16 v[152:153], v31 offset:0
  ds_read_b64_tr_b16 v[154:155], v31 offset:512
  ds_read_b64_tr_b16 v[156:157], v31 offset:8192
  ds_read_b64_tr_b16 v[158:159], v31 offset:8704
  s_branch L_wr_17_e
L_wr_17_1:
  s_cmp_lg_u32 s44, 1
  s_cbranch_scc1 L_wr_17_2
  ds_read_b64_tr_b16 v[152:153], v30 offset:0
  ds_read_b64_tr_b16 v[154:155], v30 offset:512
  ds_read_b64_tr_b16 v[156:157], v30 offset:8192
  ds_read_b64_tr_b16 v[158:159], v30 offset:8704
  ds_read_b64_tr_b16 v[144:145], v31 offset:0
  ds_read_b64_tr_b16 v[146:147], v31 offset:512
  ds_read_b64_tr_b16 v[148:149], v31 offset:8192
  ds_read_b64_tr_b16 v[150:151], v31 offset:8704
  s_branch L_wr_17_e
L_wr_17_2:
  s_cmp_lg_u32 s44, 2
  s_cbranch_scc1 L_wr_17_3
  ds_read_b64_tr_b16 v[128:129], v30 offset:0
  ds_read_b64_tr_b16 v[130:131], v30 offset:512
  ds_read_b64_tr_b16 v[132:133], v30 offset:8192
  ds_read_b64_tr_b16 v[134:135], v30 offset:8704
  ds_read_b64_tr_b16 v[136:137], v31 offset:0
  ds_read_b64_tr_b16 v[138:139], v31 offset:512
  ds_read_b64_tr_b16 v[140:141], v31 offset:8192
  ds_read_b64_tr_b16 v[142:143], v31 offset:8704
  s_branch L_wr_17_e
L_wr_17_3:
  ds_read_b64_tr_b16 v[136:137], v30 offset:0
  ds_read_b64_tr_b16 v[138:139], v30 offset:512
  ds_read_b64_tr_b16 v[140:141], v30 offset:8192
  ds_read_b64_tr_b16 v[142:143], v30 offset:8704
  ds_read_b64_tr_b16 v[128:129], v31 offset:0
  ds_read_b64_tr_b16 v[130:131], v31 offset:512
  ds_read_b64_tr_b16 v[132:133], v31 offset:8192
  ds_read_b64_tr_b16 v[134:135], v31 offset:8704
L_wr_17_e:
  s_waitcnt lgkmcnt(0)
  s_waitcnt vmcnt(24)
  s_barrier
  s_add_u32 m0, s56, 16384
  s_mov_b32 s68, 524288
  buffer_load_dwordx4 v26, s[48:51], s68 offen lds
  s_add_u32 m0, s56, 20480
  s_mov_b32 s68, 589824
  buffer_load_dwordx4 v26, s[48:51], s68 offen lds
  s_add_u32 m0, s56, 24576
  s_mov_b32 s68, 786432
  buffer_load_dwordx4 v26, s[48:51], s68 offen lds
  s_add_u32 m0, s56, 28672
  s_mov_b32 s68, 851968
  buffer_load_dwordx4 v26, s[48:51], s68 offen lds
  v_add_u32 v30, 32768, v32
  v_add_u32 v31, 32768, v33
  s_cmp_lg_u32 s44, 0
  s_cbranch_scc1 L_wr_18_1
  ds_read_b64_tr_b16 v[160:161], v30 offset:0
  ds_read_b64_tr_b16 v[162:163], v30 offset:512
  ds_read_b64_tr_b16 v[164:165], v30 offset:8192
  ds_read_b64_tr_b16 v[166:167], v30 offset:8704
  ds_read_b64_tr_b16 v[168:169], v31 offset:0
  ds_read_b64_tr_b16 v[170:171], v31 offset:512
  ds_read_b64_tr_b16 v[172:173], v31 offset:8192
  ds_read_b64_tr_b16 v[174:175], v31 offset:8704
  s_branch L_wr_18_e
L_wr_18_1:
  s_cmp_lg_u32 s44, 1
  s_cbranch_scc1 L_wr_18_2
  ds_read_b64_tr_b16 v[168:169], v30 offset:0
  ds_read_b64_tr_b16 v[170:171], v30 offset:512
  ds_read_b64_tr_b16 v[172:173], v30 offset:8192
  ds_read_b64_tr_b16 v[174:175], v30 offset:8704
  ds_read_b64_tr_b16 v[160:161], v31 offset:0
  ds_read_b64_tr_b16 v[162:163], v31 offset:512
  ds_read_b64_tr_b16 v[164:165], v31 offset:8192
  ds_read_b64_tr_b16 v[166:167], v31 offset:8704
  s_branch L_wr_18_e
L_wr_18_2:
  s_cmp_lg_u32 s44, 2
  s_cbranch_scc1 L_wr_18_3
  ds_read_b64_tr_b16 v[176:177], v30 offset:0
  ds_read_b64_tr_b16 v[178:179], v30 offset:512
  ds_read_b64_tr_b16 v[180:181], v30 offset:8192
  ds_read_b64_tr_b16 v[182:183], v30 offset:8704
  ds_read_b64_tr_b16 v[184:185], v31 offset:0
  ds_read_b64_tr_b16 v[186:187], v31 offset:512
  ds_read_b64_tr_b16 v[188:189], v31 offset:8192
  ds_read_b64_tr_b16 v[190:191], v31 offset:8704
  s_branch L_wr_18_e
L_wr_18_3:
  ds_read_b64_tr_b16 v[184:185], v30 offset:0
  ds_read_b64_tr_b16 v[186:187], v30 offset:512
  ds_read_b64_tr_b16 v[188:189], v30 offset:8192
  ds_read_b64_tr_b16 v[190:191], v30 offset:8704
  ds_read_b64_tr_b16 v[176:177], v31 offset:0
  ds_read_b64_tr_b16 v[178:179], v31 offset:512
  ds_read_b64_tr_b16 v[180:181], v31 offset:8192
  ds_read_b64_tr_b16 v[182:183], v31 offset:8704
L_wr_18_e:
  s_waitcnt lgkmcnt(0)
  s_waitcnt vmcnt(24)
  s_barrier
  s_add_u32 m0, s56, 32768
  s_mov_b32 s68, 1048576
  buffer_load_dwordx4 v26, s[48:51], s68 offen lds
  s_add_u32 m0, s56, 36864
  s_mov_b32 s68, 1114112
  buffer_load_dwordx4 v26, s[48:51], s68 offen lds
  s_add_u32 m0, s56, 40960
  s_mov_b32 s68, 1310720
  buffer_load_dwordx4 v26, s[48:51], s68 offen lds
  s_add_u32 m0, s56, 45056
  s_mov_b32 s68, 1376256
  buffer_load_dwordx4 v26, s[48:51], s68 offen lds
  v_add_u32 v30, 49152, v32
  v_add_u32 v31, 49152, v33
  s_cmp_lg_u32 s44, 0
  s_cbranch_scc1 L_wr_19_1
  ds_read_b64_tr_b16 v[176:177], v30 offset:0
  ds_read_b64_tr_b16 v[178:179], v30 offset:512
  ds_read_b64_tr_b16 v[180:181], v30 offset:8192
  ds_read_b64_tr_b16 v[182:183], v30 offset:8704
  ds_read_b64_tr_b16 v[184:185], v31 offset:0
  ds_read_b64_tr_b16 v[186:187], v31 offset:512
  ds_read_b64_tr_b16 v[188:189], v31 offset:8192
  ds_read_b64_tr_b16 v[190:191], v31 offset:8704
  s_branch L_wr_19_e
L_wr_19_1:
  s_cmp_lg_u32 s44, 1
  s_cbranch_scc1 L_wr_19_2
  ds_read_b64_tr_b16 v[184:185], v30 offset:0
  ds_read_b64_tr_b16 v[186:187], v30 offset:512
  ds_read_b64_tr_b16 v[188:189], v30 offset:8192
  ds_read_b64_tr_b16 v[190:191], v30 offset:8704
  ds_read_b64_tr_b16 v[176:177], v31 offset:0
  ds_read_b64_tr_b16 v[178:179], v31 offset:512
  ds_read_b64_tr_b16 v[180:181], v31 offset:8192
  ds_read_b64_tr_b16 v[182:183], v31 offset:8704
  s_branch L_wr_19_e
L_wr_19_2:
  s_cmp_lg_u32 s44, 2
  s_cbranch_scc1 L_wr_19_3
  ds_read_b64_tr_b16 v[160:161], v30 offset:0
  ds_read_b64_tr_b16 v[162:163], v30 offset:512
  ds_read_b64_tr_b16 v[164:165], v30 offset:8192
  ds_read_b64_tr_b16 v[166:167], v30 offset:8704
  ds_read_b64_tr_b16 v[168:169], v31 offset:0
  ds_read_b64_tr_b16 v[170:171], v31 offset:512
  ds_read_b64_tr_b16 v[172:173], v31 offset:8192
  ds_read_b64_tr_b16 v[174:175], v31 offset:8704
  s_branch L_wr_19_e
L_wr_19_3:
  ds_read_b64_tr_b16 v[168:169], v30 offset:0
  ds_read_b64_tr_b16 v[170:171], v30 offset:512
  ds_read_b64_tr_b16 v[172:173], v30 offset:8192
  ds_read_b64_tr_b16 v[174:175], v30 offset:8704
  ds_read_b64_tr_b16 v[160:161], v31 offset:0
  ds_read_b64_tr_b16 v[162:163], v31 offset:512
  ds_read_b64_tr_b16 v[164:165], v31 offset:8192
  ds_read_b64_tr_b16 v[166:167], v31 offset:8704
L_wr_19_e:
  s_waitcnt lgkmcnt(0)
  s_waitcnt vmcnt(24)
  s_barrier
  s_add_u32 m0, s56, 49152
  s_mov_b32 s68, 1572864
  buffer_load_dwordx4 v26, s[48:51], s68 offen lds
  s_add_u32 m0, s56, 53248
  s_mov_b32 s68, 1638400
  buffer_load_dwordx4 v26, s[48:51], s68 offen lds
  s_add_u32 m0, s56, 57344
  s_mov_b32 s68, 1835008
  buffer_load_dwordx4 v26, s[48:51], s68 offen lds
  s_add_u32 m0, s56, 61440
  s_mov_b32 s68, 1900544
  buffer_load_dwordx4 v26, s[48:51], s68 offen lds
  v_add_u32 v30, 65536, v32
  v_add_u32 v31, 65536, v33
  s_cmp_lg_u32 s44, 0
  s_cbranch_scc1 L_wr_20_1
  ds_read_b64_tr_b16 v[192:193], v30 offset:0
  ds_read_b64_tr_b16 v[194:195], v30 offset:512
  ds_read_b64_tr_b16 v[196:197], v30 offset:8192
  ds_read_b64_tr_b16 v[198:199], v30 offset:8704
  ds_read_b64_tr_b16 v[200:201], v31 offset:0
  ds_read_b64_tr_b16 v[202:203], v31 offset:512
  ds_read_b64_tr_b16 v[204:205], v31 offset:8192
  ds_read_b64_tr_b16 v[206:207], v31 offset:8704
  s_branch L_wr_20_e
L_wr_20_1:
  s_cmp_lg_u32 s44, 1
  s_cbranch_scc1 L_wr_20_2
  ds_read_b64_tr_b16 v[200:201], v30 offset:0
  ds_read_b64_tr_b16 v[202:203], v30 offset:512
  ds_read_b64_tr_b16 v[204:205], v30 offset:8192
  ds_read_b64_tr_b16 v[206:207], v30 offset:8704
  ds_read_b64_tr_b16 v[192:193], v31 offset:0
  ds_read_b64_tr_b16 v[194:195], v31 offset:512
  ds_read_b64_tr_b16 v[196:197], v31 offset:8192
  ds_read_b64_tr_b16 v[198:199], v31 offset:8704
  s_branch L_wr_20_e
L_wr_20_2:
  s_cmp_lg_u32 s44, 2
  s_cbranch_scc1 L_wr_20_3
  ds_read_b64_tr_b16 v[208:209], v30 offset:0
  ds_read_b64_tr_b16 v[210:211], v30 offset:512
  ds_read_b64_tr_b16 v[212:213], v30 offset:8192
  ds_read_b64_tr_b16 v[214:215], v30 offset:8704
  ds_read_b64_tr_b16 v[216:217], v31 offset:0
  ds_read_b64_tr_b16 v[218:219], v31 offset:512
  ds_read_b64_tr_b16 v[220:221], v31 offset:8192
  ds_read_b64_tr_b16 v[222:223], v31 offset:8704
  s_branch L_wr_20_e
L_wr_20_3:
  ds_read_b64_tr_b16 v[216:217], v30 offset:0
  ds_read_b64_tr_b16 v[218:219], v30 offset:512
  ds_read_b64_tr_b16 v[220:221], v30 offset:8192
  ds_read_b64_tr_b16 v[222:223], v30 offset:8704
  ds_read_b64_tr_b16 v[208:209], v31 offset:0
  ds_read_b64_tr_b16 v[210:211], v31 offset:512
  ds_read_b64_tr_b16 v[212:213], v31 offset:8192
  ds_read_b64_tr_b16 v[214:215], v31 offset:8704
L_wr_20_e:
  s_waitcnt lgkmcnt(0)
  s_waitcnt vmcnt(24)
  s_barrier
  s_add_u32 m0, s56, 65536
  s_mov_b32 s68, 2097152
  buffer_load_dwordx4 v26, s[48:51], s68 offen lds
  s_add_u32 m0, s56, 69632
  s_mov_b32 s68, 2162688
  buffer_load_dwordx4 v26, s[48:51], s68 offen lds
  s_add_u32 m0, s56, 73728
  s_mov_b32 s68, 2359296
  buffer_load_dwordx4 v26, s[48:51], s68 offen lds
  s_add_u32 m0, s56, 77824
  s_mov_b32 s68, 2424832
  buffer_load_dwordx4 v26, s[48:51], s68 offen lds
  v_add_u32 v30, 81920, v32
  v_add_u32 v31, 81920, v33
  s_cmp_lg_u32 s44, 0
  s_cbranch_scc1 L_wr_21_1
  ds_read_b64_tr_b16 v[208:209], v30 offset:0
  ds_read_b64_tr_b16 v[210:211], v30 offset:512
  ds_read_b64_tr_b16 v[212:213], v30 offset:8192
  ds_read_b64_tr_b16 v[214:215], v30 offset:8704
  ds_read_b64_tr_b16 v[216:217], v31 offset:0
  ds_read_b64_tr_b16 v[218:219], v31 offset:512
  ds_read_b64_tr_b16 v[220:221], v31 offset:8192
  ds_read_b64_tr_b16 v[222:223], v31 offset:8704
  s_branch L_wr_21_e
L_wr_21_1:
  s_cmp_lg_u32 s44, 1
  s_cbranch_scc1 L_wr_21_2
  ds_read_b64_tr_b16 v[216:217], v30 offset:0
  ds_read_b64_tr_b16 v[218:219], v30 offset:512
  ds_read_b64_tr_b16 v[220:221], v30 offset:8192
  ds_read_b64_tr_b16 v[222:223], v30 offset:8704
  ds_read_b64_tr_b16 v[208:209], v31 offset:0
  ds_read_b64_tr_b16 v[210:211], v31 offset:512
  ds_read_b64_tr_b16 v[212:213], v31 offset:8192
  ds_read_b64_tr_b16 v[214:215], v31 offset:8704
  s_branch L_wr_21_e
L_wr_21_2:
  s_cmp_lg_u32 s44, 2
  s_cbranch_scc1 L_wr_21_3
  ds_read_b64_tr_b16 v[192:193], v30 offset:0
  ds_read_b64_tr_b16 v[194:195], v30 offset:512
  ds_read_b64_tr_b16 v[196:197], v30 offset:8192
  ds_read_b64_tr_b16 v[198:199], v30 offset:8704
  ds_read_b64_tr_b16 v[200:201], v31 offset:0
  ds_read_b64_tr_b16 v[202:203], v31 offset:512
  ds_read_b64_tr_b16 v[204:205], v31 offset:8192
  ds_read_b64_tr_b16 v[206:207], v31 offset:8704
  s_branch L_wr_21_e
L_wr_21_3:
  ds_read_b64_tr_b16 v[200:201], v30 offset:0
  ds_read_b64_tr_b16 v[202:203], v30 offset:512
  ds_read_b64_tr_b16 v[204:205], v30 offset:8192
  ds_read_b64_tr_b16 v[206:207], v30 offset:8704
  ds_read_b64_tr_b16 v[192:193], v31 offset:0
  ds_read_b64_tr_b16 v[194:195], v31 offset:512
  ds_read_b64_tr_b16 v[196:197], v31 offset:8192
  ds_read_b64_tr_b16 v[198:199], v31 offset:8704
L_wr_21_e:
  s_waitcnt lgkmcnt(0)
  s_waitcnt vmcnt(24)
  s_barrier
  s_add_u32 m0, s56, 81920
  s_mov_b32 s68, 2621440
  buffer_load_dwordx4 v26, s[48:51], s68 offen lds
  s_add_u32 m0, s56, 86016
  s_mov_b32 s68, 2686976
  buffer_load_dwordx4 v26, s[48:51], s68 offen lds
  s_add_u32 m0, s56, 90112
  s_mov_b32 s68, 2883584
  buffer_load_dwordx4 v26, s[48:51], s68 offen lds
  s_add_u32 m0, s56, 94208
  s_mov_b32 s68, 2949120
  buffer_load_dwordx4 v26, s[48:51], s68 offen lds
  v_add_u32 v30, 98304, v32
  v_add_u32 v31, 98304, v33
  s_cmp_lg_u32 s44, 0
  s_cbranch_scc1 L_wr_22_1
  ds_read_b64_tr_b16 v[224:225], v30 offset:0
  ds_read_b64_tr_b16 v[226:227], v30 offset:512
  ds_read_b64_tr_b16 v[228:229], v30 offset:8192
  ds_read_b64_tr_b16 v[230:231], v30 offset:8704
  ds_read_b64_tr_b16 v[232:233], v31 offset:0
  ds_read_b64_tr_b16 v[234:235], v31 offset:512
  ds_read_b64_tr_b16 v[236:237], v31 offset:8192
  ds_read_b64_tr_b16 v[238:239], v31 offset:8704
  s_branch L_wr_22_e
L_wr_22_1:
  s_cmp_lg_u32 s44, 1
  s_cbranch_scc1 L_wr_22_2
  ds_read_b64_tr_b16 v[232:233], v30 offset:0
  ds_read_b64_tr_b16 v[234:235], v30 offset:512
  ds_read_b64_tr_b16 v[236:237], v30 offset:8192
  ds_read_b64_tr_b16 v[238:239], v30 offset:8704
  ds_read_b64_tr_b16 v[224:225], v31 offset:0
  ds_read_b64_tr_b16 v[226:227], v31 offset:512
  ds_read_b64_tr_b16 v[228:229], v31 offset:8192
  ds_read_b64_tr_b16 v[230:231], v31 offset:8704
  s_branch L_wr_22_e
L_wr_22_2:
  s_cmp_lg_u32 s44, 2
  s_cbranch_scc1 L_wr_22_3
  ds_read_b64_tr_b16 v[240:241], v30 offset:0
  ds_read_b64_tr_b16 v[242:243], v30 offset:512
  ds_read_b64_tr_b16 v[244:245], v30 offset:8192
  ds_read_b64_tr_b16 v[246:247], v30 offset:8704
  ds_read_b64_tr_b16 v[248:249], v31 offset:0
  ds_read_b64_tr_b16 v[250:251], v31 offset:512
  ds_read_b64_tr_b16 v[252:253], v31 offset:8192
  ds_read_b64_tr_b16 v[254:255], v31 offset:8704
  s_branch L_wr_22_e
L_wr_22_3:
  ds_read_b64_tr_b16 v[248:249], v30 offset:0
  ds_read_b64_tr_b16 v[250:251], v30 offset:512
  ds_read_b64_tr_b16 v[252:253], v30 offset:8192
  ds_read_b64_tr_b16 v[254:255], v30 offset:8704
  ds_read_b64_tr_b16 v[240:241], v31 offset:0
  ds_read_b64_tr_b16 v[242:243], v31 offset:512
  ds_read_b64_tr_b16 v[244:245], v31 offset:8192
  ds_read_b64_tr_b16 v[246:247], v31 offset:8704
L_wr_22_e:
  s_waitcnt lgkmcnt(0)
  s_waitcnt vmcnt(24)
  s_barrier
  s_add_u32 m0, s56, 98304
  s_mov_b32 s68, 3145728
  buffer_load_dwordx4 v26, s[48:51], s68 offen lds
  s_add_u32 m0, s56, 102400
  s_mov_b32 s68, 3211264
  buffer_load_dwordx4 v26, s[48:51], s68 offen lds
  s_add_u32 m0, s56, 106496
  s_mov_b32 s68, 3407872
  buffer_load_dwordx4 v26, s[48:51], s68 offen lds
  s_add_u32 m0, s56, 110592
  s_mov_b32 s68, 3473408
  buffer_load_dwordx4 v26, s[48:51], s68 offen lds
  v_add_u32 v30, 114688, v32
  v_add_u32 v31, 114688, v33
  s_cmp_lg_u32 s44, 0
  s_cbranch_scc1 L_wr_23_1
  ds_read_b64_tr_b16 v[240:241], v30 offset:0
  ds_read_b64_tr_b16 v[242:243], v30 offset:512
  ds_read_b64_tr_b16 v[244:245], v30 offset:8192
  ds_read_b64_tr_b16 v[246:247], v30 offset:8704
  ds_read_b64_tr_b16 v[248:249], v31 offset:0
  ds_read_b64_tr_b16 v[250:251], v31 offset:512
  ds_read_b64_tr_b16 v[252:253], v31 offset:8192
  ds_read_b64_tr_b16 v[254:255], v31 offset:8704
  s_branch L_wr_23_e
L_wr_23_1:
  s_cmp_lg_u32 s44, 1
  s_cbranch_scc1 L_wr_23_2
  ds_read_b64_tr_b16 v[248:249], v30 offset:0
  ds_read_b64_tr_b16 v[250:251], v30 offset:512
  ds_read_b64_tr_b16 v[252:253], v30 offset:8192
  ds_read_b64_tr_b16 v[254:255], v30 offset:8704
  ds_read_b64_tr_b16 v[240:241], v31 offset:0
  ds_read_b64_tr_b16 v[242:243], v31 offset:512
  ds_read_b64_tr_b16 v[244:245], v31 offset:8192
  ds_read_b64_tr_b16 v[246:247], v31 offset:8704
  s_branch L_wr_23_e
L_wr_23_2:
  s_cmp_lg_u32 s44, 2
  s_cbranch_scc1 L_wr_23_3
  ds_read_b64_tr_b16 v[224:225], v30 offset:0
  ds_read_b64_tr_b16 v[226:227], v30 offset:512
  ds_read_b64_tr_b16 v[228:229], v30 offset:8192
  ds_read_b64_tr_b16 v[230:231], v30 offset:8704
  ds_read_b64_tr_b16 v[232:233], v31 offset:0
  ds_read_b64_tr_b16 v[234:235], v31 offset:512
  ds_read_b64_tr_b16 v[236:237], v31 offset:8192
  ds_read_b64_tr_b16 v[238:239], v31 offset:8704
  s_branch L_wr_23_e
L_wr_23_3:
  ds_read_b64_tr_b16 v[232:233], v30 offset:0
  ds_read_b64_tr_b16 v[234:235], v30 offset:512
  ds_read_b64_tr_b16 v[236:237], v30 offset:8192
  ds_read_b64_tr_b16 v[238:239], v30 offset:8704
  ds_read_b64_tr_b16 v[224:225], v31 offset:0
  ds_read_b64_tr_b16 v[226:227], v31 offset:512
  ds_read_b64_tr_b16 v[228:229], v31 offset:8192
  ds_read_b64_tr_b16 v[230:231], v31 offset:8704
L_wr_23_e:
  s_waitcnt lgkmcnt(0)
  s_waitcnt vmcnt(24)
  s_barrier
  s_add_u32 m0, s56, 114688
  s_mov_b32 s68, 3670016
  buffer_load_dwordx4 v26, s[48:51], s68 offen lds
  s_add_u32 m0, s56, 118784
  s_mov_b32 s68, 3735552
  buffer_load_dwordx4 v26, s[48:51], s68 offen lds
  s_add_u32 m0, s56, 122880
  s_mov_b32 s68, 3932160
  buffer_load_dwordx4 v26, s[48:51], s68 offen lds
  s_add_u32 m0, s56, 126976
  s_mov_b32 s68, 3997696
  buffer_load_dwordx4 v26, s[48:51], s68 offen lds
  v_add_u32 v30, 0, v28
  v_add_u32 v31, 0, v29
  ds_read_b64_tr_b16 v[108:109], v30 offset:0
  ds_read_b64_tr_b16 v[110:111], v30 offset:512
  ds_read_b64_tr_b16 v[112:113], v30 offset:8192
  ds_read_b64_tr_b16 v[114:115], v30 offset:8704
  ds_read_b64_tr_b16 v[116:117], v31 offset:0
  ds_read_b64_tr_b16 v[118:119], v31 offset:512
  ds_read_b64_tr_b16 v[120:121], v31 offset:8192
  ds_read_b64_tr_b16 v[122:123], v31 offset:8704
  s_waitcnt lgkmcnt(0)
  s_barrier
  v_add_u32 v30, 0, v3
  ds_write_b128 v30, v[108:111] offset:0
  ds_write_b128 v30, v[112:115] offset:1024
  ds_write_b128 v30, v[116:119] offset:2048
  ds_write_b128 v30, v[120:123] offset:3072
  s_waitcnt lgkmcnt(0)
  s_waitcnt vmcnt(24)
  s_barrier
  v_add_u32 v30, 16384, v28
  v_add_u32 v31, 16384, v29
  ds_read_b64_tr_b16 v[108:109], v30 offset:0
  ds_read_b64_tr_b16 v[110:111], v30 offset:512
  ds_read_b64_tr_b16 v[112:113], v30 offset:8192
  ds_read_b64_tr_b16 v[114:115], v30 offset:8704
  ds_read_b64_tr_b16 v[116:117], v31 offset:0
  ds_read_b64_tr_b16 v[118:119], v31 offset:512
  ds_read_b64_tr_b16 v[120:121], v31 offset:8192
  ds_read_b64_tr_b16 v[122:123], v31 offset:8704
  s_waitcnt lgkmcnt(0)
  s_barrier
  v_add_u32 v30, 16384, v3
  ds_write_b128 v30, v[108:111] offset:0
  ds_write_b128 v30, v[112:115] offset:1024
  ds_write_b128 v30, v[116:119] offset:2048
  ds_write_b128 v30, v[120:123] offset:3072
  s_waitcnt lgkmcnt(0)
  s_waitcnt vmcnt(20)
  s_barrier
  v_add_u32 v30, 32768, v28
  v_add_u32 v31, 32768, v29
  ds_read_b64_tr_b16 v[108:109], v30 offset:0
  ds_read_b64_tr_b16 v[110:111], v30 offset:512
  ds_read_b64_tr_b16 v[112:113], v30 offset:8192
  ds_read_b64_tr_b16 v[114:115], v30 offset:8704
  ds_read_b64_tr_b16 v[116:117], v31 offset:0
  ds_read_b64_tr_b16 v[118:119], v31 offset:512
  ds_read_b64_tr_b16 v[120:121], v31 offset:8192
  ds_read_b64_tr_b16 v[122:123], v31 offset:8704
  s_waitcnt lgkmcnt(0)
  s_barrier
  v_add_u32 v30, 32768, v3
  ds_write_b128 v30, v[108:111] offset:0
  ds_write_b128 v30, v[112:115] offset:1024
  ds_write_b128 v30, v[116:119] offset:2048
  ds_write_b128 v30, v[120:123] offset:3072
  s_waitcnt lgkmcnt(0)
  s_waitcnt vmcnt(16)
  s_barrier
  v_add_u32 v30, 49152, v28
  v_add_u32 v31, 49152, v29
  ds_read_b64_tr_b16 v[108:109], v30 offset:0
  ds_read_b64_tr_b16 v[110:111], v30 offset:512
  ds_read_b64_tr_b16 v[112:113], v30 offset:8192
  ds_read_b64_tr_b16 v[114:115], v30 offset:8704
  ds_read_b64_tr_b16 v[116:117], v31 offset:0
  ds_read_b64_tr_b16 v[118:119], v31 offset:512
  ds_read_b64_tr_b16 v[120:121], v31 offset:8192
  ds_read_b64_tr_b16 v[122:123], v31 offset:8704
  s_waitcnt lgkmcnt(0)
  s_barrier
  v_add_u32 v30, 49152, v3
  ds_write_b128 v30, v[108:111] offset:0
  ds_write_b128 v30, v[112:115] offset:1024
  ds_write_b128 v30, v[116:119] offset:2048
  ds_write_b128 v30, v[120:123] offset:3072
  s_waitcnt lgkmcnt(0)
  s_waitcnt vmcnt(12)
  s_barrier
  v_add_u32 v30, 65536, v28
  v_add_u32 v31, 65536, v29
  ds_read_b64_tr_b16 v[108:109], v30 offset:0
  ds_read_b64_tr_b16 v[110:111], v30 offset:512
  ds_read_b64_tr_b16 v[112:113], v30 offset:8192
  ds_read_b64_tr_b16 v[114:115], v30 offset:8704
  ds_read_b64_tr_b16 v[116:117], v31 offset:0
  ds_read_b64_tr_b16 v[118:119], v31 offset:512
  ds_read_b64_tr_b16 v[120:121], v31 offset:8192
  ds_read_b64_tr_b16 v[122:123], v31 offset:8704
  s_waitcnt lgkmcnt(0)
  s_barrier
  v_add_u32 v30, 65536, v3
  ds_write_b128 v30, v[108:111] offset:0
  ds_write_b128 v30, v[112:115] offset:1024
  ds_write_b128 v30, v[116:119] offset:2048
  ds_write_b128 v30, v[120:123] offset:3072
  s_waitcnt lgkmcnt(0)
  s_waitcnt vmcnt(8)
  s_barrier
  v_add_u32 v30, 81920, v28
  v_add_u32 v31, 81920, v29
  ds_read_b64_tr_b16 v[108:109], v30 offset:0
  ds_read_b64_tr_b16 v[110:111], v30 offset:512
  ds_read_b64_tr_b16 v[112:113], v30 offset:8192
  ds_read_b64_tr_b16 v[114:115], v30 offset:8704
  ds_read_b64_tr_b16 v[116:117], v31 offset:0
  ds_read_b64_tr_b16 v[118:119], v31 offset:512
  ds_read_b64_tr_b16 v[120:121], v31 offset:8192
  ds_read_b64_tr_b16 v[122:123], v31 offset:8704
  s_waitcnt lgkmcnt(0)
  s_barrier
  v_add_u32 v30, 81920, v3
  ds_write_b128 v30, v[108:111] offset:0
  ds_write_b128 v30, v[112:115] offset:1024
  ds_write_b128 v30, v[116:119] offset:2048
  ds_write_b128 v30, v[120:123] offset:3072
  s_waitcnt lgkmcnt(0)
  s_waitcnt vmcnt(4)
  s_barrier
  v_add_u32 v30, 98304, v28
  v_add_u32 v31, 98304, v29
  ds_read_b64_tr_b16 v[108:109], v30 offset:0
  ds_read_b64_tr_b16 v[110:111], v30 offset:512
  ds_read_b64_tr_b16 v[112:113], v30 offset:8192
  ds_read_b64_tr_b16 v[114:115], v30 offset:8704
  ds_read_b64_tr_b16 v[116:117], v31 offset:0
  ds_read_b64_tr_b16 v[118:119], v31 offset:512
  ds_read_b64_tr_b16 v[120:121], v31 offset:8192
  ds_read_b64_tr_b16 v[122:123], v31 offset:8704
  s_waitcnt lgkmcnt(0)
  s_barrier
  v_add_u32 v30, 98304, v3
  ds_write_b128 v30, v[108:111] offset:0
  ds_write_b128 v30, v[112:115] offset:1024
  ds_write_b128 v30, v[116:119] offset:2048
  ds_write_b128 v30, v[120:123] offset:3072
  s_waitcnt lgkmcnt(0)
  s_waitcnt vmcnt(0)
  s_barrier
  v_add_u32 v30, 114688, v28
  v_add_u32 v31, 114688, v29
  ds_read_b64_tr_b16 v[108:109], v30 offset:0
  ds_read_b64_tr_b16 v[110:111], v30 offset:512
  ds_read_b64_tr_b16 v[112:113], v30 offset:8192
  ds_read_b64_tr_b16 v[114:115], v30 offset:8704
  ds_read_b64_tr_b16 v[116:117], v31 offset:0
  ds_read_b64_tr_b16 v[118:119], v31 offset:512
  ds_read_b64_tr_b16 v[120:121], v31 offset:8192
  ds_read_b64_tr_b16 v[122:123], v31 offset:8704
  s_waitcnt lgkmcnt(0)
  s_barrier
  v_add_u32 v30, 114688, v3
  ds_write_b128 v30, v[108:111] offset:0
  ds_write_b128 v30, v[112:115] offset:1024
  ds_write_b128 v30, v[116:119] offset:2048
  ds_write_b128 v30, v[120:123] offset:3072
  s_waitcnt lgkmcnt(0)
  s_lshl_b32 s68, s44, 15
  v_add_u32 v3, s68, v3
  s_mov_b32 s48, s22
  s_and_b32 s49, s23, 0xffff
  s_mov_b32 s50, 0x2000
  s_mov_b32 s51, 0x20000
  v_bfe_u32 v22, v0, 1, 3
  v_lshlrev_b32 v23, 10, v22
  v_lshrrev_b32 v22, 5, v0
  v_lshl_add_u32 v23, v22, 6, v23
  v_bfe_u32 v22, v0, 4, 1
  v_lshl_add_u32 v23, v22, 4, v23
  v_and_b32 v22, 1, v0
  v_lshl_add_u32 v23, v22, 3, v23
  s_lshl_b32 s68, s44, 8
  buffer_load_dwordx2 v[92:93], v23, s[48:51], s68 offen
  buffer_load_dwordx2 v[94:95], v23, s[48:51], s68 offen offset:32
  buffer_load_dwordx2 v[96:97], v23, s[48:51], s68 offen offset:128
  buffer_load_dwordx2 v[98:99], v23, s[48:51], s68 offen offset:160
  v_lshlrev_b32 v0, 4, v0
  v_add_u32 v0, 147456, v0
  s_mov_b32 s68, 0x05040100
  s_mov_b32 s69, 0x07060302
  s_waitcnt vmcnt(0)
  v_perm_b32 v20, v94, v92, s68
  v_perm_b32 v21, v94, v92, s69
  v_perm_b32 v22, v95, v93, s68
  v_perm_b32 v23, v95, v93, s69
  v_min_u32 v20, -2, v20
  v_min_u32 v21, -2, v21
  v_min_u32 v22, -2, v22
  v_min_u32 v23, -2, v23
  v_perm_b32 v24, v98, v96, s68
  v_perm_b32 v25, v98, v96, s69
  v_perm_b32 v26, v99, v97, s68
  v_perm_b32 v27, v99, v97, s69
  v_min_u32 v24, -2, v24
  v_min_u32 v25, -2, v25
  v_min_u32 v26, -2, v26
  v_min_u32 v27, -2, v27
L_team_init:
  buffer_load_dword v52, v17, s[52:55], 0 offen sc1
  s_add_u32 s67, s67, 1
  s_cmp_gt_u32 s67, 1048576
  s_cbranch_scc1 L_exit
  s_waitcnt vmcnt(0)
  v_cmp_gt_u32 vcc, 32, v52
  s_cbranch_vccnz L_team_init
  buffer_load_dword v52, v17, s[52:55], 0 offen offset:128 sc1
  s_mov_b32 s60, s92
L_fs_pre:
  buffer_load_dword v4, v17, s[40:43], s60 offen sc1
  s_add_u32 s67, s67, 1
  s_cmp_gt_u32 s67, 1048576
  s_cbranch_scc1 L_exit
  s_waitcnt vmcnt(0)
  v_cmp_ne_u32 vcc, 4, v4
  s_cbranch_vccnz L_fs_pre
  v_readfirstlane_b32 s69, v52
  s_mov_b32 m0, s70
  s_mov_b32 s57, s72
  buffer_load_dwordx4 v2, s[40:43], s57 offen sc1 lds
  buffer_load_dwordx4 v2, s[40:43], s57 offen offset:1024 sc1 lds
  s_mov_b32 s56, -1
  s_mov_b32 s65, 0
  s_lshl_b32 s61, s45, 12
  s_lshl_b32 s68, s44, 10
  s_sub_u32 s61, s61, s68
  s_add_u32 s61, s61, 0xbfc0000
  s_max_i32 s93, s56, 0
  s_add_u32 s56, s56, 1
  s_xor_b32 s65, s65, 1
  s_add_u32 s58, s57, 0x1000000
  s_add_u32 s68, s56, 1
  s_min_u32 s68, s68, 63
  s_lshl_b32 s68, s68, 13
  s_add_u32 s57, s72, s68
  s_add_u32 s59, s57, s73
  s_add_u32 s68, s56, 2
  s_min_u32 s68, s68, 63
  s_lshr_b32 s68, s68, 3
  s_lshl2_add_u32 s60, s68, s92
  s_add_u32 s61, s61, 0x20000
  s_xor_b32 s70, s70, 0x2000
  ds_read_b128 v[76:79], v3 offset:0
  ds_read_b128 v[80:83], v3 offset:1024
  ds_read_b128 v[84:87], v3 offset:2048
  ds_read_b128 v[88:91], v3 offset:3072
  ds_read_b128 v[92:95], v3 offset:16384
  ds_read_b128 v[96:99], v3 offset:17408
  ds_read_b128 v[100:103], v3 offset:18432
  ds_read_b128 v[104:107], v3 offset:19456
  v_xor_b32 v3, 0x8000, v3
  ds_read_b128 v[108:111], v3 offset:0
  ds_read_b128 v[112:115], v3 offset:1024
  ds_read_b128 v[116:119], v3 offset:2048
  ds_read_b128 v[120:123], v3 offset:3072
  v_mov_b64 v[52:53], 0
  v_mov_b64 v[54:55], 0
  v_mov_b64 v[56:57], 0
  v_mov_b64 v[58:59], 0
  v_mov_b64 v[60:61], 0
  v_mov_b64 v[62:63], 0
  v_mov_b64 v[64:65], 0
  v_mov_b64 v[66:67], 0
  v_mov_b64 v[68:69], 0
  v_mov_b64 v[70:71], 0
  v_mov_b64 v[72:73], 0
  v_mov_b64 v[74:75], 0
  s_waitcnt vmcnt(0) lgkmcnt(0)
  v_xor_b32 v32, 2048, v11
  v_xor_b32 v40, 4096, v11
  v_xor_b32 v48, 6144, v11
  v_bfe_u32 v45, v2, 9, 1
  v_and_b32 v4, 0x1ff, v2
  v_lshlrev_b32 v4, 2, v4
  v_lshl_add_u32 v4, v45, 24, v4
  s_bcnt1_i32_b32 s69, s69
  s_cmp_eq_u32 s69, 1
  s_cbranch_scc0 L_entry_x
  s_branch L_entry_f
L_poll2_f:
  buffer_load_dwordx4 v[20:23], v11, s[40:43], s63 offen sc1
  buffer_load_dwordx4 v[24:27], v11, s[40:43], s63 offen offset:1024 sc1
  s_add_u32 s67, s67, 1
  s_cmp_gt_u32 s67, 1048576
  s_cbranch_scc1 L_exit
  s_nop 15
  s_nop 3
  buffer_load_dwordx4 v[28:31], v11, s[40:43], s63 offen sc1
  buffer_load_dwordx4 v[36:39], v11, s[40:43], s63 offen offset:1024 sc1
L_entry_f:
  s_waitcnt vmcnt(3)
  ds_write_b128 v11, v[20:23]
  v_smfmac_f32_16x16x64_bf16 v[52:55], v[20:23], a[0:7], v1
  s_waitcnt vmcnt(2)
  ds_write_b128 v11, v[24:27] offset:1024
  v_max3_u32 v44, v20, v21, v22
  v_smfmac_f32_16x16x64_bf16 v[56:59], v[20:23], a[64:71], v1
  v_max3_u32 v45, v23, v24, v25
  v_max3_u32 v44, v44, v26, v27
  v_smfmac_f32_16x16x64_bf16 v[52:55], v[24:27], a[8:15], v1
  v_max_u32 v44, v44, v45
  v_cmp_eq_u32 vcc, -1, v44
  v_smfmac_f32_16x16x64_bf16 v[56:59], v[24:27], a[72:79], v1
  s_mov_b32 m0, s71
  v_smfmac_f32_16x16x64_bf16 v[60:63], v[20:23], a[128:135], v1
  s_cbranch_vccnz L_retry2_f
  s_waitcnt vmcnt(0)
  v_smfmac_f32_16x16x64_bf16 v[64:67], v[20:23], a[192:199], v1
  buffer_load_dwordx4 v2, s[40:43], s58 offen offset:0 sc1 lds
  buffer_load_dwordx4 v2, s[40:43], s58 offen offset:1024 sc1 lds
  v_smfmac_f32_16x16x64_bf16 v[60:63], v[24:27], a[136:143], v1
  s_waitcnt lgkmcnt(0)
  s_barrier
  ds_read_b128 v[28:31], v32 offset:0
  v_smfmac_f32_16x16x64_bf16 v[64:67], v[24:27], a[200:207], v1
  ds_read_b128 v[32:35], v32 offset:1024
  ds_read_b128 v[36:39], v40 offset:0
  v_smfmac_f32_16x16x64_bf16 v[68:71], v[20:23], v[76:83], v1
  ds_read_b128 v[40:43], v40 offset:1024
  ds_read_b128 v[44:47], v48 offset:0
  v_smfmac_f32_16x16x64_bf16 v[72:75], v[20:23], v[84:91], v1
  ds_read_b128 v[48:51], v48 offset:1024
  v_smfmac_f32_16x16x64_bf16 v[68:71], v[24:27], v[92:99], v1
  buffer_load_dword v4, v4, s[40:43], s59 offen sc1
  v_mov_b32 v16, s93
  v_smfmac_f32_16x16x64_bf16 v[72:75], v[24:27], v[100:107], v1
  s_waitcnt lgkmcnt(5)
  ds_read_b128 v[76:79], v3 offset:16384
  v_smfmac_f32_16x16x64_bf16 v[52:55], v[28:31], a[16:23], v1
  s_waitcnt lgkmcnt(5)
  ds_read_b128 v[80:83], v3 offset:17408
  v_smfmac_f32_16x16x64_bf16 v[52:55], v[32:35], a[24:31], v1
  s_waitcnt lgkmcnt(5)
  ds_read_b128 v[84:87], v3 offset:18432
  v_smfmac_f32_16x16x64_bf16 v[52:55], v[36:39], a[32:39], v1
  s_waitcnt lgkmcnt(5)
  ds_read_b128 v[88:91], v3 offset:19456
  v_xor_b32 v3, 0x18000, v3
  v_smfmac_f32_16x16x64_bf16 v[52:55], v[40:43], a[40:47], v1
  s_waitcnt lgkmcnt(4)
  ds_read_b128 v[92:95], v0 offset:0
  buffer_load_dword v4, v17, s[40:43], s60 offen sc1
  v_smfmac_f32_16x16x64_bf16 v[52:55], v[44:47], a[48:55], v1
  ds_read_b128 v[96:99], v0 offset:2048
  v_smfmac_f32_16x16x64_bf16 v[52:55], v[48:51], a[56:63], v1
  ds_read_b128 v[100:103], v0 offset:4096
  buffer_store_dword v16, v17, s[40:43], s66 offen sc1
  v_smfmac_f32_16x16x64_bf16 v[68:71], v[28:31], v[108:115], v1
  s_mov_b32 m0, s70
  ds_read_b128 v[104:107], v0 offset:6144
  v_smfmac_f32_16x16x64_bf16 v[56:59], v[28:31], a[80:87], v1
  s_nop 0
  ds_read_b128 v[108:111], v3 offset:0
  v_add_f32 v52, v52, v53
  v_smfmac_f32_16x16x64_bf16 v[56:59], v[32:35], a[88:95], v1
  ds_read_b128 v[112:115], v3 offset:1024
  v_add_f32 v54, v54, v55
  v_smfmac_f32_16x16x64_bf16 v[72:75], v[28:31], v[116:123], v1
  ds_read_b128 v[20:23], v0 offset:1024
  v_mul_f32 v52, s88, v52
  v_smfmac_f32_16x16x64_bf16 v[56:59], v[36:39], a[96:103], v1
  ds_read_b128 v[116:119], v3 offset:2048
  v_mul_f32 v54, s88, v54
  v_smfmac_f32_16x16x64_bf16 v[56:59], v[40:43], a[104:111], v1
  ds_read_b128 v[120:123], v3 offset:3072
  v_cvt_pk_bf16_f32 v52, v52, v52
  v_smfmac_f32_16x16x64_bf16 v[56:59], v[44:47], a[112:119], v1
  ds_read_b128 v[24:27], v0 offset:3072
  v_cvt_pk_bf16_f32 v53, v54, v54
  v_smfmac_f32_16x16x64_bf16 v[56:59], v[48:51], a[120:127], v1
  s_waitcnt lgkmcnt(10)
  s_nop 0
  v_smfmac_f32_16x16x64_bf16 v[68:71], v[32:35], v[76:83], v1
  s_nop 0
  buffer_store_dwordx4 v[124:127], v2, s[40:43], s61 offen sc1
  v_smfmac_f32_16x16x64_bf16 v[72:75], v[32:35], v[84:91], v1
  s_nop 0
  ds_read_b128 v[76:79], v3 offset:16384
  v_add_f32 v56, v56, v57
  v_smfmac_f32_16x16x64_bf16 v[60:63], v[28:31], a[144:151], v1
  ds_read_b128 v[80:83], v3 offset:17408
  v_add_f32 v58, v58, v59
  v_smfmac_f32_16x16x64_bf16 v[60:63], v[32:35], a[152:159], v1
  s_waitcnt lgkmcnt(3)
  ds_read_b128 v[84:87], v3 offset:18432
  v_mul_f32 v56, s88, v56
  v_smfmac_f32_16x16x64_bf16 v[68:71], v[36:39], v[108:115], v1
  ds_read_b128 v[88:91], v3 offset:19456
  v_mul_f32 v58, s88, v58
  v_smfmac_f32_16x16x64_bf16 v[60:63], v[36:39], a[160:167], v1
  v_xor_b32 v3, 0x8000, v3
  v_cvt_pk_bf16_f32 v56, v56, v56
  v_smfmac_f32_16x16x64_bf16 v[72:75], v[36:39], v[116:123], v1
  ds_read_b128 v[108:111], v3 offset:0
  v_cvt_pk_bf16_f32 v57, v58, v58
  v_smfmac_f32_16x16x64_bf16 v[60:63], v[40:43], a[168:175], v1
  s_waitcnt lgkmcnt(3)
  ds_write2st64_b64 v5, v[52:53], v[56:57] offset0:0 offset1:4
  v_smfmac_f32_16x16x64_bf16 v[68:71], v[40:43], v[76:83], v1
  ds_read_b128 v[112:115], v3 offset:1024
  v_smfmac_f32_16x16x64_bf16 v[60:63], v[44:47], a[176:183], v1
  s_waitcnt lgkmcnt(3)
  ds_read_b128 v[116:119], v3 offset:16384
  v_smfmac_f32_16x16x64_bf16 v[72:75], v[40:43], v[84:91], v1
  ds_read_b128 v[120:123], v3 offset:17408
  v_smfmac_f32_16x16x64_bf16 v[60:63], v[48:51], a[184:191], v1
  v_smfmac_f32_16x16x64_bf16 v[64:67], v[28:31], a[208:215], v1
  s_waitcnt lgkmcnt(3)
  s_barrier
  v_smfmac_f32_16x16x64_bf16 v[64:67], v[32:35], a[216:223], v1
  s_waitcnt lgkmcnt(2)
  ds_read_b64_tr_b16 v[76:77], v6 offset:0
  ds_read_b64_tr_b16 v[78:79], v6 offset:2048
  v_smfmac_f32_16x16x64_bf16 v[68:71], v[44:47], v[108:115], v1
  ds_read_b64_tr_b16 v[80:81], v6 offset:512
  ds_read_b64_tr_b16 v[82:83], v6 offset:2560
  v_smfmac_f32_16x16x64_bf16 v[64:67], v[36:39], a[224:231], v1
  s_waitcnt lgkmcnt(4)
  ds_read_b64_tr_b16 v[84:85], v6 offset:1024
  ds_read_b64_tr_b16 v[86:87], v6 offset:3072
  v_smfmac_f32_16x16x64_bf16 v[68:71], v[48:51], v[116:123], v1
  ds_read_b64_tr_b16 v[88:89], v6 offset:1536
  ds_read_b64_tr_b16 v[90:91], v6 offset:3584
  v_smfmac_f32_16x16x64_bf16 v[64:67], v[40:43], a[232:239], v1
  ds_read_b128 v[28:31], v0 offset:5120
  v_add_f32 v60, v60, v61
  v_smfmac_f32_16x16x64_bf16 v[64:67], v[44:47], a[240:247], v1
  ds_read_b128 v[32:35], v0 offset:7168
  v_add_f32 v62, v62, v63
  v_smfmac_f32_16x16x64_bf16 v[64:67], v[48:51], a[248:255], v1
  s_waitcnt lgkmcnt(8)
  ds_read_b128 v[108:111], v3 offset:2048
  v_cvt_pk_bf16_f32 v124, v60, v62
  v_mfma_f32_16x16x32_bf16 v[52:55], v[92:95], v[76:79], 0
  s_waitcnt lgkmcnt(3)
  ds_read_b128 v[112:115], v3 offset:3072
  buffer_load_dwordx4 v2, s[40:43], s57 offen offset:0 sc1 lds
  v_mfma_f32_16x16x32_bf16 v[52:55], v[96:99], v[80:83], v[52:55]
  v_add_f32 v64, v64, v65
  v_add_f32 v66, v66, v67
  v_mfma_f32_16x16x32_bf16 v[52:55], v[100:103], v[84:87], v[52:55]
  ds_read_b128 v[116:119], v3 offset:18432
  v_cvt_pk_bf16_f32 v125, v64, v66
  v_mfma_f32_16x16x32_bf16 v[52:55], v[104:107], v[88:91], v[52:55]
  ds_write2st64_b32 v5, v124, v125 offset0:16 offset1:24
  v_add_f32 v68, v68, v69
  v_mfma_f32_16x16x32_bf16 v[56:59], v[20:23], v[76:79], 0
  s_waitcnt lgkmcnt(4)
  ds_read_b128 v[120:123], v3 offset:19456
  v_add_f32 v70, v70, v71
  v_mfma_f32_16x16x32_bf16 v[56:59], v[24:27], v[80:83], v[56:59]
  s_nop 0
  v_exp_f32 v20, v52
  v_mfma_f32_16x16x32_bf16 v[56:59], v[28:31], v[84:87], v[56:59]
  s_waitcnt vmcnt(5)
  v_exp_f32 v21, v53
  v_mfma_f32_16x16x32_bf16 v[56:59], v[32:35], v[88:91], v[56:59]
  s_waitcnt lgkmcnt(1)
  s_barrier
  ds_read_b64_tr_b16 v[92:93], v6 offset:4096
  ds_read_b64_tr_b16 v[94:95], v6 offset:6144
  ds_read_b64_tr_b16 v[96:97], v6 offset:4608
  ds_read_b64_tr_b16 v[98:99], v6 offset:6656
  v_smfmac_f32_16x16x64_bf16 v[72:75], v[44:47], v[108:115], v1
  s_waitcnt lgkmcnt(4)
  ds_read_b64_tr_b16 v[100:101], v6 offset:5120
  ds_read_b64_tr_b16 v[102:103], v6 offset:7168
  v_smfmac_f32_16x16x64_bf16 v[72:75], v[48:51], v[116:123], v1
  ds_read_b64_tr_b16 v[104:105], v6 offset:5632
  ds_read_b64_tr_b16 v[106:107], v6 offset:7680
  v_exp_f32 v22, v54
  v_exp_f32 v23, v55
  v_cvt_pk_bf16_f32 v24, v20, v21
  v_exp_f32 v20, v56
  s_waitcnt lgkmcnt(4)
  v_mfma_f32_16x16x32_bf16 v[60:63], v[92:95], v[76:79], 0
  ds_read_b128 v[36:39], v2 offset:8192
  ds_read_b128 v[40:43], v2 offset:9216
  v_mfma_f32_16x16x32_bf16 v[60:63], v[96:99], v[80:83], v[60:63]
  s_waitcnt lgkmcnt(2)
  v_cvt_pk_bf16_f32 v25, v22, v23
  v_exp_f32 v21, v57
  v_mfma_f32_16x16x32_bf16 v[60:63], v[100:103], v[84:87], v[60:63]
  v_exp_f32 v22, v58
  v_mfma_f32_16x16x32_bf16 v[60:63], v[104:107], v[88:91], v[60:63]
  s_cmp_eq_u32 s56, 63
  v_exp_f32 v23, v59
  v_cvt_pk_bf16_f32 v26, v20, v21
  v_cvt_pk_bf16_f32 v27, v22, v23
  v_add_f32 v72, v72, v73
  v_add_f32 v74, v74, v75
  v_mfma_f32_16x16x32_bf16 v[64:67], v[12:15], v[24:27], 0
  s_waitcnt lgkmcnt(0)
  v_exp_f32 v20, v60
  v_mfma_f32_16x16x32_bf16 v[80:83], v[36:39], v[24:27], 0
  v_exp_f32 v21, v61
  v_mfma_f32_16x16x32_bf16 v[84:87], v[40:43], v[24:27], 0
  v_cvt_pk_bf16_f32 v16, v20, v21
  v_cvt_pk_bf16_f32 v126, v68, v70
  v_cvt_pk_bf16_f32 v127, v72, v74
  v_mfma_f32_16x16x16_bf16 v[64:67], v[12:13], v[16:17], v[64:67]
  s_cbranch_scc1 L_team_last
  v_cvt_pk_bf16_f32 v19, v20, v21
  v_xor_b32 v3, 0x18000, v3
  v_mfma_f32_16x16x16_bf16 v[80:83], v[126:127], v[16:17], v[80:83]
  buffer_load_dwordx4 v2, s[40:43], s57 offen offset:1024 sc1 lds
  v_mov_b64 v[44:45], 0
  v_mov_b64 v[46:47], 0
  v_mfma_f32_16x16x16_bf16 v[84:87], v[126:127], v[18:19], v[84:87]
  v_rcp_f32 v65, v64
  v_subrev_u32 v66, s89, v64
  v_cmp_le_u32 vcc, s91, v66
  v_mov_b64 v[48:49], 0
L_smback_f:
  v_mul_f32 v80, v80, v65
  v_mul_f32 v81, v81, v65
  v_mul_f32 v82, v82, v65
  v_mul_f32 v83, v83, v65
  v_cvt_pk_bf16_f32 v88, v80, v81
  v_cvt_pk_bf16_f32 v89, v82, v83
  v_mul_f32 v84, v84, v65
  v_mul_f32 v85, v85, v65
  v_mul_f32 v86, v86, v65
  v_mul_f32 v87, v87, v65
  v_cvt_pk_bf16_f32 v90, v84, v85
  v_cvt_pk_bf16_f32 v91, v86, v87
  s_cbranch_vccnz L_smslow_f
  ds_write_b128 v7, v[88:91]
  v_mov_b64 v[50:51], 0
  v_mov_b64 v[36:37], 0
  v_mov_b64 v[38:39], 0
  v_mov_b64 v[40:41], 0
  v_mov_b64 v[42:43], 0
  v_xor_b32 v96, 512, v7
  v_xor_b32 v100, 1024, v7
  v_xor_b32 v104, 1536, v7
  v_lshrrev_b32 v24, 16, v12
  v_cndmask_b32 v24, v24, 1.0, s[94:95]
  s_waitcnt lgkmcnt(0)
  s_barrier
  ds_read_b128 v[96:99], v96
  ds_read_b128 v[100:103], v100
  ds_read_b128 v[104:107], v104
  v_smfmac_f32_16x16x64_bf16 v[36:39], v[88:91], v[128:135], v1
  v_cndmask_b32 v20, 0, v24, s[80:81]
  v_smfmac_f32_16x16x64_bf16 v[40:43], v[88:91], v[160:167], v1
  v_cndmask_b32 v21, 0, v24, s[82:83]
  v_smfmac_f32_16x16x64_bf16 v[44:47], v[88:91], v[192:199], v1
  v_cndmask_b32 v22, 0, v24, s[84:85]
  v_smfmac_f32_16x16x64_bf16 v[48:51], v[88:91], v[224:231], v1
  v_cndmask_b32 v23, 0, v24, s[86:87]
  s_waitcnt lgkmcnt(2)
  v_smfmac_f32_16x16x64_bf16 v[36:39], v[96:99], v[136:143], v1
  s_waitcnt lgkmcnt(1)
  v_mov_b64 v[52:53], 0
  v_smfmac_f32_16x16x64_bf16 v[36:39], v[100:103], v[144:151], v1
  s_waitcnt lgkmcnt(0)
  v_mov_b64 v[54:55], 0
  v_smfmac_f32_16x16x64_bf16 v[36:39], v[104:107], v[152:159], v1
  s_nop 1
  v_mov_b64 v[56:57], 0
  v_smfmac_f32_16x16x64_bf16 v[40:43], v[96:99], v[168:175], v1
  s_nop 1
  v_mov_b64 v[58:59], 0
  v_smfmac_f32_16x16x64_bf16 v[40:43], v[100:103], v[176:183], v1
  v_cvt_pk_bf16_f32 v36, v36, v37
  v_smfmac_f32_16x16x64_bf16 v[40:43], v[104:107], v[184:191], v1
  s_nop 1
  v_cvt_pk_bf16_f32 v37, v38, v39
  v_smfmac_f32_16x16x64_bf16 v[44:47], v[96:99], v[200:207], v1
  s_nop 1
  v_and_or_b32 v36, v36, -2, s65
  v_smfmac_f32_16x16x64_bf16 v[44:47], v[100:103], v[208:215], v1
  buffer_store_dwordx2 v[36:37], v8, s[40:43], s74 offen
  v_cvt_pk_bf16_f32 v40, v40, v41
  v_smfmac_f32_16x16x64_bf16 v[44:47], v[104:107], v[216:223], v1
  s_nop 1
  v_cvt_pk_bf16_f32 v41, v42, v43
  v_smfmac_f32_16x16x64_bf16 v[48:51], v[96:99], v[232:239], v1
  s_nop 1
  v_and_or_b32 v40, v40, -2, s65
  v_smfmac_f32_16x16x64_bf16 v[48:51], v[100:103], v[240:247], v1
  buffer_store_dwordx2 v[40:41], v8, s[40:43], s75 offen
  v_cvt_pk_bf16_f32 v44, v44, v45
  v_smfmac_f32_16x16x64_bf16 v[48:51], v[104:107], v[248:255], v1
  s_nop 1
  v_cvt_pk_bf16_f32 v45, v46, v47
  v_and_or_b32 v44, v44, -2, s65
  buffer_store_dwordx2 v[44:45], v8, s[40:43], s76 offen
  s_nop 2
  v_cvt_pk_bf16_f32 v48, v48, v49
  v_cvt_pk_bf16_f32 v49, v50, v51
  v_and_or_b32 v48, v48, -2, s65
  buffer_store_dwordx2 v[48:49], v8, s[40:43], s77 offen
  s_nop 15
  s_nop 9
  s_cmp_lt_u32 s44, 1
  s_cbranch_scc1 L_poll1_f
  s_nop 9
  s_cmp_lt_u32 s44, 2
  s_cbranch_scc1 L_poll1_f
  s_nop 9
  s_cmp_lt_u32 s44, 3
  s_cbranch_scc1 L_poll1_f
  s_nop 9
L_poll1_f:
  buffer_load_dwordx4 v[28:31], v9, s[40:43], s62 offen sc1
  buffer_load_dwordx4 v[32:35], v9, s[40:43], s62 offen offset:1024 sc1
  v_mov_b64 v[60:61], 0
  v_mov_b64 v[62:63], 0
  v_mov_b64 v[64:65], 0
  v_mov_b64 v[66:67], 0
  v_mov_b64 v[68:69], 0
  v_mov_b64 v[70:71], 0
  v_mov_b64 v[72:73], 0
  v_mov_b64 v[74:75], 0
  s_nop 15
  s_nop 3
  buffer_load_dwordx4 v[36:39], v9, s[40:43], s62 offen sc1
  buffer_load_dwordx4 v[40:43], v9, s[40:43], s62 offen offset:1024 sc1
L_poll1b_f:
  s_waitcnt vmcnt(3)
  v_mfma_f32_16x16x32_bf16 v[24:27], v[28:31], v[20:23], 0
  v_bitop3_b32 v44, v28, v30, s65 bitop3:0x7e
  s_waitcnt vmcnt(2)
  v_mfma_f32_16x16x32_bf16 v[24:27], v[32:35], v[20:23], v[24:27]
  v_bitop3_b32 v45, v32, v34, s65 bitop3:0x7e
  v_or_b32 v44, v44, v45
  v_and_b32 v44, 1, v44
  v_cmp_ne_u32 vcc, 0, v44
  s_nop 2
  s_cbranch_vccnz L_retry1_f
L_got1_f:
  v_add_f32 v24, v24, v25
  v_add_f32 v26, v26, v27
  s_nop 1
  v_permlane16_swap_b32 v24, v26
  v_add_f32 v24, v24, v26
  v_cvt_pk_bf16_f32 v24, v24, v17
  v_min_u32 v24, s90, v24
  v_cndmask_b32 v24, v24, -1, s[78:79]
  buffer_store_short v24, v10, s[40:43], s64 offen
  ds_read_b128 v[76:79], v3 offset:0
  ds_read_b128 v[80:83], v3 offset:1024
  ds_read_b128 v[84:87], v3 offset:2048
  ds_read_b128 v[88:91], v3 offset:3072
  ds_read_b128 v[92:95], v3 offset:16384
  ds_read_b128 v[96:99], v3 offset:17408
  ds_read_b128 v[100:103], v3 offset:18432
  ds_read_b128 v[104:107], v3 offset:19456
  v_xor_b32 v3, 0x8000, v3
  ds_read_b128 v[108:111], v3 offset:0
  ds_read_b128 v[112:115], v3 offset:1024
  ds_read_b128 v[116:119], v3 offset:2048
  ds_read_b128 v[120:123], v3 offset:3072
  v_cmp_ne_u32 vcc, 4, v4
  v_xor_b32 v10, 0x2000, v10
  v_xor_b32 v11, 0x2000, v11
  v_xor_b32 v0, 0x2000, v0
  s_waitcnt vmcnt(1)
  v_xor_b32 v32, 2048, v11
  v_xor_b32 v40, 4096, v11
  v_xor_b32 v48, 6144, v11
  s_cbranch_vccnz L_fs_f
L_fsback_f:
  v_bfe_u32 v45, v2, 9, 1
  v_and_b32 v4, 0x1ff, v2
  v_lshlrev_b32 v4, 2, v4
  v_lshl_add_u32 v4, v45, 24, v4
  s_max_i32 s93, s56, 0
  s_add_u32 s56, s56, 1
  s_xor_b32 s65, s65, 1
  s_add_u32 s58, s57, 0x1000000
  s_add_u32 s68, s56, 1
  s_min_u32 s68, s68, 63
  s_lshl_b32 s68, s68, 13
  s_add_u32 s57, s72, s68
  s_add_u32 s59, s57, s73
  s_add_u32 s68, s56, 2
  s_min_u32 s68, s68, 63
  s_lshr_b32 s68, s68, 3
  s_lshl2_add_u32 s60, s68, s92
  s_add_u32 s61, s61, 0x20000
  s_xor_b32 s70, s70, 0x2000
  s_nop 9
  s_branch L_poll2_f
L_retry2_f:
  s_waitcnt vmcnt(0)
  v_max3_u32 v44, v28, v29, v30
  v_max3_u32 v45, v31, v36, v37
  v_max3_u32 v44, v44, v38, v39
  v_max_u32 v44, v44, v45
  v_cmp_eq_u32 vcc, -1, v44
  v_mov_b64 v[20:21], v[28:29]
  v_mov_b64 v[22:23], v[30:31]
  v_mov_b64 v[24:25], v[36:37]
  v_mov_b64 v[26:27], v[38:39]
  v_mov_b64 v[52:53], 0
  v_mov_b64 v[54:55], 0
  v_mov_b64 v[56:57], 0
  v_mov_b64 v[58:59], 0
  v_mov_b64 v[60:61], 0
  v_mov_b64 v[62:63], 0
  s_cbranch_vccnz L_poll2_f
  s_branch L_entry_f
L_retry1_f:
  buffer_load_dwordx4 v[28:31], v9, s[40:43], s62 offen sc1
  buffer_load_dwordx4 v[32:35], v9, s[40:43], s62 offen offset:1024 sc1
  s_add_u32 s67, s67, 1
  s_cmp_gt_u32 s67, 1048576
  s_cbranch_scc1 L_exit
  s_waitcnt vmcnt(3)
  v_mfma_f32_16x16x32_bf16 v[24:27], v[36:39], v[20:23], 0
  v_bitop3_b32 v44, v36, v38, s65 bitop3:0x7e
  s_waitcnt vmcnt(2)
  v_mfma_f32_16x16x32_bf16 v[24:27], v[40:43], v[20:23], v[24:27]
  v_bitop3_b32 v45, v40, v42, s65 bitop3:0x7e
  v_or_b32 v44, v44, v45
  v_and_b32 v44, 1, v44
  v_cmp_ne_u32 vcc, 0, v44
  s_nop 2
  s_cbranch_vccz L_got1_f
  buffer_load_dwordx4 v[36:39], v9, s[40:43], s62 offen sc1
  buffer_load_dwordx4 v[40:43], v9, s[40:43], s62 offen offset:1024 sc1
  s_branch L_poll1b_f
L_smslow_f:
  v_max3_f32 v22, v52, v53, v54
  v_max3_f32 v22, v22, v55, v56
  v_max3_f32 v22, v22, v57, v58
  v_max3_f32 v22, v22, v59, v60
  v_max_f32 v22, v22, v61
  v_mov_b32 v20, v22
  s_nop 1
  v_permlane32_swap_b32 v20, v22
  v_max_f32 v22, v22, v20
  v_mov_b32 v20, v22
  s_nop 1
  v_permlane16_swap_b32 v20, v22
  v_max_f32 v22, v22, v20
  v_sub_f32 v20, v52, v22
  v_sub_f32 v21, v53, v22
  v_exp_f32 v20, v20
  v_exp_f32 v21, v21
  s_nop 0
  v_cvt_pk_bf16_f32 v24, v20, v21
  v_sub_f32 v20, v54, v22
  v_sub_f32 v21, v55, v22
  v_exp_f32 v20, v20
  v_exp_f32 v21, v21
  s_nop 0
  v_cvt_pk_bf16_f32 v25, v20, v21
  v_sub_f32 v20, v56, v22
  v_sub_f32 v21, v57, v22
  v_exp_f32 v20, v20
  v_exp_f32 v21, v21
  s_nop 0
  v_cvt_pk_bf16_f32 v26, v20, v21
  v_sub_f32 v20, v58, v22
  v_sub_f32 v21, v59, v22
  v_exp_f32 v20, v20
  v_exp_f32 v21, v21
  s_nop 0
  v_cvt_pk_bf16_f32 v27, v20, v21
  v_sub_f32 v20, v60, v22
  v_sub_f32 v21, v61, v22
  v_exp_f32 v20, v20
  v_exp_f32 v21, v21
  s_nop 0
  v_cvt_pk_bf16_f32 v16, v20, v21
  v_cvt_pk_bf16_f32 v19, v20, v21
  s_nop 1
  v_mfma_f32_16x16x32_bf16 v[64:67], v[12:15], v[24:27], 0
  v_mfma_f32_16x16x32_bf16 v[80:83], v[36:39], v[24:27], 0
  v_mfma_f32_16x16x32_bf16 v[84:87], v[40:43], v[24:27], 0
  s_nop 3
  v_mfma_f32_16x16x16_bf16 v[64:67], v[12:13], v[16:17], v[64:67]
  v_mfma_f32_16x16x16_bf16 v[80:83], v[126:127], v[16:17], v[80:83]
  v_mfma_f32_16x16x16_bf16 v[84:87], v[126:127], v[18:19], v[84:87]
  s_nop 7
  v_rcp_f32 v65, v64
  s_mov_b64 vcc, 0
  s_branch L_smback_f
L_fs_f:
  buffer_load_dword v4, v17, s[40:43], s60 offen sc1
  s_add_u32 s67, s67, 1
  s_cmp_gt_u32 s67, 1048576
  s_cbranch_scc1 L_exit
  s_waitcnt vmcnt(0)
  v_cmp_ne_u32 vcc, 4, v4
  s_cbranch_vccnz L_fs_f
  s_branch L_fsback_f
L_poll2_x:
  buffer_load_dwordx4 v[20:23], v11, s[40:43], s63 offen sc1
  buffer_load_dwordx4 v[24:27], v11, s[40:43], s63 offen offset:1024 sc1
  s_add_u32 s67, s67, 1
  s_cmp_gt_u32 s67, 1048576
  s_cbranch_scc1 L_exit
  s_nop 15
  s_nop 3
  buffer_load_dwordx4 v[28:31], v11, s[40:43], s63 offen sc1
  buffer_load_dwordx4 v[36:39], v11, s[40:43], s63 offen offset:1024 sc1
L_entry_x:
  s_waitcnt vmcnt(3)
  ds_write_b128 v11, v[20:23]
  v_smfmac_f32_16x16x64_bf16 v[52:55], v[20:23], a[0:7], v1
  s_waitcnt vmcnt(2)
  ds_write_b128 v11, v[24:27] offset:1024
  v_max3_u32 v44, v20, v21, v22
  v_smfmac_f32_16x16x64_bf16 v[56:59], v[20:23], a[64:71], v1
  v_max3_u32 v45, v23, v24, v25
  v_max3_u32 v44, v44, v26, v27
  v_smfmac_f32_16x16x64_bf16 v[52:55], v[24:27], a[8:15], v1
  v_max_u32 v44, v44, v45
  v_cmp_eq_u32 vcc, -1, v44
  v_smfmac_f32_16x16x64_bf16 v[56:59], v[24:27], a[72:79], v1
  s_mov_b32 m0, s71
  v_smfmac_f32_16x16x64_bf16 v[60:63], v[20:23], a[128:135], v1
  s_cbranch_vccnz L_retry2_x
  s_waitcnt vmcnt(0)
  v_smfmac_f32_16x16x64_bf16 v[64:67], v[20:23], a[192:199], v1
  buffer_load_dwordx4 v2, s[40:43], s58 offen offset:0 sc1 lds
  buffer_load_dwordx4 v2, s[40:43], s58 offen offset:1024 sc1 lds
  v_smfmac_f32_16x16x64_bf16 v[60:63], v[24:27], a[136:143], v1
  s_waitcnt lgkmcnt(0)
  s_barrier
  ds_read_b128 v[28:31], v32 offset:0
  v_smfmac_f32_16x16x64_bf16 v[64:67], v[24:27], a[200:207], v1
  ds_read_b128 v[32:35], v32 offset:1024
  ds_read_b128 v[36:39], v40 offset:0
  v_smfmac_f32_16x16x64_bf16 v[68:71], v[20:23], v[76:83], v1
  ds_read_b128 v[40:43], v40 offset:1024
  ds_read_b128 v[44:47], v48 offset:0
  v_smfmac_f32_16x16x64_bf16 v[72:75], v[20:23], v[84:91], v1
  ds_read_b128 v[48:51], v48 offset:1024
  v_smfmac_f32_16x16x64_bf16 v[68:71], v[24:27], v[92:99], v1
  buffer_load_dword v4, v4, s[40:43], s59 offen sc1
  v_mov_b32 v16, s93
  v_smfmac_f32_16x16x64_bf16 v[72:75], v[24:27], v[100:107], v1
  s_waitcnt lgkmcnt(5)
  ds_read_b128 v[76:79], v3 offset:16384
  v_smfmac_f32_16x16x64_bf16 v[52:55], v[28:31], a[16:23], v1
  s_waitcnt lgkmcnt(5)
  ds_read_b128 v[80:83], v3 offset:17408
  v_smfmac_f32_16x16x64_bf16 v[52:55], v[32:35], a[24:31], v1
  s_waitcnt lgkmcnt(5)
  ds_read_b128 v[84:87], v3 offset:18432
  v_smfmac_f32_16x16x64_bf16 v[52:55], v[36:39], a[32:39], v1
  s_waitcnt lgkmcnt(5)
  ds_read_b128 v[88:91], v3 offset:19456
  v_xor_b32 v3, 0x18000, v3
  v_smfmac_f32_16x16x64_bf16 v[52:55], v[40:43], a[40:47], v1
  s_waitcnt lgkmcnt(4)
  ds_read_b128 v[92:95], v0 offset:0
  buffer_load_dword v4, v17, s[40:43], s60 offen sc1
  v_smfmac_f32_16x16x64_bf16 v[52:55], v[44:47], a[48:55], v1
  ds_read_b128 v[96:99], v0 offset:2048
  v_smfmac_f32_16x16x64_bf16 v[52:55], v[48:51], a[56:63], v1
  ds_read_b128 v[100:103], v0 offset:4096
  buffer_store_dword v16, v17, s[40:43], s66 offen sc1
  v_smfmac_f32_16x16x64_bf16 v[68:71], v[28:31], v[108:115], v1
  s_mov_b32 m0, s70
  ds_read_b128 v[104:107], v0 offset:6144
  v_smfmac_f32_16x16x64_bf16 v[56:59], v[28:31], a[80:87], v1
  s_nop 0
  ds_read_b128 v[108:111], v3 offset:0
  v_add_f32 v52, v52, v53
  v_smfmac_f32_16x16x64_bf16 v[56:59], v[32:35], a[88:95], v1
  ds_read_b128 v[112:115], v3 offset:1024
  v_add_f32 v54, v54, v55
  v_smfmac_f32_16x16x64_bf16 v[72:75], v[28:31], v[116:123], v1
  ds_read_b128 v[20:23], v0 offset:1024
  v_mul_f32 v52, s88, v52
  v_smfmac_f32_16x16x64_bf16 v[56:59], v[36:39], a[96:103], v1
  ds_read_b128 v[116:119], v3 offset:2048
  v_mul_f32 v54, s88, v54
  v_smfmac_f32_16x16x64_bf16 v[56:59], v[40:43], a[104:111], v1
  ds_read_b128 v[120:123], v3 offset:3072
  v_cvt_pk_bf16_f32 v52, v52, v52
  v_smfmac_f32_16x16x64_bf16 v[56:59], v[44:47], a[112:119], v1
  ds_read_b128 v[24:27], v0 offset:3072
  v_cvt_pk_bf16_f32 v53, v54, v54
  v_smfmac_f32_16x16x64_bf16 v[56:59], v[48:51], a[120:127], v1
  s_waitcnt lgkmcnt(10)
  s_nop 0
  v_smfmac_f32_16x16x64_bf16 v[68:71], v[32:35], v[76:83], v1
  s_nop 0
  buffer_store_dwordx4 v[124:127], v2, s[40:43], s61 offen sc1
  v_smfmac_f32_16x16x64_bf16 v[72:75], v[32:35], v[84:91], v1
  s_nop 0
  ds_read_b128 v[76:79], v3 offset:16384
  v_add_f32 v56, v56, v57
  v_smfmac_f32_16x16x64_bf16 v[60:63], v[28:31], a[144:151], v1
  ds_read_b128 v[80:83], v3 offset:17408
  v_add_f32 v58, v58, v59
  v_smfmac_f32_16x16x64_bf16 v[60:63], v[32:35], a[152:159], v1
  s_waitcnt lgkmcnt(3)
  ds_read_b128 v[84:87], v3 offset:18432
  v_mul_f32 v56, s88, v56
  v_smfmac_f32_16x16x64_bf16 v[68:71], v[36:39], v[108:115], v1
  ds_read_b128 v[88:91], v3 offset:19456
  v_mul_f32 v58, s88, v58
  v_smfmac_f32_16x16x64_bf16 v[60:63], v[36:39], a[160:167], v1
  v_xor_b32 v3, 0x8000, v3
  v_cvt_pk_bf16_f32 v56, v56, v56
  v_smfmac_f32_16x16x64_bf16 v[72:75], v[36:39], v[116:123], v1
  ds_read_b128 v[108:111], v3 offset:0
  v_cvt_pk_bf16_f32 v57, v58, v58
  v_smfmac_f32_16x16x64_bf16 v[60:63], v[40:43], a[168:175], v1
  s_waitcnt lgkmcnt(3)
  ds_write2st64_b64 v5, v[52:53], v[56:57] offset0:0 offset1:4
  v_smfmac_f32_16x16x64_bf16 v[68:71], v[40:43], v[76:83], v1
  ds_read_b128 v[112:115], v3 offset:1024
  v_smfmac_f32_16x16x64_bf16 v[60:63], v[44:47], a[176:183], v1
  s_waitcnt lgkmcnt(3)
  ds_read_b128 v[116:119], v3 offset:16384
  v_smfmac_f32_16x16x64_bf16 v[72:75], v[40:43], v[84:91], v1
  ds_read_b128 v[120:123], v3 offset:17408
  v_smfmac_f32_16x16x64_bf16 v[60:63], v[48:51], a[184:191], v1
  v_smfmac_f32_16x16x64_bf16 v[64:67], v[28:31], a[208:215], v1
  s_waitcnt lgkmcnt(3)
  s_barrier
  v_smfmac_f32_16x16x64_bf16 v[64:67], v[32:35], a[216:223], v1
  s_waitcnt lgkmcnt(2)
  ds_read_b64_tr_b16 v[76:77], v6 offset:0
  ds_read_b64_tr_b16 v[78:79], v6 offset:2048
  v_smfmac_f32_16x16x64_bf16 v[68:71], v[44:47], v[108:115], v1
  ds_read_b64_tr_b16 v[80:81], v6 offset:512
  ds_read_b64_tr_b16 v[82:83], v6 offset:2560
  v_smfmac_f32_16x16x64_bf16 v[64:67], v[36:39], a[224:231], v1
  s_waitcnt lgkmcnt(4)
  ds_read_b64_tr_b16 v[84:85], v6 offset:1024
  ds_read_b64_tr_b16 v[86:87], v6 offset:3072
  v_smfmac_f32_16x16x64_bf16 v[68:71], v[48:51], v[116:123], v1
  ds_read_b64_tr_b16 v[88:89], v6 offset:1536
  ds_read_b64_tr_b16 v[90:91], v6 offset:3584
  v_smfmac_f32_16x16x64_bf16 v[64:67], v[40:43], a[232:239], v1
  ds_read_b128 v[28:31], v0 offset:5120
  v_add_f32 v60, v60, v61
  v_smfmac_f32_16x16x64_bf16 v[64:67], v[44:47], a[240:247], v1
  ds_read_b128 v[32:35], v0 offset:7168
  v_add_f32 v62, v62, v63
  v_smfmac_f32_16x16x64_bf16 v[64:67], v[48:51], a[248:255], v1
  s_waitcnt lgkmcnt(8)
  ds_read_b128 v[108:111], v3 offset:2048
  v_cvt_pk_bf16_f32 v124, v60, v62
  v_mfma_f32_16x16x32_bf16 v[52:55], v[92:95], v[76:79], 0
  s_waitcnt lgkmcnt(3)
  ds_read_b128 v[112:115], v3 offset:3072
  buffer_load_dwordx4 v2, s[40:43], s57 offen offset:0 sc1 lds
  v_mfma_f32_16x16x32_bf16 v[52:55], v[96:99], v[80:83], v[52:55]
  v_add_f32 v64, v64, v65
  v_add_f32 v66, v66, v67
  v_mfma_f32_16x16x32_bf16 v[52:55], v[100:103], v[84:87], v[52:55]
  ds_read_b128 v[116:119], v3 offset:18432
  v_cvt_pk_bf16_f32 v125, v64, v66
  v_mfma_f32_16x16x32_bf16 v[52:55], v[104:107], v[88:91], v[52:55]
  ds_write2st64_b32 v5, v124, v125 offset0:16 offset1:24
  v_add_f32 v68, v68, v69
  v_mfma_f32_16x16x32_bf16 v[56:59], v[20:23], v[76:79], 0
  s_waitcnt lgkmcnt(4)
  ds_read_b128 v[120:123], v3 offset:19456
  v_add_f32 v70, v70, v71
  v_mfma_f32_16x16x32_bf16 v[56:59], v[24:27], v[80:83], v[56:59]
  s_nop 0
  v_exp_f32 v20, v52
  v_mfma_f32_16x16x32_bf16 v[56:59], v[28:31], v[84:87], v[56:59]
  s_waitcnt vmcnt(5)
  v_exp_f32 v21, v53
  v_mfma_f32_16x16x32_bf16 v[56:59], v[32:35], v[88:91], v[56:59]
  s_waitcnt lgkmcnt(1)
  s_barrier
  ds_read_b64_tr_b16 v[92:93], v6 offset:4096
  ds_read_b64_tr_b16 v[94:95], v6 offset:6144
  ds_read_b64_tr_b16 v[96:97], v6 offset:4608
  ds_read_b64_tr_b16 v[98:99], v6 offset:6656
  v_smfmac_f32_16x16x64_bf16 v[72:75], v[44:47], v[108:115], v1
  s_waitcnt lgkmcnt(4)
  ds_read_b64_tr_b16 v[100:101], v6 offset:5120
  ds_read_b64_tr_b16 v[102:103], v6 offset:7168
  v_smfmac_f32_16x16x64_bf16 v[72:75], v[48:51], v[116:123], v1
  ds_read_b64_tr_b16 v[104:105], v6 offset:5632
  ds_read_b64_tr_b16 v[106:107], v6 offset:7680
  v_exp_f32 v22, v54
  v_exp_f32 v23, v55
  v_cvt_pk_bf16_f32 v24, v20, v21
  v_exp_f32 v20, v56
  s_waitcnt lgkmcnt(4)
  v_mfma_f32_16x16x32_bf16 v[60:63], v[92:95], v[76:79], 0
  ds_read_b128 v[36:39], v2 offset:8192
  ds_read_b128 v[40:43], v2 offset:9216
  v_mfma_f32_16x16x32_bf16 v[60:63], v[96:99], v[80:83], v[60:63]
  s_waitcnt lgkmcnt(2)
  v_cvt_pk_bf16_f32 v25, v22, v23
  v_exp_f32 v21, v57
  v_mfma_f32_16x16x32_bf16 v[60:63], v[100:103], v[84:87], v[60:63]
  v_exp_f32 v22, v58
  v_mfma_f32_16x16x32_bf16 v[60:63], v[104:107], v[88:91], v[60:63]
  s_cmp_eq_u32 s56, 63
  v_exp_f32 v23, v59
  v_cvt_pk_bf16_f32 v26, v20, v21
  v_cvt_pk_bf16_f32 v27, v22, v23
  v_add_f32 v72, v72, v73
  v_add_f32 v74, v74, v75
  v_mfma_f32_16x16x32_bf16 v[64:67], v[12:15], v[24:27], 0
  s_waitcnt lgkmcnt(0)
  v_exp_f32 v20, v60
  v_mfma_f32_16x16x32_bf16 v[80:83], v[36:39], v[24:27], 0
  v_exp_f32 v21, v61
  v_mfma_f32_16x16x32_bf16 v[84:87], v[40:43], v[24:27], 0
  v_cvt_pk_bf16_f32 v16, v20, v21
  v_cvt_pk_bf16_f32 v126, v68, v70
  v_cvt_pk_bf16_f32 v127, v72, v74
  v_mfma_f32_16x16x16_bf16 v[64:67], v[12:13], v[16:17], v[64:67]
  s_cbranch_scc1 L_team_last
  v_cvt_pk_bf16_f32 v19, v20, v21
  v_xor_b32 v3, 0x18000, v3
  v_mfma_f32_16x16x16_bf16 v[80:83], v[126:127], v[16:17], v[80:83]
  buffer_load_dwordx4 v2, s[40:43], s57 offen offset:1024 sc1 lds
  v_mov_b64 v[44:45], 0
  v_mov_b64 v[46:47], 0
  v_mfma_f32_16x16x16_bf16 v[84:87], v[126:127], v[18:19], v[84:87]
  v_rcp_f32 v65, v64
  v_subrev_u32 v66, s89, v64
  v_cmp_le_u32 vcc, s91, v66
  v_mov_b64 v[48:49], 0
L_smback_x:
  v_mul_f32 v80, v80, v65
  v_mul_f32 v81, v81, v65
  v_mul_f32 v82, v82, v65
  v_mul_f32 v83, v83, v65
  v_cvt_pk_bf16_f32 v88, v80, v81
  v_cvt_pk_bf16_f32 v89, v82, v83
  v_mul_f32 v84, v84, v65
  v_mul_f32 v85, v85, v65
  v_mul_f32 v86, v86, v65
  v_mul_f32 v87, v87, v65
  v_cvt_pk_bf16_f32 v90, v84, v85
  v_cvt_pk_bf16_f32 v91, v86, v87
  s_cbranch_vccnz L_smslow_x
  ds_write_b128 v7, v[88:91]
  v_mov_b64 v[50:51], 0
  v_mov_b64 v[36:37], 0
  v_mov_b64 v[38:39], 0
  v_mov_b64 v[40:41], 0
  v_mov_b64 v[42:43], 0
  v_xor_b32 v96, 512, v7
  v_xor_b32 v100, 1024, v7
  v_xor_b32 v104, 1536, v7
  v_lshrrev_b32 v24, 16, v12
  v_cndmask_b32 v24, v24, 1.0, s[94:95]
  s_waitcnt lgkmcnt(0)
  s_barrier
  ds_read_b128 v[96:99], v96
  ds_read_b128 v[100:103], v100
  ds_read_b128 v[104:107], v104
  v_smfmac_f32_16x16x64_bf16 v[36:39], v[88:91], v[128:135], v1
  v_cndmask_b32 v20, 0, v24, s[80:81]
  v_smfmac_f32_16x16x64_bf16 v[40:43], v[88:91], v[160:167], v1
  v_cndmask_b32 v21, 0, v24, s[82:83]
  v_smfmac_f32_16x16x64_bf16 v[44:47], v[88:91], v[192:199], v1
  v_cndmask_b32 v22, 0, v24, s[84:85]
  v_smfmac_f32_16x16x64_bf16 v[48:51], v[88:91], v[224:231], v1
  v_cndmask_b32 v23, 0, v24, s[86:87]
  s_waitcnt lgkmcnt(2)
  v_smfmac_f32_16x16x64_bf16 v[36:39], v[96:99], v[136:143], v1
  s_waitcnt lgkmcnt(1)
  v_mov_b64 v[52:53], 0
  v_smfmac_f32_16x16x64_bf16 v[36:39], v[100:103], v[144:151], v1
  s_waitcnt lgkmcnt(0)
  v_mov_b64 v[54:55], 0
  v_smfmac_f32_16x16x64_bf16 v[36:39], v[104:107], v[152:159], v1
  s_nop 1
  v_mov_b64 v[56:57], 0
  v_smfmac_f32_16x16x64_bf16 v[40:43], v[96:99], v[168:175], v1
  s_nop 1
  v_mov_b64 v[58:59], 0
  v_smfmac_f32_16x16x64_bf16 v[40:43], v[100:103], v[176:183], v1
  v_cvt_pk_bf16_f32 v36, v36, v37
  v_smfmac_f32_16x16x64_bf16 v[40:43], v[104:107], v[184:191], v1
  s_nop 1
  v_cvt_pk_bf16_f32 v37, v38, v39
  v_smfmac_f32_16x16x64_bf16 v[44:47], v[96:99], v[200:207], v1
  s_nop 1
  v_and_or_b32 v36, v36, -2, s65
  v_smfmac_f32_16x16x64_bf16 v[44:47], v[100:103], v[208:215], v1
  buffer_store_dwordx2 v[36:37], v8, s[40:43], s74 offen sc1
  v_cvt_pk_bf16_f32 v40, v40, v41
  v_smfmac_f32_16x16x64_bf16 v[44:47], v[104:107], v[216:223], v1
  s_nop 1
  v_cvt_pk_bf16_f32 v41, v42, v43
  v_smfmac_f32_16x16x64_bf16 v[48:51], v[96:99], v[232:239], v1
  s_nop 1
  v_and_or_b32 v40, v40, -2, s65
  v_smfmac_f32_16x16x64_bf16 v[48:51], v[100:103], v[240:247], v1
  buffer_store_dwordx2 v[40:41], v8, s[40:43], s75 offen sc1
  v_cvt_pk_bf16_f32 v44, v44, v45
  v_smfmac_f32_16x16x64_bf16 v[48:51], v[104:107], v[248:255], v1
  s_nop 1
  v_cvt_pk_bf16_f32 v45, v46, v47
  v_and_or_b32 v44, v44, -2, s65
  buffer_store_dwordx2 v[44:45], v8, s[40:43], s76 offen sc1
  s_nop 2
  v_cvt_pk_bf16_f32 v48, v48, v49
  v_cvt_pk_bf16_f32 v49, v50, v51
  v_and_or_b32 v48, v48, -2, s65
  buffer_store_dwordx2 v[48:49], v8, s[40:43], s77 offen sc1
  s_nop 15
  s_nop 9
  s_cmp_lt_u32 s44, 1
  s_cbranch_scc1 L_poll1_x
  s_nop 9
  s_cmp_lt_u32 s44, 2
  s_cbranch_scc1 L_poll1_x
  s_nop 9
  s_cmp_lt_u32 s44, 3
  s_cbranch_scc1 L_poll1_x
  s_nop 9
L_poll1_x:
  buffer_load_dwordx4 v[28:31], v9, s[40:43], s62 offen sc1
  buffer_load_dwordx4 v[32:35], v9, s[40:43], s62 offen offset:1024 sc1
  v_mov_b64 v[60:61], 0
  v_mov_b64 v[62:63], 0
  v_mov_b64 v[64:65], 0
  v_mov_b64 v[66:67], 0
  v_mov_b64 v[68:69], 0
  v_mov_b64 v[70:71], 0
  v_mov_b64 v[72:73], 0
  v_mov_b64 v[74:75], 0
  s_nop 15
  s_nop 3
  buffer_load_dwordx4 v[36:39], v9, s[40:43], s62 offen sc1
  buffer_load_dwordx4 v[40:43], v9, s[40:43], s62 offen offset:1024 sc1
L_poll1b_x:
  s_waitcnt vmcnt(3)
  v_mfma_f32_16x16x32_bf16 v[24:27], v[28:31], v[20:23], 0
  v_bitop3_b32 v44, v28, v30, s65 bitop3:0x7e
  s_waitcnt vmcnt(2)
  v_mfma_f32_16x16x32_bf16 v[24:27], v[32:35], v[20:23], v[24:27]
  v_bitop3_b32 v45, v32, v34, s65 bitop3:0x7e
  v_or_b32 v44, v44, v45
  v_and_b32 v44, 1, v44
  v_cmp_ne_u32 vcc, 0, v44
  s_nop 2
  s_cbranch_vccnz L_retry1_x
L_got1_x:
  v_add_f32 v24, v24, v25
  v_add_f32 v26, v26, v27
  s_nop 1
  v_permlane16_swap_b32 v24, v26
  v_add_f32 v24, v24, v26
  v_cvt_pk_bf16_f32 v24, v24, v17
  v_min_u32 v24, s90, v24
  v_cndmask_b32 v24, v24, -1, s[78:79]
  buffer_store_short v24, v10, s[40:43], s64 offen sc1
  ds_read_b128 v[76:79], v3 offset:0
  ds_read_b128 v[80:83], v3 offset:1024
  ds_read_b128 v[84:87], v3 offset:2048
  ds_read_b128 v[88:91], v3 offset:3072
  ds_read_b128 v[92:95], v3 offset:16384
  ds_read_b128 v[96:99], v3 offset:17408
  ds_read_b128 v[100:103], v3 offset:18432
  ds_read_b128 v[104:107], v3 offset:19456
  v_xor_b32 v3, 0x8000, v3
  ds_read_b128 v[108:111], v3 offset:0
  ds_read_b128 v[112:115], v3 offset:1024
  ds_read_b128 v[116:119], v3 offset:2048
  ds_read_b128 v[120:123], v3 offset:3072
  v_cmp_ne_u32 vcc, 4, v4
  v_xor_b32 v10, 0x2000, v10
  v_xor_b32 v11, 0x2000, v11
  v_xor_b32 v0, 0x2000, v0
  s_waitcnt vmcnt(1)
  v_xor_b32 v32, 2048, v11
  v_xor_b32 v40, 4096, v11
  v_xor_b32 v48, 6144, v11
  s_cbranch_vccnz L_fs_x
L_fsback_x:
  v_bfe_u32 v45, v2, 9, 1
  v_and_b32 v4, 0x1ff, v2
  v_lshlrev_b32 v4, 2, v4
  v_lshl_add_u32 v4, v45, 24, v4
  s_max_i32 s93, s56, 0
  s_add_u32 s56, s56, 1
  s_xor_b32 s65, s65, 1
  s_add_u32 s58, s57, 0x1000000
  s_add_u32 s68, s56, 1
  s_min_u32 s68, s68, 63
  s_lshl_b32 s68, s68, 13
  s_add_u32 s57, s72, s68
  s_add_u32 s59, s57, s73
  s_add_u32 s68, s56, 2
  s_min_u32 s68, s68, 63
  s_lshr_b32 s68, s68, 3
  s_lshl2_add_u32 s60, s68, s92
  s_add_u32 s61, s61, 0x20000
  s_xor_b32 s70, s70, 0x2000
  s_nop 9
  s_branch L_poll2_x
L_retry2_x:
  s_waitcnt vmcnt(0)
  v_max3_u32 v44, v28, v29, v30
  v_max3_u32 v45, v31, v36, v37
  v_max3_u32 v44, v44, v38, v39
  v_max_u32 v44, v44, v45
  v_cmp_eq_u32 vcc, -1, v44
  v_mov_b64 v[20:21], v[28:29]
  v_mov_b64 v[22:23], v[30:31]
  v_mov_b64 v[24:25], v[36:37]
  v_mov_b64 v[26:27], v[38:39]
  v_mov_b64 v[52:53], 0
  v_mov_b64 v[54:55], 0
  v_mov_b64 v[56:57], 0
  v_mov_b64 v[58:59], 0
  v_mov_b64 v[60:61], 0
  v_mov_b64 v[62:63], 0
  s_cbranch_vccnz L_poll2_x
  s_branch L_entry_x
L_retry1_x:
  buffer_load_dwordx4 v[28:31], v9, s[40:43], s62 offen sc1
  buffer_load_dwordx4 v[32:35], v9, s[40:43], s62 offen offset:1024 sc1
  s_add_u32 s67, s67, 1
  s_cmp_gt_u32 s67, 1048576
  s_cbranch_scc1 L_exit
  s_waitcnt vmcnt(3)
  v_mfma_f32_16x16x32_bf16 v[24:27], v[36:39], v[20:23], 0
  v_bitop3_b32 v44, v36, v38, s65 bitop3:0x7e
  s_waitcnt vmcnt(2)
  v_mfma_f32_16x16x32_bf16 v[24:27], v[40:43], v[20:23], v[24:27]
  v_bitop3_b32 v45, v40, v42, s65 bitop3:0x7e
  v_or_b32 v44, v44, v45
  v_and_b32 v44, 1, v44
  v_cmp_ne_u32 vcc, 0, v44
  s_nop 2
  s_cbranch_vccz L_got1_x
  buffer_load_dwordx4 v[36:39], v9, s[40:43], s62 offen sc1
  buffer_load_dwordx4 v[40:43], v9, s[40:43], s62 offen offset:1024 sc1
  s_branch L_poll1b_x
L_smslow_x:
  v_max3_f32 v22, v52, v53, v54
  v_max3_f32 v22, v22, v55, v56
  v_max3_f32 v22, v22, v57, v58
  v_max3_f32 v22, v22, v59, v60
  v_max_f32 v22, v22, v61
  v_mov_b32 v20, v22
  s_nop 1
  v_permlane32_swap_b32 v20, v22
  v_max_f32 v22, v22, v20
  v_mov_b32 v20, v22
  s_nop 1
  v_permlane16_swap_b32 v20, v22
  v_max_f32 v22, v22, v20
  v_sub_f32 v20, v52, v22
  v_sub_f32 v21, v53, v22
  v_exp_f32 v20, v20
  v_exp_f32 v21, v21
  s_nop 0
  v_cvt_pk_bf16_f32 v24, v20, v21
  v_sub_f32 v20, v54, v22
  v_sub_f32 v21, v55, v22
  v_exp_f32 v20, v20
  v_exp_f32 v21, v21
  s_nop 0
  v_cvt_pk_bf16_f32 v25, v20, v21
  v_sub_f32 v20, v56, v22
  v_sub_f32 v21, v57, v22
  v_exp_f32 v20, v20
  v_exp_f32 v21, v21
  s_nop 0
  v_cvt_pk_bf16_f32 v26, v20, v21
  v_sub_f32 v20, v58, v22
  v_sub_f32 v21, v59, v22
  v_exp_f32 v20, v20
  v_exp_f32 v21, v21
  s_nop 0
  v_cvt_pk_bf16_f32 v27, v20, v21
  v_sub_f32 v20, v60, v22
  v_sub_f32 v21, v61, v22
  v_exp_f32 v20, v20
  v_exp_f32 v21, v21
  s_nop 0
  v_cvt_pk_bf16_f32 v16, v20, v21
  v_cvt_pk_bf16_f32 v19, v20, v21
  s_nop 1
  v_mfma_f32_16x16x32_bf16 v[64:67], v[12:15], v[24:27], 0
  v_mfma_f32_16x16x32_bf16 v[80:83], v[36:39], v[24:27], 0
  v_mfma_f32_16x16x32_bf16 v[84:87], v[40:43], v[24:27], 0
  s_nop 3
  v_mfma_f32_16x16x16_bf16 v[64:67], v[12:13], v[16:17], v[64:67]
  v_mfma_f32_16x16x16_bf16 v[80:83], v[126:127], v[16:17], v[80:83]
  v_mfma_f32_16x16x16_bf16 v[84:87], v[126:127], v[18:19], v[84:87]
  s_nop 7
  v_rcp_f32 v65, v64
  s_mov_b64 vcc, 0
  s_branch L_smback_x
L_fs_x:
  buffer_load_dword v4, v17, s[40:43], s60 offen sc1
  s_add_u32 s67, s67, 1
  s_cmp_gt_u32 s67, 1048576
  s_cbranch_scc1 L_exit
  s_waitcnt vmcnt(0)
  v_cmp_ne_u32 vcc, 4, v4
  s_cbranch_vccnz L_fs_x
  s_branch L_fsback_x
L_team_last:
  s_waitcnt vmcnt(0)
  s_add_u32 s61, s61, 0x20000
  v_mov_b32 v4, 64
  buffer_store_dwordx4 v[124:127], v2, s[40:43], s61 offen sc1
  s_waitcnt vmcnt(0)
  s_barrier
  buffer_store_dword v4, v17, s[40:43], s66 offen sc1
  s_waitcnt vmcnt(0)
  s_endpgm
L_exit:
  s_endpgm
.p2align 8
.type L_ptab,@object
L_ptab:
.long 7,0x4000020,0x4001020,0x17,0x1000000,0x2101001,0x2280001,0x1401000,0x1580000,0x2681001,0x2800001,0x1981000,0x1b00000,0x2c01001,0x7005,0xe,0xc0,0x1c0,0x1e,0x2c0,0x1e,0x3c0,4,4,4,4,4,4,4,4,4,4
.long 7,0x5000021,0x5001021,0x117,0x1000000,0x2101001,0x2280001,0x1401000,0x1580000,0x2681001,0x2800001,0x1981000,0x1b00000,0x2c01001,0x7015,0xe,0x10c0,0x11c0,0x1e,0x12c0,0x1e,0x13c0,4,4,4,4,4,4,4,4,4,4
.long 7,0x4080020,0x4081020,0x217,0x1000000,0x2101001,0x2280001,0x1401000,0x1580000,0x2681001,0x2800001,0x1981000,0x1b00000,0x2c01001,0x7025,0xe,0x20c0,0x21c0,0x1e,0x22c0,0x1e,0x23c0,4,4,4,4,4,4,4,4,4,4
.long 7,0x5080021,0x5081021,0x317,0x1000000,0x2101001,0x2280001,0x1401000,0x1580000,0x2681001,0x2800001,0x1981000,0x1b00000,0x2c01001,0x7035,0xe,0x30c0,0x31c0,0x1e,0x32c0,0x1e,0x33c0,4,4,4,4,4,4,4,4,4,4
.long 7,0x4100020,0x4101020,0x417,0x1000000,0x2101001,0x2280001,0x1401000,0x1580000,0x2681001,0x2800001,0x1981000,0x1b00000,0x2c01001,0x7045,0xe,0x40c0,0x41c0,0x1e,0x42c0,0x1e,0x43c0,4,4,4,4,4,4,4,4,4,4
.long 7,0x5100021,0x5101021,0x517,0x1000000,0x2101001,0x2280001,0x1401000,0x1580000,0x2681001,0x2800001,0x1981000,0x1b00000,0x2c01001,0x7055,0xe,0x50c0,0x51c0,0x1e,0x52c0,0x1e,0x53c0,4,4,4,4,4,4,4,4,4,4
.long 7,0x4180020,0x4181020,0x617,0x1000000,0x2101001,0x2280001,0x1401000,0x1580000,0x2681001,0x2800001,0x1981000,0x1b00000,0x2c01001,0x7065,0xe,0x60c0,0x61c0,0x1e,0x62c0,0x1e,0x63c0,4,4,4,4,4,4,4,4,4,4
.long 7,0x5180021,0x5181021,0x717,0x1000000,0x2101001,0x2280001,0x1401000,0x1580000,0x2681001,0x2800001,0x1981000,0x1b00000,0x2c01001,0x7075,0xe,0x70c0,0x71c0,0x1e,0x72c0,0x1e,0x73c0,4,4,4,4,4,4,4,4,4,4
.long 7,0x4e00020,0x4e01020,0x17,0x1001000,0x1180000,0x2281001,0x2400001,0x1581000,0x1700000,0x2801001,0x2980001,0x1b01000,0x1c80000,0x2d80001,0x7085,0xe,0xd0,0x1d0,0x1e,0x2d0,0x1e,0x3d0,4,4,4,4,4,4,4,4,4
.long 7,0x5e00021,0x5e01021,0x117,0x1001000,0x1180000,0x2281001,0x2400001,0x1581000,0x1700000,0x2801001,0x2980001,0x1b01000,0x1c80000,0x2d80001,0x7095,0xe,0x10d0,0x11d0,0x1e,0x12d0,0x1e,0x13d0,4,4,4,4,4,4,4,4,4
.long 7,0x4e80020,0x4e81020,0x217,0x1001000,0x1180000,0x2281001,0x2400001,0x1581000,0x1700000,0x2801001,0x2980001,0x1b01000,0x1c80000,0x2d80001,0x70a5,0xe,0x20d0,0x21d0,0x1e,0x22d0,0x1e,0x23d0,4,4,4,4,4,4,4,4,4
.long 7,0x5e80021,0x5e81021,0x317,0x1001000,0x1180000,0x2281001,0x2400001,0x1581000,0x1700000,0x2801001,0x2980001,0x1b01000,0x1c80000,0x2d80001,0x70b5,0xe,0x30d0,0x31d0,0x1e,0x32d0,0x1e,0x33d0,4,4,4,4,4,4,4,4,4
.long 7,0x4f00020,0x4f01020,0x417,0x1001000,0x1180000,0x2281001,0x2400001,0x1581000,0x1700000,0x2801001,0x2980001,0x1b01000,0x1c80000,0x2d80001,0x70c5,0xe,0x40d0,0x41d0,0x1e,0x42d0,0x1e,0x43d0,4,4,4,4,4,4,4,4,4
.long 7,0x5f00021,0x5f01021,0x517,0x1001000,0x1180000,0x2281001,0x2400001,0x1581000,0x1700000,0x2801001,0x2980001,0x1b01000,0x1c80000,0x2d80001,0x70d5,0xe,0x50d0,0x51d0,0x1e,0x52d0,0x1e,0x53d0,4,4,4,4,4,4,4,4,4
.long 7,0x4f80020,0x4f81020,0x617,0x1001000,0x1180000,0x2281001,0x2400001,0x1581000,0x1700000,0x2801001,0x2980001,0x1b01000,0x1c80000,0x2d80001,0x70e5,0xe,0x60d0,0x61d0,0x1e,0x62d0,0x1e,0x63d0,4,4,4,4,4,4,4,4,4
.long 7,0x5f80021,0x5f81021,0x717,0x1001000,0x1180000,0x2281001,0x2400001,0x1581000,0x1700000,0x2801001,0x2980001,0x1b01000,0x1c80000,0x2d80001,0x70f5,0xe,0x70d0,0x71d0,0x1e,0x72d0,0x1e,0x73d0,4,4,4,4,4,4,4,4,4
.long 0x107,0x4000020,0x5200021,0x4480020,0x5680021,0x4900020,0x5b00021,0x4d80020,0x5f80021,0x400012,0x880012,0xd00012,0x3180032,0x3600032,0x3a80032,0x3f00032,0x6005,0xe,0x80,0x180,0x1e,0x280,0x1e,0x380,4,4,4,4,4,4,4,4
.long 0x207,0x4000020,0x5200021,0x4480020,0x5680021,0x4900020,0x5b00021,0x4d80020,0x5f80021,0x400012,0x880012,0xd00012,0x3180032,0x3600032,0x3a80032,0x3f00032,0x6015,0xe,0x1080,0x1180,0x1e,0x1280,0x1e,0x1380,4,4,4,4,4,4,4,4
.long 0x307,0x4000020,0x5200021,0x4480020,0x5680021,0x4900020,0x5b00021,0x4d80020,0x5f80021,0x400012,0x880012,0xd00012,0x3180032,0x3600032,0x3a80032,0x3f00032,0x6025,0xe,0x2080,0x2180,0x1e,0x2280,0x1e,0x2380,4,4,4,4,4,4,4,4
.long 0x407,0x4000020,0x5200021,0x4480020,0x5680021,0x4900020,0x5b00021,0x4d80020,0x5f80021,0x400012,0x880012,0xd00012,0x3180032,0x3600032,0x3a80032,0x3f00032,0x6035,0xe,0x3080,0x3180,0x1e,0x3280,0x1e,0x3380,4,4,4,4,4,4,4,4
.long 0x507,0x4000020,0x5200021,0x4480020,0x5680021,0x4900020,0x5b00021,0x4d80020,0x5f80021,0x400012,0x880012,0xd00012,0x3180032,0x3600032,0x3a80032,0x3f00032,0x6045,0xe,0x4080,0x4180,0x1e,0x4280,0x1e,0x4380,4,4,4,4,4,4,4,4
.long 0x607,0x4000020,0x5200021,0x4480020,0x5680021,0x4900020,0x5b00021,0x4d80020,0x5f80021,0x400012,0x880012,0xd00012,0x3180032,0x3600032,0x3a80032,0x3f00032,0x6055,0xe,0x5080,0x5180,0x1e,0x5280,0x1e,0x5380,4,4,4,4,4,4,4,4
.long 0x707,0x4000020,0x5200021,0x4480020,0x5680021,0x4900020,0x5b00021,0x4d80020,0x5f80021,0x400012,0x880012,0xd00012,0x3180032,0x3600032,0x3a80032,0x3f00032,0x6065,0xe,0x6080,0x6180,0x1e,0x6280,0x1e,0x6380,4,4,4,4,4,4,4,4
.long 0x107,0x4001020,0x5201021,0x4481020,0x5681021,0x4901020,0x5b01021,0x4d81020,0x5f81021,0x401012,0x881012,0xd01012,0x3181032,0x3601032,0x3a81032,0x3f01032,0x6075,0xe,0x7080,0x7180,0x1e,0x7280,0x1e,0x7380,4,4,4,4,4,4,4,4
.long 0x207,0x4001020,0x5201021,0x4481020,0x5681021,0x4901020,0x5b01021,0x4d81020,0x5f81021,0x401012,0x881012,0xd01012,0x3181032,0x3601032,0x3a81032,0x3f01032,0x6085,0xe,0x90,0x190,0x1e,0x290,0x1e,0x390,4,4,4,4,4,4,4,4
.long 0x307,0x4001020,0x5201021,0x4481020,0x5681021,0x4901020,0x5b01021,0x4d81020,0x5f81021,0x401012,0x881012,0xd01012,0x3181032,0x3601032,0x3a81032,0x3f01032,0x6095,0xe,0x1090,0x1190,0x1e,0x1290,0x1e,0x1390,4,4,4,4,4,4,4,4
.long 0x407,0x4001020,0x5201021,0x4481020,0x5681021,0x4901020,0x5b01021,0x4d81020,0x5f81021,0x401012,0x881012,0xd01012,0x3181032,0x3601032,0x3a81032,0x3f01032,0x60a5,0xe,0x2090,0x2190,0x1e,0x2290,0x1e,0x2390,4,4,4,4,4,4,4,4
.long 0x507,0x4001020,0x5201021,0x4481020,0x5681021,0x4901020,0x5b01021,0x4d81020,0x5f81021,0x401012,0x881012,0xd01012,0x3181032,0x3601032,0x3a81032,0x3f01032,0x60b5,0xe,0x3090,0x3190,0x1e,0x3290,0x1e,0x3390,4,4,4,4,4,4,4,4
.long 0x607,0x4001020,0x5201021,0x4481020,0x5681021,0x4901020,0x5b01021,0x4d81020,0x5f81021,0x401012,0x881012,0xd01012,0x3181032,0x3601032,0x3a81032,0x3f01032,0x60c5,0xe,0x4090,0x4190,0x1e,0x4290,0x1e,0x4390,4,4,4,4,4,4,4,4
.long 0x707,0x4001020,0x5201021,0x4481020,0x5681021,0x4901020,0x5b01021,0x4d81020,0x5f81021,0x401012,0x881012,0xd01012,0x3181032,0x3601032,0x3a81032,0x3f01032,0x60d5,0xe,0x5090,0x5190,0x1e,0x5290,0x1e,0x5390,4,4,4,4,4,4,4,4
.long 7,0x12,0x280012,0x500012,0x780012,0xa00012,0xc80012,0xf00012,0x3180032,0x3400032,0x3680032,0x3900032,0x3b80032,0x3e00032,0x60e5,0xe,0x6090,0x6190,0x1e,0x6290,0x1e,0x6390,4,4,4,4,4,4,4,4,4,4
.long 7,0x1012,0x281012,0x501012,0x781012,0xa01012,0xc81012,0xf01012,0x3181032,0x3401032,0x3681032,0x3901032,0x3b81032,0x3e01032,0x60f5,0xe,0x7090,0x7190,0x1e,0x7290,0x1e,0x7390,4,4,4,4,4,4,4,4,4,4
.long 7,0x4200020,0x4201020,0x17,0x2000001,0x1181000,0x1300000,0x2401001,0x2580001,0x1701000,0x1880000,0x2981001,0x2b00001,0x1c81000,0x5005,0xe,0x40,0x140,0x1e,0x240,0x1e,0x340,4,4,4,4,4,4,4,4,4,4
.long 7,0x5200021,0x5201021,0x117,0x2000001,0x1181000,0x1300000,0x2401001,0x2580001,0x1701000,0x1880000,0x2981001,0x2b00001,0x1c81000,0x5015,0xe,0x1040,0x1140,0x1e,0x1240,0x1e,0x1340,4,4,4,4,4,4,4,4,4,4
.long 7,0x4280020,0x4281020,0x217,0x2000001,0x1181000,0x1300000,0x2401001,0x2580001,0x1701000,0x1880000,0x2981001,0x2b00001,0x1c81000,0x5025,0xe,0x2040,0x2140,0x1e,0x2240,0x1e,0x2340,4,4,4,4,4,4,4,4,4,4
.long 7,0x5280021,0x5281021,0x317,0x2000001,0x1181000,0x1300000,0x2401001,0x2580001,0x1701000,0x1880000,0x2981001,0x2b00001,0x1c81000,0x5035,0xe,0x3040,0x3140,0x1e,0x3240,0x1e,0x3340,4,4,4,4,4,4,4,4,4,4
.long 7,0x4300020,0x4301020,0x417,0x2000001,0x1181000,0x1300000,0x2401001,0x2580001,0x1701000,0x1880000,0x2981001,0x2b00001,0x1c81000,0x5045,0xe,0x4040,0x4140,0x1e,0x4240,0x1e,0x4340,4,4,4,4,4,4,4,4,4,4
.long 7,0x5300021,0x5301021,0x517,0x2000001,0x1181000,0x1300000,0x2401001,0x2580001,0x1701000,0x1880000,0x2981001,0x2b00001,0x1c81000,0x5055,0xe,0x5040,0x5140,0x1e,0x5240,0x1e,0x5340,4,4,4,4,4,4,4,4,4,4
.long 7,0x4380020,0x4381020,0x617,0x2000001,0x1181000,0x1300000,0x2401001,0x2580001,0x1701000,0x1880000,0x2981001,0x2b00001,0x1c81000,0x5065,0xe,0x6040,0x6140,0x1e,0x6240,0x1e,0x6340,4,4,4,4,4,4,4,4,4,4
.long 7,0x5380021,0x5381021,0x717,0x2000001,0x1181000,0x1300000,0x2401001,0x2580001,0x1701000,0x1880000,0x2981001,0x2b00001,0x1c81000,0x5075,0xe,0x7040,0x7140,0x1e,0x7240,0x1e,0x7340,4,4,4,4,4,4,4,4,4,4
.long 0x107,0x5000021,0x4280020,0x5480021,0x4700020,0x5900021,0x4b80020,0x5d80021,0x12,0x480012,0x900012,0xd80012,0x3200032,0x3680032,0x3b00032,0x3f80032,0x5085,0xe,0x50,0x150,0x1e,0x250,0x1e,0x350,4,4,4,4,4,4,4,4
.long 0x207,0x5000021,0x4280020,0x5480021,0x4700020,0x5900021,0x4b80020,0x5d80021,0x12,0x480012,0x900012,0xd80012,0x3200032,0x3680032,0x3b00032,0x3f80032,0x5095,0xe,0x1050,0x1150,0x1e,0x1250,0x1e,0x1350,4,4,4,4,4,4,4,4
.long 0x307,0x5000021,0x4280020,0x5480021,0x4700020,0x5900021,0x4b80020,0x5d80021,0x12,0x480012,0x900012,0xd80012,0x3200032,0x3680032,0x3b00032,0x3f80032,0x50a5,0xe,0x2050,0x2150,0x1e,0x2250,0x1e,0x2350,4,4,4,4,4,4,4,4
.long 0x407,0x5000021,0x4280020,0x5480021,0x4700020,0x5900021,0x4b80020,0x5d80021,0x12,0x480012,0x900012,0xd80012,0x3200032,0x3680032,0x3b00032,0x3f80032,0x50b5,0xe,0x3050,0x3150,0x1e,0x3250,0x1e,0x3350,4,4,4,4,4,4,4,4
.long 0x507,0x5000021,0x4280020,0x5480021,0x4700020,0x5900021,0x4b80020,0x5d80021,0x12,0x480012,0x900012,0xd80012,0x3200032,0x3680032,0x3b00032,0x3f80032,0x50c5,0xe,0x4050,0x4150,0x1e,0x4250,0x1e,0x4350,4,4,4,4,4,4,4,4
.long 0x607,0x5000021,0x4280020,0x5480021,0x4700020,0x5900021,0x4b80020,0x5d80021,0x12,0x480012,0x900012,0xd80012,0x3200032,0x3680032,0x3b00032,0x3f80032,0x50d5,0xe,0x5050,0x5150,0x1e,0x5250,0x1e,0x5350,4,4,4,4,4,4,4,4
.long 0x707,0x5000021,0x4280020,0x5480021,0x4700020,0x5900021,0x4b80020,0x5d80021,0x12,0x480012,0x900012,0xd80012,0x3200032,0x3680032,0x3b00032,0x3f80032,0x50e5,0xe,0x6050,0x6150,0x1e,0x6250,0x1e,0x6350,4,4,4,4,4,4,4,4
.long 0x107,0x5001021,0x4281020,0x5481021,0x4701020,0x5901021,0x4b81020,0x5d81021,0x1012,0x481012,0x901012,0xd81012,0x3201032,0x3681032,0x3b01032,0x3f81032,0x50f5,0xe,0x7050,0x7150,0x1e,0x7250,0x1e,0x7350,4,4,4,4,4,4,4,4
.long 0x207,0x5001021,0x4281020,0x5481021,0x4701020,0x5901021,0x4b81020,0x5d81021,0x1012,0x481012,0x901012,0xd81012,0x3201032,0x3681032,0x3b01032,0x3f81032,0x4005,0xe,0,0x100,0x1e,0x200,0x1e,0x300,4,4,4,4,4,4,4,4
.long 0x307,0x5001021,0x4281020,0x5481021,0x4701020,0x5901021,0x4b81020,0x5d81021,0x1012,0x481012,0x901012,0xd81012,0x3201032,0x3681032,0x3b01032,0x3f81032,0x4015,0xe,0x1000,0x1100,0x1e,0x1200,0x1e,0x1300,4,4,4,4,4,4,4,4
.long 0x407,0x5001021,0x4281020,0x5481021,0x4701020,0x5901021,0x4b81020,0x5d81021,0x1012,0x481012,0x901012,0xd81012,0x3201032,0x3681032,0x3b01032,0x3f81032,0x4025,0xe,0x2000,0x2100,0x1e,0x2200,0x1e,0x2300,4,4,4,4,4,4,4,4
.long 0x507,0x5001021,0x4281020,0x5481021,0x4701020,0x5901021,0x4b81020,0x5d81021,0x1012,0x481012,0x901012,0xd81012,0x3201032,0x3681032,0x3b01032,0x3f81032,0x4035,0xe,0x3000,0x3100,0x1e,0x3200,0x1e,0x3300,4,4,4,4,4,4,4,4
.long 0x607,0x5001021,0x4281020,0x5481021,0x4701020,0x5901021,0x4b81020,0x5d81021,0x1012,0x481012,0x901012,0xd81012,0x3201032,0x3681032,0x3b01032,0x3f81032,0x4045,0xe,0x4000,0x4100,0x1e,0x4200,0x1e,0x4300,4,4,4,4,4,4,4,4
.long 0x707,0x5001021,0x4281020,0x5481021,0x4701020,0x5901021,0x4b81020,0x5d81021,0x1012,0x481012,0x901012,0xd81012,0x3201032,0x3681032,0x3b01032,0x3f81032,0x4055,0xe,0x5000,0x5100,0x1e,0x5200,0x1e,0x5300,4,4,4,4,4,4,4,4
.long 0x107,0x4080020,0x5280021,0x4500020,0x5700021,0x4980020,0x5b80021,0x4e00020,0x80012,0x500012,0x980012,0xe00012,0x3280032,0x3700032,0x3b80032,0x4065,0xe,0x6000,0x6100,0x1e,0x6200,0x1e,0x6300,4,4,4,4,4,4,4,4,4
.long 0x207,0x4080020,0x5280021,0x4500020,0x5700021,0x4980020,0x5b80021,0x4e00020,0x80012,0x500012,0x980012,0xe00012,0x3280032,0x3700032,0x3b80032,0x4075,0xe,0x7000,0x7100,0x1e,0x7200,0x1e,0x7300,4,4,4,4,4,4,4,4,4
.long 0x307,0x4080020,0x5280021,0x4500020,0x5700021,0x4980020,0x5b80021,0x4e00020,0x80012,0x500012,0x980012,0xe00012,0x3280032,0x3700032,0x3b80032,0x4085,0xe,0x10,0x110,0x1e,0x210,0x1e,0x310,4,4,4,4,4,4,4,4,4
.long 0x407,0x4080020,0x5280021,0x4500020,0x5700021,0x4980020,0x5b80021,0x4e00020,0x80012,0x500012,0x980012,0xe00012,0x3280032,0x3700032,0x3b80032,0x4095,0xe,0x1010,0x1110,0x1e,0x1210,0x1e,0x1310,4,4,4,4,4,4,4,4,4
.long 0x507,0x4080020,0x5280021,0x4500020,0x5700021,0x4980020,0x5b80021,0x4e00020,0x80012,0x500012,0x980012,0xe00012,0x3280032,0x3700032,0x3b80032,0x40a5,0xe,0x2010,0x2110,0x1e,0x2210,0x1e,0x2310,4,4,4,4,4,4,4,4,4
.long 0x607,0x4080020,0x5280021,0x4500020,0x5700021,0x4980020,0x5b80021,0x4e00020,0x80012,0x500012,0x980012,0xe00012,0x3280032,0x3700032,0x3b80032,0x40b5,0xe,0x3010,0x3110,0x1e,0x3210,0x1e,0x3310,4,4,4,4,4,4,4,4,4
.long 0x707,0x4080020,0x5280021,0x4500020,0x5700021,0x4980020,0x5b80021,0x4e00020,0x80012,0x500012,0x980012,0xe00012,0x3280032,0x3700032,0x3b80032,0x40c5,0xe,0x4010,0x4110,0x1e,0x4210,0x1e,0x4310,4,4,4,4,4,4,4,4,4
.long 0x107,0x4201020,0x5401021,0x4681020,0x5881021,0x4b01020,0x5d01021,0x4f81020,0x381012,0x801012,0xc81012,0x3101032,0x3581032,0x3a01032,0x3e81032,0x40d5,0xe,0x5010,0x5110,0x1e,0x5210,0x1e,0x5310,4,4,4,4,4,4,4,4,4
.long 0x207,0x4201020,0x5401021,0x4681020,0x5881021,0x4b01020,0x5d01021,0x4f81020,0x381012,0x801012,0xc81012,0x3101032,0x3581032,0x3a01032,0x3e81032,0x40e5,0xe,0x6010,0x6110,0x1e,0x6210,0x1e,0x6310,4,4,4,4,4,4,4,4,4
.long 0x307,0x4201020,0x5401021,0x4681020,0x5881021,0x4b01020,0x5d01021,0x4f81020,0x381012,0x801012,0xc81012,0x3101032,0x3581032,0x3a01032,0x3e81032,0x40f5,0xe,0x7010,0x7110,0x1e,0x7210,0x1e,0x7310,4,4,4,4,4,4,4,4,4
.long 7,0x4400020,0x4401020,0x17,0x2001001,0x2180001,0x1301000,0x1480000,0x2581001,0x2700001,0x1881000,0x1a00000,0x2b01001,0x2c80001,0x2d81001,0x3005,6,0x40,0xa0,0x100,0x160,0x1c0,0x220,0x280,0x2e0,0x340,0x3a0,4,4,4,4,4
.long 7,0x5400021,0x5401021,0x117,0x2001001,0x2180001,0x1301000,0x1480000,0x2581001,0x2700001,0x1881000,0x1a00000,0x2b01001,0x2c80001,0x2d81001,0x3015,0x16,0x40,0xa0,0x100,0x160,0x1c0,0x220,0x280,0x2e0,0x340,0x3a0,4,4,4,4,4
.long 7,0x4480020,0x4481020,0x217,0x2001001,0x2180001,0x1301000,0x1480000,0x2581001,0x2700001,0x1881000,0x1a00000,0x2b01001,0x2c80001,0x2d81001,0x3025,0x26,0x40,0xa0,0x100,0x160,0x1c0,0x220,0x280,0x2e0,0x340,0x3a0,4,4,4,4,4
.long 7,0x5480021,0x5481021,0x317,0x2001001,0x2180001,0x1301000,0x1480000,0x2581001,0x2700001,0x1881000,0x1a00000,0x2b01001,0x2c80001,0x2d81001,0x3035,0x36,0x40,0xa0,0x100,0x160,0x1c0,0x220,0x280,0x2e0,0x340,0x3a0,4,4,4,4,4
.long 7,0x4500020,0x4501020,0x417,0x2001001,0x2180001,0x1301000,0x1480000,0x2581001,0x2700001,0x1881000,0x1a00000,0x2b01001,0x2c80001,0x2d81001,0x3045,0x46,0x40,0xa0,0x100,0x160,0x1c0,0x220,0x280,0x2e0,0x340,0x3a0,4,4,4,4,4
.long 7,0x5500021,0x5501021,0x517,0x2001001,0x2180001,0x1301000,0x1480000,0x2581001,0x2700001,0x1881000,0x1a00000,0x2b01001,0x2c80001,0x2d81001,0x3055,0x56,0x40,0xa0,0x100,0x160,0x1c0,0x220,0x280,0x2e0,0x340,0x3a0,4,4,4,4,4
.long 7,0x4580020,0x4581020,0x617,0x2001001,0x2180001,0x1301000,0x1480000,0x2581001,0x2700001,0x1881000,0x1a00000,0x2b01001,0x2c80001,0x2d81001,0x3065,0x66,0x40,0xa0,0x100,0x160,0x1c0,0x220,0x280,0x2e0,0x340,0x3a0,4,4,4,4,4
.long 7,0x5580021,0x5581021,0x717,0x2001001,0x2180001,0x1301000,0x1480000,0x2581001,0x2700001,0x1881000,0x1a00000,0x2b01001,0x2c80001,0x2d81001,0x3075,0x76,0x40,0xa0,0x100,0x160,0x1c0,0x220,0x280,0x2e0,0x340,0x3a0,4,4,4,4,4
.long 0x17,0x1080000,0x2181001,0x2300001,0x1481000,0x1600000,0x2701001,0x2880001,0x1a01000,0x1b80000,0x2c81001,0x1e00000,0x2e81001,0x2f00001,0x1f81000,0x3085,0x86,0x40,0xa0,0x100,0x160,0x1c0,0x220,0x280,0x2e0,0x340,0x3a0,4,4,4,4,4
.long 0x117,0x1080000,0x2181001,0x2300001,0x1481000,0x1600000,0x2701001,0x2880001,0x1a01000,0x1b80000,0x2c81001,0x1e00000,0x2e81001,0x2f00001,0x1f81000,0x3095,0x96,0x40,0xa0,0x100,0x160,0x1c0,0x220,0x280,0x2e0,0x340,0x3a0,4,4,4,4,4
.long 0x217,0x1080000,0x2181001,0x2300001,0x1481000,0x1600000,0x2701001,0x2880001,0x1a01000,0x1b80000,0x2c81001,0x1e00000,0x2e81001,0x2f00001,0x1f81000,0x30a5,0xa6,0x40,0xa0,0x100,0x160,0x1c0,0x220,0x280,0x2e0,0x340,0x3a0,4,4,4,4,4
.long 0x317,0x1080000,0x2181001,0x2300001,0x1481000,0x1600000,0x2701001,0x2880001,0x1a01000,0x1b80000,0x2c81001,0x1e00000,0x2e81001,0x2f00001,0x1f81000,0x30b5,0xb6,0x40,0xa0,0x100,0x160,0x1c0,0x220,0x280,0x2e0,0x340,0x3a0,4,4,4,4,4
.long 0x417,0x1080000,0x2181001,0x2300001,0x1481000,0x1600000,0x2701001,0x2880001,0x1a01000,0x1b80000,0x2c81001,0x1e00000,0x2e81001,0x2f00001,0x1f81000,0x30c5,0xc6,0x40,0xa0,0x100,0x160,0x1c0,0x220,0x280,0x2e0,0x340,0x3a0,4,4,4,4,4
.long 0x517,0x1080000,0x2181001,0x2300001,0x1481000,0x1600000,0x2701001,0x2880001,0x1a01000,0x1b80000,0x2c81001,0x1e00000,0x2e81001,0x2f00001,0x1f81000,0x30d5,0xd6,0x40,0xa0,0x100,0x160,0x1c0,0x220,0x280,0x2e0,0x340,0x3a0,4,4,4,4,4
.long 0x617,0x1080000,0x2181001,0x2300001,0x1481000,0x1600000,0x2701001,0x2880001,0x1a01000,0x1b80000,0x2c81001,0x1e00000,0x2e81001,0x2f00001,0x1f81000,0x30e5,0xe6,0x40,0xa0,0x100,0x160,0x1c0,0x220,0x280,0x2e0,0x340,0x3a0,4,4,4,4,4
.long 0x717,0x1080000,0x2181001,0x2300001,0x1481000,0x1600000,0x2701001,0x2880001,0x1a01000,0x1b80000,0x2c81001,0x1e00000,0x2e81001,0x2f00001,0x1f81000,0x30f5,0xf6,0x40,0xa0,0x100,0x160,0x1c0,0x220,0x280,0x2e0,0x340,0x3a0,4,4,4,4,4
.long 0x107,0x4081020,0x5281021,0x4501020,0x5701021,0x4981020,0x5b81021,0x4e01020,0x81012,0x501012,0x981012,0xe01012,0x3281032,0x3701032,0x3b81032,0x2005,6,0,0x60,0xc0,0x120,0x180,0x1e0,0x240,0x2a0,0x300,0x360,0x3c0,4,4,4,4
.long 0x207,0x4081020,0x5281021,0x4501020,0x5701021,0x4981020,0x5b81021,0x4e01020,0x81012,0x501012,0x981012,0xe01012,0x3281032,0x3701032,0x3b81032,0x2015,0x16,0,0x60,0xc0,0x120,0x180,0x1e0,0x240,0x2a0,0x300,0x360,0x3c0,4,4,4,4
.long 0x307,0x4081020,0x5281021,0x4501020,0x5701021,0x4981020,0x5b81021,0x4e01020,0x81012,0x501012,0x981012,0xe01012,0x3281032,0x3701032,0x3b81032,0x2025,0x26,0,0x60,0xc0,0x120,0x180,0x1e0,0x240,0x2a0,0x300,0x360,0x3c0,4,4,4,4
.long 0x407,0x4081020,0x5281021,0x4501020,0x5701021,0x4981020,0x5b81021,0x4e01020,0x81012,0x501012,0x981012,0xe01012,0x3281032,0x3701032,0x3b81032,0x2035,0x36,0,0x60,0xc0,0x120,0x180,0x1e0,0x240,0x2a0,0x300,0x360,0x3c0,4,4,4,4
.long 0x507,0x4081020,0x5281021,0x4501020,0x5701021,0x4981020,0x5b81021,0x4e01020,0x81012,0x501012,0x981012,0xe01012,0x3281032,0x3701032,0x3b81032,0x2045,0x46,0,0x60,0xc0,0x120,0x180,0x1e0,0x240,0x2a0,0x300,0x360,0x3c0,4,4,4,4
.long 0x607,0x4081020,0x5281021,0x4501020,0x5701021,0x4981020,0x5b81021,0x4e01020,0x81012,0x501012,0x981012,0xe01012,0x3281032,0x3701032,0x3b81032,0x2055,0x56,0,0x60,0xc0,0x120,0x180,0x1e0,0x240,0x2a0,0x300,0x360,0x3c0,4,4,4,4
.long 0x707,0x4081020,0x5281021,0x4501020,0x5701021,0x4981020,0x5b81021,0x4e01020,0x81012,0x501012,0x981012,0xe01012,0x3281032,0x3701032,0x3b81032,0x2065,0x66,0,0x60,0xc0,0x120,0x180,0x1e0,0x240,0x2a0,0x300,0x360,0x3c0,4,4,4,4
.long 0x107,0x5080021,0x4300020,0x5500021,0x4780020,0x5980021,0x4c00020,0x5e00021,0x100012,0x580012,0xa00012,0xe80012,0x3300032,0x3780032,0x3c00032,0x2075,0x76,0,0x60,0xc0,0x120,0x180,0x1e0,0x240,0x2a0,0x300,0x360,0x3c0,4,4,4,4
.long 0x207,0x5080021,0x4300020,0x5500021,0x4780020,0x5980021,0x4c00020,0x5e00021,0x100012,0x580012,0xa00012,0xe80012,0x3300032,0x3780032,0x3c00032,0x2085,0x86,0,0x60,0xc0,0x120,0x180,0x1e0,0x240,0x2a0,0x300,0x360,0x3c0,4,4,4,4
.long 0x307,0x5080021,0x4300020,0x5500021,0x4780020,0x5980021,0x4c00020,0x5e00021,0x100012,0x580012,0xa00012,0xe80012,0x3300032,0x3780032,0x3c00032,0x2095,0x96,0,0x60,0xc0,0x120,0x180,0x1e0,0x240,0x2a0,0x300,0x360,0x3c0,4,4,4,4
.long 0x407,0x5080021,0x4300020,0x5500021,0x4780020,0x5980021,0x4c00020,0x5e00021,0x100012,0x580012,0xa00012,0xe80012,0x3300032,0x3780032,0x3c00032,0x20a5,0xa6,0,0x60,0xc0,0x120,0x180,0x1e0,0x240,0x2a0,0x300,0x360,0x3c0,4,4,4,4
.long 0x507,0x5080021,0x4300020,0x5500021,0x4780020,0x5980021,0x4c00020,0x5e00021,0x100012,0x580012,0xa00012,0xe80012,0x3300032,0x3780032,0x3c00032,0x20b5,0xb6,0,0x60,0xc0,0x120,0x180,0x1e0,0x240,0x2a0,0x300,0x360,0x3c0,4,4,4,4
.long 0x607,0x5080021,0x4300020,0x5500021,0x4780020,0x5980021,0x4c00020,0x5e00021,0x100012,0x580012,0xa00012,0xe80012,0x3300032,0x3780032,0x3c00032,0x20c5,0xc6,0,0x60,0xc0,0x120,0x180,0x1e0,0x240,0x2a0,0x300,0x360,0x3c0,4,4,4,4
.long 0x707,0x5080021,0x4300020,0x5500021,0x4780020,0x5980021,0x4c00020,0x5e00021,0x100012,0x580012,0xa00012,0xe80012,0x3300032,0x3780032,0x3c00032,0x20d5,0xd6,0,0x60,0xc0,0x120,0x180,0x1e0,0x240,0x2a0,0x300,0x360,0x3c0,4,4,4,4
.long 7,0x80012,0x300012,0x580012,0x800012,0xa80012,0xd00012,0xf80012,0x3200032,0x3480032,0x3700032,0x3980032,0x3c00032,0x3e80032,0x20e5,0xe6,0,0x60,0xc0,0x120,0x180,0x1e0,0x240,0x2a0,0x300,0x360,0x3c0,4,4,4,4,4
.long 7,0x81012,0x301012,0x581012,0x801012,0xa81012,0xd01012,0xf81012,0x3201032,0x3481032,0x3701032,0x3981032,0x3c01032,0x3e81032,0x20f5,0xf6,0,0x60,0xc0,0x120,0x180,0x1e0,0x240,0x2a0,0x300,0x360,0x3c0,4,4,4,4,4
.long 7,0x4600020,0x4601020,0x17,0x1081000,0x1200000,0x2301001,0x2480001,0x1601000,0x1780000,0x2881001,0x2a00001,0x1b81000,0x1d00000,0x1e01000,0x1005,5,6,0x20,0x80,0xe0,0x140,0x1a0,0x200,0x260,0x2c0,0x320,0x380,0x3e0,4,4,4
.long 7,0x5600021,0x5601021,0x117,0x1081000,0x1200000,0x2301001,0x2480001,0x1601000,0x1780000,0x2881001,0x2a00001,0x1b81000,0x1d00000,0x1e01000,0x1015,0x15,0x16,0x20,0x80,0xe0,0x140,0x1a0,0x200,0x260,0x2c0,0x320,0x380,0x3e0,4,4,4
.long 7,0x4680020,0x4681020,0x217,0x1081000,0x1200000,0x2301001,0x2480001,0x1601000,0x1780000,0x2881001,0x2a00001,0x1b81000,0x1d00000,0x1e01000,0x1025,0x25,0x26,0x20,0x80,0xe0,0x140,0x1a0,0x200,0x260,0x2c0,0x320,0x380,0x3e0,4,4,4
.long 7,0x5680021,0x5681021,0x317,0x1081000,0x1200000,0x2301001,0x2480001,0x1601000,0x1780000,0x2881001,0x2a00001,0x1b81000,0x1d00000,0x1e01000,0x1035,0x35,0x36,0x20,0x80,0xe0,0x140,0x1a0,0x200,0x260,0x2c0,0x320,0x380,0x3e0,4,4,4
.long 7,0x4700020,0x4701020,0x417,0x1081000,0x1200000,0x2301001,0x2480001,0x1601000,0x1780000,0x2881001,0x2a00001,0x1b81000,0x1d00000,0x1e01000,0x1045,0x45,0x46,0x20,0x80,0xe0,0x140,0x1a0,0x200,0x260,0x2c0,0x320,0x380,0x3e0,4,4,4
.long 7,0x5700021,0x5701021,0x517,0x1081000,0x1200000,0x2301001,0x2480001,0x1601000,0x1780000,0x2881001,0x2a00001,0x1b81000,0x1d00000,0x1e01000,0x1055,0x55,0x56,0x20,0x80,0xe0,0x140,0x1a0,0x200,0x260,0x2c0,0x320,0x380,0x3e0,4,4,4
.long 7,0x4780020,0x4781020,0x617,0x1081000,0x1200000,0x2301001,0x2480001,0x1601000,0x1780000,0x2881001,0x2a00001,0x1b81000,0x1d00000,0x1e01000,0x1065,0x65,0x66,0x20,0x80,0xe0,0x140,0x1a0,0x200,0x260,0x2c0,0x320,0x380,0x3e0,4,4,4
.long 7,0x5780021,0x5781021,0x717,0x1081000,0x1200000,0x2301001,0x2480001,0x1601000,0x1780000,0x2881001,0x2a00001,0x1b81000,0x1d00000,0x1e01000,0x1075,0x75,0x76,0x20,0x80,0xe0,0x140,0x1a0,0x200,0x260,0x2c0,0x320,0x380,0x3e0,4,4,4
.long 0x107,0x5081021,0x4301020,0x5501021,0x4781020,0x5981021,0x4c01020,0x5e01021,0x101012,0x581012,0xa01012,0xe81012,0x3301032,0x3781032,0x3c01032,0x1085,0x85,0x86,0x20,0x80,0xe0,0x140,0x1a0,0x200,0x260,0x2c0,0x320,0x380,0x3e0,4,4,4
.long 0x207,0x5081021,0x4301020,0x5501021,0x4781020,0x5981021,0x4c01020,0x5e01021,0x101012,0x581012,0xa01012,0xe81012,0x3301032,0x3781032,0x3c01032,0x1095,0x95,0x96,0x20,0x80,0xe0,0x140,0x1a0,0x200,0x260,0x2c0,0x320,0x380,0x3e0,4,4,4
.long 0x307,0x5081021,0x4301020,0x5501021,0x4781020,0x5981021,0x4c01020,0x5e01021,0x101012,0x581012,0xa01012,0xe81012,0x3301032,0x3781032,0x3c01032,0x10a5,0xa5,0xa6,0x20,0x80,0xe0,0x140,0x1a0,0x200,0x260,0x2c0,0x320,0x380,0x3e0,4,4,4
.long 0x407,0x5081021,0x4301020,0x5501021,0x4781020,0x5981021,0x4c01020,0x5e01021,0x101012,0x581012,0xa01012,0xe81012,0x3301032,0x3781032,0x3c01032,0x10b5,0xb5,0xb6,0x20,0x80,0xe0,0x140,0x1a0,0x200,0x260,0x2c0,0x320,0x380,0x3e0,4,4,4
.long 0x507,0x5081021,0x4301020,0x5501021,0x4781020,0x5981021,0x4c01020,0x5e01021,0x101012,0x581012,0xa01012,0xe81012,0x3301032,0x3781032,0x3c01032,0x10c5,0xc5,0xc6,0x20,0x80,0xe0,0x140,0x1a0,0x200,0x260,0x2c0,0x320,0x380,0x3e0,4,4,4
.long 0x607,0x5081021,0x4301020,0x5501021,0x4781020,0x5981021,0x4c01020,0x5e01021,0x101012,0x581012,0xa01012,0xe81012,0x3301032,0x3781032,0x3c01032,0x10d5,0xd5,0xd6,0x20,0x80,0xe0,0x140,0x1a0,0x200,0x260,0x2c0,0x320,0x380,0x3e0,4,4,4
.long 0x707,0x5081021,0x4301020,0x5501021,0x4781020,0x5981021,0x4c01020,0x5e01021,0x101012,0x581012,0xa01012,0xe81012,0x3301032,0x3781032,0x3c01032,0x10e5,0xe5,0xe6,0x20,0x80,0xe0,0x140,0x1a0,0x200,0x260,0x2c0,0x320,0x380,0x3e0,4,4,4
.long 0x107,0x4100020,0x5300021,0x4580020,0x5780021,0x4a00020,0x5c00021,0x4e80020,0x180012,0x600012,0xa80012,0xf00012,0x3380032,0x3800032,0x3c80032,0x10f5,0xf5,0xf6,0x20,0x80,0xe0,0x140,0x1a0,0x200,0x260,0x2c0,0x320,0x380,0x3e0,4,4,4
.long 0x207,0x4100020,0x5300021,0x4580020,0x5780021,0x4a00020,0x5c00021,0x4e80020,0x180012,0x600012,0xa80012,0xf00012,0x3380032,0x3800032,0x3c80032,0x7105,0xe,0xe0,0x1e0,0x1e,0x2e0,0x1e,0x3e0,4,4,4,4,4,4,4,4,4
.long 0x307,0x4100020,0x5300021,0x4580020,0x5780021,0x4a00020,0x5c00021,0x4e80020,0x180012,0x600012,0xa80012,0xf00012,0x3380032,0x3800032,0x3c80032,0x7115,0xe,0x10e0,0x11e0,0x1e,0x12e0,0x1e,0x13e0,4,4,4,4,4,4,4,4,4
.long 0x407,0x4100020,0x5300021,0x4580020,0x5780021,0x4a00020,0x5c00021,0x4e80020,0x180012,0x600012,0xa80012,0xf00012,0x3380032,0x3800032,0x3c80032,0x7125,0xe,0x20e0,0x21e0,0x1e,0x22e0,0x1e,0x23e0,4,4,4,4,4,4,4,4,4
.long 0x507,0x4100020,0x5300021,0x4580020,0x5780021,0x4a00020,0x5c00021,0x4e80020,0x180012,0x600012,0xa80012,0xf00012,0x3380032,0x3800032,0x3c80032,0x7135,0xe,0x30e0,0x31e0,0x1e,0x32e0,0x1e,0x33e0,4,4,4,4,4,4,4,4,4
.long 0x607,0x4100020,0x5300021,0x4580020,0x5780021,0x4a00020,0x5c00021,0x4e80020,0x180012,0x600012,0xa80012,0xf00012,0x3380032,0x3800032,0x3c80032,0x7145,0xe,0x40e0,0x41e0,0x1e,0x42e0,0x1e,0x43e0,4,4,4,4,4,4,4,4,4
.long 0x707,0x4100020,0x5300021,0x4580020,0x5780021,0x4a00020,0x5c00021,0x4e80020,0x180012,0x600012,0xa80012,0xf00012,0x3380032,0x3800032,0x3c80032,0x7155,0xe,0x50e0,0x51e0,0x1e,0x52e0,0x1e,0x53e0,4,4,4,4,4,4,4,4,4
.long 0x107,0x4101020,0x5301021,0x4581020,0x5781021,0x4a01020,0x5c01021,0x4e81020,0x181012,0x601012,0xa81012,0xf01012,0x3381032,0x3801032,0x3c81032,0x7165,0xe,0x60e0,0x61e0,0x1e,0x62e0,0x1e,0x63e0,4,4,4,4,4,4,4,4,4
.long 0x207,0x4101020,0x5301021,0x4581020,0x5781021,0x4a01020,0x5c01021,0x4e81020,0x181012,0x601012,0xa81012,0xf01012,0x3381032,0x3801032,0x3c81032,0x7175,0xe,0x70e0,0x71e0,0x1e,0x72e0,0x1e,0x73e0,4,4,4,4,4,4,4,4,4
.long 0x307,0x4101020,0x5301021,0x4581020,0x5781021,0x4a01020,0x5c01021,0x4e81020,0x181012,0x601012,0xa81012,0xf01012,0x3381032,0x3801032,0x3c81032,0x7185,0xe,0xf0,0x1f0,0x1e,0x2f0,0x1e,0x3f0,4,4,4,4,4,4,4,4,4
.long 0x407,0x4101020,0x5301021,0x4581020,0x5781021,0x4a01020,0x5c01021,0x4e81020,0x181012,0x601012,0xa81012,0xf01012,0x3381032,0x3801032,0x3c81032,0x7195,0xe,0x10f0,0x11f0,0x1e,0x12f0,0x1e,0x13f0,4,4,4,4,4,4,4,4,4
.long 0x507,0x4101020,0x5301021,0x4581020,0x5781021,0x4a01020,0x5c01021,0x4e81020,0x181012,0x601012,0xa81012,0xf01012,0x3381032,0x3801032,0x3c81032,0x71a5,0xe,0x20f0,0x21f0,0x1e,0x22f0,0x1e,0x23f0,4,4,4,4,4,4,4,4,4
.long 0x607,0x4101020,0x5301021,0x4581020,0x5781021,0x4a01020,0x5c01021,0x4e81020,0x181012,0x601012,0xa81012,0xf01012,0x3381032,0x3801032,0x3c81032,0x71b5,0xe,0x30f0,0x31f0,0x1e,0x32f0,0x1e,0x33f0,4,4,4,4,4,4,4,4,4
.long 0x707,0x4101020,0x5301021,0x4581020,0x5781021,0x4a01020,0x5c01021,0x4e81020,0x181012,0x601012,0xa81012,0xf01012,0x3381032,0x3801032,0x3c81032,0x71c5,0xe,0x40f0,0x41f0,0x1e,0x42f0,0x1e,0x43f0,4,4,4,4,4,4,4,4,4
.long 0x407,0x4201020,0x5401021,0x4681020,0x5881021,0x4b01020,0x5d01021,0x4f81020,0x381012,0x801012,0xc81012,0x3101032,0x3581032,0x3a01032,0x3e81032,0x71d5,0xe,0x50f0,0x51f0,0x1e,0x52f0,0x1e,0x53f0,4,4,4,4,4,4,4,4,4
.long 0x507,0x4201020,0x5401021,0x4681020,0x5881021,0x4b01020,0x5d01021,0x4f81020,0x381012,0x801012,0xc81012,0x3101032,0x3581032,0x3a01032,0x3e81032,0x71e5,0xe,0x60f0,0x61f0,0x1e,0x62f0,0x1e,0x63f0,4,4,4,4,4,4,4,4,4
.long 0x607,0x4201020,0x5401021,0x4681020,0x5881021,0x4b01020,0x5d01021,0x4f81020,0x381012,0x801012,0xc81012,0x3101032,0x3581032,0x3a01032,0x3e81032,0x71f5,0xe,0x70f0,0x71f0,0x1e,0x72f0,0x1e,0x73f0,4,4,4,4,4,4,4,4,4
.long 7,0x4800020,0x4801020,0x17,0x2080001,0x1201000,0x1380000,0x2481001,0x2600001,0x1781000,0x1900000,0x2a01001,0x2b80001,0x1d01000,0x2e00001,0x6105,0xe,0xa0,0x1a0,0x1e,0x2a0,0x1e,0x3a0,4,4,4,4,4,4,4,4,4
.long 7,0x5800021,0x5801021,0x117,0x2080001,0x1201000,0x1380000,0x2481001,0x2600001,0x1781000,0x1900000,0x2a01001,0x2b80001,0x1d01000,0x2e00001,0x6115,0xe,0x10a0,0x11a0,0x1e,0x12a0,0x1e,0x13a0,4,4,4,4,4,4,4,4,4
.long 7,0x4880020,0x4881020,0x217,0x2080001,0x1201000,0x1380000,0x2481001,0x2600001,0x1781000,0x1900000,0x2a01001,0x2b80001,0x1d01000,0x2e00001,0x6125,0xe,0x20a0,0x21a0,0x1e,0x22a0,0x1e,0x23a0,4,4,4,4,4,4,4,4,4
.long 7,0x5880021,0x5881021,0x317,0x2080001,0x1201000,0x1380000,0x2481001,0x2600001,0x1781000,0x1900000,0x2a01001,0x2b80001,0x1d01000,0x2e00001,0x6135,0xe,0x30a0,0x31a0,0x1e,0x32a0,0x1e,0x33a0,4,4,4,4,4,4,4,4,4
.long 7,0x4900020,0x4901020,0x417,0x2080001,0x1201000,0x1380000,0x2481001,0x2600001,0x1781000,0x1900000,0x2a01001,0x2b80001,0x1d01000,0x2e00001,0x6145,0xe,0x40a0,0x41a0,0x1e,0x42a0,0x1e,0x43a0,4,4,4,4,4,4,4,4,4
.long 7,0x5900021,0x5901021,0x517,0x2080001,0x1201000,0x1380000,0x2481001,0x2600001,0x1781000,0x1900000,0x2a01001,0x2b80001,0x1d01000,0x2e00001,0x6155,0xe,0x50a0,0x51a0,0x1e,0x52a0,0x1e,0x53a0,4,4,4,4,4,4,4,4,4
.long 7,0x4980020,0x4981020,0x617,0x2080001,0x1201000,0x1380000,0x2481001,0x2600001,0x1781000,0x1900000,0x2a01001,0x2b80001,0x1d01000,0x2e00001,0x6165,0xe,0x60a0,0x61a0,0x1e,0x62a0,0x1e,0x63a0,4,4,4,4,4,4,4,4,4
.long 7,0x5980021,0x5981021,0x717,0x2080001,0x1201000,0x1380000,0x2481001,0x2600001,0x1781000,0x1900000,0x2a01001,0x2b80001,0x1d01000,0x2e00001,0x6175,0xe,0x70a0,0x71a0,0x1e,0x72a0,0x1e,0x73a0,4,4,4,4,4,4,4,4,4
.long 0x17,0x2081001,0x2200001,0x1381000,0x1500000,0x2601001,0x2780001,0x1901000,0x1a80000,0x2b81001,0x2d00001,0x2e01001,0x1f00000,0x2f01001,0x2f80001,0x6185,0xe,0xb0,0x1b0,0x1e,0x2b0,0x1e,0x3b0,4,4,4,4,4,4,4,4,4
.long 0x117,0x2081001,0x2200001,0x1381000,0x1500000,0x2601001,0x2780001,0x1901000,0x1a80000,0x2b81001,0x2d00001,0x2e01001,0x1f00000,0x2f01001,0x2f80001,0x6195,0xe,0x10b0,0x11b0,0x1e,0x12b0,0x1e,0x13b0,4,4,4,4,4,4,4,4,4
.long 0x217,0x2081001,0x2200001,0x1381000,0x1500000,0x2601001,0x2780001,0x1901000,0x1a80000,0x2b81001,0x2d00001,0x2e01001,0x1f00000,0x2f01001,0x2f80001,0x61a5,0xe,0x20b0,0x21b0,0x1e,0x22b0,0x1e,0x23b0,4,4,4,4,4,4,4,4,4
.long 0x317,0x2081001,0x2200001,0x1381000,0x1500000,0x2601001,0x2780001,0x1901000,0x1a80000,0x2b81001,0x2d00001,0x2e01001,0x1f00000,0x2f01001,0x2f80001,0x61b5,0xe,0x30b0,0x31b0,0x1e,0x32b0,0x1e,0x33b0,4,4,4,4,4,4,4,4,4
.long 0x417,0x2081001,0x2200001,0x1381000,0x1500000,0x2601001,0x2780001,0x1901000,0x1a80000,0x2b81001,0x2d00001,0x2e01001,0x1f00000,0x2f01001,0x2f80001,0x61c5,0xe,0x40b0,0x41b0,0x1e,0x42b0,0x1e,0x43b0,4,4,4,4,4,4,4,4,4
.long 0x517,0x2081001,0x2200001,0x1381000,0x1500000,0x2601001,0x2780001,0x1901000,0x1a80000,0x2b81001,0x2d00001,0x2e01001,0x1f00000,0x2f01001,0x2f80001,0x61d5,0xe,0x50b0,0x51b0,0x1e,0x52b0,0x1e,0x53b0,4,4,4,4,4,4,4,4,4
.long 0x617,0x2081001,0x2200001,0x1381000,0x1500000,0x2601001,0x2780001,0x1901000,0x1a80000,0x2b81001,0x2d00001,0x2e01001,0x1f00000,0x2f01001,0x2f80001,0x61e5,0xe,0x60b0,0x61b0,0x1e,0x62b0,0x1e,0x63b0,4,4,4,4,4,4,4,4,4
.long 0x717,0x2081001,0x2200001,0x1381000,0x1500000,0x2601001,0x2780001,0x1901000,0x1a80000,0x2b81001,0x2d00001,0x2e01001,0x1f00000,0x2f01001,0x2f80001,0x61f5,0xe,0x70b0,0x71b0,0x1e,0x72b0,0x1e,0x73b0,4,4,4,4,4,4,4,4,4
.long 0x107,0x5100021,0x4380020,0x5580021,0x4800020,0x5a00021,0x4c80020,0x5e80021,0x200012,0x680012,0xb00012,0xf80012,0x3400032,0x3880032,0x3d00032,0x5105,0xe,0x60,0x160,0x1e,0x260,0x1e,0x360,4,4,4,4,4,4,4,4,4
.long 0x207,0x5100021,0x4380020,0x5580021,0x4800020,0x5a00021,0x4c80020,0x5e80021,0x200012,0x680012,0xb00012,0xf80012,0x3400032,0x3880032,0x3d00032,0x5115,0xe,0x1060,0x1160,0x1e,0x1260,0x1e,0x1360,4,4,4,4,4,4,4,4,4
.long 0x307,0x5100021,0x4380020,0x5580021,0x4800020,0x5a00021,0x4c80020,0x5e80021,0x200012,0x680012,0xb00012,0xf80012,0x3400032,0x3880032,0x3d00032,0x5125,0xe,0x2060,0x2160,0x1e,0x2260,0x1e,0x2360,4,4,4,4,4,4,4,4,4
.long 0x407,0x5100021,0x4380020,0x5580021,0x4800020,0x5a00021,0x4c80020,0x5e80021,0x200012,0x680012,0xb00012,0xf80012,0x3400032,0x3880032,0x3d00032,0x5135,0xe,0x3060,0x3160,0x1e,0x3260,0x1e,0x3360,4,4,4,4,4,4,4,4,4
.long 0x507,0x5100021,0x4380020,0x5580021,0x4800020,0x5a00021,0x4c80020,0x5e80021,0x200012,0x680012,0xb00012,0xf80012,0x3400032,0x3880032,0x3d00032,0x5145,0xe,0x4060,0x4160,0x1e,0x4260,0x1e,0x4360,4,4,4,4,4,4,4,4,4
.long 0x607,0x5100021,0x4380020,0x5580021,0x4800020,0x5a00021,0x4c80020,0x5e80021,0x200012,0x680012,0xb00012,0xf80012,0x3400032,0x3880032,0x3d00032,0x5155,0xe,0x5060,0x5160,0x1e,0x5260,0x1e,0x5360,4,4,4,4,4,4,4,4,4
.long 0x707,0x5100021,0x4380020,0x5580021,0x4800020,0x5a00021,0x4c80020,0x5e80021,0x200012,0x680012,0xb00012,0xf80012,0x3400032,0x3880032,0x3d00032,0x5165,0xe,0x6060,0x6160,0x1e,0x6260,0x1e,0x6360,4,4,4,4,4,4,4,4,4
.long 0x107,0x5101021,0x4381020,0x5581021,0x4801020,0x5a01021,0x4c81020,0x5e81021,0x201012,0x681012,0xb01012,0xf81012,0x3401032,0x3881032,0x3d01032,0x5175,0xe,0x7060,0x7160,0x1e,0x7260,0x1e,0x7360,4,4,4,4,4,4,4,4,4
.long 0x207,0x5101021,0x4381020,0x5581021,0x4801020,0x5a01021,0x4c81020,0x5e81021,0x201012,0x681012,0xb01012,0xf81012,0x3401032,0x3881032,0x3d01032,0x5185,0xe,0x70,0x170,0x1e,0x270,0x1e,0x370,4,4,4,4,4,4,4,4,4
.long 0x307,0x5101021,0x4381020,0x5581021,0x4801020,0x5a01021,0x4c81020,0x5e81021,0x201012,0x681012,0xb01012,0xf81012,0x3401032,0x3881032,0x3d01032,0x5195,0xe,0x1070,0x1170,0x1e,0x1270,0x1e,0x1370,4,4,4,4,4,4,4,4,4
.long 0x407,0x5101021,0x4381020,0x5581021,0x4801020,0x5a01021,0x4c81020,0x5e81021,0x201012,0x681012,0xb01012,0xf81012,0x3401032,0x3881032,0x3d01032,0x51a5,0xe,0x2070,0x2170,0x1e,0x2270,0x1e,0x2370,4,4,4,4,4,4,4,4,4
.long 0x507,0x5101021,0x4381020,0x5581021,0x4801020,0x5a01021,0x4c81020,0x5e81021,0x201012,0x681012,0xb01012,0xf81012,0x3401032,0x3881032,0x3d01032,0x51b5,0xe,0x3070,0x3170,0x1e,0x3270,0x1e,0x3370,4,4,4,4,4,4,4,4,4
.long 0x607,0x5101021,0x4381020,0x5581021,0x4801020,0x5a01021,0x4c81020,0x5e81021,0x201012,0x681012,0xb01012,0xf81012,0x3401032,0x3881032,0x3d01032,0x51c5,0xe,0x4070,0x4170,0x1e,0x4270,0x1e,0x4370,4,4,4,4,4,4,4,4,4
.long 0x707,0x5101021,0x4381020,0x5581021,0x4801020,0x5a01021,0x4c81020,0x5e81021,0x201012,0x681012,0xb01012,0xf81012,0x3401032,0x3881032,0x3d01032,0x51d5,0xe,0x5070,0x5170,0x1e,0x5270,0x1e,0x5370,4,4,4,4,4,4,4,4,4
.long 7,0x100012,0x380012,0x600012,0x880012,0xb00012,0xd80012,0x3000032,0x3280032,0x3500032,0x3780032,0x3a00032,0x3c80032,0x3f00032,0x51e5,0xe,0x6070,0x6170,0x1e,0x6270,0x1e,0x6370,4,4,4,4,4,4,4,4,4,4
.long 7,0x101012,0x381012,0x601012,0x881012,0xb01012,0xd81012,0x3001032,0x3281032,0x3501032,0x3781032,0x3a01032,0x3c81032,0x3f01032,0x51f5,0xe,0x7070,0x7170,0x1e,0x7270,0x1e,0x7370,4,4,4,4,4,4,4,4,4,4
.long 7,0x4a00020,0x4a01020,0x17,0x1100000,0x2201001,0x2380001,0x1501000,0x1680000,0x2781001,0x2900001,0x1a81000,0x1c00000,0x2d01001,0x1e80000,0x4105,0xe,0x20,0x120,0x1e,0x220,0x1e,0x320,4,4,4,4,4,4,4,4,4
.long 7,0x5a00021,0x5a01021,0x117,0x1100000,0x2201001,0x2380001,0x1501000,0x1680000,0x2781001,0x2900001,0x1a81000,0x1c00000,0x2d01001,0x1e80000,0x4115,0xe,0x1020,0x1120,0x1e,0x1220,0x1e,0x1320,4,4,4,4,4,4,4,4,4
.long 7,0x4a80020,0x4a81020,0x217,0x1100000,0x2201001,0x2380001,0x1501000,0x1680000,0x2781001,0x2900001,0x1a81000,0x1c00000,0x2d01001,0x1e80000,0x4125,0xe,0x2020,0x2120,0x1e,0x2220,0x1e,0x2320,4,4,4,4,4,4,4,4,4
.long 7,0x5a80021,0x5a81021,0x317,0x1100000,0x2201001,0x2380001,0x1501000,0x1680000,0x2781001,0x2900001,0x1a81000,0x1c00000,0x2d01001,0x1e80000,0x4135,0xe,0x3020,0x3120,0x1e,0x3220,0x1e,0x3320,4,4,4,4,4,4,4,4,4
.long 7,0x4b00020,0x4b01020,0x417,0x1100000,0x2201001,0x2380001,0x1501000,0x1680000,0x2781001,0x2900001,0x1a81000,0x1c00000,0x2d01001,0x1e80000,0x4145,0xe,0x4020,0x4120,0x1e,0x4220,0x1e,0x4320,4,4,4,4,4,4,4,4,4
.long 7,0x5b00021,0x5b01021,0x517,0x1100000,0x2201001,0x2380001,0x1501000,0x1680000,0x2781001,0x2900001,0x1a81000,0x1c00000,0x2d01001,0x1e80000,0x4155,0xe,0x5020,0x5120,0x1e,0x5220,0x1e,0x5320,4,4,4,4,4,4,4,4,4
.long 7,0x4b80020,0x4b81020,0x617,0x1100000,0x2201001,0x2380001,0x1501000,0x1680000,0x2781001,0x2900001,0x1a81000,0x1c00000,0x2d01001,0x1e80000,0x4165,0xe,0x6020,0x6120,0x1e,0x6220,0x1e,0x6320,4,4,4,4,4,4,4,4,4
.long 7,0x5b80021,0x5b81021,0x717,0x1100000,0x2201001,0x2380001,0x1501000,0x1680000,0x2781001,0x2900001,0x1a81000,0x1c00000,0x2d01001,0x1e80000,0x4175,0xe,0x7020,0x7120,0x1e,0x7220,0x1e,0x7320,4,4,4,4,4,4,4,4,4
.long 0x107,0x4180020,0x5380021,0x4600020,0x5800021,0x4a80020,0x5c80021,0x4f00020,0x280012,0x700012,0xb80012,0x3000032,0x3480032,0x3900032,0x3d80032,0x4185,0xe,0x30,0x130,0x1e,0x230,0x1e,0x330,4,4,4,4,4,4,4,4,4
.long 0x207,0x4180020,0x5380021,0x4600020,0x5800021,0x4a80020,0x5c80021,0x4f00020,0x280012,0x700012,0xb80012,0x3000032,0x3480032,0x3900032,0x3d80032,0x4195,0xe,0x1030,0x1130,0x1e,0x1230,0x1e,0x1330,4,4,4,4,4,4,4,4,4
.long 0x307,0x4180020,0x5380021,0x4600020,0x5800021,0x4a80020,0x5c80021,0x4f00020,0x280012,0x700012,0xb80012,0x3000032,0x3480032,0x3900032,0x3d80032,0x41a5,0xe,0x2030,0x2130,0x1e,0x2230,0x1e,0x2330,4,4,4,4,4,4,4,4,4
.long 0x407,0x4180020,0x5380021,0x4600020,0x5800021,0x4a80020,0x5c80021,0x4f00020,0x280012,0x700012,0xb80012,0x3000032,0x3480032,0x3900032,0x3d80032,0x41b5,0xe,0x3030,0x3130,0x1e,0x3230,0x1e,0x3330,4,4,4,4,4,4,4,4,4
.long 0x507,0x4180020,0x5380021,0x4600020,0x5800021,0x4a80020,0x5c80021,0x4f00020,0x280012,0x700012,0xb80012,0x3000032,0x3480032,0x3900032,0x3d80032,0x41c5,0xe,0x4030,0x4130,0x1e,0x4230,0x1e,0x4330,4,4,4,4,4,4,4,4,4
.long 0x607,0x4180020,0x5380021,0x4600020,0x5800021,0x4a80020,0x5c80021,0x4f00020,0x280012,0x700012,0xb80012,0x3000032,0x3480032,0x3900032,0x3d80032,0x41d5,0xe,0x5030,0x5130,0x1e,0x5230,0x1e,0x5330,4,4,4,4,4,4,4,4,4
.long 0x707,0x4180020,0x5380021,0x4600020,0x5800021,0x4a80020,0x5c80021,0x4f00020,0x280012,0x700012,0xb80012,0x3000032,0x3480032,0x3900032,0x3d80032,0x41e5,0xe,0x6030,0x6130,0x1e,0x6230,0x1e,0x6330,4,4,4,4,4,4,4,4,4
.long 0x107,0x4181020,0x5381021,0x4601020,0x5801021,0x4a81020,0x5c81021,0x4f01020,0x281012,0x701012,0xb81012,0x3001032,0x3481032,0x3901032,0x3d81032,0x41f5,0xe,0x7030,0x7130,0x1e,0x7230,0x1e,0x7330,4,4,4,4,4,4,4,4,4
.long 0x207,0x4181020,0x5381021,0x4601020,0x5801021,0x4a81020,0x5c81021,0x4f01020,0x281012,0x701012,0xb81012,0x3001032,0x3481032,0x3901032,0x3d81032,0x3105,6,0x50,0xb0,0x110,0x170,0x1d0,0x230,0x290,0x2f0,0x350,0x3b0,4,4,4,4,4
.long 0x307,0x4181020,0x5381021,0x4601020,0x5801021,0x4a81020,0x5c81021,0x4f01020,0x281012,0x701012,0xb81012,0x3001032,0x3481032,0x3901032,0x3d81032,0x3115,0x16,0x50,0xb0,0x110,0x170,0x1d0,0x230,0x290,0x2f0,0x350,0x3b0,4,4,4,4,4
.long 0x407,0x4181020,0x5381021,0x4601020,0x5801021,0x4a81020,0x5c81021,0x4f01020,0x281012,0x701012,0xb81012,0x3001032,0x3481032,0x3901032,0x3d81032,0x3125,0x26,0x50,0xb0,0x110,0x170,0x1d0,0x230,0x290,0x2f0,0x350,0x3b0,4,4,4,4,4
.long 0x507,0x4181020,0x5381021,0x4601020,0x5801021,0x4a81020,0x5c81021,0x4f01020,0x281012,0x701012,0xb81012,0x3001032,0x3481032,0x3901032,0x3d81032,0x3135,0x36,0x50,0xb0,0x110,0x170,0x1d0,0x230,0x290,0x2f0,0x350,0x3b0,4,4,4,4,4
.long 0x607,0x4181020,0x5381021,0x4601020,0x5801021,0x4a81020,0x5c81021,0x4f01020,0x281012,0x701012,0xb81012,0x3001032,0x3481032,0x3901032,0x3d81032,0x3145,0x46,0x50,0xb0,0x110,0x170,0x1d0,0x230,0x290,0x2f0,0x350,0x3b0,4,4,4,4,4
.long 0x707,0x4181020,0x5381021,0x4601020,0x5801021,0x4a81020,0x5c81021,0x4f01020,0x281012,0x701012,0xb81012,0x3001032,0x3481032,0x3901032,0x3d81032,0x3155,0x56,0x50,0xb0,0x110,0x170,0x1d0,0x230,0x290,0x2f0,0x350,0x3b0,4,4,4,4,4
.long 0x107,0x5180021,0x4400020,0x5600021,0x4880020,0x5a80021,0x4d00020,0x5f00021,0x300012,0x780012,0xc00012,0x3080032,0x3500032,0x3980032,0x3e00032,0x3165,0x66,0x50,0xb0,0x110,0x170,0x1d0,0x230,0x290,0x2f0,0x350,0x3b0,4,4,4,4,4
.long 0x207,0x5180021,0x4400020,0x5600021,0x4880020,0x5a80021,0x4d00020,0x5f00021,0x300012,0x780012,0xc00012,0x3080032,0x3500032,0x3980032,0x3e00032,0x3175,0x76,0x50,0xb0,0x110,0x170,0x1d0,0x230,0x290,0x2f0,0x350,0x3b0,4,4,4,4,4
.long 0x307,0x5180021,0x4400020,0x5600021,0x4880020,0x5a80021,0x4d00020,0x5f00021,0x300012,0x780012,0xc00012,0x3080032,0x3500032,0x3980032,0x3e00032,0x3185,0x86,0x50,0xb0,0x110,0x170,0x1d0,0x230,0x290,0x2f0,0x350,0x3b0,4,4,4,4,4
.long 0x407,0x5180021,0x4400020,0x5600021,0x4880020,0x5a80021,0x4d00020,0x5f00021,0x300012,0x780012,0xc00012,0x3080032,0x3500032,0x3980032,0x3e00032,0x3195,0x96,0x50,0xb0,0x110,0x170,0x1d0,0x230,0x290,0x2f0,0x350,0x3b0,4,4,4,4,4
.long 0x507,0x5180021,0x4400020,0x5600021,0x4880020,0x5a80021,0x4d00020,0x5f00021,0x300012,0x780012,0xc00012,0x3080032,0x3500032,0x3980032,0x3e00032,0x31a5,0xa6,0x50,0xb0,0x110,0x170,0x1d0,0x230,0x290,0x2f0,0x350,0x3b0,4,4,4,4,4
.long 0x607,0x5180021,0x4400020,0x5600021,0x4880020,0x5a80021,0x4d00020,0x5f00021,0x300012,0x780012,0xc00012,0x3080032,0x3500032,0x3980032,0x3e00032,0x31b5,0xb6,0x50,0xb0,0x110,0x170,0x1d0,0x230,0x290,0x2f0,0x350,0x3b0,4,4,4,4,4
.long 0x707,0x5180021,0x4400020,0x5600021,0x4880020,0x5a80021,0x4d00020,0x5f00021,0x300012,0x780012,0xc00012,0x3080032,0x3500032,0x3980032,0x3e00032,0x31c5,0xc6,0x50,0xb0,0x110,0x170,0x1d0,0x230,0x290,0x2f0,0x350,0x3b0,4,4,4,4,4
.long 0x707,0x4201020,0x5401021,0x4681020,0x5881021,0x4b01020,0x5d01021,0x4f81020,0x381012,0x801012,0xc81012,0x3101032,0x3581032,0x3a01032,0x3e81032,0x31d5,0xd6,0x50,0xb0,0x110,0x170,0x1d0,0x230,0x290,0x2f0,0x350,0x3b0,4,4,4,4,4
.long 7,0x200012,0x480012,0x700012,0x980012,0xc00012,0xe80012,0x3100032,0x3380032,0x3600032,0x3880032,0x3b00032,0x3d80032,0x31e5,0xe6,0x50,0xb0,0x110,0x170,0x1d0,0x230,0x290,0x2f0,0x350,0x3b0,4,4,4,4,4,4,4
.long 0x27,0x201012,0x481012,0x701012,0x981012,0xc01012,0xe81012,0x3101032,0x3381032,0x3601032,0x3881032,0x3b01032,0x3d81032,0x31f5,0xf6,0x50,0xb0,0x110,0x170,0x1d0,0x230,0x290,0x2f0,0x350,0x3b0,4,4,4,4,4,4,4
.long 7,0x4c00020,0x4c01020,0x17,0x1101000,0x1280000,0x2381001,0x2500001,0x1681000,0x1800000,0x2901001,0x2a80001,0x1c01000,0x1d80000,0x1e81000,0x2105,6,0x10,0x70,0xd0,0x130,0x190,0x1f0,0x250,0x2b0,0x310,0x370,0x3d0,4,4,4,4
.long 7,0x5c00021,0x5c01021,0x117,0x1101000,0x1280000,0x2381001,0x2500001,0x1681000,0x1800000,0x2901001,0x2a80001,0x1c01000,0x1d80000,0x1e81000,0x2115,0x16,0x10,0x70,0xd0,0x130,0x190,0x1f0,0x250,0x2b0,0x310,0x370,0x3d0,4,4,4,4
.long 7,0x4c80020,0x4c81020,0x217,0x1101000,0x1280000,0x2381001,0x2500001,0x1681000,0x1800000,0x2901001,0x2a80001,0x1c01000,0x1d80000,0x1e81000,0x2125,0x26,0x10,0x70,0xd0,0x130,0x190,0x1f0,0x250,0x2b0,0x310,0x370,0x3d0,4,4,4,4
.long 7,0x5c80021,0x5c81021,0x317,0x1101000,0x1280000,0x2381001,0x2500001,0x1681000,0x1800000,0x2901001,0x2a80001,0x1c01000,0x1d80000,0x1e81000,0x2135,0x36,0x10,0x70,0xd0,0x130,0x190,0x1f0,0x250,0x2b0,0x310,0x370,0x3d0,4,4,4,4
.long 7,0x4d00020,0x4d01020,0x417,0x1101000,0x1280000,0x2381001,0x2500001,0x1681000,0x1800000,0x2901001,0x2a80001,0x1c01000,0x1d80000,0x1e81000,0x2145,0x46,0x10,0x70,0xd0,0x130,0x190,0x1f0,0x250,0x2b0,0x310,0x370,0x3d0,4,4,4,4
.long 7,0x5d00021,0x5d01021,0x517,0x1101000,0x1280000,0x2381001,0x2500001,0x1681000,0x1800000,0x2901001,0x2a80001,0x1c01000,0x1d80000,0x1e81000,0x2155,0x56,0x10,0x70,0xd0,0x130,0x190,0x1f0,0x250,0x2b0,0x310,0x370,0x3d0,4,4,4,4
.long 7,0x4d80020,0x4d81020,0x617,0x1101000,0x1280000,0x2381001,0x2500001,0x1681000,0x1800000,0x2901001,0x2a80001,0x1c01000,0x1d80000,0x1e81000,0x2165,0x66,0x10,0x70,0xd0,0x130,0x190,0x1f0,0x250,0x2b0,0x310,0x370,0x3d0,4,4,4,4
.long 7,0x5d80021,0x5d81021,0x717,0x1101000,0x1280000,0x2381001,0x2500001,0x1681000,0x1800000,0x2901001,0x2a80001,0x1c01000,0x1d80000,0x1e81000,0x2175,0x76,0x10,0x70,0xd0,0x130,0x190,0x1f0,0x250,0x2b0,0x310,0x370,0x3d0,4,4,4,4
.long 0x17,0x2100001,0x1281000,0x1400000,0x2501001,0x2680001,0x1801000,0x1980000,0x2a81001,0x2c00001,0x1d81000,0x2e80001,0x1f01000,0x1f80000,0x2f81001,0x2185,0x86,0x10,0x70,0xd0,0x130,0x190,0x1f0,0x250,0x2b0,0x310,0x370,0x3d0,4,4,4,4
.long 0x117,0x2100001,0x1281000,0x1400000,0x2501001,0x2680001,0x1801000,0x1980000,0x2a81001,0x2c00001,0x1d81000,0x2e80001,0x1f01000,0x1f80000,0x2f81001,0x2195,0x96,0x10,0x70,0xd0,0x130,0x190,0x1f0,0x250,0x2b0,0x310,0x370,0x3d0,4,4,4,4
.long 0x217,0x2100001,0x1281000,0x1400000,0x2501001,0x2680001,0x1801000,0x1980000,0x2a81001,0x2c00001,0x1d81000,0x2e80001,0x1f01000,0x1f80000,0x2f81001,0x21a5,0xa6,0x10,0x70,0xd0,0x130,0x190,0x1f0,0x250,0x2b0,0x310,0x370,0x3d0,4,4,4,4
.long 0x317,0x2100001,0x1281000,0x1400000,0x2501001,0x2680001,0x1801000,0x1980000,0x2a81001,0x2c00001,0x1d81000,0x2e80001,0x1f01000,0x1f80000,0x2f81001,0x21b5,0xb6,0x10,0x70,0xd0,0x130,0x190,0x1f0,0x250,0x2b0,0x310,0x370,0x3d0,4,4,4,4
.long 0x417,0x2100001,0x1281000,0x1400000,0x2501001,0x2680001,0x1801000,0x1980000,0x2a81001,0x2c00001,0x1d81000,0x2e80001,0x1f01000,0x1f80000,0x2f81001,0x21c5,0xc6,0x10,0x70,0xd0,0x130,0x190,0x1f0,0x250,0x2b0,0x310,0x370,0x3d0,4,4,4,4
.long 0x517,0x2100001,0x1281000,0x1400000,0x2501001,0x2680001,0x1801000,0x1980000,0x2a81001,0x2c00001,0x1d81000,0x2e80001,0x1f01000,0x1f80000,0x2f81001,0x21d5,0xd6,0x10,0x70,0xd0,0x130,0x190,0x1f0,0x250,0x2b0,0x310,0x370,0x3d0,4,4,4,4
.long 0x617,0x2100001,0x1281000,0x1400000,0x2501001,0x2680001,0x1801000,0x1980000,0x2a81001,0x2c00001,0x1d81000,0x2e80001,0x1f01000,0x1f80000,0x2f81001,0x21e5,0xe6,0x10,0x70,0xd0,0x130,0x190,0x1f0,0x250,0x2b0,0x310,0x370,0x3d0,4,4,4,4
.long 0x717,0x2100001,0x1281000,0x1400000,0x2501001,0x2680001,0x1801000,0x1980000,0x2a81001,0x2c00001,0x1d81000,0x2e80001,0x1f01000,0x1f80000,0x2f81001,0x21f5,0xf6,0x10,0x70,0xd0,0x130,0x190,0x1f0,0x250,0x2b0,0x310,0x370,0x3d0,4,4,4,4
.long 0x107,0x5181021,0x4401020,0x5601021,0x4881020,0x5a81021,0x4d01020,0x5f01021,0x301012,0x781012,0xc01012,0x3081032,0x3501032,0x3981032,0x3e01032,0x1105,0x105,6,0x30,0x90,0xf0,0x150,0x1b0,0x210,0x270,0x2d0,0x330,0x390,0x3f0,4,4,4
.long 0x207,0x5181021,0x4401020,0x5601021,0x4881020,0x5a81021,0x4d01020,0x5f01021,0x301012,0x781012,0xc01012,0x3081032,0x3501032,0x3981032,0x3e01032,0x1115,0x115,0x16,0x30,0x90,0xf0,0x150,0x1b0,0x210,0x270,0x2d0,0x330,0x390,0x3f0,4,4,4
.long 0x307,0x5181021,0x4401020,0x5601021,0x4881020,0x5a81021,0x4d01020,0x5f01021,0x301012,0x781012,0xc01012,0x3081032,0x3501032,0x3981032,0x3e01032,0x1125,0x125,0x26,0x30,0x90,0xf0,0x150,0x1b0,0x210,0x270,0x2d0,0x330,0x390,0x3f0,4,4,4
.long 0x407,0x5181021,0x4401020,0x5601021,0x4881020,0x5a81021,0x4d01020,0x5f01021,0x301012,0x781012,0xc01012,0x3081032,0x3501032,0x3981032,0x3e01032,0x1135,0x135,0x36,0x30,0x90,0xf0,0x150,0x1b0,0x210,0x270,0x2d0,0x330,0x390,0x3f0,4,4,4
.long 0x507,0x5181021,0x4401020,0x5601021,0x4881020,0x5a81021,0x4d01020,0x5f01021,0x301012,0x781012,0xc01012,0x3081032,0x3501032,0x3981032,0x3e01032,0x1145,0x145,0x46,0x30,0x90,0xf0,0x150,0x1b0,0x210,0x270,0x2d0,0x330,0x390,0x3f0,4,4,4
.long 0x607,0x5181021,0x4401020,0x5601021,0x4881020,0x5a81021,0x4d01020,0x5f01021,0x301012,0x781012,0xc01012,0x3081032,0x3501032,0x3981032,0x3e01032,0x1155,0x155,0x56,0x30,0x90,0xf0,0x150,0x1b0,0x210,0x270,0x2d0,0x330,0x390,0x3f0,4,4,4
.long 0x707,0x5181021,0x4401020,0x5601021,0x4881020,0x5a81021,0x4d01020,0x5f01021,0x301012,0x781012,0xc01012,0x3081032,0x3501032,0x3981032,0x3e01032,0x1165,0x165,0x66,0x30,0x90,0xf0,0x150,0x1b0,0x210,0x270,0x2d0,0x330,0x390,0x3f0,4,4,4
.long 0x127,0x4200020,0x5400021,0x4680020,0x5880021,0x4b00020,0x5d00021,0x4f80020,0x380012,0x800012,0xc80012,0x3100032,0x3580032,0x3a00032,0x3e80032,0x1175,0x175,0x76,0x30,0x90,0xf0,0x150,0x1b0,0x210,0x270,0x2d0,0x330,0x390,0x3f0,4,4,4
.long 0x227,0x4200020,0x5400021,0x4680020,0x5880021,0x4b00020,0x5d00021,0x4f80020,0x380012,0x800012,0xc80012,0x3100032,0x3580032,0x3a00032,0x3e80032,0x1185,0x185,0x86,0x30,0x90,0xf0,0x150,0x1b0,0x210,0x270,0x2d0,0x330,0x390,0x3f0,4,4,4
.long 0x327,0x4200020,0x5400021,0x4680020,0x5880021,0x4b00020,0x5d00021,0x4f80020,0x380012,0x800012,0xc80012,0x3100032,0x3580032,0x3a00032,0x3e80032,0x1195,0x195,0x96,0x30,0x90,0xf0,0x150,0x1b0,0x210,0x270,0x2d0,0x330,0x390,0x3f0,4,4,4
.long 0x427,0x4200020,0x5400021,0x4680020,0x5880021,0x4b00020,0x5d00021,0x4f80020,0x380012,0x800012,0xc80012,0x3100032,0x3580032,0x3a00032,0x3e80032,0x11a5,0x1a5,0xa6,0x30,0x90,0xf0,0x150,0x1b0,0x210,0x270,0x2d0,0x330,0x390,0x3f0,4,4,4
.long 0x527,0x4200020,0x5400021,0x4680020,0x5880021,0x4b00020,0x5d00021,0x4f80020,0x380012,0x800012,0xc80012,0x3100032,0x3580032,0x3a00032,0x3e80032,0x11b5,0x1b5,0xb6,0x30,0x90,0xf0,0x150,0x1b0,0x210,0x270,0x2d0,0x330,0x390,0x3f0,4,4,4
.long 0x627,0x4200020,0x5400021,0x4680020,0x5880021,0x4b00020,0x5d00021,0x4f80020,0x380012,0x800012,0xc80012,0x3100032,0x3580032,0x3a00032,0x3e80032,0x11c5,0x1c5,0xc6,0x30,0x90,0xf0,0x150,0x1b0,0x210,0x270,0x2d0,0x330,0x390,0x3f0,4,4,4
.long 0x727,0x4200020,0x5400021,0x4680020,0x5880021,0x4b00020,0x5d00021,0x4f80020,0x380012,0x800012,0xc80012,0x3100032,0x3580032,0x3a00032,0x3e80032,0x11d5,0x1d5,0xd6,0x30,0x90,0xf0,0x150,0x1b0,0x210,0x270,0x2d0,0x330,0x390,0x3f0,4,4,4
.long 7,0x180012,0x400012,0x680012,0x900012,0xb80012,0xe00012,0x3080032,0x3300032,0x3580032,0x3800032,0x3a80032,0x3d00032,0x3f80032,0x11e5,0x1e5,0xe6,0x30,0x90,0xf0,0x150,0x1b0,0x210,0x270,0x2d0,0x330,0x390,0x3f0,4,4,4,4
.long 7,0x181012,0x401012,0x681012,0x901012,0xb81012,0xe01012,0x3081032,0x3301032,0x3581032,0x3801032,0x3a81032,0x3d01032,0x3f81032,0x11f5,0x1f5,0xf6,0x30,0x90,0xf0,0x150,0x1b0,0x210,0x270,0x2d0,0x330,0x390,0x3f0,4,4,4,4
.section .rodata,"a"
.p2align 6
.amdhsa_kernel gated_mix__compressed_kv_cla__memory_aug_recurrent_mem_tr__prompt_kernel
  .amdhsa_next_free_vgpr 512
  .amdhsa_next_free_sgpr 102
  .amdhsa_accum_offset 256
  .amdhsa_group_segment_fixed_size 0
  .amdhsa_kernarg_size 136
  .amdhsa_user_sgpr_count 2
  .amdhsa_user_sgpr_kernarg_segment_ptr 1
  .amdhsa_system_sgpr_workgroup_id_x 1
  .amdhsa_float_denorm_mode_32 3
.end_amdhsa_kernel
```

```asm
; @launch grid=(256,1,1) block=(256,1,1) lds=163840
.amdgcn_target "amdgcn-amd-amdhsa--gfx950"
.text
.globl gated_mix__compressed_kv_cla__memory_aug_recurrent_mem_tr__prompt_kernel
.p2align 8
.type gated_mix__compressed_kv_cla__memory_aug_recurrent_mem_tr__prompt_kernel,@function
gated_mix__compressed_kv_cla__memory_aug_recurrent_mem_tr__prompt_kernel:
  s_cmp_ge_u32 s2, 256
  s_cbranch_scc1 L_exit
  s_load_dwordx16 s[8:23], s[0:1], 0
  s_load_dwordx16 s[24:39], s[0:1], 64
  s_load_dwordx2 s[40:41], s[0:1], 128
  s_and_b32 s47, s2, 7
  s_lshr_b32 s45, s2, 3
  s_max_u32 s3, s47, 1
  s_sub_u32 s3, s3, 1
  s_lshl_b32 s3, s3, 5
  s_add_u32 s94, s3, s45
  s_getpc_b64 s[4:5]
L_pc0:
  s_add_u32 s4, s4, L_ptab-L_pc0
  s_addc_u32 s5, s5, 0
  s_lshl_b32 s3, s94, 7
  v_and_b32 v2, 31, v0
  v_lshl_add_u32 v2, v2, 2, s3
  global_load_dword v1, v2, s[4:5]
  s_getreg_b32 s46, hwreg(HW_REG_XCC_ID, 0, 4)
  v_lshrrev_b32 v3, 6, v0
  v_and_b32 v0, 63, v0
  v_readfirstlane_b32 s44, v3
  s_and_b32 s46, s46, 7
  s_waitcnt lgkmcnt(0)
  s_and_b32 s41, s41, 0xffff
  s_mov_b32 s42, 0x10000000
  s_mov_b32 s43, 0x20000
  s_cmp_eq_u32 s47, 0
  s_cbranch_scc1 L_team
  s_lshl2_add_u32 s3, s94, s44
  v_lshlrev_b32 v2, 7, v0
  s_mov_b32 s95, 0
  s_mov_b32 s50, 0x200000
  s_mov_b32 s51, 0x20000
  s_add_u32 s4, s3, 0
  s_lshr_b32 s5, s4, 8
  s_and_b32 s4, s4, 255
  s_lshl_b32 s4, s4, 13
  s_mov_b64 s[48:49], s[8:9]
  s_mov_b32 s6, 0
  s_cmp_eq_u32 s5, 0
  s_cselect_b64 s[48:49], s[8:9], s[48:49]
  s_cselect_b32 s6, 0x0, s6
  s_cmp_eq_u32 s5, 1
  s_cselect_b64 s[48:49], s[10:11], s[48:49]
  s_cselect_b32 s6, 0x0, s6
  s_add_u32 s48, s48, s6
  s_addc_u32 s49, s49, 0
  s_and_b32 s49, s49, 0xffff
  s_cmp_lt_u32 s5, 2
  s_cselect_b32 s4, s4, 0x40000000
  buffer_load_dword v31, v2, s[48:51], s4 offen
  s_waitcnt vmcnt(1)
L_next:
  v_readlane_b32 s3, v1, s95
  s_add_u32 s95, s95, 1
  s_nop 0
  s_and_b32 s4, s3, 3
  s_cmp_eq_u32 s4, 0
  s_cbranch_scc1 L_after_p
  s_cmp_eq_u32 s4, 2
  s_cbranch_scc1 L_go_outx
L_go_att:
  s_bfe_u32 s56, s3, 0x50004
  s_bfe_u32 s57, s3, 0x3000c
  s_bitcmp1_b32 s3, 3
  s_cbranch_scc1 L_feed
L_att:
  v_lshlrev_b32 v2, 4, v0
  s_lshl_b32 s65, s44, 11
  v_add_u32 v3, s65, v2
  s_mov_b32 s74, 0
  v_and_b32 v6, 7, v0
  s_lshl3_add_u32 s67, s57, 8
  v_lshlrev_b32 v7, 4, v6
  v_sub_u32 v7, s67, v7
  v_med3_i32 v7, v7, 0, 16
  s_lshl_b32 s66, s56, 7
  s_add_u32 s66, s66, 0xd080000
  v_lshl_add_u32 v6, v6, 2, s66
  s_bfe_u32 s66, s57, 0x10001
  s_sub_u32 m0, 5, s66
  s_and_b32 s66, s57, 1
  s_lshl3_add_u32 s66, s66, 8
  s_cmp_lt_u32 s57, 4
  s_cselect_b32 s67, 16, 0
  s_add_u32 s67, s67, s66
  v_writelane_b32 v7, s67, m0
  s_lshl_b32 s66, s57, 7
  s_add_u32 s66, s66, 0xd086400
  v_writelane_b32 v6, s66, 63
  v_writelane_b32 v7, 16, 63
  buffer_load_dword v24, v6, s[40:43], 0 offen sc1
  v_mov_b64 v[128:129], 0
  v_mov_b64 v[130:131], 0
  v_mov_b64 v[132:133], 0
  v_mov_b64 v[134:135], 0
  v_mov_b64 v[136:137], 0
  v_mov_b64 v[138:139], 0
  v_mov_b64 v[140:141], 0
  v_mov_b64 v[142:143], 0
  v_mov_b64 v[144:145], 0
  v_mov_b64 v[146:147], 0
  v_mov_b64 v[148:149], 0
  v_mov_b64 v[150:151], 0
  v_mov_b64 v[152:153], 0
  v_mov_b64 v[154:155], 0
  v_mov_b64 v[156:157], 0
  v_mov_b64 v[158:159], 0
  v_mov_b64 v[160:161], 0
  v_mov_b64 v[162:163], 0
  v_mov_b64 v[164:165], 0
  v_mov_b64 v[166:167], 0
  v_mov_b64 v[168:169], 0
  v_mov_b64 v[170:171], 0
  v_mov_b64 v[172:173], 0
  v_mov_b64 v[174:175], 0
  v_mov_b64 v[176:177], 0
  v_mov_b64 v[178:179], 0
  v_mov_b64 v[180:181], 0
  v_mov_b64 v[182:183], 0
  v_mov_b64 v[184:185], 0
  v_mov_b64 v[186:187], 0
  v_mov_b64 v[188:189], 0
  v_mov_b64 v[190:191], 0
  v_mov_b64 v[192:193], 0
  v_mov_b64 v[194:195], 0
  v_mov_b64 v[196:197], 0
  v_mov_b64 v[198:199], 0
  v_mov_b64 v[200:201], 0
  v_mov_b64 v[202:203], 0
  v_mov_b64 v[204:205], 0
  v_mov_b64 v[206:207], 0
  v_mov_b64 v[208:209], 0
  v_mov_b64 v[210:211], 0
  v_mov_b64 v[212:213], 0
  v_mov_b64 v[214:215], 0
  v_mov_b64 v[216:217], 0
  v_mov_b64 v[218:219], 0
  v_mov_b64 v[220:221], 0
  v_mov_b64 v[222:223], 0
  v_mov_b64 v[224:225], 0
  v_mov_b64 v[226:227], 0
  v_mov_b64 v[228:229], 0
  v_mov_b64 v[230:231], 0
  v_mov_b64 v[232:233], 0
  v_mov_b64 v[234:235], 0
  v_mov_b64 v[236:237], 0
  v_mov_b64 v[238:239], 0
  v_mov_b64 v[240:241], 0
  v_mov_b64 v[242:243], 0
  v_mov_b64 v[244:245], 0
  v_mov_b64 v[246:247], 0
  v_mov_b64 v[248:249], 0
  v_mov_b64 v[250:251], 0
  v_mov_b64 v[252:253], 0
  v_mov_b64 v[254:255], 0
  v_mov_b64 v[96:97], 0
  v_accvgpr_write_b32 a128, 0
  v_mov_b64 v[98:99], 0
  v_accvgpr_write_b32 a129, 0
  v_mov_b64 v[100:101], 0
  v_accvgpr_write_b32 a130, 0
  v_mov_b64 v[102:103], 0
  v_accvgpr_write_b32 a131, 0
  v_mov_b64 v[104:105], 0
  v_accvgpr_write_b32 a132, 0
  v_mov_b64 v[106:107], 0
  v_accvgpr_write_b32 a133, 0
  v_mov_b64 v[108:109], 0
  v_accvgpr_write_b32 a134, 0
  v_mov_b64 v[110:111], 0
  v_accvgpr_write_b32 a135, 0
  v_mov_b64 v[112:113], 0
  v_accvgpr_write_b32 a136, 0
  v_mov_b64 v[114:115], 0
  v_accvgpr_write_b32 a137, 0
  v_mov_b64 v[116:117], 0
  v_accvgpr_write_b32 a138, 0
  v_mov_b64 v[118:119], 0
  v_accvgpr_write_b32 a139, 0
  v_mov_b64 v[120:121], 0
  v_accvgpr_write_b32 a140, 0
  v_mov_b64 v[122:123], 0
  v_accvgpr_write_b32 a141, 0
  v_mov_b64 v[124:125], 0
  v_accvgpr_write_b32 a142, 0
  v_mov_b64 v[126:127], 0
  v_accvgpr_write_b32 a143, 0
  v_mov_b32 v16, 0x3f803f80
  v_mov_b32 v17, 0x3f803f80
  v_mov_b32 v18, 0x3f803f80
  v_mov_b32 v19, 0x3f803f80
  s_mov_b32 s48, s18
  s_and_b32 s49, s19, 0xffff
  s_mov_b32 s50, 0x400000
  s_mov_b32 s51, 0x20000
  s_lshl_b32 s66, s56, 19
  s_add_u32 s60, s66, 0x1000000
  s_add_u32 s61, s66, 0x2000000
  s_lshl_b32 s59, s57, 3
  s_lshr_b32 s67, s44, 1
  s_add_u32 s67, s67, s59
  s_lshl_b32 s68, s67, 13
  s_add_u32 s68, s68, s66
  s_and_b32 s67, s44, 1
  s_lshl_b32 s67, s67, 10
  s_add_u32 s68, s68, s67
  s_lshl4_add_u32 s69, s57, s44
  s_add_u32 s63, s59, 7
  s_lshl_b32 s63, s63, 13
  s_add_u32 s63, s63, s60
  s_sub_u32 s59, s59, 1
  s_add_u32 s62, s60, 0x4000
  s_mov_b32 s64, 0
  s_mov_b32 s70, 0x40004000
  s_lshl_b32 s73, s44, 12
  s_lshl_b32 s72, s56, 17
  s_lshl_b32 s67, s44, 15
  s_add_u32 s72, s72, s67
  v_lshrrev_b32 v8, 4, v0
  v_and_b32 v9, 15, v0
  s_lshl_b32 s67, s44, 4
  v_add_u32 v25, s67, v9
  v_lshlrev_b32 v10, 2, v8
  v_sub_u32 v25, v25, v10
  v_lshlrev_b32 v8, 1, v8
  v_and_b32 v10, 7, v0
  v_xor_b32 v8, v8, v10
  v_lshlrev_b32 v8, 4, v8
  v_lshrrev_b32 v10, 3, v0
  v_lshl_add_u32 v26, v10, 10, v8
  v_lshlrev_b32 v9, 2, v9
  v_add_u32 v4, 122880, v2
L_a_wait:
  s_waitcnt vmcnt(0)
  v_cmp_gt_u32 vcc, v7, v24
  s_cbranch_vccz L_a_go
  buffer_load_dword v24, v6, s[40:43], 0 offen sc1
  s_add_u32 s74, s74, 1
  s_cmp_gt_u32 s74, 1048576
  s_cbranch_scc1 L_exit
  s_branch L_a_wait
L_a_go:
  s_add_u32 m0, s65, 131072
  s_add_u32 s66, s60, 0x2000
  buffer_load_dwordx4 v3, s[40:43], s60 offen sc1 lds
  buffer_load_dwordx4 v3, s[40:43], s60 offen offset:1024 sc1 lds
  s_add_u32 m0, s65, 139264
  s_lshl_b32 s67, s69, 6
  buffer_load_dwordx4 v3, s[40:43], s66 offen sc1 lds
  buffer_load_dwordx4 v3, s[40:43], s66 offen offset:1024 sc1 lds
  s_add_u32 s67, s67, 0xd0c0000
  s_add_u32 s58, s68, 0x1000
  buffer_load_dwordx4 a[0:3], v2, s[40:43], s68 offen offset:0 sc1
  buffer_load_dwordx4 a[4:7], v2, s[40:43], s68 offen offset:2048 sc1
  buffer_load_dwordx4 a[8:11], v2, s[40:43], s58 offen offset:0 sc1
  buffer_load_dwordx4 a[12:15], v2, s[40:43], s58 offen offset:2048 sc1
  s_add_u32 s68, s68, 0x4000
  s_add_u32 s58, s68, 0x1000
  buffer_load_dwordx4 a[16:19], v2, s[40:43], s68 offen offset:0 sc1
  buffer_load_dwordx4 a[20:23], v2, s[40:43], s68 offen offset:2048 sc1
  buffer_load_dwordx4 a[24:27], v2, s[40:43], s58 offen offset:0 sc1
  buffer_load_dwordx4 a[28:31], v2, s[40:43], s58 offen offset:2048 sc1
  s_add_u32 s68, s68, 0x4000
  s_add_u32 s58, s68, 0x1000
  buffer_load_dwordx4 a[32:35], v2, s[40:43], s68 offen offset:0 sc1
  buffer_load_dwordx4 a[36:39], v2, s[40:43], s68 offen offset:2048 sc1
  buffer_load_dwordx4 a[40:43], v2, s[40:43], s58 offen offset:0 sc1
  buffer_load_dwordx4 a[44:47], v2, s[40:43], s58 offen offset:2048 sc1
  s_add_u32 s68, s68, 0x4000
  s_add_u32 s58, s68, 0x1000
  buffer_load_dwordx4 a[48:51], v2, s[40:43], s68 offen offset:0 sc1
  buffer_load_dwordx4 a[52:55], v2, s[40:43], s68 offen offset:2048 sc1
  buffer_load_dwordx4 a[56:59], v2, s[40:43], s58 offen offset:0 sc1
  buffer_load_dwordx4 a[60:63], v2, s[40:43], s58 offen offset:2048 sc1
  s_add_u32 s68, s68, 0x4000
  buffer_load_dword v20, v9, s[40:43], s67 offen offset:0 sc1
  buffer_load_dword v21, v9, s[40:43], s67 offen offset:256 sc1
  buffer_load_dword v22, v9, s[40:43], s67 offen offset:512 sc1
  buffer_load_dword v23, v9, s[40:43], s67 offen offset:768 sc1
  s_add_u32 m0, s64, s65
  s_nop 0
  buffer_load_dwordx4 v3, s[40:43], s61 offen sc1 lds
  s_min_u32 s66, s62, s63
  s_nop 0
  buffer_load_dwordx4 v3, s[40:43], s61 offen offset:1024 sc1 lds
  s_add_u32 m0, m0, 0x2000
  s_nop 0
  buffer_load_dwordx4 v3, s[40:43], s66 offen sc1 lds
  s_add_u32 s61, s61, 0x2000
  s_nop 0
  buffer_load_dwordx4 v3, s[40:43], s66 offen offset:1024 sc1 lds
  s_add_u32 s62, s62, 0x2000
  s_add_u32 s64, s64, 0x4000
  s_and_b32 s64, s64, 0x1ffff
  s_add_u32 m0, s64, s65
  s_nop 0
  buffer_load_dwordx4 v3, s[40:43], s61 offen sc1 lds
  s_min_u32 s66, s62, s63
  s_nop 0
  buffer_load_dwordx4 v3, s[40:43], s61 offen offset:1024 sc1 lds
  s_add_u32 m0, m0, 0x2000
  s_nop 0
  buffer_load_dwordx4 v3, s[40:43], s66 offen sc1 lds
  s_add_u32 s61, s61, 0x2000
  s_nop 0
  buffer_load_dwordx4 v3, s[40:43], s66 offen offset:1024 sc1 lds
  s_add_u32 s62, s62, 0x2000
  s_add_u32 s64, s64, 0x4000
  s_and_b32 s64, s64, 0x1ffff
  s_mul_i32 s69, s69, 786432
  s_lshl_b32 s67, s56, 14
  s_add_u32 s69, s69, s67
  s_add_u32 s76, s69, 0x6000000
  s_add_u32 s77, s69, 0x6300000
  s_add_u32 s78, s69, 0x6600000
  s_add_u32 s79, s69, 0x6900000
  v_mov_b32 v24, 0xff800000
  s_cmp_lg_u32 s57, 0
  s_cbranch_scc1 L_a_nomask0
  v_cmp_gt_i32 s[80:81], 0, v25
  v_cmp_gt_i32 s[82:83], 1, v25
  v_cmp_gt_i32 s[84:85], 2, v25
  v_cmp_gt_i32 s[86:87], 3, v25
  v_cndmask_b32 v96, v96, v24, s[80:81]
  v_cndmask_b32 v97, v97, v24, s[82:83]
  v_cndmask_b32 v98, v98, v24, s[84:85]
  v_cndmask_b32 v99, v99, v24, s[86:87]
  v_cmp_gt_i32 s[80:81], 16, v25
  v_cmp_gt_i32 s[82:83], 17, v25
  v_cmp_gt_i32 s[84:85], 18, v25
  v_cmp_gt_i32 s[86:87], 19, v25
  v_cndmask_b32 v100, v100, v24, s[80:81]
  v_cndmask_b32 v101, v101, v24, s[82:83]
  v_cndmask_b32 v102, v102, v24, s[84:85]
  v_cndmask_b32 v103, v103, v24, s[86:87]
L_a_nomask0:
  s_waitcnt vmcnt(28)
  s_barrier
  ds_read_b128 a[64:67], v4 offset:8192
  ds_read_b128 a[68:71], v4 offset:9216
  ds_read_b128 a[72:75], v4 offset:10240
  ds_read_b128 a[76:79], v4 offset:11264
  ds_read_b128 a[80:83], v4 offset:12288
  ds_read_b128 a[84:87], v4 offset:13312
  ds_read_b128 a[88:91], v4 offset:14336
  ds_read_b128 a[92:95], v4 offset:15360
  v_add_u32 v4, 0x2000, v4
  s_waitcnt vmcnt(24) lgkmcnt(0)
  v_mfma_f32_16x16x32_bf16 v[32:35], a[64:67], a[0:3], v[96:99]
  v_mfma_f32_16x16x32_bf16 v[32:35], a[72:75], a[4:7], v[32:35]
  v_mfma_f32_16x16x32_bf16 v[32:35], a[80:83], a[8:11], v[32:35]
  v_mfma_f32_16x16x32_bf16 v[32:35], a[88:91], a[12:15], v[32:35]
  v_mfma_f32_16x16x32_bf16 v[36:39], a[68:71], a[0:3], v[100:103]
  v_mfma_f32_16x16x32_bf16 v[36:39], a[76:79], a[4:7], v[36:39]
  v_mfma_f32_16x16x32_bf16 v[36:39], a[84:87], a[8:11], v[36:39]
  v_mfma_f32_16x16x32_bf16 v[36:39], a[92:95], a[12:15], v[36:39]
  s_waitcnt vmcnt(20) lgkmcnt(0)
  v_mfma_f32_16x16x32_bf16 v[40:43], a[64:67], a[16:19], v[104:107]
  v_mfma_f32_16x16x32_bf16 v[40:43], a[72:75], a[20:23], v[40:43]
  v_mfma_f32_16x16x32_bf16 v[40:43], a[80:83], a[24:27], v[40:43]
  v_mfma_f32_16x16x32_bf16 v[40:43], a[88:91], a[28:31], v[40:43]
  v_mfma_f32_16x16x32_bf16 v[44:47], a[68:71], a[16:19], v[108:111]
  v_mfma_f32_16x16x32_bf16 v[44:47], a[76:79], a[20:23], v[44:47]
  v_mfma_f32_16x16x32_bf16 v[44:47], a[84:87], a[24:27], v[44:47]
  v_mfma_f32_16x16x32_bf16 v[44:47], a[92:95], a[28:31], v[44:47]
  s_waitcnt vmcnt(16) lgkmcnt(0)
  v_mfma_f32_16x16x32_bf16 v[48:51], a[64:67], a[32:35], v[112:115]
  v_mfma_f32_16x16x32_bf16 v[48:51], a[72:75], a[36:39], v[48:51]
  v_mfma_f32_16x16x32_bf16 v[48:51], a[80:83], a[40:43], v[48:51]
  v_mfma_f32_16x16x32_bf16 v[48:51], a[88:91], a[44:47], v[48:51]
  v_mfma_f32_16x16x32_bf16 v[52:55], a[68:71], a[32:35], v[116:119]
  v_mfma_f32_16x16x32_bf16 v[52:55], a[76:79], a[36:39], v[52:55]
  v_mfma_f32_16x16x32_bf16 v[52:55], a[84:87], a[40:43], v[52:55]
  v_mfma_f32_16x16x32_bf16 v[52:55], a[92:95], a[44:47], v[52:55]
  s_waitcnt vmcnt(12) lgkmcnt(0)
  v_mfma_f32_16x16x32_bf16 v[56:59], a[64:67], a[48:51], v[120:123]
  v_mfma_f32_16x16x32_bf16 v[56:59], a[72:75], a[52:55], v[56:59]
  v_mfma_f32_16x16x32_bf16 v[56:59], a[80:83], a[56:59], v[56:59]
  v_mfma_f32_16x16x32_bf16 v[56:59], a[88:91], a[60:63], v[56:59]
  v_mfma_f32_16x16x32_bf16 v[60:63], a[68:71], a[48:51], v[124:127]
  v_mfma_f32_16x16x32_bf16 v[60:63], a[76:79], a[52:55], v[60:63]
  v_mfma_f32_16x16x32_bf16 v[60:63], a[84:87], a[56:59], v[60:63]
  v_mfma_f32_16x16x32_bf16 v[60:63], a[92:95], a[60:63], v[60:63]
  ds_read_b128 a[64:67], v4 offset:8192
  ds_read_b128 a[68:71], v4 offset:9216
  ds_read_b128 a[72:75], v4 offset:10240
  ds_read_b128 a[76:79], v4 offset:11264
  ds_read_b128 a[80:83], v4 offset:12288
  ds_read_b128 a[84:87], v4 offset:13312
  ds_read_b128 a[88:91], v4 offset:14336
  ds_read_b128 a[92:95], v4 offset:15360
  v_mov_b32 v4, v2
  s_add_u32 m0, s64, s65
  s_nop 0
  buffer_load_dwordx4 v3, s[40:43], s61 offen sc1 lds
  s_min_u32 s66, s62, s63
  s_nop 0
  buffer_load_dwordx4 v3, s[40:43], s61 offen offset:1024 sc1 lds
  s_add_u32 m0, m0, 0x2000
  s_nop 0
  buffer_load_dwordx4 v3, s[40:43], s66 offen sc1 lds
  s_add_u32 s61, s61, 0x2000
  s_nop 0
  buffer_load_dwordx4 v3, s[40:43], s66 offen offset:1024 sc1 lds
  s_add_u32 s62, s62, 0x2000
  s_add_u32 s64, s64, 0x4000
  s_and_b32 s64, s64, 0x1ffff
  v_max3_f32 v6, v32, v33, v34
  v_max3_f32 v7, v35, v36, v37
  v_max3_f32 v6, v6, v38, v39
  v_max_f32 v6, v6, v7
  v_mov_b32 v7, v6
  s_nop 1
  v_permlane32_swap_b32 v7, v6
  v_max_f32 v6, v6, v7
  v_mov_b32 v7, v6
  s_nop 1
  v_permlane16_swap_b32 v7, v6
  v_max_f32 v6, v6, v7
  v_add_f32 v6, 0x41800000, v6
  v_sub_f32 v96, v96, v6
  v_sub_f32 v97, v97, v6
  v_sub_f32 v98, v98, v6
  v_sub_f32 v99, v99, v6
  v_sub_f32 v100, v100, v6
  v_sub_f32 v101, v101, v6
  v_sub_f32 v102, v102, v6
  v_sub_f32 v103, v103, v6
  v_sub_f32 v8, v32, v6
  v_sub_f32 v9, v33, v6
  v_sub_f32 v10, v34, v6
  v_sub_f32 v11, v35, v6
  v_sub_f32 v12, v36, v6
  v_sub_f32 v13, v37, v6
  v_sub_f32 v14, v38, v6
  v_sub_f32 v15, v39, v6
  v_exp_f32 v8, v8
  v_exp_f32 v9, v9
  v_exp_f32 v10, v10
  v_exp_f32 v11, v11
  v_exp_f32 v12, v12
  v_exp_f32 v13, v13
  v_exp_f32 v14, v14
  v_exp_f32 v15, v15
  v_cvt_pk_bf16_f32 v64, v8, v9
  v_cvt_pk_bf16_f32 v65, v10, v11
  v_cvt_pk_bf16_f32 v66, v12, v13
  v_cvt_pk_bf16_f32 v67, v14, v15
  s_add_u32 m0, s64, s65
  s_nop 0
  buffer_load_dwordx4 v3, s[40:43], s61 offen sc1 lds
  s_min_u32 s66, s62, s63
  s_nop 0
  buffer_load_dwordx4 v3, s[40:43], s61 offen offset:1024 sc1 lds
  s_add_u32 m0, m0, 0x2000
  s_nop 0
  buffer_load_dwordx4 v3, s[40:43], s66 offen sc1 lds
  s_add_u32 s61, s61, 0x2000
  s_nop 0
  buffer_load_dwordx4 v3, s[40:43], s66 offen offset:1024 sc1 lds
  s_add_u32 s62, s62, 0x2000
  s_add_u32 s64, s64, 0x4000
  s_and_b32 s64, s64, 0x1ffff
  v_max3_f32 v6, v40, v41, v42
  v_max3_f32 v7, v43, v44, v45
  v_max3_f32 v6, v6, v46, v47
  v_max_f32 v6, v6, v7
  v_mov_b32 v7, v6
  s_nop 1
  v_permlane32_swap_b32 v7, v6
  v_max_f32 v6, v6, v7
  v_mov_b32 v7, v6
  s_nop 1
  v_permlane16_swap_b32 v7, v6
  v_max_f32 v6, v6, v7
  v_add_f32 v6, 0x41800000, v6
  v_sub_f32 v104, v104, v6
  v_sub_f32 v105, v105, v6
  v_sub_f32 v106, v106, v6
  v_sub_f32 v107, v107, v6
  v_sub_f32 v108, v108, v6
  v_sub_f32 v109, v109, v6
  v_sub_f32 v110, v110, v6
  v_sub_f32 v111, v111, v6
  v_sub_f32 v8, v40, v6
  v_sub_f32 v9, v41, v6
  v_sub_f32 v10, v42, v6
  v_sub_f32 v11, v43, v6
  v_sub_f32 v12, v44, v6
  v_sub_f32 v13, v45, v6
  v_sub_f32 v14, v46, v6
  v_sub_f32 v15, v47, v6
  v_exp_f32 v8, v8
  v_exp_f32 v9, v9
  v_exp_f32 v10, v10
  v_exp_f32 v11, v11
  v_exp_f32 v12, v12
  v_exp_f32 v13, v13
  v_exp_f32 v14, v14
  v_exp_f32 v15, v15
  v_cvt_pk_bf16_f32 v68, v8, v9
  v_cvt_pk_bf16_f32 v69, v10, v11
  v_cvt_pk_bf16_f32 v70, v12, v13
  v_cvt_pk_bf16_f32 v71, v14, v15
  s_add_u32 m0, s64, s65
  s_nop 0
  buffer_load_dwordx4 v3, s[40:43], s61 offen sc1 lds
  s_min_u32 s66, s62, s63
  s_nop 0
  buffer_load_dwordx4 v3, s[40:43], s61 offen offset:1024 sc1 lds
  s_add_u32 m0, m0, 0x2000
  s_nop 0
  buffer_load_dwordx4 v3, s[40:43], s66 offen sc1 lds
  s_add_u32 s61, s61, 0x2000
  s_nop 0
  buffer_load_dwordx4 v3, s[40:43], s66 offen offset:1024 sc1 lds
  s_add_u32 s62, s62, 0x2000
  s_add_u32 s64, s64, 0x4000
  s_and_b32 s64, s64, 0x1ffff
  v_max3_f32 v6, v48, v49, v50
  v_max3_f32 v7, v51, v52, v53
  v_max3_f32 v6, v6, v54, v55
  v_max_f32 v6, v6, v7
  v_mov_b32 v7, v6
  s_nop 1
  v_permlane32_swap_b32 v7, v6
  v_max_f32 v6, v6, v7
  v_mov_b32 v7, v6
  s_nop 1
  v_permlane16_swap_b32 v7, v6
  v_max_f32 v6, v6, v7
  v_add_f32 v6, 0x41800000, v6
  v_sub_f32 v112, v112, v6
  v_sub_f32 v113, v113, v6
  v_sub_f32 v114, v114, v6
  v_sub_f32 v115, v115, v6
  v_sub_f32 v116, v116, v6
  v_sub_f32 v117, v117, v6
  v_sub_f32 v118, v118, v6
  v_sub_f32 v119, v119, v6
  v_sub_f32 v8, v48, v6
  v_sub_f32 v9, v49, v6
  v_sub_f32 v10, v50, v6
  v_sub_f32 v11, v51, v6
  v_sub_f32 v12, v52, v6
  v_sub_f32 v13, v53, v6
  v_sub_f32 v14, v54, v6
  v_sub_f32 v15, v55, v6
  v_exp_f32 v8, v8
  v_exp_f32 v9, v9
  v_exp_f32 v10, v10
  v_exp_f32 v11, v11
  v_exp_f32 v12, v12
  v_exp_f32 v13, v13
  v_exp_f32 v14, v14
  v_exp_f32 v15, v15
  v_cvt_pk_bf16_f32 v72, v8, v9
  v_cvt_pk_bf16_f32 v73, v10, v11
  v_cvt_pk_bf16_f32 v74, v12, v13
  v_cvt_pk_bf16_f32 v75, v14, v15
  s_add_u32 m0, s64, s65
  s_nop 0
  buffer_load_dwordx4 v3, s[40:43], s61 offen sc1 lds
  s_min_u32 s66, s62, s63
  s_nop 0
  buffer_load_dwordx4 v3, s[40:43], s61 offen offset:1024 sc1 lds
  s_add_u32 m0, m0, 0x2000
  s_nop 0
  buffer_load_dwordx4 v3, s[40:43], s66 offen sc1 lds
  s_add_u32 s61, s61, 0x2000
  s_nop 0
  buffer_load_dwordx4 v3, s[40:43], s66 offen offset:1024 sc1 lds
  s_add_u32 s62, s62, 0x2000
  s_add_u32 s64, s64, 0x4000
  s_and_b32 s64, s64, 0x1ffff
  v_max3_f32 v6, v56, v57, v58
  v_max3_f32 v7, v59, v60, v61
  v_max3_f32 v6, v6, v62, v63
  v_max_f32 v6, v6, v7
  v_mov_b32 v7, v6
  s_nop 1
  v_permlane32_swap_b32 v7, v6
  v_max_f32 v6, v6, v7
  v_mov_b32 v7, v6
  s_nop 1
  v_permlane16_swap_b32 v7, v6
  v_max_f32 v6, v6, v7
  v_add_f32 v6, 0x41800000, v6
  v_sub_f32 v120, v120, v6
  v_sub_f32 v121, v121, v6
  v_sub_f32 v122, v122, v6
  v_sub_f32 v123, v123, v6
  v_sub_f32 v124, v124, v6
  v_sub_f32 v125, v125, v6
  v_sub_f32 v126, v126, v6
  v_sub_f32 v127, v127, v6
  v_sub_f32 v8, v56, v6
  v_sub_f32 v9, v57, v6
  v_sub_f32 v10, v58, v6
  v_sub_f32 v11, v59, v6
  v_sub_f32 v12, v60, v6
  v_sub_f32 v13, v61, v6
  v_sub_f32 v14, v62, v6
  v_sub_f32 v15, v63, v6
  v_exp_f32 v8, v8
  v_exp_f32 v9, v9
  v_exp_f32 v10, v10
  v_exp_f32 v11, v11
  v_exp_f32 v12, v12
  v_exp_f32 v13, v13
  v_exp_f32 v14, v14
  v_exp_f32 v15, v15
  v_cvt_pk_bf16_f32 v76, v8, v9
  v_cvt_pk_bf16_f32 v77, v10, v11
  v_cvt_pk_bf16_f32 v78, v12, v13
  v_cvt_pk_bf16_f32 v79, v14, v15
  s_add_u32 m0, s64, s65
  s_nop 0
  buffer_load_dwordx4 v3, s[40:43], s61 offen sc1 lds
  s_min_u32 s66, s62, s63
  s_nop 0
  buffer_load_dwordx4 v3, s[40:43], s61 offen offset:1024 sc1 lds
  s_add_u32 m0, m0, 0x2000
  s_nop 0
  buffer_load_dwordx4 v3, s[40:43], s66 offen sc1 lds
  s_add_u32 s61, s61, 0x2000
  s_nop 0
  buffer_load_dwordx4 v3, s[40:43], s66 offen offset:1024 sc1 lds
  s_add_u32 s62, s62, 0x2000
  s_add_u32 s64, s64, 0x4000
  s_and_b32 s64, s64, 0x1ffff
  s_mov_b32 s58, 0
  s_cmp_lg_u32 s57, 0
  s_cbranch_scc1 L_a_s0
  v_cmp_gt_i32 s[80:81], 32, v25
  v_cmp_gt_i32 s[82:83], 33, v25
  v_cmp_gt_i32 s[84:85], 34, v25
  v_cmp_gt_i32 s[86:87], 35, v25
  v_cndmask_b32 v96, v96, v24, s[80:81]
  v_cndmask_b32 v97, v97, v24, s[82:83]
  v_cndmask_b32 v98, v98, v24, s[84:85]
  v_cndmask_b32 v99, v99, v24, s[86:87]
  v_cmp_gt_i32 s[80:81], 48, v25
  v_cmp_gt_i32 s[82:83], 49, v25
  v_cmp_gt_i32 s[84:85], 50, v25
  v_cmp_gt_i32 s[86:87], 51, v25
  v_cndmask_b32 v100, v100, v24, s[80:81]
  v_cndmask_b32 v101, v101, v24, s[82:83]
  v_cndmask_b32 v102, v102, v24, s[84:85]
  v_cndmask_b32 v103, v103, v24, s[86:87]
  s_branch L_a_d1
L_a_s1:
  s_waitcnt vmcnt(24) lgkmcnt(0)
  v_mfma_f32_16x16x32_bf16 v[32:35], a[64:67], a[0:3], v[96:99]
  s_barrier
  ds_read_b128 a[96:99], v4 offset:0
  v_mfma_f32_16x16x32_bf16 v[32:35], a[72:75], a[4:7], v[32:35]
  s_nop 0
  ds_read_b128 a[100:103], v4 offset:1024
  v_mfma_f32_16x16x32_bf16 v[32:35], a[80:83], a[8:11], v[32:35]
  s_nop 0
  ds_read_b128 a[104:107], v4 offset:2048
  v_mfma_f32_16x16x32_bf16 v[32:35], a[88:91], a[12:15], v[32:35]
  s_nop 0
  ds_read_b128 a[108:111], v4 offset:3072
  v_mfma_f32_16x16x32_bf16 v[36:39], a[68:71], a[0:3], v[100:103]
  s_nop 0
  ds_read_b128 a[112:115], v4 offset:4096
  v_mfma_f32_16x16x32_bf16 v[36:39], a[76:79], a[4:7], v[36:39]
  s_nop 0
  ds_read_b128 a[116:119], v4 offset:5120
  v_mfma_f32_16x16x32_bf16 v[36:39], a[84:87], a[8:11], v[36:39]
  s_nop 0
  ds_read_b128 a[120:123], v4 offset:6144
  v_mfma_f32_16x16x32_bf16 v[36:39], a[92:95], a[12:15], v[36:39]
  s_nop 0
  ds_read_b128 a[124:127], v4 offset:7168
  v_mfma_f32_16x16x32_bf16 v[40:43], a[64:67], a[16:19], v[104:107]
  s_nop 0
  v_exp_f32 v8, v32
  v_mfma_f32_16x16x32_bf16 v[40:43], a[72:75], a[20:23], v[40:43]
  s_nop 0
  v_exp_f32 v9, v33
  v_mfma_f32_16x16x32_bf16 v[40:43], a[80:83], a[24:27], v[40:43]
  s_nop 0
  v_exp_f32 v10, v34
  v_mfma_f32_16x16x32_bf16 v[40:43], a[88:91], a[28:31], v[40:43]
  s_nop 0
  v_exp_f32 v11, v35
  v_mfma_f32_16x16x32_bf16 v[44:47], a[68:71], a[16:19], v[108:111]
  s_nop 0
  v_cvt_pk_bf16_f32 v64, v8, v9
  v_cvt_pk_bf16_f32 v65, v10, v11
  v_mfma_f32_16x16x32_bf16 v[44:47], a[76:79], a[20:23], v[44:47]
  s_nop 0
  v_or_b32 v5, v64, v65
  v_mfma_f32_16x16x32_bf16 v[44:47], a[84:87], a[24:27], v[44:47]
  s_nop 0
  v_exp_f32 v12, v36
  v_mfma_f32_16x16x32_bf16 v[44:47], a[92:95], a[28:31], v[44:47]
  s_nop 0
  v_exp_f32 v13, v37
  v_mfma_f32_16x16x32_bf16 v[48:51], a[64:67], a[32:35], v[112:115]
  s_nop 0
  v_exp_f32 v14, v38
  v_mfma_f32_16x16x32_bf16 v[48:51], a[72:75], a[36:39], v[48:51]
  s_nop 0
  v_exp_f32 v15, v39
  v_mfma_f32_16x16x32_bf16 v[48:51], a[80:83], a[40:43], v[48:51]
  s_nop 0
  v_cvt_pk_bf16_f32 v66, v12, v13
  v_cvt_pk_bf16_f32 v67, v14, v15
  v_mfma_f32_16x16x32_bf16 v[48:51], a[88:91], a[44:47], v[48:51]
  s_add_u32 m0, s64, s65
  s_nop 0
  buffer_load_dwordx4 v3, s[40:43], s61 offen sc1 lds
  v_or3_b32 v5, v5, v66, v67
  v_mfma_f32_16x16x32_bf16 v[52:55], a[68:71], a[32:35], v[116:119]
  s_nop 0
  v_exp_f32 v8, v40
  v_mfma_f32_16x16x32_bf16 v[52:55], a[76:79], a[36:39], v[52:55]
  s_nop 0
  v_exp_f32 v9, v41
  v_mfma_f32_16x16x32_bf16 v[52:55], a[84:87], a[40:43], v[52:55]
  s_min_u32 s66, s62, s63
  buffer_load_dwordx4 v3, s[40:43], s61 offen offset:1024 sc1 lds
  v_mfma_f32_16x16x32_bf16 v[52:55], a[92:95], a[44:47], v[52:55]
  s_nop 0
  v_exp_f32 v10, v42
  v_mfma_f32_16x16x32_bf16 v[56:59], a[64:67], a[48:51], v[120:123]
  s_nop 0
  v_exp_f32 v11, v43
  v_mfma_f32_16x16x32_bf16 v[56:59], a[72:75], a[52:55], v[56:59]
  s_add_u32 m0, m0, 0x2000
  s_nop 0
  buffer_load_dwordx4 v3, s[40:43], s66 offen sc1 lds
  v_cvt_pk_bf16_f32 v68, v8, v9
  v_mfma_f32_16x16x32_bf16 v[56:59], a[80:83], a[56:59], v[56:59]
  s_nop 0
  v_cvt_pk_bf16_f32 v69, v10, v11
  v_or3_b32 v5, v5, v68, v69
  v_mfma_f32_16x16x32_bf16 v[56:59], a[88:91], a[60:63], v[56:59]
  s_nop 0
  v_exp_f32 v12, v44
  v_mfma_f32_16x16x32_bf16 v[60:63], a[68:71], a[48:51], v[124:127]
  s_add_u32 s61, s61, 0x2000
  buffer_load_dwordx4 v3, s[40:43], s66 offen offset:1024 sc1 lds
  v_mfma_f32_16x16x32_bf16 v[60:63], a[76:79], a[52:55], v[60:63]
  s_add_u32 s62, s62, 0x2000
  v_exp_f32 v13, v45
  v_mfma_f32_16x16x32_bf16 v[60:63], a[84:87], a[56:59], v[60:63]
  s_add_u32 s64, s64, 0x4000
  v_exp_f32 v14, v46
  v_mfma_f32_16x16x32_bf16 v[60:63], a[92:95], a[60:63], v[60:63]
  s_and_b32 s64, s64, 0x1ffff
  v_exp_f32 v15, v47
  v_mfma_f32_16x16x32_bf16 a[128:131], v[16:19], v[80:83], a[128:131]
  s_add_u32 s58, s58, 1
  v_cvt_pk_bf16_f32 v70, v12, v13
  v_cvt_pk_bf16_f32 v71, v14, v15
  v_mfma_f32_16x16x32_bf16 a[132:135], v[16:19], v[84:87], a[132:135]
  s_nop 0
  ds_read_b128 a[64:67], v4 offset:8192
  v_or3_b32 v5, v5, v70, v71
  v_mfma_f32_16x16x32_bf16 a[136:139], v[16:19], v[88:91], a[136:139]
  s_nop 0
  v_exp_f32 v8, v48
  v_mfma_f32_16x16x32_bf16 a[140:143], v[16:19], v[92:95], a[140:143]
  s_nop 0
  v_exp_f32 v9, v49
  s_waitcnt lgkmcnt(1)
  v_mfma_f32_16x16x32_bf16 v[128:131], a[96:99], v[80:83], v[128:131]
  ds_read_b128 a[68:71], v4 offset:9216
  v_mfma_f32_16x16x32_bf16 v[160:163], a[96:99], v[84:87], v[160:163]
  v_exp_f32 v10, v50
  v_mfma_f32_16x16x32_bf16 v[192:195], a[96:99], v[88:91], v[192:195]
  v_exp_f32 v11, v51
  v_mfma_f32_16x16x32_bf16 v[224:227], a[96:99], v[92:95], v[224:227]
  ds_read_b128 a[72:75], v4 offset:10240
  v_cvt_pk_bf16_f32 v72, v8, v9
  v_mfma_f32_16x16x32_bf16 v[132:135], a[100:103], v[80:83], v[132:135]
  v_cvt_pk_bf16_f32 v73, v10, v11
  v_or3_b32 v5, v5, v72, v73
  v_mfma_f32_16x16x32_bf16 v[164:167], a[100:103], v[84:87], v[164:167]
  v_exp_f32 v12, v52
  v_mfma_f32_16x16x32_bf16 v[196:199], a[100:103], v[88:91], v[196:199]
  ds_read_b128 a[76:79], v4 offset:11264
  v_mfma_f32_16x16x32_bf16 v[228:231], a[100:103], v[92:95], v[228:231]
  v_exp_f32 v13, v53
  v_mfma_f32_16x16x32_bf16 v[136:139], a[104:107], v[80:83], v[136:139]
  v_exp_f32 v14, v54
  v_mfma_f32_16x16x32_bf16 v[168:171], a[104:107], v[84:87], v[168:171]
  ds_read_b128 a[80:83], v4 offset:12288
  v_mfma_f32_16x16x32_bf16 v[200:203], a[104:107], v[88:91], v[200:203]
  v_exp_f32 v15, v55
  v_mfma_f32_16x16x32_bf16 v[232:235], a[104:107], v[92:95], v[232:235]
  v_cvt_pk_bf16_f32 v74, v12, v13
  v_cvt_pk_bf16_f32 v75, v14, v15
  v_mfma_f32_16x16x32_bf16 v[140:143], a[108:111], v[80:83], v[140:143]
  ds_read_b128 a[84:87], v4 offset:13312
  v_or3_b32 v5, v5, v74, v75
  v_mfma_f32_16x16x32_bf16 v[172:175], a[108:111], v[84:87], v[172:175]
  v_exp_f32 v8, v56
  v_mfma_f32_16x16x32_bf16 v[204:207], a[108:111], v[88:91], v[204:207]
  v_exp_f32 v9, v57
  v_mfma_f32_16x16x32_bf16 v[236:239], a[108:111], v[92:95], v[236:239]
  ds_read_b128 a[88:91], v4 offset:14336
  v_mfma_f32_16x16x32_bf16 v[144:147], a[112:115], v[80:83], v[144:147]
  v_exp_f32 v10, v58
  v_mfma_f32_16x16x32_bf16 v[176:179], a[112:115], v[84:87], v[176:179]
  v_exp_f32 v11, v59
  v_mfma_f32_16x16x32_bf16 v[208:211], a[112:115], v[88:91], v[208:211]
  ds_read_b128 a[92:95], v4 offset:15360
  v_cvt_pk_bf16_f32 v76, v8, v9
  v_mfma_f32_16x16x32_bf16 v[240:243], a[112:115], v[92:95], v[240:243]
  v_cvt_pk_bf16_f32 v77, v10, v11
  v_or3_b32 v5, v5, v76, v77
  v_mfma_f32_16x16x32_bf16 v[148:151], a[116:119], v[80:83], v[148:151]
  v_exp_f32 v12, v60
  v_mfma_f32_16x16x32_bf16 v[180:183], a[116:119], v[84:87], v[180:183]
  v_exp_f32 v13, v61
  v_mfma_f32_16x16x32_bf16 v[212:215], a[116:119], v[88:91], v[212:215]
  v_exp_f32 v14, v62
  v_mfma_f32_16x16x32_bf16 v[244:247], a[116:119], v[92:95], v[244:247]
  v_exp_f32 v15, v63
  v_mfma_f32_16x16x32_bf16 v[152:155], a[120:123], v[80:83], v[152:155]
  v_cvt_pk_bf16_f32 v78, v12, v13
  v_cvt_pk_bf16_f32 v79, v14, v15
  v_mfma_f32_16x16x32_bf16 v[184:187], a[120:123], v[84:87], v[184:187]
  v_or3_b32 v5, v5, v78, v79
  v_and_b32 v5, s70, v5
  v_mfma_f32_16x16x32_bf16 v[216:219], a[120:123], v[88:91], v[216:219]
  v_cmp_ne_u32 vcc, 0, v5
  v_add_u32 v4, 0x4000, v4
  v_mfma_f32_16x16x32_bf16 v[248:251], a[120:123], v[92:95], v[248:251]
  v_and_b32 v4, 0x1ffff, v4
  v_mfma_f32_16x16x32_bf16 v[156:159], a[124:127], v[80:83], v[156:159]
  v_mfma_f32_16x16x32_bf16 v[188:191], a[124:127], v[84:87], v[188:191]
  v_mfma_f32_16x16x32_bf16 v[220:223], a[124:127], v[88:91], v[220:223]
  v_mfma_f32_16x16x32_bf16 v[252:255], a[124:127], v[92:95], v[252:255]
  s_cbranch_vccnz L_a_s1_t
L_a_s1_r:
L_a_s0:
  s_waitcnt vmcnt(24) lgkmcnt(0)
  v_mfma_f32_16x16x32_bf16 v[32:35], a[64:67], a[0:3], v[96:99]
  s_barrier
  ds_read_b128 a[96:99], v4 offset:0
  v_mfma_f32_16x16x32_bf16 v[32:35], a[72:75], a[4:7], v[32:35]
  s_nop 0
  ds_read_b128 a[100:103], v4 offset:1024
  v_mfma_f32_16x16x32_bf16 v[32:35], a[80:83], a[8:11], v[32:35]
  s_nop 0
  ds_read_b128 a[104:107], v4 offset:2048
  v_mfma_f32_16x16x32_bf16 v[32:35], a[88:91], a[12:15], v[32:35]
  s_nop 0
  ds_read_b128 a[108:111], v4 offset:3072
  v_mfma_f32_16x16x32_bf16 v[36:39], a[68:71], a[0:3], v[100:103]
  s_nop 0
  ds_read_b128 a[112:115], v4 offset:4096
  v_mfma_f32_16x16x32_bf16 v[36:39], a[76:79], a[4:7], v[36:39]
  s_nop 0
  ds_read_b128 a[116:119], v4 offset:5120
  v_mfma_f32_16x16x32_bf16 v[36:39], a[84:87], a[8:11], v[36:39]
  s_nop 0
  ds_read_b128 a[120:123], v4 offset:6144
  v_mfma_f32_16x16x32_bf16 v[36:39], a[92:95], a[12:15], v[36:39]
  s_nop 0
  ds_read_b128 a[124:127], v4 offset:7168
  v_mfma_f32_16x16x32_bf16 v[40:43], a[64:67], a[16:19], v[104:107]
  s_nop 0
  v_exp_f32 v8, v32
  v_mfma_f32_16x16x32_bf16 v[40:43], a[72:75], a[20:23], v[40:43]
  s_nop 0
  v_exp_f32 v9, v33
  v_mfma_f32_16x16x32_bf16 v[40:43], a[80:83], a[24:27], v[40:43]
  s_nop 0
  v_exp_f32 v10, v34
  v_mfma_f32_16x16x32_bf16 v[40:43], a[88:91], a[28:31], v[40:43]
  s_nop 0
  v_exp_f32 v11, v35
  v_mfma_f32_16x16x32_bf16 v[44:47], a[68:71], a[16:19], v[108:111]
  s_nop 0
  v_cvt_pk_bf16_f32 v80, v8, v9
  v_cvt_pk_bf16_f32 v81, v10, v11
  v_mfma_f32_16x16x32_bf16 v[44:47], a[76:79], a[20:23], v[44:47]
  s_nop 0
  v_or_b32 v5, v80, v81
  v_mfma_f32_16x16x32_bf16 v[44:47], a[84:87], a[24:27], v[44:47]
  s_nop 0
  v_exp_f32 v12, v36
  v_mfma_f32_16x16x32_bf16 v[44:47], a[92:95], a[28:31], v[44:47]
  s_nop 0
  v_exp_f32 v13, v37
  v_mfma_f32_16x16x32_bf16 v[48:51], a[64:67], a[32:35], v[112:115]
  s_nop 0
  v_exp_f32 v14, v38
  v_mfma_f32_16x16x32_bf16 v[48:51], a[72:75], a[36:39], v[48:51]
  s_nop 0
  v_exp_f32 v15, v39
  v_mfma_f32_16x16x32_bf16 v[48:51], a[80:83], a[40:43], v[48:51]
  s_nop 0
  v_cvt_pk_bf16_f32 v82, v12, v13
  v_cvt_pk_bf16_f32 v83, v14, v15
  v_mfma_f32_16x16x32_bf16 v[48:51], a[88:91], a[44:47], v[48:51]
  s_add_u32 m0, s64, s65
  s_nop 0
  buffer_load_dwordx4 v3, s[40:43], s61 offen sc1 lds
  v_or3_b32 v5, v5, v82, v83
  v_mfma_f32_16x16x32_bf16 v[52:55], a[68:71], a[32:35], v[116:119]
  s_nop 0
  v_exp_f32 v8, v40
  v_mfma_f32_16x16x32_bf16 v[52:55], a[76:79], a[36:39], v[52:55]
  s_nop 0
  v_exp_f32 v9, v41
  v_mfma_f32_16x16x32_bf16 v[52:55], a[84:87], a[40:43], v[52:55]
  s_min_u32 s66, s62, s63
  buffer_load_dwordx4 v3, s[40:43], s61 offen offset:1024 sc1 lds
  v_mfma_f32_16x16x32_bf16 v[52:55], a[92:95], a[44:47], v[52:55]
  s_nop 0
  v_exp_f32 v10, v42
  v_mfma_f32_16x16x32_bf16 v[56:59], a[64:67], a[48:51], v[120:123]
  s_nop 0
  v_exp_f32 v11, v43
  v_mfma_f32_16x16x32_bf16 v[56:59], a[72:75], a[52:55], v[56:59]
  s_add_u32 m0, m0, 0x2000
  s_nop 0
  buffer_load_dwordx4 v3, s[40:43], s66 offen sc1 lds
  v_cvt_pk_bf16_f32 v84, v8, v9
  v_mfma_f32_16x16x32_bf16 v[56:59], a[80:83], a[56:59], v[56:59]
  s_nop 0
  v_cvt_pk_bf16_f32 v85, v10, v11
  v_or3_b32 v5, v5, v84, v85
  v_mfma_f32_16x16x32_bf16 v[56:59], a[88:91], a[60:63], v[56:59]
  s_nop 0
  v_exp_f32 v12, v44
  v_mfma_f32_16x16x32_bf16 v[60:63], a[68:71], a[48:51], v[124:127]
  s_add_u32 s61, s61, 0x2000
  buffer_load_dwordx4 v3, s[40:43], s66 offen offset:1024 sc1 lds
  v_mfma_f32_16x16x32_bf16 v[60:63], a[76:79], a[52:55], v[60:63]
  s_add_u32 s62, s62, 0x2000
  v_exp_f32 v13, v45
  v_mfma_f32_16x16x32_bf16 v[60:63], a[84:87], a[56:59], v[60:63]
  s_add_u32 s64, s64, 0x4000
  v_exp_f32 v14, v46
  v_mfma_f32_16x16x32_bf16 v[60:63], a[92:95], a[60:63], v[60:63]
  s_and_b32 s64, s64, 0x1ffff
  v_exp_f32 v15, v47
  v_mfma_f32_16x16x32_bf16 a[128:131], v[16:19], v[64:67], a[128:131]
  s_add_u32 s58, s58, 1
  v_cvt_pk_bf16_f32 v86, v12, v13
  v_cvt_pk_bf16_f32 v87, v14, v15
  v_mfma_f32_16x16x32_bf16 a[132:135], v[16:19], v[68:71], a[132:135]
  s_nop 0
  ds_read_b128 a[64:67], v4 offset:8192
  v_or3_b32 v5, v5, v86, v87
  v_mfma_f32_16x16x32_bf16 a[136:139], v[16:19], v[72:75], a[136:139]
  s_nop 0
  v_exp_f32 v8, v48
  v_mfma_f32_16x16x32_bf16 a[140:143], v[16:19], v[76:79], a[140:143]
  s_nop 0
  v_exp_f32 v9, v49
  s_waitcnt lgkmcnt(1)
  v_mfma_f32_16x16x32_bf16 v[128:131], a[96:99], v[64:67], v[128:131]
  ds_read_b128 a[68:71], v4 offset:9216
  v_mfma_f32_16x16x32_bf16 v[160:163], a[96:99], v[68:71], v[160:163]
  v_exp_f32 v10, v50
  v_mfma_f32_16x16x32_bf16 v[192:195], a[96:99], v[72:75], v[192:195]
  v_exp_f32 v11, v51
  v_mfma_f32_16x16x32_bf16 v[224:227], a[96:99], v[76:79], v[224:227]
  ds_read_b128 a[72:75], v4 offset:10240
  v_cvt_pk_bf16_f32 v88, v8, v9
  v_mfma_f32_16x16x32_bf16 v[132:135], a[100:103], v[64:67], v[132:135]
  v_cvt_pk_bf16_f32 v89, v10, v11
  v_or3_b32 v5, v5, v88, v89
  v_mfma_f32_16x16x32_bf16 v[164:167], a[100:103], v[68:71], v[164:167]
  v_exp_f32 v12, v52
  v_mfma_f32_16x16x32_bf16 v[196:199], a[100:103], v[72:75], v[196:199]
  ds_read_b128 a[76:79], v4 offset:11264
  v_mfma_f32_16x16x32_bf16 v[228:231], a[100:103], v[76:79], v[228:231]
  v_exp_f32 v13, v53
  v_mfma_f32_16x16x32_bf16 v[136:139], a[104:107], v[64:67], v[136:139]
  v_exp_f32 v14, v54
  v_mfma_f32_16x16x32_bf16 v[168:171], a[104:107], v[68:71], v[168:171]
  ds_read_b128 a[80:83], v4 offset:12288
  v_mfma_f32_16x16x32_bf16 v[200:203], a[104:107], v[72:75], v[200:203]
  v_exp_f32 v15, v55
  v_mfma_f32_16x16x32_bf16 v[232:235], a[104:107], v[76:79], v[232:235]
  v_cvt_pk_bf16_f32 v90, v12, v13
  v_cvt_pk_bf16_f32 v91, v14, v15
  v_mfma_f32_16x16x32_bf16 v[140:143], a[108:111], v[64:67], v[140:143]
  ds_read_b128 a[84:87], v4 offset:13312
  v_or3_b32 v5, v5, v90, v91
  v_mfma_f32_16x16x32_bf16 v[172:175], a[108:111], v[68:71], v[172:175]
  v_exp_f32 v8, v56
  v_mfma_f32_16x16x32_bf16 v[204:207], a[108:111], v[72:75], v[204:207]
  v_exp_f32 v9, v57
  v_mfma_f32_16x16x32_bf16 v[236:239], a[108:111], v[76:79], v[236:239]
  ds_read_b128 a[88:91], v4 offset:14336
  v_mfma_f32_16x16x32_bf16 v[144:147], a[112:115], v[64:67], v[144:147]
  v_exp_f32 v10, v58
  v_mfma_f32_16x16x32_bf16 v[176:179], a[112:115], v[68:71], v[176:179]
  v_exp_f32 v11, v59
  v_mfma_f32_16x16x32_bf16 v[208:211], a[112:115], v[72:75], v[208:211]
  ds_read_b128 a[92:95], v4 offset:15360
  v_cvt_pk_bf16_f32 v92, v8, v9
  v_mfma_f32_16x16x32_bf16 v[240:243], a[112:115], v[76:79], v[240:243]
  v_cvt_pk_bf16_f32 v93, v10, v11
  v_or3_b32 v5, v5, v92, v93
  v_mfma_f32_16x16x32_bf16 v[148:151], a[116:119], v[64:67], v[148:151]
  v_exp_f32 v12, v60
  v_mfma_f32_16x16x32_bf16 v[180:183], a[116:119], v[68:71], v[180:183]
  v_exp_f32 v13, v61
  v_mfma_f32_16x16x32_bf16 v[212:215], a[116:119], v[72:75], v[212:215]
  v_exp_f32 v14, v62
  v_mfma_f32_16x16x32_bf16 v[244:247], a[116:119], v[76:79], v[244:247]
  v_exp_f32 v15, v63
  v_mfma_f32_16x16x32_bf16 v[152:155], a[120:123], v[64:67], v[152:155]
  v_cvt_pk_bf16_f32 v94, v12, v13
  v_cvt_pk_bf16_f32 v95, v14, v15
  v_mfma_f32_16x16x32_bf16 v[184:187], a[120:123], v[68:71], v[184:187]
  v_or3_b32 v5, v5, v94, v95
  v_and_b32 v5, s70, v5
  v_mfma_f32_16x16x32_bf16 v[216:219], a[120:123], v[72:75], v[216:219]
  v_cmp_ne_u32 vcc, 0, v5
  v_add_u32 v4, 0x4000, v4
  v_mfma_f32_16x16x32_bf16 v[248:251], a[120:123], v[76:79], v[248:251]
  v_and_b32 v4, 0x1ffff, v4
  v_mfma_f32_16x16x32_bf16 v[156:159], a[124:127], v[64:67], v[156:159]
  v_mfma_f32_16x16x32_bf16 v[188:191], a[124:127], v[68:71], v[188:191]
  v_mfma_f32_16x16x32_bf16 v[220:223], a[124:127], v[72:75], v[220:223]
  v_mfma_f32_16x16x32_bf16 v[252:255], a[124:127], v[76:79], v[252:255]
  s_cbranch_vccnz L_a_s0_t
L_a_s0_r:
  s_cmp_eq_u32 s58, s59
  s_cbranch_scc0 L_a_s1
  v_cmp_gt_i32 s[80:81], 0, v25
  v_cmp_gt_i32 s[82:83], 1, v25
  v_cmp_gt_i32 s[84:85], 2, v25
  v_cmp_gt_i32 s[86:87], 3, v25
  v_cndmask_b32 v96, v96, v24, s[80:81]
  v_cndmask_b32 v97, v97, v24, s[82:83]
  v_cndmask_b32 v98, v98, v24, s[84:85]
  v_cndmask_b32 v99, v99, v24, s[86:87]
  v_cmp_gt_i32 s[80:81], 16, v25
  v_cmp_gt_i32 s[82:83], 17, v25
  v_cmp_gt_i32 s[84:85], 18, v25
  v_cmp_gt_i32 s[86:87], 19, v25
  v_cndmask_b32 v100, v100, v24, s[80:81]
  v_cndmask_b32 v101, v101, v24, s[82:83]
  v_cndmask_b32 v102, v102, v24, s[84:85]
  v_cndmask_b32 v103, v103, v24, s[86:87]
  s_nop 0
L_a_d0:
  s_waitcnt vmcnt(24) lgkmcnt(0)
  v_mfma_f32_16x16x32_bf16 v[32:35], a[64:67], a[0:3], v[96:99]
  s_barrier
  ds_read_b128 a[96:99], v4 offset:0
  v_mfma_f32_16x16x32_bf16 v[32:35], a[72:75], a[4:7], v[32:35]
  s_nop 0
  ds_read_b128 a[100:103], v4 offset:1024
  v_mfma_f32_16x16x32_bf16 v[32:35], a[80:83], a[8:11], v[32:35]
  s_nop 0
  ds_read_b128 a[104:107], v4 offset:2048
  v_mfma_f32_16x16x32_bf16 v[32:35], a[88:91], a[12:15], v[32:35]
  s_nop 0
  ds_read_b128 a[108:111], v4 offset:3072
  v_mfma_f32_16x16x32_bf16 v[36:39], a[68:71], a[0:3], v[100:103]
  s_nop 0
  ds_read_b128 a[112:115], v4 offset:4096
  v_mfma_f32_16x16x32_bf16 v[36:39], a[76:79], a[4:7], v[36:39]
  s_nop 0
  ds_read_b128 a[116:119], v4 offset:5120
  v_mfma_f32_16x16x32_bf16 v[36:39], a[84:87], a[8:11], v[36:39]
  s_nop 0
  ds_read_b128 a[120:123], v4 offset:6144
  v_mfma_f32_16x16x32_bf16 v[36:39], a[92:95], a[12:15], v[36:39]
  s_nop 0
  ds_read_b128 a[124:127], v4 offset:7168
  v_mfma_f32_16x16x32_bf16 v[40:43], a[64:67], a[16:19], v[104:107]
  s_nop 0
  v_exp_f32 v8, v32
  v_mfma_f32_16x16x32_bf16 v[40:43], a[72:75], a[20:23], v[40:43]
  s_nop 0
  v_exp_f32 v9, v33
  v_mfma_f32_16x16x32_bf16 v[40:43], a[80:83], a[24:27], v[40:43]
  s_nop 0
  v_exp_f32 v10, v34
  v_mfma_f32_16x16x32_bf16 v[40:43], a[88:91], a[28:31], v[40:43]
  s_nop 0
  v_exp_f32 v11, v35
  v_mfma_f32_16x16x32_bf16 v[44:47], a[68:71], a[16:19], v[108:111]
  s_nop 0
  v_cvt_pk_bf16_f32 v64, v8, v9
  v_cvt_pk_bf16_f32 v65, v10, v11
  v_mfma_f32_16x16x32_bf16 v[44:47], a[76:79], a[20:23], v[44:47]
  s_nop 0
  v_or_b32 v5, v64, v65
  v_mfma_f32_16x16x32_bf16 v[44:47], a[84:87], a[24:27], v[44:47]
  s_nop 0
  v_exp_f32 v12, v36
  v_mfma_f32_16x16x32_bf16 v[44:47], a[92:95], a[28:31], v[44:47]
  s_nop 0
  v_exp_f32 v13, v37
  v_mfma_f32_16x16x32_bf16 v[48:51], a[64:67], a[32:35], v[112:115]
  s_nop 0
  v_exp_f32 v14, v38
  v_mfma_f32_16x16x32_bf16 v[48:51], a[72:75], a[36:39], v[48:51]
  s_nop 0
  v_exp_f32 v15, v39
  v_mfma_f32_16x16x32_bf16 v[48:51], a[80:83], a[40:43], v[48:51]
  s_nop 0
  v_cvt_pk_bf16_f32 v66, v12, v13
  v_cvt_pk_bf16_f32 v67, v14, v15
  v_mfma_f32_16x16x32_bf16 v[48:51], a[88:91], a[44:47], v[48:51]
  s_add_u32 m0, s64, s65
  s_nop 0
  buffer_load_dwordx4 v3, s[40:43], s61 offen sc1 lds
  v_or3_b32 v5, v5, v66, v67
  v_mfma_f32_16x16x32_bf16 v[52:55], a[68:71], a[32:35], v[116:119]
  s_nop 0
  v_exp_f32 v8, v40
  v_mfma_f32_16x16x32_bf16 v[52:55], a[76:79], a[36:39], v[52:55]
  s_nop 0
  v_exp_f32 v9, v41
  v_mfma_f32_16x16x32_bf16 v[52:55], a[84:87], a[40:43], v[52:55]
  s_min_u32 s66, s62, s63
  buffer_load_dwordx4 v3, s[40:43], s61 offen offset:1024 sc1 lds
  v_mfma_f32_16x16x32_bf16 v[52:55], a[92:95], a[44:47], v[52:55]
  s_nop 0
  v_exp_f32 v10, v42
  v_mfma_f32_16x16x32_bf16 v[56:59], a[64:67], a[48:51], v[120:123]
  s_nop 0
  v_exp_f32 v11, v43
  v_mfma_f32_16x16x32_bf16 v[56:59], a[72:75], a[52:55], v[56:59]
  s_add_u32 m0, m0, 0x2000
  s_nop 0
  buffer_load_dwordx4 v3, s[40:43], s66 offen sc1 lds
  v_cvt_pk_bf16_f32 v68, v8, v9
  v_mfma_f32_16x16x32_bf16 v[56:59], a[80:83], a[56:59], v[56:59]
  s_nop 0
  v_cvt_pk_bf16_f32 v69, v10, v11
  v_or3_b32 v5, v5, v68, v69
  v_mfma_f32_16x16x32_bf16 v[56:59], a[88:91], a[60:63], v[56:59]
  s_nop 0
  v_exp_f32 v12, v44
  v_mfma_f32_16x16x32_bf16 v[60:63], a[68:71], a[48:51], v[124:127]
  s_add_u32 s61, s61, 0x2000
  buffer_load_dwordx4 v3, s[40:43], s66 offen offset:1024 sc1 lds
  v_mfma_f32_16x16x32_bf16 v[60:63], a[76:79], a[52:55], v[60:63]
  s_add_u32 s62, s62, 0x2000
  v_exp_f32 v13, v45
  v_mfma_f32_16x16x32_bf16 v[60:63], a[84:87], a[56:59], v[60:63]
  s_add_u32 s64, s64, 0x4000
  v_exp_f32 v14, v46
  v_mfma_f32_16x16x32_bf16 v[60:63], a[92:95], a[60:63], v[60:63]
  s_and_b32 s64, s64, 0x1ffff
  v_exp_f32 v15, v47
  v_mfma_f32_16x16x32_bf16 a[128:131], v[16:19], v[80:83], a[128:131]
  s_add_u32 s58, s58, 1
  v_cvt_pk_bf16_f32 v70, v12, v13
  v_cvt_pk_bf16_f32 v71, v14, v15
  v_mfma_f32_16x16x32_bf16 a[132:135], v[16:19], v[84:87], a[132:135]
  s_nop 0
  ds_read_b128 a[64:67], v4 offset:8192
  v_or3_b32 v5, v5, v70, v71
  v_mfma_f32_16x16x32_bf16 a[136:139], v[16:19], v[88:91], a[136:139]
  s_nop 0
  v_exp_f32 v8, v48
  v_mfma_f32_16x16x32_bf16 a[140:143], v[16:19], v[92:95], a[140:143]
  s_nop 0
  v_exp_f32 v9, v49
  s_waitcnt lgkmcnt(1)
  v_mfma_f32_16x16x32_bf16 v[128:131], a[96:99], v[80:83], v[128:131]
  ds_read_b128 a[68:71], v4 offset:9216
  v_mfma_f32_16x16x32_bf16 v[160:163], a[96:99], v[84:87], v[160:163]
  v_exp_f32 v10, v50
  v_mfma_f32_16x16x32_bf16 v[192:195], a[96:99], v[88:91], v[192:195]
  v_exp_f32 v11, v51
  v_mfma_f32_16x16x32_bf16 v[224:227], a[96:99], v[92:95], v[224:227]
  ds_read_b128 a[72:75], v4 offset:10240
  v_cvt_pk_bf16_f32 v72, v8, v9
  v_mfma_f32_16x16x32_bf16 v[132:135], a[100:103], v[80:83], v[132:135]
  v_cvt_pk_bf16_f32 v73, v10, v11
  v_or3_b32 v5, v5, v72, v73
  v_mfma_f32_16x16x32_bf16 v[164:167], a[100:103], v[84:87], v[164:167]
  v_exp_f32 v12, v52
  v_mfma_f32_16x16x32_bf16 v[196:199], a[100:103], v[88:91], v[196:199]
  ds_read_b128 a[76:79], v4 offset:11264
  v_mfma_f32_16x16x32_bf16 v[228:231], a[100:103], v[92:95], v[228:231]
  v_exp_f32 v13, v53
  v_mfma_f32_16x16x32_bf16 v[136:139], a[104:107], v[80:83], v[136:139]
  v_exp_f32 v14, v54
  v_mfma_f32_16x16x32_bf16 v[168:171], a[104:107], v[84:87], v[168:171]
  ds_read_b128 a[80:83], v4 offset:12288
  v_mfma_f32_16x16x32_bf16 v[200:203], a[104:107], v[88:91], v[200:203]
  v_exp_f32 v15, v55
  v_mfma_f32_16x16x32_bf16 v[232:235], a[104:107], v[92:95], v[232:235]
  v_cvt_pk_bf16_f32 v74, v12, v13
  v_cvt_pk_bf16_f32 v75, v14, v15
  v_mfma_f32_16x16x32_bf16 v[140:143], a[108:111], v[80:83], v[140:143]
  ds_read_b128 a[84:87], v4 offset:13312
  v_or3_b32 v5, v5, v74, v75
  v_mfma_f32_16x16x32_bf16 v[172:175], a[108:111], v[84:87], v[172:175]
  v_exp_f32 v8, v56
  v_mfma_f32_16x16x32_bf16 v[204:207], a[108:111], v[88:91], v[204:207]
  v_exp_f32 v9, v57
  v_mfma_f32_16x16x32_bf16 v[236:239], a[108:111], v[92:95], v[236:239]
  ds_read_b128 a[88:91], v4 offset:14336
  v_mfma_f32_16x16x32_bf16 v[144:147], a[112:115], v[80:83], v[144:147]
  v_exp_f32 v10, v58
  v_mfma_f32_16x16x32_bf16 v[176:179], a[112:115], v[84:87], v[176:179]
  v_exp_f32 v11, v59
  v_mfma_f32_16x16x32_bf16 v[208:211], a[112:115], v[88:91], v[208:211]
  ds_read_b128 a[92:95], v4 offset:15360
  v_cvt_pk_bf16_f32 v76, v8, v9
  v_mfma_f32_16x16x32_bf16 v[240:243], a[112:115], v[92:95], v[240:243]
  v_cvt_pk_bf16_f32 v77, v10, v11
  v_or3_b32 v5, v5, v76, v77
  v_mfma_f32_16x16x32_bf16 v[148:151], a[116:119], v[80:83], v[148:151]
  v_exp_f32 v12, v60
  v_mfma_f32_16x16x32_bf16 v[180:183], a[116:119], v[84:87], v[180:183]
  v_exp_f32 v13, v61
  v_mfma_f32_16x16x32_bf16 v[212:215], a[116:119], v[88:91], v[212:215]
  v_exp_f32 v14, v62
  v_mfma_f32_16x16x32_bf16 v[244:247], a[116:119], v[92:95], v[244:247]
  v_exp_f32 v15, v63
  v_mfma_f32_16x16x32_bf16 v[152:155], a[120:123], v[80:83], v[152:155]
  v_cvt_pk_bf16_f32 v78, v12, v13
  v_cvt_pk_bf16_f32 v79, v14, v15
  v_mfma_f32_16x16x32_bf16 v[184:187], a[120:123], v[84:87], v[184:187]
  v_or3_b32 v5, v5, v78, v79
  v_and_b32 v5, s70, v5
  v_mfma_f32_16x16x32_bf16 v[216:219], a[120:123], v[88:91], v[216:219]
  v_cmp_ne_u32 vcc, 0, v5
  v_cmp_gt_i32 s[80:81], 32, v25
  v_mfma_f32_16x16x32_bf16 v[248:251], a[120:123], v[92:95], v[248:251]
  v_cmp_gt_i32 s[82:83], 33, v25
  v_cmp_gt_i32 s[84:85], 34, v25
  v_mfma_f32_16x16x32_bf16 v[156:159], a[124:127], v[80:83], v[156:159]
  v_cmp_gt_i32 s[86:87], 35, v25
  v_cndmask_b32 v96, v96, v24, s[80:81]
  v_mfma_f32_16x16x32_bf16 v[188:191], a[124:127], v[84:87], v[188:191]
  v_cndmask_b32 v97, v97, v24, s[82:83]
  v_cndmask_b32 v98, v98, v24, s[84:85]
  v_mfma_f32_16x16x32_bf16 v[220:223], a[124:127], v[88:91], v[220:223]
  v_cndmask_b32 v99, v99, v24, s[86:87]
  v_cmp_gt_i32 s[80:81], 48, v25
  v_mfma_f32_16x16x32_bf16 v[252:255], a[124:127], v[92:95], v[252:255]
  v_cmp_gt_i32 s[82:83], 49, v25
  v_cmp_gt_i32 s[84:85], 50, v25
  v_cmp_gt_i32 s[86:87], 51, v25
  v_cndmask_b32 v100, v100, v24, s[80:81]
  v_cndmask_b32 v101, v101, v24, s[82:83]
  v_cndmask_b32 v102, v102, v24, s[84:85]
  v_cndmask_b32 v103, v103, v24, s[86:87]
  v_add_u32 v4, 0x4000, v4
  v_and_b32 v4, 0x1ffff, v4
  s_cbranch_vccnz L_a_d0_t
L_a_d0_r:
L_a_d1:
  s_waitcnt vmcnt(24) lgkmcnt(0)
  v_mfma_f32_16x16x32_bf16 v[32:35], a[64:67], a[0:3], v[96:99]
  s_barrier
  ds_read_b128 a[96:99], v4 offset:0
  v_mfma_f32_16x16x32_bf16 v[32:35], a[72:75], a[4:7], v[32:35]
  s_nop 0
  ds_read_b128 a[100:103], v4 offset:1024
  v_mfma_f32_16x16x32_bf16 v[32:35], a[80:83], a[8:11], v[32:35]
  s_nop 0
  ds_read_b128 a[104:107], v4 offset:2048
  v_mfma_f32_16x16x32_bf16 v[32:35], a[88:91], a[12:15], v[32:35]
  s_nop 0
  ds_read_b128 a[108:111], v4 offset:3072
  v_mfma_f32_16x16x32_bf16 v[36:39], a[68:71], a[0:3], v[100:103]
  s_nop 0
  ds_read_b128 a[112:115], v4 offset:4096
  v_mfma_f32_16x16x32_bf16 v[36:39], a[76:79], a[4:7], v[36:39]
  s_nop 0
  ds_read_b128 a[116:119], v4 offset:5120
  v_mfma_f32_16x16x32_bf16 v[36:39], a[84:87], a[8:11], v[36:39]
  s_nop 0
  ds_read_b128 a[120:123], v4 offset:6144
  v_mfma_f32_16x16x32_bf16 v[36:39], a[92:95], a[12:15], v[36:39]
  s_nop 0
  ds_read_b128 a[124:127], v4 offset:7168
  v_mfma_f32_16x16x32_bf16 v[40:43], a[64:67], a[16:19], v[104:107]
  s_nop 0
  v_exp_f32 v8, v32
  v_mfma_f32_16x16x32_bf16 v[40:43], a[72:75], a[20:23], v[40:43]
  s_nop 0
  v_exp_f32 v9, v33
  v_mfma_f32_16x16x32_bf16 v[40:43], a[80:83], a[24:27], v[40:43]
  s_nop 0
  v_exp_f32 v10, v34
  v_mfma_f32_16x16x32_bf16 v[40:43], a[88:91], a[28:31], v[40:43]
  s_nop 0
  v_exp_f32 v11, v35
  v_mfma_f32_16x16x32_bf16 v[44:47], a[68:71], a[16:19], v[108:111]
  s_nop 0
  v_cvt_pk_bf16_f32 v80, v8, v9
  v_cvt_pk_bf16_f32 v81, v10, v11
  v_mfma_f32_16x16x32_bf16 v[44:47], a[76:79], a[20:23], v[44:47]
  s_nop 0
  v_or_b32 v5, v80, v81
  v_mfma_f32_16x16x32_bf16 v[44:47], a[84:87], a[24:27], v[44:47]
  s_nop 0
  v_exp_f32 v12, v36
  v_mfma_f32_16x16x32_bf16 v[44:47], a[92:95], a[28:31], v[44:47]
  s_nop 0
  v_exp_f32 v13, v37
  v_mfma_f32_16x16x32_bf16 v[48:51], a[64:67], a[32:35], v[112:115]
  s_nop 0
  v_exp_f32 v14, v38
  v_mfma_f32_16x16x32_bf16 v[48:51], a[72:75], a[36:39], v[48:51]
  s_nop 0
  v_exp_f32 v15, v39
  v_mfma_f32_16x16x32_bf16 v[48:51], a[80:83], a[40:43], v[48:51]
  s_nop 0
  v_cvt_pk_bf16_f32 v82, v12, v13
  v_cvt_pk_bf16_f32 v83, v14, v15
  v_mfma_f32_16x16x32_bf16 v[48:51], a[88:91], a[44:47], v[48:51]
  s_add_u32 m0, s64, s65
  s_nop 0
  buffer_load_dwordx4 v3, s[40:43], s61 offen sc1 lds
  v_or3_b32 v5, v5, v82, v83
  v_mfma_f32_16x16x32_bf16 v[52:55], a[68:71], a[32:35], v[116:119]
  s_nop 0
  v_exp_f32 v8, v40
  v_mfma_f32_16x16x32_bf16 v[52:55], a[76:79], a[36:39], v[52:55]
  s_nop 0
  v_exp_f32 v9, v41
  v_mfma_f32_16x16x32_bf16 v[52:55], a[84:87], a[40:43], v[52:55]
  s_min_u32 s66, s62, s63
  buffer_load_dwordx4 v3, s[40:43], s61 offen offset:1024 sc1 lds
  v_mfma_f32_16x16x32_bf16 v[52:55], a[92:95], a[44:47], v[52:55]
  s_nop 0
  v_exp_f32 v10, v42
  v_mfma_f32_16x16x32_bf16 v[56:59], a[64:67], a[48:51], v[120:123]
  s_nop 0
  v_exp_f32 v11, v43
  v_mfma_f32_16x16x32_bf16 v[56:59], a[72:75], a[52:55], v[56:59]
  s_add_u32 m0, m0, 0x2000
  s_nop 0
  buffer_load_dwordx4 v3, s[40:43], s66 offen sc1 lds
  v_cvt_pk_bf16_f32 v84, v8, v9
  v_mfma_f32_16x16x32_bf16 v[56:59], a[80:83], a[56:59], v[56:59]
  s_nop 0
  v_cvt_pk_bf16_f32 v85, v10, v11
  v_or3_b32 v5, v5, v84, v85
  v_mfma_f32_16x16x32_bf16 v[56:59], a[88:91], a[60:63], v[56:59]
  s_nop 0
  v_exp_f32 v12, v44
  v_mfma_f32_16x16x32_bf16 v[60:63], a[68:71], a[48:51], v[124:127]
  s_add_u32 s61, s61, 0x2000
  buffer_load_dwordx4 v3, s[40:43], s66 offen offset:1024 sc1 lds
  v_mfma_f32_16x16x32_bf16 v[60:63], a[76:79], a[52:55], v[60:63]
  s_add_u32 s62, s62, 0x2000
  v_exp_f32 v13, v45
  v_mfma_f32_16x16x32_bf16 v[60:63], a[84:87], a[56:59], v[60:63]
  s_add_u32 s64, s64, 0x4000
  v_exp_f32 v14, v46
  v_mfma_f32_16x16x32_bf16 v[60:63], a[92:95], a[60:63], v[60:63]
  s_and_b32 s64, s64, 0x1ffff
  v_exp_f32 v15, v47
  v_mfma_f32_16x16x32_bf16 a[128:131], v[16:19], v[64:67], a[128:131]
  s_add_u32 s58, s58, 1
  v_cvt_pk_bf16_f32 v86, v12, v13
  v_cvt_pk_bf16_f32 v87, v14, v15
  v_mfma_f32_16x16x32_bf16 a[132:135], v[16:19], v[68:71], a[132:135]
  s_nop 0
  ds_read_b128 a[64:67], v4 offset:8192
  v_or3_b32 v5, v5, v86, v87
  v_mfma_f32_16x16x32_bf16 a[136:139], v[16:19], v[72:75], a[136:139]
  s_nop 0
  v_exp_f32 v8, v48
  v_mfma_f32_16x16x32_bf16 a[140:143], v[16:19], v[76:79], a[140:143]
  s_nop 0
  v_exp_f32 v9, v49
  s_waitcnt lgkmcnt(1)
  v_mfma_f32_16x16x32_bf16 v[128:131], a[96:99], v[64:67], v[128:131]
  ds_read_b128 a[68:71], v4 offset:9216
  v_mfma_f32_16x16x32_bf16 v[160:163], a[96:99], v[68:71], v[160:163]
  v_exp_f32 v10, v50
  v_mfma_f32_16x16x32_bf16 v[192:195], a[96:99], v[72:75], v[192:195]
  v_exp_f32 v11, v51
  v_mfma_f32_16x16x32_bf16 v[224:227], a[96:99], v[76:79], v[224:227]
  ds_read_b128 a[72:75], v4 offset:10240
  v_cvt_pk_bf16_f32 v88, v8, v9
  v_mfma_f32_16x16x32_bf16 v[132:135], a[100:103], v[64:67], v[132:135]
  v_cvt_pk_bf16_f32 v89, v10, v11
  v_or3_b32 v5, v5, v88, v89
  v_mfma_f32_16x16x32_bf16 v[164:167], a[100:103], v[68:71], v[164:167]
  v_exp_f32 v12, v52
  v_mfma_f32_16x16x32_bf16 v[196:199], a[100:103], v[72:75], v[196:199]
  ds_read_b128 a[76:79], v4 offset:11264
  v_mfma_f32_16x16x32_bf16 v[228:231], a[100:103], v[76:79], v[228:231]
  v_exp_f32 v13, v53
  v_mfma_f32_16x16x32_bf16 v[136:139], a[104:107], v[64:67], v[136:139]
  v_exp_f32 v14, v54
  v_mfma_f32_16x16x32_bf16 v[168:171], a[104:107], v[68:71], v[168:171]
  ds_read_b128 a[80:83], v4 offset:12288
  v_mfma_f32_16x16x32_bf16 v[200:203], a[104:107], v[72:75], v[200:203]
  v_exp_f32 v15, v55
  v_mfma_f32_16x16x32_bf16 v[232:235], a[104:107], v[76:79], v[232:235]
  v_cvt_pk_bf16_f32 v90, v12, v13
  v_cvt_pk_bf16_f32 v91, v14, v15
  v_mfma_f32_16x16x32_bf16 v[140:143], a[108:111], v[64:67], v[140:143]
  ds_read_b128 a[84:87], v4 offset:13312
  v_or3_b32 v5, v5, v90, v91
  v_mfma_f32_16x16x32_bf16 v[172:175], a[108:111], v[68:71], v[172:175]
  v_exp_f32 v8, v56
  v_mfma_f32_16x16x32_bf16 v[204:207], a[108:111], v[72:75], v[204:207]
  v_exp_f32 v9, v57
  v_mfma_f32_16x16x32_bf16 v[236:239], a[108:111], v[76:79], v[236:239]
  ds_read_b128 a[88:91], v4 offset:14336
  v_mfma_f32_16x16x32_bf16 v[144:147], a[112:115], v[64:67], v[144:147]
  v_exp_f32 v10, v58
  v_mfma_f32_16x16x32_bf16 v[176:179], a[112:115], v[68:71], v[176:179]
  v_exp_f32 v11, v59
  v_mfma_f32_16x16x32_bf16 v[208:211], a[112:115], v[72:75], v[208:211]
  ds_read_b128 a[92:95], v4 offset:15360
  v_cvt_pk_bf16_f32 v92, v8, v9
  v_mfma_f32_16x16x32_bf16 v[240:243], a[112:115], v[76:79], v[240:243]
  v_cvt_pk_bf16_f32 v93, v10, v11
  v_or3_b32 v5, v5, v92, v93
  v_mfma_f32_16x16x32_bf16 v[148:151], a[116:119], v[64:67], v[148:151]
  v_exp_f32 v12, v60
  v_mfma_f32_16x16x32_bf16 v[180:183], a[116:119], v[68:71], v[180:183]
  v_exp_f32 v13, v61
  v_mfma_f32_16x16x32_bf16 v[212:215], a[116:119], v[72:75], v[212:215]
  v_exp_f32 v14, v62
  v_mfma_f32_16x16x32_bf16 v[244:247], a[116:119], v[76:79], v[244:247]
  v_exp_f32 v15, v63
  v_mfma_f32_16x16x32_bf16 v[152:155], a[120:123], v[64:67], v[152:155]
  v_cvt_pk_bf16_f32 v94, v12, v13
  v_cvt_pk_bf16_f32 v95, v14, v15
  v_mfma_f32_16x16x32_bf16 v[184:187], a[120:123], v[68:71], v[184:187]
  v_or3_b32 v5, v5, v94, v95
  v_and_b32 v5, s70, v5
  v_mfma_f32_16x16x32_bf16 v[216:219], a[120:123], v[72:75], v[216:219]
  v_cmp_ne_u32 vcc, 0, v5
  v_cmp_gt_i32 s[80:81], 0, v25
  v_mfma_f32_16x16x32_bf16 v[248:251], a[120:123], v[76:79], v[248:251]
  v_cmp_gt_i32 s[82:83], 1, v25
  v_cmp_gt_i32 s[84:85], 2, v25
  v_mfma_f32_16x16x32_bf16 v[156:159], a[124:127], v[64:67], v[156:159]
  v_cmp_gt_i32 s[86:87], 3, v25
  v_cndmask_b32 v104, v104, v24, s[80:81]
  v_mfma_f32_16x16x32_bf16 v[188:191], a[124:127], v[68:71], v[188:191]
  v_cndmask_b32 v105, v105, v24, s[82:83]
  v_cndmask_b32 v106, v106, v24, s[84:85]
  v_mfma_f32_16x16x32_bf16 v[220:223], a[124:127], v[72:75], v[220:223]
  v_cndmask_b32 v107, v107, v24, s[86:87]
  v_cmp_gt_i32 s[80:81], 16, v25
  v_mfma_f32_16x16x32_bf16 v[252:255], a[124:127], v[76:79], v[252:255]
  v_cmp_gt_i32 s[82:83], 17, v25
  v_cmp_gt_i32 s[84:85], 18, v25
  v_cmp_gt_i32 s[86:87], 19, v25
  v_cndmask_b32 v108, v108, v24, s[80:81]
  v_cndmask_b32 v109, v109, v24, s[82:83]
  v_cndmask_b32 v110, v110, v24, s[84:85]
  v_cndmask_b32 v111, v111, v24, s[86:87]
  v_add_u32 v4, 0x4000, v4
  v_and_b32 v4, 0x1ffff, v4
  s_cbranch_vccnz L_a_d1_t
L_a_d1_r:
L_a_d2:
  s_waitcnt vmcnt(24) lgkmcnt(0)
  v_mfma_f32_16x16x32_bf16 v[40:43], a[64:67], a[16:19], v[104:107]
  s_barrier
  ds_read_b128 a[96:99], v4 offset:0
  v_mfma_f32_16x16x32_bf16 v[40:43], a[72:75], a[20:23], v[40:43]
  s_nop 0
  ds_read_b128 a[100:103], v4 offset:1024
  v_mfma_f32_16x16x32_bf16 v[40:43], a[80:83], a[24:27], v[40:43]
  s_nop 0
  ds_read_b128 a[104:107], v4 offset:2048
  v_mfma_f32_16x16x32_bf16 v[40:43], a[88:91], a[28:31], v[40:43]
  s_nop 0
  ds_read_b128 a[108:111], v4 offset:3072
  v_mfma_f32_16x16x32_bf16 v[44:47], a[68:71], a[16:19], v[108:111]
  s_nop 0
  ds_read_b128 a[112:115], v4 offset:4096
  v_mfma_f32_16x16x32_bf16 v[44:47], a[76:79], a[20:23], v[44:47]
  s_nop 0
  ds_read_b128 a[116:119], v4 offset:5120
  v_mfma_f32_16x16x32_bf16 v[44:47], a[84:87], a[24:27], v[44:47]
  s_nop 0
  ds_read_b128 a[120:123], v4 offset:6144
  v_mfma_f32_16x16x32_bf16 v[44:47], a[92:95], a[28:31], v[44:47]
  s_nop 0
  ds_read_b128 a[124:127], v4 offset:7168
  v_mfma_f32_16x16x32_bf16 v[48:51], a[64:67], a[32:35], v[112:115]
  s_add_u32 m0, s73, 0
  s_add_u32 s66, s72, 0
  buffer_load_dwordx4 v26, s[48:51], s66 offen lds
  v_mfma_f32_16x16x32_bf16 v[48:51], a[72:75], a[36:39], v[48:51]
  s_add_u32 m0, s73, 1024
  s_add_u32 s66, s72, 8192
  buffer_load_dwordx4 v26, s[48:51], s66 offen lds
  v_mfma_f32_16x16x32_bf16 v[48:51], a[80:83], a[40:43], v[48:51]
  s_add_u32 m0, s73, 2048
  s_add_u32 s66, s72, 16384
  buffer_load_dwordx4 v26, s[48:51], s66 offen lds
  v_mfma_f32_16x16x32_bf16 v[48:51], a[88:91], a[44:47], v[48:51]
  s_add_u32 m0, s73, 3072
  s_add_u32 s66, s72, 24576
  buffer_load_dwordx4 v26, s[48:51], s66 offen lds
  v_mfma_f32_16x16x32_bf16 v[52:55], a[68:71], a[32:35], v[116:119]
  s_add_u32 s58, s58, 1
  v_exp_f32 v8, v40
  v_mfma_f32_16x16x32_bf16 v[52:55], a[76:79], a[36:39], v[52:55]
  s_nop 0
  v_exp_f32 v9, v41
  v_mfma_f32_16x16x32_bf16 v[52:55], a[84:87], a[40:43], v[52:55]
  s_nop 0
  v_exp_f32 v10, v42
  v_mfma_f32_16x16x32_bf16 v[52:55], a[92:95], a[44:47], v[52:55]
  s_nop 0
  v_exp_f32 v11, v43
  v_mfma_f32_16x16x32_bf16 v[56:59], a[64:67], a[48:51], v[120:123]
  s_nop 0
  v_cvt_pk_bf16_f32 v68, v8, v9
  v_cvt_pk_bf16_f32 v69, v10, v11
  v_mfma_f32_16x16x32_bf16 v[56:59], a[72:75], a[52:55], v[56:59]
  s_nop 0
  v_or_b32 v5, v68, v69
  v_mfma_f32_16x16x32_bf16 v[56:59], a[80:83], a[56:59], v[56:59]
  s_nop 0
  v_exp_f32 v12, v44
  v_mfma_f32_16x16x32_bf16 v[56:59], a[88:91], a[60:63], v[56:59]
  s_nop 0
  v_exp_f32 v13, v45
  v_mfma_f32_16x16x32_bf16 v[60:63], a[68:71], a[48:51], v[124:127]
  s_nop 0
  v_exp_f32 v14, v46
  v_mfma_f32_16x16x32_bf16 v[60:63], a[76:79], a[52:55], v[60:63]
  s_nop 0
  v_exp_f32 v15, v47
  v_mfma_f32_16x16x32_bf16 v[60:63], a[84:87], a[56:59], v[60:63]
  s_nop 0
  v_cvt_pk_bf16_f32 v70, v12, v13
  v_cvt_pk_bf16_f32 v71, v14, v15
  v_mfma_f32_16x16x32_bf16 v[60:63], a[92:95], a[60:63], v[60:63]
  s_nop 0
  v_or3_b32 v5, v5, v70, v71
  v_mfma_f32_16x16x32_bf16 a[128:131], v[16:19], v[80:83], a[128:131]
  s_nop 0
  v_exp_f32 v8, v48
  v_mfma_f32_16x16x32_bf16 a[132:135], v[16:19], v[84:87], a[132:135]
  s_nop 0
  ds_read_b128 a[64:67], v4 offset:8192
  v_mfma_f32_16x16x32_bf16 a[136:139], v[16:19], v[88:91], a[136:139]
  s_nop 0
  v_exp_f32 v9, v49
  v_mfma_f32_16x16x32_bf16 a[140:143], v[16:19], v[92:95], a[140:143]
  s_nop 0
  v_exp_f32 v10, v50
  s_waitcnt lgkmcnt(1)
  v_mfma_f32_16x16x32_bf16 v[128:131], a[96:99], v[80:83], v[128:131]
  ds_read_b128 a[68:71], v4 offset:9216
  v_mfma_f32_16x16x32_bf16 v[160:163], a[96:99], v[84:87], v[160:163]
  v_exp_f32 v11, v51
  v_mfma_f32_16x16x32_bf16 v[192:195], a[96:99], v[88:91], v[192:195]
  v_cvt_pk_bf16_f32 v72, v8, v9
  v_cvt_pk_bf16_f32 v73, v10, v11
  v_mfma_f32_16x16x32_bf16 v[224:227], a[96:99], v[92:95], v[224:227]
  ds_read_b128 a[72:75], v4 offset:10240
  v_or3_b32 v5, v5, v72, v73
  v_mfma_f32_16x16x32_bf16 v[132:135], a[100:103], v[80:83], v[132:135]
  v_exp_f32 v12, v52
  v_mfma_f32_16x16x32_bf16 v[164:167], a[100:103], v[84:87], v[164:167]
  v_exp_f32 v13, v53
  v_mfma_f32_16x16x32_bf16 v[196:199], a[100:103], v[88:91], v[196:199]
  ds_read_b128 a[76:79], v4 offset:11264
  v_mfma_f32_16x16x32_bf16 v[228:231], a[100:103], v[92:95], v[228:231]
  v_exp_f32 v14, v54
  v_mfma_f32_16x16x32_bf16 v[136:139], a[104:107], v[80:83], v[136:139]
  v_exp_f32 v15, v55
  v_mfma_f32_16x16x32_bf16 v[168:171], a[104:107], v[84:87], v[168:171]
  ds_read_b128 a[80:83], v4 offset:12288
  v_cvt_pk_bf16_f32 v74, v12, v13
  v_mfma_f32_16x16x32_bf16 v[200:203], a[104:107], v[88:91], v[200:203]
  v_cvt_pk_bf16_f32 v75, v14, v15
  v_or3_b32 v5, v5, v74, v75
  v_mfma_f32_16x16x32_bf16 v[232:235], a[104:107], v[92:95], v[232:235]
  v_exp_f32 v8, v56
  v_mfma_f32_16x16x32_bf16 v[140:143], a[108:111], v[80:83], v[140:143]
  ds_read_b128 a[84:87], v4 offset:13312
  v_mfma_f32_16x16x32_bf16 v[172:175], a[108:111], v[84:87], v[172:175]
  v_exp_f32 v9, v57
  v_mfma_f32_16x16x32_bf16 v[204:207], a[108:111], v[88:91], v[204:207]
  v_exp_f32 v10, v58
  v_mfma_f32_16x16x32_bf16 v[236:239], a[108:111], v[92:95], v[236:239]
  ds_read_b128 a[88:91], v4 offset:14336
  v_mfma_f32_16x16x32_bf16 v[144:147], a[112:115], v[80:83], v[144:147]
  v_exp_f32 v11, v59
  v_mfma_f32_16x16x32_bf16 v[176:179], a[112:115], v[84:87], v[176:179]
  v_cvt_pk_bf16_f32 v76, v8, v9
  v_cvt_pk_bf16_f32 v77, v10, v11
  v_mfma_f32_16x16x32_bf16 v[208:211], a[112:115], v[88:91], v[208:211]
  ds_read_b128 a[92:95], v4 offset:15360
  v_or3_b32 v5, v5, v76, v77
  v_mfma_f32_16x16x32_bf16 v[240:243], a[112:115], v[92:95], v[240:243]
  v_exp_f32 v12, v60
  v_mfma_f32_16x16x32_bf16 v[148:151], a[116:119], v[80:83], v[148:151]
  v_exp_f32 v13, v61
  v_mfma_f32_16x16x32_bf16 v[180:183], a[116:119], v[84:87], v[180:183]
  v_exp_f32 v14, v62
  v_mfma_f32_16x16x32_bf16 v[212:215], a[116:119], v[88:91], v[212:215]
  v_exp_f32 v15, v63
  v_mfma_f32_16x16x32_bf16 v[244:247], a[116:119], v[92:95], v[244:247]
  v_cvt_pk_bf16_f32 v78, v12, v13
  v_cvt_pk_bf16_f32 v79, v14, v15
  v_mfma_f32_16x16x32_bf16 v[152:155], a[120:123], v[80:83], v[152:155]
  v_or3_b32 v5, v5, v78, v79
  v_and_b32 v5, s70, v5
  v_mfma_f32_16x16x32_bf16 v[184:187], a[120:123], v[84:87], v[184:187]
  v_cmp_ne_u32 vcc, 0, v5
  v_cmp_gt_i32 s[80:81], 32, v25
  v_mfma_f32_16x16x32_bf16 v[216:219], a[120:123], v[88:91], v[216:219]
  v_cmp_gt_i32 s[82:83], 33, v25
  v_cmp_gt_i32 s[84:85], 34, v25
  v_mfma_f32_16x16x32_bf16 v[248:251], a[120:123], v[92:95], v[248:251]
  v_cmp_gt_i32 s[86:87], 35, v25
  v_cndmask_b32 v104, v104, v24, s[80:81]
  v_mfma_f32_16x16x32_bf16 v[156:159], a[124:127], v[80:83], v[156:159]
  v_cndmask_b32 v105, v105, v24, s[82:83]
  v_cndmask_b32 v106, v106, v24, s[84:85]
  v_mfma_f32_16x16x32_bf16 v[188:191], a[124:127], v[84:87], v[188:191]
  v_cndmask_b32 v107, v107, v24, s[86:87]
  v_cmp_gt_i32 s[80:81], 48, v25
  v_mfma_f32_16x16x32_bf16 v[220:223], a[124:127], v[88:91], v[220:223]
  v_cmp_gt_i32 s[82:83], 49, v25
  v_cmp_gt_i32 s[84:85], 50, v25
  v_mfma_f32_16x16x32_bf16 v[252:255], a[124:127], v[92:95], v[252:255]
  v_cmp_gt_i32 s[86:87], 51, v25
  v_cndmask_b32 v108, v108, v24, s[80:81]
  v_cndmask_b32 v109, v109, v24, s[82:83]
  v_cndmask_b32 v110, v110, v24, s[84:85]
  v_cndmask_b32 v111, v111, v24, s[86:87]
  v_add_u32 v4, 0x4000, v4
  v_and_b32 v4, 0x1ffff, v4
  s_cbranch_vccnz L_a_d2_t
L_a_d2_r:
L_a_d3:
  s_waitcnt vmcnt(24) lgkmcnt(0)
  v_mfma_f32_16x16x32_bf16 v[40:43], a[64:67], a[16:19], v[104:107]
  s_barrier
  ds_read_b128 a[96:99], v4 offset:0
  v_mfma_f32_16x16x32_bf16 v[40:43], a[72:75], a[20:23], v[40:43]
  s_nop 0
  ds_read_b128 a[100:103], v4 offset:1024
  v_mfma_f32_16x16x32_bf16 v[40:43], a[80:83], a[24:27], v[40:43]
  s_nop 0
  ds_read_b128 a[104:107], v4 offset:2048
  v_mfma_f32_16x16x32_bf16 v[40:43], a[88:91], a[28:31], v[40:43]
  s_nop 0
  ds_read_b128 a[108:111], v4 offset:3072
  v_mfma_f32_16x16x32_bf16 v[44:47], a[68:71], a[16:19], v[108:111]
  s_nop 0
  ds_read_b128 a[112:115], v4 offset:4096
  v_mfma_f32_16x16x32_bf16 v[44:47], a[76:79], a[20:23], v[44:47]
  s_nop 0
  ds_read_b128 a[116:119], v4 offset:5120
  v_mfma_f32_16x16x32_bf16 v[44:47], a[84:87], a[24:27], v[44:47]
  s_nop 0
  ds_read_b128 a[120:123], v4 offset:6144
  v_mfma_f32_16x16x32_bf16 v[44:47], a[92:95], a[28:31], v[44:47]
  s_nop 0
  ds_read_b128 a[124:127], v4 offset:7168
  v_mfma_f32_16x16x32_bf16 v[48:51], a[64:67], a[32:35], v[112:115]
  s_add_u32 m0, s73, 16384
  s_add_u32 s66, s72, 128
  buffer_load_dwordx4 v26, s[48:51], s66 offen lds
  v_mfma_f32_16x16x32_bf16 v[48:51], a[72:75], a[36:39], v[48:51]
  s_add_u32 m0, s73, 17408
  s_add_u32 s66, s72, 8320
  buffer_load_dwordx4 v26, s[48:51], s66 offen lds
  v_mfma_f32_16x16x32_bf16 v[48:51], a[80:83], a[40:43], v[48:51]
  s_add_u32 m0, s73, 18432
  s_add_u32 s66, s72, 16512
  buffer_load_dwordx4 v26, s[48:51], s66 offen lds
  v_mfma_f32_16x16x32_bf16 v[48:51], a[88:91], a[44:47], v[48:51]
  s_add_u32 m0, s73, 19456
  s_add_u32 s66, s72, 24704
  buffer_load_dwordx4 v26, s[48:51], s66 offen lds
  v_mfma_f32_16x16x32_bf16 v[52:55], a[68:71], a[32:35], v[116:119]
  s_add_u32 s58, s58, 1
  v_exp_f32 v8, v40
  v_mfma_f32_16x16x32_bf16 v[52:55], a[76:79], a[36:39], v[52:55]
  s_nop 0
  v_exp_f32 v9, v41
  v_mfma_f32_16x16x32_bf16 v[52:55], a[84:87], a[40:43], v[52:55]
  s_nop 0
  v_exp_f32 v10, v42
  v_mfma_f32_16x16x32_bf16 v[52:55], a[92:95], a[44:47], v[52:55]
  s_nop 0
  v_exp_f32 v11, v43
  v_mfma_f32_16x16x32_bf16 v[56:59], a[64:67], a[48:51], v[120:123]
  s_nop 0
  v_cvt_pk_bf16_f32 v84, v8, v9
  v_cvt_pk_bf16_f32 v85, v10, v11
  v_mfma_f32_16x16x32_bf16 v[56:59], a[72:75], a[52:55], v[56:59]
  s_nop 0
  v_or_b32 v5, v84, v85
  v_mfma_f32_16x16x32_bf16 v[56:59], a[80:83], a[56:59], v[56:59]
  s_nop 0
  v_exp_f32 v12, v44
  v_mfma_f32_16x16x32_bf16 v[56:59], a[88:91], a[60:63], v[56:59]
  s_nop 0
  v_exp_f32 v13, v45
  v_mfma_f32_16x16x32_bf16 v[60:63], a[68:71], a[48:51], v[124:127]
  s_nop 0
  v_exp_f32 v14, v46
  v_mfma_f32_16x16x32_bf16 v[60:63], a[76:79], a[52:55], v[60:63]
  s_nop 0
  v_exp_f32 v15, v47
  v_mfma_f32_16x16x32_bf16 v[60:63], a[84:87], a[56:59], v[60:63]
  s_nop 0
  v_cvt_pk_bf16_f32 v86, v12, v13
  v_cvt_pk_bf16_f32 v87, v14, v15
  v_mfma_f32_16x16x32_bf16 v[60:63], a[92:95], a[60:63], v[60:63]
  s_nop 0
  v_or3_b32 v5, v5, v86, v87
  v_mfma_f32_16x16x32_bf16 a[132:135], v[16:19], v[68:71], a[132:135]
  s_nop 0
  ds_read_b128 a[64:67], v4 offset:8192
  v_mfma_f32_16x16x32_bf16 a[136:139], v[16:19], v[72:75], a[136:139]
  s_nop 0
  ds_read_b128 a[68:71], v4 offset:9216
  v_mfma_f32_16x16x32_bf16 a[140:143], v[16:19], v[76:79], a[140:143]
  s_nop 0
  ds_read_b128 a[72:75], v4 offset:10240
  s_waitcnt lgkmcnt(3)
  v_mfma_f32_16x16x32_bf16 v[160:163], a[96:99], v[68:71], v[160:163]
  s_nop 0
  ds_read_b128 a[76:79], v4 offset:11264
  v_mfma_f32_16x16x32_bf16 v[192:195], a[96:99], v[72:75], v[192:195]
  ds_read_b128 a[80:83], v4 offset:12288
  v_mfma_f32_16x16x32_bf16 v[224:227], a[96:99], v[76:79], v[224:227]
  ds_read_b128 a[84:87], v4 offset:13312
  v_mfma_f32_16x16x32_bf16 v[164:167], a[100:103], v[68:71], v[164:167]
  ds_read_b128 a[88:91], v4 offset:14336
  v_mfma_f32_16x16x32_bf16 v[196:199], a[100:103], v[72:75], v[196:199]
  ds_read_b128 a[92:95], v4 offset:15360
  v_mfma_f32_16x16x32_bf16 v[228:231], a[100:103], v[76:79], v[228:231]
  v_exp_f32 v8, v48
  v_mfma_f32_16x16x32_bf16 v[168:171], a[104:107], v[68:71], v[168:171]
  v_exp_f32 v9, v49
  v_mfma_f32_16x16x32_bf16 v[200:203], a[104:107], v[72:75], v[200:203]
  v_exp_f32 v10, v50
  v_mfma_f32_16x16x32_bf16 v[232:235], a[104:107], v[76:79], v[232:235]
  v_exp_f32 v11, v51
  v_mfma_f32_16x16x32_bf16 v[172:175], a[108:111], v[68:71], v[172:175]
  v_cvt_pk_bf16_f32 v88, v8, v9
  v_cvt_pk_bf16_f32 v89, v10, v11
  v_mfma_f32_16x16x32_bf16 v[204:207], a[108:111], v[72:75], v[204:207]
  v_or3_b32 v5, v5, v88, v89
  v_mfma_f32_16x16x32_bf16 v[236:239], a[108:111], v[76:79], v[236:239]
  v_exp_f32 v12, v52
  v_mfma_f32_16x16x32_bf16 v[176:179], a[112:115], v[68:71], v[176:179]
  v_exp_f32 v13, v53
  v_mfma_f32_16x16x32_bf16 v[208:211], a[112:115], v[72:75], v[208:211]
  v_exp_f32 v14, v54
  v_mfma_f32_16x16x32_bf16 v[240:243], a[112:115], v[76:79], v[240:243]
  v_exp_f32 v15, v55
  v_mfma_f32_16x16x32_bf16 v[180:183], a[116:119], v[68:71], v[180:183]
  v_cvt_pk_bf16_f32 v90, v12, v13
  v_cvt_pk_bf16_f32 v91, v14, v15
  v_mfma_f32_16x16x32_bf16 v[212:215], a[116:119], v[72:75], v[212:215]
  v_or3_b32 v5, v5, v90, v91
  v_mfma_f32_16x16x32_bf16 v[244:247], a[116:119], v[76:79], v[244:247]
  v_exp_f32 v8, v56
  v_mfma_f32_16x16x32_bf16 v[184:187], a[120:123], v[68:71], v[184:187]
  v_exp_f32 v9, v57
  v_mfma_f32_16x16x32_bf16 v[216:219], a[120:123], v[72:75], v[216:219]
  v_exp_f32 v10, v58
  v_mfma_f32_16x16x32_bf16 v[248:251], a[120:123], v[76:79], v[248:251]
  v_exp_f32 v11, v59
  v_mfma_f32_16x16x32_bf16 v[188:191], a[124:127], v[68:71], v[188:191]
  v_cvt_pk_bf16_f32 v92, v8, v9
  v_cvt_pk_bf16_f32 v93, v10, v11
  v_mfma_f32_16x16x32_bf16 v[220:223], a[124:127], v[72:75], v[220:223]
  v_or3_b32 v5, v5, v92, v93
  v_mfma_f32_16x16x32_bf16 v[252:255], a[124:127], v[76:79], v[252:255]
  v_exp_f32 v12, v60
  v_exp_f32 v13, v61
  v_exp_f32 v14, v62
  v_exp_f32 v15, v63
  s_nop 0
  v_cvt_pk_bf16_f32 v94, v12, v13
  v_cvt_pk_bf16_f32 v95, v14, v15
  v_or3_b32 v5, v5, v94, v95
  v_and_b32 v5, s70, v5
  v_cmp_ne_u32 vcc, 0, v5
  v_cmp_gt_i32 s[80:81], 0, v25
  v_cmp_gt_i32 s[82:83], 1, v25
  v_cmp_gt_i32 s[84:85], 2, v25
  v_cmp_gt_i32 s[86:87], 3, v25
  v_cndmask_b32 v112, v112, v24, s[80:81]
  v_cndmask_b32 v113, v113, v24, s[82:83]
  v_cndmask_b32 v114, v114, v24, s[84:85]
  v_cndmask_b32 v115, v115, v24, s[86:87]
  v_cmp_gt_i32 s[80:81], 16, v25
  v_cmp_gt_i32 s[82:83], 17, v25
  v_cmp_gt_i32 s[84:85], 18, v25
  v_cmp_gt_i32 s[86:87], 19, v25
  v_cndmask_b32 v116, v116, v24, s[80:81]
  v_cndmask_b32 v117, v117, v24, s[82:83]
  v_cndmask_b32 v118, v118, v24, s[84:85]
  v_cndmask_b32 v119, v119, v24, s[86:87]
  v_add_u32 v4, 0x4000, v4
  v_and_b32 v4, 0x1ffff, v4
  s_cbranch_vccnz L_a_d3_t
L_a_d3_r:
L_a_d4:
  s_waitcnt vmcnt(24) lgkmcnt(0)
  v_mfma_f32_16x16x32_bf16 v[48:51], a[64:67], a[32:35], v[112:115]
  s_barrier
  ds_read_b128 a[96:99], v4 offset:0
  v_mfma_f32_16x16x32_bf16 v[48:51], a[72:75], a[36:39], v[48:51]
  s_nop 0
  ds_read_b128 a[100:103], v4 offset:1024
  v_mfma_f32_16x16x32_bf16 v[48:51], a[80:83], a[40:43], v[48:51]
  s_nop 0
  ds_read_b128 a[104:107], v4 offset:2048
  v_mfma_f32_16x16x32_bf16 v[48:51], a[88:91], a[44:47], v[48:51]
  s_nop 0
  ds_read_b128 a[108:111], v4 offset:3072
  v_mfma_f32_16x16x32_bf16 v[52:55], a[68:71], a[32:35], v[116:119]
  s_nop 0
  ds_read_b128 a[112:115], v4 offset:4096
  v_mfma_f32_16x16x32_bf16 v[52:55], a[76:79], a[36:39], v[52:55]
  s_nop 0
  ds_read_b128 a[116:119], v4 offset:5120
  v_mfma_f32_16x16x32_bf16 v[52:55], a[84:87], a[40:43], v[52:55]
  s_nop 0
  ds_read_b128 a[120:123], v4 offset:6144
  v_mfma_f32_16x16x32_bf16 v[52:55], a[92:95], a[44:47], v[52:55]
  s_nop 0
  ds_read_b128 a[124:127], v4 offset:7168
  v_mfma_f32_16x16x32_bf16 v[56:59], a[64:67], a[48:51], v[120:123]
  s_add_u32 m0, s73, 32768
  s_add_u32 s66, s72, 256
  buffer_load_dwordx4 v26, s[48:51], s66 offen lds
  v_mfma_f32_16x16x32_bf16 v[56:59], a[72:75], a[52:55], v[56:59]
  s_add_u32 m0, s73, 33792
  s_add_u32 s66, s72, 8448
  buffer_load_dwordx4 v26, s[48:51], s66 offen lds
  v_mfma_f32_16x16x32_bf16 v[56:59], a[80:83], a[56:59], v[56:59]
  s_add_u32 m0, s73, 34816
  s_add_u32 s66, s72, 16640
  buffer_load_dwordx4 v26, s[48:51], s66 offen lds
  v_mfma_f32_16x16x32_bf16 v[56:59], a[88:91], a[60:63], v[56:59]
  s_add_u32 m0, s73, 35840
  s_add_u32 s66, s72, 24832
  buffer_load_dwordx4 v26, s[48:51], s66 offen lds
  v_mfma_f32_16x16x32_bf16 v[60:63], a[68:71], a[48:51], v[124:127]
  s_add_u32 s58, s58, 1
  v_exp_f32 v8, v48
  v_mfma_f32_16x16x32_bf16 v[60:63], a[76:79], a[52:55], v[60:63]
  s_nop 0
  v_exp_f32 v9, v49
  v_mfma_f32_16x16x32_bf16 v[60:63], a[84:87], a[56:59], v[60:63]
  s_nop 0
  v_exp_f32 v10, v50
  v_mfma_f32_16x16x32_bf16 v[60:63], a[92:95], a[60:63], v[60:63]
  s_nop 0
  v_exp_f32 v11, v51
  v_mfma_f32_16x16x32_bf16 a[132:135], v[16:19], v[84:87], a[132:135]
  s_nop 0
  ds_read_b128 a[64:67], v4 offset:8192
  v_cvt_pk_bf16_f32 v72, v8, v9
  v_mfma_f32_16x16x32_bf16 a[136:139], v[16:19], v[88:91], a[136:139]
  s_nop 0
  ds_read_b128 a[68:71], v4 offset:9216
  v_cvt_pk_bf16_f32 v73, v10, v11
  v_mfma_f32_16x16x32_bf16 a[140:143], v[16:19], v[92:95], a[140:143]
  s_nop 0
  ds_read_b128 a[72:75], v4 offset:10240
  v_or_b32 v5, v72, v73
  s_waitcnt lgkmcnt(3)
  v_mfma_f32_16x16x32_bf16 v[160:163], a[96:99], v[84:87], v[160:163]
  s_nop 0
  ds_read_b128 a[76:79], v4 offset:11264
  v_mfma_f32_16x16x32_bf16 v[192:195], a[96:99], v[88:91], v[192:195]
  ds_read_b128 a[80:83], v4 offset:12288
  v_mfma_f32_16x16x32_bf16 v[224:227], a[96:99], v[92:95], v[224:227]
  ds_read_b128 a[84:87], v4 offset:13312
  v_mfma_f32_16x16x32_bf16 v[164:167], a[100:103], v[84:87], v[164:167]
  ds_read_b128 a[88:91], v4 offset:14336
  v_mfma_f32_16x16x32_bf16 v[196:199], a[100:103], v[88:91], v[196:199]
  ds_read_b128 a[92:95], v4 offset:15360
  v_mfma_f32_16x16x32_bf16 v[228:231], a[100:103], v[92:95], v[228:231]
  v_exp_f32 v12, v52
  v_mfma_f32_16x16x32_bf16 v[168:171], a[104:107], v[84:87], v[168:171]
  v_exp_f32 v13, v53
  v_mfma_f32_16x16x32_bf16 v[200:203], a[104:107], v[88:91], v[200:203]
  v_exp_f32 v14, v54
  v_mfma_f32_16x16x32_bf16 v[232:235], a[104:107], v[92:95], v[232:235]
  v_exp_f32 v15, v55
  v_mfma_f32_16x16x32_bf16 v[172:175], a[108:111], v[84:87], v[172:175]
  v_cvt_pk_bf16_f32 v74, v12, v13
  v_cvt_pk_bf16_f32 v75, v14, v15
  v_mfma_f32_16x16x32_bf16 v[204:207], a[108:111], v[88:91], v[204:207]
  v_or3_b32 v5, v5, v74, v75
  v_mfma_f32_16x16x32_bf16 v[236:239], a[108:111], v[92:95], v[236:239]
  v_exp_f32 v8, v56
  v_mfma_f32_16x16x32_bf16 v[176:179], a[112:115], v[84:87], v[176:179]
  v_exp_f32 v9, v57
  v_mfma_f32_16x16x32_bf16 v[208:211], a[112:115], v[88:91], v[208:211]
  v_exp_f32 v10, v58
  v_mfma_f32_16x16x32_bf16 v[240:243], a[112:115], v[92:95], v[240:243]
  v_exp_f32 v11, v59
  v_mfma_f32_16x16x32_bf16 v[180:183], a[116:119], v[84:87], v[180:183]
  v_cvt_pk_bf16_f32 v76, v8, v9
  v_cvt_pk_bf16_f32 v77, v10, v11
  v_mfma_f32_16x16x32_bf16 v[212:215], a[116:119], v[88:91], v[212:215]
  v_or3_b32 v5, v5, v76, v77
  v_mfma_f32_16x16x32_bf16 v[244:247], a[116:119], v[92:95], v[244:247]
  v_exp_f32 v12, v60
  v_mfma_f32_16x16x32_bf16 v[184:187], a[120:123], v[84:87], v[184:187]
  v_exp_f32 v13, v61
  v_mfma_f32_16x16x32_bf16 v[216:219], a[120:123], v[88:91], v[216:219]
  v_exp_f32 v14, v62
  v_mfma_f32_16x16x32_bf16 v[248:251], a[120:123], v[92:95], v[248:251]
  v_exp_f32 v15, v63
  v_mfma_f32_16x16x32_bf16 v[188:191], a[124:127], v[84:87], v[188:191]
  v_cvt_pk_bf16_f32 v78, v12, v13
  v_cvt_pk_bf16_f32 v79, v14, v15
  v_mfma_f32_16x16x32_bf16 v[220:223], a[124:127], v[88:91], v[220:223]
  v_or3_b32 v5, v5, v78, v79
  v_and_b32 v5, s70, v5
  v_mfma_f32_16x16x32_bf16 v[252:255], a[124:127], v[92:95], v[252:255]
  v_cmp_ne_u32 vcc, 0, v5
  v_cmp_gt_i32 s[80:81], 32, v25
  v_cmp_gt_i32 s[82:83], 33, v25
  v_cmp_gt_i32 s[84:85], 34, v25
  v_cmp_gt_i32 s[86:87], 35, v25
  v_cndmask_b32 v112, v112, v24, s[80:81]
  v_cndmask_b32 v113, v113, v24, s[82:83]
  v_cndmask_b32 v114, v114, v24, s[84:85]
  v_cndmask_b32 v115, v115, v24, s[86:87]
  v_cmp_gt_i32 s[80:81], 48, v25
  v_cmp_gt_i32 s[82:83], 49, v25
  v_cmp_gt_i32 s[84:85], 50, v25
  v_cmp_gt_i32 s[86:87], 51, v25
  v_cndmask_b32 v116, v116, v24, s[80:81]
  v_cndmask_b32 v117, v117, v24, s[82:83]
  v_cndmask_b32 v118, v118, v24, s[84:85]
  v_cndmask_b32 v119, v119, v24, s[86:87]
  v_add_u32 v4, 0x4000, v4
  v_and_b32 v4, 0x1ffff, v4
  s_cbranch_vccnz L_a_d4_t
L_a_d4_r:
L_a_d5:
  s_waitcnt vmcnt(24) lgkmcnt(0)
  v_mfma_f32_16x16x32_bf16 v[48:51], a[64:67], a[32:35], v[112:115]
  s_barrier
  ds_read_b128 a[96:99], v4 offset:0
  v_mfma_f32_16x16x32_bf16 v[48:51], a[72:75], a[36:39], v[48:51]
  s_nop 0
  ds_read_b128 a[100:103], v4 offset:1024
  v_mfma_f32_16x16x32_bf16 v[48:51], a[80:83], a[40:43], v[48:51]
  s_nop 0
  ds_read_b128 a[104:107], v4 offset:2048
  v_mfma_f32_16x16x32_bf16 v[48:51], a[88:91], a[44:47], v[48:51]
  s_nop 0
  ds_read_b128 a[108:111], v4 offset:3072
  v_mfma_f32_16x16x32_bf16 v[52:55], a[68:71], a[32:35], v[116:119]
  s_nop 0
  ds_read_b128 a[112:115], v4 offset:4096
  v_mfma_f32_16x16x32_bf16 v[52:55], a[76:79], a[36:39], v[52:55]
  s_nop 0
  ds_read_b128 a[116:119], v4 offset:5120
  v_mfma_f32_16x16x32_bf16 v[52:55], a[84:87], a[40:43], v[52:55]
  s_nop 0
  ds_read_b128 a[120:123], v4 offset:6144
  v_mfma_f32_16x16x32_bf16 v[52:55], a[92:95], a[44:47], v[52:55]
  s_nop 0
  ds_read_b128 a[124:127], v4 offset:7168
  v_mfma_f32_16x16x32_bf16 v[56:59], a[64:67], a[48:51], v[120:123]
  s_add_u32 m0, s73, 49152
  s_add_u32 s66, s72, 384
  buffer_load_dwordx4 v26, s[48:51], s66 offen lds
  v_mfma_f32_16x16x32_bf16 v[56:59], a[72:75], a[52:55], v[56:59]
  s_add_u32 m0, s73, 50176
  s_add_u32 s66, s72, 8576
  buffer_load_dwordx4 v26, s[48:51], s66 offen lds
  v_mfma_f32_16x16x32_bf16 v[56:59], a[80:83], a[56:59], v[56:59]
  s_add_u32 m0, s73, 51200
  s_add_u32 s66, s72, 16768
  buffer_load_dwordx4 v26, s[48:51], s66 offen lds
  v_mfma_f32_16x16x32_bf16 v[56:59], a[88:91], a[60:63], v[56:59]
  s_add_u32 m0, s73, 52224
  s_add_u32 s66, s72, 24960
  buffer_load_dwordx4 v26, s[48:51], s66 offen lds
  v_mfma_f32_16x16x32_bf16 v[60:63], a[68:71], a[48:51], v[124:127]
  s_add_u32 s58, s58, 1
  v_exp_f32 v8, v48
  v_mfma_f32_16x16x32_bf16 v[60:63], a[76:79], a[52:55], v[60:63]
  s_nop 0
  v_exp_f32 v9, v49
  v_mfma_f32_16x16x32_bf16 v[60:63], a[84:87], a[56:59], v[60:63]
  s_nop 0
  v_exp_f32 v10, v50
  v_mfma_f32_16x16x32_bf16 v[60:63], a[92:95], a[60:63], v[60:63]
  s_nop 0
  v_exp_f32 v11, v51
  v_mfma_f32_16x16x32_bf16 a[136:139], v[16:19], v[72:75], a[136:139]
  s_nop 0
  ds_read_b128 a[64:67], v4 offset:8192
  v_cvt_pk_bf16_f32 v88, v8, v9
  v_mfma_f32_16x16x32_bf16 a[140:143], v[16:19], v[76:79], a[140:143]
  s_nop 0
  ds_read_b128 a[68:71], v4 offset:9216
  v_cvt_pk_bf16_f32 v89, v10, v11
  s_waitcnt lgkmcnt(2)
  v_mfma_f32_16x16x32_bf16 v[192:195], a[96:99], v[72:75], v[192:195]
  s_nop 0
  ds_read_b128 a[72:75], v4 offset:10240
  v_or_b32 v5, v88, v89
  v_mfma_f32_16x16x32_bf16 v[224:227], a[96:99], v[76:79], v[224:227]
  s_nop 0
  ds_read_b128 a[76:79], v4 offset:11264
  v_mfma_f32_16x16x32_bf16 v[196:199], a[100:103], v[72:75], v[196:199]
  ds_read_b128 a[80:83], v4 offset:12288
  v_mfma_f32_16x16x32_bf16 v[228:231], a[100:103], v[76:79], v[228:231]
  ds_read_b128 a[84:87], v4 offset:13312
  v_mfma_f32_16x16x32_bf16 v[200:203], a[104:107], v[72:75], v[200:203]
  ds_read_b128 a[88:91], v4 offset:14336
  v_mfma_f32_16x16x32_bf16 v[232:235], a[104:107], v[76:79], v[232:235]
  ds_read_b128 a[92:95], v4 offset:15360
  v_mfma_f32_16x16x32_bf16 v[204:207], a[108:111], v[72:75], v[204:207]
  v_exp_f32 v12, v52
  v_mfma_f32_16x16x32_bf16 v[236:239], a[108:111], v[76:79], v[236:239]
  v_exp_f32 v13, v53
  v_mfma_f32_16x16x32_bf16 v[208:211], a[112:115], v[72:75], v[208:211]
  v_exp_f32 v14, v54
  v_mfma_f32_16x16x32_bf16 v[240:243], a[112:115], v[76:79], v[240:243]
  v_exp_f32 v15, v55
  v_mfma_f32_16x16x32_bf16 v[212:215], a[116:119], v[72:75], v[212:215]
  v_cvt_pk_bf16_f32 v90, v12, v13
  v_cvt_pk_bf16_f32 v91, v14, v15
  v_mfma_f32_16x16x32_bf16 v[244:247], a[116:119], v[76:79], v[244:247]
  v_or3_b32 v5, v5, v90, v91
  v_mfma_f32_16x16x32_bf16 v[216:219], a[120:123], v[72:75], v[216:219]
  v_exp_f32 v8, v56
  v_mfma_f32_16x16x32_bf16 v[248:251], a[120:123], v[76:79], v[248:251]
  v_exp_f32 v9, v57
  v_mfma_f32_16x16x32_bf16 v[220:223], a[124:127], v[72:75], v[220:223]
  v_exp_f32 v10, v58
  v_mfma_f32_16x16x32_bf16 v[252:255], a[124:127], v[76:79], v[252:255]
  v_exp_f32 v11, v59
  s_nop 0
  v_cvt_pk_bf16_f32 v92, v8, v9
  v_cvt_pk_bf16_f32 v93, v10, v11
  v_or3_b32 v5, v5, v92, v93
  v_exp_f32 v12, v60
  v_exp_f32 v13, v61
  v_exp_f32 v14, v62
  v_exp_f32 v15, v63
  s_nop 0
  v_cvt_pk_bf16_f32 v94, v12, v13
  v_cvt_pk_bf16_f32 v95, v14, v15
  v_or3_b32 v5, v5, v94, v95
  v_and_b32 v5, s70, v5
  v_cmp_ne_u32 vcc, 0, v5
  v_cmp_gt_i32 s[80:81], 0, v25
  v_cmp_gt_i32 s[82:83], 1, v25
  v_cmp_gt_i32 s[84:85], 2, v25
  v_cmp_gt_i32 s[86:87], 3, v25
  v_cndmask_b32 v120, v120, v24, s[80:81]
  v_cndmask_b32 v121, v121, v24, s[82:83]
  v_cndmask_b32 v122, v122, v24, s[84:85]
  v_cndmask_b32 v123, v123, v24, s[86:87]
  v_cmp_gt_i32 s[80:81], 16, v25
  v_cmp_gt_i32 s[82:83], 17, v25
  v_cmp_gt_i32 s[84:85], 18, v25
  v_cmp_gt_i32 s[86:87], 19, v25
  v_cndmask_b32 v124, v124, v24, s[80:81]
  v_cndmask_b32 v125, v125, v24, s[82:83]
  v_cndmask_b32 v126, v126, v24, s[84:85]
  v_cndmask_b32 v127, v127, v24, s[86:87]
  v_add_u32 v4, 0x4000, v4
  v_and_b32 v4, 0x1ffff, v4
  s_cbranch_vccnz L_a_d5_t
L_a_d5_r:
L_a_d6:
  s_waitcnt vmcnt(24) lgkmcnt(0)
  v_mfma_f32_16x16x32_bf16 v[56:59], a[64:67], a[48:51], v[120:123]
  s_barrier
  ds_read_b128 a[96:99], v4 offset:0
  v_mfma_f32_16x16x32_bf16 v[56:59], a[72:75], a[52:55], v[56:59]
  s_nop 0
  ds_read_b128 a[100:103], v4 offset:1024
  v_mfma_f32_16x16x32_bf16 v[56:59], a[80:83], a[56:59], v[56:59]
  s_nop 0
  ds_read_b128 a[104:107], v4 offset:2048
  v_mfma_f32_16x16x32_bf16 v[56:59], a[88:91], a[60:63], v[56:59]
  s_nop 0
  ds_read_b128 a[108:111], v4 offset:3072
  v_mfma_f32_16x16x32_bf16 v[60:63], a[68:71], a[48:51], v[124:127]
  s_nop 0
  ds_read_b128 a[112:115], v4 offset:4096
  v_mfma_f32_16x16x32_bf16 v[60:63], a[76:79], a[52:55], v[60:63]
  s_nop 0
  ds_read_b128 a[116:119], v4 offset:5120
  v_mfma_f32_16x16x32_bf16 v[60:63], a[84:87], a[56:59], v[60:63]
  s_nop 0
  ds_read_b128 a[120:123], v4 offset:6144
  v_mfma_f32_16x16x32_bf16 v[60:63], a[92:95], a[60:63], v[60:63]
  s_nop 0
  ds_read_b128 a[124:127], v4 offset:7168
  v_mfma_f32_16x16x32_bf16 a[136:139], v[16:19], v[88:91], a[136:139]
  s_add_u32 m0, s73, 65536
  s_add_u32 s66, s72, 512
  buffer_load_dwordx4 v26, s[48:51], s66 offen lds
  v_mfma_f32_16x16x32_bf16 a[140:143], v[16:19], v[92:95], a[140:143]
  s_add_u32 m0, s73, 66560
  s_add_u32 s66, s72, 8704
  buffer_load_dwordx4 v26, s[48:51], s66 offen lds
  s_waitcnt lgkmcnt(0)
  v_mfma_f32_16x16x32_bf16 v[192:195], a[96:99], v[88:91], v[192:195]
  s_add_u32 m0, s73, 67584
  s_add_u32 s66, s72, 16896
  buffer_load_dwordx4 v26, s[48:51], s66 offen lds
  v_mfma_f32_16x16x32_bf16 v[224:227], a[96:99], v[92:95], v[224:227]
  s_add_u32 m0, s73, 68608
  s_add_u32 s66, s72, 25088
  buffer_load_dwordx4 v26, s[48:51], s66 offen lds
  v_mfma_f32_16x16x32_bf16 v[196:199], a[100:103], v[88:91], v[196:199]
  s_add_u32 s58, s58, 1
  ds_read_b128 a[64:67], v4 offset:8192
  v_mfma_f32_16x16x32_bf16 v[228:231], a[100:103], v[92:95], v[228:231]
  ds_read_b128 a[68:71], v4 offset:9216
  v_mfma_f32_16x16x32_bf16 v[200:203], a[104:107], v[88:91], v[200:203]
  ds_read_b128 a[72:75], v4 offset:10240
  v_mfma_f32_16x16x32_bf16 v[232:235], a[104:107], v[92:95], v[232:235]
  ds_read_b128 a[76:79], v4 offset:11264
  v_mfma_f32_16x16x32_bf16 v[204:207], a[108:111], v[88:91], v[204:207]
  ds_read_b128 a[80:83], v4 offset:12288
  v_mfma_f32_16x16x32_bf16 v[236:239], a[108:111], v[92:95], v[236:239]
  ds_read_b128 a[84:87], v4 offset:13312
  v_mfma_f32_16x16x32_bf16 v[208:211], a[112:115], v[88:91], v[208:211]
  ds_read_b128 a[88:91], v4 offset:14336
  v_mfma_f32_16x16x32_bf16 v[240:243], a[112:115], v[92:95], v[240:243]
  ds_read_b128 a[92:95], v4 offset:15360
  v_mfma_f32_16x16x32_bf16 v[212:215], a[116:119], v[88:91], v[212:215]
  v_exp_f32 v8, v56
  v_mfma_f32_16x16x32_bf16 v[244:247], a[116:119], v[92:95], v[244:247]
  v_exp_f32 v9, v57
  v_mfma_f32_16x16x32_bf16 v[216:219], a[120:123], v[88:91], v[216:219]
  v_exp_f32 v10, v58
  v_mfma_f32_16x16x32_bf16 v[248:251], a[120:123], v[92:95], v[248:251]
  v_exp_f32 v11, v59
  v_mfma_f32_16x16x32_bf16 v[220:223], a[124:127], v[88:91], v[220:223]
  v_cvt_pk_bf16_f32 v76, v8, v9
  v_cvt_pk_bf16_f32 v77, v10, v11
  v_mfma_f32_16x16x32_bf16 v[252:255], a[124:127], v[92:95], v[252:255]
  v_or_b32 v5, v76, v77
  v_exp_f32 v12, v60
  v_exp_f32 v13, v61
  v_exp_f32 v14, v62
  v_exp_f32 v15, v63
  s_nop 0
  v_cvt_pk_bf16_f32 v78, v12, v13
  v_cvt_pk_bf16_f32 v79, v14, v15
  v_or3_b32 v5, v5, v78, v79
  v_and_b32 v5, s70, v5
  v_cmp_ne_u32 vcc, 0, v5
  v_cmp_gt_i32 s[80:81], 32, v25
  v_cmp_gt_i32 s[82:83], 33, v25
  v_cmp_gt_i32 s[84:85], 34, v25
  v_cmp_gt_i32 s[86:87], 35, v25
  v_cndmask_b32 v120, v120, v24, s[80:81]
  v_cndmask_b32 v121, v121, v24, s[82:83]
  v_cndmask_b32 v122, v122, v24, s[84:85]
  v_cndmask_b32 v123, v123, v24, s[86:87]
  v_cmp_gt_i32 s[80:81], 48, v25
  v_cmp_gt_i32 s[82:83], 49, v25
  v_cmp_gt_i32 s[84:85], 50, v25
  v_cmp_gt_i32 s[86:87], 51, v25
  v_cndmask_b32 v124, v124, v24, s[80:81]
  v_cndmask_b32 v125, v125, v24, s[82:83]
  v_cndmask_b32 v126, v126, v24, s[84:85]
  v_cndmask_b32 v127, v127, v24, s[86:87]
  v_add_u32 v4, 0x4000, v4
  v_and_b32 v4, 0x1ffff, v4
  s_cbranch_vccnz L_a_d6_t
L_a_d6_r:
L_a_d7:
  s_waitcnt vmcnt(24) lgkmcnt(0)
  v_mfma_f32_16x16x32_bf16 v[56:59], a[64:67], a[48:51], v[120:123]
  s_barrier
  ds_read_b128 a[96:99], v4 offset:0
  v_mfma_f32_16x16x32_bf16 v[56:59], a[72:75], a[52:55], v[56:59]
  s_nop 0
  ds_read_b128 a[100:103], v4 offset:1024
  v_mfma_f32_16x16x32_bf16 v[56:59], a[80:83], a[56:59], v[56:59]
  s_nop 0
  ds_read_b128 a[104:107], v4 offset:2048
  v_mfma_f32_16x16x32_bf16 v[56:59], a[88:91], a[60:63], v[56:59]
  s_nop 0
  ds_read_b128 a[108:111], v4 offset:3072
  v_mfma_f32_16x16x32_bf16 v[60:63], a[68:71], a[48:51], v[124:127]
  s_nop 0
  ds_read_b128 a[112:115], v4 offset:4096
  v_mfma_f32_16x16x32_bf16 v[60:63], a[76:79], a[52:55], v[60:63]
  s_nop 0
  ds_read_b128 a[116:119], v4 offset:5120
  v_mfma_f32_16x16x32_bf16 v[60:63], a[84:87], a[56:59], v[60:63]
  s_nop 0
  ds_read_b128 a[120:123], v4 offset:6144
  v_mfma_f32_16x16x32_bf16 v[60:63], a[92:95], a[60:63], v[60:63]
  s_nop 0
  ds_read_b128 a[124:127], v4 offset:7168
  v_mfma_f32_16x16x32_bf16 a[140:143], v[16:19], v[76:79], a[140:143]
  s_add_u32 m0, s73, 81920
  s_add_u32 s66, s72, 640
  buffer_load_dwordx4 v26, s[48:51], s66 offen lds
  s_waitcnt lgkmcnt(0)
  v_mfma_f32_16x16x32_bf16 v[224:227], a[96:99], v[76:79], v[224:227]
  s_add_u32 m0, s73, 82944
  s_add_u32 s66, s72, 8832
  buffer_load_dwordx4 v26, s[48:51], s66 offen lds
  v_mfma_f32_16x16x32_bf16 v[228:231], a[100:103], v[76:79], v[228:231]
  s_add_u32 m0, s73, 83968
  s_add_u32 s66, s72, 17024
  buffer_load_dwordx4 v26, s[48:51], s66 offen lds
  v_mfma_f32_16x16x32_bf16 v[232:235], a[104:107], v[76:79], v[232:235]
  s_add_u32 m0, s73, 84992
  s_add_u32 s66, s72, 25216
  buffer_load_dwordx4 v26, s[48:51], s66 offen lds
  v_mfma_f32_16x16x32_bf16 v[236:239], a[108:111], v[76:79], v[236:239]
  s_add_u32 s58, s58, 1
  v_exp_f32 v8, v56
  v_mfma_f32_16x16x32_bf16 v[240:243], a[112:115], v[76:79], v[240:243]
  v_exp_f32 v9, v57
  v_mfma_f32_16x16x32_bf16 v[244:247], a[116:119], v[76:79], v[244:247]
  v_exp_f32 v10, v58
  v_mfma_f32_16x16x32_bf16 v[248:251], a[120:123], v[76:79], v[248:251]
  v_exp_f32 v11, v59
  v_mfma_f32_16x16x32_bf16 v[252:255], a[124:127], v[76:79], v[252:255]
  v_cvt_pk_bf16_f32 v92, v8, v9
  v_cvt_pk_bf16_f32 v93, v10, v11
  v_or_b32 v5, v92, v93
  v_exp_f32 v12, v60
  v_exp_f32 v13, v61
  v_exp_f32 v14, v62
  v_exp_f32 v15, v63
  s_nop 0
  v_cvt_pk_bf16_f32 v94, v12, v13
  v_cvt_pk_bf16_f32 v95, v14, v15
  v_or3_b32 v5, v5, v94, v95
  v_and_b32 v5, s70, v5
  v_cmp_ne_u32 vcc, 0, v5
  v_add_u32 v4, 0x4000, v4
  v_and_b32 v4, 0x1ffff, v4
  s_cbranch_vccnz L_a_d7_t
L_a_d7_r:
  s_waitcnt vmcnt(24)
  s_barrier
  ds_read_b128 a[96:99], v4 offset:0
  ds_read_b128 a[100:103], v4 offset:1024
  ds_read_b128 a[104:107], v4 offset:2048
  ds_read_b128 a[108:111], v4 offset:3072
  ds_read_b128 a[112:115], v4 offset:4096
  ds_read_b128 a[116:119], v4 offset:5120
  ds_read_b128 a[120:123], v4 offset:6144
  ds_read_b128 a[124:127], v4 offset:7168
  s_add_u32 m0, s73, 98304
  s_add_u32 s66, s72, 768
  buffer_load_dwordx4 v26, s[48:51], s66 offen lds
  s_add_u32 m0, s73, 99328
  s_add_u32 s66, s72, 8960
  buffer_load_dwordx4 v26, s[48:51], s66 offen lds
  s_add_u32 m0, s73, 100352
  s_add_u32 s66, s72, 17152
  buffer_load_dwordx4 v26, s[48:51], s66 offen lds
  s_add_u32 m0, s73, 101376
  s_add_u32 s66, s72, 25344
  buffer_load_dwordx4 v26, s[48:51], s66 offen lds
  v_mfma_f32_16x16x32_bf16 a[140:143], v[16:19], v[92:95], a[140:143]
  s_waitcnt lgkmcnt(7)
  v_mfma_f32_16x16x32_bf16 v[224:227], a[96:99], v[92:95], v[224:227]
  s_waitcnt lgkmcnt(6)
  v_mfma_f32_16x16x32_bf16 v[228:231], a[100:103], v[92:95], v[228:231]
  s_waitcnt lgkmcnt(5)
  v_mfma_f32_16x16x32_bf16 v[232:235], a[104:107], v[92:95], v[232:235]
  s_waitcnt lgkmcnt(4)
  v_mfma_f32_16x16x32_bf16 v[236:239], a[108:111], v[92:95], v[236:239]
  s_waitcnt lgkmcnt(3)
  v_mfma_f32_16x16x32_bf16 v[240:243], a[112:115], v[92:95], v[240:243]
  s_waitcnt lgkmcnt(2)
  v_mfma_f32_16x16x32_bf16 v[244:247], a[116:119], v[92:95], v[244:247]
  s_waitcnt lgkmcnt(1)
  v_mfma_f32_16x16x32_bf16 v[248:251], a[120:123], v[92:95], v[248:251]
  s_waitcnt lgkmcnt(0)
  v_mfma_f32_16x16x32_bf16 v[252:255], a[124:127], v[92:95], v[252:255]
  s_barrier
  s_add_u32 m0, s73, 114688
  s_add_u32 s66, s72, 896
  buffer_load_dwordx4 v26, s[48:51], s66 offen lds
  s_add_u32 m0, s73, 115712
  s_add_u32 s66, s72, 9088
  buffer_load_dwordx4 v26, s[48:51], s66 offen lds
  s_add_u32 m0, s73, 116736
  s_add_u32 s66, s72, 17280
  buffer_load_dwordx4 v26, s[48:51], s66 offen lds
  s_add_u32 m0, s73, 117760
  s_add_u32 s66, s72, 25472
  buffer_load_dwordx4 v26, s[48:51], s66 offen lds
  v_accvgpr_read_b32 v6, a128
  v_rcp_f32 v6, v6
  s_nop 0
  v_mul_f32 v20, v20, v6
  v_accvgpr_read_b32 v6, a132
  v_rcp_f32 v6, v6
  s_nop 0
  v_mul_f32 v21, v21, v6
  v_accvgpr_read_b32 v6, a136
  v_rcp_f32 v6, v6
  s_nop 0
  v_mul_f32 v22, v22, v6
  v_accvgpr_read_b32 v6, a140
  v_rcp_f32 v6, v6
  s_nop 0
  v_mul_f32 v23, v23, v6
  v_mul_f32 v128, v128, v20
  v_mul_f32 v129, v129, v20
  v_mul_f32 v130, v130, v20
  v_mul_f32 v131, v131, v20
  v_mul_f32 v132, v132, v20
  v_mul_f32 v133, v133, v20
  v_mul_f32 v134, v134, v20
  v_mul_f32 v135, v135, v20
  v_cvt_pk_bf16_f32 v32, v128, v129
  v_cvt_pk_bf16_f32 v33, v130, v131
  v_cvt_pk_bf16_f32 v34, v132, v133
  v_cvt_pk_bf16_f32 v35, v134, v135
  v_mul_f32 v136, v136, v20
  v_mul_f32 v137, v137, v20
  v_mul_f32 v138, v138, v20
  v_mul_f32 v139, v139, v20
  v_mul_f32 v140, v140, v20
  v_mul_f32 v141, v141, v20
  v_mul_f32 v142, v142, v20
  v_mul_f32 v143, v143, v20
  v_cvt_pk_bf16_f32 v36, v136, v137
  v_cvt_pk_bf16_f32 v37, v138, v139
  v_cvt_pk_bf16_f32 v38, v140, v141
  v_cvt_pk_bf16_f32 v39, v142, v143
  v_mul_f32 v144, v144, v20
  v_mul_f32 v145, v145, v20
  v_mul_f32 v146, v146, v20
  v_mul_f32 v147, v147, v20
  v_mul_f32 v148, v148, v20
  v_mul_f32 v149, v149, v20
  v_mul_f32 v150, v150, v20
  v_mul_f32 v151, v151, v20
  v_cvt_pk_bf16_f32 v40, v144, v145
  v_cvt_pk_bf16_f32 v41, v146, v147
  v_cvt_pk_bf16_f32 v42, v148, v149
  v_cvt_pk_bf16_f32 v43, v150, v151
  v_mul_f32 v152, v152, v20
  v_mul_f32 v153, v153, v20
  v_mul_f32 v154, v154, v20
  v_mul_f32 v155, v155, v20
  v_mul_f32 v156, v156, v20
  v_mul_f32 v157, v157, v20
  v_mul_f32 v158, v158, v20
  v_mul_f32 v159, v159, v20
  v_cvt_pk_bf16_f32 v44, v152, v153
  v_cvt_pk_bf16_f32 v45, v154, v155
  v_cvt_pk_bf16_f32 v46, v156, v157
  v_cvt_pk_bf16_f32 v47, v158, v159
  v_mul_f32 v160, v160, v21
  v_mul_f32 v161, v161, v21
  v_mul_f32 v162, v162, v21
  v_mul_f32 v163, v163, v21
  v_mul_f32 v164, v164, v21
  v_mul_f32 v165, v165, v21
  v_mul_f32 v166, v166, v21
  v_mul_f32 v167, v167, v21
  v_cvt_pk_bf16_f32 v48, v160, v161
  v_cvt_pk_bf16_f32 v49, v162, v163
  v_cvt_pk_bf16_f32 v50, v164, v165
  v_cvt_pk_bf16_f32 v51, v166, v167
  v_mul_f32 v168, v168, v21
  v_mul_f32 v169, v169, v21
  v_mul_f32 v170, v170, v21
  v_mul_f32 v171, v171, v21
  v_mul_f32 v172, v172, v21
  v_mul_f32 v173, v173, v21
  v_mul_f32 v174, v174, v21
  v_mul_f32 v175, v175, v21
  v_cvt_pk_bf16_f32 v52, v168, v169
  v_cvt_pk_bf16_f32 v53, v170, v171
  v_cvt_pk_bf16_f32 v54, v172, v173
  v_cvt_pk_bf16_f32 v55, v174, v175
  v_mul_f32 v176, v176, v21
  v_mul_f32 v177, v177, v21
  v_mul_f32 v178, v178, v21
  v_mul_f32 v179, v179, v21
  v_mul_f32 v180, v180, v21
  v_mul_f32 v181, v181, v21
  v_mul_f32 v182, v182, v21
  v_mul_f32 v183, v183, v21
  v_cvt_pk_bf16_f32 v56, v176, v177
  v_cvt_pk_bf16_f32 v57, v178, v179
  v_cvt_pk_bf16_f32 v58, v180, v181
  v_cvt_pk_bf16_f32 v59, v182, v183
  v_mul_f32 v184, v184, v21
  v_mul_f32 v185, v185, v21
  v_mul_f32 v186, v186, v21
  v_mul_f32 v187, v187, v21
  v_mul_f32 v188, v188, v21
  v_mul_f32 v189, v189, v21
  v_mul_f32 v190, v190, v21
  v_mul_f32 v191, v191, v21
  v_cvt_pk_bf16_f32 v60, v184, v185
  v_cvt_pk_bf16_f32 v61, v186, v187
  v_cvt_pk_bf16_f32 v62, v188, v189
  v_cvt_pk_bf16_f32 v63, v190, v191
  v_mul_f32 v192, v192, v22
  v_mul_f32 v193, v193, v22
  v_mul_f32 v194, v194, v22
  v_mul_f32 v195, v195, v22
  v_mul_f32 v196, v196, v22
  v_mul_f32 v197, v197, v22
  v_mul_f32 v198, v198, v22
  v_mul_f32 v199, v199, v22
  v_cvt_pk_bf16_f32 v64, v192, v193
  v_cvt_pk_bf16_f32 v65, v194, v195
  v_cvt_pk_bf16_f32 v66, v196, v197
  v_cvt_pk_bf16_f32 v67, v198, v199
  v_mul_f32 v200, v200, v22
  v_mul_f32 v201, v201, v22
  v_mul_f32 v202, v202, v22
  v_mul_f32 v203, v203, v22
  v_mul_f32 v204, v204, v22
  v_mul_f32 v205, v205, v22
  v_mul_f32 v206, v206, v22
  v_mul_f32 v207, v207, v22
  v_cvt_pk_bf16_f32 v68, v200, v201
  v_cvt_pk_bf16_f32 v69, v202, v203
  v_cvt_pk_bf16_f32 v70, v204, v205
  v_cvt_pk_bf16_f32 v71, v206, v207
  v_mul_f32 v208, v208, v22
  v_mul_f32 v209, v209, v22
  v_mul_f32 v210, v210, v22
  v_mul_f32 v211, v211, v22
  v_mul_f32 v212, v212, v22
  v_mul_f32 v213, v213, v22
  v_mul_f32 v214, v214, v22
  v_mul_f32 v215, v215, v22
  v_cvt_pk_bf16_f32 v72, v208, v209
  v_cvt_pk_bf16_f32 v73, v210, v211
  v_cvt_pk_bf16_f32 v74, v212, v213
  v_cvt_pk_bf16_f32 v75, v214, v215
  v_mul_f32 v216, v216, v22
  v_mul_f32 v217, v217, v22
  v_mul_f32 v218, v218, v22
  v_mul_f32 v219, v219, v22
  v_mul_f32 v220, v220, v22
  v_mul_f32 v221, v221, v22
  v_mul_f32 v222, v222, v22
  v_mul_f32 v223, v223, v22
  v_cvt_pk_bf16_f32 v76, v216, v217
  v_cvt_pk_bf16_f32 v77, v218, v219
  v_cvt_pk_bf16_f32 v78, v220, v221
  v_cvt_pk_bf16_f32 v79, v222, v223
  v_mul_f32 v224, v224, v23
  v_mul_f32 v225, v225, v23
  v_mul_f32 v226, v226, v23
  v_mul_f32 v227, v227, v23
  v_mul_f32 v228, v228, v23
  v_mul_f32 v229, v229, v23
  v_mul_f32 v230, v230, v23
  v_mul_f32 v231, v231, v23
  v_cvt_pk_bf16_f32 v80, v224, v225
  v_cvt_pk_bf16_f32 v81, v226, v227
  v_cvt_pk_bf16_f32 v82, v228, v229
  v_cvt_pk_bf16_f32 v83, v230, v231
  v_mul_f32 v232, v232, v23
  v_mul_f32 v233, v233, v23
  v_mul_f32 v234, v234, v23
  v_mul_f32 v235, v235, v23
  v_mul_f32 v236, v236, v23
  v_mul_f32 v237, v237, v23
  v_mul_f32 v238, v238, v23
  v_mul_f32 v239, v239, v23
  v_cvt_pk_bf16_f32 v84, v232, v233
  v_cvt_pk_bf16_f32 v85, v234, v235
  v_cvt_pk_bf16_f32 v86, v236, v237
  v_cvt_pk_bf16_f32 v87, v238, v239
  v_mul_f32 v240, v240, v23
  v_mul_f32 v241, v241, v23
  v_mul_f32 v242, v242, v23
  v_mul_f32 v243, v243, v23
  v_mul_f32 v244, v244, v23
  v_mul_f32 v245, v245, v23
  v_mul_f32 v246, v246, v23
  v_mul_f32 v247, v247, v23
  v_cvt_pk_bf16_f32 v88, v240, v241
  v_cvt_pk_bf16_f32 v89, v242, v243
  v_cvt_pk_bf16_f32 v90, v244, v245
  v_cvt_pk_bf16_f32 v91, v246, v247
  v_mul_f32 v248, v248, v23
  v_mul_f32 v249, v249, v23
  v_mul_f32 v250, v250, v23
  v_mul_f32 v251, v251, v23
  v_mul_f32 v252, v252, v23
  v_mul_f32 v253, v253, v23
  v_mul_f32 v254, v254, v23
  v_mul_f32 v255, v255, v23
  v_cvt_pk_bf16_f32 v92, v248, v249
  v_cvt_pk_bf16_f32 v93, v250, v251
  v_cvt_pk_bf16_f32 v94, v252, v253
  v_cvt_pk_bf16_f32 v95, v254, v255
  v_lshrrev_b32 v6, 2, v0
  v_lshlrev_b32 v8, 7, v6
  v_bfe_u32 v6, v0, 3, 2
  v_lshl_add_u32 v8, v6, 5, v8
  v_and_b32 v6, 3, v0
  v_lshl_add_u32 v8, v6, 3, v8
  v_xor_b32 v9, 32, v8
  v_xor_b32 v10, 64, v8
  v_xor_b32 v11, 96, v8
  v_add_u32 v12, 0x10000, v8
  v_add_u32 v13, 0x10000, v9
  v_add_u32 v14, 0x10000, v10
  v_add_u32 v15, 0x10000, v11
  s_waitcnt vmcnt(4)
  s_barrier
  ds_read_b64_tr_b16 a[64:65], v8 offset:0
  ds_read_b64_tr_b16 a[66:67], v8 offset:2048
  ds_read_b64_tr_b16 a[68:69], v8 offset:4096
  ds_read_b64_tr_b16 a[70:71], v8 offset:6144
  ds_read_b64_tr_b16 a[72:73], v8 offset:8192
  ds_read_b64_tr_b16 a[74:75], v8 offset:10240
  ds_read_b64_tr_b16 a[76:77], v8 offset:12288
  ds_read_b64_tr_b16 a[78:79], v8 offset:14336
  ds_read_b64_tr_b16 a[80:81], v9 offset:0
  ds_read_b64_tr_b16 a[82:83], v9 offset:2048
  ds_read_b64_tr_b16 a[84:85], v9 offset:4096
  ds_read_b64_tr_b16 a[86:87], v9 offset:6144
  ds_read_b64_tr_b16 a[88:89], v9 offset:8192
  ds_read_b64_tr_b16 a[90:91], v9 offset:10240
  ds_read_b64_tr_b16 a[92:93], v9 offset:12288
  ds_read_b64_tr_b16 a[94:95], v9 offset:14336
  s_waitcnt lgkmcnt(8)
  v_mfma_f32_16x16x32_bf16 v[128:131], a[64:67], v[32:35], 0
  ds_read_b64_tr_b16 a[96:97], v10 offset:0
  v_mfma_f32_16x16x32_bf16 v[128:131], a[68:71], v[36:39], v[128:131]
  v_mfma_f32_16x16x32_bf16 v[128:131], a[72:75], v[40:43], v[128:131]
  ds_read_b64_tr_b16 a[98:99], v10 offset:2048
  v_mfma_f32_16x16x32_bf16 v[128:131], a[76:79], v[44:47], v[128:131]
  v_mfma_f32_16x16x32_bf16 v[136:139], a[64:67], v[48:51], 0
  ds_read_b64_tr_b16 a[100:101], v10 offset:4096
  v_mfma_f32_16x16x32_bf16 v[136:139], a[68:71], v[52:55], v[136:139]
  v_mfma_f32_16x16x32_bf16 v[136:139], a[72:75], v[56:59], v[136:139]
  ds_read_b64_tr_b16 a[102:103], v10 offset:6144
  v_mfma_f32_16x16x32_bf16 v[136:139], a[76:79], v[60:63], v[136:139]
  v_mfma_f32_16x16x32_bf16 v[144:147], a[64:67], v[64:67], 0
  ds_read_b64_tr_b16 a[104:105], v10 offset:8192
  v_mfma_f32_16x16x32_bf16 v[144:147], a[68:71], v[68:71], v[144:147]
  v_mfma_f32_16x16x32_bf16 v[144:147], a[72:75], v[72:75], v[144:147]
  ds_read_b64_tr_b16 a[106:107], v10 offset:10240
  v_mfma_f32_16x16x32_bf16 v[144:147], a[76:79], v[76:79], v[144:147]
  v_mfma_f32_16x16x32_bf16 v[152:155], a[64:67], v[80:83], 0
  ds_read_b64_tr_b16 a[108:109], v10 offset:12288
  v_mfma_f32_16x16x32_bf16 v[152:155], a[68:71], v[84:87], v[152:155]
  v_mfma_f32_16x16x32_bf16 v[152:155], a[72:75], v[88:91], v[152:155]
  ds_read_b64_tr_b16 a[110:111], v10 offset:14336
  v_mfma_f32_16x16x32_bf16 v[152:155], a[76:79], v[92:95], v[152:155]
  s_waitcnt lgkmcnt(8)
  v_mfma_f32_16x16x32_bf16 v[132:135], a[80:83], v[32:35], 0
  ds_read_b64_tr_b16 a[112:113], v11 offset:0
  v_mfma_f32_16x16x32_bf16 v[132:135], a[84:87], v[36:39], v[132:135]
  v_mfma_f32_16x16x32_bf16 v[132:135], a[88:91], v[40:43], v[132:135]
  ds_read_b64_tr_b16 a[114:115], v11 offset:2048
  v_mfma_f32_16x16x32_bf16 v[132:135], a[92:95], v[44:47], v[132:135]
  v_mfma_f32_16x16x32_bf16 v[140:143], a[80:83], v[48:51], 0
  ds_read_b64_tr_b16 a[116:117], v11 offset:4096
  v_mfma_f32_16x16x32_bf16 v[140:143], a[84:87], v[52:55], v[140:143]
  v_mfma_f32_16x16x32_bf16 v[140:143], a[88:91], v[56:59], v[140:143]
  ds_read_b64_tr_b16 a[118:119], v11 offset:6144
  v_mfma_f32_16x16x32_bf16 v[140:143], a[92:95], v[60:63], v[140:143]
  v_mfma_f32_16x16x32_bf16 v[148:151], a[80:83], v[64:67], 0
  ds_read_b64_tr_b16 a[120:121], v11 offset:8192
  v_mfma_f32_16x16x32_bf16 v[148:151], a[84:87], v[68:71], v[148:151]
  v_mfma_f32_16x16x32_bf16 v[148:151], a[88:91], v[72:75], v[148:151]
  ds_read_b64_tr_b16 a[122:123], v11 offset:10240
  v_mfma_f32_16x16x32_bf16 v[148:151], a[92:95], v[76:79], v[148:151]
  v_mfma_f32_16x16x32_bf16 v[156:159], a[80:83], v[80:83], 0
  ds_read_b64_tr_b16 a[124:125], v11 offset:12288
  v_mfma_f32_16x16x32_bf16 v[156:159], a[84:87], v[84:87], v[156:159]
  v_mfma_f32_16x16x32_bf16 v[156:159], a[88:91], v[88:91], v[156:159]
  ds_read_b64_tr_b16 a[126:127], v11 offset:14336
  v_mfma_f32_16x16x32_bf16 v[156:159], a[92:95], v[92:95], v[156:159]
  s_waitcnt lgkmcnt(8)
  v_mfma_f32_16x16x32_bf16 v[160:163], a[96:99], v[32:35], 0
  ds_read_b64_tr_b16 a[64:65], v8 offset:16384
  v_mfma_f32_16x16x32_bf16 v[160:163], a[100:103], v[36:39], v[160:163]
  s_nop 1
  v_mfma_f32_16x16x32_bf16 v[160:163], a[104:107], v[40:43], v[160:163]
  ds_read_b64_tr_b16 a[66:67], v8 offset:18432
  v_mfma_f32_16x16x32_bf16 v[160:163], a[108:111], v[44:47], v[160:163]
  v_cvt_pk_bf16_f32 v96, v128, v129
  v_cvt_pk_bf16_f32 v97, v130, v131
  v_mfma_f32_16x16x32_bf16 v[168:171], a[96:99], v[48:51], 0
  ds_read_b64_tr_b16 a[68:69], v8 offset:20480
  v_mfma_f32_16x16x32_bf16 v[168:171], a[100:103], v[52:55], v[168:171]
  v_cvt_pk_bf16_f32 v98, v132, v133
  v_cvt_pk_bf16_f32 v99, v134, v135
  v_mfma_f32_16x16x32_bf16 v[168:171], a[104:107], v[56:59], v[168:171]
  ds_read_b64_tr_b16 a[70:71], v8 offset:22528
  v_mfma_f32_16x16x32_bf16 v[168:171], a[108:111], v[60:63], v[168:171]
  buffer_store_dwordx4 v[96:99], v2, s[40:43], s76 offen offset:0 sc1
  v_mfma_f32_16x16x32_bf16 v[176:179], a[96:99], v[64:67], 0
  ds_read_b64_tr_b16 a[72:73], v8 offset:24576
  v_mfma_f32_16x16x32_bf16 v[176:179], a[100:103], v[68:71], v[176:179]
  v_cvt_pk_bf16_f32 v100, v136, v137
  v_cvt_pk_bf16_f32 v101, v138, v139
  v_mfma_f32_16x16x32_bf16 v[176:179], a[104:107], v[72:75], v[176:179]
  ds_read_b64_tr_b16 a[74:75], v8 offset:26624
  v_mfma_f32_16x16x32_bf16 v[176:179], a[108:111], v[76:79], v[176:179]
  v_cvt_pk_bf16_f32 v102, v140, v141
  v_cvt_pk_bf16_f32 v103, v142, v143
  v_mfma_f32_16x16x32_bf16 v[184:187], a[96:99], v[80:83], 0
  ds_read_b64_tr_b16 a[76:77], v8 offset:28672
  v_mfma_f32_16x16x32_bf16 v[184:187], a[100:103], v[84:87], v[184:187]
  buffer_store_dwordx4 v[100:103], v2, s[40:43], s77 offen offset:0 sc1
  v_mfma_f32_16x16x32_bf16 v[184:187], a[104:107], v[88:91], v[184:187]
  ds_read_b64_tr_b16 a[78:79], v8 offset:30720
  v_mfma_f32_16x16x32_bf16 v[184:187], a[108:111], v[92:95], v[184:187]
  s_waitcnt lgkmcnt(8)
  v_cvt_pk_bf16_f32 v104, v144, v145
  v_cvt_pk_bf16_f32 v105, v146, v147
  v_mfma_f32_16x16x32_bf16 v[164:167], a[112:115], v[32:35], 0
  ds_read_b64_tr_b16 a[80:81], v9 offset:16384
  v_mfma_f32_16x16x32_bf16 v[164:167], a[116:119], v[36:39], v[164:167]
  v_cvt_pk_bf16_f32 v106, v148, v149
  v_cvt_pk_bf16_f32 v107, v150, v151
  v_mfma_f32_16x16x32_bf16 v[164:167], a[120:123], v[40:43], v[164:167]
  ds_read_b64_tr_b16 a[82:83], v9 offset:18432
  v_mfma_f32_16x16x32_bf16 v[164:167], a[124:127], v[44:47], v[164:167]
  buffer_store_dwordx4 v[104:107], v2, s[40:43], s78 offen offset:0 sc1
  v_mfma_f32_16x16x32_bf16 v[172:175], a[112:115], v[48:51], 0
  ds_read_b64_tr_b16 a[84:85], v9 offset:20480
  v_mfma_f32_16x16x32_bf16 v[172:175], a[116:119], v[52:55], v[172:175]
  v_cvt_pk_bf16_f32 v108, v152, v153
  v_cvt_pk_bf16_f32 v109, v154, v155
  v_mfma_f32_16x16x32_bf16 v[172:175], a[120:123], v[56:59], v[172:175]
  ds_read_b64_tr_b16 a[86:87], v9 offset:22528
  v_mfma_f32_16x16x32_bf16 v[172:175], a[124:127], v[60:63], v[172:175]
  v_cvt_pk_bf16_f32 v110, v156, v157
  v_cvt_pk_bf16_f32 v111, v158, v159
  v_mfma_f32_16x16x32_bf16 v[180:183], a[112:115], v[64:67], 0
  ds_read_b64_tr_b16 a[88:89], v9 offset:24576
  v_mfma_f32_16x16x32_bf16 v[180:183], a[116:119], v[68:71], v[180:183]
  buffer_store_dwordx4 v[108:111], v2, s[40:43], s79 offen offset:0 sc1
  v_mfma_f32_16x16x32_bf16 v[180:183], a[120:123], v[72:75], v[180:183]
  ds_read_b64_tr_b16 a[90:91], v9 offset:26624
  v_mfma_f32_16x16x32_bf16 v[180:183], a[124:127], v[76:79], v[180:183]
  v_mfma_f32_16x16x32_bf16 v[188:191], a[112:115], v[80:83], 0
  ds_read_b64_tr_b16 a[92:93], v9 offset:28672
  v_mfma_f32_16x16x32_bf16 v[188:191], a[116:119], v[84:87], v[188:191]
  v_mfma_f32_16x16x32_bf16 v[188:191], a[120:123], v[88:91], v[188:191]
  ds_read_b64_tr_b16 a[94:95], v9 offset:30720
  v_mfma_f32_16x16x32_bf16 v[188:191], a[124:127], v[92:95], v[188:191]
  s_waitcnt lgkmcnt(8)
  v_mfma_f32_16x16x32_bf16 v[128:131], a[64:67], v[32:35], 0
  ds_read_b64_tr_b16 a[96:97], v10 offset:16384
  v_mfma_f32_16x16x32_bf16 v[128:131], a[68:71], v[36:39], v[128:131]
  s_nop 1
  v_mfma_f32_16x16x32_bf16 v[128:131], a[72:75], v[40:43], v[128:131]
  ds_read_b64_tr_b16 a[98:99], v10 offset:18432
  v_mfma_f32_16x16x32_bf16 v[128:131], a[76:79], v[44:47], v[128:131]
  v_cvt_pk_bf16_f32 v112, v160, v161
  v_cvt_pk_bf16_f32 v113, v162, v163
  v_mfma_f32_16x16x32_bf16 v[136:139], a[64:67], v[48:51], 0
  ds_read_b64_tr_b16 a[100:101], v10 offset:20480
  v_mfma_f32_16x16x32_bf16 v[136:139], a[68:71], v[52:55], v[136:139]
  v_cvt_pk_bf16_f32 v114, v164, v165
  v_cvt_pk_bf16_f32 v115, v166, v167
  v_mfma_f32_16x16x32_bf16 v[136:139], a[72:75], v[56:59], v[136:139]
  ds_read_b64_tr_b16 a[102:103], v10 offset:22528
  v_mfma_f32_16x16x32_bf16 v[136:139], a[76:79], v[60:63], v[136:139]
  buffer_store_dwordx4 v[112:115], v2, s[40:43], s76 offen offset:1024 sc1
  v_mfma_f32_16x16x32_bf16 v[144:147], a[64:67], v[64:67], 0
  ds_read_b64_tr_b16 a[104:105], v10 offset:24576
  v_mfma_f32_16x16x32_bf16 v[144:147], a[68:71], v[68:71], v[144:147]
  v_cvt_pk_bf16_f32 v116, v168, v169
  v_cvt_pk_bf16_f32 v117, v170, v171
  v_mfma_f32_16x16x32_bf16 v[144:147], a[72:75], v[72:75], v[144:147]
  ds_read_b64_tr_b16 a[106:107], v10 offset:26624
  v_mfma_f32_16x16x32_bf16 v[144:147], a[76:79], v[76:79], v[144:147]
  v_cvt_pk_bf16_f32 v118, v172, v173
  v_cvt_pk_bf16_f32 v119, v174, v175
  v_mfma_f32_16x16x32_bf16 v[152:155], a[64:67], v[80:83], 0
  ds_read_b64_tr_b16 a[108:109], v10 offset:28672
  v_mfma_f32_16x16x32_bf16 v[152:155], a[68:71], v[84:87], v[152:155]
  buffer_store_dwordx4 v[116:119], v2, s[40:43], s77 offen offset:1024 sc1
  v_mfma_f32_16x16x32_bf16 v[152:155], a[72:75], v[88:91], v[152:155]
  ds_read_b64_tr_b16 a[110:111], v10 offset:30720
  v_mfma_f32_16x16x32_bf16 v[152:155], a[76:79], v[92:95], v[152:155]
  s_waitcnt lgkmcnt(8)
  v_cvt_pk_bf16_f32 v120, v176, v177
  v_cvt_pk_bf16_f32 v121, v178, v179
  v_mfma_f32_16x16x32_bf16 v[132:135], a[80:83], v[32:35], 0
  ds_read_b64_tr_b16 a[112:113], v11 offset:16384
  v_mfma_f32_16x16x32_bf16 v[132:135], a[84:87], v[36:39], v[132:135]
  v_cvt_pk_bf16_f32 v122, v180, v181
  v_cvt_pk_bf16_f32 v123, v182, v183
  v_mfma_f32_16x16x32_bf16 v[132:135], a[88:91], v[40:43], v[132:135]
  ds_read_b64_tr_b16 a[114:115], v11 offset:18432
  v_mfma_f32_16x16x32_bf16 v[132:135], a[92:95], v[44:47], v[132:135]
  buffer_store_dwordx4 v[120:123], v2, s[40:43], s78 offen offset:1024 sc1
  v_mfma_f32_16x16x32_bf16 v[140:143], a[80:83], v[48:51], 0
  ds_read_b64_tr_b16 a[116:117], v11 offset:20480
  v_mfma_f32_16x16x32_bf16 v[140:143], a[84:87], v[52:55], v[140:143]
  v_cvt_pk_bf16_f32 v124, v184, v185
  v_cvt_pk_bf16_f32 v125, v186, v187
  v_mfma_f32_16x16x32_bf16 v[140:143], a[88:91], v[56:59], v[140:143]
  ds_read_b64_tr_b16 a[118:119], v11 offset:22528
  v_mfma_f32_16x16x32_bf16 v[140:143], a[92:95], v[60:63], v[140:143]
  v_cvt_pk_bf16_f32 v126, v188, v189
  v_cvt_pk_bf16_f32 v127, v190, v191
  v_mfma_f32_16x16x32_bf16 v[148:151], a[80:83], v[64:67], 0
  ds_read_b64_tr_b16 a[120:121], v11 offset:24576
  v_mfma_f32_16x16x32_bf16 v[148:151], a[84:87], v[68:71], v[148:151]
  buffer_store_dwordx4 v[124:127], v2, s[40:43], s79 offen offset:1024 sc1
  v_mfma_f32_16x16x32_bf16 v[148:151], a[88:91], v[72:75], v[148:151]
  ds_read_b64_tr_b16 a[122:123], v11 offset:26624
  v_mfma_f32_16x16x32_bf16 v[148:151], a[92:95], v[76:79], v[148:151]
  v_mfma_f32_16x16x32_bf16 v[156:159], a[80:83], v[80:83], 0
  ds_read_b64_tr_b16 a[124:125], v11 offset:28672
  v_mfma_f32_16x16x32_bf16 v[156:159], a[84:87], v[84:87], v[156:159]
  v_mfma_f32_16x16x32_bf16 v[156:159], a[88:91], v[88:91], v[156:159]
  ds_read_b64_tr_b16 a[126:127], v11 offset:30720
  v_mfma_f32_16x16x32_bf16 v[156:159], a[92:95], v[92:95], v[156:159]
  s_waitcnt lgkmcnt(8)
  v_mfma_f32_16x16x32_bf16 v[160:163], a[96:99], v[32:35], 0
  ds_read_b64_tr_b16 a[64:65], v8 offset:32768
  v_mfma_f32_16x16x32_bf16 v[160:163], a[100:103], v[36:39], v[160:163]
  s_nop 1
  v_mfma_f32_16x16x32_bf16 v[160:163], a[104:107], v[40:43], v[160:163]
  ds_read_b64_tr_b16 a[66:67], v8 offset:34816
  v_mfma_f32_16x16x32_bf16 v[160:163], a[108:111], v[44:47], v[160:163]
  v_cvt_pk_bf16_f32 v96, v128, v129
  v_cvt_pk_bf16_f32 v97, v130, v131
  v_mfma_f32_16x16x32_bf16 v[168:171], a[96:99], v[48:51], 0
  ds_read_b64_tr_b16 a[68:69], v8 offset:36864
  v_mfma_f32_16x16x32_bf16 v[168:171], a[100:103], v[52:55], v[168:171]
  v_cvt_pk_bf16_f32 v98, v132, v133
  v_cvt_pk_bf16_f32 v99, v134, v135
  v_mfma_f32_16x16x32_bf16 v[168:171], a[104:107], v[56:59], v[168:171]
  ds_read_b64_tr_b16 a[70:71], v8 offset:38912
  v_mfma_f32_16x16x32_bf16 v[168:171], a[108:111], v[60:63], v[168:171]
  buffer_store_dwordx4 v[96:99], v2, s[40:43], s76 offen offset:2048 sc1
  v_mfma_f32_16x16x32_bf16 v[176:179], a[96:99], v[64:67], 0
  ds_read_b64_tr_b16 a[72:73], v8 offset:40960
  v_mfma_f32_16x16x32_bf16 v[176:179], a[100:103], v[68:71], v[176:179]
  v_cvt_pk_bf16_f32 v100, v136, v137
  v_cvt_pk_bf16_f32 v101, v138, v139
  v_mfma_f32_16x16x32_bf16 v[176:179], a[104:107], v[72:75], v[176:179]
  ds_read_b64_tr_b16 a[74:75], v8 offset:43008
  v_mfma_f32_16x16x32_bf16 v[176:179], a[108:111], v[76:79], v[176:179]
  v_cvt_pk_bf16_f32 v102, v140, v141
  v_cvt_pk_bf16_f32 v103, v142, v143
  v_mfma_f32_16x16x32_bf16 v[184:187], a[96:99], v[80:83], 0
  ds_read_b64_tr_b16 a[76:77], v8 offset:45056
  v_mfma_f32_16x16x32_bf16 v[184:187], a[100:103], v[84:87], v[184:187]
  buffer_store_dwordx4 v[100:103], v2, s[40:43], s77 offen offset:2048 sc1
  v_mfma_f32_16x16x32_bf16 v[184:187], a[104:107], v[88:91], v[184:187]
  ds_read_b64_tr_b16 a[78:79], v8 offset:47104
  v_mfma_f32_16x16x32_bf16 v[184:187], a[108:111], v[92:95], v[184:187]
  s_waitcnt lgkmcnt(8)
  v_cvt_pk_bf16_f32 v104, v144, v145
  v_cvt_pk_bf16_f32 v105, v146, v147
  v_mfma_f32_16x16x32_bf16 v[164:167], a[112:115], v[32:35], 0
  ds_read_b64_tr_b16 a[80:81], v9 offset:32768
  v_mfma_f32_16x16x32_bf16 v[164:167], a[116:119], v[36:39], v[164:167]
  v_cvt_pk_bf16_f32 v106, v148, v149
  v_cvt_pk_bf16_f32 v107, v150, v151
  v_mfma_f32_16x16x32_bf16 v[164:167], a[120:123], v[40:43], v[164:167]
  ds_read_b64_tr_b16 a[82:83], v9 offset:34816
  v_mfma_f32_16x16x32_bf16 v[164:167], a[124:127], v[44:47], v[164:167]
  buffer_store_dwordx4 v[104:107], v2, s[40:43], s78 offen offset:2048 sc1
  v_mfma_f32_16x16x32_bf16 v[172:175], a[112:115], v[48:51], 0
  ds_read_b64_tr_b16 a[84:85], v9 offset:36864
  v_mfma_f32_16x16x32_bf16 v[172:175], a[116:119], v[52:55], v[172:175]
  v_cvt_pk_bf16_f32 v108, v152, v153
  v_cvt_pk_bf16_f32 v109, v154, v155
  v_mfma_f32_16x16x32_bf16 v[172:175], a[120:123], v[56:59], v[172:175]
  ds_read_b64_tr_b16 a[86:87], v9 offset:38912
  v_mfma_f32_16x16x32_bf16 v[172:175], a[124:127], v[60:63], v[172:175]
  v_cvt_pk_bf16_f32 v110, v156, v157
  v_cvt_pk_bf16_f32 v111, v158, v159
  v_mfma_f32_16x16x32_bf16 v[180:183], a[112:115], v[64:67], 0
  ds_read_b64_tr_b16 a[88:89], v9 offset:40960
  v_mfma_f32_16x16x32_bf16 v[180:183], a[116:119], v[68:71], v[180:183]
  buffer_store_dwordx4 v[108:111], v2, s[40:43], s79 offen offset:2048 sc1
  v_mfma_f32_16x16x32_bf16 v[180:183], a[120:123], v[72:75], v[180:183]
  ds_read_b64_tr_b16 a[90:91], v9 offset:43008
  v_mfma_f32_16x16x32_bf16 v[180:183], a[124:127], v[76:79], v[180:183]
  v_mfma_f32_16x16x32_bf16 v[188:191], a[112:115], v[80:83], 0
  ds_read_b64_tr_b16 a[92:93], v9 offset:45056
  v_mfma_f32_16x16x32_bf16 v[188:191], a[116:119], v[84:87], v[188:191]
  v_mfma_f32_16x16x32_bf16 v[188:191], a[120:123], v[88:91], v[188:191]
  ds_read_b64_tr_b16 a[94:95], v9 offset:47104
  v_mfma_f32_16x16x32_bf16 v[188:191], a[124:127], v[92:95], v[188:191]
  s_waitcnt lgkmcnt(8)
  v_mfma_f32_16x16x32_bf16 v[128:131], a[64:67], v[32:35], 0
  ds_read_b64_tr_b16 a[96:97], v10 offset:32768
  v_mfma_f32_16x16x32_bf16 v[128:131], a[68:71], v[36:39], v[128:131]
  s_nop 1
  v_mfma_f32_16x16x32_bf16 v[128:131], a[72:75], v[40:43], v[128:131]
  ds_read_b64_tr_b16 a[98:99], v10 offset:34816
  v_mfma_f32_16x16x32_bf16 v[128:131], a[76:79], v[44:47], v[128:131]
  v_cvt_pk_bf16_f32 v112, v160, v161
  v_cvt_pk_bf16_f32 v113, v162, v163
  v_mfma_f32_16x16x32_bf16 v[136:139], a[64:67], v[48:51], 0
  ds_read_b64_tr_b16 a[100:101], v10 offset:36864
  v_mfma_f32_16x16x32_bf16 v[136:139], a[68:71], v[52:55], v[136:139]
  v_cvt_pk_bf16_f32 v114, v164, v165
  v_cvt_pk_bf16_f32 v115, v166, v167
  v_mfma_f32_16x16x32_bf16 v[136:139], a[72:75], v[56:59], v[136:139]
  ds_read_b64_tr_b16 a[102:103], v10 offset:38912
  v_mfma_f32_16x16x32_bf16 v[136:139], a[76:79], v[60:63], v[136:139]
  buffer_store_dwordx4 v[112:115], v2, s[40:43], s76 offen offset:3072 sc1
  v_mfma_f32_16x16x32_bf16 v[144:147], a[64:67], v[64:67], 0
  ds_read_b64_tr_b16 a[104:105], v10 offset:40960
  v_mfma_f32_16x16x32_bf16 v[144:147], a[68:71], v[68:71], v[144:147]
  v_cvt_pk_bf16_f32 v116, v168, v169
  v_cvt_pk_bf16_f32 v117, v170, v171
  v_mfma_f32_16x16x32_bf16 v[144:147], a[72:75], v[72:75], v[144:147]
  ds_read_b64_tr_b16 a[106:107], v10 offset:43008
  v_mfma_f32_16x16x32_bf16 v[144:147], a[76:79], v[76:79], v[144:147]
  v_cvt_pk_bf16_f32 v118, v172, v173
  v_cvt_pk_bf16_f32 v119, v174, v175
  v_mfma_f32_16x16x32_bf16 v[152:155], a[64:67], v[80:83], 0
  ds_read_b64_tr_b16 a[108:109], v10 offset:45056
  v_mfma_f32_16x16x32_bf16 v[152:155], a[68:71], v[84:87], v[152:155]
  buffer_store_dwordx4 v[116:119], v2, s[40:43], s77 offen offset:3072 sc1
  v_mfma_f32_16x16x32_bf16 v[152:155], a[72:75], v[88:91], v[152:155]
  ds_read_b64_tr_b16 a[110:111], v10 offset:47104
  v_mfma_f32_16x16x32_bf16 v[152:155], a[76:79], v[92:95], v[152:155]
  s_waitcnt lgkmcnt(8)
  v_cvt_pk_bf16_f32 v120, v176, v177
  v_cvt_pk_bf16_f32 v121, v178, v179
  v_mfma_f32_16x16x32_bf16 v[132:135], a[80:83], v[32:35], 0
  ds_read_b64_tr_b16 a[112:113], v11 offset:32768
  v_mfma_f32_16x16x32_bf16 v[132:135], a[84:87], v[36:39], v[132:135]
  v_cvt_pk_bf16_f32 v122, v180, v181
  v_cvt_pk_bf16_f32 v123, v182, v183
  v_mfma_f32_16x16x32_bf16 v[132:135], a[88:91], v[40:43], v[132:135]
  ds_read_b64_tr_b16 a[114:115], v11 offset:34816
  v_mfma_f32_16x16x32_bf16 v[132:135], a[92:95], v[44:47], v[132:135]
  buffer_store_dwordx4 v[120:123], v2, s[40:43], s78 offen offset:3072 sc1
  v_mfma_f32_16x16x32_bf16 v[140:143], a[80:83], v[48:51], 0
  ds_read_b64_tr_b16 a[116:117], v11 offset:36864
  v_mfma_f32_16x16x32_bf16 v[140:143], a[84:87], v[52:55], v[140:143]
  v_cvt_pk_bf16_f32 v124, v184, v185
  v_cvt_pk_bf16_f32 v125, v186, v187
  v_mfma_f32_16x16x32_bf16 v[140:143], a[88:91], v[56:59], v[140:143]
  ds_read_b64_tr_b16 a[118:119], v11 offset:38912
  v_mfma_f32_16x16x32_bf16 v[140:143], a[92:95], v[60:63], v[140:143]
  v_cvt_pk_bf16_f32 v126, v188, v189
  v_cvt_pk_bf16_f32 v127, v190, v191
  v_mfma_f32_16x16x32_bf16 v[148:151], a[80:83], v[64:67], 0
  ds_read_b64_tr_b16 a[120:121], v11 offset:40960
  v_mfma_f32_16x16x32_bf16 v[148:151], a[84:87], v[68:71], v[148:151]
  buffer_store_dwordx4 v[124:127], v2, s[40:43], s79 offen offset:3072 sc1
  v_mfma_f32_16x16x32_bf16 v[148:151], a[88:91], v[72:75], v[148:151]
  ds_read_b64_tr_b16 a[122:123], v11 offset:43008
  v_mfma_f32_16x16x32_bf16 v[148:151], a[92:95], v[76:79], v[148:151]
  v_mfma_f32_16x16x32_bf16 v[156:159], a[80:83], v[80:83], 0
  ds_read_b64_tr_b16 a[124:125], v11 offset:45056
  v_mfma_f32_16x16x32_bf16 v[156:159], a[84:87], v[84:87], v[156:159]
  v_mfma_f32_16x16x32_bf16 v[156:159], a[88:91], v[88:91], v[156:159]
  ds_read_b64_tr_b16 a[126:127], v11 offset:47104
  v_mfma_f32_16x16x32_bf16 v[156:159], a[92:95], v[92:95], v[156:159]
  s_waitcnt lgkmcnt(8)
  v_mfma_f32_16x16x32_bf16 v[160:163], a[96:99], v[32:35], 0
  ds_read_b64_tr_b16 a[64:65], v8 offset:49152
  v_mfma_f32_16x16x32_bf16 v[160:163], a[100:103], v[36:39], v[160:163]
  s_add_u32 s76, s76, 0x1000
  s_add_u32 s77, s77, 0x1000
  s_add_u32 s78, s78, 0x1000
  s_add_u32 s79, s79, 0x1000
  v_mfma_f32_16x16x32_bf16 v[160:163], a[104:107], v[40:43], v[160:163]
  ds_read_b64_tr_b16 a[66:67], v8 offset:51200
  v_mfma_f32_16x16x32_bf16 v[160:163], a[108:111], v[44:47], v[160:163]
  v_cvt_pk_bf16_f32 v96, v128, v129
  v_cvt_pk_bf16_f32 v97, v130, v131
  v_mfma_f32_16x16x32_bf16 v[168:171], a[96:99], v[48:51], 0
  ds_read_b64_tr_b16 a[68:69], v8 offset:53248
  v_mfma_f32_16x16x32_bf16 v[168:171], a[100:103], v[52:55], v[168:171]
  v_cvt_pk_bf16_f32 v98, v132, v133
  v_cvt_pk_bf16_f32 v99, v134, v135
  v_mfma_f32_16x16x32_bf16 v[168:171], a[104:107], v[56:59], v[168:171]
  ds_read_b64_tr_b16 a[70:71], v8 offset:55296
  v_mfma_f32_16x16x32_bf16 v[168:171], a[108:111], v[60:63], v[168:171]
  buffer_store_dwordx4 v[96:99], v2, s[40:43], s76 offen offset:0 sc1
  v_mfma_f32_16x16x32_bf16 v[176:179], a[96:99], v[64:67], 0
  ds_read_b64_tr_b16 a[72:73], v8 offset:57344
  v_mfma_f32_16x16x32_bf16 v[176:179], a[100:103], v[68:71], v[176:179]
  v_cvt_pk_bf16_f32 v100, v136, v137
  v_cvt_pk_bf16_f32 v101, v138, v139
  v_mfma_f32_16x16x32_bf16 v[176:179], a[104:107], v[72:75], v[176:179]
  ds_read_b64_tr_b16 a[74:75], v8 offset:59392
  v_mfma_f32_16x16x32_bf16 v[176:179], a[108:111], v[76:79], v[176:179]
  v_cvt_pk_bf16_f32 v102, v140, v141
  v_cvt_pk_bf16_f32 v103, v142, v143
  v_mfma_f32_16x16x32_bf16 v[184:187], a[96:99], v[80:83], 0
  ds_read_b64_tr_b16 a[76:77], v8 offset:61440
  v_mfma_f32_16x16x32_bf16 v[184:187], a[100:103], v[84:87], v[184:187]
  buffer_store_dwordx4 v[100:103], v2, s[40:43], s77 offen offset:0 sc1
  v_mfma_f32_16x16x32_bf16 v[184:187], a[104:107], v[88:91], v[184:187]
  ds_read_b64_tr_b16 a[78:79], v8 offset:63488
  v_mfma_f32_16x16x32_bf16 v[184:187], a[108:111], v[92:95], v[184:187]
  s_waitcnt lgkmcnt(8)
  v_cvt_pk_bf16_f32 v104, v144, v145
  v_cvt_pk_bf16_f32 v105, v146, v147
  v_mfma_f32_16x16x32_bf16 v[164:167], a[112:115], v[32:35], 0
  ds_read_b64_tr_b16 a[80:81], v9 offset:49152
  v_mfma_f32_16x16x32_bf16 v[164:167], a[116:119], v[36:39], v[164:167]
  v_cvt_pk_bf16_f32 v106, v148, v149
  v_cvt_pk_bf16_f32 v107, v150, v151
  v_mfma_f32_16x16x32_bf16 v[164:167], a[120:123], v[40:43], v[164:167]
  ds_read_b64_tr_b16 a[82:83], v9 offset:51200
  v_mfma_f32_16x16x32_bf16 v[164:167], a[124:127], v[44:47], v[164:167]
  buffer_store_dwordx4 v[104:107], v2, s[40:43], s78 offen offset:0 sc1
  v_mfma_f32_16x16x32_bf16 v[172:175], a[112:115], v[48:51], 0
  ds_read_b64_tr_b16 a[84:85], v9 offset:53248
  v_mfma_f32_16x16x32_bf16 v[172:175], a[116:119], v[52:55], v[172:175]
  v_cvt_pk_bf16_f32 v108, v152, v153
  v_cvt_pk_bf16_f32 v109, v154, v155
  v_mfma_f32_16x16x32_bf16 v[172:175], a[120:123], v[56:59], v[172:175]
  ds_read_b64_tr_b16 a[86:87], v9 offset:55296
  v_mfma_f32_16x16x32_bf16 v[172:175], a[124:127], v[60:63], v[172:175]
  v_cvt_pk_bf16_f32 v110, v156, v157
  v_cvt_pk_bf16_f32 v111, v158, v159
  v_mfma_f32_16x16x32_bf16 v[180:183], a[112:115], v[64:67], 0
  ds_read_b64_tr_b16 a[88:89], v9 offset:57344
  v_mfma_f32_16x16x32_bf16 v[180:183], a[116:119], v[68:71], v[180:183]
  buffer_store_dwordx4 v[108:111], v2, s[40:43], s79 offen offset:0 sc1
  v_mfma_f32_16x16x32_bf16 v[180:183], a[120:123], v[72:75], v[180:183]
  ds_read_b64_tr_b16 a[90:91], v9 offset:59392
  v_mfma_f32_16x16x32_bf16 v[180:183], a[124:127], v[76:79], v[180:183]
  v_mfma_f32_16x16x32_bf16 v[188:191], a[112:115], v[80:83], 0
  ds_read_b64_tr_b16 a[92:93], v9 offset:61440
  v_mfma_f32_16x16x32_bf16 v[188:191], a[116:119], v[84:87], v[188:191]
  v_mfma_f32_16x16x32_bf16 v[188:191], a[120:123], v[88:91], v[188:191]
  ds_read_b64_tr_b16 a[94:95], v9 offset:63488
  v_mfma_f32_16x16x32_bf16 v[188:191], a[124:127], v[92:95], v[188:191]
  s_waitcnt lgkmcnt(8)
  v_mfma_f32_16x16x32_bf16 v[128:131], a[64:67], v[32:35], 0
  ds_read_b64_tr_b16 a[96:97], v10 offset:49152
  v_mfma_f32_16x16x32_bf16 v[128:131], a[68:71], v[36:39], v[128:131]
  s_nop 1
  v_mfma_f32_16x16x32_bf16 v[128:131], a[72:75], v[40:43], v[128:131]
  ds_read_b64_tr_b16 a[98:99], v10 offset:51200
  v_mfma_f32_16x16x32_bf16 v[128:131], a[76:79], v[44:47], v[128:131]
  v_cvt_pk_bf16_f32 v112, v160, v161
  v_cvt_pk_bf16_f32 v113, v162, v163
  v_mfma_f32_16x16x32_bf16 v[136:139], a[64:67], v[48:51], 0
  ds_read_b64_tr_b16 a[100:101], v10 offset:53248
  v_mfma_f32_16x16x32_bf16 v[136:139], a[68:71], v[52:55], v[136:139]
  v_cvt_pk_bf16_f32 v114, v164, v165
  v_cvt_pk_bf16_f32 v115, v166, v167
  v_mfma_f32_16x16x32_bf16 v[136:139], a[72:75], v[56:59], v[136:139]
  ds_read_b64_tr_b16 a[102:103], v10 offset:55296
  v_mfma_f32_16x16x32_bf16 v[136:139], a[76:79], v[60:63], v[136:139]
  buffer_store_dwordx4 v[112:115], v2, s[40:43], s76 offen offset:1024 sc1
  v_mfma_f32_16x16x32_bf16 v[144:147], a[64:67], v[64:67], 0
  ds_read_b64_tr_b16 a[104:105], v10 offset:57344
  v_mfma_f32_16x16x32_bf16 v[144:147], a[68:71], v[68:71], v[144:147]
  v_cvt_pk_bf16_f32 v116, v168, v169
  v_cvt_pk_bf16_f32 v117, v170, v171
  v_mfma_f32_16x16x32_bf16 v[144:147], a[72:75], v[72:75], v[144:147]
  ds_read_b64_tr_b16 a[106:107], v10 offset:59392
  v_mfma_f32_16x16x32_bf16 v[144:147], a[76:79], v[76:79], v[144:147]
  v_cvt_pk_bf16_f32 v118, v172, v173
  v_cvt_pk_bf16_f32 v119, v174, v175
  v_mfma_f32_16x16x32_bf16 v[152:155], a[64:67], v[80:83], 0
  ds_read_b64_tr_b16 a[108:109], v10 offset:61440
  v_mfma_f32_16x16x32_bf16 v[152:155], a[68:71], v[84:87], v[152:155]
  buffer_store_dwordx4 v[116:119], v2, s[40:43], s77 offen offset:1024 sc1
  v_mfma_f32_16x16x32_bf16 v[152:155], a[72:75], v[88:91], v[152:155]
  ds_read_b64_tr_b16 a[110:111], v10 offset:63488
  v_mfma_f32_16x16x32_bf16 v[152:155], a[76:79], v[92:95], v[152:155]
  s_waitcnt lgkmcnt(8)
  v_cvt_pk_bf16_f32 v120, v176, v177
  v_cvt_pk_bf16_f32 v121, v178, v179
  v_mfma_f32_16x16x32_bf16 v[132:135], a[80:83], v[32:35], 0
  ds_read_b64_tr_b16 a[112:113], v11 offset:49152
  v_mfma_f32_16x16x32_bf16 v[132:135], a[84:87], v[36:39], v[132:135]
  v_cvt_pk_bf16_f32 v122, v180, v181
  v_cvt_pk_bf16_f32 v123, v182, v183
  v_mfma_f32_16x16x32_bf16 v[132:135], a[88:91], v[40:43], v[132:135]
  ds_read_b64_tr_b16 a[114:115], v11 offset:51200
  v_mfma_f32_16x16x32_bf16 v[132:135], a[92:95], v[44:47], v[132:135]
  buffer_store_dwordx4 v[120:123], v2, s[40:43], s78 offen offset:1024 sc1
  v_mfma_f32_16x16x32_bf16 v[140:143], a[80:83], v[48:51], 0
  ds_read_b64_tr_b16 a[116:117], v11 offset:53248
  v_mfma_f32_16x16x32_bf16 v[140:143], a[84:87], v[52:55], v[140:143]
  v_cvt_pk_bf16_f32 v124, v184, v185
  v_cvt_pk_bf16_f32 v125, v186, v187
  v_mfma_f32_16x16x32_bf16 v[140:143], a[88:91], v[56:59], v[140:143]
  ds_read_b64_tr_b16 a[118:119], v11 offset:55296
  v_mfma_f32_16x16x32_bf16 v[140:143], a[92:95], v[60:63], v[140:143]
  v_cvt_pk_bf16_f32 v126, v188, v189
  v_cvt_pk_bf16_f32 v127, v190, v191
  v_mfma_f32_16x16x32_bf16 v[148:151], a[80:83], v[64:67], 0
  ds_read_b64_tr_b16 a[120:121], v11 offset:57344
  v_mfma_f32_16x16x32_bf16 v[148:151], a[84:87], v[68:71], v[148:151]
  buffer_store_dwordx4 v[124:127], v2, s[40:43], s79 offen offset:1024 sc1
  v_mfma_f32_16x16x32_bf16 v[148:151], a[88:91], v[72:75], v[148:151]
  ds_read_b64_tr_b16 a[122:123], v11 offset:59392
  v_mfma_f32_16x16x32_bf16 v[148:151], a[92:95], v[76:79], v[148:151]
  v_mfma_f32_16x16x32_bf16 v[156:159], a[80:83], v[80:83], 0
  ds_read_b64_tr_b16 a[124:125], v11 offset:61440
  v_mfma_f32_16x16x32_bf16 v[156:159], a[84:87], v[84:87], v[156:159]
  v_mfma_f32_16x16x32_bf16 v[156:159], a[88:91], v[88:91], v[156:159]
  ds_read_b64_tr_b16 a[126:127], v11 offset:63488
  v_mfma_f32_16x16x32_bf16 v[156:159], a[92:95], v[92:95], v[156:159]
  s_waitcnt lgkmcnt(8)
  v_mfma_f32_16x16x32_bf16 v[160:163], a[96:99], v[32:35], 0
  ds_read_b64_tr_b16 a[64:65], v12 offset:0
  v_mfma_f32_16x16x32_bf16 v[160:163], a[100:103], v[36:39], v[160:163]
  s_nop 1
  v_mfma_f32_16x16x32_bf16 v[160:163], a[104:107], v[40:43], v[160:163]
  ds_read_b64_tr_b16 a[66:67], v12 offset:2048
  v_mfma_f32_16x16x32_bf16 v[160:163], a[108:111], v[44:47], v[160:163]
  v_cvt_pk_bf16_f32 v96, v128, v129
  v_cvt_pk_bf16_f32 v97, v130, v131
  v_mfma_f32_16x16x32_bf16 v[168:171], a[96:99], v[48:51], 0
  ds_read_b64_tr_b16 a[68:69], v12 offset:4096
  v_mfma_f32_16x16x32_bf16 v[168:171], a[100:103], v[52:55], v[168:171]
  v_cvt_pk_bf16_f32 v98, v132, v133
  v_cvt_pk_bf16_f32 v99, v134, v135
  v_mfma_f32_16x16x32_bf16 v[168:171], a[104:107], v[56:59], v[168:171]
  ds_read_b64_tr_b16 a[70:71], v12 offset:6144
  v_mfma_f32_16x16x32_bf16 v[168:171], a[108:111], v[60:63], v[168:171]
  buffer_store_dwordx4 v[96:99], v2, s[40:43], s76 offen offset:2048 sc1
  v_mfma_f32_16x16x32_bf16 v[176:179], a[96:99], v[64:67], 0
  ds_read_b64_tr_b16 a[72:73], v12 offset:8192
  v_mfma_f32_16x16x32_bf16 v[176:179], a[100:103], v[68:71], v[176:179]
  v_cvt_pk_bf16_f32 v100, v136, v137
  v_cvt_pk_bf16_f32 v101, v138, v139
  v_mfma_f32_16x16x32_bf16 v[176:179], a[104:107], v[72:75], v[176:179]
  ds_read_b64_tr_b16 a[74:75], v12 offset:10240
  v_mfma_f32_16x16x32_bf16 v[176:179], a[108:111], v[76:79], v[176:179]
  v_cvt_pk_bf16_f32 v102, v140, v141
  v_cvt_pk_bf16_f32 v103, v142, v143
  v_mfma_f32_16x16x32_bf16 v[184:187], a[96:99], v[80:83], 0
  ds_read_b64_tr_b16 a[76:77], v12 offset:12288
  v_mfma_f32_16x16x32_bf16 v[184:187], a[100:103], v[84:87], v[184:187]
  buffer_store_dwordx4 v[100:103], v2, s[40:43], s77 offen offset:2048 sc1
  v_mfma_f32_16x16x32_bf16 v[184:187], a[104:107], v[88:91], v[184:187]
  ds_read_b64_tr_b16 a[78:79], v12 offset:14336
  v_mfma_f32_16x16x32_bf16 v[184:187], a[108:111], v[92:95], v[184:187]
  s_waitcnt lgkmcnt(8)
  v_cvt_pk_bf16_f32 v104, v144, v145
  v_cvt_pk_bf16_f32 v105, v146, v147
  v_mfma_f32_16x16x32_bf16 v[164:167], a[112:115], v[32:35], 0
  ds_read_b64_tr_b16 a[80:81], v13 offset:0
  v_mfma_f32_16x16x32_bf16 v[164:167], a[116:119], v[36:39], v[164:167]
  v_cvt_pk_bf16_f32 v106, v148, v149
  v_cvt_pk_bf16_f32 v107, v150, v151
  v_mfma_f32_16x16x32_bf16 v[164:167], a[120:123], v[40:43], v[164:167]
  ds_read_b64_tr_b16 a[82:83], v13 offset:2048
  v_mfma_f32_16x16x32_bf16 v[164:167], a[124:127], v[44:47], v[164:167]
  buffer_store_dwordx4 v[104:107], v2, s[40:43], s78 offen offset:2048 sc1
  v_mfma_f32_16x16x32_bf16 v[172:175], a[112:115], v[48:51], 0
  ds_read_b64_tr_b16 a[84:85], v13 offset:4096
  v_mfma_f32_16x16x32_bf16 v[172:175], a[116:119], v[52:55], v[172:175]
  v_cvt_pk_bf16_f32 v108, v152, v153
  v_cvt_pk_bf16_f32 v109, v154, v155
  v_mfma_f32_16x16x32_bf16 v[172:175], a[120:123], v[56:59], v[172:175]
  ds_read_b64_tr_b16 a[86:87], v13 offset:6144
  v_mfma_f32_16x16x32_bf16 v[172:175], a[124:127], v[60:63], v[172:175]
  v_cvt_pk_bf16_f32 v110, v156, v157
  v_cvt_pk_bf16_f32 v111, v158, v159
  v_mfma_f32_16x16x32_bf16 v[180:183], a[112:115], v[64:67], 0
  ds_read_b64_tr_b16 a[88:89], v13 offset:8192
  v_mfma_f32_16x16x32_bf16 v[180:183], a[116:119], v[68:71], v[180:183]
  buffer_store_dwordx4 v[108:111], v2, s[40:43], s79 offen offset:2048 sc1
  v_mfma_f32_16x16x32_bf16 v[180:183], a[120:123], v[72:75], v[180:183]
  ds_read_b64_tr_b16 a[90:91], v13 offset:10240
  v_mfma_f32_16x16x32_bf16 v[180:183], a[124:127], v[76:79], v[180:183]
  v_mfma_f32_16x16x32_bf16 v[188:191], a[112:115], v[80:83], 0
  ds_read_b64_tr_b16 a[92:93], v13 offset:12288
  v_mfma_f32_16x16x32_bf16 v[188:191], a[116:119], v[84:87], v[188:191]
  v_mfma_f32_16x16x32_bf16 v[188:191], a[120:123], v[88:91], v[188:191]
  ds_read_b64_tr_b16 a[94:95], v13 offset:14336
  v_mfma_f32_16x16x32_bf16 v[188:191], a[124:127], v[92:95], v[188:191]
  s_waitcnt lgkmcnt(8)
  v_mfma_f32_16x16x32_bf16 v[128:131], a[64:67], v[32:35], 0
  ds_read_b64_tr_b16 a[96:97], v14 offset:0
  v_mfma_f32_16x16x32_bf16 v[128:131], a[68:71], v[36:39], v[128:131]
  s_nop 1
  v_mfma_f32_16x16x32_bf16 v[128:131], a[72:75], v[40:43], v[128:131]
  ds_read_b64_tr_b16 a[98:99], v14 offset:2048
  v_mfma_f32_16x16x32_bf16 v[128:131], a[76:79], v[44:47], v[128:131]
  v_cvt_pk_bf16_f32 v112, v160, v161
  v_cvt_pk_bf16_f32 v113, v162, v163
  v_mfma_f32_16x16x32_bf16 v[136:139], a[64:67], v[48:51], 0
  ds_read_b64_tr_b16 a[100:101], v14 offset:4096
  v_mfma_f32_16x16x32_bf16 v[136:139], a[68:71], v[52:55], v[136:139]
  v_cvt_pk_bf16_f32 v114, v164, v165
  v_cvt_pk_bf16_f32 v115, v166, v167
  v_mfma_f32_16x16x32_bf16 v[136:139], a[72:75], v[56:59], v[136:139]
  ds_read_b64_tr_b16 a[102:103], v14 offset:6144
  v_mfma_f32_16x16x32_bf16 v[136:139], a[76:79], v[60:63], v[136:139]
  buffer_store_dwordx4 v[112:115], v2, s[40:43], s76 offen offset:3072 sc1
  v_mfma_f32_16x16x32_bf16 v[144:147], a[64:67], v[64:67], 0
  ds_read_b64_tr_b16 a[104:105], v14 offset:8192
  v_mfma_f32_16x16x32_bf16 v[144:147], a[68:71], v[68:71], v[144:147]
  v_cvt_pk_bf16_f32 v116, v168, v169
  v_cvt_pk_bf16_f32 v117, v170, v171
  v_mfma_f32_16x16x32_bf16 v[144:147], a[72:75], v[72:75], v[144:147]
  ds_read_b64_tr_b16 a[106:107], v14 offset:10240
  v_mfma_f32_16x16x32_bf16 v[144:147], a[76:79], v[76:79], v[144:147]
  v_cvt_pk_bf16_f32 v118, v172, v173
  v_cvt_pk_bf16_f32 v119, v174, v175
  v_mfma_f32_16x16x32_bf16 v[152:155], a[64:67], v[80:83], 0
  ds_read_b64_tr_b16 a[108:109], v14 offset:12288
  v_mfma_f32_16x16x32_bf16 v[152:155], a[68:71], v[84:87], v[152:155]
  buffer_store_dwordx4 v[116:119], v2, s[40:43], s77 offen offset:3072 sc1
  v_mfma_f32_16x16x32_bf16 v[152:155], a[72:75], v[88:91], v[152:155]
  ds_read_b64_tr_b16 a[110:111], v14 offset:14336
  v_mfma_f32_16x16x32_bf16 v[152:155], a[76:79], v[92:95], v[152:155]
  s_waitcnt lgkmcnt(8)
  v_cvt_pk_bf16_f32 v120, v176, v177
  v_cvt_pk_bf16_f32 v121, v178, v179
  v_mfma_f32_16x16x32_bf16 v[132:135], a[80:83], v[32:35], 0
  ds_read_b64_tr_b16 a[112:113], v15 offset:0
  v_mfma_f32_16x16x32_bf16 v[132:135], a[84:87], v[36:39], v[132:135]
  v_cvt_pk_bf16_f32 v122, v180, v181
  v_cvt_pk_bf16_f32 v123, v182, v183
  v_mfma_f32_16x16x32_bf16 v[132:135], a[88:91], v[40:43], v[132:135]
  ds_read_b64_tr_b16 a[114:115], v15 offset:2048
  v_mfma_f32_16x16x32_bf16 v[132:135], a[92:95], v[44:47], v[132:135]
  buffer_store_dwordx4 v[120:123], v2, s[40:43], s78 offen offset:3072 sc1
  v_mfma_f32_16x16x32_bf16 v[140:143], a[80:83], v[48:51], 0
  ds_read_b64_tr_b16 a[116:117], v15 offset:4096
  v_mfma_f32_16x16x32_bf16 v[140:143], a[84:87], v[52:55], v[140:143]
  v_cvt_pk_bf16_f32 v124, v184, v185
  v_cvt_pk_bf16_f32 v125, v186, v187
  v_mfma_f32_16x16x32_bf16 v[140:143], a[88:91], v[56:59], v[140:143]
  ds_read_b64_tr_b16 a[118:119], v15 offset:6144
  v_mfma_f32_16x16x32_bf16 v[140:143], a[92:95], v[60:63], v[140:143]
  v_cvt_pk_bf16_f32 v126, v188, v189
  v_cvt_pk_bf16_f32 v127, v190, v191
  v_mfma_f32_16x16x32_bf16 v[148:151], a[80:83], v[64:67], 0
  ds_read_b64_tr_b16 a[120:121], v15 offset:8192
  v_mfma_f32_16x16x32_bf16 v[148:151], a[84:87], v[68:71], v[148:151]
  buffer_store_dwordx4 v[124:127], v2, s[40:43], s79 offen offset:3072 sc1
  v_mfma_f32_16x16x32_bf16 v[148:151], a[88:91], v[72:75], v[148:151]
  ds_read_b64_tr_b16 a[122:123], v15 offset:10240
  v_mfma_f32_16x16x32_bf16 v[148:151], a[92:95], v[76:79], v[148:151]
  v_mfma_f32_16x16x32_bf16 v[156:159], a[80:83], v[80:83], 0
  ds_read_b64_tr_b16 a[124:125], v15 offset:12288
  v_mfma_f32_16x16x32_bf16 v[156:159], a[84:87], v[84:87], v[156:159]
  v_mfma_f32_16x16x32_bf16 v[156:159], a[88:91], v[88:91], v[156:159]
  ds_read_b64_tr_b16 a[126:127], v15 offset:14336
  v_mfma_f32_16x16x32_bf16 v[156:159], a[92:95], v[92:95], v[156:159]
  s_waitcnt lgkmcnt(8)
  v_mfma_f32_16x16x32_bf16 v[160:163], a[96:99], v[32:35], 0
  ds_read_b64_tr_b16 a[64:65], v12 offset:16384
  v_mfma_f32_16x16x32_bf16 v[160:163], a[100:103], v[36:39], v[160:163]
  s_add_u32 s76, s76, 0x1000
  s_add_u32 s77, s77, 0x1000
  s_add_u32 s78, s78, 0x1000
  s_add_u32 s79, s79, 0x1000
  v_mfma_f32_16x16x32_bf16 v[160:163], a[104:107], v[40:43], v[160:163]
  ds_read_b64_tr_b16 a[66:67], v12 offset:18432
  v_mfma_f32_16x16x32_bf16 v[160:163], a[108:111], v[44:47], v[160:163]
  v_cvt_pk_bf16_f32 v96, v128, v129
  v_cvt_pk_bf16_f32 v97, v130, v131
  v_mfma_f32_16x16x32_bf16 v[168:171], a[96:99], v[48:51], 0
  ds_read_b64_tr_b16 a[68:69], v12 offset:20480
  v_mfma_f32_16x16x32_bf16 v[168:171], a[100:103], v[52:55], v[168:171]
  v_cvt_pk_bf16_f32 v98, v132, v133
  v_cvt_pk_bf16_f32 v99, v134, v135
  v_mfma_f32_16x16x32_bf16 v[168:171], a[104:107], v[56:59], v[168:171]
  ds_read_b64_tr_b16 a[70:71], v12 offset:22528
  v_mfma_f32_16x16x32_bf16 v[168:171], a[108:111], v[60:63], v[168:171]
  buffer_store_dwordx4 v[96:99], v2, s[40:43], s76 offen offset:0 sc1
  v_mfma_f32_16x16x32_bf16 v[176:179], a[96:99], v[64:67], 0
  ds_read_b64_tr_b16 a[72:73], v12 offset:24576
  v_mfma_f32_16x16x32_bf16 v[176:179], a[100:103], v[68:71], v[176:179]
  v_cvt_pk_bf16_f32 v100, v136, v137
  v_cvt_pk_bf16_f32 v101, v138, v139
  v_mfma_f32_16x16x32_bf16 v[176:179], a[104:107], v[72:75], v[176:179]
  ds_read_b64_tr_b16 a[74:75], v12 offset:26624
  v_mfma_f32_16x16x32_bf16 v[176:179], a[108:111], v[76:79], v[176:179]
  v_cvt_pk_bf16_f32 v102, v140, v141
  v_cvt_pk_bf16_f32 v103, v142, v143
  v_mfma_f32_16x16x32_bf16 v[184:187], a[96:99], v[80:83], 0
  ds_read_b64_tr_b16 a[76:77], v12 offset:28672
  v_mfma_f32_16x16x32_bf16 v[184:187], a[100:103], v[84:87], v[184:187]
  buffer_store_dwordx4 v[100:103], v2, s[40:43], s77 offen offset:0 sc1
  v_mfma_f32_16x16x32_bf16 v[184:187], a[104:107], v[88:91], v[184:187]
  ds_read_b64_tr_b16 a[78:79], v12 offset:30720
  v_mfma_f32_16x16x32_bf16 v[184:187], a[108:111], v[92:95], v[184:187]
  s_waitcnt lgkmcnt(8)
  v_cvt_pk_bf16_f32 v104, v144, v145
  v_cvt_pk_bf16_f32 v105, v146, v147
  v_mfma_f32_16x16x32_bf16 v[164:167], a[112:115], v[32:35], 0
  ds_read_b64_tr_b16 a[80:81], v13 offset:16384
  v_mfma_f32_16x16x32_bf16 v[164:167], a[116:119], v[36:39], v[164:167]
  v_cvt_pk_bf16_f32 v106, v148, v149
  v_cvt_pk_bf16_f32 v107, v150, v151
  v_mfma_f32_16x16x32_bf16 v[164:167], a[120:123], v[40:43], v[164:167]
  ds_read_b64_tr_b16 a[82:83], v13 offset:18432
  v_mfma_f32_16x16x32_bf16 v[164:167], a[124:127], v[44:47], v[164:167]
  buffer_store_dwordx4 v[104:107], v2, s[40:43], s78 offen offset:0 sc1
  v_mfma_f32_16x16x32_bf16 v[172:175], a[112:115], v[48:51], 0
  ds_read_b64_tr_b16 a[84:85], v13 offset:20480
  v_mfma_f32_16x16x32_bf16 v[172:175], a[116:119], v[52:55], v[172:175]
  v_cvt_pk_bf16_f32 v108, v152, v153
  v_cvt_pk_bf16_f32 v109, v154, v155
  v_mfma_f32_16x16x32_bf16 v[172:175], a[120:123], v[56:59], v[172:175]
  ds_read_b64_tr_b16 a[86:87], v13 offset:22528
  v_mfma_f32_16x16x32_bf16 v[172:175], a[124:127], v[60:63], v[172:175]
  v_cvt_pk_bf16_f32 v110, v156, v157
  v_cvt_pk_bf16_f32 v111, v158, v159
  v_mfma_f32_16x16x32_bf16 v[180:183], a[112:115], v[64:67], 0
  ds_read_b64_tr_b16 a[88:89], v13 offset:24576
  v_mfma_f32_16x16x32_bf16 v[180:183], a[116:119], v[68:71], v[180:183]
  buffer_store_dwordx4 v[108:111], v2, s[40:43], s79 offen offset:0 sc1
  v_mfma_f32_16x16x32_bf16 v[180:183], a[120:123], v[72:75], v[180:183]
  ds_read_b64_tr_b16 a[90:91], v13 offset:26624
  v_mfma_f32_16x16x32_bf16 v[180:183], a[124:127], v[76:79], v[180:183]
  v_mfma_f32_16x16x32_bf16 v[188:191], a[112:115], v[80:83], 0
  ds_read_b64_tr_b16 a[92:93], v13 offset:28672
  v_mfma_f32_16x16x32_bf16 v[188:191], a[116:119], v[84:87], v[188:191]
  v_mfma_f32_16x16x32_bf16 v[188:191], a[120:123], v[88:91], v[188:191]
  ds_read_b64_tr_b16 a[94:95], v13 offset:30720
  v_mfma_f32_16x16x32_bf16 v[188:191], a[124:127], v[92:95], v[188:191]
  s_waitcnt lgkmcnt(8)
  v_mfma_f32_16x16x32_bf16 v[128:131], a[64:67], v[32:35], 0
  ds_read_b64_tr_b16 a[96:97], v14 offset:16384
  v_mfma_f32_16x16x32_bf16 v[128:131], a[68:71], v[36:39], v[128:131]
  s_nop 1
  v_mfma_f32_16x16x32_bf16 v[128:131], a[72:75], v[40:43], v[128:131]
  ds_read_b64_tr_b16 a[98:99], v14 offset:18432
  v_mfma_f32_16x16x32_bf16 v[128:131], a[76:79], v[44:47], v[128:131]
  v_cvt_pk_bf16_f32 v112, v160, v161
  v_cvt_pk_bf16_f32 v113, v162, v163
  v_mfma_f32_16x16x32_bf16 v[136:139], a[64:67], v[48:51], 0
  ds_read_b64_tr_b16 a[100:101], v14 offset:20480
  v_mfma_f32_16x16x32_bf16 v[136:139], a[68:71], v[52:55], v[136:139]
  v_cvt_pk_bf16_f32 v114, v164, v165
  v_cvt_pk_bf16_f32 v115, v166, v167
  v_mfma_f32_16x16x32_bf16 v[136:139], a[72:75], v[56:59], v[136:139]
  ds_read_b64_tr_b16 a[102:103], v14 offset:22528
  v_mfma_f32_16x16x32_bf16 v[136:139], a[76:79], v[60:63], v[136:139]
  buffer_store_dwordx4 v[112:115], v2, s[40:43], s76 offen offset:1024 sc1
  v_mfma_f32_16x16x32_bf16 v[144:147], a[64:67], v[64:67], 0
  ds_read_b64_tr_b16 a[104:105], v14 offset:24576
  v_mfma_f32_16x16x32_bf16 v[144:147], a[68:71], v[68:71], v[144:147]
  v_cvt_pk_bf16_f32 v116, v168, v169
  v_cvt_pk_bf16_f32 v117, v170, v171
  v_mfma_f32_16x16x32_bf16 v[144:147], a[72:75], v[72:75], v[144:147]
  ds_read_b64_tr_b16 a[106:107], v14 offset:26624
  v_mfma_f32_16x16x32_bf16 v[144:147], a[76:79], v[76:79], v[144:147]
  v_cvt_pk_bf16_f32 v118, v172, v173
  v_cvt_pk_bf16_f32 v119, v174, v175
  v_mfma_f32_16x16x32_bf16 v[152:155], a[64:67], v[80:83], 0
  ds_read_b64_tr_b16 a[108:109], v14 offset:28672
  v_mfma_f32_16x16x32_bf16 v[152:155], a[68:71], v[84:87], v[152:155]
  buffer_store_dwordx4 v[116:119], v2, s[40:43], s77 offen offset:1024 sc1
  v_mfma_f32_16x16x32_bf16 v[152:155], a[72:75], v[88:91], v[152:155]
  ds_read_b64_tr_b16 a[110:111], v14 offset:30720
  v_mfma_f32_16x16x32_bf16 v[152:155], a[76:79], v[92:95], v[152:155]
  s_waitcnt lgkmcnt(8)
  v_cvt_pk_bf16_f32 v120, v176, v177
  v_cvt_pk_bf16_f32 v121, v178, v179
  v_mfma_f32_16x16x32_bf16 v[132:135], a[80:83], v[32:35], 0
  ds_read_b64_tr_b16 a[112:113], v15 offset:16384
  v_mfma_f32_16x16x32_bf16 v[132:135], a[84:87], v[36:39], v[132:135]
  v_cvt_pk_bf16_f32 v122, v180, v181
  v_cvt_pk_bf16_f32 v123, v182, v183
  v_mfma_f32_16x16x32_bf16 v[132:135], a[88:91], v[40:43], v[132:135]
  ds_read_b64_tr_b16 a[114:115], v15 offset:18432
  v_mfma_f32_16x16x32_bf16 v[132:135], a[92:95], v[44:47], v[132:135]
  buffer_store_dwordx4 v[120:123], v2, s[40:43], s78 offen offset:1024 sc1
  v_mfma_f32_16x16x32_bf16 v[140:143], a[80:83], v[48:51], 0
  ds_read_b64_tr_b16 a[116:117], v15 offset:20480
  v_mfma_f32_16x16x32_bf16 v[140:143], a[84:87], v[52:55], v[140:143]
  v_cvt_pk_bf16_f32 v124, v184, v185
  v_cvt_pk_bf16_f32 v125, v186, v187
  v_mfma_f32_16x16x32_bf16 v[140:143], a[88:91], v[56:59], v[140:143]
  ds_read_b64_tr_b16 a[118:119], v15 offset:22528
  v_mfma_f32_16x16x32_bf16 v[140:143], a[92:95], v[60:63], v[140:143]
  v_cvt_pk_bf16_f32 v126, v188, v189
  v_cvt_pk_bf16_f32 v127, v190, v191
  v_mfma_f32_16x16x32_bf16 v[148:151], a[80:83], v[64:67], 0
  ds_read_b64_tr_b16 a[120:121], v15 offset:24576
  v_mfma_f32_16x16x32_bf16 v[148:151], a[84:87], v[68:71], v[148:151]
  buffer_store_dwordx4 v[124:127], v2, s[40:43], s79 offen offset:1024 sc1
  v_mfma_f32_16x16x32_bf16 v[148:151], a[88:91], v[72:75], v[148:151]
  ds_read_b64_tr_b16 a[122:123], v15 offset:26624
  v_mfma_f32_16x16x32_bf16 v[148:151], a[92:95], v[76:79], v[148:151]
  v_mfma_f32_16x16x32_bf16 v[156:159], a[80:83], v[80:83], 0
  ds_read_b64_tr_b16 a[124:125], v15 offset:28672
  v_mfma_f32_16x16x32_bf16 v[156:159], a[84:87], v[84:87], v[156:159]
  v_mfma_f32_16x16x32_bf16 v[156:159], a[88:91], v[88:91], v[156:159]
  ds_read_b64_tr_b16 a[126:127], v15 offset:30720
  v_mfma_f32_16x16x32_bf16 v[156:159], a[92:95], v[92:95], v[156:159]
  s_waitcnt lgkmcnt(8)
  v_mfma_f32_16x16x32_bf16 v[160:163], a[96:99], v[32:35], 0
  ds_read_b64_tr_b16 a[64:65], v12 offset:32768
  v_mfma_f32_16x16x32_bf16 v[160:163], a[100:103], v[36:39], v[160:163]
  s_nop 1
  v_mfma_f32_16x16x32_bf16 v[160:163], a[104:107], v[40:43], v[160:163]
  ds_read_b64_tr_b16 a[66:67], v12 offset:34816
  v_mfma_f32_16x16x32_bf16 v[160:163], a[108:111], v[44:47], v[160:163]
  v_cvt_pk_bf16_f32 v96, v128, v129
  v_cvt_pk_bf16_f32 v97, v130, v131
  v_mfma_f32_16x16x32_bf16 v[168:171], a[96:99], v[48:51], 0
  ds_read_b64_tr_b16 a[68:69], v12 offset:36864
  v_mfma_f32_16x16x32_bf16 v[168:171], a[100:103], v[52:55], v[168:171]
  v_cvt_pk_bf16_f32 v98, v132, v133
  v_cvt_pk_bf16_f32 v99, v134, v135
  v_mfma_f32_16x16x32_bf16 v[168:171], a[104:107], v[56:59], v[168:171]
  ds_read_b64_tr_b16 a[70:71], v12 offset:38912
  v_mfma_f32_16x16x32_bf16 v[168:171], a[108:111], v[60:63], v[168:171]
  buffer_store_dwordx4 v[96:99], v2, s[40:43], s76 offen offset:2048 sc1
  v_mfma_f32_16x16x32_bf16 v[176:179], a[96:99], v[64:67], 0
  ds_read_b64_tr_b16 a[72:73], v12 offset:40960
  v_mfma_f32_16x16x32_bf16 v[176:179], a[100:103], v[68:71], v[176:179]
  v_cvt_pk_bf16_f32 v100, v136, v137
  v_cvt_pk_bf16_f32 v101, v138, v139
  v_mfma_f32_16x16x32_bf16 v[176:179], a[104:107], v[72:75], v[176:179]
  ds_read_b64_tr_b16 a[74:75], v12 offset:43008
  v_mfma_f32_16x16x32_bf16 v[176:179], a[108:111], v[76:79], v[176:179]
  v_cvt_pk_bf16_f32 v102, v140, v141
  v_cvt_pk_bf16_f32 v103, v142, v143
  v_mfma_f32_16x16x32_bf16 v[184:187], a[96:99], v[80:83], 0
  ds_read_b64_tr_b16 a[76:77], v12 offset:45056
  v_mfma_f32_16x16x32_bf16 v[184:187], a[100:103], v[84:87], v[184:187]
  buffer_store_dwordx4 v[100:103], v2, s[40:43], s77 offen offset:2048 sc1
  v_mfma_f32_16x16x32_bf16 v[184:187], a[104:107], v[88:91], v[184:187]
  ds_read_b64_tr_b16 a[78:79], v12 offset:47104
  v_mfma_f32_16x16x32_bf16 v[184:187], a[108:111], v[92:95], v[184:187]
  s_waitcnt lgkmcnt(8)
  v_cvt_pk_bf16_f32 v104, v144, v145
  v_cvt_pk_bf16_f32 v105, v146, v147
  v_mfma_f32_16x16x32_bf16 v[164:167], a[112:115], v[32:35], 0
  ds_read_b64_tr_b16 a[80:81], v13 offset:32768
  v_mfma_f32_16x16x32_bf16 v[164:167], a[116:119], v[36:39], v[164:167]
  v_cvt_pk_bf16_f32 v106, v148, v149
  v_cvt_pk_bf16_f32 v107, v150, v151
  v_mfma_f32_16x16x32_bf16 v[164:167], a[120:123], v[40:43], v[164:167]
  ds_read_b64_tr_b16 a[82:83], v13 offset:34816
  v_mfma_f32_16x16x32_bf16 v[164:167], a[124:127], v[44:47], v[164:167]
  buffer_store_dwordx4 v[104:107], v2, s[40:43], s78 offen offset:2048 sc1
  v_mfma_f32_16x16x32_bf16 v[172:175], a[112:115], v[48:51], 0
  ds_read_b64_tr_b16 a[84:85], v13 offset:36864
  v_mfma_f32_16x16x32_bf16 v[172:175], a[116:119], v[52:55], v[172:175]
  v_cvt_pk_bf16_f32 v108, v152, v153
  v_cvt_pk_bf16_f32 v109, v154, v155
  v_mfma_f32_16x16x32_bf16 v[172:175], a[120:123], v[56:59], v[172:175]
  ds_read_b64_tr_b16 a[86:87], v13 offset:38912
  v_mfma_f32_16x16x32_bf16 v[172:175], a[124:127], v[60:63], v[172:175]
  v_cvt_pk_bf16_f32 v110, v156, v157
  v_cvt_pk_bf16_f32 v111, v158, v159
  v_mfma_f32_16x16x32_bf16 v[180:183], a[112:115], v[64:67], 0
  ds_read_b64_tr_b16 a[88:89], v13 offset:40960
  v_mfma_f32_16x16x32_bf16 v[180:183], a[116:119], v[68:71], v[180:183]
  buffer_store_dwordx4 v[108:111], v2, s[40:43], s79 offen offset:2048 sc1
  v_mfma_f32_16x16x32_bf16 v[180:183], a[120:123], v[72:75], v[180:183]
  ds_read_b64_tr_b16 a[90:91], v13 offset:43008
  v_mfma_f32_16x16x32_bf16 v[180:183], a[124:127], v[76:79], v[180:183]
  v_mfma_f32_16x16x32_bf16 v[188:191], a[112:115], v[80:83], 0
  ds_read_b64_tr_b16 a[92:93], v13 offset:45056
  v_mfma_f32_16x16x32_bf16 v[188:191], a[116:119], v[84:87], v[188:191]
  v_mfma_f32_16x16x32_bf16 v[188:191], a[120:123], v[88:91], v[188:191]
  ds_read_b64_tr_b16 a[94:95], v13 offset:47104
  v_mfma_f32_16x16x32_bf16 v[188:191], a[124:127], v[92:95], v[188:191]
  s_waitcnt lgkmcnt(8)
  v_mfma_f32_16x16x32_bf16 v[128:131], a[64:67], v[32:35], 0
  ds_read_b64_tr_b16 a[96:97], v14 offset:32768
  v_mfma_f32_16x16x32_bf16 v[128:131], a[68:71], v[36:39], v[128:131]
  s_nop 1
  v_mfma_f32_16x16x32_bf16 v[128:131], a[72:75], v[40:43], v[128:131]
  ds_read_b64_tr_b16 a[98:99], v14 offset:34816
  v_mfma_f32_16x16x32_bf16 v[128:131], a[76:79], v[44:47], v[128:131]
  v_cvt_pk_bf16_f32 v112, v160, v161
  v_cvt_pk_bf16_f32 v113, v162, v163
  v_mfma_f32_16x16x32_bf16 v[136:139], a[64:67], v[48:51], 0
  ds_read_b64_tr_b16 a[100:101], v14 offset:36864
  v_mfma_f32_16x16x32_bf16 v[136:139], a[68:71], v[52:55], v[136:139]
  v_cvt_pk_bf16_f32 v114, v164, v165
  v_cvt_pk_bf16_f32 v115, v166, v167
  v_mfma_f32_16x16x32_bf16 v[136:139], a[72:75], v[56:59], v[136:139]
  ds_read_b64_tr_b16 a[102:103], v14 offset:38912
  v_mfma_f32_16x16x32_bf16 v[136:139], a[76:79], v[60:63], v[136:139]
  buffer_store_dwordx4 v[112:115], v2, s[40:43], s76 offen offset:3072 sc1
  v_mfma_f32_16x16x32_bf16 v[144:147], a[64:67], v[64:67], 0
  ds_read_b64_tr_b16 a[104:105], v14 offset:40960
  v_mfma_f32_16x16x32_bf16 v[144:147], a[68:71], v[68:71], v[144:147]
  v_cvt_pk_bf16_f32 v116, v168, v169
  v_cvt_pk_bf16_f32 v117, v170, v171
  v_mfma_f32_16x16x32_bf16 v[144:147], a[72:75], v[72:75], v[144:147]
  ds_read_b64_tr_b16 a[106:107], v14 offset:43008
  v_mfma_f32_16x16x32_bf16 v[144:147], a[76:79], v[76:79], v[144:147]
  v_cvt_pk_bf16_f32 v118, v172, v173
  v_cvt_pk_bf16_f32 v119, v174, v175
  v_mfma_f32_16x16x32_bf16 v[152:155], a[64:67], v[80:83], 0
  ds_read_b64_tr_b16 a[108:109], v14 offset:45056
  v_mfma_f32_16x16x32_bf16 v[152:155], a[68:71], v[84:87], v[152:155]
  buffer_store_dwordx4 v[116:119], v2, s[40:43], s77 offen offset:3072 sc1
  v_mfma_f32_16x16x32_bf16 v[152:155], a[72:75], v[88:91], v[152:155]
  ds_read_b64_tr_b16 a[110:111], v14 offset:47104
  v_mfma_f32_16x16x32_bf16 v[152:155], a[76:79], v[92:95], v[152:155]
  s_waitcnt lgkmcnt(8)
  v_cvt_pk_bf16_f32 v120, v176, v177
  v_cvt_pk_bf16_f32 v121, v178, v179
  v_mfma_f32_16x16x32_bf16 v[132:135], a[80:83], v[32:35], 0
  ds_read_b64_tr_b16 a[112:113], v15 offset:32768
  v_mfma_f32_16x16x32_bf16 v[132:135], a[84:87], v[36:39], v[132:135]
  v_cvt_pk_bf16_f32 v122, v180, v181
  v_cvt_pk_bf16_f32 v123, v182, v183
  v_mfma_f32_16x16x32_bf16 v[132:135], a[88:91], v[40:43], v[132:135]
  ds_read_b64_tr_b16 a[114:115], v15 offset:34816
  v_mfma_f32_16x16x32_bf16 v[132:135], a[92:95], v[44:47], v[132:135]
  buffer_store_dwordx4 v[120:123], v2, s[40:43], s78 offen offset:3072 sc1
  v_mfma_f32_16x16x32_bf16 v[140:143], a[80:83], v[48:51], 0
  ds_read_b64_tr_b16 a[116:117], v15 offset:36864
  v_mfma_f32_16x16x32_bf16 v[140:143], a[84:87], v[52:55], v[140:143]
  v_cvt_pk_bf16_f32 v124, v184, v185
  v_cvt_pk_bf16_f32 v125, v186, v187
  v_mfma_f32_16x16x32_bf16 v[140:143], a[88:91], v[56:59], v[140:143]
  ds_read_b64_tr_b16 a[118:119], v15 offset:38912
  v_mfma_f32_16x16x32_bf16 v[140:143], a[92:95], v[60:63], v[140:143]
  v_cvt_pk_bf16_f32 v126, v188, v189
  v_cvt_pk_bf16_f32 v127, v190, v191
  v_mfma_f32_16x16x32_bf16 v[148:151], a[80:83], v[64:67], 0
  ds_read_b64_tr_b16 a[120:121], v15 offset:40960
  v_mfma_f32_16x16x32_bf16 v[148:151], a[84:87], v[68:71], v[148:151]
  buffer_store_dwordx4 v[124:127], v2, s[40:43], s79 offen offset:3072 sc1
  v_mfma_f32_16x16x32_bf16 v[148:151], a[88:91], v[72:75], v[148:151]
  ds_read_b64_tr_b16 a[122:123], v15 offset:43008
  v_mfma_f32_16x16x32_bf16 v[148:151], a[92:95], v[76:79], v[148:151]
  v_mfma_f32_16x16x32_bf16 v[156:159], a[80:83], v[80:83], 0
  ds_read_b64_tr_b16 a[124:125], v15 offset:45056
  v_mfma_f32_16x16x32_bf16 v[156:159], a[84:87], v[84:87], v[156:159]
  v_mfma_f32_16x16x32_bf16 v[156:159], a[88:91], v[88:91], v[156:159]
  s_waitcnt vmcnt(32)
  s_barrier
  ds_read_b64_tr_b16 a[126:127], v15 offset:47104
  v_mfma_f32_16x16x32_bf16 v[156:159], a[92:95], v[92:95], v[156:159]
  s_waitcnt lgkmcnt(8)
  v_mfma_f32_16x16x32_bf16 v[160:163], a[96:99], v[32:35], 0
  ds_read_b64_tr_b16 a[64:65], v12 offset:49152
  v_mfma_f32_16x16x32_bf16 v[160:163], a[100:103], v[36:39], v[160:163]
  s_add_u32 s76, s76, 0x1000
  s_add_u32 s77, s77, 0x1000
  s_add_u32 s78, s78, 0x1000
  s_add_u32 s79, s79, 0x1000
  v_mfma_f32_16x16x32_bf16 v[160:163], a[104:107], v[40:43], v[160:163]
  ds_read_b64_tr_b16 a[66:67], v12 offset:51200
  v_mfma_f32_16x16x32_bf16 v[160:163], a[108:111], v[44:47], v[160:163]
  v_cvt_pk_bf16_f32 v96, v128, v129
  v_cvt_pk_bf16_f32 v97, v130, v131
  v_mfma_f32_16x16x32_bf16 v[168:171], a[96:99], v[48:51], 0
  ds_read_b64_tr_b16 a[68:69], v12 offset:53248
  v_mfma_f32_16x16x32_bf16 v[168:171], a[100:103], v[52:55], v[168:171]
  v_cvt_pk_bf16_f32 v98, v132, v133
  v_cvt_pk_bf16_f32 v99, v134, v135
  v_mfma_f32_16x16x32_bf16 v[168:171], a[104:107], v[56:59], v[168:171]
  ds_read_b64_tr_b16 a[70:71], v12 offset:55296
  v_mfma_f32_16x16x32_bf16 v[168:171], a[108:111], v[60:63], v[168:171]
  buffer_store_dwordx4 v[96:99], v2, s[40:43], s76 offen offset:0 sc1
  v_mfma_f32_16x16x32_bf16 v[176:179], a[96:99], v[64:67], 0
  ds_read_b64_tr_b16 a[72:73], v12 offset:57344
  v_mfma_f32_16x16x32_bf16 v[176:179], a[100:103], v[68:71], v[176:179]
  v_cvt_pk_bf16_f32 v100, v136, v137
  v_cvt_pk_bf16_f32 v101, v138, v139
  v_mfma_f32_16x16x32_bf16 v[176:179], a[104:107], v[72:75], v[176:179]
  ds_read_b64_tr_b16 a[74:75], v12 offset:59392
  v_mfma_f32_16x16x32_bf16 v[176:179], a[108:111], v[76:79], v[176:179]
  v_cvt_pk_bf16_f32 v102, v140, v141
  v_cvt_pk_bf16_f32 v103, v142, v143
  v_mfma_f32_16x16x32_bf16 v[184:187], a[96:99], v[80:83], 0
  ds_read_b64_tr_b16 a[76:77], v12 offset:61440
  v_mfma_f32_16x16x32_bf16 v[184:187], a[100:103], v[84:87], v[184:187]
  buffer_store_dwordx4 v[100:103], v2, s[40:43], s77 offen offset:0 sc1
  v_mfma_f32_16x16x32_bf16 v[184:187], a[104:107], v[88:91], v[184:187]
  ds_read_b64_tr_b16 a[78:79], v12 offset:63488
  v_mfma_f32_16x16x32_bf16 v[184:187], a[108:111], v[92:95], v[184:187]
  s_waitcnt lgkmcnt(8)
  v_cvt_pk_bf16_f32 v104, v144, v145
  v_cvt_pk_bf16_f32 v105, v146, v147
  v_mfma_f32_16x16x32_bf16 v[164:167], a[112:115], v[32:35], 0
  ds_read_b64_tr_b16 a[80:81], v13 offset:49152
  v_mfma_f32_16x16x32_bf16 v[164:167], a[116:119], v[36:39], v[164:167]
  v_cvt_pk_bf16_f32 v106, v148, v149
  v_cvt_pk_bf16_f32 v107, v150, v151
  v_mfma_f32_16x16x32_bf16 v[164:167], a[120:123], v[40:43], v[164:167]
  ds_read_b64_tr_b16 a[82:83], v13 offset:51200
  v_mfma_f32_16x16x32_bf16 v[164:167], a[124:127], v[44:47], v[164:167]
  buffer_store_dwordx4 v[104:107], v2, s[40:43], s78 offen offset:0 sc1
  v_mfma_f32_16x16x32_bf16 v[172:175], a[112:115], v[48:51], 0
  ds_read_b64_tr_b16 a[84:85], v13 offset:53248
  v_mfma_f32_16x16x32_bf16 v[172:175], a[116:119], v[52:55], v[172:175]
  v_cvt_pk_bf16_f32 v108, v152, v153
  v_cvt_pk_bf16_f32 v109, v154, v155
  v_mfma_f32_16x16x32_bf16 v[172:175], a[120:123], v[56:59], v[172:175]
  ds_read_b64_tr_b16 a[86:87], v13 offset:55296
  v_mfma_f32_16x16x32_bf16 v[172:175], a[124:127], v[60:63], v[172:175]
  v_cvt_pk_bf16_f32 v110, v156, v157
  v_cvt_pk_bf16_f32 v111, v158, v159
  v_mfma_f32_16x16x32_bf16 v[180:183], a[112:115], v[64:67], 0
  ds_read_b64_tr_b16 a[88:89], v13 offset:57344
  v_mfma_f32_16x16x32_bf16 v[180:183], a[116:119], v[68:71], v[180:183]
  buffer_store_dwordx4 v[108:111], v2, s[40:43], s79 offen offset:0 sc1
  v_mfma_f32_16x16x32_bf16 v[180:183], a[120:123], v[72:75], v[180:183]
  ds_read_b64_tr_b16 a[90:91], v13 offset:59392
  v_mfma_f32_16x16x32_bf16 v[180:183], a[124:127], v[76:79], v[180:183]
  v_mfma_f32_16x16x32_bf16 v[188:191], a[112:115], v[80:83], 0
  ds_read_b64_tr_b16 a[92:93], v13 offset:61440
  v_mfma_f32_16x16x32_bf16 v[188:191], a[116:119], v[84:87], v[188:191]
  v_mfma_f32_16x16x32_bf16 v[188:191], a[120:123], v[88:91], v[188:191]
  ds_read_b64_tr_b16 a[94:95], v13 offset:63488
  v_mfma_f32_16x16x32_bf16 v[188:191], a[124:127], v[92:95], v[188:191]
  s_waitcnt lgkmcnt(8)
  v_mfma_f32_16x16x32_bf16 v[128:131], a[64:67], v[32:35], 0
  ds_read_b64_tr_b16 a[96:97], v14 offset:49152
  v_mfma_f32_16x16x32_bf16 v[128:131], a[68:71], v[36:39], v[128:131]
  s_nop 1
  v_mfma_f32_16x16x32_bf16 v[128:131], a[72:75], v[40:43], v[128:131]
  ds_read_b64_tr_b16 a[98:99], v14 offset:51200
  v_mfma_f32_16x16x32_bf16 v[128:131], a[76:79], v[44:47], v[128:131]
  v_cvt_pk_bf16_f32 v112, v160, v161
  v_cvt_pk_bf16_f32 v113, v162, v163
  v_mfma_f32_16x16x32_bf16 v[136:139], a[64:67], v[48:51], 0
  ds_read_b64_tr_b16 a[100:101], v14 offset:53248
  v_mfma_f32_16x16x32_bf16 v[136:139], a[68:71], v[52:55], v[136:139]
  v_cvt_pk_bf16_f32 v114, v164, v165
  v_cvt_pk_bf16_f32 v115, v166, v167
  v_mfma_f32_16x16x32_bf16 v[136:139], a[72:75], v[56:59], v[136:139]
  ds_read_b64_tr_b16 a[102:103], v14 offset:55296
  v_mfma_f32_16x16x32_bf16 v[136:139], a[76:79], v[60:63], v[136:139]
  buffer_store_dwordx4 v[112:115], v2, s[40:43], s76 offen offset:1024 sc1
  v_mfma_f32_16x16x32_bf16 v[144:147], a[64:67], v[64:67], 0
  ds_read_b64_tr_b16 a[104:105], v14 offset:57344
  v_mfma_f32_16x16x32_bf16 v[144:147], a[68:71], v[68:71], v[144:147]
  v_cvt_pk_bf16_f32 v116, v168, v169
  v_cvt_pk_bf16_f32 v117, v170, v171
  v_mfma_f32_16x16x32_bf16 v[144:147], a[72:75], v[72:75], v[144:147]
  ds_read_b64_tr_b16 a[106:107], v14 offset:59392
  v_mfma_f32_16x16x32_bf16 v[144:147], a[76:79], v[76:79], v[144:147]
  v_cvt_pk_bf16_f32 v118, v172, v173
  v_cvt_pk_bf16_f32 v119, v174, v175
  v_mfma_f32_16x16x32_bf16 v[152:155], a[64:67], v[80:83], 0
  ds_read_b64_tr_b16 a[108:109], v14 offset:61440
  v_mfma_f32_16x16x32_bf16 v[152:155], a[68:71], v[84:87], v[152:155]
  buffer_store_dwordx4 v[116:119], v2, s[40:43], s77 offen offset:1024 sc1
  v_mfma_f32_16x16x32_bf16 v[152:155], a[72:75], v[88:91], v[152:155]
  ds_read_b64_tr_b16 a[110:111], v14 offset:63488
  v_mfma_f32_16x16x32_bf16 v[152:155], a[76:79], v[92:95], v[152:155]
  s_waitcnt lgkmcnt(8)
  v_cvt_pk_bf16_f32 v120, v176, v177
  v_cvt_pk_bf16_f32 v121, v178, v179
  v_mfma_f32_16x16x32_bf16 v[132:135], a[80:83], v[32:35], 0
  ds_read_b64_tr_b16 a[112:113], v15 offset:49152
  v_mfma_f32_16x16x32_bf16 v[132:135], a[84:87], v[36:39], v[132:135]
  v_cvt_pk_bf16_f32 v122, v180, v181
  v_cvt_pk_bf16_f32 v123, v182, v183
  v_mfma_f32_16x16x32_bf16 v[132:135], a[88:91], v[40:43], v[132:135]
  ds_read_b64_tr_b16 a[114:115], v15 offset:51200
  v_mfma_f32_16x16x32_bf16 v[132:135], a[92:95], v[44:47], v[132:135]
  buffer_store_dwordx4 v[120:123], v2, s[40:43], s78 offen offset:1024 sc1
  v_mfma_f32_16x16x32_bf16 v[140:143], a[80:83], v[48:51], 0
  ds_read_b64_tr_b16 a[116:117], v15 offset:53248
  v_mfma_f32_16x16x32_bf16 v[140:143], a[84:87], v[52:55], v[140:143]
  v_cvt_pk_bf16_f32 v124, v184, v185
  v_cvt_pk_bf16_f32 v125, v186, v187
  v_mfma_f32_16x16x32_bf16 v[140:143], a[88:91], v[56:59], v[140:143]
  ds_read_b64_tr_b16 a[118:119], v15 offset:55296
  v_mfma_f32_16x16x32_bf16 v[140:143], a[92:95], v[60:63], v[140:143]
  v_cvt_pk_bf16_f32 v126, v188, v189
  v_cvt_pk_bf16_f32 v127, v190, v191
  v_mfma_f32_16x16x32_bf16 v[148:151], a[80:83], v[64:67], 0
  ds_read_b64_tr_b16 a[120:121], v15 offset:57344
  v_mfma_f32_16x16x32_bf16 v[148:151], a[84:87], v[68:71], v[148:151]
  buffer_store_dwordx4 v[124:127], v2, s[40:43], s79 offen offset:1024 sc1
  v_mfma_f32_16x16x32_bf16 v[148:151], a[88:91], v[72:75], v[148:151]
  ds_read_b64_tr_b16 a[122:123], v15 offset:59392
  v_mfma_f32_16x16x32_bf16 v[148:151], a[92:95], v[76:79], v[148:151]
  v_mfma_f32_16x16x32_bf16 v[156:159], a[80:83], v[80:83], 0
  ds_read_b64_tr_b16 a[124:125], v15 offset:61440
  v_mfma_f32_16x16x32_bf16 v[156:159], a[84:87], v[84:87], v[156:159]
  v_mfma_f32_16x16x32_bf16 v[156:159], a[88:91], v[88:91], v[156:159]
  ds_read_b64_tr_b16 a[126:127], v15 offset:63488
  v_mfma_f32_16x16x32_bf16 v[156:159], a[92:95], v[92:95], v[156:159]
  s_waitcnt lgkmcnt(8)
  v_mfma_f32_16x16x32_bf16 v[160:163], a[96:99], v[32:35], 0
  v_mfma_f32_16x16x32_bf16 v[160:163], a[100:103], v[36:39], v[160:163]
  s_nop 1
  v_mfma_f32_16x16x32_bf16 v[160:163], a[104:107], v[40:43], v[160:163]
  v_mfma_f32_16x16x32_bf16 v[160:163], a[108:111], v[44:47], v[160:163]
  v_cvt_pk_bf16_f32 v96, v128, v129
  v_cvt_pk_bf16_f32 v97, v130, v131
  v_mfma_f32_16x16x32_bf16 v[168:171], a[96:99], v[48:51], 0
  v_mfma_f32_16x16x32_bf16 v[168:171], a[100:103], v[52:55], v[168:171]
  v_cvt_pk_bf16_f32 v98, v132, v133
  v_cvt_pk_bf16_f32 v99, v134, v135
  v_mfma_f32_16x16x32_bf16 v[168:171], a[104:107], v[56:59], v[168:171]
  v_mfma_f32_16x16x32_bf16 v[168:171], a[108:111], v[60:63], v[168:171]
  buffer_store_dwordx4 v[96:99], v2, s[40:43], s76 offen offset:2048 sc1
  v_mfma_f32_16x16x32_bf16 v[176:179], a[96:99], v[64:67], 0
  v_mfma_f32_16x16x32_bf16 v[176:179], a[100:103], v[68:71], v[176:179]
  v_cvt_pk_bf16_f32 v100, v136, v137
  v_cvt_pk_bf16_f32 v101, v138, v139
  v_mfma_f32_16x16x32_bf16 v[176:179], a[104:107], v[72:75], v[176:179]
  v_mfma_f32_16x16x32_bf16 v[176:179], a[108:111], v[76:79], v[176:179]
  v_cvt_pk_bf16_f32 v102, v140, v141
  v_cvt_pk_bf16_f32 v103, v142, v143
  v_mfma_f32_16x16x32_bf16 v[184:187], a[96:99], v[80:83], 0
  v_mfma_f32_16x16x32_bf16 v[184:187], a[100:103], v[84:87], v[184:187]
  buffer_store_dwordx4 v[100:103], v2, s[40:43], s77 offen offset:2048 sc1
  v_mfma_f32_16x16x32_bf16 v[184:187], a[104:107], v[88:91], v[184:187]
  v_mfma_f32_16x16x32_bf16 v[184:187], a[108:111], v[92:95], v[184:187]
  s_waitcnt lgkmcnt(0)
  v_cvt_pk_bf16_f32 v104, v144, v145
  v_cvt_pk_bf16_f32 v105, v146, v147
  v_mfma_f32_16x16x32_bf16 v[164:167], a[112:115], v[32:35], 0
  v_mfma_f32_16x16x32_bf16 v[164:167], a[116:119], v[36:39], v[164:167]
  v_cvt_pk_bf16_f32 v106, v148, v149
  v_cvt_pk_bf16_f32 v107, v150, v151
  v_mfma_f32_16x16x32_bf16 v[164:167], a[120:123], v[40:43], v[164:167]
  v_mfma_f32_16x16x32_bf16 v[164:167], a[124:127], v[44:47], v[164:167]
  buffer_store_dwordx4 v[104:107], v2, s[40:43], s78 offen offset:2048 sc1
  v_mfma_f32_16x16x32_bf16 v[172:175], a[112:115], v[48:51], 0
  v_mfma_f32_16x16x32_bf16 v[172:175], a[116:119], v[52:55], v[172:175]
  v_cvt_pk_bf16_f32 v108, v152, v153
  v_cvt_pk_bf16_f32 v109, v154, v155
  v_mfma_f32_16x16x32_bf16 v[172:175], a[120:123], v[56:59], v[172:175]
  v_mfma_f32_16x16x32_bf16 v[172:175], a[124:127], v[60:63], v[172:175]
  v_cvt_pk_bf16_f32 v110, v156, v157
  v_cvt_pk_bf16_f32 v111, v158, v159
  v_mfma_f32_16x16x32_bf16 v[180:183], a[112:115], v[64:67], 0
  v_mfma_f32_16x16x32_bf16 v[180:183], a[116:119], v[68:71], v[180:183]
  buffer_store_dwordx4 v[108:111], v2, s[40:43], s79 offen offset:2048 sc1
  v_mfma_f32_16x16x32_bf16 v[180:183], a[120:123], v[72:75], v[180:183]
  v_mfma_f32_16x16x32_bf16 v[180:183], a[124:127], v[76:79], v[180:183]
  v_mfma_f32_16x16x32_bf16 v[188:191], a[112:115], v[80:83], 0
  v_mfma_f32_16x16x32_bf16 v[188:191], a[116:119], v[84:87], v[188:191]
  v_mfma_f32_16x16x32_bf16 v[188:191], a[120:123], v[88:91], v[188:191]
  v_mfma_f32_16x16x32_bf16 v[188:191], a[124:127], v[92:95], v[188:191]
  s_nop 7
  v_cvt_pk_bf16_f32 v112, v160, v161
  v_cvt_pk_bf16_f32 v113, v162, v163
  v_cvt_pk_bf16_f32 v114, v164, v165
  v_cvt_pk_bf16_f32 v115, v166, v167
  buffer_store_dwordx4 v[112:115], v2, s[40:43], s76 offen offset:3072 sc1
  v_cvt_pk_bf16_f32 v116, v168, v169
  v_cvt_pk_bf16_f32 v117, v170, v171
  v_cvt_pk_bf16_f32 v118, v172, v173
  v_cvt_pk_bf16_f32 v119, v174, v175
  buffer_store_dwordx4 v[116:119], v2, s[40:43], s77 offen offset:3072 sc1
  v_cvt_pk_bf16_f32 v120, v176, v177
  v_cvt_pk_bf16_f32 v121, v178, v179
  v_cvt_pk_bf16_f32 v122, v180, v181
  v_cvt_pk_bf16_f32 v123, v182, v183
  buffer_store_dwordx4 v[120:123], v2, s[40:43], s78 offen offset:3072 sc1
  v_cvt_pk_bf16_f32 v124, v184, v185
  v_cvt_pk_bf16_f32 v125, v186, v187
  v_cvt_pk_bf16_f32 v126, v188, v189
  v_cvt_pk_bf16_f32 v127, v190, v191
  buffer_store_dwordx4 v[124:127], v2, s[40:43], s79 offen offset:3072 sc1
  s_lshl_b32 s66, s57, 7
  s_add_u32 s66, s66, 0xd086000
  s_cmp_eq_u32 s44, 0
  s_cselect_b32 s66, s66, 0x40000000
  v_mov_b32 v6, 1
  s_waitcnt vmcnt(0)
  s_barrier
  s_mov_b64 exec, 1
  buffer_atomic_add v6, v2, s[40:43], s66 offen
  s_mov_b64 exec, -1
  s_branch L_att_end
L_a_s1_t:
  s_mov_b32 s71, 0
  s_nop 6
  s_branch L_a_slow0_0
L_a_s0_t:
  s_mov_b32 s71, 1
  s_nop 6
  s_branch L_a_slow1_0
L_a_d0_t:
  s_mov_b32 s71, 2
  s_nop 6
  s_branch L_a_slow0_0
L_a_d1_t:
  s_mov_b32 s71, 3
  s_nop 6
  s_branch L_a_slow1_0
L_a_d2_t:
  s_mov_b32 s71, 4
  s_nop 6
  s_branch L_a_slow0_1
L_a_d3_t:
  s_mov_b32 s71, 5
  s_nop 6
  s_branch L_a_slow1_1
L_a_d4_t:
  s_mov_b32 s71, 6
  s_nop 6
  s_branch L_a_slow0_2
L_a_d5_t:
  s_mov_b32 s71, 7
  s_nop 6
  s_branch L_a_slow1_2
L_a_d6_t:
  s_mov_b32 s71, 8
  s_nop 6
  s_branch L_a_slow0_3
L_a_d7_t:
  s_mov_b32 s71, 9
  s_nop 6
  s_branch L_a_slow1_3
L_a_slow0_0:
  v_max3_f32 v6, v32, v33, v34
  v_max3_f32 v7, v35, v36, v37
  v_max3_f32 v6, v6, v38, v39
  v_max_f32 v6, v6, v7
  v_mov_b32 v7, v6
  s_nop 1
  v_permlane32_swap_b32 v7, v6
  v_max_f32 v6, v6, v7
  v_mov_b32 v7, v6
  s_nop 1
  v_permlane16_swap_b32 v7, v6
  v_max_f32 v6, v6, v7
  v_add_f32 v6, 0x41800000, v6
  v_max_f32 v6, 0, v6
  v_exp_f32 v7, -v6
  v_sub_f32 v96, v96, v6
  v_sub_f32 v97, v97, v6
  v_sub_f32 v98, v98, v6
  v_sub_f32 v99, v99, v6
  v_sub_f32 v100, v100, v6
  v_sub_f32 v101, v101, v6
  v_sub_f32 v102, v102, v6
  v_sub_f32 v103, v103, v6
  v_mul_f32 v128, v128, v7
  v_mul_f32 v129, v129, v7
  v_mul_f32 v130, v130, v7
  v_mul_f32 v131, v131, v7
  v_mul_f32 v132, v132, v7
  v_mul_f32 v133, v133, v7
  v_mul_f32 v134, v134, v7
  v_mul_f32 v135, v135, v7
  v_mul_f32 v136, v136, v7
  v_mul_f32 v137, v137, v7
  v_mul_f32 v138, v138, v7
  v_mul_f32 v139, v139, v7
  v_mul_f32 v140, v140, v7
  v_mul_f32 v141, v141, v7
  v_mul_f32 v142, v142, v7
  v_mul_f32 v143, v143, v7
  v_mul_f32 v144, v144, v7
  v_mul_f32 v145, v145, v7
  v_mul_f32 v146, v146, v7
  v_mul_f32 v147, v147, v7
  v_mul_f32 v148, v148, v7
  v_mul_f32 v149, v149, v7
  v_mul_f32 v150, v150, v7
  v_mul_f32 v151, v151, v7
  v_mul_f32 v152, v152, v7
  v_mul_f32 v153, v153, v7
  v_mul_f32 v154, v154, v7
  v_mul_f32 v155, v155, v7
  v_mul_f32 v156, v156, v7
  v_mul_f32 v157, v157, v7
  v_mul_f32 v158, v158, v7
  v_mul_f32 v159, v159, v7
  v_accvgpr_read_b32 v8, a128
  v_mul_f32 v8, v8, v7
  v_accvgpr_write_b32 a128, v8
  v_accvgpr_read_b32 v8, a129
  v_mul_f32 v8, v8, v7
  v_accvgpr_write_b32 a129, v8
  v_accvgpr_read_b32 v8, a130
  v_mul_f32 v8, v8, v7
  v_accvgpr_write_b32 a130, v8
  v_accvgpr_read_b32 v8, a131
  v_mul_f32 v8, v8, v7
  v_accvgpr_write_b32 a131, v8
  v_sub_f32 v8, v32, v6
  v_sub_f32 v9, v33, v6
  v_sub_f32 v10, v34, v6
  v_sub_f32 v11, v35, v6
  v_sub_f32 v12, v36, v6
  v_sub_f32 v13, v37, v6
  v_sub_f32 v14, v38, v6
  v_sub_f32 v15, v39, v6
  v_exp_f32 v8, v8
  v_exp_f32 v9, v9
  v_exp_f32 v10, v10
  v_exp_f32 v11, v11
  v_exp_f32 v12, v12
  v_exp_f32 v13, v13
  v_exp_f32 v14, v14
  v_exp_f32 v15, v15
  v_cvt_pk_bf16_f32 v64, v8, v9
  v_cvt_pk_bf16_f32 v65, v10, v11
  v_cvt_pk_bf16_f32 v66, v12, v13
  v_cvt_pk_bf16_f32 v67, v14, v15
L_a_slow0_1:
  v_max3_f32 v6, v40, v41, v42
  v_max3_f32 v7, v43, v44, v45
  v_max3_f32 v6, v6, v46, v47
  v_max_f32 v6, v6, v7
  v_mov_b32 v7, v6
  s_nop 1
  v_permlane32_swap_b32 v7, v6
  v_max_f32 v6, v6, v7
  v_mov_b32 v7, v6
  s_nop 1
  v_permlane16_swap_b32 v7, v6
  v_max_f32 v6, v6, v7
  v_add_f32 v6, 0x41800000, v6
  v_max_f32 v6, 0, v6
  v_exp_f32 v7, -v6
  v_sub_f32 v104, v104, v6
  v_sub_f32 v105, v105, v6
  v_sub_f32 v106, v106, v6
  v_sub_f32 v107, v107, v6
  v_sub_f32 v108, v108, v6
  v_sub_f32 v109, v109, v6
  v_sub_f32 v110, v110, v6
  v_sub_f32 v111, v111, v6
  v_mul_f32 v160, v160, v7
  v_mul_f32 v161, v161, v7
  v_mul_f32 v162, v162, v7
  v_mul_f32 v163, v163, v7
  v_mul_f32 v164, v164, v7
  v_mul_f32 v165, v165, v7
  v_mul_f32 v166, v166, v7
  v_mul_f32 v167, v167, v7
  v_mul_f32 v168, v168, v7
  v_mul_f32 v169, v169, v7
  v_mul_f32 v170, v170, v7
  v_mul_f32 v171, v171, v7
  v_mul_f32 v172, v172, v7
  v_mul_f32 v173, v173, v7
  v_mul_f32 v174, v174, v7
  v_mul_f32 v175, v175, v7
  v_mul_f32 v176, v176, v7
  v_mul_f32 v177, v177, v7
  v_mul_f32 v178, v178, v7
  v_mul_f32 v179, v179, v7
  v_mul_f32 v180, v180, v7
  v_mul_f32 v181, v181, v7
  v_mul_f32 v182, v182, v7
  v_mul_f32 v183, v183, v7
  v_mul_f32 v184, v184, v7
  v_mul_f32 v185, v185, v7
  v_mul_f32 v186, v186, v7
  v_mul_f32 v187, v187, v7
  v_mul_f32 v188, v188, v7
  v_mul_f32 v189, v189, v7
  v_mul_f32 v190, v190, v7
  v_mul_f32 v191, v191, v7
  v_accvgpr_read_b32 v8, a132
  v_mul_f32 v8, v8, v7
  v_accvgpr_write_b32 a132, v8
  v_accvgpr_read_b32 v8, a133
  v_mul_f32 v8, v8, v7
  v_accvgpr_write_b32 a133, v8
  v_accvgpr_read_b32 v8, a134
  v_mul_f32 v8, v8, v7
  v_accvgpr_write_b32 a134, v8
  v_accvgpr_read_b32 v8, a135
  v_mul_f32 v8, v8, v7
  v_accvgpr_write_b32 a135, v8
  v_sub_f32 v8, v40, v6
  v_sub_f32 v9, v41, v6
  v_sub_f32 v10, v42, v6
  v_sub_f32 v11, v43, v6
  v_sub_f32 v12, v44, v6
  v_sub_f32 v13, v45, v6
  v_sub_f32 v14, v46, v6
  v_sub_f32 v15, v47, v6
  v_exp_f32 v8, v8
  v_exp_f32 v9, v9
  v_exp_f32 v10, v10
  v_exp_f32 v11, v11
  v_exp_f32 v12, v12
  v_exp_f32 v13, v13
  v_exp_f32 v14, v14
  v_exp_f32 v15, v15
  v_cvt_pk_bf16_f32 v68, v8, v9
  v_cvt_pk_bf16_f32 v69, v10, v11
  v_cvt_pk_bf16_f32 v70, v12, v13
  v_cvt_pk_bf16_f32 v71, v14, v15
L_a_slow0_2:
  v_max3_f32 v6, v48, v49, v50
  v_max3_f32 v7, v51, v52, v53
  v_max3_f32 v6, v6, v54, v55
  v_max_f32 v6, v6, v7
  v_mov_b32 v7, v6
  s_nop 1
  v_permlane32_swap_b32 v7, v6
  v_max_f32 v6, v6, v7
  v_mov_b32 v7, v6
  s_nop 1
  v_permlane16_swap_b32 v7, v6
  v_max_f32 v6, v6, v7
  v_add_f32 v6, 0x41800000, v6
  v_max_f32 v6, 0, v6
  v_exp_f32 v7, -v6
  v_sub_f32 v112, v112, v6
  v_sub_f32 v113, v113, v6
  v_sub_f32 v114, v114, v6
  v_sub_f32 v115, v115, v6
  v_sub_f32 v116, v116, v6
  v_sub_f32 v117, v117, v6
  v_sub_f32 v118, v118, v6
  v_sub_f32 v119, v119, v6
  v_mul_f32 v192, v192, v7
  v_mul_f32 v193, v193, v7
  v_mul_f32 v194, v194, v7
  v_mul_f32 v195, v195, v7
  v_mul_f32 v196, v196, v7
  v_mul_f32 v197, v197, v7
  v_mul_f32 v198, v198, v7
  v_mul_f32 v199, v199, v7
  v_mul_f32 v200, v200, v7
  v_mul_f32 v201, v201, v7
  v_mul_f32 v202, v202, v7
  v_mul_f32 v203, v203, v7
  v_mul_f32 v204, v204, v7
  v_mul_f32 v205, v205, v7
  v_mul_f32 v206, v206, v7
  v_mul_f32 v207, v207, v7
  v_mul_f32 v208, v208, v7
  v_mul_f32 v209, v209, v7
  v_mul_f32 v210, v210, v7
  v_mul_f32 v211, v211, v7
  v_mul_f32 v212, v212, v7
  v_mul_f32 v213, v213, v7
  v_mul_f32 v214, v214, v7
  v_mul_f32 v215, v215, v7
  v_mul_f32 v216, v216, v7
  v_mul_f32 v217, v217, v7
  v_mul_f32 v218, v218, v7
  v_mul_f32 v219, v219, v7
  v_mul_f32 v220, v220, v7
  v_mul_f32 v221, v221, v7
  v_mul_f32 v222, v222, v7
  v_mul_f32 v223, v223, v7
  v_accvgpr_read_b32 v8, a136
  v_mul_f32 v8, v8, v7
  v_accvgpr_write_b32 a136, v8
  v_accvgpr_read_b32 v8, a137
  v_mul_f32 v8, v8, v7
  v_accvgpr_write_b32 a137, v8
  v_accvgpr_read_b32 v8, a138
  v_mul_f32 v8, v8, v7
  v_accvgpr_write_b32 a138, v8
  v_accvgpr_read_b32 v8, a139
  v_mul_f32 v8, v8, v7
  v_accvgpr_write_b32 a139, v8
  v_sub_f32 v8, v48, v6
  v_sub_f32 v9, v49, v6
  v_sub_f32 v10, v50, v6
  v_sub_f32 v11, v51, v6
  v_sub_f32 v12, v52, v6
  v_sub_f32 v13, v53, v6
  v_sub_f32 v14, v54, v6
  v_sub_f32 v15, v55, v6
  v_exp_f32 v8, v8
  v_exp_f32 v9, v9
  v_exp_f32 v10, v10
  v_exp_f32 v11, v11
  v_exp_f32 v12, v12
  v_exp_f32 v13, v13
  v_exp_f32 v14, v14
  v_exp_f32 v15, v15
  v_cvt_pk_bf16_f32 v72, v8, v9
  v_cvt_pk_bf16_f32 v73, v10, v11
  v_cvt_pk_bf16_f32 v74, v12, v13
  v_cvt_pk_bf16_f32 v75, v14, v15
L_a_slow0_3:
  v_max3_f32 v6, v56, v57, v58
  v_max3_f32 v7, v59, v60, v61
  v_max3_f32 v6, v6, v62, v63
  v_max_f32 v6, v6, v7
  v_mov_b32 v7, v6
  s_nop 1
  v_permlane32_swap_b32 v7, v6
  v_max_f32 v6, v6, v7
  v_mov_b32 v7, v6
  s_nop 1
  v_permlane16_swap_b32 v7, v6
  v_max_f32 v6, v6, v7
  v_add_f32 v6, 0x41800000, v6
  v_max_f32 v6, 0, v6
  v_exp_f32 v7, -v6
  v_sub_f32 v120, v120, v6
  v_sub_f32 v121, v121, v6
  v_sub_f32 v122, v122, v6
  v_sub_f32 v123, v123, v6
  v_sub_f32 v124, v124, v6
  v_sub_f32 v125, v125, v6
  v_sub_f32 v126, v126, v6
  v_sub_f32 v127, v127, v6
  v_mul_f32 v224, v224, v7
  v_mul_f32 v225, v225, v7
  v_mul_f32 v226, v226, v7
  v_mul_f32 v227, v227, v7
  v_mul_f32 v228, v228, v7
  v_mul_f32 v229, v229, v7
  v_mul_f32 v230, v230, v7
  v_mul_f32 v231, v231, v7
  v_mul_f32 v232, v232, v7
  v_mul_f32 v233, v233, v7
  v_mul_f32 v234, v234, v7
  v_mul_f32 v235, v235, v7
  v_mul_f32 v236, v236, v7
  v_mul_f32 v237, v237, v7
  v_mul_f32 v238, v238, v7
  v_mul_f32 v239, v239, v7
  v_mul_f32 v240, v240, v7
  v_mul_f32 v241, v241, v7
  v_mul_f32 v242, v242, v7
  v_mul_f32 v243, v243, v7
  v_mul_f32 v244, v244, v7
  v_mul_f32 v245, v245, v7
  v_mul_f32 v246, v246, v7
  v_mul_f32 v247, v247, v7
  v_mul_f32 v248, v248, v7
  v_mul_f32 v249, v249, v7
  v_mul_f32 v250, v250, v7
  v_mul_f32 v251, v251, v7
  v_mul_f32 v252, v252, v7
  v_mul_f32 v253, v253, v7
  v_mul_f32 v254, v254, v7
  v_mul_f32 v255, v255, v7
  v_accvgpr_read_b32 v8, a140
  v_mul_f32 v8, v8, v7
  v_accvgpr_write_b32 a140, v8
  v_accvgpr_read_b32 v8, a141
  v_mul_f32 v8, v8, v7
  v_accvgpr_write_b32 a141, v8
  v_accvgpr_read_b32 v8, a142
  v_mul_f32 v8, v8, v7
  v_accvgpr_write_b32 a142, v8
  v_accvgpr_read_b32 v8, a143
  v_mul_f32 v8, v8, v7
  v_accvgpr_write_b32 a143, v8
  v_sub_f32 v8, v56, v6
  v_sub_f32 v9, v57, v6
  v_sub_f32 v10, v58, v6
  v_sub_f32 v11, v59, v6
  v_sub_f32 v12, v60, v6
  v_sub_f32 v13, v61, v6
  v_sub_f32 v14, v62, v6
  v_sub_f32 v15, v63, v6
  v_exp_f32 v8, v8
  v_exp_f32 v9, v9
  v_exp_f32 v10, v10
  v_exp_f32 v11, v11
  v_exp_f32 v12, v12
  v_exp_f32 v13, v13
  v_exp_f32 v14, v14
  v_exp_f32 v15, v15
  v_cvt_pk_bf16_f32 v76, v8, v9
  v_cvt_pk_bf16_f32 v77, v10, v11
  v_cvt_pk_bf16_f32 v78, v12, v13
  v_cvt_pk_bf16_f32 v79, v14, v15
  s_cmp_eq_u32 s71, 0
  s_cbranch_scc1 L_a_s1_r
  s_cmp_eq_u32 s71, 2
  s_cbranch_scc1 L_a_d0_r
  s_cmp_eq_u32 s71, 4
  s_cbranch_scc1 L_a_d2_r
  s_cmp_eq_u32 s71, 6
  s_cbranch_scc1 L_a_d4_r
  s_branch L_a_d6_r
L_a_slow1_0:
  v_max3_f32 v6, v32, v33, v34
  v_max3_f32 v7, v35, v36, v37
  v_max3_f32 v6, v6, v38, v39
  v_max_f32 v6, v6, v7
  v_mov_b32 v7, v6
  s_nop 1
  v_permlane32_swap_b32 v7, v6
  v_max_f32 v6, v6, v7
  v_mov_b32 v7, v6
  s_nop 1
  v_permlane16_swap_b32 v7, v6
  v_max_f32 v6, v6, v7
  v_add_f32 v6, 0x41800000, v6
  v_max_f32 v6, 0, v6
  v_exp_f32 v7, -v6
  v_sub_f32 v96, v96, v6
  v_sub_f32 v97, v97, v6
  v_sub_f32 v98, v98, v6
  v_sub_f32 v99, v99, v6
  v_sub_f32 v100, v100, v6
  v_sub_f32 v101, v101, v6
  v_sub_f32 v102, v102, v6
  v_sub_f32 v103, v103, v6
  v_mul_f32 v128, v128, v7
  v_mul_f32 v129, v129, v7
  v_mul_f32 v130, v130, v7
  v_mul_f32 v131, v131, v7
  v_mul_f32 v132, v132, v7
  v_mul_f32 v133, v133, v7
  v_mul_f32 v134, v134, v7
  v_mul_f32 v135, v135, v7
  v_mul_f32 v136, v136, v7
  v_mul_f32 v137, v137, v7
  v_mul_f32 v138, v138, v7
  v_mul_f32 v139, v139, v7
  v_mul_f32 v140, v140, v7
  v_mul_f32 v141, v141, v7
  v_mul_f32 v142, v142, v7
  v_mul_f32 v143, v143, v7
  v_mul_f32 v144, v144, v7
  v_mul_f32 v145, v145, v7
  v_mul_f32 v146, v146, v7
  v_mul_f32 v147, v147, v7
  v_mul_f32 v148, v148, v7
  v_mul_f32 v149, v149, v7
  v_mul_f32 v150, v150, v7
  v_mul_f32 v151, v151, v7
  v_mul_f32 v152, v152, v7
  v_mul_f32 v153, v153, v7
  v_mul_f32 v154, v154, v7
  v_mul_f32 v155, v155, v7
  v_mul_f32 v156, v156, v7
  v_mul_f32 v157, v157, v7
  v_mul_f32 v158, v158, v7
  v_mul_f32 v159, v159, v7
  v_accvgpr_read_b32 v8, a128
  v_mul_f32 v8, v8, v7
  v_accvgpr_write_b32 a128, v8
  v_accvgpr_read_b32 v8, a129
  v_mul_f32 v8, v8, v7
  v_accvgpr_write_b32 a129, v8
  v_accvgpr_read_b32 v8, a130
  v_mul_f32 v8, v8, v7
  v_accvgpr_write_b32 a130, v8
  v_accvgpr_read_b32 v8, a131
  v_mul_f32 v8, v8, v7
  v_accvgpr_write_b32 a131, v8
  v_sub_f32 v8, v32, v6
  v_sub_f32 v9, v33, v6
  v_sub_f32 v10, v34, v6
  v_sub_f32 v11, v35, v6
  v_sub_f32 v12, v36, v6
  v_sub_f32 v13, v37, v6
  v_sub_f32 v14, v38, v6
  v_sub_f32 v15, v39, v6
  v_exp_f32 v8, v8
  v_exp_f32 v9, v9
  v_exp_f32 v10, v10
  v_exp_f32 v11, v11
  v_exp_f32 v12, v12
  v_exp_f32 v13, v13
  v_exp_f32 v14, v14
  v_exp_f32 v15, v15
  v_cvt_pk_bf16_f32 v80, v8, v9
  v_cvt_pk_bf16_f32 v81, v10, v11
  v_cvt_pk_bf16_f32 v82, v12, v13
  v_cvt_pk_bf16_f32 v83, v14, v15
L_a_slow1_1:
  v_max3_f32 v6, v40, v41, v42
  v_max3_f32 v7, v43, v44, v45
  v_max3_f32 v6, v6, v46, v47
  v_max_f32 v6, v6, v7
  v_mov_b32 v7, v6
  s_nop 1
  v_permlane32_swap_b32 v7, v6
  v_max_f32 v6, v6, v7
  v_mov_b32 v7, v6
  s_nop 1
  v_permlane16_swap_b32 v7, v6
  v_max_f32 v6, v6, v7
  v_add_f32 v6, 0x41800000, v6
  v_max_f32 v6, 0, v6
  v_exp_f32 v7, -v6
  v_sub_f32 v104, v104, v6
  v_sub_f32 v105, v105, v6
  v_sub_f32 v106, v106, v6
  v_sub_f32 v107, v107, v6
  v_sub_f32 v108, v108, v6
  v_sub_f32 v109, v109, v6
  v_sub_f32 v110, v110, v6
  v_sub_f32 v111, v111, v6
  v_mul_f32 v160, v160, v7
  v_mul_f32 v161, v161, v7
  v_mul_f32 v162, v162, v7
  v_mul_f32 v163, v163, v7
  v_mul_f32 v164, v164, v7
  v_mul_f32 v165, v165, v7
  v_mul_f32 v166, v166, v7
  v_mul_f32 v167, v167, v7
  v_mul_f32 v168, v168, v7
  v_mul_f32 v169, v169, v7
  v_mul_f32 v170, v170, v7
  v_mul_f32 v171, v171, v7
  v_mul_f32 v172, v172, v7
  v_mul_f32 v173, v173, v7
  v_mul_f32 v174, v174, v7
  v_mul_f32 v175, v175, v7
  v_mul_f32 v176, v176, v7
  v_mul_f32 v177, v177, v7
  v_mul_f32 v178, v178, v7
  v_mul_f32 v179, v179, v7
  v_mul_f32 v180, v180, v7
  v_mul_f32 v181, v181, v7
  v_mul_f32 v182, v182, v7
  v_mul_f32 v183, v183, v7
  v_mul_f32 v184, v184, v7
  v_mul_f32 v185, v185, v7
  v_mul_f32 v186, v186, v7
  v_mul_f32 v187, v187, v7
  v_mul_f32 v188, v188, v7
  v_mul_f32 v189, v189, v7
  v_mul_f32 v190, v190, v7
  v_mul_f32 v191, v191, v7
  v_accvgpr_read_b32 v8, a132
  v_mul_f32 v8, v8, v7
  v_accvgpr_write_b32 a132, v8
  v_accvgpr_read_b32 v8, a133
  v_mul_f32 v8, v8, v7
  v_accvgpr_write_b32 a133, v8
  v_accvgpr_read_b32 v8, a134
  v_mul_f32 v8, v8, v7
  v_accvgpr_write_b32 a134, v8
  v_accvgpr_read_b32 v8, a135
  v_mul_f32 v8, v8, v7
  v_accvgpr_write_b32 a135, v8
  v_sub_f32 v8, v40, v6
  v_sub_f32 v9, v41, v6
  v_sub_f32 v10, v42, v6
  v_sub_f32 v11, v43, v6
  v_sub_f32 v12, v44, v6
  v_sub_f32 v13, v45, v6
  v_sub_f32 v14, v46, v6
  v_sub_f32 v15, v47, v6
  v_exp_f32 v8, v8
  v_exp_f32 v9, v9
  v_exp_f32 v10, v10
  v_exp_f32 v11, v11
  v_exp_f32 v12, v12
  v_exp_f32 v13, v13
  v_exp_f32 v14, v14
  v_exp_f32 v15, v15
  v_cvt_pk_bf16_f32 v84, v8, v9
  v_cvt_pk_bf16_f32 v85, v10, v11
  v_cvt_pk_bf16_f32 v86, v12, v13
  v_cvt_pk_bf16_f32 v87, v14, v15
L_a_slow1_2:
  v_max3_f32 v6, v48, v49, v50
  v_max3_f32 v7, v51, v52, v53
  v_max3_f32 v6, v6, v54, v55
  v_max_f32 v6, v6, v7
  v_mov_b32 v7, v6
  s_nop 1
  v_permlane32_swap_b32 v7, v6
  v_max_f32 v6, v6, v7
  v_mov_b32 v7, v6
  s_nop 1
  v_permlane16_swap_b32 v7, v6
  v_max_f32 v6, v6, v7
  v_add_f32 v6, 0x41800000, v6
  v_max_f32 v6, 0, v6
  v_exp_f32 v7, -v6
  v_sub_f32 v112, v112, v6
  v_sub_f32 v113, v113, v6
  v_sub_f32 v114, v114, v6
  v_sub_f32 v115, v115, v6
  v_sub_f32 v116, v116, v6
  v_sub_f32 v117, v117, v6
  v_sub_f32 v118, v118, v6
  v_sub_f32 v119, v119, v6
  v_mul_f32 v192, v192, v7
  v_mul_f32 v193, v193, v7
  v_mul_f32 v194, v194, v7
  v_mul_f32 v195, v195, v7
  v_mul_f32 v196, v196, v7
  v_mul_f32 v197, v197, v7
  v_mul_f32 v198, v198, v7
  v_mul_f32 v199, v199, v7
  v_mul_f32 v200, v200, v7
  v_mul_f32 v201, v201, v7
  v_mul_f32 v202, v202, v7
  v_mul_f32 v203, v203, v7
  v_mul_f32 v204, v204, v7
  v_mul_f32 v205, v205, v7
  v_mul_f32 v206, v206, v7
  v_mul_f32 v207, v207, v7
  v_mul_f32 v208, v208, v7
  v_mul_f32 v209, v209, v7
  v_mul_f32 v210, v210, v7
  v_mul_f32 v211, v211, v7
  v_mul_f32 v212, v212, v7
  v_mul_f32 v213, v213, v7
  v_mul_f32 v214, v214, v7
  v_mul_f32 v215, v215, v7
  v_mul_f32 v216, v216, v7
  v_mul_f32 v217, v217, v7
  v_mul_f32 v218, v218, v7
  v_mul_f32 v219, v219, v7
  v_mul_f32 v220, v220, v7
  v_mul_f32 v221, v221, v7
  v_mul_f32 v222, v222, v7
  v_mul_f32 v223, v223, v7
  v_accvgpr_read_b32 v8, a136
  v_mul_f32 v8, v8, v7
  v_accvgpr_write_b32 a136, v8
  v_accvgpr_read_b32 v8, a137
  v_mul_f32 v8, v8, v7
  v_accvgpr_write_b32 a137, v8
  v_accvgpr_read_b32 v8, a138
  v_mul_f32 v8, v8, v7
  v_accvgpr_write_b32 a138, v8
  v_accvgpr_read_b32 v8, a139
  v_mul_f32 v8, v8, v7
  v_accvgpr_write_b32 a139, v8
  v_sub_f32 v8, v48, v6
  v_sub_f32 v9, v49, v6
  v_sub_f32 v10, v50, v6
  v_sub_f32 v11, v51, v6
  v_sub_f32 v12, v52, v6
  v_sub_f32 v13, v53, v6
  v_sub_f32 v14, v54, v6
  v_sub_f32 v15, v55, v6
  v_exp_f32 v8, v8
  v_exp_f32 v9, v9
  v_exp_f32 v10, v10
  v_exp_f32 v11, v11
  v_exp_f32 v12, v12
  v_exp_f32 v13, v13
  v_exp_f32 v14, v14
  v_exp_f32 v15, v15
  v_cvt_pk_bf16_f32 v88, v8, v9
  v_cvt_pk_bf16_f32 v89, v10, v11
  v_cvt_pk_bf16_f32 v90, v12, v13
  v_cvt_pk_bf16_f32 v91, v14, v15
L_a_slow1_3:
  v_max3_f32 v6, v56, v57, v58
  v_max3_f32 v7, v59, v60, v61
  v_max3_f32 v6, v6, v62, v63
  v_max_f32 v6, v6, v7
  v_mov_b32 v7, v6
  s_nop 1
  v_permlane32_swap_b32 v7, v6
  v_max_f32 v6, v6, v7
  v_mov_b32 v7, v6
  s_nop 1
  v_permlane16_swap_b32 v7, v6
  v_max_f32 v6, v6, v7
  v_add_f32 v6, 0x41800000, v6
  v_max_f32 v6, 0, v6
  v_exp_f32 v7, -v6
  v_sub_f32 v120, v120, v6
  v_sub_f32 v121, v121, v6
  v_sub_f32 v122, v122, v6
  v_sub_f32 v123, v123, v6
  v_sub_f32 v124, v124, v6
  v_sub_f32 v125, v125, v6
  v_sub_f32 v126, v126, v6
  v_sub_f32 v127, v127, v6
  v_mul_f32 v224, v224, v7
  v_mul_f32 v225, v225, v7
  v_mul_f32 v226, v226, v7
  v_mul_f32 v227, v227, v7
  v_mul_f32 v228, v228, v7
  v_mul_f32 v229, v229, v7
  v_mul_f32 v230, v230, v7
  v_mul_f32 v231, v231, v7
  v_mul_f32 v232, v232, v7
  v_mul_f32 v233, v233, v7
  v_mul_f32 v234, v234, v7
  v_mul_f32 v235, v235, v7
  v_mul_f32 v236, v236, v7
  v_mul_f32 v237, v237, v7
  v_mul_f32 v238, v238, v7
  v_mul_f32 v239, v239, v7
  v_mul_f32 v240, v240, v7
  v_mul_f32 v241, v241, v7
  v_mul_f32 v242, v242, v7
  v_mul_f32 v243, v243, v7
  v_mul_f32 v244, v244, v7
  v_mul_f32 v245, v245, v7
  v_mul_f32 v246, v246, v7
  v_mul_f32 v247, v247, v7
  v_mul_f32 v248, v248, v7
  v_mul_f32 v249, v249, v7
  v_mul_f32 v250, v250, v7
  v_mul_f32 v251, v251, v7
  v_mul_f32 v252, v252, v7
  v_mul_f32 v253, v253, v7
  v_mul_f32 v254, v254, v7
  v_mul_f32 v255, v255, v7
  v_accvgpr_read_b32 v8, a140
  v_mul_f32 v8, v8, v7
  v_accvgpr_write_b32 a140, v8
  v_accvgpr_read_b32 v8, a141
  v_mul_f32 v8, v8, v7
  v_accvgpr_write_b32 a141, v8
  v_accvgpr_read_b32 v8, a142
  v_mul_f32 v8, v8, v7
  v_accvgpr_write_b32 a142, v8
  v_accvgpr_read_b32 v8, a143
  v_mul_f32 v8, v8, v7
  v_accvgpr_write_b32 a143, v8
  v_sub_f32 v8, v56, v6
  v_sub_f32 v9, v57, v6
  v_sub_f32 v10, v58, v6
  v_sub_f32 v11, v59, v6
  v_sub_f32 v12, v60, v6
  v_sub_f32 v13, v61, v6
  v_sub_f32 v14, v62, v6
  v_sub_f32 v15, v63, v6
  v_exp_f32 v8, v8
  v_exp_f32 v9, v9
  v_exp_f32 v10, v10
  v_exp_f32 v11, v11
  v_exp_f32 v12, v12
  v_exp_f32 v13, v13
  v_exp_f32 v14, v14
  v_exp_f32 v15, v15
  v_cvt_pk_bf16_f32 v92, v8, v9
  v_cvt_pk_bf16_f32 v93, v10, v11
  v_cvt_pk_bf16_f32 v94, v12, v13
  v_cvt_pk_bf16_f32 v95, v14, v15
  s_cmp_eq_u32 s71, 1
  s_cbranch_scc1 L_a_s0_r
  s_cmp_eq_u32 s71, 3
  s_cbranch_scc1 L_a_d1_r
  s_cmp_eq_u32 s71, 5
  s_cbranch_scc1 L_a_d3_r
  s_cmp_eq_u32 s71, 7
  s_cbranch_scc1 L_a_d5_r
  s_branch L_a_d7_r
L_att_end:
  s_branch L_next
L_go_outx:
  s_bfe_u32 s56, s3, 0x40004
  s_bfe_u32 s62, s3, 0x10004
  s_bitcmp1_b32 s3, 3
  s_cbranch_scc1 L_red
L_barr:
  s_mov_b32 s48, s30
  s_and_b32 s49, s31, 0xffff
  s_mov_b32 s50, 0x400000
  s_mov_b32 s51, 0x20000
  v_lshlrev_b32 v2, 4, v0
  v_mov_b32 v7, 0
  s_mov_b32 s57, 0
  v_lshrrev_b32 v3, 4, v0
  v_and_b32 v4, 15, v0
  v_lshlrev_b32 v5, 1, v3
  v_xor_b32 v5, v5, v4
  v_lshlrev_b32 v5, 4, v5
  v_lshl_add_u32 v88, v3, 10, v5
  v_xor_b32 v89, 128, v88
  s_lshl_b32 s66, s44, 15
  s_lshl_b32 s60, s56, 18
  s_lshl_b32 s58, s44, 8
  s_add_u32 s60, s60, s58
  s_add_u32 m0, s66, 0
  s_add_u32 s58, s60, 0
  buffer_load_dwordx4 v88, s[48:51], s58 offen lds
  s_add_u32 m0, s66, 1024
  s_add_u32 s58, s60, 4096
  buffer_load_dwordx4 v89, s[48:51], s58 offen lds
  s_add_u32 m0, s66, 2048
  s_add_u32 s58, s60, 8192
  buffer_load_dwordx4 v88, s[48:51], s58 offen lds
  s_add_u32 m0, s66, 3072
  s_add_u32 s58, s60, 12288
  buffer_load_dwordx4 v89, s[48:51], s58 offen lds
  s_add_u32 m0, s66, 4096
  s_add_u32 s58, s60, 16384
  buffer_load_dwordx4 v88, s[48:51], s58 offen lds
  s_add_u32 m0, s66, 5120
  s_add_u32 s58, s60, 20480
  buffer_load_dwordx4 v89, s[48:51], s58 offen lds
  s_add_u32 m0, s66, 6144
  s_add_u32 s58, s60, 24576
  buffer_load_dwordx4 v88, s[48:51], s58 offen lds
  s_add_u32 m0, s66, 7168
  s_add_u32 s58, s60, 28672
  buffer_load_dwordx4 v89, s[48:51], s58 offen lds
  s_add_u32 m0, s66, 8192
  s_add_u32 s58, s60, 32768
  buffer_load_dwordx4 v88, s[48:51], s58 offen lds
  s_add_u32 m0, s66, 9216
  s_add_u32 s58, s60, 36864
  buffer_load_dwordx4 v89, s[48:51], s58 offen lds
  s_add_u32 m0, s66, 10240
  s_add_u32 s58, s60, 40960
  buffer_load_dwordx4 v88, s[48:51], s58 offen lds
  s_add_u32 m0, s66, 11264
  s_add_u32 s58, s60, 45056
  buffer_load_dwordx4 v89, s[48:51], s58 offen lds
  s_add_u32 m0, s66, 12288
  s_add_u32 s58, s60, 49152
  buffer_load_dwordx4 v88, s[48:51], s58 offen lds
  s_add_u32 m0, s66, 13312
  s_add_u32 s58, s60, 53248
  buffer_load_dwordx4 v89, s[48:51], s58 offen lds
  s_add_u32 m0, s66, 14336
  s_add_u32 s58, s60, 57344
  buffer_load_dwordx4 v88, s[48:51], s58 offen lds
  s_add_u32 m0, s66, 15360
  s_add_u32 s58, s60, 61440
  buffer_load_dwordx4 v89, s[48:51], s58 offen lds
  s_add_u32 m0, s66, 16384
  s_add_u32 s58, s60, 65536
  buffer_load_dwordx4 v88, s[48:51], s58 offen lds
  s_add_u32 m0, s66, 17408
  s_add_u32 s58, s60, 69632
  buffer_load_dwordx4 v89, s[48:51], s58 offen lds
  s_add_u32 m0, s66, 18432
  s_add_u32 s58, s60, 73728
  buffer_load_dwordx4 v88, s[48:51], s58 offen lds
  s_add_u32 m0, s66, 19456
  s_add_u32 s58, s60, 77824
  buffer_load_dwordx4 v89, s[48:51], s58 offen lds
  s_add_u32 m0, s66, 20480
  s_add_u32 s58, s60, 81920
  buffer_load_dwordx4 v88, s[48:51], s58 offen lds
  s_add_u32 m0, s66, 21504
  s_add_u32 s58, s60, 86016
  buffer_load_dwordx4 v89, s[48:51], s58 offen lds
  s_add_u32 m0, s66, 22528
  s_add_u32 s58, s60, 90112
  buffer_load_dwordx4 v88, s[48:51], s58 offen lds
  s_add_u32 m0, s66, 23552
  s_add_u32 s58, s60, 94208
  buffer_load_dwordx4 v89, s[48:51], s58 offen lds
  s_add_u32 m0, s66, 24576
  s_add_u32 s58, s60, 98304
  buffer_load_dwordx4 v88, s[48:51], s58 offen lds
  s_add_u32 m0, s66, 25600
  s_add_u32 s58, s60, 102400
  buffer_load_dwordx4 v89, s[48:51], s58 offen lds
  s_add_u32 m0, s66, 26624
  s_add_u32 s58, s60, 106496
  buffer_load_dwordx4 v88, s[48:51], s58 offen lds
  s_add_u32 m0, s66, 27648
  s_add_u32 s58, s60, 110592
  buffer_load_dwordx4 v89, s[48:51], s58 offen lds
  s_add_u32 m0, s66, 28672
  s_add_u32 s58, s60, 114688
  buffer_load_dwordx4 v88, s[48:51], s58 offen lds
  s_add_u32 m0, s66, 29696
  s_add_u32 s58, s60, 118784
  buffer_load_dwordx4 v89, s[48:51], s58 offen lds
  s_add_u32 m0, s66, 30720
  s_add_u32 s58, s60, 122880
  buffer_load_dwordx4 v88, s[48:51], s58 offen lds
  s_add_u32 m0, s66, 31744
  s_add_u32 s58, s60, 126976
  buffer_load_dwordx4 v89, s[48:51], s58 offen lds
  v_lshrrev_b32 v5, 2, v0
  v_lshl_add_u32 v104, v5, 8, s66
  v_and_b32 v5, 7, v5
  v_lshl_add_u32 v104, v5, 5, v104
  v_and_b32 v5, 3, v0
  v_lshl_add_u32 v104, v5, 3, v104
  v_xor_b32 v105, 32, v104
  v_xor_b32 v106, 64, v104
  v_xor_b32 v107, 96, v104
  v_xor_b32 v108, 128, v104
  v_xor_b32 v109, 160, v104
  v_xor_b32 v110, 192, v104
  v_xor_b32 v111, 224, v104
  s_waitcnt vmcnt(24)
  ds_read_b64_tr_b16 a[0:1], v104 offset:0
  ds_read_b64_tr_b16 a[2:3], v104 offset:4096
  ds_read_b64_tr_b16 a[32:33], v105 offset:0
  ds_read_b64_tr_b16 a[34:35], v105 offset:4096
  ds_read_b64_tr_b16 a[64:65], v106 offset:0
  ds_read_b64_tr_b16 a[66:67], v106 offset:4096
  ds_read_b64_tr_b16 a[96:97], v107 offset:0
  ds_read_b64_tr_b16 a[98:99], v107 offset:4096
  ds_read_b64_tr_b16 a[128:129], v108 offset:0
  ds_read_b64_tr_b16 a[130:131], v108 offset:4096
  ds_read_b64_tr_b16 a[160:161], v109 offset:0
  ds_read_b64_tr_b16 a[162:163], v109 offset:4096
  ds_read_b64_tr_b16 a[192:193], v110 offset:0
  ds_read_b64_tr_b16 a[194:195], v110 offset:4096
  ds_read_b64_tr_b16 a[224:225], v111 offset:0
  ds_read_b64_tr_b16 a[226:227], v111 offset:4096
  s_waitcnt vmcnt(16)
  ds_read_b64_tr_b16 a[4:5], v104 offset:8192
  ds_read_b64_tr_b16 a[6:7], v104 offset:12288
  ds_read_b64_tr_b16 a[36:37], v105 offset:8192
  ds_read_b64_tr_b16 a[38:39], v105 offset:12288
  ds_read_b64_tr_b16 a[68:69], v106 offset:8192
  ds_read_b64_tr_b16 a[70:71], v106 offset:12288
  ds_read_b64_tr_b16 a[100:101], v107 offset:8192
  ds_read_b64_tr_b16 a[102:103], v107 offset:12288
  ds_read_b64_tr_b16 a[132:133], v108 offset:8192
  ds_read_b64_tr_b16 a[134:135], v108 offset:12288
  ds_read_b64_tr_b16 a[164:165], v109 offset:8192
  ds_read_b64_tr_b16 a[166:167], v109 offset:12288
  ds_read_b64_tr_b16 a[196:197], v110 offset:8192
  ds_read_b64_tr_b16 a[198:199], v110 offset:12288
  ds_read_b64_tr_b16 a[228:229], v111 offset:8192
  ds_read_b64_tr_b16 a[230:231], v111 offset:12288
  s_waitcnt vmcnt(8)
  ds_read_b64_tr_b16 a[8:9], v104 offset:16384
  ds_read_b64_tr_b16 a[10:11], v104 offset:20480
  ds_read_b64_tr_b16 a[40:41], v105 offset:16384
  ds_read_b64_tr_b16 a[42:43], v105 offset:20480
  ds_read_b64_tr_b16 a[72:73], v106 offset:16384
  ds_read_b64_tr_b16 a[74:75], v106 offset:20480
  ds_read_b64_tr_b16 a[104:105], v107 offset:16384
  ds_read_b64_tr_b16 a[106:107], v107 offset:20480
  ds_read_b64_tr_b16 a[136:137], v108 offset:16384
  ds_read_b64_tr_b16 a[138:139], v108 offset:20480
  ds_read_b64_tr_b16 a[168:169], v109 offset:16384
  ds_read_b64_tr_b16 a[170:171], v109 offset:20480
  ds_read_b64_tr_b16 a[200:201], v110 offset:16384
  ds_read_b64_tr_b16 a[202:203], v110 offset:20480
  ds_read_b64_tr_b16 a[232:233], v111 offset:16384
  ds_read_b64_tr_b16 a[234:235], v111 offset:20480
  s_waitcnt vmcnt(0)
  ds_read_b64_tr_b16 a[12:13], v104 offset:24576
  ds_read_b64_tr_b16 a[14:15], v104 offset:28672
  ds_read_b64_tr_b16 a[44:45], v105 offset:24576
  ds_read_b64_tr_b16 a[46:47], v105 offset:28672
  ds_read_b64_tr_b16 a[76:77], v106 offset:24576
  ds_read_b64_tr_b16 a[78:79], v106 offset:28672
  ds_read_b64_tr_b16 a[108:109], v107 offset:24576
  ds_read_b64_tr_b16 a[110:111], v107 offset:28672
  ds_read_b64_tr_b16 a[140:141], v108 offset:24576
  ds_read_b64_tr_b16 a[142:143], v108 offset:28672
  ds_read_b64_tr_b16 a[172:173], v109 offset:24576
  ds_read_b64_tr_b16 a[174:175], v109 offset:28672
  ds_read_b64_tr_b16 a[204:205], v110 offset:24576
  ds_read_b64_tr_b16 a[206:207], v110 offset:28672
  ds_read_b64_tr_b16 a[236:237], v111 offset:24576
  ds_read_b64_tr_b16 a[238:239], v111 offset:28672
  s_waitcnt lgkmcnt(0)
  s_add_u32 m0, s66, 0
  s_add_u32 s58, s60, 131072
  buffer_load_dwordx4 v88, s[48:51], s58 offen lds
  s_add_u32 m0, s66, 1024
  s_add_u32 s58, s60, 135168
  buffer_load_dwordx4 v89, s[48:51], s58 offen lds
  s_add_u32 m0, s66, 2048
  s_add_u32 s58, s60, 139264
  buffer_load_dwordx4 v88, s[48:51], s58 offen lds
  s_add_u32 m0, s66, 3072
  s_add_u32 s58, s60, 143360
  buffer_load_dwordx4 v89, s[48:51], s58 offen lds
  s_add_u32 m0, s66, 4096
  s_add_u32 s58, s60, 147456
  buffer_load_dwordx4 v88, s[48:51], s58 offen lds
  s_add_u32 m0, s66, 5120
  s_add_u32 s58, s60, 151552
  buffer_load_dwordx4 v89, s[48:51], s58 offen lds
  s_add_u32 m0, s66, 6144
  s_add_u32 s58, s60, 155648
  buffer_load_dwordx4 v88, s[48:51], s58 offen lds
  s_add_u32 m0, s66, 7168
  s_add_u32 s58, s60, 159744
  buffer_load_dwordx4 v89, s[48:51], s58 offen lds
  s_add_u32 m0, s66, 8192
  s_add_u32 s58, s60, 163840
  buffer_load_dwordx4 v88, s[48:51], s58 offen lds
  s_add_u32 m0, s66, 9216
  s_add_u32 s58, s60, 167936
  buffer_load_dwordx4 v89, s[48:51], s58 offen lds
  s_add_u32 m0, s66, 10240
  s_add_u32 s58, s60, 172032
  buffer_load_dwordx4 v88, s[48:51], s58 offen lds
  s_add_u32 m0, s66, 11264
  s_add_u32 s58, s60, 176128
  buffer_load_dwordx4 v89, s[48:51], s58 offen lds
  s_add_u32 m0, s66, 12288
  s_add_u32 s58, s60, 180224
  buffer_load_dwordx4 v88, s[48:51], s58 offen lds
  s_add_u32 m0, s66, 13312
  s_add_u32 s58, s60, 184320
  buffer_load_dwordx4 v89, s[48:51], s58 offen lds
  s_add_u32 m0, s66, 14336
  s_add_u32 s58, s60, 188416
  buffer_load_dwordx4 v88, s[48:51], s58 offen lds
  s_add_u32 m0, s66, 15360
  s_add_u32 s58, s60, 192512
  buffer_load_dwordx4 v89, s[48:51], s58 offen lds
  s_add_u32 m0, s66, 16384
  s_add_u32 s58, s60, 196608
  buffer_load_dwordx4 v88, s[48:51], s58 offen lds
  s_add_u32 m0, s66, 17408
  s_add_u32 s58, s60, 200704
  buffer_load_dwordx4 v89, s[48:51], s58 offen lds
  s_add_u32 m0, s66, 18432
  s_add_u32 s58, s60, 204800
  buffer_load_dwordx4 v88, s[48:51], s58 offen lds
  s_add_u32 m0, s66, 19456
  s_add_u32 s58, s60, 208896
  buffer_load_dwordx4 v89, s[48:51], s58 offen lds
  s_add_u32 m0, s66, 20480
  s_add_u32 s58, s60, 212992
  buffer_load_dwordx4 v88, s[48:51], s58 offen lds
  s_add_u32 m0, s66, 21504
  s_add_u32 s58, s60, 217088
  buffer_load_dwordx4 v89, s[48:51], s58 offen lds
  s_add_u32 m0, s66, 22528
  s_add_u32 s58, s60, 221184
  buffer_load_dwordx4 v88, s[48:51], s58 offen lds
  s_add_u32 m0, s66, 23552
  s_add_u32 s58, s60, 225280
  buffer_load_dwordx4 v89, s[48:51], s58 offen lds
  s_add_u32 m0, s66, 24576
  s_add_u32 s58, s60, 229376
  buffer_load_dwordx4 v88, s[48:51], s58 offen lds
  s_add_u32 m0, s66, 25600
  s_add_u32 s58, s60, 233472
  buffer_load_dwordx4 v89, s[48:51], s58 offen lds
  s_add_u32 m0, s66, 26624
  s_add_u32 s58, s60, 237568
  buffer_load_dwordx4 v88, s[48:51], s58 offen lds
  s_add_u32 m0, s66, 27648
  s_add_u32 s58, s60, 241664
  buffer_load_dwordx4 v89, s[48:51], s58 offen lds
  s_add_u32 m0, s66, 28672
  s_add_u32 s58, s60, 245760
  buffer_load_dwordx4 v88, s[48:51], s58 offen lds
  s_add_u32 m0, s66, 29696
  s_add_u32 s58, s60, 249856
  buffer_load_dwordx4 v89, s[48:51], s58 offen lds
  s_add_u32 m0, s66, 30720
  s_add_u32 s58, s60, 253952
  buffer_load_dwordx4 v88, s[48:51], s58 offen lds
  s_add_u32 m0, s66, 31744
  s_add_u32 s58, s60, 258048
  buffer_load_dwordx4 v89, s[48:51], s58 offen lds
  s_lshr_b32 s58, s44, 1
  s_lshl1_add_u32 s61, s56, s58
  s_and_b32 s59, s44, 1
  s_lshl_b32 s60, s44, 12
  s_add_u32 s60, s60, 131072
  v_bfe_u32 v6, v0, 3, 1
  v_lshl_add_u32 v8, v6, 8, s60
  v_lshl_add_u32 v8, v3, 6, v8
  v_and_b32 v6, 7, v0
  v_lshl_add_u32 v8, v6, 3, v8
  v_lshrrev_b32 v6, 5, v0
  v_lshl_add_u32 v9, v6, 8, s60
  v_and_b32 v6, 3, v0
  v_lshl_add_u32 v9, v6, 6, v9
  v_bfe_u32 v6, v0, 2, 3
  v_lshl_add_u32 v9, v6, 3, v9
  s_mul_i32 s60, s58, 24576
  v_add_u32 v12, s60, v2
  s_lshl_b32 s66, s59, 12
  s_lshl_b32 s67, s61, 19
  s_add_u32 s67, s67, s66
  s_add_u32 s67, s67, 0x3000000
  s_add_u32 s66, s66, s60
  s_lshl1_add_u32 s60, s59, s58
  s_lshl_b32 s60, s60, 12
  s_add_u32 s60, s60, 98304
  v_add_u32 v13, s60, v2
  v_add_u32 v14, 98304, v2
  s_lshl_b32 s60, s59, 4
  v_add_u32 v4, s60, v4
  v_lshlrev_b32 v31, 2, v4
  v_add_u32 v31, 0xd0c0000, v31
  v_lshlrev_b32 v3, 2, v3
  v_sub_u32 v4, v4, v3
  v_mov_b32 v6, 0xff800000
  s_lshl_b32 s68, s61, 7
  s_add_u32 s73, s68, 0xd081000
  s_add_u32 s68, s68, 0xd084000
  s_lshl_b32 s69, s61, 12
  s_add_u32 s69, s69, 0xc020000
  s_lshl2_add_u32 s70, s56, s44
  s_lshl_b32 s70, s70, 12
  s_add_u32 s70, s70, 0x6080000
  s_cmp_eq_u32 s44, 0
  s_mov_b32 s72, 0x40000000
  s_cmov_b32 s72, 0xd087000
  v_cmp_gt_i32 vcc, 0, v4
  v_mov_b32 v16, 0x3f803f80
  s_nop 0
  v_cndmask_b32 v20, 0, v6, vcc
  v_cmp_gt_i32 vcc, 1, v4
  v_mov_b32 v17, 0x3f803f80
  s_nop 0
  v_cndmask_b32 v21, 0, v6, vcc
  v_cmp_gt_i32 vcc, 2, v4
  v_mov_b32 v18, 0x3f803f80
  s_nop 0
  v_cndmask_b32 v22, 0, v6, vcc
  v_cmp_gt_i32 vcc, 3, v4
  v_mov_b32 v19, 0x3f803f80
  s_nop 0
  v_cndmask_b32 v23, 0, v6, vcc
  v_cmp_gt_i32 vcc, 16, v4
  v_mov_b32 v16, 0x3f803f80
  s_nop 0
  v_cndmask_b32 v24, 0, v6, vcc
  v_cmp_gt_i32 vcc, 17, v4
  v_mov_b32 v17, 0x3f803f80
  s_nop 0
  v_cndmask_b32 v25, 0, v6, vcc
  v_cmp_gt_i32 vcc, 18, v4
  v_mov_b32 v18, 0x3f803f80
  s_nop 0
  v_cndmask_b32 v26, 0, v6, vcc
  v_cmp_gt_i32 vcc, 19, v4
  v_mov_b32 v19, 0x3f803f80
  s_nop 0
  v_cndmask_b32 v27, 0, v6, vcc
  v_mov_b32 v33, 0
  v_mov_b32 v34, 0
  s_waitcnt vmcnt(24)
  ds_read_b64_tr_b16 a[16:17], v104 offset:0
  ds_read_b64_tr_b16 a[18:19], v104 offset:4096
  ds_read_b64_tr_b16 a[48:49], v105 offset:0
  ds_read_b64_tr_b16 a[50:51], v105 offset:4096
  ds_read_b64_tr_b16 a[80:81], v106 offset:0
  ds_read_b64_tr_b16 a[82:83], v106 offset:4096
  ds_read_b64_tr_b16 a[112:113], v107 offset:0
  ds_read_b64_tr_b16 a[114:115], v107 offset:4096
  ds_read_b64_tr_b16 a[144:145], v108 offset:0
  ds_read_b64_tr_b16 a[146:147], v108 offset:4096
  ds_read_b64_tr_b16 a[176:177], v109 offset:0
  ds_read_b64_tr_b16 a[178:179], v109 offset:4096
  ds_read_b64_tr_b16 a[208:209], v110 offset:0
  ds_read_b64_tr_b16 a[210:211], v110 offset:4096
  ds_read_b64_tr_b16 a[240:241], v111 offset:0
  ds_read_b64_tr_b16 a[242:243], v111 offset:4096
  s_waitcnt vmcnt(16)
  ds_read_b64_tr_b16 a[20:21], v104 offset:8192
  ds_read_b64_tr_b16 a[22:23], v104 offset:12288
  ds_read_b64_tr_b16 a[52:53], v105 offset:8192
  ds_read_b64_tr_b16 a[54:55], v105 offset:12288
  ds_read_b64_tr_b16 a[84:85], v106 offset:8192
  ds_read_b64_tr_b16 a[86:87], v106 offset:12288
  ds_read_b64_tr_b16 a[116:117], v107 offset:8192
  ds_read_b64_tr_b16 a[118:119], v107 offset:12288
  ds_read_b64_tr_b16 a[148:149], v108 offset:8192
  ds_read_b64_tr_b16 a[150:151], v108 offset:12288
  ds_read_b64_tr_b16 a[180:181], v109 offset:8192
  ds_read_b64_tr_b16 a[182:183], v109 offset:12288
  ds_read_b64_tr_b16 a[212:213], v110 offset:8192
  ds_read_b64_tr_b16 a[214:215], v110 offset:12288
  ds_read_b64_tr_b16 a[244:245], v111 offset:8192
  ds_read_b64_tr_b16 a[246:247], v111 offset:12288
  s_waitcnt vmcnt(8)
  ds_read_b64_tr_b16 a[24:25], v104 offset:16384
  ds_read_b64_tr_b16 a[26:27], v104 offset:20480
  ds_read_b64_tr_b16 a[56:57], v105 offset:16384
  ds_read_b64_tr_b16 a[58:59], v105 offset:20480
  ds_read_b64_tr_b16 a[88:89], v106 offset:16384
  ds_read_b64_tr_b16 a[90:91], v106 offset:20480
  ds_read_b64_tr_b16 a[120:121], v107 offset:16384
  ds_read_b64_tr_b16 a[122:123], v107 offset:20480
  ds_read_b64_tr_b16 a[152:153], v108 offset:16384
  ds_read_b64_tr_b16 a[154:155], v108 offset:20480
  ds_read_b64_tr_b16 a[184:185], v109 offset:16384
  ds_read_b64_tr_b16 a[186:187], v109 offset:20480
  ds_read_b64_tr_b16 a[216:217], v110 offset:16384
  ds_read_b64_tr_b16 a[218:219], v110 offset:20480
  ds_read_b64_tr_b16 a[248:249], v111 offset:16384
  ds_read_b64_tr_b16 a[250:251], v111 offset:20480
  s_waitcnt vmcnt(0)
  ds_read_b64_tr_b16 a[28:29], v104 offset:24576
  ds_read_b64_tr_b16 a[30:31], v104 offset:28672
  ds_read_b64_tr_b16 a[60:61], v105 offset:24576
  ds_read_b64_tr_b16 a[62:63], v105 offset:28672
  ds_read_b64_tr_b16 a[92:93], v106 offset:24576
  ds_read_b64_tr_b16 a[94:95], v106 offset:28672
  ds_read_b64_tr_b16 a[124:125], v107 offset:24576
  ds_read_b64_tr_b16 a[126:127], v107 offset:28672
  ds_read_b64_tr_b16 a[156:157], v108 offset:24576
  ds_read_b64_tr_b16 a[158:159], v108 offset:28672
  ds_read_b64_tr_b16 a[188:189], v109 offset:24576
  ds_read_b64_tr_b16 a[190:191], v109 offset:28672
  ds_read_b64_tr_b16 a[220:221], v110 offset:24576
  ds_read_b64_tr_b16 a[222:223], v110 offset:28672
  ds_read_b64_tr_b16 a[252:253], v111 offset:24576
  ds_read_b64_tr_b16 a[254:255], v111 offset:28672
  s_waitcnt lgkmcnt(0)
  s_lshl_b32 s58, s61, 7
  s_add_u32 s58, s58, 0xd080010
  v_lshl_add_u32 v3, v0, 2, s58
  v_and_b32 v4, 7, v0
  v_lshlrev_b32 v4, 7, v4
  v_add_u32 v4, 0xd086400, v4
  v_cmp_gt_u32 vcc, 2, v0
  v_mov_b32 v249, 0
  s_nop 0
  v_cndmask_b32 v3, v4, v3, vcc
  v_cndmask_b32 v4, 16, 32, vcc
L_b_w0:
  buffer_load_dword v5, v3, s[40:43], 0 offen sc1
  s_add_u32 s57, s57, 1
  s_cmp_gt_u32 s57, 1048576
  s_cbranch_scc1 L_exit
  s_waitcnt vmcnt(0)
  v_cmp_ne_u32 vcc, v4, v5
  s_cbranch_vccnz L_b_w0
  v_readlane_b32 s63, v1, s95
  s_mov_b32 s62, 4
  s_mov_b32 s65, 0
  s_barrier
  s_bitcmp1_b32 s63, 2
  s_cbranch_scc1 L_b_nodma_1
  s_lshr_b32 s59, s63, 4
L_b_nodma_1_c:
  v_cmp_lt_u32 vcc, s59, v249
  s_cbranch_vccnz L_b_nodma_1_go
  buffer_load_dword v249, v7, s[40:43], s73 offen sc1
  buffer_load_dword v248, v7, s[40:43], s68 offen sc1
  s_add_u32 s57, s57, 1
  s_cmp_gt_u32 s57, 1048576
  s_cbranch_scc1 L_exit
  s_waitcnt vmcnt(0)
  s_branch L_b_nodma_1_c
L_b_nodma_1_go:
  s_lshl_b32 s58, s63, 9
  s_add_u32 s58, s58, s67
  s_add_u32 m0, s66, 0
  s_add_u32 s59, s58, 0x0
  buffer_load_dwordx4 v2, s[40:43], s59 offen offset:0 sc1 lds
  buffer_load_dwordx4 v2, s[40:43], s59 offen offset:1024 sc1 lds
  buffer_load_dwordx4 v2, s[40:43], s59 offen offset:2048 sc1 lds
  buffer_load_dwordx4 v2, s[40:43], s59 offen offset:3072 sc1 lds
  s_add_u32 m0, s66, 8192
  s_add_u32 s59, s58, 0x1000000
  buffer_load_dwordx4 v2, s[40:43], s59 offen offset:0 sc1 lds
  buffer_load_dwordx4 v2, s[40:43], s59 offen offset:1024 sc1 lds
  buffer_load_dwordx4 v2, s[40:43], s59 offen offset:2048 sc1 lds
  buffer_load_dwordx4 v2, s[40:43], s59 offen offset:3072 sc1 lds
  s_add_u32 m0, s66, 16384
  s_add_u32 s59, s58, 0x2000000
  buffer_load_dwordx4 v2, s[40:43], s59 offen offset:0 sc1 lds
  buffer_load_dwordx4 v2, s[40:43], s59 offen offset:1024 sc1 lds
  buffer_load_dwordx4 v2, s[40:43], s59 offen offset:2048 sc1 lds
  buffer_load_dwordx4 v2, s[40:43], s59 offen offset:3072 sc1 lds
  s_lshl_b32 s58, s63, 3
  buffer_load_dword v11, v31, s[40:43], s58 offen sc1
L_b_nodma_1:
L_b_round:
  s_mov_b32 s64, s62
  s_mov_b32 s62, s63
  s_add_u32 s95, s95, 1
  v_readlane_b32 s63, v1, s95
  s_cmp_ge_u32 s66, 49152
  s_mov_b32 s60, 49152
  s_cmov_b32 s60, -49152
  s_add_u32 s66, s66, s60
  s_waitcnt vmcnt(0)
  s_barrier
  v_sub_f32 v10, 1.0, v11
  s_and_b32 s59, s44, 1
  s_lshl_b32 s59, s59, 10
  v_add_u32 v4, s59, v12
  ds_read_b128 v[88:91], v4 offset:0
  ds_read_b128 v[104:107], v12 offset:8192
  ds_read_b128 v[108:111], v12 offset:9216
  ds_read_b128 v[92:95], v4 offset:2048
  ds_read_b128 v[112:115], v12 offset:10240
  ds_read_b128 v[116:119], v12 offset:11264
  ds_read_b128 v[96:99], v4 offset:4096
  ds_read_b128 v[120:123], v12 offset:12288
  ds_read_b128 v[124:127], v12 offset:13312
  ds_read_b128 v[100:103], v4 offset:6144
  ds_read_b128 v[128:131], v12 offset:14336
  ds_read_b128 v[132:135], v12 offset:15360
  s_lshl_b32 s58, s64, 2
  s_add_u32 s58, s58, s72
  s_bitcmp1_b32 s64, 2
  s_cselect_b32 s58, 0x40000000, s58
  v_mov_b32 v3, 1
  s_mov_b64 exec, 1
  buffer_atomic_add v3, v7, s[40:43], s58 offen
  s_mov_b64 exec, -1
  s_cmp_eq_u32 s65, 0
  s_cbranch_scc1 L_b_late
L_b_have:
  ds_write2st64_b32 v8, v56, v57 offset0:0 offset1:8
  ds_write2st64_b32 v8, v60, v61 offset0:2 offset1:10
  ds_write2st64_b32 v8, v64, v65 offset0:4 offset1:12
  ds_write2st64_b32 v8, v68, v69 offset0:6 offset1:14
  s_waitcnt lgkmcnt(4)
  v_mfma_f32_16x16x32_bf16 v[40:43], v[104:107], v[88:91], v[20:23]
  ds_read_b64_tr_b16 v[72:73], v9 offset:0
  v_mfma_f32_16x16x32_bf16 v[44:47], v[108:111], v[88:91], v[24:27]
  ds_read_b64_tr_b16 v[74:75], v9 offset:2048
  v_mfma_f32_16x16x32_bf16 v[40:43], v[112:115], v[92:95], v[40:43]
  ds_read_b64_tr_b16 v[76:77], v9 offset:512
  v_mfma_f32_16x16x32_bf16 v[44:47], v[116:119], v[92:95], v[44:47]
  ds_read_b64_tr_b16 v[78:79], v9 offset:2560
  v_mfma_f32_16x16x32_bf16 v[40:43], v[120:123], v[96:99], v[40:43]
  ds_read_b64_tr_b16 v[80:81], v9 offset:1024
  v_mfma_f32_16x16x32_bf16 v[44:47], v[124:127], v[96:99], v[44:47]
  ds_read_b64_tr_b16 v[82:83], v9 offset:3072
  v_mfma_f32_16x16x32_bf16 v[40:43], v[128:131], v[100:103], v[40:43]
  ds_read_b64_tr_b16 v[84:85], v9 offset:1536
  v_mfma_f32_16x16x32_bf16 v[44:47], v[132:135], v[100:103], v[44:47]
  ds_read_b64_tr_b16 v[86:87], v9 offset:3584
  ds_read_b128 v[136:139], v12 offset:16384
  ds_read_b128 v[140:143], v12 offset:17408
  ds_read_b128 v[144:147], v12 offset:18432
  ds_read_b128 v[148:151], v12 offset:19456
  ds_read_b128 v[152:155], v12 offset:20480
  ds_read_b128 v[156:159], v12 offset:21504
  s_bitcmp1_b32 s63, 2
  s_cbranch_scc1 L_b_nodma_2
  s_lshr_b32 s59, s63, 4
L_b_nodma_2_c:
  v_cmp_lt_u32 vcc, s59, v249
  s_cbranch_vccnz L_b_nodma_2_go
  buffer_load_dword v249, v7, s[40:43], s73 offen sc1
  buffer_load_dword v248, v7, s[40:43], s68 offen sc1
  s_add_u32 s57, s57, 1
  s_cmp_gt_u32 s57, 1048576
  s_cbranch_scc1 L_exit
  s_waitcnt vmcnt(0)
  s_branch L_b_nodma_2_c
L_b_nodma_2_go:
  s_lshl_b32 s58, s63, 9
  s_add_u32 s58, s58, s67
  s_add_u32 m0, s66, 0
  s_add_u32 s59, s58, 0x0
  buffer_load_dwordx4 v2, s[40:43], s59 offen offset:0 sc1 lds
  buffer_load_dwordx4 v2, s[40:43], s59 offen offset:1024 sc1 lds
  buffer_load_dwordx4 v2, s[40:43], s59 offen offset:2048 sc1 lds
  buffer_load_dwordx4 v2, s[40:43], s59 offen offset:3072 sc1 lds
  s_add_u32 m0, s66, 8192
  s_add_u32 s59, s58, 0x1000000
  buffer_load_dwordx4 v2, s[40:43], s59 offen offset:0 sc1 lds
  buffer_load_dwordx4 v2, s[40:43], s59 offen offset:1024 sc1 lds
  buffer_load_dwordx4 v2, s[40:43], s59 offen offset:2048 sc1 lds
  buffer_load_dwordx4 v2, s[40:43], s59 offen offset:3072 sc1 lds
  s_add_u32 m0, s66, 16384
  s_add_u32 s59, s58, 0x2000000
  buffer_load_dwordx4 v2, s[40:43], s59 offen offset:0 sc1 lds
  buffer_load_dwordx4 v2, s[40:43], s59 offen offset:1024 sc1 lds
  buffer_load_dwordx4 v2, s[40:43], s59 offen offset:2048 sc1 lds
  buffer_load_dwordx4 v2, s[40:43], s59 offen offset:3072 sc1 lds
  s_lshl_b32 s58, s63, 3
  buffer_load_dword v11, v31, s[40:43], s58 offen sc1
L_b_nodma_2:
  s_waitcnt lgkmcnt(6)
  v_mfma_f32_16x16x32_bf16 v[48:51], v[72:75], v[88:91], 0
  ds_read_b128 v[160:163], v12 offset:22528
  v_mfma_f32_16x16x32_bf16 v[48:51], v[76:79], v[92:95], v[48:51]
  ds_read_b128 v[164:167], v12 offset:23552
  v_mfma_f32_16x16x32_bf16 v[48:51], v[80:83], v[96:99], v[48:51]
  v_mfma_f32_16x16x32_bf16 v[48:51], v[84:87], v[100:103], v[48:51]
  v_add_u32 v12, s60, v12
  v_max_f32 v3, v40, v41
  v_max3_f32 v3, v3, v42, v43
  v_max3_f32 v3, v3, v44, v45
  v_max3_f32 v3, v3, v46, v47
  s_nop 2
  v_max3_f32 v3, v3, v48, v49
  v_mov_b32 v4, v3
  s_nop 1
  v_permlane32_swap_b32 v4, v3
  v_max_f32 v3, v3, v4
  v_mov_b32 v4, v3
  s_nop 1
  v_permlane16_swap_b32 v4, v3
  v_max_f32 v3, v3, v4
  v_sub_f32 v40, v40, v3
  v_sub_f32 v41, v41, v3
  v_sub_f32 v42, v42, v3
  v_sub_f32 v43, v43, v3
  v_sub_f32 v44, v44, v3
  v_sub_f32 v45, v45, v3
  v_sub_f32 v46, v46, v3
  v_sub_f32 v47, v47, v3
  v_sub_f32 v48, v48, v3
  v_sub_f32 v49, v49, v3
  v_exp_f32 v40, v40
  v_exp_f32 v41, v41
  v_exp_f32 v42, v42
  v_exp_f32 v43, v43
  v_exp_f32 v44, v44
  v_exp_f32 v45, v45
  v_exp_f32 v46, v46
  v_exp_f32 v47, v47
  v_exp_f32 v48, v48
  v_exp_f32 v49, v49
  v_cvt_pk_bf16_f32 v36, v40, v41
  v_cvt_pk_bf16_f32 v37, v42, v43
  v_cvt_pk_bf16_f32 v38, v44, v45
  v_cvt_pk_bf16_f32 v39, v46, v47
  v_cvt_pk_bf16_f32 v32, v48, v49
  v_cvt_pk_bf16_f32 v35, v48, v49
  s_waitcnt lgkmcnt(0)
  v_mfma_f32_16x16x32_bf16 v[52:55], v[16:19], v[36:39], 0
  v_mfma_f32_16x16x32_bf16 v[168:171], v[136:139], v[36:39], 0
  v_mfma_f32_16x16x32_bf16 v[172:175], v[140:143], v[36:39], 0
  v_mfma_f32_16x16x32_bf16 v[176:179], v[144:147], v[36:39], 0
  v_mfma_f32_16x16x32_bf16 v[180:183], v[148:151], v[36:39], 0
  v_mfma_f32_16x16x32_bf16 v[184:187], v[152:155], v[36:39], 0
  v_mfma_f32_16x16x32_bf16 v[188:191], v[156:159], v[36:39], 0
  v_mfma_f32_16x16x16_bf16 v[52:55], v[16:17], v[32:33], v[52:55]
  v_mfma_f32_16x16x32_bf16 v[192:195], v[160:163], v[36:39], 0
  v_mfma_f32_16x16x32_bf16 v[196:199], v[164:167], v[36:39], 0
  v_mfma_f32_16x16x16_bf16 v[168:171], v[58:59], v[32:33], v[168:171]
  v_mfma_f32_16x16x16_bf16 v[172:175], v[58:59], v[34:35], v[172:175]
  v_mfma_f32_16x16x16_bf16 v[176:179], v[62:63], v[32:33], v[176:179]
  v_mfma_f32_16x16x16_bf16 v[180:183], v[62:63], v[34:35], v[180:183]
  v_mfma_f32_16x16x16_bf16 v[184:187], v[66:67], v[32:33], v[184:187]
  v_mfma_f32_16x16x16_bf16 v[188:191], v[66:67], v[34:35], v[188:191]
  v_rcp_f32 v3, v52
  v_mfma_f32_16x16x16_bf16 v[192:195], v[70:71], v[32:33], v[192:195]
  v_mul_f32 v3, v3, v10
  v_mfma_f32_16x16x16_bf16 v[196:199], v[70:71], v[34:35], v[196:199]
  v_mul_f32 v168, v168, v3
  v_mul_f32 v169, v169, v3
  v_mul_f32 v170, v170, v3
  v_mul_f32 v171, v171, v3
  v_mul_f32 v172, v172, v3
  v_mul_f32 v173, v173, v3
  v_mul_f32 v174, v174, v3
  v_mul_f32 v175, v175, v3
  v_cvt_pk_bf16_f32 v232, v168, v169
  v_cvt_pk_bf16_f32 v233, v170, v171
  v_cvt_pk_bf16_f32 v234, v172, v173
  v_cvt_pk_bf16_f32 v235, v174, v175
  ds_write_b128 v13, v[232:235] offset:0
  v_mul_f32 v176, v176, v3
  v_mul_f32 v177, v177, v3
  v_mul_f32 v178, v178, v3
  v_mul_f32 v179, v179, v3
  v_mul_f32 v180, v180, v3
  v_mul_f32 v181, v181, v3
  v_mul_f32 v182, v182, v3
  v_mul_f32 v183, v183, v3
  v_cvt_pk_bf16_f32 v236, v176, v177
  v_cvt_pk_bf16_f32 v237, v178, v179
  v_cvt_pk_bf16_f32 v238, v180, v181
  v_cvt_pk_bf16_f32 v239, v182, v183
  ds_write_b128 v13, v[236:239] offset:1024
  v_mul_f32 v184, v184, v3
  v_mul_f32 v185, v185, v3
  v_mul_f32 v186, v186, v3
  v_mul_f32 v187, v187, v3
  v_mul_f32 v188, v188, v3
  v_mul_f32 v189, v189, v3
  v_mul_f32 v190, v190, v3
  v_mul_f32 v191, v191, v3
  v_cvt_pk_bf16_f32 v240, v184, v185
  v_cvt_pk_bf16_f32 v241, v186, v187
  v_cvt_pk_bf16_f32 v242, v188, v189
  v_cvt_pk_bf16_f32 v243, v190, v191
  ds_write_b128 v13, v[240:243] offset:2048
  v_mul_f32 v192, v192, v3
  v_mul_f32 v193, v193, v3
  v_mul_f32 v194, v194, v3
  v_mul_f32 v195, v195, v3
  v_mul_f32 v196, v196, v3
  v_mul_f32 v197, v197, v3
  v_mul_f32 v198, v198, v3
  v_mul_f32 v199, v199, v3
  v_cvt_pk_bf16_f32 v244, v192, v193
  v_cvt_pk_bf16_f32 v245, v194, v195
  v_cvt_pk_bf16_f32 v246, v196, v197
  v_cvt_pk_bf16_f32 v247, v198, v199
  ds_write_b128 v13, v[244:247] offset:3072
  buffer_load_dword v249, v7, s[40:43], s73 offen sc1
  buffer_load_dword v248, v7, s[40:43], s68 offen sc1
  v_xor_b32 v13, 0x4000, v13
  s_mul_i32 s71, s62, 98304
  s_add_u32 s71, s71, s70
  s_waitcnt lgkmcnt(0)
  s_barrier
  ds_read_b128 v[104:107], v14 offset:0
  ds_read_b128 v[108:111], v14 offset:1024
  ds_read_b128 v[112:115], v14 offset:2048
  ds_read_b128 v[116:119], v14 offset:3072
  ds_read_b128 v[120:123], v14 offset:4096
  ds_read_b128 v[124:127], v14 offset:5120
  ds_read_b128 v[128:131], v14 offset:6144
  ds_read_b128 v[132:135], v14 offset:7168
  s_waitcnt lgkmcnt(7)
  v_mfma_f32_16x16x32_bf16 v[200:203], a[0:3], v[104:107], 0
  s_waitcnt lgkmcnt(6)
  v_mfma_f32_16x16x32_bf16 v[200:203], a[4:7], v[108:111], v[200:203]
  s_waitcnt lgkmcnt(5)
  v_mfma_f32_16x16x32_bf16 v[200:203], a[8:11], v[112:115], v[200:203]
  s_waitcnt lgkmcnt(4)
  v_mfma_f32_16x16x32_bf16 v[200:203], a[12:15], v[116:119], v[200:203]
  s_waitcnt lgkmcnt(3)
  v_mfma_f32_16x16x32_bf16 v[200:203], a[16:19], v[120:123], v[200:203]
  s_waitcnt lgkmcnt(2)
  v_mfma_f32_16x16x32_bf16 v[200:203], a[20:23], v[124:127], v[200:203]
  s_waitcnt lgkmcnt(1)
  v_mfma_f32_16x16x32_bf16 v[200:203], a[24:27], v[128:131], v[200:203]
  s_waitcnt lgkmcnt(0)
  v_mfma_f32_16x16x32_bf16 v[200:203], a[28:31], v[132:135], v[200:203]
  v_mfma_f32_16x16x32_bf16 v[204:207], a[32:35], v[104:107], 0
  ds_read_b128 v[136:139], v14 offset:8192
  v_mfma_f32_16x16x32_bf16 v[204:207], a[36:39], v[108:111], v[204:207]
  ds_read_b128 v[140:143], v14 offset:9216
  v_mfma_f32_16x16x32_bf16 v[204:207], a[40:43], v[112:115], v[204:207]
  ds_read_b128 v[144:147], v14 offset:10240
  v_mfma_f32_16x16x32_bf16 v[204:207], a[44:47], v[116:119], v[204:207]
  ds_read_b128 v[148:151], v14 offset:11264
  v_mfma_f32_16x16x32_bf16 v[204:207], a[48:51], v[120:123], v[204:207]
  ds_read_b128 v[152:155], v14 offset:12288
  v_mfma_f32_16x16x32_bf16 v[204:207], a[52:55], v[124:127], v[204:207]
  ds_read_b128 v[156:159], v14 offset:13312
  v_mfma_f32_16x16x32_bf16 v[204:207], a[56:59], v[128:131], v[204:207]
  ds_read_b128 v[160:163], v14 offset:14336
  v_mfma_f32_16x16x32_bf16 v[204:207], a[60:63], v[132:135], v[204:207]
  ds_read_b128 v[164:167], v14 offset:15360
  v_mfma_f32_16x16x32_bf16 v[208:211], a[64:67], v[104:107], 0
  v_mfma_f32_16x16x32_bf16 v[208:211], a[68:71], v[108:111], v[208:211]
  v_mfma_f32_16x16x32_bf16 v[208:211], a[72:75], v[112:115], v[208:211]
  v_mfma_f32_16x16x32_bf16 v[208:211], a[76:79], v[116:119], v[208:211]
  v_mfma_f32_16x16x32_bf16 v[208:211], a[80:83], v[120:123], v[208:211]
  v_mfma_f32_16x16x32_bf16 v[208:211], a[84:87], v[124:127], v[208:211]
  v_mfma_f32_16x16x32_bf16 v[208:211], a[88:91], v[128:131], v[208:211]
  v_mfma_f32_16x16x32_bf16 v[208:211], a[92:95], v[132:135], v[208:211]
  v_cvt_pk_bf16_f32 v232, v200, v201
  v_cvt_pk_bf16_f32 v233, v202, v203
  v_mfma_f32_16x16x32_bf16 v[212:215], a[96:99], v[104:107], 0
  v_cvt_pk_bf16_f32 v234, v204, v205
  v_cvt_pk_bf16_f32 v235, v206, v207
  v_mfma_f32_16x16x32_bf16 v[212:215], a[100:103], v[108:111], v[212:215]
  buffer_store_dwordx4 v[232:235], v2, s[40:43], s71 offen offset:0 sc1
  v_mfma_f32_16x16x32_bf16 v[212:215], a[104:107], v[112:115], v[212:215]
  v_mfma_f32_16x16x32_bf16 v[212:215], a[108:111], v[116:119], v[212:215]
  v_mfma_f32_16x16x32_bf16 v[212:215], a[112:115], v[120:123], v[212:215]
  v_mfma_f32_16x16x32_bf16 v[212:215], a[116:119], v[124:127], v[212:215]
  v_mfma_f32_16x16x32_bf16 v[212:215], a[120:123], v[128:131], v[212:215]
  v_mfma_f32_16x16x32_bf16 v[212:215], a[124:127], v[132:135], v[212:215]
  v_mfma_f32_16x16x32_bf16 v[216:219], a[128:131], v[104:107], 0
  v_mfma_f32_16x16x32_bf16 v[216:219], a[132:135], v[108:111], v[216:219]
  v_mfma_f32_16x16x32_bf16 v[216:219], a[136:139], v[112:115], v[216:219]
  v_mfma_f32_16x16x32_bf16 v[216:219], a[140:143], v[116:119], v[216:219]
  v_mfma_f32_16x16x32_bf16 v[216:219], a[144:147], v[120:123], v[216:219]
  v_mfma_f32_16x16x32_bf16 v[216:219], a[148:151], v[124:127], v[216:219]
  v_mfma_f32_16x16x32_bf16 v[216:219], a[152:155], v[128:131], v[216:219]
  v_mfma_f32_16x16x32_bf16 v[216:219], a[156:159], v[132:135], v[216:219]
  v_cvt_pk_bf16_f32 v236, v208, v209
  v_cvt_pk_bf16_f32 v237, v210, v211
  v_mfma_f32_16x16x32_bf16 v[220:223], a[160:163], v[104:107], 0
  s_waitcnt lgkmcnt(0)
  v_xor_b32 v14, 0x4000, v14
  v_cvt_pk_bf16_f32 v238, v212, v213
  v_cvt_pk_bf16_f32 v239, v214, v215
  v_mfma_f32_16x16x32_bf16 v[220:223], a[164:167], v[108:111], v[220:223]
  buffer_store_dwordx4 v[236:239], v2, s[40:43], s71 offen offset:1024 sc1
  v_mfma_f32_16x16x32_bf16 v[220:223], a[168:171], v[112:115], v[220:223]
  v_mfma_f32_16x16x32_bf16 v[220:223], a[172:175], v[116:119], v[220:223]
  v_mfma_f32_16x16x32_bf16 v[220:223], a[176:179], v[120:123], v[220:223]
  v_mfma_f32_16x16x32_bf16 v[220:223], a[180:183], v[124:127], v[220:223]
  v_mfma_f32_16x16x32_bf16 v[220:223], a[184:187], v[128:131], v[220:223]
  v_mfma_f32_16x16x32_bf16 v[220:223], a[188:191], v[132:135], v[220:223]
  v_mfma_f32_16x16x32_bf16 v[224:227], a[192:195], v[104:107], 0
  v_mfma_f32_16x16x32_bf16 v[224:227], a[196:199], v[108:111], v[224:227]
  v_mfma_f32_16x16x32_bf16 v[224:227], a[200:203], v[112:115], v[224:227]
  v_mfma_f32_16x16x32_bf16 v[224:227], a[204:207], v[116:119], v[224:227]
  v_mfma_f32_16x16x32_bf16 v[224:227], a[208:211], v[120:123], v[224:227]
  v_mfma_f32_16x16x32_bf16 v[224:227], a[212:215], v[124:127], v[224:227]
  v_mfma_f32_16x16x32_bf16 v[224:227], a[216:219], v[128:131], v[224:227]
  v_mfma_f32_16x16x32_bf16 v[224:227], a[220:223], v[132:135], v[224:227]
  v_cvt_pk_bf16_f32 v240, v216, v217
  v_cvt_pk_bf16_f32 v241, v218, v219
  v_mfma_f32_16x16x32_bf16 v[228:231], a[224:227], v[104:107], 0
  v_cvt_pk_bf16_f32 v242, v220, v221
  v_cvt_pk_bf16_f32 v243, v222, v223
  v_mfma_f32_16x16x32_bf16 v[228:231], a[228:231], v[108:111], v[228:231]
  buffer_store_dwordx4 v[240:243], v2, s[40:43], s71 offen offset:2048 sc1
  v_mfma_f32_16x16x32_bf16 v[228:231], a[232:235], v[112:115], v[228:231]
  v_mfma_f32_16x16x32_bf16 v[228:231], a[236:239], v[116:119], v[228:231]
  v_mfma_f32_16x16x32_bf16 v[228:231], a[240:243], v[120:123], v[228:231]
  s_waitcnt vmcnt(3)
  s_lshr_b32 s59, s63, 4
  v_mfma_f32_16x16x32_bf16 v[228:231], a[244:247], v[124:127], v[228:231]
  v_cmp_lt_u32 vcc, s59, v248
  v_mfma_f32_16x16x32_bf16 v[228:231], a[248:251], v[128:131], v[228:231]
  v_mfma_f32_16x16x32_bf16 v[228:231], a[252:255], v[132:135], v[228:231]
  v_mfma_f32_16x16x32_bf16 v[200:203], a[0:3], v[136:139], 0
  s_mov_b32 s65, 0
  s_cbranch_vccz L_b_nofetch
  s_lshl_b32 s58, s63, 13
  s_add_u32 s58, s58, s69
  buffer_load_dwordx4 v[56:59], v2, s[40:43], s58 offen offset:0 sc1
  buffer_load_dwordx4 v[60:63], v2, s[40:43], s58 offen offset:1024 sc1
  buffer_load_dwordx4 v[64:67], v2, s[40:43], s58 offen offset:2048 sc1
  buffer_load_dwordx4 v[68:71], v2, s[40:43], s58 offen offset:3072 sc1
  s_mov_b32 s65, 1
L_b_nofetch:
  v_mfma_f32_16x16x32_bf16 v[200:203], a[4:7], v[140:143], v[200:203]
  v_mfma_f32_16x16x32_bf16 v[200:203], a[8:11], v[144:147], v[200:203]
  v_mfma_f32_16x16x32_bf16 v[200:203], a[12:15], v[148:151], v[200:203]
  v_mfma_f32_16x16x32_bf16 v[200:203], a[16:19], v[152:155], v[200:203]
  v_mfma_f32_16x16x32_bf16 v[200:203], a[20:23], v[156:159], v[200:203]
  v_mfma_f32_16x16x32_bf16 v[200:203], a[24:27], v[160:163], v[200:203]
  v_mfma_f32_16x16x32_bf16 v[200:203], a[28:31], v[164:167], v[200:203]
  v_cvt_pk_bf16_f32 v244, v224, v225
  v_cvt_pk_bf16_f32 v245, v226, v227
  v_mfma_f32_16x16x32_bf16 v[204:207], a[32:35], v[136:139], 0
  v_cvt_pk_bf16_f32 v246, v228, v229
  v_cvt_pk_bf16_f32 v247, v230, v231
  v_mfma_f32_16x16x32_bf16 v[204:207], a[36:39], v[140:143], v[204:207]
  buffer_store_dwordx4 v[244:247], v2, s[40:43], s71 offen offset:3072 sc1
  v_mfma_f32_16x16x32_bf16 v[204:207], a[40:43], v[144:147], v[204:207]
  v_mfma_f32_16x16x32_bf16 v[204:207], a[44:47], v[148:151], v[204:207]
  v_mfma_f32_16x16x32_bf16 v[204:207], a[48:51], v[152:155], v[204:207]
  v_mfma_f32_16x16x32_bf16 v[204:207], a[52:55], v[156:159], v[204:207]
  v_mfma_f32_16x16x32_bf16 v[204:207], a[56:59], v[160:163], v[204:207]
  v_mfma_f32_16x16x32_bf16 v[204:207], a[60:63], v[164:167], v[204:207]
  v_mfma_f32_16x16x32_bf16 v[208:211], a[64:67], v[136:139], 0
  v_mfma_f32_16x16x32_bf16 v[208:211], a[68:71], v[140:143], v[208:211]
  v_mfma_f32_16x16x32_bf16 v[208:211], a[72:75], v[144:147], v[208:211]
  v_mfma_f32_16x16x32_bf16 v[208:211], a[76:79], v[148:151], v[208:211]
  v_mfma_f32_16x16x32_bf16 v[208:211], a[80:83], v[152:155], v[208:211]
  v_mfma_f32_16x16x32_bf16 v[208:211], a[84:87], v[156:159], v[208:211]
  v_mfma_f32_16x16x32_bf16 v[208:211], a[88:91], v[160:163], v[208:211]
  s_add_u32 s71, s71, 786432
  v_mfma_f32_16x16x32_bf16 v[208:211], a[92:95], v[164:167], v[208:211]
  v_cvt_pk_bf16_f32 v232, v200, v201
  v_cvt_pk_bf16_f32 v233, v202, v203
  v_mfma_f32_16x16x32_bf16 v[212:215], a[96:99], v[136:139], 0
  v_cvt_pk_bf16_f32 v234, v204, v205
  v_cvt_pk_bf16_f32 v235, v206, v207
  v_mfma_f32_16x16x32_bf16 v[212:215], a[100:103], v[140:143], v[212:215]
  buffer_store_dwordx4 v[232:235], v2, s[40:43], s71 offen offset:0 sc1
  v_mfma_f32_16x16x32_bf16 v[212:215], a[104:107], v[144:147], v[212:215]
  v_mfma_f32_16x16x32_bf16 v[212:215], a[108:111], v[148:151], v[212:215]
  v_mfma_f32_16x16x32_bf16 v[212:215], a[112:115], v[152:155], v[212:215]
  v_mfma_f32_16x16x32_bf16 v[212:215], a[116:119], v[156:159], v[212:215]
  v_mfma_f32_16x16x32_bf16 v[212:215], a[120:123], v[160:163], v[212:215]
  v_mfma_f32_16x16x32_bf16 v[212:215], a[124:127], v[164:167], v[212:215]
  v_mfma_f32_16x16x32_bf16 v[216:219], a[128:131], v[136:139], 0
  v_mfma_f32_16x16x32_bf16 v[216:219], a[132:135], v[140:143], v[216:219]
  v_mfma_f32_16x16x32_bf16 v[216:219], a[136:139], v[144:147], v[216:219]
  v_mfma_f32_16x16x32_bf16 v[216:219], a[140:143], v[148:151], v[216:219]
  v_mfma_f32_16x16x32_bf16 v[216:219], a[144:147], v[152:155], v[216:219]
  v_mfma_f32_16x16x32_bf16 v[216:219], a[148:151], v[156:159], v[216:219]
  v_mfma_f32_16x16x32_bf16 v[216:219], a[152:155], v[160:163], v[216:219]
  v_mfma_f32_16x16x32_bf16 v[216:219], a[156:159], v[164:167], v[216:219]
  v_cvt_pk_bf16_f32 v236, v208, v209
  v_cvt_pk_bf16_f32 v237, v210, v211
  v_mfma_f32_16x16x32_bf16 v[220:223], a[160:163], v[136:139], 0
  v_cvt_pk_bf16_f32 v238, v212, v213
  v_cvt_pk_bf16_f32 v239, v214, v215
  v_mfma_f32_16x16x32_bf16 v[220:223], a[164:167], v[140:143], v[220:223]
  buffer_store_dwordx4 v[236:239], v2, s[40:43], s71 offen offset:1024 sc1
  v_mfma_f32_16x16x32_bf16 v[220:223], a[168:171], v[144:147], v[220:223]
  v_mfma_f32_16x16x32_bf16 v[220:223], a[172:175], v[148:151], v[220:223]
  v_mfma_f32_16x16x32_bf16 v[220:223], a[176:179], v[152:155], v[220:223]
  v_mfma_f32_16x16x32_bf16 v[220:223], a[180:183], v[156:159], v[220:223]
  v_mfma_f32_16x16x32_bf16 v[220:223], a[184:187], v[160:163], v[220:223]
  v_mfma_f32_16x16x32_bf16 v[220:223], a[188:191], v[164:167], v[220:223]
  v_mfma_f32_16x16x32_bf16 v[224:227], a[192:195], v[136:139], 0
  v_mfma_f32_16x16x32_bf16 v[224:227], a[196:199], v[140:143], v[224:227]
  v_mfma_f32_16x16x32_bf16 v[224:227], a[200:203], v[144:147], v[224:227]
  v_mfma_f32_16x16x32_bf16 v[224:227], a[204:207], v[148:151], v[224:227]
  v_mfma_f32_16x16x32_bf16 v[224:227], a[208:211], v[152:155], v[224:227]
  v_mfma_f32_16x16x32_bf16 v[224:227], a[212:215], v[156:159], v[224:227]
  v_mfma_f32_16x16x32_bf16 v[224:227], a[216:219], v[160:163], v[224:227]
  v_mfma_f32_16x16x32_bf16 v[224:227], a[220:223], v[164:167], v[224:227]
  v_cvt_pk_bf16_f32 v240, v216, v217
  v_cvt_pk_bf16_f32 v241, v218, v219
  v_mfma_f32_16x16x32_bf16 v[228:231], a[224:227], v[136:139], 0
  v_cvt_pk_bf16_f32 v242, v220, v221
  v_cvt_pk_bf16_f32 v243, v222, v223
  v_mfma_f32_16x16x32_bf16 v[228:231], a[228:231], v[140:143], v[228:231]
  buffer_store_dwordx4 v[240:243], v2, s[40:43], s71 offen offset:2048 sc1
  v_mfma_f32_16x16x32_bf16 v[228:231], a[232:235], v[144:147], v[228:231]
  v_mfma_f32_16x16x32_bf16 v[228:231], a[236:239], v[148:151], v[228:231]
  v_mfma_f32_16x16x32_bf16 v[228:231], a[240:243], v[152:155], v[228:231]
  v_mfma_f32_16x16x32_bf16 v[228:231], a[244:247], v[156:159], v[228:231]
  v_mfma_f32_16x16x32_bf16 v[228:231], a[248:251], v[160:163], v[228:231]
  v_mfma_f32_16x16x32_bf16 v[228:231], a[252:255], v[164:167], v[228:231]
  s_nop 7
  v_cvt_pk_bf16_f32 v244, v224, v225
  v_cvt_pk_bf16_f32 v245, v226, v227
  v_cvt_pk_bf16_f32 v246, v228, v229
  v_cvt_pk_bf16_f32 v247, v230, v231
  buffer_store_dwordx4 v[244:247], v2, s[40:43], s71 offen offset:3072 sc1
  s_bitcmp1_b32 s63, 2
  s_cbranch_scc0 L_b_round
  s_mov_b32 s64, s62
  s_waitcnt vmcnt(0)
  s_barrier
  s_lshl_b32 s58, s64, 2
  s_add_u32 s58, s58, s72
  s_bitcmp1_b32 s64, 2
  s_cselect_b32 s58, 0x40000000, s58
  v_mov_b32 v3, 1
  s_mov_b64 exec, 1
  buffer_atomic_add v3, v7, s[40:43], s58 offen
  s_mov_b64 exec, -1
  s_branch L_next
L_b_late:
  s_lshr_b32 s59, s62, 4
L_b_late2:
  buffer_load_dword v249, v7, s[40:43], s73 offen sc1
  buffer_load_dword v248, v7, s[40:43], s68 offen sc1
  s_add_u32 s57, s57, 1
  s_cmp_gt_u32 s57, 1048576
  s_cbranch_scc1 L_exit
  s_waitcnt vmcnt(0)
  v_cmp_lt_u32 vcc, s59, v248
  s_cbranch_vccz L_b_late2
  s_lshl_b32 s58, s62, 13
  s_add_u32 s58, s58, s69
  buffer_load_dwordx4 v[56:59], v2, s[40:43], s58 offen offset:0 sc1
  buffer_load_dwordx4 v[60:63], v2, s[40:43], s58 offen offset:1024 sc1
  buffer_load_dwordx4 v[64:67], v2, s[40:43], s58 offen offset:2048 sc1
  buffer_load_dwordx4 v[68:71], v2, s[40:43], s58 offen offset:3072 sc1
  s_waitcnt vmcnt(0)
  s_branch L_b_have
L_red:
  s_mov_b32 s48, s36
  s_and_b32 s49, s37, 0xffff
  s_mov_b32 s50, 0x200000
  s_mov_b32 s51, 0x20000
  v_lshlrev_b32 v2, 4, v0
  v_mov_b32 v7, 0
  s_mov_b32 s57, 0
  v_and_b32 v3, 4, v1
  v_cmp_ne_u32 vcc, 0, v3
  v_bfe_u32 v3, v1, 4, 6
  v_lshrrev_b32 v4, 3, v3
  s_lshr_b32 s58, vcc_lo, s95
  s_ff1_i32_b32 s58, s58
  s_bfm_b32 s58, s58, s95
  s_cmp_eq_u32 s62, 0
  s_cselect_b32 s59, s58, 0
  v_lshlrev_b32 v4, 7, v4
  v_add_u32 v4, 0xd086000, v4
  v_lshlrev_b32 v3, 6, v3
  v_add_u32 v3, 0xd087000, v3
  v_cmp_gt_u32 vcc, 32, v0
  v_and_b32 v5, 15, v0
  v_lshrrev_b32 v6, 4, v0
  v_cndmask_b32 v3, v3, v4, vcc
  v_cndmask_b32 v4, 16, 32, vcc
  buffer_load_dword v16, v3, s[40:43], 0 offen sc1
  v_lshlrev_b32 v24, 10, v5
  v_lshl_add_u32 v24, v6, 4, v24
  v_bfe_u32 v17, v0, 2, 1
  v_lshlrev_b32 v17, 1, v17
  v_sub_u32 v17, v6, v17
  v_bfe_u32 v18, v0, 3, 1
  v_bfe_u32 v19, v0, 1, 1
  v_lshl_add_u32 v18, v18, 1, v19
  v_lshl_add_u32 v17, v17, 2, v18
  v_and_b32 v18, 1, v0
  v_lshlrev_b32 v18, 4, v18
  v_mov_b32 v19, 0x3f80
  v_lshlrev_b32 v18, v18, v19
  v_cmp_eq_u32 vcc, 0, v17
  s_nop 1
  v_cndmask_b32 v8, 0, v18, vcc
  v_cmp_eq_u32 vcc, 1, v17
  s_nop 1
  v_cndmask_b32 v9, 0, v18, vcc
  v_cmp_eq_u32 vcc, 2, v17
  s_nop 1
  v_cndmask_b32 v10, 0, v18, vcc
  v_cmp_eq_u32 vcc, 3, v17
  s_nop 1
  v_cndmask_b32 v11, 0, v18, vcc
  v_cmp_eq_u32 vcc, 4, v17
  s_nop 1
  v_cndmask_b32 v12, 0, v18, vcc
  v_cmp_eq_u32 vcc, 5, v17
  s_nop 1
  v_cndmask_b32 v13, 0, v18, vcc
  v_cmp_eq_u32 vcc, 6, v17
  s_nop 1
  v_cndmask_b32 v14, 0, v18, vcc
  v_cmp_eq_u32 vcc, 7, v17
  s_nop 1
  v_cndmask_b32 v15, 0, v18, vcc
  v_readlane_b32 s63, v1, s95
L_r_wait:
  s_waitcnt vmcnt(0)
  v_cmp_gt_u32 vcc, v4, v16
  s_nop 0
  s_and_b64 vcc, vcc, s[58:59]
  s_cbranch_scc0 L_r_go
  buffer_load_dword v16, v3, s[40:43], 0 offen sc1
  s_add_u32 s57, s57, 1
  s_cmp_gt_u32 s57, 1048576
  s_cbranch_scc1 L_exit
  s_branch L_r_wait
L_r_go:
  s_bfe_u32 s58, s63, 0x60004
  s_bfe_u32 s59, s63, 0x1000e
  s_lshl1_add_u32 s58, s58, s59
  s_mul_i32 s64, s58, 786432
  s_bfe_u32 s59, s63, 0x2000c
  s_lshl2_add_u32 s59, s59, s44
  s_lshl_b32 s58, s58, 14
  s_lshl_b32 s71, s59, 6
  s_add_u32 s71, s71, s58
  s_lshl_b32 s59, s59, 10
  s_add_u32 s64, s64, s59
  s_add_u32 s64, s64, 0x6000000
  s_bitcmp1_b32 s63, 2
  s_cselect_b32 s64, 0x40000000, s64
  buffer_load_dwordx4 v[64:67], v2, s[40:43], s64 offen sc1
  s_add_u32 s64, s64, 0x4000
  buffer_load_dwordx4 v[68:71], v2, s[40:43], s64 offen sc1
  s_add_u32 s64, s64, 0x4000
  buffer_load_dwordx4 v[72:75], v2, s[40:43], s64 offen sc1
  s_add_u32 s64, s64, 0x4000
  buffer_load_dwordx4 v[76:79], v2, s[40:43], s64 offen sc1
  s_add_u32 s64, s64, 0x4000
  buffer_load_dwordx4 v[80:83], v2, s[40:43], s64 offen sc1
  s_add_u32 s64, s64, 0x4000
  buffer_load_dwordx4 v[84:87], v2, s[40:43], s64 offen sc1
  s_add_u32 s64, s64, 0x4000
  buffer_load_dwordx4 v[88:91], v2, s[40:43], s64 offen sc1
  s_add_u32 s64, s64, 0x4000
  buffer_load_dwordx4 v[92:95], v2, s[40:43], s64 offen sc1
  s_add_u32 s64, s64, 0x4000
  buffer_load_dwordx4 v[96:99], v2, s[40:43], s64 offen sc1
  s_add_u32 s64, s64, 0x4000
  buffer_load_dwordx4 v[100:103], v2, s[40:43], s64 offen sc1
  s_add_u32 s64, s64, 0x4000
  buffer_load_dwordx4 v[104:107], v2, s[40:43], s64 offen sc1
  s_add_u32 s64, s64, 0x4000
  buffer_load_dwordx4 v[108:111], v2, s[40:43], s64 offen sc1
  s_add_u32 s64, s64, 0x4000
  buffer_load_dwordx4 v[112:115], v2, s[40:43], s64 offen sc1
  s_add_u32 s64, s64, 0x4000
  buffer_load_dwordx4 v[116:119], v2, s[40:43], s64 offen sc1
  s_add_u32 s64, s64, 0x4000
  buffer_load_dwordx4 v[120:123], v2, s[40:43], s64 offen sc1
  s_add_u32 s64, s64, 0x4000
L_r_loop:
  s_mov_b32 s61, s63
  s_mov_b32 s65, s71
  s_add_u32 s95, s95, 1
  s_nop 0
  v_readlane_b32 s63, v1, s95
  buffer_load_dwordx4 v[124:127], v2, s[40:43], s64 offen sc1
  s_add_u32 s64, s64, 0x4000
  s_waitcnt vmcnt(15)
  v_mfma_f32_16x16x32_bf16 v[16:19], v[8:11], v[64:67], 0
  v_mfma_f32_16x16x32_bf16 v[20:23], v[12:15], v[64:67], 0
  buffer_load_dwordx4 v[64:67], v2, s[40:43], s64 offen sc1
  s_add_u32 s64, s64, 0x4000
  s_waitcnt vmcnt(15)
  v_mfma_f32_16x16x32_bf16 v[16:19], v[8:11], v[68:71], v[16:19]
  v_mfma_f32_16x16x32_bf16 v[20:23], v[12:15], v[68:71], v[20:23]
  buffer_load_dwordx4 v[68:71], v2, s[40:43], s64 offen sc1
  s_add_u32 s64, s64, 0x4000
  s_waitcnt vmcnt(15)
  v_mfma_f32_16x16x32_bf16 v[16:19], v[8:11], v[72:75], v[16:19]
  v_mfma_f32_16x16x32_bf16 v[20:23], v[12:15], v[72:75], v[20:23]
  buffer_load_dwordx4 v[72:75], v2, s[40:43], s64 offen sc1
  s_add_u32 s64, s64, 0x4000
  s_waitcnt vmcnt(15)
  v_mfma_f32_16x16x32_bf16 v[16:19], v[8:11], v[76:79], v[16:19]
  v_mfma_f32_16x16x32_bf16 v[20:23], v[12:15], v[76:79], v[20:23]
  buffer_load_dwordx4 v[76:79], v2, s[40:43], s64 offen sc1
  s_add_u32 s64, s64, 0x4000
  s_waitcnt vmcnt(15)
  v_mfma_f32_16x16x32_bf16 v[16:19], v[8:11], v[80:83], v[16:19]
  v_mfma_f32_16x16x32_bf16 v[20:23], v[12:15], v[80:83], v[20:23]
  buffer_load_dwordx4 v[80:83], v2, s[40:43], s64 offen sc1
  s_add_u32 s64, s64, 0x4000
  s_waitcnt vmcnt(15)
  v_mfma_f32_16x16x32_bf16 v[16:19], v[8:11], v[84:87], v[16:19]
  v_mfma_f32_16x16x32_bf16 v[20:23], v[12:15], v[84:87], v[20:23]
  buffer_load_dwordx4 v[84:87], v2, s[40:43], s64 offen sc1
  s_add_u32 s64, s64, 0x4000
  s_waitcnt vmcnt(15)
  v_mfma_f32_16x16x32_bf16 v[16:19], v[8:11], v[88:91], v[16:19]
  v_mfma_f32_16x16x32_bf16 v[20:23], v[12:15], v[88:91], v[20:23]
  buffer_load_dwordx4 v[88:91], v2, s[40:43], s64 offen sc1
  s_add_u32 s64, s64, 0x4000
  s_waitcnt vmcnt(15)
  v_mfma_f32_16x16x32_bf16 v[16:19], v[8:11], v[92:95], v[16:19]
  v_mfma_f32_16x16x32_bf16 v[20:23], v[12:15], v[92:95], v[20:23]
  buffer_load_dwordx4 v[92:95], v2, s[40:43], s64 offen sc1
  s_add_u32 s64, s64, 0x4000
  s_waitcnt vmcnt(15)
  v_mfma_f32_16x16x32_bf16 v[16:19], v[8:11], v[96:99], v[16:19]
  v_mfma_f32_16x16x32_bf16 v[20:23], v[12:15], v[96:99], v[20:23]
  buffer_load_dwordx4 v[96:99], v2, s[40:43], s64 offen sc1
  s_add_u32 s64, s64, 0x4000
  s_waitcnt vmcnt(15)
  v_mfma_f32_16x16x32_bf16 v[16:19], v[8:11], v[100:103], v[16:19]
  v_mfma_f32_16x16x32_bf16 v[20:23], v[12:15], v[100:103], v[20:23]
  buffer_load_dwordx4 v[100:103], v2, s[40:43], s64 offen sc1
  s_add_u32 s64, s64, 0x4000
  s_waitcnt vmcnt(15)
  v_mfma_f32_16x16x32_bf16 v[16:19], v[8:11], v[104:107], v[16:19]
  v_mfma_f32_16x16x32_bf16 v[20:23], v[12:15], v[104:107], v[20:23]
  buffer_load_dwordx4 v[104:107], v2, s[40:43], s64 offen sc1
  s_add_u32 s64, s64, 0x4000
  s_waitcnt vmcnt(15)
  v_mfma_f32_16x16x32_bf16 v[16:19], v[8:11], v[108:111], v[16:19]
  v_mfma_f32_16x16x32_bf16 v[20:23], v[12:15], v[108:111], v[20:23]
  buffer_load_dwordx4 v[108:111], v2, s[40:43], s64 offen sc1
  s_add_u32 s64, s64, 0x4000
  s_waitcnt vmcnt(15)
  v_mfma_f32_16x16x32_bf16 v[16:19], v[8:11], v[112:115], v[16:19]
  v_mfma_f32_16x16x32_bf16 v[20:23], v[12:15], v[112:115], v[20:23]
  buffer_load_dwordx4 v[112:115], v2, s[40:43], s64 offen sc1
  s_add_u32 s64, s64, 0x4000
  s_waitcnt vmcnt(15)
  v_mfma_f32_16x16x32_bf16 v[16:19], v[8:11], v[116:119], v[16:19]
  v_mfma_f32_16x16x32_bf16 v[20:23], v[12:15], v[116:119], v[20:23]
  buffer_load_dwordx4 v[116:119], v2, s[40:43], s64 offen sc1
  s_add_u32 s64, s64, 0x4000
  s_waitcnt vmcnt(15)
  v_mfma_f32_16x16x32_bf16 v[16:19], v[8:11], v[120:123], v[16:19]
  v_mfma_f32_16x16x32_bf16 v[20:23], v[12:15], v[120:123], v[20:23]
  buffer_load_dwordx4 v[120:123], v2, s[40:43], s64 offen sc1
  s_add_u32 s64, s64, 0x4000
  s_waitcnt vmcnt(15)
  v_mfma_f32_16x16x32_bf16 v[16:19], v[8:11], v[124:127], v[16:19]
  v_mfma_f32_16x16x32_bf16 v[20:23], v[12:15], v[124:127], v[20:23]
  buffer_load_dwordx4 v[124:127], v2, s[40:43], s64 offen sc1
  s_add_u32 s64, s64, 0x4000
  s_waitcnt vmcnt(15)
  v_mfma_f32_16x16x32_bf16 v[16:19], v[8:11], v[64:67], v[16:19]
  v_mfma_f32_16x16x32_bf16 v[20:23], v[12:15], v[64:67], v[20:23]
  s_cmp_lg_u32 s62, 0
  s_cbranch_scc1 L_r_stage
L_r_stageback:
  buffer_load_dwordx4 v[64:67], v2, s[40:43], s64 offen sc1
  s_add_u32 s64, s64, 0x4000
  s_waitcnt vmcnt(15)
  v_mfma_f32_16x16x32_bf16 v[16:19], v[8:11], v[68:71], v[16:19]
  v_mfma_f32_16x16x32_bf16 v[20:23], v[12:15], v[68:71], v[20:23]
  buffer_load_dwordx4 v[68:71], v2, s[40:43], s64 offen sc1
  s_add_u32 s64, s64, 0x4000
  s_waitcnt vmcnt(15)
  v_mfma_f32_16x16x32_bf16 v[16:19], v[8:11], v[72:75], v[16:19]
  v_mfma_f32_16x16x32_bf16 v[20:23], v[12:15], v[72:75], v[20:23]
  buffer_load_dwordx4 v[72:75], v2, s[40:43], s64 offen sc1
  s_add_u32 s64, s64, 0x4000
  s_waitcnt vmcnt(15)
  v_mfma_f32_16x16x32_bf16 v[16:19], v[8:11], v[76:79], v[16:19]
  v_mfma_f32_16x16x32_bf16 v[20:23], v[12:15], v[76:79], v[20:23]
  buffer_load_dwordx4 v[76:79], v2, s[40:43], s64 offen sc1
  s_add_u32 s64, s64, 0x4000
  s_waitcnt vmcnt(15)
  v_mfma_f32_16x16x32_bf16 v[16:19], v[8:11], v[80:83], v[16:19]
  v_mfma_f32_16x16x32_bf16 v[20:23], v[12:15], v[80:83], v[20:23]
  buffer_load_dwordx4 v[80:83], v2, s[40:43], s64 offen sc1
  s_add_u32 s64, s64, 0x4000
  s_waitcnt vmcnt(15)
  v_mfma_f32_16x16x32_bf16 v[16:19], v[8:11], v[84:87], v[16:19]
  v_mfma_f32_16x16x32_bf16 v[20:23], v[12:15], v[84:87], v[20:23]
  buffer_load_dwordx4 v[84:87], v2, s[40:43], s64 offen sc1
  s_add_u32 s64, s64, 0x4000
  s_waitcnt vmcnt(15)
  v_mfma_f32_16x16x32_bf16 v[16:19], v[8:11], v[88:91], v[16:19]
  v_mfma_f32_16x16x32_bf16 v[20:23], v[12:15], v[88:91], v[20:23]
  buffer_load_dwordx4 v[88:91], v2, s[40:43], s64 offen sc1
  s_add_u32 s64, s64, 0x4000
  s_waitcnt vmcnt(15)
  v_mfma_f32_16x16x32_bf16 v[16:19], v[8:11], v[92:95], v[16:19]
  v_mfma_f32_16x16x32_bf16 v[20:23], v[12:15], v[92:95], v[20:23]
  buffer_load_dwordx4 v[92:95], v2, s[40:43], s64 offen sc1
  s_add_u32 s64, s64, 0x4000
  s_waitcnt vmcnt(15)
  v_mfma_f32_16x16x32_bf16 v[16:19], v[8:11], v[96:99], v[16:19]
  v_mfma_f32_16x16x32_bf16 v[20:23], v[12:15], v[96:99], v[20:23]
  buffer_load_dwordx4 v[96:99], v2, s[40:43], s64 offen sc1
  s_add_u32 s64, s64, 0x4000
  s_waitcnt vmcnt(15)
  v_mfma_f32_16x16x32_bf16 v[16:19], v[8:11], v[100:103], v[16:19]
  v_mfma_f32_16x16x32_bf16 v[20:23], v[12:15], v[100:103], v[20:23]
  buffer_load_dwordx4 v[100:103], v2, s[40:43], s64 offen sc1
  s_add_u32 s64, s64, 0x4000
  s_waitcnt vmcnt(15)
  v_mfma_f32_16x16x32_bf16 v[16:19], v[8:11], v[104:107], v[16:19]
  v_mfma_f32_16x16x32_bf16 v[20:23], v[12:15], v[104:107], v[20:23]
  buffer_load_dwordx4 v[104:107], v2, s[40:43], s64 offen sc1
  s_add_u32 s64, s64, 0x4000
  s_waitcnt vmcnt(15)
  v_mfma_f32_16x16x32_bf16 v[16:19], v[8:11], v[108:111], v[16:19]
  v_mfma_f32_16x16x32_bf16 v[20:23], v[12:15], v[108:111], v[20:23]
  buffer_load_dwordx4 v[108:111], v2, s[40:43], s64 offen sc1
  s_add_u32 s64, s64, 0x4000
  s_waitcnt vmcnt(15)
  v_mfma_f32_16x16x32_bf16 v[16:19], v[8:11], v[112:115], v[16:19]
  v_mfma_f32_16x16x32_bf16 v[20:23], v[12:15], v[112:115], v[20:23]
  buffer_load_dwordx4 v[112:115], v2, s[40:43], s64 offen sc1
  s_add_u32 s64, s64, 0x4000
  s_waitcnt vmcnt(15)
  v_mfma_f32_16x16x32_bf16 v[16:19], v[8:11], v[116:119], v[16:19]
  v_mfma_f32_16x16x32_bf16 v[20:23], v[12:15], v[116:119], v[20:23]
  buffer_load_dwordx4 v[116:119], v2, s[40:43], s64 offen sc1
  s_add_u32 s64, s64, 0x4000
  s_waitcnt vmcnt(15)
  v_mfma_f32_16x16x32_bf16 v[16:19], v[8:11], v[120:123], v[16:19]
  v_mfma_f32_16x16x32_bf16 v[20:23], v[12:15], v[120:123], v[20:23]
  buffer_load_dwordx4 v[120:123], v2, s[40:43], s64 offen sc1
  s_add_u32 s64, s64, 0x4000
  s_waitcnt vmcnt(15)
  v_mfma_f32_16x16x32_bf16 v[16:19], v[8:11], v[124:127], v[16:19]
  v_mfma_f32_16x16x32_bf16 v[20:23], v[12:15], v[124:127], v[20:23]
  buffer_load_dwordx4 v[124:127], v2, s[40:43], s64 offen sc1
  s_add_u32 s64, s64, 0x4000
  s_waitcnt vmcnt(15)
  v_mfma_f32_16x16x32_bf16 v[16:19], v[8:11], v[64:67], v[16:19]
  v_mfma_f32_16x16x32_bf16 v[20:23], v[12:15], v[64:67], v[20:23]
  s_bfe_u32 s58, s63, 0x60004
  s_bfe_u32 s59, s63, 0x1000e
  s_lshl1_add_u32 s58, s58, s59
  s_mul_i32 s64, s58, 786432
  s_bfe_u32 s59, s63, 0x2000c
  s_lshl2_add_u32 s59, s59, s44
  s_lshl_b32 s58, s58, 14
  s_lshl_b32 s71, s59, 6
  s_add_u32 s71, s71, s58
  s_lshl_b32 s59, s59, 10
  s_add_u32 s64, s64, s59
  s_add_u32 s64, s64, 0x6000000
  s_bitcmp1_b32 s63, 2
  s_cselect_b32 s64, 0x40000000, s64
  buffer_load_dwordx4 v[64:67], v2, s[40:43], s64 offen sc1
  s_add_u32 s64, s64, 0x4000
  s_waitcnt vmcnt(15)
  v_mfma_f32_16x16x32_bf16 v[16:19], v[8:11], v[68:71], v[16:19]
  v_mfma_f32_16x16x32_bf16 v[20:23], v[12:15], v[68:71], v[20:23]
  buffer_load_dwordx4 v[68:71], v2, s[40:43], s64 offen sc1
  s_add_u32 s64, s64, 0x4000
  s_waitcnt vmcnt(15)
  v_mfma_f32_16x16x32_bf16 v[16:19], v[8:11], v[72:75], v[16:19]
  v_mfma_f32_16x16x32_bf16 v[20:23], v[12:15], v[72:75], v[20:23]
  buffer_load_dwordx4 v[72:75], v2, s[40:43], s64 offen sc1
  s_add_u32 s64, s64, 0x4000
  s_waitcnt vmcnt(15)
  v_mfma_f32_16x16x32_bf16 v[16:19], v[8:11], v[76:79], v[16:19]
  v_mfma_f32_16x16x32_bf16 v[20:23], v[12:15], v[76:79], v[20:23]
  buffer_load_dwordx4 v[76:79], v2, s[40:43], s64 offen sc1
  s_add_u32 s64, s64, 0x4000
  s_waitcnt vmcnt(15)
  v_mfma_f32_16x16x32_bf16 v[16:19], v[8:11], v[80:83], v[16:19]
  v_mfma_f32_16x16x32_bf16 v[20:23], v[12:15], v[80:83], v[20:23]
  buffer_load_dwordx4 v[80:83], v2, s[40:43], s64 offen sc1
  s_add_u32 s64, s64, 0x4000
  s_waitcnt vmcnt(15)
  v_mfma_f32_16x16x32_bf16 v[16:19], v[8:11], v[84:87], v[16:19]
  v_mfma_f32_16x16x32_bf16 v[20:23], v[12:15], v[84:87], v[20:23]
  buffer_load_dwordx4 v[84:87], v2, s[40:43], s64 offen sc1
  s_add_u32 s64, s64, 0x4000
  s_waitcnt vmcnt(15)
  v_mfma_f32_16x16x32_bf16 v[16:19], v[8:11], v[88:91], v[16:19]
  v_mfma_f32_16x16x32_bf16 v[20:23], v[12:15], v[88:91], v[20:23]
  buffer_load_dwordx4 v[88:91], v2, s[40:43], s64 offen sc1
  s_add_u32 s64, s64, 0x4000
  s_waitcnt vmcnt(15)
  v_mfma_f32_16x16x32_bf16 v[16:19], v[8:11], v[92:95], v[16:19]
  v_mfma_f32_16x16x32_bf16 v[20:23], v[12:15], v[92:95], v[20:23]
  buffer_load_dwordx4 v[92:95], v2, s[40:43], s64 offen sc1
  s_add_u32 s64, s64, 0x4000
  s_waitcnt vmcnt(15)
  v_mfma_f32_16x16x32_bf16 v[16:19], v[8:11], v[96:99], v[16:19]
  v_mfma_f32_16x16x32_bf16 v[20:23], v[12:15], v[96:99], v[20:23]
  buffer_load_dwordx4 v[96:99], v2, s[40:43], s64 offen sc1
  s_add_u32 s64, s64, 0x4000
  s_waitcnt vmcnt(15)
  v_mfma_f32_16x16x32_bf16 v[16:19], v[8:11], v[100:103], v[16:19]
  v_mfma_f32_16x16x32_bf16 v[20:23], v[12:15], v[100:103], v[20:23]
  buffer_load_dwordx4 v[100:103], v2, s[40:43], s64 offen sc1
  s_add_u32 s64, s64, 0x4000
  s_waitcnt vmcnt(15)
  v_mfma_f32_16x16x32_bf16 v[16:19], v[8:11], v[104:107], v[16:19]
  v_mfma_f32_16x16x32_bf16 v[20:23], v[12:15], v[104:107], v[20:23]
  buffer_load_dwordx4 v[104:107], v2, s[40:43], s64 offen sc1
  s_add_u32 s64, s64, 0x4000
  s_waitcnt vmcnt(15)
  v_mfma_f32_16x16x32_bf16 v[16:19], v[8:11], v[108:111], v[16:19]
  v_mfma_f32_16x16x32_bf16 v[20:23], v[12:15], v[108:111], v[20:23]
  buffer_load_dwordx4 v[108:111], v2, s[40:43], s64 offen sc1
  s_add_u32 s64, s64, 0x4000
  s_waitcnt vmcnt(15)
  v_mfma_f32_16x16x32_bf16 v[16:19], v[8:11], v[112:115], v[16:19]
  v_mfma_f32_16x16x32_bf16 v[20:23], v[12:15], v[112:115], v[20:23]
  buffer_load_dwordx4 v[112:115], v2, s[40:43], s64 offen sc1
  s_add_u32 s64, s64, 0x4000
  s_waitcnt vmcnt(15)
  v_mfma_f32_16x16x32_bf16 v[16:19], v[8:11], v[116:119], v[16:19]
  v_mfma_f32_16x16x32_bf16 v[20:23], v[12:15], v[116:119], v[20:23]
  buffer_load_dwordx4 v[116:119], v2, s[40:43], s64 offen sc1
  s_add_u32 s64, s64, 0x4000
  s_waitcnt vmcnt(15)
  v_mfma_f32_16x16x32_bf16 v[16:19], v[8:11], v[120:123], v[16:19]
  v_mfma_f32_16x16x32_bf16 v[20:23], v[12:15], v[120:123], v[20:23]
  buffer_load_dwordx4 v[120:123], v2, s[40:43], s64 offen sc1
  s_add_u32 s64, s64, 0x4000
  s_waitcnt vmcnt(15)
  v_mfma_f32_16x16x32_bf16 v[16:19], v[8:11], v[124:127], v[16:19]
  v_mfma_f32_16x16x32_bf16 v[20:23], v[12:15], v[124:127], v[20:23]
  s_nop 6
  v_cvt_pk_bf16_f32 v32, v16, v17
  v_cvt_pk_bf16_f32 v33, v18, v19
  v_cvt_pk_bf16_f32 v34, v20, v21
  v_cvt_pk_bf16_f32 v35, v22, v23
  buffer_store_dwordx4 v[32:35], v24, s[48:51], s65 offen
  s_bitcmp1_b32 s63, 2
  s_cbranch_scc0 L_r_loop
  s_waitcnt vmcnt(1)
  s_branch L_next
L_r_stage:
  s_bfe_u32 s66, s61, 0x60004
  s_lshl_b32 s66, s66, 6
  s_add_u32 s66, s66, 0xd087000
L_r_st2:
  buffer_load_dword v3, v7, s[40:43], s66 offen sc1
  s_add_u32 s57, s57, 1
  s_cmp_gt_u32 s57, 1048576
  s_cbranch_scc1 L_exit
  s_waitcnt vmcnt(0)
  v_cmp_gt_u32 vcc, 16, v3
  s_cbranch_vccnz L_r_st2
  s_branch L_r_stageback
L_feed:
  s_cmp_lt_u32 s57, 4
  s_cselect_b64 s[52:53], s[10:11], s[8:9]
  s_cselect_b64 s[48:49], s[14:15], s[12:13]
  s_cselect_b64 s[4:5], s[16:17], s[24:25]
  s_cselect_b32 s72, 0x21, 0x30
  s_cselect_b32 s67, 16, 32
  s_cselect_b32 s69, 1.0, 0x3e0293ee
  s_cselect_b32 s70, 0, 0xffe80000
  s_cselect_b32 s74, 2, 4
  s_cmp_eq_u32 s57, 6
  s_cselect_b64 s[48:49], s[26:27], s[48:49]
  s_cselect_b64 s[4:5], s[28:29], s[4:5]
  s_cselect_b32 s72, 0x54, s72
  s_cselect_b32 s67, 64, s67
  s_cselect_b32 s69, 1.0, s69
  s_cselect_b32 s70, 0, s70
  s_cselect_b32 s74, 2, s74
  s_lshl_b32 s58, s57, 2
  s_lshr_b32 s73, 0x0233210, s58
  s_and_b32 s73, s73, 15
  s_ashr_i32 s71, s70, 2
  s_add_u32 s71, s71, 0x2000
  s_and_b32 s53, s53, 0xffff
  s_mov_b32 s54, 0x200000
  s_mov_b32 s55, 0x20000
  s_cmp_lt_u32 s44, 2
  s_cselect_b64 s[48:49], s[48:49], s[4:5]
  s_cselect_b32 s58, 0, 4
  s_lshr_b32 s72, s72, s58
  s_and_b32 s72, s72, 15
  s_and_b32 s49, s49, 0xffff
  s_mov_b32 s50, 0x400000
  s_mov_b32 s51, 0x20000
  v_lshlrev_b32 v2, 4, v0
  v_mov_b32 v6, 0
  v_lshrrev_b32 v3, 3, v0
  v_lshlrev_b32 v20, 13, v3
  v_and_b32 v3, 2, v3
  v_and_b32 v4, 7, v0
  v_xor_b32 v3, v3, v4
  v_lshl_add_u32 v20, v3, 4, v20
  v_xor_b32 v21, 64, v20
  s_lshl_b32 s60, s44, 14
  s_add_u32 s60, s60, 0x18000
  s_and_b32 s59, s44, 1
  s_lshl1_add_u32 s75, s56, s59
  s_lshl_b32 s75, s75, 7
  s_lshl_b32 s58, s57, 2
  s_lshr_b32 s78, 0, s58
  s_and_b32 s78, s78, 15
  s_lshl_b32 s58, s78, 20
  s_or_b32 s75, s75, s58
  s_cmp_lt_u32 s72, 3
  s_cbranch_scc1 L_f_w_3
  s_add_u32 m0, s60, 0
  s_xor_b32 s58, s75, 0
  buffer_load_dwordx4 v20, s[48:51], s58 offen  lds
  s_add_u32 m0, s60, 1024
  s_xor_b32 s58, s75, 65536
  buffer_load_dwordx4 v21, s[48:51], s58 offen  lds
  s_add_u32 m0, s60, 2048
  s_xor_b32 s58, s75, 131072
  buffer_load_dwordx4 v20, s[48:51], s58 offen  lds
  s_add_u32 m0, s60, 3072
  s_xor_b32 s58, s75, 196608
  buffer_load_dwordx4 v21, s[48:51], s58 offen  lds
  s_branch L_f_w_3e
L_f_w_3:
  s_add_u32 m0, s60, 0
  s_xor_b32 s58, s75, 0
  buffer_load_dwordx4 v20, s[48:51], s58 offen nt lds
  s_add_u32 m0, s60, 1024
  s_xor_b32 s58, s75, 65536
  buffer_load_dwordx4 v21, s[48:51], s58 offen nt lds
  s_add_u32 m0, s60, 2048
  s_xor_b32 s58, s75, 131072
  buffer_load_dwordx4 v20, s[48:51], s58 offen nt lds
  s_add_u32 m0, s60, 3072
  s_xor_b32 s58, s75, 196608
  buffer_load_dwordx4 v21, s[48:51], s58 offen nt lds
L_f_w_3e:
  s_cmp_lt_u32 s72, 3
  s_cbranch_scc1 L_f_w_4
  s_add_u32 m0, s60, 4096
  s_xor_b32 s58, s75, 262144
  buffer_load_dwordx4 v20, s[48:51], s58 offen  lds
  s_add_u32 m0, s60, 5120
  s_xor_b32 s58, s75, 327680
  buffer_load_dwordx4 v21, s[48:51], s58 offen  lds
  s_add_u32 m0, s60, 6144
  s_xor_b32 s58, s75, 393216
  buffer_load_dwordx4 v20, s[48:51], s58 offen  lds
  s_add_u32 m0, s60, 7168
  s_xor_b32 s58, s75, 458752
  buffer_load_dwordx4 v21, s[48:51], s58 offen  lds
  s_branch L_f_w_4e
L_f_w_4:
  s_add_u32 m0, s60, 4096
  s_xor_b32 s58, s75, 262144
  buffer_load_dwordx4 v20, s[48:51], s58 offen nt lds
  s_add_u32 m0, s60, 5120
  s_xor_b32 s58, s75, 327680
  buffer_load_dwordx4 v21, s[48:51], s58 offen nt lds
  s_add_u32 m0, s60, 6144
  s_xor_b32 s58, s75, 393216
  buffer_load_dwordx4 v20, s[48:51], s58 offen nt lds
  s_add_u32 m0, s60, 7168
  s_xor_b32 s58, s75, 458752
  buffer_load_dwordx4 v21, s[48:51], s58 offen nt lds
L_f_w_4e:
  s_cmp_lt_u32 s72, 3
  s_cbranch_scc1 L_f_w_5
  s_add_u32 m0, s60, 8192
  s_xor_b32 s58, s75, 524288
  buffer_load_dwordx4 v20, s[48:51], s58 offen  lds
  s_add_u32 m0, s60, 9216
  s_xor_b32 s58, s75, 589824
  buffer_load_dwordx4 v21, s[48:51], s58 offen  lds
  s_add_u32 m0, s60, 10240
  s_xor_b32 s58, s75, 655360
  buffer_load_dwordx4 v20, s[48:51], s58 offen  lds
  s_add_u32 m0, s60, 11264
  s_xor_b32 s58, s75, 720896
  buffer_load_dwordx4 v21, s[48:51], s58 offen  lds
  s_branch L_f_w_5e
L_f_w_5:
  s_add_u32 m0, s60, 8192
  s_xor_b32 s58, s75, 524288
  buffer_load_dwordx4 v20, s[48:51], s58 offen nt lds
  s_add_u32 m0, s60, 9216
  s_xor_b32 s58, s75, 589824
  buffer_load_dwordx4 v21, s[48:51], s58 offen nt lds
  s_add_u32 m0, s60, 10240
  s_xor_b32 s58, s75, 655360
  buffer_load_dwordx4 v20, s[48:51], s58 offen nt lds
  s_add_u32 m0, s60, 11264
  s_xor_b32 s58, s75, 720896
  buffer_load_dwordx4 v21, s[48:51], s58 offen nt lds
L_f_w_5e:
  s_cmp_lt_u32 s72, 3
  s_cbranch_scc1 L_f_w_6
  s_add_u32 m0, s60, 12288
  s_xor_b32 s58, s75, 786432
  buffer_load_dwordx4 v20, s[48:51], s58 offen  lds
  s_add_u32 m0, s60, 13312
  s_xor_b32 s58, s75, 851968
  buffer_load_dwordx4 v21, s[48:51], s58 offen  lds
  s_add_u32 m0, s60, 14336
  s_xor_b32 s58, s75, 917504
  buffer_load_dwordx4 v20, s[48:51], s58 offen  lds
  s_add_u32 m0, s60, 15360
  s_xor_b32 s58, s75, 983040
  buffer_load_dwordx4 v21, s[48:51], s58 offen  lds
  s_branch L_f_w_6e
L_f_w_6:
  s_add_u32 m0, s60, 12288
  s_xor_b32 s58, s75, 786432
  buffer_load_dwordx4 v20, s[48:51], s58 offen nt lds
  s_add_u32 m0, s60, 13312
  s_xor_b32 s58, s75, 851968
  buffer_load_dwordx4 v21, s[48:51], s58 offen nt lds
  s_add_u32 m0, s60, 14336
  s_xor_b32 s58, s75, 917504
  buffer_load_dwordx4 v20, s[48:51], s58 offen nt lds
  s_add_u32 m0, s60, 15360
  s_xor_b32 s58, s75, 983040
  buffer_load_dwordx4 v21, s[48:51], s58 offen nt lds
L_f_w_6e:
  s_mov_b32 s76, 0x40000000
  v_and_b32 v32, 15, v0
  v_mov_b32 v33, 1
  s_lshl2_add_u32 s58, s44, s57
  s_cmp_ge_u32 s58, 4
  s_cbranch_scc1 L_f_nogate
  s_mov_b64 s[4:5], s[8:9]
  s_mov_b64 s[6:7], s[34:35]
  v_lshrrev_b32 v4, 4, v0
  v_lshlrev_b32 v4, 4, v4
  v_lshl_add_u32 v5, v32, 10, v4
  s_lshl2_add_u32 s77, s56, s57
  s_lshl_b32 s58, s77, 14
  v_add_u32 v5, s58, v5
  global_load_dwordx4 v[64:67], v5, s[4:5] offset:0
  global_load_dwordx4 v[128:131], v4, s[6:7] offset:0
  global_load_dwordx4 v[68:71], v5, s[4:5] offset:64
  global_load_dwordx4 v[132:135], v4, s[6:7] offset:64
  global_load_dwordx4 v[72:75], v5, s[4:5] offset:128
  global_load_dwordx4 v[136:139], v4, s[6:7] offset:128
  global_load_dwordx4 v[76:79], v5, s[4:5] offset:192
  global_load_dwordx4 v[140:143], v4, s[6:7] offset:192
  global_load_dwordx4 v[80:83], v5, s[4:5] offset:256
  global_load_dwordx4 v[144:147], v4, s[6:7] offset:256
  global_load_dwordx4 v[84:87], v5, s[4:5] offset:320
  global_load_dwordx4 v[148:151], v4, s[6:7] offset:320
  global_load_dwordx4 v[88:91], v5, s[4:5] offset:384
  global_load_dwordx4 v[152:155], v4, s[6:7] offset:384
  global_load_dwordx4 v[92:95], v5, s[4:5] offset:448
  global_load_dwordx4 v[156:159], v4, s[6:7] offset:448
  global_load_dwordx4 v[96:99], v5, s[4:5] offset:512
  global_load_dwordx4 v[160:163], v4, s[6:7] offset:512
  global_load_dwordx4 v[100:103], v5, s[4:5] offset:576
  global_load_dwordx4 v[164:167], v4, s[6:7] offset:576
  global_load_dwordx4 v[104:107], v5, s[4:5] offset:640
  global_load_dwordx4 v[168:171], v4, s[6:7] offset:640
  global_load_dwordx4 v[108:111], v5, s[4:5] offset:704
  global_load_dwordx4 v[172:175], v4, s[6:7] offset:704
  global_load_dwordx4 v[112:115], v5, s[4:5] offset:768
  global_load_dwordx4 v[176:179], v4, s[6:7] offset:768
  global_load_dwordx4 v[116:119], v5, s[4:5] offset:832
  global_load_dwordx4 v[180:183], v4, s[6:7] offset:832
  global_load_dwordx4 v[120:123], v5, s[4:5] offset:896
  global_load_dwordx4 v[184:187], v4, s[6:7] offset:896
  global_load_dwordx4 v[124:127], v5, s[4:5] offset:960
  global_load_dwordx4 v[188:191], v4, s[6:7] offset:960
  v_lshlrev_b32 v32, 2, v32
  s_lshl_b32 s77, s77, 6
  s_add_u32 s77, s77, 0xd0c0000
  s_lshr_b32 s76, s56, 2
  s_lshl_b32 s76, s76, 7
  s_add_u32 s76, s76, 0xd086400
L_f_nogate:
  v_lshrrev_b32 v3, 4, v0
  v_lshl_add_u32 v24, v3, 10, s60
  v_bfe_u32 v4, v0, 2, 2
  v_lshl_add_u32 v24, v4, 7, v24
  v_bfe_u32 v4, v0, 3, 2
  v_lshl_add_u32 v24, v4, 5, v24
  v_and_b32 v4, 3, v0
  v_lshl_add_u32 v24, v4, 3, v24
  v_and_b32 v4, 15, v0
  v_xor_b32 v3, v3, v4
  v_lshlrev_b32 v3, 4, v3
  v_lshl_add_u32 v16, v4, 10, v3
  s_lshl1_add_u32 s58, s78, s59
  s_lshl_b32 s58, s58, 7
  v_xor_b32 v8, s58, v2
  s_lshl_b32 s62, s72, 24
  s_lshl_b32 s58, s56, 19
  s_add_u32 s62, s62, s58
  s_lshl_b32 s58, s73, 17
  s_add_u32 s62, s62, s58
  s_lshl_b32 s58, s59, 12
  s_add_u32 s62, s62, s58
  s_add_u32 s62, s62, 0x40000000
  s_mov_b32 s65, 0xc0000000
  s_lshl_b32 s58, s57, 2
  s_cmp_eq_u32 s57, 6
  s_cselect_b32 s58, 0x1000, s58
  s_lshl_b32 s64, s56, 7
  s_add_u32 s64, s64, s58
  s_add_u32 s64, s64, 0xd080000
  s_cmp_eq_u32 s44, 0
  s_cselect_b32 s64, s64, 0x40000000
  v_xor_b32 v25, 32, v24
  v_xor_b32 v17, 64, v16
  v_xor_b32 v26, 64, v24
  v_xor_b32 v18, 128, v16
  v_xor_b32 v27, 96, v24
  v_xor_b32 v19, 192, v16
  v_xor_b32 v9, 16, v8
  v_xor_b32 v10, 32, v8
  v_xor_b32 v11, 48, v8
  v_xor_b32 v12, 64, v8
  v_xor_b32 v13, 80, v8
  v_xor_b32 v14, 96, v8
  v_xor_b32 v15, 112, v8
  s_lshl_b32 s66, s44, 13
  s_lshl_b32 s61, s73, 19
  s_add_u32 s61, s61, s66
  s_mov_b32 s63, 0
  s_mov_b32 s68, 0
  s_waitcnt vmcnt(12)
  ds_read_b64_tr_b16 a[0:1], v24 offset:0
  ds_read_b64_tr_b16 a[2:3], v24 offset:512
  ds_read_b64_tr_b16 a[64:65], v25 offset:0
  ds_read_b64_tr_b16 a[66:67], v25 offset:512
  ds_read_b64_tr_b16 a[128:129], v26 offset:0
  ds_read_b64_tr_b16 a[130:131], v26 offset:512
  ds_read_b64_tr_b16 a[192:193], v27 offset:0
  ds_read_b64_tr_b16 a[194:195], v27 offset:512
  s_waitcnt lgkmcnt(0)
  s_cmp_lt_u32 s72, 3
  s_cbranch_scc1 L_f_w_7
  s_add_u32 m0, s60, 0
  s_xor_b32 s58, s75, 1048576
  buffer_load_dwordx4 v20, s[48:51], s58 offen  lds
  s_add_u32 m0, s60, 1024
  s_xor_b32 s58, s75, 1114112
  buffer_load_dwordx4 v21, s[48:51], s58 offen  lds
  s_add_u32 m0, s60, 2048
  s_xor_b32 s58, s75, 1179648
  buffer_load_dwordx4 v20, s[48:51], s58 offen  lds
  s_add_u32 m0, s60, 3072
  s_xor_b32 s58, s75, 1245184
  buffer_load_dwordx4 v21, s[48:51], s58 offen  lds
  s_branch L_f_w_7e
L_f_w_7:
  s_add_u32 m0, s60, 0
  s_xor_b32 s58, s75, 1048576
  buffer_load_dwordx4 v20, s[48:51], s58 offen nt lds
  s_add_u32 m0, s60, 1024
  s_xor_b32 s58, s75, 1114112
  buffer_load_dwordx4 v21, s[48:51], s58 offen nt lds
  s_add_u32 m0, s60, 2048
  s_xor_b32 s58, s75, 1179648
  buffer_load_dwordx4 v20, s[48:51], s58 offen nt lds
  s_add_u32 m0, s60, 3072
  s_xor_b32 s58, s75, 1245184
  buffer_load_dwordx4 v21, s[48:51], s58 offen nt lds
L_f_w_7e:
  s_waitcnt vmcnt(12)
  ds_read_b64_tr_b16 a[4:5], v24 offset:4096
  ds_read_b64_tr_b16 a[6:7], v24 offset:4608
  ds_read_b64_tr_b16 a[68:69], v25 offset:4096
  ds_read_b64_tr_b16 a[70:71], v25 offset:4608
  ds_read_b64_tr_b16 a[132:133], v26 offset:4096
  ds_read_b64_tr_b16 a[134:135], v26 offset:4608
  ds_read_b64_tr_b16 a[196:197], v27 offset:4096
  ds_read_b64_tr_b16 a[198:199], v27 offset:4608
  s_waitcnt lgkmcnt(0)
  s_cmp_lt_u32 s72, 3
  s_cbranch_scc1 L_f_w_8
  s_add_u32 m0, s60, 4096
  s_xor_b32 s58, s75, 1310720
  buffer_load_dwordx4 v20, s[48:51], s58 offen  lds
  s_add_u32 m0, s60, 5120
  s_xor_b32 s58, s75, 1376256
  buffer_load_dwordx4 v21, s[48:51], s58 offen  lds
  s_add_u32 m0, s60, 6144
  s_xor_b32 s58, s75, 1441792
  buffer_load_dwordx4 v20, s[48:51], s58 offen  lds
  s_add_u32 m0, s60, 7168
  s_xor_b32 s58, s75, 1507328
  buffer_load_dwordx4 v21, s[48:51], s58 offen  lds
  s_branch L_f_w_8e
L_f_w_8:
  s_add_u32 m0, s60, 4096
  s_xor_b32 s58, s75, 1310720
  buffer_load_dwordx4 v20, s[48:51], s58 offen nt lds
  s_add_u32 m0, s60, 5120
  s_xor_b32 s58, s75, 1376256
  buffer_load_dwordx4 v21, s[48:51], s58 offen nt lds
  s_add_u32 m0, s60, 6144
  s_xor_b32 s58, s75, 1441792
  buffer_load_dwordx4 v20, s[48:51], s58 offen nt lds
  s_add_u32 m0, s60, 7168
  s_xor_b32 s58, s75, 1507328
  buffer_load_dwordx4 v21, s[48:51], s58 offen nt lds
L_f_w_8e:
  s_waitcnt vmcnt(12)
  ds_read_b64_tr_b16 a[8:9], v24 offset:8192
  ds_read_b64_tr_b16 a[10:11], v24 offset:8704
  ds_read_b64_tr_b16 a[72:73], v25 offset:8192
  ds_read_b64_tr_b16 a[74:75], v25 offset:8704
  ds_read_b64_tr_b16 a[136:137], v26 offset:8192
  ds_read_b64_tr_b16 a[138:139], v26 offset:8704
  ds_read_b64_tr_b16 a[200:201], v27 offset:8192
  ds_read_b64_tr_b16 a[202:203], v27 offset:8704
  s_waitcnt lgkmcnt(0)
  s_cmp_lt_u32 s72, 3
  s_cbranch_scc1 L_f_w_9
  s_add_u32 m0, s60, 8192
  s_xor_b32 s58, s75, 1572864
  buffer_load_dwordx4 v20, s[48:51], s58 offen  lds
  s_add_u32 m0, s60, 9216
  s_xor_b32 s58, s75, 1638400
  buffer_load_dwordx4 v21, s[48:51], s58 offen  lds
  s_add_u32 m0, s60, 10240
  s_xor_b32 s58, s75, 1703936
  buffer_load_dwordx4 v20, s[48:51], s58 offen  lds
  s_add_u32 m0, s60, 11264
  s_xor_b32 s58, s75, 1769472
  buffer_load_dwordx4 v21, s[48:51], s58 offen  lds
  s_branch L_f_w_9e
L_f_w_9:
  s_add_u32 m0, s60, 8192
  s_xor_b32 s58, s75, 1572864
  buffer_load_dwordx4 v20, s[48:51], s58 offen nt lds
  s_add_u32 m0, s60, 9216
  s_xor_b32 s58, s75, 1638400
  buffer_load_dwordx4 v21, s[48:51], s58 offen nt lds
  s_add_u32 m0, s60, 10240
  s_xor_b32 s58, s75, 1703936
  buffer_load_dwordx4 v20, s[48:51], s58 offen nt lds
  s_add_u32 m0, s60, 11264
  s_xor_b32 s58, s75, 1769472
  buffer_load_dwordx4 v21, s[48:51], s58 offen nt lds
L_f_w_9e:
  s_waitcnt vmcnt(12)
  ds_read_b64_tr_b16 a[12:13], v24 offset:12288
  ds_read_b64_tr_b16 a[14:15], v24 offset:12800
  ds_read_b64_tr_b16 a[76:77], v25 offset:12288
  ds_read_b64_tr_b16 a[78:79], v25 offset:12800
  ds_read_b64_tr_b16 a[140:141], v26 offset:12288
  ds_read_b64_tr_b16 a[142:143], v26 offset:12800
  ds_read_b64_tr_b16 a[204:205], v27 offset:12288
  ds_read_b64_tr_b16 a[206:207], v27 offset:12800
  s_waitcnt lgkmcnt(0)
  s_cmp_lt_u32 s72, 3
  s_cbranch_scc1 L_f_w_10
  s_add_u32 m0, s60, 12288
  s_xor_b32 s58, s75, 1835008
  buffer_load_dwordx4 v20, s[48:51], s58 offen  lds
  s_add_u32 m0, s60, 13312
  s_xor_b32 s58, s75, 1900544
  buffer_load_dwordx4 v21, s[48:51], s58 offen  lds
  s_add_u32 m0, s60, 14336
  s_xor_b32 s58, s75, 1966080
  buffer_load_dwordx4 v20, s[48:51], s58 offen  lds
  s_add_u32 m0, s60, 15360
  s_xor_b32 s58, s75, 2031616
  buffer_load_dwordx4 v21, s[48:51], s58 offen  lds
  s_branch L_f_w_10e
L_f_w_10:
  s_add_u32 m0, s60, 12288
  s_xor_b32 s58, s75, 1835008
  buffer_load_dwordx4 v20, s[48:51], s58 offen nt lds
  s_add_u32 m0, s60, 13312
  s_xor_b32 s58, s75, 1900544
  buffer_load_dwordx4 v21, s[48:51], s58 offen nt lds
  s_add_u32 m0, s60, 14336
  s_xor_b32 s58, s75, 1966080
  buffer_load_dwordx4 v20, s[48:51], s58 offen nt lds
  s_add_u32 m0, s60, 15360
  s_xor_b32 s58, s75, 2031616
  buffer_load_dwordx4 v21, s[48:51], s58 offen nt lds
L_f_w_10e:
  s_waitcnt vmcnt(12)
  ds_read_b64_tr_b16 a[16:17], v24 offset:0
  ds_read_b64_tr_b16 a[18:19], v24 offset:512
  ds_read_b64_tr_b16 a[80:81], v25 offset:0
  ds_read_b64_tr_b16 a[82:83], v25 offset:512
  ds_read_b64_tr_b16 a[144:145], v26 offset:0
  ds_read_b64_tr_b16 a[146:147], v26 offset:512
  ds_read_b64_tr_b16 a[208:209], v27 offset:0
  ds_read_b64_tr_b16 a[210:211], v27 offset:512
  s_waitcnt lgkmcnt(0)
  s_cmp_lt_u32 s72, 3
  s_cbranch_scc1 L_f_w_11
  s_add_u32 m0, s60, 0
  s_xor_b32 s58, s75, 2097152
  buffer_load_dwordx4 v20, s[48:51], s58 offen  lds
  s_add_u32 m0, s60, 1024
  s_xor_b32 s58, s75, 2162688
  buffer_load_dwordx4 v21, s[48:51], s58 offen  lds
  s_add_u32 m0, s60, 2048
  s_xor_b32 s58, s75, 2228224
  buffer_load_dwordx4 v20, s[48:51], s58 offen  lds
  s_add_u32 m0, s60, 3072
  s_xor_b32 s58, s75, 2293760
  buffer_load_dwordx4 v21, s[48:51], s58 offen  lds
  s_branch L_f_w_11e
L_f_w_11:
  s_add_u32 m0, s60, 0
  s_xor_b32 s58, s75, 2097152
  buffer_load_dwordx4 v20, s[48:51], s58 offen nt lds
  s_add_u32 m0, s60, 1024
  s_xor_b32 s58, s75, 2162688
  buffer_load_dwordx4 v21, s[48:51], s58 offen nt lds
  s_add_u32 m0, s60, 2048
  s_xor_b32 s58, s75, 2228224
  buffer_load_dwordx4 v20, s[48:51], s58 offen nt lds
  s_add_u32 m0, s60, 3072
  s_xor_b32 s58, s75, 2293760
  buffer_load_dwordx4 v21, s[48:51], s58 offen nt lds
L_f_w_11e:
  s_waitcnt vmcnt(12)
  ds_read_b64_tr_b16 a[20:21], v24 offset:4096
  ds_read_b64_tr_b16 a[22:23], v24 offset:4608
  ds_read_b64_tr_b16 a[84:85], v25 offset:4096
  ds_read_b64_tr_b16 a[86:87], v25 offset:4608
  ds_read_b64_tr_b16 a[148:149], v26 offset:4096
  ds_read_b64_tr_b16 a[150:151], v26 offset:4608
  ds_read_b64_tr_b16 a[212:213], v27 offset:4096
  ds_read_b64_tr_b16 a[214:215], v27 offset:4608
  s_waitcnt lgkmcnt(0)
  s_cmp_lt_u32 s72, 3
  s_cbranch_scc1 L_f_w_12
  s_add_u32 m0, s60, 4096
  s_xor_b32 s58, s75, 2359296
  buffer_load_dwordx4 v20, s[48:51], s58 offen  lds
  s_add_u32 m0, s60, 5120
  s_xor_b32 s58, s75, 2424832
  buffer_load_dwordx4 v21, s[48:51], s58 offen  lds
  s_add_u32 m0, s60, 6144
  s_xor_b32 s58, s75, 2490368
  buffer_load_dwordx4 v20, s[48:51], s58 offen  lds
  s_add_u32 m0, s60, 7168
  s_xor_b32 s58, s75, 2555904
  buffer_load_dwordx4 v21, s[48:51], s58 offen  lds
  s_branch L_f_w_12e
L_f_w_12:
  s_add_u32 m0, s60, 4096
  s_xor_b32 s58, s75, 2359296
  buffer_load_dwordx4 v20, s[48:51], s58 offen nt lds
  s_add_u32 m0, s60, 5120
  s_xor_b32 s58, s75, 2424832
  buffer_load_dwordx4 v21, s[48:51], s58 offen nt lds
  s_add_u32 m0, s60, 6144
  s_xor_b32 s58, s75, 2490368
  buffer_load_dwordx4 v20, s[48:51], s58 offen nt lds
  s_add_u32 m0, s60, 7168
  s_xor_b32 s58, s75, 2555904
  buffer_load_dwordx4 v21, s[48:51], s58 offen nt lds
L_f_w_12e:
  s_waitcnt vmcnt(12)
  ds_read_b64_tr_b16 a[24:25], v24 offset:8192
  ds_read_b64_tr_b16 a[26:27], v24 offset:8704
  ds_read_b64_tr_b16 a[88:89], v25 offset:8192
  ds_read_b64_tr_b16 a[90:91], v25 offset:8704
  ds_read_b64_tr_b16 a[152:153], v26 offset:8192
  ds_read_b64_tr_b16 a[154:155], v26 offset:8704
  ds_read_b64_tr_b16 a[216:217], v27 offset:8192
  ds_read_b64_tr_b16 a[218:219], v27 offset:8704
  s_waitcnt lgkmcnt(0)
  s_cmp_lt_u32 s72, 3
  s_cbranch_scc1 L_f_w_13
  s_add_u32 m0, s60, 8192
  s_xor_b32 s58, s75, 2621440
  buffer_load_dwordx4 v20, s[48:51], s58 offen  lds
  s_add_u32 m0, s60, 9216
  s_xor_b32 s58, s75, 2686976
  buffer_load_dwordx4 v21, s[48:51], s58 offen  lds
  s_add_u32 m0, s60, 10240
  s_xor_b32 s58, s75, 2752512
  buffer_load_dwordx4 v20, s[48:51], s58 offen  lds
  s_add_u32 m0, s60, 11264
  s_xor_b32 s58, s75, 2818048
  buffer_load_dwordx4 v21, s[48:51], s58 offen  lds
  s_branch L_f_w_13e
L_f_w_13:
  s_add_u32 m0, s60, 8192
  s_xor_b32 s58, s75, 2621440
  buffer_load_dwordx4 v20, s[48:51], s58 offen nt lds
  s_add_u32 m0, s60, 9216
  s_xor_b32 s58, s75, 2686976
  buffer_load_dwordx4 v21, s[48:51], s58 offen nt lds
  s_add_u32 m0, s60, 10240
  s_xor_b32 s58, s75, 2752512
  buffer_load_dwordx4 v20, s[48:51], s58 offen nt lds
  s_add_u32 m0, s60, 11264
  s_xor_b32 s58, s75, 2818048
  buffer_load_dwordx4 v21, s[48:51], s58 offen nt lds
L_f_w_13e:
  s_waitcnt vmcnt(12)
  ds_read_b64_tr_b16 a[28:29], v24 offset:12288
  ds_read_b64_tr_b16 a[30:31], v24 offset:12800
  ds_read_b64_tr_b16 a[92:93], v25 offset:12288
  ds_read_b64_tr_b16 a[94:95], v25 offset:12800
  ds_read_b64_tr_b16 a[156:157], v26 offset:12288
  ds_read_b64_tr_b16 a[158:159], v26 offset:12800
  ds_read_b64_tr_b16 a[220:221], v27 offset:12288
  ds_read_b64_tr_b16 a[222:223], v27 offset:12800
  s_waitcnt lgkmcnt(0)
  s_cmp_lt_u32 s72, 3
  s_cbranch_scc1 L_f_w_14
  s_add_u32 m0, s60, 12288
  s_xor_b32 s58, s75, 2883584
  buffer_load_dwordx4 v20, s[48:51], s58 offen  lds
  s_add_u32 m0, s60, 13312
  s_xor_b32 s58, s75, 2949120
  buffer_load_dwordx4 v21, s[48:51], s58 offen  lds
  s_add_u32 m0, s60, 14336
  s_xor_b32 s58, s75, 3014656
  buffer_load_dwordx4 v20, s[48:51], s58 offen  lds
  s_add_u32 m0, s60, 15360
  s_xor_b32 s58, s75, 3080192
  buffer_load_dwordx4 v21, s[48:51], s58 offen  lds
  s_branch L_f_w_14e
L_f_w_14:
  s_add_u32 m0, s60, 12288
  s_xor_b32 s58, s75, 2883584
  buffer_load_dwordx4 v20, s[48:51], s58 offen nt lds
  s_add_u32 m0, s60, 13312
  s_xor_b32 s58, s75, 2949120
  buffer_load_dwordx4 v21, s[48:51], s58 offen nt lds
  s_add_u32 m0, s60, 14336
  s_xor_b32 s58, s75, 3014656
  buffer_load_dwordx4 v20, s[48:51], s58 offen nt lds
  s_add_u32 m0, s60, 15360
  s_xor_b32 s58, s75, 3080192
  buffer_load_dwordx4 v21, s[48:51], s58 offen nt lds
L_f_w_14e:
  s_waitcnt vmcnt(12)
  ds_read_b64_tr_b16 a[32:33], v24 offset:0
  ds_read_b64_tr_b16 a[34:35], v24 offset:512
  ds_read_b64_tr_b16 a[96:97], v25 offset:0
  ds_read_b64_tr_b16 a[98:99], v25 offset:512
  ds_read_b64_tr_b16 a[160:161], v26 offset:0
  ds_read_b64_tr_b16 a[162:163], v26 offset:512
  ds_read_b64_tr_b16 a[224:225], v27 offset:0
  ds_read_b64_tr_b16 a[226:227], v27 offset:512
  s_waitcnt lgkmcnt(0)
  s_cmp_lt_u32 s72, 3
  s_cbranch_scc1 L_f_w_15
  s_add_u32 m0, s60, 0
  s_xor_b32 s58, s75, 3145728
  buffer_load_dwordx4 v20, s[48:51], s58 offen  lds
  s_add_u32 m0, s60, 1024
  s_xor_b32 s58, s75, 3211264
  buffer_load_dwordx4 v21, s[48:51], s58 offen  lds
  s_add_u32 m0, s60, 2048
  s_xor_b32 s58, s75, 3276800
  buffer_load_dwordx4 v20, s[48:51], s58 offen  lds
  s_add_u32 m0, s60, 3072
  s_xor_b32 s58, s75, 3342336
  buffer_load_dwordx4 v21, s[48:51], s58 offen  lds
  s_branch L_f_w_15e
L_f_w_15:
  s_add_u32 m0, s60, 0
  s_xor_b32 s58, s75, 3145728
  buffer_load_dwordx4 v20, s[48:51], s58 offen nt lds
  s_add_u32 m0, s60, 1024
  s_xor_b32 s58, s75, 3211264
  buffer_load_dwordx4 v21, s[48:51], s58 offen nt lds
  s_add_u32 m0, s60, 2048
  s_xor_b32 s58, s75, 3276800
  buffer_load_dwordx4 v20, s[48:51], s58 offen nt lds
  s_add_u32 m0, s60, 3072
  s_xor_b32 s58, s75, 3342336
  buffer_load_dwordx4 v21, s[48:51], s58 offen nt lds
L_f_w_15e:
  s_waitcnt vmcnt(12)
  ds_read_b64_tr_b16 a[36:37], v24 offset:4096
  ds_read_b64_tr_b16 a[38:39], v24 offset:4608
  ds_read_b64_tr_b16 a[100:101], v25 offset:4096
  ds_read_b64_tr_b16 a[102:103], v25 offset:4608
  ds_read_b64_tr_b16 a[164:165], v26 offset:4096
  ds_read_b64_tr_b16 a[166:167], v26 offset:4608
  ds_read_b64_tr_b16 a[228:229], v27 offset:4096
  ds_read_b64_tr_b16 a[230:231], v27 offset:4608
  s_waitcnt lgkmcnt(0)
  s_cmp_lt_u32 s72, 3
  s_cbranch_scc1 L_f_w_16
  s_add_u32 m0, s60, 4096
  s_xor_b32 s58, s75, 3407872
  buffer_load_dwordx4 v20, s[48:51], s58 offen  lds
  s_add_u32 m0, s60, 5120
  s_xor_b32 s58, s75, 3473408
  buffer_load_dwordx4 v21, s[48:51], s58 offen  lds
  s_add_u32 m0, s60, 6144
  s_xor_b32 s58, s75, 3538944
  buffer_load_dwordx4 v20, s[48:51], s58 offen  lds
  s_add_u32 m0, s60, 7168
  s_xor_b32 s58, s75, 3604480
  buffer_load_dwordx4 v21, s[48:51], s58 offen  lds
  s_branch L_f_w_16e
L_f_w_16:
  s_add_u32 m0, s60, 4096
  s_xor_b32 s58, s75, 3407872
  buffer_load_dwordx4 v20, s[48:51], s58 offen nt lds
  s_add_u32 m0, s60, 5120
  s_xor_b32 s58, s75, 3473408
  buffer_load_dwordx4 v21, s[48:51], s58 offen nt lds
  s_add_u32 m0, s60, 6144
  s_xor_b32 s58, s75, 3538944
  buffer_load_dwordx4 v20, s[48:51], s58 offen nt lds
  s_add_u32 m0, s60, 7168
  s_xor_b32 s58, s75, 3604480
  buffer_load_dwordx4 v21, s[48:51], s58 offen nt lds
L_f_w_16e:
  s_waitcnt vmcnt(12)
  ds_read_b64_tr_b16 a[40:41], v24 offset:8192
  ds_read_b64_tr_b16 a[42:43], v24 offset:8704
  ds_read_b64_tr_b16 a[104:105], v25 offset:8192
  ds_read_b64_tr_b16 a[106:107], v25 offset:8704
  ds_read_b64_tr_b16 a[168:169], v26 offset:8192
  ds_read_b64_tr_b16 a[170:171], v26 offset:8704
  ds_read_b64_tr_b16 a[232:233], v27 offset:8192
  ds_read_b64_tr_b16 a[234:235], v27 offset:8704
  s_waitcnt lgkmcnt(0)
  s_cmp_lt_u32 s72, 3
  s_cbranch_scc1 L_f_w_17
  s_add_u32 m0, s60, 8192
  s_xor_b32 s58, s75, 3670016
  buffer_load_dwordx4 v20, s[48:51], s58 offen  lds
  s_add_u32 m0, s60, 9216
  s_xor_b32 s58, s75, 3735552
  buffer_load_dwordx4 v21, s[48:51], s58 offen  lds
  s_add_u32 m0, s60, 10240
  s_xor_b32 s58, s75, 3801088
  buffer_load_dwordx4 v20, s[48:51], s58 offen  lds
  s_add_u32 m0, s60, 11264
  s_xor_b32 s58, s75, 3866624
  buffer_load_dwordx4 v21, s[48:51], s58 offen  lds
  s_branch L_f_w_17e
L_f_w_17:
  s_add_u32 m0, s60, 8192
  s_xor_b32 s58, s75, 3670016
  buffer_load_dwordx4 v20, s[48:51], s58 offen nt lds
  s_add_u32 m0, s60, 9216
  s_xor_b32 s58, s75, 3735552
  buffer_load_dwordx4 v21, s[48:51], s58 offen nt lds
  s_add_u32 m0, s60, 10240
  s_xor_b32 s58, s75, 3801088
  buffer_load_dwordx4 v20, s[48:51], s58 offen nt lds
  s_add_u32 m0, s60, 11264
  s_xor_b32 s58, s75, 3866624
  buffer_load_dwordx4 v21, s[48:51], s58 offen nt lds
L_f_w_17e:
  s_waitcnt vmcnt(12)
  ds_read_b64_tr_b16 a[44:45], v24 offset:12288
  ds_read_b64_tr_b16 a[46:47], v24 offset:12800
  ds_read_b64_tr_b16 a[108:109], v25 offset:12288
  ds_read_b64_tr_b16 a[110:111], v25 offset:12800
  ds_read_b64_tr_b16 a[172:173], v26 offset:12288
  ds_read_b64_tr_b16 a[174:175], v26 offset:12800
  ds_read_b64_tr_b16 a[236:237], v27 offset:12288
  ds_read_b64_tr_b16 a[238:239], v27 offset:12800
  s_waitcnt lgkmcnt(0)
  s_cmp_lt_u32 s72, 3
  s_cbranch_scc1 L_f_w_18
  s_add_u32 m0, s60, 12288
  s_xor_b32 s58, s75, 3932160
  buffer_load_dwordx4 v20, s[48:51], s58 offen  lds
  s_add_u32 m0, s60, 13312
  s_xor_b32 s58, s75, 3997696
  buffer_load_dwordx4 v21, s[48:51], s58 offen  lds
  s_add_u32 m0, s60, 14336
  s_xor_b32 s58, s75, 4063232
  buffer_load_dwordx4 v20, s[48:51], s58 offen  lds
  s_add_u32 m0, s60, 15360
  s_xor_b32 s58, s75, 4128768
  buffer_load_dwordx4 v21, s[48:51], s58 offen  lds
  s_branch L_f_w_18e
L_f_w_18:
  s_add_u32 m0, s60, 12288
  s_xor_b32 s58, s75, 3932160
  buffer_load_dwordx4 v20, s[48:51], s58 offen nt lds
  s_add_u32 m0, s60, 13312
  s_xor_b32 s58, s75, 3997696
  buffer_load_dwordx4 v21, s[48:51], s58 offen nt lds
  s_add_u32 m0, s60, 14336
  s_xor_b32 s58, s75, 4063232
  buffer_load_dwordx4 v20, s[48:51], s58 offen nt lds
  s_add_u32 m0, s60, 15360
  s_xor_b32 s58, s75, 4128768
  buffer_load_dwordx4 v21, s[48:51], s58 offen nt lds
L_f_w_18e:
  s_waitcnt vmcnt(12)
  ds_read_b64_tr_b16 a[48:49], v24 offset:0
  ds_read_b64_tr_b16 a[50:51], v24 offset:512
  ds_read_b64_tr_b16 a[112:113], v25 offset:0
  ds_read_b64_tr_b16 a[114:115], v25 offset:512
  ds_read_b64_tr_b16 a[176:177], v26 offset:0
  ds_read_b64_tr_b16 a[178:179], v26 offset:512
  ds_read_b64_tr_b16 a[240:241], v27 offset:0
  ds_read_b64_tr_b16 a[242:243], v27 offset:512
  s_mov_b32 s48, s38
  s_and_b32 s49, s39, 0xffff
  s_mov_b32 s50, 0x100
  s_mov_b32 s51, 0x20000
  buffer_load_dword v3, v6, s[48:51], 0 offen sc1
  s_add_u32 m0, s66, 0
  s_add_u32 s58, s61, 0
  buffer_load_dwordx4 v8, s[52:55], s58 offen lds
  s_add_u32 m0, s66, 1024
  s_add_u32 s58, s61, 1024
  buffer_load_dwordx4 v9, s[52:55], s58 offen lds
  s_add_u32 m0, s66, 2048
  s_add_u32 s58, s61, 2048
  buffer_load_dwordx4 v10, s[52:55], s58 offen lds
  s_add_u32 m0, s66, 3072
  s_add_u32 s58, s61, 3072
  buffer_load_dwordx4 v11, s[52:55], s58 offen lds
  s_add_u32 m0, s66, 4096
  s_add_u32 s58, s61, 4096
  buffer_load_dwordx4 v12, s[52:55], s58 offen lds
  s_add_u32 m0, s66, 5120
  s_add_u32 s58, s61, 5120
  buffer_load_dwordx4 v13, s[52:55], s58 offen lds
  s_add_u32 m0, s66, 6144
  s_add_u32 s58, s61, 6144
  buffer_load_dwordx4 v14, s[52:55], s58 offen lds
  s_add_u32 m0, s66, 7168
  s_add_u32 s58, s61, 7168
  buffer_load_dwordx4 v15, s[52:55], s58 offen lds
  s_add_u32 s61, s61, 0x8000
  s_add_u32 s66, s66, 0x8000
  s_and_b32 s66, s66, 0x1ffff
  s_waitcnt vmcnt(17)
  ds_read_b64_tr_b16 a[52:53], v24 offset:4096
  ds_read_b64_tr_b16 a[54:55], v24 offset:4608
  ds_read_b64_tr_b16 a[116:117], v25 offset:4096
  ds_read_b64_tr_b16 a[118:119], v25 offset:4608
  ds_read_b64_tr_b16 a[180:181], v26 offset:4096
  ds_read_b64_tr_b16 a[182:183], v26 offset:4608
  ds_read_b64_tr_b16 a[244:245], v27 offset:4096
  ds_read_b64_tr_b16 a[246:247], v27 offset:4608
  s_add_u32 m0, s66, 0
  s_add_u32 s58, s61, 0
  buffer_load_dwordx4 v8, s[52:55], s58 offen lds
  s_add_u32 m0, s66, 1024
  s_add_u32 s58, s61, 1024
  buffer_load_dwordx4 v9, s[52:55], s58 offen lds
  s_add_u32 m0, s66, 2048
  s_add_u32 s58, s61, 2048
  buffer_load_dwordx4 v10, s[52:55], s58 offen lds
  s_add_u32 m0, s66, 3072
  s_add_u32 s58, s61, 3072
  buffer_load_dwordx4 v11, s[52:55], s58 offen lds
  s_add_u32 m0, s66, 4096
  s_add_u32 s58, s61, 4096
  buffer_load_dwordx4 v12, s[52:55], s58 offen lds
  s_add_u32 m0, s66, 5120
  s_add_u32 s58, s61, 5120
  buffer_load_dwordx4 v13, s[52:55], s58 offen lds
  s_add_u32 m0, s66, 6144
  s_add_u32 s58, s61, 6144
  buffer_load_dwordx4 v14, s[52:55], s58 offen lds
  s_add_u32 m0, s66, 7168
  s_add_u32 s58, s61, 7168
  buffer_load_dwordx4 v15, s[52:55], s58 offen lds
  s_add_u32 s61, s61, 0x8000
  s_add_u32 s66, s66, 0x8000
  s_and_b32 s66, s66, 0x1ffff
  s_waitcnt vmcnt(21)
  ds_read_b64_tr_b16 a[56:57], v24 offset:8192
  ds_read_b64_tr_b16 a[58:59], v24 offset:8704
  ds_read_b64_tr_b16 a[120:121], v25 offset:8192
  ds_read_b64_tr_b16 a[122:123], v25 offset:8704
  ds_read_b64_tr_b16 a[184:185], v26 offset:8192
  ds_read_b64_tr_b16 a[186:187], v26 offset:8704
  ds_read_b64_tr_b16 a[248:249], v27 offset:8192
  ds_read_b64_tr_b16 a[250:251], v27 offset:8704
  s_add_u32 m0, s66, 0
  s_add_u32 s58, s61, 0
  buffer_load_dwordx4 v8, s[52:55], s58 offen lds
  s_add_u32 m0, s66, 1024
  s_add_u32 s58, s61, 1024
  buffer_load_dwordx4 v9, s[52:55], s58 offen lds
  s_add_u32 m0, s66, 2048
  s_add_u32 s58, s61, 2048
  buffer_load_dwordx4 v10, s[52:55], s58 offen lds
  s_add_u32 m0, s66, 3072
  s_add_u32 s58, s61, 3072
  buffer_load_dwordx4 v11, s[52:55], s58 offen lds
  s_add_u32 m0, s66, 4096
  s_add_u32 s58, s61, 4096
  buffer_load_dwordx4 v12, s[52:55], s58 offen lds
  s_add_u32 m0, s66, 5120
  s_add_u32 s58, s61, 5120
  buffer_load_dwordx4 v13, s[52:55], s58 offen lds
  s_add_u32 m0, s66, 6144
  s_add_u32 s58, s61, 6144
  buffer_load_dwordx4 v14, s[52:55], s58 offen lds
  s_add_u32 m0, s66, 7168
  s_add_u32 s58, s61, 7168
  buffer_load_dwordx4 v15, s[52:55], s58 offen lds
  s_add_u32 s61, s61, 0x8000
  s_add_u32 s66, s66, 0x8000
  s_and_b32 s66, s66, 0x1ffff
  s_waitcnt vmcnt(25)
  ds_read_b64_tr_b16 a[60:61], v24 offset:12288
  ds_read_b64_tr_b16 a[62:63], v24 offset:12800
  ds_read_b64_tr_b16 a[124:125], v25 offset:12288
  ds_read_b64_tr_b16 a[126:127], v25 offset:12800
  ds_read_b64_tr_b16 a[188:189], v26 offset:12288
  ds_read_b64_tr_b16 a[190:191], v26 offset:12800
  ds_read_b64_tr_b16 a[252:253], v27 offset:12288
  ds_read_b64_tr_b16 a[254:255], v27 offset:12800
  s_cmp_eq_u32 s76, 0x40000000
  s_cbranch_scc1 L_f_nogate2
  v_mfma_f32_16x16x32_bf16 v[192:195], v[128:131], v[64:67], 0
  v_mfma_f32_16x16x32_bf16 v[192:195], v[132:135], v[68:71], v[192:195]
  v_mfma_f32_16x16x32_bf16 v[192:195], v[136:139], v[72:75], v[192:195]
  v_mfma_f32_16x16x32_bf16 v[192:195], v[140:143], v[76:79], v[192:195]
  v_mfma_f32_16x16x32_bf16 v[192:195], v[144:147], v[80:83], v[192:195]
  v_mfma_f32_16x16x32_bf16 v[192:195], v[148:151], v[84:87], v[192:195]
  v_mfma_f32_16x16x32_bf16 v[192:195], v[152:155], v[88:91], v[192:195]
  v_mfma_f32_16x16x32_bf16 v[192:195], v[156:159], v[92:95], v[192:195]
  v_mfma_f32_16x16x32_bf16 v[192:195], v[160:163], v[96:99], v[192:195]
  v_mfma_f32_16x16x32_bf16 v[192:195], v[164:167], v[100:103], v[192:195]
  v_mfma_f32_16x16x32_bf16 v[192:195], v[168:171], v[104:107], v[192:195]
  v_mfma_f32_16x16x32_bf16 v[192:195], v[172:175], v[108:111], v[192:195]
  v_mfma_f32_16x16x32_bf16 v[192:195], v[176:179], v[112:115], v[192:195]
  v_mfma_f32_16x16x32_bf16 v[192:195], v[180:183], v[116:119], v[192:195]
  v_mfma_f32_16x16x32_bf16 v[192:195], v[184:187], v[120:123], v[192:195]
  v_mfma_f32_16x16x32_bf16 v[192:195], v[188:191], v[124:127], v[192:195]
  s_nop 7
  v_mul_f32 v192, 0xbfb8aa3b, v192
  v_exp_f32 v192, v192
  s_nop 0
  v_add_f32 v192, 1.0, v192
  v_rcp_f32 v192, v192
  s_nop 0
  buffer_store_dword v192, v32, s[40:43], s77 offen sc1
L_f_nogate2:
  s_waitcnt vmcnt(16) lgkmcnt(0)
L_f_init:
  v_cmp_gt_u32 vcc, 32, v3
  s_cbranch_vccz L_f_go
  buffer_load_dword v3, v6, s[48:51], 0 offen sc1
  s_add_u32 s68, s68, 1
  s_cmp_gt_u32 s68, 1048576
  s_cbranch_scc1 L_exit
  s_waitcnt vmcnt(0)
  s_branch L_f_init
L_f_go:
  s_barrier
  ds_read_b128 v[64:67], v16 offset:0
  ds_read_b128 v[68:71], v16 offset:16384
  ds_read_b128 v[72:75], v17 offset:0
  ds_read_b128 v[76:79], v17 offset:16384
  ds_read_b128 v[80:83], v18 offset:0
  ds_read_b128 v[84:87], v18 offset:16384
  ds_read_b128 v[88:91], v19 offset:0
  ds_read_b128 v[92:95], v19 offset:16384
  s_cmp_lt_u32 s44, s74
  s_waitcnt lgkmcnt(0)
  s_cbranch_scc0 L_f_10
L_f_00:
  v_mfma_f32_16x16x32_bf16 v[128:131], a[0:3], v[64:67], 0
  v_mfma_f32_16x16x32_bf16 v[128:131], a[4:7], v[72:75], v[128:131]
  v_mfma_f32_16x16x32_bf16 v[128:131], a[8:11], v[80:83], v[128:131]
  ds_read_b128 v[96:99], v16 offset:256
  v_mfma_f32_16x16x32_bf16 v[128:131], a[12:15], v[88:91], v[128:131]
  v_mfma_f32_16x16x32_bf16 v[136:139], a[0:3], v[68:71], 0
  ds_read_b128 v[100:103], v16 offset:16640
  v_mfma_f32_16x16x32_bf16 v[136:139], a[4:7], v[76:79], v[136:139]
  v_mfma_f32_16x16x32_bf16 v[136:139], a[8:11], v[84:87], v[136:139]
  ds_read_b128 v[104:107], v17 offset:256
  v_mfma_f32_16x16x32_bf16 v[136:139], a[12:15], v[92:95], v[136:139]
  v_mfma_f32_16x16x32_bf16 v[132:135], a[64:67], v[64:67], 0
  ds_read_b128 v[108:111], v17 offset:16640
  v_mfma_f32_16x16x32_bf16 v[132:135], a[68:71], v[72:75], v[132:135]
  v_mul_f32 v160, s69, v160
  v_mul_f32 v161, s69, v161
  v_mfma_f32_16x16x32_bf16 v[132:135], a[72:75], v[80:83], v[132:135]
  ds_read_b128 v[112:115], v18 offset:256
  v_mul_f32 v162, s69, v162
  v_mfma_f32_16x16x32_bf16 v[132:135], a[76:79], v[88:91], v[132:135]
  v_mul_f32 v163, s69, v163
  v_mul_f32 v164, s69, v164
  v_mfma_f32_16x16x32_bf16 v[140:143], a[64:67], v[68:71], 0
  ds_read_b128 v[116:119], v18 offset:16640
  v_mul_f32 v165, s69, v165
  v_mfma_f32_16x16x32_bf16 v[140:143], a[68:71], v[76:79], v[140:143]
  v_mul_f32 v166, s69, v166
  v_mul_f32 v167, s69, v167
  v_mfma_f32_16x16x32_bf16 v[140:143], a[72:75], v[84:87], v[140:143]
  ds_read_b128 v[120:123], v19 offset:256
  v_cvt_pk_bf16_f32 v192, v160, v161
  v_mfma_f32_16x16x32_bf16 v[140:143], a[76:79], v[92:95], v[140:143]
  v_cvt_pk_bf16_f32 v193, v162, v163
  v_cvt_pk_bf16_f32 v194, v164, v165
  v_mfma_f32_16x16x32_bf16 v[144:147], a[128:131], v[64:67], 0
  ds_read_b128 v[124:127], v19 offset:16640
  v_cvt_pk_bf16_f32 v195, v166, v167
  v_mfma_f32_16x16x32_bf16 v[144:147], a[132:135], v[72:75], v[144:147]
  buffer_store_dwordx4 v[192:195], v2, s[40:43], s62 offen offset:0 sc1
  v_mfma_f32_16x16x32_bf16 v[144:147], a[136:139], v[80:83], v[144:147]
  v_mul_f32 v168, s69, v168
  v_mul_f32 v169, s69, v169
  v_mfma_f32_16x16x32_bf16 v[144:147], a[140:143], v[88:91], v[144:147]
  v_mul_f32 v170, s69, v170
  v_mul_f32 v171, s69, v171
  v_mfma_f32_16x16x32_bf16 v[152:155], a[128:131], v[68:71], 0
  v_mul_f32 v172, s69, v172
  v_mul_f32 v173, s69, v173
  v_mfma_f32_16x16x32_bf16 v[152:155], a[132:135], v[76:79], v[152:155]
  v_mul_f32 v174, s69, v174
  v_mul_f32 v175, s69, v175
  v_mfma_f32_16x16x32_bf16 v[152:155], a[136:139], v[84:87], v[152:155]
  v_cvt_pk_bf16_f32 v196, v168, v169
  v_cvt_pk_bf16_f32 v197, v170, v171
  v_mfma_f32_16x16x32_bf16 v[152:155], a[140:143], v[92:95], v[152:155]
  v_cvt_pk_bf16_f32 v198, v172, v173
  v_cvt_pk_bf16_f32 v199, v174, v175
  v_mfma_f32_16x16x32_bf16 v[148:151], a[192:195], v[64:67], 0
  buffer_store_dwordx4 v[196:199], v2, s[40:43], s62 offen offset:1024 sc1
  v_mfma_f32_16x16x32_bf16 v[148:151], a[196:199], v[72:75], v[148:151]
  v_mul_f32 v176, s69, v176
  v_mul_f32 v177, s69, v177
  v_mfma_f32_16x16x32_bf16 v[148:151], a[200:203], v[80:83], v[148:151]
  v_mul_f32 v178, s69, v178
  v_mul_f32 v179, s69, v179
  v_mfma_f32_16x16x32_bf16 v[148:151], a[204:207], v[88:91], v[148:151]
  v_mul_f32 v180, s69, v180
  v_mul_f32 v181, s69, v181
  v_mfma_f32_16x16x32_bf16 v[156:159], a[192:195], v[68:71], 0
  v_mul_f32 v182, s69, v182
  v_mul_f32 v183, s69, v183
  v_mfma_f32_16x16x32_bf16 v[156:159], a[196:199], v[76:79], v[156:159]
  v_cvt_pk_bf16_f32 v200, v176, v177
  v_cvt_pk_bf16_f32 v201, v178, v179
  v_mfma_f32_16x16x32_bf16 v[156:159], a[200:203], v[84:87], v[156:159]
  v_cvt_pk_bf16_f32 v202, v180, v181
  v_cvt_pk_bf16_f32 v203, v182, v183
  v_mfma_f32_16x16x32_bf16 v[156:159], a[204:207], v[92:95], v[156:159]
  s_waitcnt lgkmcnt(0)
  buffer_store_dwordx4 v[200:203], v2, s[40:43], s62 offen offset:2048 sc1
  v_mfma_f32_16x16x32_bf16 v[128:131], a[16:19], v[96:99], v[128:131]
  v_mul_f32 v184, s69, v184
  v_mul_f32 v185, s69, v185
  v_mfma_f32_16x16x32_bf16 v[128:131], a[20:23], v[104:107], v[128:131]
  v_mul_f32 v186, s69, v186
  v_mul_f32 v187, s69, v187
  v_mfma_f32_16x16x32_bf16 v[128:131], a[24:27], v[112:115], v[128:131]
  ds_read_b128 v[64:67], v16 offset:512
  v_mul_f32 v188, s69, v188
  v_mfma_f32_16x16x32_bf16 v[128:131], a[28:31], v[120:123], v[128:131]
  v_mul_f32 v189, s69, v189
  v_mul_f32 v190, s69, v190
  v_mfma_f32_16x16x32_bf16 v[136:139], a[16:19], v[100:103], v[136:139]
  ds_read_b128 v[68:71], v16 offset:16896
  v_mul_f32 v191, s69, v191
  v_mfma_f32_16x16x32_bf16 v[136:139], a[20:23], v[108:111], v[136:139]
  v_cvt_pk_bf16_f32 v204, v184, v185
  v_cvt_pk_bf16_f32 v205, v186, v187
  v_mfma_f32_16x16x32_bf16 v[136:139], a[24:27], v[116:119], v[136:139]
  ds_read_b128 v[72:75], v17 offset:512
  v_cvt_pk_bf16_f32 v206, v188, v189
  v_mfma_f32_16x16x32_bf16 v[136:139], a[28:31], v[124:127], v[136:139]
  v_cvt_pk_bf16_f32 v207, v190, v191
  v_mfma_f32_16x16x32_bf16 v[132:135], a[80:83], v[96:99], v[132:135]
  ds_read_b128 v[76:79], v17 offset:16896
  v_mfma_f32_16x16x32_bf16 v[132:135], a[84:87], v[104:107], v[132:135]
  buffer_store_dwordx4 v[204:207], v2, s[40:43], s62 offen offset:3072 sc1
  v_mfma_f32_16x16x32_bf16 v[132:135], a[88:91], v[112:115], v[132:135]
  ds_read_b128 v[80:83], v18 offset:512
  v_mfma_f32_16x16x32_bf16 v[132:135], a[92:95], v[120:123], v[132:135]
  v_mfma_f32_16x16x32_bf16 v[140:143], a[80:83], v[100:103], v[140:143]
  ds_read_b128 v[84:87], v18 offset:16896
  v_mfma_f32_16x16x32_bf16 v[140:143], a[84:87], v[108:111], v[140:143]
  v_mfma_f32_16x16x32_bf16 v[140:143], a[88:91], v[116:119], v[140:143]
  ds_read_b128 v[88:91], v19 offset:512
  v_mfma_f32_16x16x32_bf16 v[140:143], a[92:95], v[124:127], v[140:143]
  v_mfma_f32_16x16x32_bf16 v[144:147], a[144:147], v[96:99], v[144:147]
  ds_read_b128 v[92:95], v19 offset:16896
  v_mfma_f32_16x16x32_bf16 v[144:147], a[148:151], v[104:107], v[144:147]
  v_mfma_f32_16x16x32_bf16 v[144:147], a[152:155], v[112:115], v[144:147]
  s_add_u32 s62, s62, s65
  s_cmp_eq_u32 s63, 15
  s_cselect_b32 s65, s71, 0x2000
  v_mfma_f32_16x16x32_bf16 v[144:147], a[156:159], v[120:123], v[144:147]
  s_add_u32 m0, s66, 0
  s_add_u32 s58, s61, 0
  v_mfma_f32_16x16x32_bf16 v[152:155], a[144:147], v[100:103], v[152:155]
  v_mfma_f32_16x16x32_bf16 v[152:155], a[148:151], v[108:111], v[152:155]
  buffer_load_dwordx4 v8, s[52:55], s58 offen lds
  v_mfma_f32_16x16x32_bf16 v[152:155], a[152:155], v[116:119], v[152:155]
  v_mfma_f32_16x16x32_bf16 v[152:155], a[156:159], v[124:127], v[152:155]
  s_add_u32 m0, s66, 1024
  s_add_u32 s58, s61, 1024
  v_mfma_f32_16x16x32_bf16 v[148:151], a[208:211], v[96:99], v[148:151]
  v_mfma_f32_16x16x32_bf16 v[148:151], a[212:215], v[104:107], v[148:151]
  buffer_load_dwordx4 v9, s[52:55], s58 offen lds
  v_mfma_f32_16x16x32_bf16 v[148:151], a[216:219], v[112:115], v[148:151]
  v_mfma_f32_16x16x32_bf16 v[148:151], a[220:223], v[120:123], v[148:151]
  s_add_u32 m0, s66, 2048
  s_add_u32 s58, s61, 2048
  v_mfma_f32_16x16x32_bf16 v[156:159], a[208:211], v[100:103], v[156:159]
  v_mfma_f32_16x16x32_bf16 v[156:159], a[212:215], v[108:111], v[156:159]
  buffer_load_dwordx4 v10, s[52:55], s58 offen lds
  v_mfma_f32_16x16x32_bf16 v[156:159], a[216:219], v[116:119], v[156:159]
  v_mfma_f32_16x16x32_bf16 v[156:159], a[220:223], v[124:127], v[156:159]
  s_waitcnt lgkmcnt(0)
  s_add_u32 m0, s66, 3072
  s_add_u32 s58, s61, 3072
  v_mfma_f32_16x16x32_bf16 v[128:131], a[32:35], v[64:67], v[128:131]
  v_mfma_f32_16x16x32_bf16 v[128:131], a[36:39], v[72:75], v[128:131]
  buffer_load_dwordx4 v11, s[52:55], s58 offen lds
  v_mfma_f32_16x16x32_bf16 v[128:131], a[40:43], v[80:83], v[128:131]
  ds_read_b128 v[96:99], v16 offset:768
  v_mfma_f32_16x16x32_bf16 v[128:131], a[44:47], v[88:91], v[128:131]
  s_add_u32 m0, s66, 4096
  s_add_u32 s58, s61, 4096
  v_mfma_f32_16x16x32_bf16 v[136:139], a[32:35], v[68:71], v[136:139]
  ds_read_b128 v[100:103], v16 offset:17152
  v_mfma_f32_16x16x32_bf16 v[136:139], a[36:39], v[76:79], v[136:139]
  buffer_load_dwordx4 v12, s[52:55], s58 offen lds
  v_mfma_f32_16x16x32_bf16 v[136:139], a[40:43], v[84:87], v[136:139]
  ds_read_b128 v[104:107], v17 offset:768
  v_mfma_f32_16x16x32_bf16 v[136:139], a[44:47], v[92:95], v[136:139]
  s_add_u32 m0, s66, 5120
  s_add_u32 s58, s61, 5120
  v_mfma_f32_16x16x32_bf16 v[132:135], a[96:99], v[64:67], v[132:135]
  ds_read_b128 v[108:111], v17 offset:17152
  v_mfma_f32_16x16x32_bf16 v[132:135], a[100:103], v[72:75], v[132:135]
  buffer_load_dwordx4 v13, s[52:55], s58 offen lds
  v_mfma_f32_16x16x32_bf16 v[132:135], a[104:107], v[80:83], v[132:135]
  ds_read_b128 v[112:115], v18 offset:768
  v_mfma_f32_16x16x32_bf16 v[132:135], a[108:111], v[88:91], v[132:135]
  s_add_u32 m0, s66, 6144
  s_add_u32 s58, s61, 6144
  v_mfma_f32_16x16x32_bf16 v[140:143], a[96:99], v[68:71], v[140:143]
  ds_read_b128 v[116:119], v18 offset:17152
  v_mfma_f32_16x16x32_bf16 v[140:143], a[100:103], v[76:79], v[140:143]
  buffer_load_dwordx4 v14, s[52:55], s58 offen lds
  v_mfma_f32_16x16x32_bf16 v[140:143], a[104:107], v[84:87], v[140:143]
  ds_read_b128 v[120:123], v19 offset:768
  v_mfma_f32_16x16x32_bf16 v[140:143], a[108:111], v[92:95], v[140:143]
  s_add_u32 m0, s66, 7168
  s_add_u32 s58, s61, 7168
  v_mfma_f32_16x16x32_bf16 v[144:147], a[160:163], v[64:67], v[144:147]
  ds_read_b128 v[124:127], v19 offset:17152
  v_mfma_f32_16x16x32_bf16 v[144:147], a[164:167], v[72:75], v[144:147]
  buffer_load_dwordx4 v15, s[52:55], s58 offen lds
  v_mfma_f32_16x16x32_bf16 v[144:147], a[168:171], v[80:83], v[144:147]
  v_mfma_f32_16x16x32_bf16 v[144:147], a[172:175], v[88:91], v[144:147]
  s_cmp_eq_u32 s63, 12
  s_cselect_b32 s59, s70, 0
  s_add_u32 s61, s61, s59
  v_mfma_f32_16x16x32_bf16 v[152:155], a[160:163], v[68:71], v[152:155]
  v_add_u32 v16, 0x8000, v16
  v_mfma_f32_16x16x32_bf16 v[152:155], a[164:167], v[76:79], v[152:155]
  s_add_u32 s61, s61, 0x8000
  v_and_b32 v16, 0x1ffff, v16
  v_mfma_f32_16x16x32_bf16 v[152:155], a[168:171], v[84:87], v[152:155]
  s_add_u32 s66, s66, 0x8000
  v_add_u32 v17, 0x8000, v17
  v_mfma_f32_16x16x32_bf16 v[152:155], a[172:175], v[92:95], v[152:155]
  s_and_b32 s66, s66, 0x1ffff
  v_and_b32 v17, 0x1ffff, v17
  v_mfma_f32_16x16x32_bf16 v[148:151], a[224:227], v[64:67], v[148:151]
  v_add_u32 v18, 0x8000, v18
  v_mfma_f32_16x16x32_bf16 v[148:151], a[228:231], v[72:75], v[148:151]
  v_and_b32 v18, 0x1ffff, v18
  v_mfma_f32_16x16x32_bf16 v[148:151], a[232:235], v[80:83], v[148:151]
  v_add_u32 v19, 0x8000, v19
  v_mfma_f32_16x16x32_bf16 v[148:151], a[236:239], v[88:91], v[148:151]
  v_and_b32 v19, 0x1ffff, v19
  v_mfma_f32_16x16x32_bf16 v[156:159], a[224:227], v[68:71], v[156:159]
  s_sub_u32 s59, s63, 1
  s_max_i32 s59, s59, 0
  v_mfma_f32_16x16x32_bf16 v[156:159], a[228:231], v[76:79], v[156:159]
  v_mov_b32 v7, s59
  v_mfma_f32_16x16x32_bf16 v[156:159], a[232:235], v[84:87], v[156:159]
  v_mfma_f32_16x16x32_bf16 v[156:159], a[236:239], v[92:95], v[156:159]
  s_waitcnt lgkmcnt(0)
  v_mfma_f32_16x16x32_bf16 v[128:131], a[48:51], v[96:99], v[128:131]
  s_waitcnt vmcnt(20)
  v_mfma_f32_16x16x32_bf16 v[128:131], a[52:55], v[104:107], v[128:131]
  s_barrier
  v_mfma_f32_16x16x32_bf16 v[128:131], a[56:59], v[112:115], v[128:131]
  ds_read_b128 v[64:67], v16 offset:0
  v_mfma_f32_16x16x32_bf16 v[128:131], a[60:63], v[120:123], v[128:131]
  buffer_store_dword v7, v6, s[40:43], s64 offen sc1
  v_mfma_f32_16x16x32_bf16 v[136:139], a[48:51], v[100:103], v[136:139]
  ds_read_b128 v[68:71], v16 offset:16384
  v_mfma_f32_16x16x32_bf16 v[136:139], a[52:55], v[108:111], v[136:139]
  v_mfma_f32_16x16x32_bf16 v[136:139], a[56:59], v[116:119], v[136:139]
  ds_read_b128 v[72:75], v17 offset:0
  v_mfma_f32_16x16x32_bf16 v[136:139], a[60:63], v[124:127], v[136:139]
  v_mfma_f32_16x16x32_bf16 v[132:135], a[112:115], v[96:99], v[132:135]
  ds_read_b128 v[76:79], v17 offset:16384
  v_mfma_f32_16x16x32_bf16 v[132:135], a[116:119], v[104:107], v[132:135]
  v_mfma_f32_16x16x32_bf16 v[132:135], a[120:123], v[112:115], v[132:135]
  ds_read_b128 v[80:83], v18 offset:0
  v_mfma_f32_16x16x32_bf16 v[132:135], a[124:127], v[120:123], v[132:135]
  v_mfma_f32_16x16x32_bf16 v[140:143], a[112:115], v[100:103], v[140:143]
  ds_read_b128 v[84:87], v18 offset:16384
  v_mfma_f32_16x16x32_bf16 v[140:143], a[116:119], v[108:111], v[140:143]
  v_mfma_f32_16x16x32_bf16 v[140:143], a[120:123], v[116:119], v[140:143]
  ds_read_b128 v[88:91], v19 offset:0
  v_mfma_f32_16x16x32_bf16 v[140:143], a[124:127], v[124:127], v[140:143]
  v_mfma_f32_16x16x32_bf16 v[144:147], a[176:179], v[96:99], v[144:147]
  ds_read_b128 v[92:95], v19 offset:16384
  v_mfma_f32_16x16x32_bf16 v[144:147], a[180:183], v[104:107], v[144:147]
  v_mfma_f32_16x16x32_bf16 v[144:147], a[184:187], v[112:115], v[144:147]
  v_mfma_f32_16x16x32_bf16 v[144:147], a[188:191], v[120:123], v[144:147]
  v_mfma_f32_16x16x32_bf16 v[152:155], a[176:179], v[100:103], v[152:155]
  v_mfma_f32_16x16x32_bf16 v[152:155], a[180:183], v[108:111], v[152:155]
  v_mfma_f32_16x16x32_bf16 v[152:155], a[184:187], v[116:119], v[152:155]
  v_mfma_f32_16x16x32_bf16 v[152:155], a[188:191], v[124:127], v[152:155]
  v_mfma_f32_16x16x32_bf16 v[148:151], a[240:243], v[96:99], v[148:151]
  s_add_u32 s63, s63, 1
  v_mfma_f32_16x16x32_bf16 v[148:151], a[244:247], v[104:107], v[148:151]
  v_mfma_f32_16x16x32_bf16 v[148:151], a[248:251], v[112:115], v[148:151]
  v_mfma_f32_16x16x32_bf16 v[148:151], a[252:255], v[120:123], v[148:151]
  v_mfma_f32_16x16x32_bf16 v[156:159], a[240:243], v[100:103], v[156:159]
  v_mfma_f32_16x16x32_bf16 v[156:159], a[244:247], v[108:111], v[156:159]
  v_mfma_f32_16x16x32_bf16 v[156:159], a[248:251], v[116:119], v[156:159]
  s_cmp_lt_u32 s63, s67
  v_mfma_f32_16x16x32_bf16 v[156:159], a[252:255], v[124:127], v[156:159]
  s_waitcnt lgkmcnt(0)
L_f_01:
  v_mfma_f32_16x16x32_bf16 v[160:163], a[0:3], v[64:67], 0
  v_mfma_f32_16x16x32_bf16 v[160:163], a[4:7], v[72:75], v[160:163]
  v_mfma_f32_16x16x32_bf16 v[160:163], a[8:11], v[80:83], v[160:163]
  ds_read_b128 v[96:99], v16 offset:256
  v_mfma_f32_16x16x32_bf16 v[160:163], a[12:15], v[88:91], v[160:163]
  v_mfma_f32_16x16x32_bf16 v[168:171], a[0:3], v[68:71], 0
  ds_read_b128 v[100:103], v16 offset:16640
  v_mfma_f32_16x16x32_bf16 v[168:171], a[4:7], v[76:79], v[168:171]
  v_mfma_f32_16x16x32_bf16 v[168:171], a[8:11], v[84:87], v[168:171]
  ds_read_b128 v[104:107], v17 offset:256
  v_mfma_f32_16x16x32_bf16 v[168:171], a[12:15], v[92:95], v[168:171]
  v_mfma_f32_16x16x32_bf16 v[164:167], a[64:67], v[64:67], 0
  ds_read_b128 v[108:111], v17 offset:16640
  v_mfma_f32_16x16x32_bf16 v[164:167], a[68:71], v[72:75], v[164:167]
  v_mul_f32 v128, s69, v128
  v_mul_f32 v129, s69, v129
  v_mfma_f32_16x16x32_bf16 v[164:167], a[72:75], v[80:83], v[164:167]
  ds_read_b128 v[112:115], v18 offset:256
  v_mul_f32 v130, s69, v130
  v_mfma_f32_16x16x32_bf16 v[164:167], a[76:79], v[88:91], v[164:167]
  v_mul_f32 v131, s69, v131
  v_mul_f32 v132, s69, v132
  v_mfma_f32_16x16x32_bf16 v[172:175], a[64:67], v[68:71], 0
  ds_read_b128 v[116:119], v18 offset:16640
  v_mul_f32 v133, s69, v133
  v_mfma_f32_16x16x32_bf16 v[172:175], a[68:71], v[76:79], v[172:175]
  v_mul_f32 v134, s69, v134
  v_mul_f32 v135, s69, v135
  v_mfma_f32_16x16x32_bf16 v[172:175], a[72:75], v[84:87], v[172:175]
  ds_read_b128 v[120:123], v19 offset:256
  v_cvt_pk_bf16_f32 v192, v128, v129
  v_mfma_f32_16x16x32_bf16 v[172:175], a[76:79], v[92:95], v[172:175]
  v_cvt_pk_bf16_f32 v193, v130, v131
  v_cvt_pk_bf16_f32 v194, v132, v133
  v_mfma_f32_16x16x32_bf16 v[176:179], a[128:131], v[64:67], 0
  ds_read_b128 v[124:127], v19 offset:16640
  v_cvt_pk_bf16_f32 v195, v134, v135
  v_mfma_f32_16x16x32_bf16 v[176:179], a[132:135], v[72:75], v[176:179]
  buffer_store_dwordx4 v[192:195], v2, s[40:43], s62 offen offset:0 sc1
  v_mfma_f32_16x16x32_bf16 v[176:179], a[136:139], v[80:83], v[176:179]
  v_mul_f32 v136, s69, v136
  v_mul_f32 v137, s69, v137
  v_mfma_f32_16x16x32_bf16 v[176:179], a[140:143], v[88:91], v[176:179]
  v_mul_f32 v138, s69, v138
  v_mul_f32 v139, s69, v139
  v_mfma_f32_16x16x32_bf16 v[184:187], a[128:131], v[68:71], 0
  v_mul_f32 v140, s69, v140
  v_mul_f32 v141, s69, v141
  v_mfma_f32_16x16x32_bf16 v[184:187], a[132:135], v[76:79], v[184:187]
  v_mul_f32 v142, s69, v142
  v_mul_f32 v143, s69, v143
  v_mfma_f32_16x16x32_bf16 v[184:187], a[136:139], v[84:87], v[184:187]
  v_cvt_pk_bf16_f32 v196, v136, v137
  v_cvt_pk_bf16_f32 v197, v138, v139
  v_mfma_f32_16x16x32_bf16 v[184:187], a[140:143], v[92:95], v[184:187]
  v_cvt_pk_bf16_f32 v198, v140, v141
  v_cvt_pk_bf16_f32 v199, v142, v143
  v_mfma_f32_16x16x32_bf16 v[180:183], a[192:195], v[64:67], 0
  buffer_store_dwordx4 v[196:199], v2, s[40:43], s62 offen offset:1024 sc1
  v_mfma_f32_16x16x32_bf16 v[180:183], a[196:199], v[72:75], v[180:183]
  v_mul_f32 v144, s69, v144
  v_mul_f32 v145, s69, v145
  v_mfma_f32_16x16x32_bf16 v[180:183], a[200:203], v[80:83], v[180:183]
  v_mul_f32 v146, s69, v146
  v_mul_f32 v147, s69, v147
  v_mfma_f32_16x16x32_bf16 v[180:183], a[204:207], v[88:91], v[180:183]
  v_mul_f32 v148, s69, v148
  v_mul_f32 v149, s69, v149
  v_mfma_f32_16x16x32_bf16 v[188:191], a[192:195], v[68:71], 0
  v_mul_f32 v150, s69, v150
  v_mul_f32 v151, s69, v151
  v_mfma_f32_16x16x32_bf16 v[188:191], a[196:199], v[76:79], v[188:191]
  v_cvt_pk_bf16_f32 v200, v144, v145
  v_cvt_pk_bf16_f32 v201, v146, v147
  v_mfma_f32_16x16x32_bf16 v[188:191], a[200:203], v[84:87], v[188:191]
  v_cvt_pk_bf16_f32 v202, v148, v149
  v_cvt_pk_bf16_f32 v203, v150, v151
  v_mfma_f32_16x16x32_bf16 v[188:191], a[204:207], v[92:95], v[188:191]
  s_waitcnt lgkmcnt(0)
  buffer_store_dwordx4 v[200:203], v2, s[40:43], s62 offen offset:2048 sc1
  v_mfma_f32_16x16x32_bf16 v[160:163], a[16:19], v[96:99], v[160:163]
  v_mul_f32 v152, s69, v152
  v_mul_f32 v153, s69, v153
  v_mfma_f32_16x16x32_bf16 v[160:163], a[20:23], v[104:107], v[160:163]
  v_mul_f32 v154, s69, v154
  v_mul_f32 v155, s69, v155
  v_mfma_f32_16x16x32_bf16 v[160:163], a[24:27], v[112:115], v[160:163]
  ds_read_b128 v[64:67], v16 offset:512
  v_mul_f32 v156, s69, v156
  v_mfma_f32_16x16x32_bf16 v[160:163], a[28:31], v[120:123], v[160:163]
  v_mul_f32 v157, s69, v157
  v_mul_f32 v158, s69, v158
  v_mfma_f32_16x16x32_bf16 v[168:171], a[16:19], v[100:103], v[168:171]
  ds_read_b128 v[68:71], v16 offset:16896
  v_mul_f32 v159, s69, v159
  v_mfma_f32_16x16x32_bf16 v[168:171], a[20:23], v[108:111], v[168:171]
  v_cvt_pk_bf16_f32 v204, v152, v153
  v_cvt_pk_bf16_f32 v205, v154, v155
  v_mfma_f32_16x16x32_bf16 v[168:171], a[24:27], v[116:119], v[168:171]
  ds_read_b128 v[72:75], v17 offset:512
  v_cvt_pk_bf16_f32 v206, v156, v157
  v_mfma_f32_16x16x32_bf16 v[168:171], a[28:31], v[124:127], v[168:171]
  v_cvt_pk_bf16_f32 v207, v158, v159
  v_mfma_f32_16x16x32_bf16 v[164:167], a[80:83], v[96:99], v[164:167]
  ds_read_b128 v[76:79], v17 offset:16896
  v_mfma_f32_16x16x32_bf16 v[164:167], a[84:87], v[104:107], v[164:167]
  buffer_store_dwordx4 v[204:207], v2, s[40:43], s62 offen offset:3072 sc1
  v_mfma_f32_16x16x32_bf16 v[164:167], a[88:91], v[112:115], v[164:167]
  ds_read_b128 v[80:83], v18 offset:512
  v_mfma_f32_16x16x32_bf16 v[164:167], a[92:95], v[120:123], v[164:167]
  v_mfma_f32_16x16x32_bf16 v[172:175], a[80:83], v[100:103], v[172:175]
  ds_read_b128 v[84:87], v18 offset:16896
  v_mfma_f32_16x16x32_bf16 v[172:175], a[84:87], v[108:111], v[172:175]
  v_mfma_f32_16x16x32_bf16 v[172:175], a[88:91], v[116:119], v[172:175]
  ds_read_b128 v[88:91], v19 offset:512
  v_mfma_f32_16x16x32_bf16 v[172:175], a[92:95], v[124:127], v[172:175]
  v_mfma_f32_16x16x32_bf16 v[176:179], a[144:147], v[96:99], v[176:179]
  ds_read_b128 v[92:95], v19 offset:16896
  v_mfma_f32_16x16x32_bf16 v[176:179], a[148:151], v[104:107], v[176:179]
  v_mfma_f32_16x16x32_bf16 v[176:179], a[152:155], v[112:115], v[176:179]
  s_add_u32 s62, s62, s65
  s_cmp_eq_u32 s63, 15
  s_cselect_b32 s65, s71, 0x2000
  v_mfma_f32_16x16x32_bf16 v[176:179], a[156:159], v[120:123], v[176:179]
  s_add_u32 m0, s66, 0
  s_add_u32 s58, s61, 0
  v_mfma_f32_16x16x32_bf16 v[184:187], a[144:147], v[100:103], v[184:187]
  v_mfma_f32_16x16x32_bf16 v[184:187], a[148:151], v[108:111], v[184:187]
  buffer_load_dwordx4 v8, s[52:55], s58 offen lds
  v_mfma_f32_16x16x32_bf16 v[184:187], a[152:155], v[116:119], v[184:187]
  v_mfma_f32_16x16x32_bf16 v[184:187], a[156:159], v[124:127], v[184:187]
  s_add_u32 m0, s66, 1024
  s_add_u32 s58, s61, 1024
  v_mfma_f32_16x16x32_bf16 v[180:183], a[208:211], v[96:99], v[180:183]
  v_mfma_f32_16x16x32_bf16 v[180:183], a[212:215], v[104:107], v[180:183]
  buffer_load_dwordx4 v9, s[52:55], s58 offen lds
  v_mfma_f32_16x16x32_bf16 v[180:183], a[216:219], v[112:115], v[180:183]
  v_mfma_f32_16x16x32_bf16 v[180:183], a[220:223], v[120:123], v[180:183]
  s_add_u32 m0, s66, 2048
  s_add_u32 s58, s61, 2048
  v_mfma_f32_16x16x32_bf16 v[188:191], a[208:211], v[100:103], v[188:191]
  v_mfma_f32_16x16x32_bf16 v[188:191], a[212:215], v[108:111], v[188:191]
  buffer_load_dwordx4 v10, s[52:55], s58 offen lds
  v_mfma_f32_16x16x32_bf16 v[188:191], a[216:219], v[116:119], v[188:191]
  v_mfma_f32_16x16x32_bf16 v[188:191], a[220:223], v[124:127], v[188:191]
  s_waitcnt lgkmcnt(0)
  s_add_u32 m0, s66, 3072
  s_add_u32 s58, s61, 3072
  v_mfma_f32_16x16x32_bf16 v[160:163], a[32:35], v[64:67], v[160:163]
  v_mfma_f32_16x16x32_bf16 v[160:163], a[36:39], v[72:75], v[160:163]
  buffer_load_dwordx4 v11, s[52:55], s58 offen lds
  v_mfma_f32_16x16x32_bf16 v[160:163], a[40:43], v[80:83], v[160:163]
  ds_read_b128 v[96:99], v16 offset:768
  v_mfma_f32_16x16x32_bf16 v[160:163], a[44:47], v[88:91], v[160:163]
  s_add_u32 m0, s66, 4096
  s_add_u32 s58, s61, 4096
  v_mfma_f32_16x16x32_bf16 v[168:171], a[32:35], v[68:71], v[168:171]
  ds_read_b128 v[100:103], v16 offset:17152
  v_mfma_f32_16x16x32_bf16 v[168:171], a[36:39], v[76:79], v[168:171]
  buffer_load_dwordx4 v12, s[52:55], s58 offen lds
  v_mfma_f32_16x16x32_bf16 v[168:171], a[40:43], v[84:87], v[168:171]
  ds_read_b128 v[104:107], v17 offset:768
  v_mfma_f32_16x16x32_bf16 v[168:171], a[44:47], v[92:95], v[168:171]
  s_add_u32 m0, s66, 5120
  s_add_u32 s58, s61, 5120
  v_mfma_f32_16x16x32_bf16 v[164:167], a[96:99], v[64:67], v[164:167]
  ds_read_b128 v[108:111], v17 offset:17152
  v_mfma_f32_16x16x32_bf16 v[164:167], a[100:103], v[72:75], v[164:167]
  buffer_load_dwordx4 v13, s[52:55], s58 offen lds
  v_mfma_f32_16x16x32_bf16 v[164:167], a[104:107], v[80:83], v[164:167]
  ds_read_b128 v[112:115], v18 offset:768
  v_mfma_f32_16x16x32_bf16 v[164:167], a[108:111], v[88:91], v[164:167]
  s_add_u32 m0, s66, 6144
  s_add_u32 s58, s61, 6144
  v_mfma_f32_16x16x32_bf16 v[172:175], a[96:99], v[68:71], v[172:175]
  ds_read_b128 v[116:119], v18 offset:17152
  v_mfma_f32_16x16x32_bf16 v[172:175], a[100:103], v[76:79], v[172:175]
  buffer_load_dwordx4 v14, s[52:55], s58 offen lds
  v_mfma_f32_16x16x32_bf16 v[172:175], a[104:107], v[84:87], v[172:175]
  ds_read_b128 v[120:123], v19 offset:768
  v_mfma_f32_16x16x32_bf16 v[172:175], a[108:111], v[92:95], v[172:175]
  s_add_u32 m0, s66, 7168
  s_add_u32 s58, s61, 7168
  v_mfma_f32_16x16x32_bf16 v[176:179], a[160:163], v[64:67], v[176:179]
  ds_read_b128 v[124:127], v19 offset:17152
  v_mfma_f32_16x16x32_bf16 v[176:179], a[164:167], v[72:75], v[176:179]
  buffer_load_dwordx4 v15, s[52:55], s58 offen lds
  v_mfma_f32_16x16x32_bf16 v[176:179], a[168:171], v[80:83], v[176:179]
  v_mfma_f32_16x16x32_bf16 v[176:179], a[172:175], v[88:91], v[176:179]
  s_cmp_eq_u32 s63, 12
  s_cselect_b32 s59, s70, 0
  s_add_u32 s61, s61, s59
  v_mfma_f32_16x16x32_bf16 v[184:187], a[160:163], v[68:71], v[184:187]
  v_add_u32 v16, 0x8000, v16
  v_mfma_f32_16x16x32_bf16 v[184:187], a[164:167], v[76:79], v[184:187]
  s_add_u32 s61, s61, 0x8000
  v_and_b32 v16, 0x1ffff, v16
  v_mfma_f32_16x16x32_bf16 v[184:187], a[168:171], v[84:87], v[184:187]
  s_add_u32 s66, s66, 0x8000
  v_add_u32 v17, 0x8000, v17
  v_mfma_f32_16x16x32_bf16 v[184:187], a[172:175], v[92:95], v[184:187]
  s_and_b32 s66, s66, 0x1ffff
  v_and_b32 v17, 0x1ffff, v17
  v_mfma_f32_16x16x32_bf16 v[180:183], a[224:227], v[64:67], v[180:183]
  v_add_u32 v18, 0x8000, v18
  v_mfma_f32_16x16x32_bf16 v[180:183], a[228:231], v[72:75], v[180:183]
  v_and_b32 v18, 0x1ffff, v18
  v_mfma_f32_16x16x32_bf16 v[180:183], a[232:235], v[80:83], v[180:183]
  v_add_u32 v19, 0x8000, v19
  v_mfma_f32_16x16x32_bf16 v[180:183], a[236:239], v[88:91], v[180:183]
  v_and_b32 v19, 0x1ffff, v19
  v_mfma_f32_16x16x32_bf16 v[188:191], a[224:227], v[68:71], v[188:191]
  s_sub_u32 s59, s63, 1
  s_max_i32 s59, s59, 0
  v_mfma_f32_16x16x32_bf16 v[188:191], a[228:231], v[76:79], v[188:191]
  v_mov_b32 v7, s59
  v_mfma_f32_16x16x32_bf16 v[188:191], a[232:235], v[84:87], v[188:191]
  v_mfma_f32_16x16x32_bf16 v[188:191], a[236:239], v[92:95], v[188:191]
  s_waitcnt lgkmcnt(0)
  v_mfma_f32_16x16x32_bf16 v[160:163], a[48:51], v[96:99], v[160:163]
  s_waitcnt vmcnt(20)
  v_mfma_f32_16x16x32_bf16 v[160:163], a[52:55], v[104:107], v[160:163]
  s_barrier
  v_mfma_f32_16x16x32_bf16 v[160:163], a[56:59], v[112:115], v[160:163]
  ds_read_b128 v[64:67], v16 offset:0
  v_mfma_f32_16x16x32_bf16 v[160:163], a[60:63], v[120:123], v[160:163]
  buffer_store_dword v7, v6, s[40:43], s64 offen sc1
  v_mfma_f32_16x16x32_bf16 v[168:171], a[48:51], v[100:103], v[168:171]
  ds_read_b128 v[68:71], v16 offset:16384
  v_mfma_f32_16x16x32_bf16 v[168:171], a[52:55], v[108:111], v[168:171]
  v_mfma_f32_16x16x32_bf16 v[168:171], a[56:59], v[116:119], v[168:171]
  ds_read_b128 v[72:75], v17 offset:0
  v_mfma_f32_16x16x32_bf16 v[168:171], a[60:63], v[124:127], v[168:171]
  v_mfma_f32_16x16x32_bf16 v[164:167], a[112:115], v[96:99], v[164:167]
  ds_read_b128 v[76:79], v17 offset:16384
  v_mfma_f32_16x16x32_bf16 v[164:167], a[116:119], v[104:107], v[164:167]
  v_mfma_f32_16x16x32_bf16 v[164:167], a[120:123], v[112:115], v[164:167]
  ds_read_b128 v[80:83], v18 offset:0
  v_mfma_f32_16x16x32_bf16 v[164:167], a[124:127], v[120:123], v[164:167]
  v_mfma_f32_16x16x32_bf16 v[172:175], a[112:115], v[100:103], v[172:175]
  ds_read_b128 v[84:87], v18 offset:16384
  v_mfma_f32_16x16x32_bf16 v[172:175], a[116:119], v[108:111], v[172:175]
  v_mfma_f32_16x16x32_bf16 v[172:175], a[120:123], v[116:119], v[172:175]
  ds_read_b128 v[88:91], v19 offset:0
  v_mfma_f32_16x16x32_bf16 v[172:175], a[124:127], v[124:127], v[172:175]
  v_mfma_f32_16x16x32_bf16 v[176:179], a[176:179], v[96:99], v[176:179]
  ds_read_b128 v[92:95], v19 offset:16384
  v_mfma_f32_16x16x32_bf16 v[176:179], a[180:183], v[104:107], v[176:179]
  v_mfma_f32_16x16x32_bf16 v[176:179], a[184:187], v[112:115], v[176:179]
  v_mfma_f32_16x16x32_bf16 v[176:179], a[188:191], v[120:123], v[176:179]
  s_mov_b64 exec, 1
  buffer_atomic_add v33, v6, s[40:43], s76 offen
  s_mov_b64 exec, -1
  v_mfma_f32_16x16x32_bf16 v[184:187], a[176:179], v[100:103], v[184:187]
  s_mov_b32 s76, 0x40000000
  v_mfma_f32_16x16x32_bf16 v[184:187], a[180:183], v[108:111], v[184:187]
  v_mfma_f32_16x16x32_bf16 v[184:187], a[184:187], v[116:119], v[184:187]
  v_mfma_f32_16x16x32_bf16 v[184:187], a[188:191], v[124:127], v[184:187]
  v_mfma_f32_16x16x32_bf16 v[180:183], a[240:243], v[96:99], v[180:183]
  s_add_u32 s63, s63, 1
  v_mfma_f32_16x16x32_bf16 v[180:183], a[244:247], v[104:107], v[180:183]
  v_mfma_f32_16x16x32_bf16 v[180:183], a[248:251], v[112:115], v[180:183]
  v_mfma_f32_16x16x32_bf16 v[180:183], a[252:255], v[120:123], v[180:183]
  v_mfma_f32_16x16x32_bf16 v[188:191], a[240:243], v[100:103], v[188:191]
  v_mfma_f32_16x16x32_bf16 v[188:191], a[244:247], v[108:111], v[188:191]
  v_mfma_f32_16x16x32_bf16 v[188:191], a[248:251], v[116:119], v[188:191]
  s_cmp_lt_u32 s63, s67
  v_mfma_f32_16x16x32_bf16 v[188:191], a[252:255], v[124:127], v[188:191]
  s_waitcnt lgkmcnt(0)
  s_cbranch_scc1 L_f_00
  s_branch L_f_done
L_f_10:
  v_mfma_f32_16x16x32_bf16 v[128:131], v[64:67], a[0:3], 0
  v_mfma_f32_16x16x32_bf16 v[128:131], v[72:75], a[4:7], v[128:131]
  v_mfma_f32_16x16x32_bf16 v[128:131], v[80:83], a[8:11], v[128:131]
  ds_read_b128 v[96:99], v16 offset:256
  v_mfma_f32_16x16x32_bf16 v[128:131], v[88:91], a[12:15], v[128:131]
  v_mfma_f32_16x16x32_bf16 v[132:135], v[68:71], a[0:3], 0
  ds_read_b128 v[100:103], v16 offset:16640
  v_mfma_f32_16x16x32_bf16 v[132:135], v[76:79], a[4:7], v[132:135]
  v_mfma_f32_16x16x32_bf16 v[132:135], v[84:87], a[8:11], v[132:135]
  ds_read_b128 v[104:107], v17 offset:256
  v_mfma_f32_16x16x32_bf16 v[132:135], v[92:95], a[12:15], v[132:135]
  v_mfma_f32_16x16x32_bf16 v[136:139], v[64:67], a[64:67], 0
  ds_read_b128 v[108:111], v17 offset:16640
  v_mfma_f32_16x16x32_bf16 v[136:139], v[72:75], a[68:71], v[136:139]
  v_cvt_pk_bf16_f32 v192, v160, v161
  v_cvt_pk_bf16_f32 v193, v162, v163
  v_mfma_f32_16x16x32_bf16 v[136:139], v[80:83], a[72:75], v[136:139]
  ds_read_b128 v[112:115], v18 offset:256
  v_cvt_pk_bf16_f32 v194, v164, v165
  v_mfma_f32_16x16x32_bf16 v[136:139], v[88:91], a[76:79], v[136:139]
  v_cvt_pk_bf16_f32 v195, v166, v167
  v_mfma_f32_16x16x32_bf16 v[140:143], v[68:71], a[64:67], 0
  ds_read_b128 v[116:119], v18 offset:16640
  v_mfma_f32_16x16x32_bf16 v[140:143], v[76:79], a[68:71], v[140:143]
  buffer_store_dwordx4 v[192:195], v2, s[40:43], s62 offen offset:0 sc1
  v_mfma_f32_16x16x32_bf16 v[140:143], v[84:87], a[72:75], v[140:143]
  ds_read_b128 v[120:123], v19 offset:256
  v_cvt_pk_bf16_f32 v196, v168, v169
  v_mfma_f32_16x16x32_bf16 v[140:143], v[92:95], a[76:79], v[140:143]
  v_cvt_pk_bf16_f32 v197, v170, v171
  v_cvt_pk_bf16_f32 v198, v172, v173
  v_mfma_f32_16x16x32_bf16 v[144:147], v[64:67], a[128:131], 0
  ds_read_b128 v[124:127], v19 offset:16640
  v_cvt_pk_bf16_f32 v199, v174, v175
  v_mfma_f32_16x16x32_bf16 v[144:147], v[72:75], a[132:135], v[144:147]
  buffer_store_dwordx4 v[196:199], v2, s[40:43], s62 offen offset:1024 sc1
  v_mfma_f32_16x16x32_bf16 v[144:147], v[80:83], a[136:139], v[144:147]
  v_cvt_pk_bf16_f32 v200, v176, v177
  v_cvt_pk_bf16_f32 v201, v178, v179
  v_mfma_f32_16x16x32_bf16 v[144:147], v[88:91], a[140:143], v[144:147]
  v_cvt_pk_bf16_f32 v202, v180, v181
  v_cvt_pk_bf16_f32 v203, v182, v183
  v_mfma_f32_16x16x32_bf16 v[148:151], v[68:71], a[128:131], 0
  buffer_store_dwordx4 v[200:203], v2, s[40:43], s62 offen offset:2048 sc1
  v_mfma_f32_16x16x32_bf16 v[148:151], v[76:79], a[132:135], v[148:151]
  v_cvt_pk_bf16_f32 v204, v184, v185
  v_cvt_pk_bf16_f32 v205, v186, v187
  v_mfma_f32_16x16x32_bf16 v[148:151], v[84:87], a[136:139], v[148:151]
  v_cvt_pk_bf16_f32 v206, v188, v189
  v_cvt_pk_bf16_f32 v207, v190, v191
  v_mfma_f32_16x16x32_bf16 v[148:151], v[92:95], a[140:143], v[148:151]
  buffer_store_dwordx4 v[204:207], v2, s[40:43], s62 offen offset:3072 sc1
  v_mfma_f32_16x16x32_bf16 v[152:155], v[64:67], a[192:195], 0
  v_mfma_f32_16x16x32_bf16 v[152:155], v[72:75], a[196:199], v[152:155]
  v_mfma_f32_16x16x32_bf16 v[152:155], v[80:83], a[200:203], v[152:155]
  v_mfma_f32_16x16x32_bf16 v[152:155], v[88:91], a[204:207], v[152:155]
  v_mfma_f32_16x16x32_bf16 v[156:159], v[68:71], a[192:195], 0
  v_mfma_f32_16x16x32_bf16 v[156:159], v[76:79], a[196:199], v[156:159]
  v_mfma_f32_16x16x32_bf16 v[156:159], v[84:87], a[200:203], v[156:159]
  v_mfma_f32_16x16x32_bf16 v[156:159], v[92:95], a[204:207], v[156:159]
  s_waitcnt lgkmcnt(0)
  v_mfma_f32_16x16x32_bf16 v[128:131], v[96:99], a[16:19], v[128:131]
  v_mfma_f32_16x16x32_bf16 v[128:131], v[104:107], a[20:23], v[128:131]
  v_mfma_f32_16x16x32_bf16 v[128:131], v[112:115], a[24:27], v[128:131]
  ds_read_b128 v[64:67], v16 offset:512
  v_mfma_f32_16x16x32_bf16 v[128:131], v[120:123], a[28:31], v[128:131]
  v_mfma_f32_16x16x32_bf16 v[132:135], v[100:103], a[16:19], v[132:135]
  ds_read_b128 v[68:71], v16 offset:16896
  v_mfma_f32_16x16x32_bf16 v[132:135], v[108:111], a[20:23], v[132:135]
  v_mfma_f32_16x16x32_bf16 v[132:135], v[116:119], a[24:27], v[132:135]
  ds_read_b128 v[72:75], v17 offset:512
  v_mfma_f32_16x16x32_bf16 v[132:135], v[124:127], a[28:31], v[132:135]
  v_mfma_f32_16x16x32_bf16 v[136:139], v[96:99], a[80:83], v[136:139]
  ds_read_b128 v[76:79], v17 offset:16896
  v_mfma_f32_16x16x32_bf16 v[136:139], v[104:107], a[84:87], v[136:139]
  v_mfma_f32_16x16x32_bf16 v[136:139], v[112:115], a[88:91], v[136:139]
  ds_read_b128 v[80:83], v18 offset:512
  v_mfma_f32_16x16x32_bf16 v[136:139], v[120:123], a[92:95], v[136:139]
  v_mfma_f32_16x16x32_bf16 v[140:143], v[100:103], a[80:83], v[140:143]
  ds_read_b128 v[84:87], v18 offset:16896
  v_mfma_f32_16x16x32_bf16 v[140:143], v[108:111], a[84:87], v[140:143]
  v_mfma_f32_16x16x32_bf16 v[140:143], v[116:119], a[88:91], v[140:143]
  ds_read_b128 v[88:91], v19 offset:512
  v_mfma_f32_16x16x32_bf16 v[140:143], v[124:127], a[92:95], v[140:143]
  v_mfma_f32_16x16x32_bf16 v[144:147], v[96:99], a[144:147], v[144:147]
  ds_read_b128 v[92:95], v19 offset:16896
  v_mfma_f32_16x16x32_bf16 v[144:147], v[104:107], a[148:151], v[144:147]
  v_mfma_f32_16x16x32_bf16 v[144:147], v[112:115], a[152:155], v[144:147]
  s_add_u32 s62, s62, s65
  s_cmp_eq_u32 s63, 15
  s_cselect_b32 s65, s71, 0x2000
  v_mfma_f32_16x16x32_bf16 v[144:147], v[120:123], a[156:159], v[144:147]
  s_add_u32 m0, s66, 0
  s_add_u32 s58, s61, 0
  v_mfma_f32_16x16x32_bf16 v[148:151], v[100:103], a[144:147], v[148:151]
  v_mfma_f32_16x16x32_bf16 v[148:151], v[108:111], a[148:151], v[148:151]
  buffer_load_dwordx4 v8, s[52:55], s58 offen lds
  v_mfma_f32_16x16x32_bf16 v[148:151], v[116:119], a[152:155], v[148:151]
  v_mfma_f32_16x16x32_bf16 v[148:151], v[124:127], a[156:159], v[148:151]
  s_add_u32 m0, s66, 1024
  s_add_u32 s58, s61, 1024
  v_mfma_f32_16x16x32_bf16 v[152:155], v[96:99], a[208:211], v[152:155]
  v_mfma_f32_16x16x32_bf16 v[152:155], v[104:107], a[212:215], v[152:155]
  buffer_load_dwordx4 v9, s[52:55], s58 offen lds
  v_mfma_f32_16x16x32_bf16 v[152:155], v[112:115], a[216:219], v[152:155]
  v_mfma_f32_16x16x32_bf16 v[152:155], v[120:123], a[220:223], v[152:155]
  s_add_u32 m0, s66, 2048
  s_add_u32 s58, s61, 2048
  v_mfma_f32_16x16x32_bf16 v[156:159], v[100:103], a[208:211], v[156:159]
  v_mfma_f32_16x16x32_bf16 v[156:159], v[108:111], a[212:215], v[156:159]
  buffer_load_dwordx4 v10, s[52:55], s58 offen lds
  v_mfma_f32_16x16x32_bf16 v[156:159], v[116:119], a[216:219], v[156:159]
  v_mfma_f32_16x16x32_bf16 v[156:159], v[124:127], a[220:223], v[156:159]
  s_waitcnt lgkmcnt(0)
  s_add_u32 m0, s66, 3072
  s_add_u32 s58, s61, 3072
  v_mfma_f32_16x16x32_bf16 v[128:131], v[64:67], a[32:35], v[128:131]
  v_mfma_f32_16x16x32_bf16 v[128:131], v[72:75], a[36:39], v[128:131]
  buffer_load_dwordx4 v11, s[52:55], s58 offen lds
  v_mfma_f32_16x16x32_bf16 v[128:131], v[80:83], a[40:43], v[128:131]
  ds_read_b128 v[96:99], v16 offset:768
  v_mfma_f32_16x16x32_bf16 v[128:131], v[88:91], a[44:47], v[128:131]
  s_add_u32 m0, s66, 4096
  s_add_u32 s58, s61, 4096
  v_mfma_f32_16x16x32_bf16 v[132:135], v[68:71], a[32:35], v[132:135]
  ds_read_b128 v[100:103], v16 offset:17152
  v_mfma_f32_16x16x32_bf16 v[132:135], v[76:79], a[36:39], v[132:135]
  buffer_load_dwordx4 v12, s[52:55], s58 offen lds
  v_mfma_f32_16x16x32_bf16 v[132:135], v[84:87], a[40:43], v[132:135]
  ds_read_b128 v[104:107], v17 offset:768
  v_mfma_f32_16x16x32_bf16 v[132:135], v[92:95], a[44:47], v[132:135]
  s_add_u32 m0, s66, 5120
  s_add_u32 s58, s61, 5120
  v_mfma_f32_16x16x32_bf16 v[136:139], v[64:67], a[96:99], v[136:139]
  ds_read_b128 v[108:111], v17 offset:17152
  v_mfma_f32_16x16x32_bf16 v[136:139], v[72:75], a[100:103], v[136:139]
  buffer_load_dwordx4 v13, s[52:55], s58 offen lds
  v_mfma_f32_16x16x32_bf16 v[136:139], v[80:83], a[104:107], v[136:139]
  ds_read_b128 v[112:115], v18 offset:768
  v_mfma_f32_16x16x32_bf16 v[136:139], v[88:91], a[108:111], v[136:139]
  s_add_u32 m0, s66, 6144
  s_add_u32 s58, s61, 6144
  v_mfma_f32_16x16x32_bf16 v[140:143], v[68:71], a[96:99], v[140:143]
  ds_read_b128 v[116:119], v18 offset:17152
  v_mfma_f32_16x16x32_bf16 v[140:143], v[76:79], a[100:103], v[140:143]
  buffer_load_dwordx4 v14, s[52:55], s58 offen lds
  v_mfma_f32_16x16x32_bf16 v[140:143], v[84:87], a[104:107], v[140:143]
  ds_read_b128 v[120:123], v19 offset:768
  v_mfma_f32_16x16x32_bf16 v[140:143], v[92:95], a[108:111], v[140:143]
  s_add_u32 m0, s66, 7168
  s_add_u32 s58, s61, 7168
  v_mfma_f32_16x16x32_bf16 v[144:147], v[64:67], a[160:163], v[144:147]
  ds_read_b128 v[124:127], v19 offset:17152
  v_mfma_f32_16x16x32_bf16 v[144:147], v[72:75], a[164:167], v[144:147]
  buffer_load_dwordx4 v15, s[52:55], s58 offen lds
  v_mfma_f32_16x16x32_bf16 v[144:147], v[80:83], a[168:171], v[144:147]
  v_mfma_f32_16x16x32_bf16 v[144:147], v[88:91], a[172:175], v[144:147]
  s_cmp_eq_u32 s63, 12
  s_cselect_b32 s59, s70, 0
  s_add_u32 s61, s61, s59
  v_mfma_f32_16x16x32_bf16 v[148:151], v[68:71], a[160:163], v[148:151]
  v_add_u32 v16, 0x8000, v16
  v_mfma_f32_16x16x32_bf16 v[148:151], v[76:79], a[164:167], v[148:151]
  s_add_u32 s61, s61, 0x8000
  v_and_b32 v16, 0x1ffff, v16
  v_mfma_f32_16x16x32_bf16 v[148:151], v[84:87], a[168:171], v[148:151]
  s_add_u32 s66, s66, 0x8000
  v_add_u32 v17, 0x8000, v17
  v_mfma_f32_16x16x32_bf16 v[148:151], v[92:95], a[172:175], v[148:151]
  s_and_b32 s66, s66, 0x1ffff
  v_and_b32 v17, 0x1ffff, v17
  v_mfma_f32_16x16x32_bf16 v[152:155], v[64:67], a[224:227], v[152:155]
  v_add_u32 v18, 0x8000, v18
  v_mfma_f32_16x16x32_bf16 v[152:155], v[72:75], a[228:231], v[152:155]
  v_and_b32 v18, 0x1ffff, v18
  v_mfma_f32_16x16x32_bf16 v[152:155], v[80:83], a[232:235], v[152:155]
  v_add_u32 v19, 0x8000, v19
  v_mfma_f32_16x16x32_bf16 v[152:155], v[88:91], a[236:239], v[152:155]
  v_and_b32 v19, 0x1ffff, v19
  v_mfma_f32_16x16x32_bf16 v[156:159], v[68:71], a[224:227], v[156:159]
  s_sub_u32 s59, s63, 1
  s_max_i32 s59, s59, 0
  v_mfma_f32_16x16x32_bf16 v[156:159], v[76:79], a[228:231], v[156:159]
  v_mov_b32 v7, s59
  v_mfma_f32_16x16x32_bf16 v[156:159], v[84:87], a[232:235], v[156:159]
  v_mfma_f32_16x16x32_bf16 v[156:159], v[92:95], a[236:239], v[156:159]
  s_waitcnt lgkmcnt(0)
  v_mfma_f32_16x16x32_bf16 v[128:131], v[96:99], a[48:51], v[128:131]
  s_waitcnt vmcnt(20)
  v_mfma_f32_16x16x32_bf16 v[128:131], v[104:107], a[52:55], v[128:131]
  s_barrier
  v_mfma_f32_16x16x32_bf16 v[128:131], v[112:115], a[56:59], v[128:131]
  ds_read_b128 v[64:67], v16 offset:0
  v_mfma_f32_16x16x32_bf16 v[128:131], v[120:123], a[60:63], v[128:131]
  buffer_store_dword v7, v6, s[40:43], s64 offen sc1
  v_mfma_f32_16x16x32_bf16 v[132:135], v[100:103], a[48:51], v[132:135]
  ds_read_b128 v[68:71], v16 offset:16384
  v_mfma_f32_16x16x32_bf16 v[132:135], v[108:111], a[52:55], v[132:135]
  v_mfma_f32_16x16x32_bf16 v[132:135], v[116:119], a[56:59], v[132:135]
  ds_read_b128 v[72:75], v17 offset:0
  v_mfma_f32_16x16x32_bf16 v[132:135], v[124:127], a[60:63], v[132:135]
  v_mfma_f32_16x16x32_bf16 v[136:139], v[96:99], a[112:115], v[136:139]
  ds_read_b128 v[76:79], v17 offset:16384
  v_mfma_f32_16x16x32_bf16 v[136:139], v[104:107], a[116:119], v[136:139]
  v_mfma_f32_16x16x32_bf16 v[136:139], v[112:115], a[120:123], v[136:139]
  ds_read_b128 v[80:83], v18 offset:0
  v_mfma_f32_16x16x32_bf16 v[136:139], v[120:123], a[124:127], v[136:139]
  v_mfma_f32_16x16x32_bf16 v[140:143], v[100:103], a[112:115], v[140:143]
  ds_read_b128 v[84:87], v18 offset:16384
  v_mfma_f32_16x16x32_bf16 v[140:143], v[108:111], a[116:119], v[140:143]
  v_mfma_f32_16x16x32_bf16 v[140:143], v[116:119], a[120:123], v[140:143]
  ds_read_b128 v[88:91], v19 offset:0
  v_mfma_f32_16x16x32_bf16 v[140:143], v[124:127], a[124:127], v[140:143]
  v_mfma_f32_16x16x32_bf16 v[144:147], v[96:99], a[176:179], v[144:147]
  ds_read_b128 v[92:95], v19 offset:16384
  v_mfma_f32_16x16x32_bf16 v[144:147], v[104:107], a[180:183], v[144:147]
  v_mfma_f32_16x16x32_bf16 v[144:147], v[112:115], a[184:187], v[144:147]
  v_mfma_f32_16x16x32_bf16 v[144:147], v[120:123], a[188:191], v[144:147]
  v_mfma_f32_16x16x32_bf16 v[148:151], v[100:103], a[176:179], v[148:151]
  v_mfma_f32_16x16x32_bf16 v[148:151], v[108:111], a[180:183], v[148:151]
  v_mfma_f32_16x16x32_bf16 v[148:151], v[116:119], a[184:187], v[148:151]
  v_mfma_f32_16x16x32_bf16 v[148:151], v[124:127], a[188:191], v[148:151]
  v_mfma_f32_16x16x32_bf16 v[152:155], v[96:99], a[240:243], v[152:155]
  s_add_u32 s63, s63, 1
  v_mfma_f32_16x16x32_bf16 v[152:155], v[104:107], a[244:247], v[152:155]
  v_mfma_f32_16x16x32_bf16 v[152:155], v[112:115], a[248:251], v[152:155]
  v_mfma_f32_16x16x32_bf16 v[152:155], v[120:123], a[252:255], v[152:155]
  v_mfma_f32_16x16x32_bf16 v[156:159], v[100:103], a[240:243], v[156:159]
  v_mfma_f32_16x16x32_bf16 v[156:159], v[108:111], a[244:247], v[156:159]
  v_mfma_f32_16x16x32_bf16 v[156:159], v[116:119], a[248:251], v[156:159]
  s_cmp_lt_u32 s63, s67
  v_mfma_f32_16x16x32_bf16 v[156:159], v[124:127], a[252:255], v[156:159]
  s_waitcnt lgkmcnt(0)
L_f_11:
  v_mfma_f32_16x16x32_bf16 v[160:163], v[64:67], a[0:3], 0
  v_mfma_f32_16x16x32_bf16 v[160:163], v[72:75], a[4:7], v[160:163]
  v_mfma_f32_16x16x32_bf16 v[160:163], v[80:83], a[8:11], v[160:163]
  ds_read_b128 v[96:99], v16 offset:256
  v_mfma_f32_16x16x32_bf16 v[160:163], v[88:91], a[12:15], v[160:163]
  v_mfma_f32_16x16x32_bf16 v[164:167], v[68:71], a[0:3], 0
  ds_read_b128 v[100:103], v16 offset:16640
  v_mfma_f32_16x16x32_bf16 v[164:167], v[76:79], a[4:7], v[164:167]
  v_mfma_f32_16x16x32_bf16 v[164:167], v[84:87], a[8:11], v[164:167]
  ds_read_b128 v[104:107], v17 offset:256
  v_mfma_f32_16x16x32_bf16 v[164:167], v[92:95], a[12:15], v[164:167]
  v_mfma_f32_16x16x32_bf16 v[168:171], v[64:67], a[64:67], 0
  ds_read_b128 v[108:111], v17 offset:16640
  v_mfma_f32_16x16x32_bf16 v[168:171], v[72:75], a[68:71], v[168:171]
  v_cvt_pk_bf16_f32 v192, v128, v129
  v_cvt_pk_bf16_f32 v193, v130, v131
  v_mfma_f32_16x16x32_bf16 v[168:171], v[80:83], a[72:75], v[168:171]
  ds_read_b128 v[112:115], v18 offset:256
  v_cvt_pk_bf16_f32 v194, v132, v133
  v_mfma_f32_16x16x32_bf16 v[168:171], v[88:91], a[76:79], v[168:171]
  v_cvt_pk_bf16_f32 v195, v134, v135
  v_mfma_f32_16x16x32_bf16 v[172:175], v[68:71], a[64:67], 0
  ds_read_b128 v[116:119], v18 offset:16640
  v_mfma_f32_16x16x32_bf16 v[172:175], v[76:79], a[68:71], v[172:175]
  buffer_store_dwordx4 v[192:195], v2, s[40:43], s62 offen offset:0 sc1
  v_mfma_f32_16x16x32_bf16 v[172:175], v[84:87], a[72:75], v[172:175]
  ds_read_b128 v[120:123], v19 offset:256
  v_cvt_pk_bf16_f32 v196, v136, v137
  v_mfma_f32_16x16x32_bf16 v[172:175], v[92:95], a[76:79], v[172:175]
  v_cvt_pk_bf16_f32 v197, v138, v139
  v_cvt_pk_bf16_f32 v198, v140, v141
  v_mfma_f32_16x16x32_bf16 v[176:179], v[64:67], a[128:131], 0
  ds_read_b128 v[124:127], v19 offset:16640
  v_cvt_pk_bf16_f32 v199, v142, v143
  v_mfma_f32_16x16x32_bf16 v[176:179], v[72:75], a[132:135], v[176:179]
  buffer_store_dwordx4 v[196:199], v2, s[40:43], s62 offen offset:1024 sc1
  v_mfma_f32_16x16x32_bf16 v[176:179], v[80:83], a[136:139], v[176:179]
  v_cvt_pk_bf16_f32 v200, v144, v145
  v_cvt_pk_bf16_f32 v201, v146, v147
  v_mfma_f32_16x16x32_bf16 v[176:179], v[88:91], a[140:143], v[176:179]
  v_cvt_pk_bf16_f32 v202, v148, v149
  v_cvt_pk_bf16_f32 v203, v150, v151
  v_mfma_f32_16x16x32_bf16 v[180:183], v[68:71], a[128:131], 0
  buffer_store_dwordx4 v[200:203], v2, s[40:43], s62 offen offset:2048 sc1
  v_mfma_f32_16x16x32_bf16 v[180:183], v[76:79], a[132:135], v[180:183]
  v_cvt_pk_bf16_f32 v204, v152, v153
  v_cvt_pk_bf16_f32 v205, v154, v155
  v_mfma_f32_16x16x32_bf16 v[180:183], v[84:87], a[136:139], v[180:183]
  v_cvt_pk_bf16_f32 v206, v156, v157
  v_cvt_pk_bf16_f32 v207, v158, v159
  v_mfma_f32_16x16x32_bf16 v[180:183], v[92:95], a[140:143], v[180:183]
  buffer_store_dwordx4 v[204:207], v2, s[40:43], s62 offen offset:3072 sc1
  v_mfma_f32_16x16x32_bf16 v[184:187], v[64:67], a[192:195], 0
  v_mfma_f32_16x16x32_bf16 v[184:187], v[72:75], a[196:199], v[184:187]
  v_mfma_f32_16x16x32_bf16 v[184:187], v[80:83], a[200:203], v[184:187]
  v_mfma_f32_16x16x32_bf16 v[184:187], v[88:91], a[204:207], v[184:187]
  v_mfma_f32_16x16x32_bf16 v[188:191], v[68:71], a[192:195], 0
  v_mfma_f32_16x16x32_bf16 v[188:191], v[76:79], a[196:199], v[188:191]
  v_mfma_f32_16x16x32_bf16 v[188:191], v[84:87], a[200:203], v[188:191]
  v_mfma_f32_16x16x32_bf16 v[188:191], v[92:95], a[204:207], v[188:191]
  s_waitcnt lgkmcnt(0)
  v_mfma_f32_16x16x32_bf16 v[160:163], v[96:99], a[16:19], v[160:163]
  v_mfma_f32_16x16x32_bf16 v[160:163], v[104:107], a[20:23], v[160:163]
  v_mfma_f32_16x16x32_bf16 v[160:163], v[112:115], a[24:27], v[160:163]
  ds_read_b128 v[64:67], v16 offset:512
  v_mfma_f32_16x16x32_bf16 v[160:163], v[120:123], a[28:31], v[160:163]
  v_mfma_f32_16x16x32_bf16 v[164:167], v[100:103], a[16:19], v[164:167]
  ds_read_b128 v[68:71], v16 offset:16896
  v_mfma_f32_16x16x32_bf16 v[164:167], v[108:111], a[20:23], v[164:167]
  v_mfma_f32_16x16x32_bf16 v[164:167], v[116:119], a[24:27], v[164:167]
  ds_read_b128 v[72:75], v17 offset:512
  v_mfma_f32_16x16x32_bf16 v[164:167], v[124:127], a[28:31], v[164:167]
  v_mfma_f32_16x16x32_bf16 v[168:171], v[96:99], a[80:83], v[168:171]
  ds_read_b128 v[76:79], v17 offset:16896
  v_mfma_f32_16x16x32_bf16 v[168:171], v[104:107], a[84:87], v[168:171]
  v_mfma_f32_16x16x32_bf16 v[168:171], v[112:115], a[88:91], v[168:171]
  ds_read_b128 v[80:83], v18 offset:512
  v_mfma_f32_16x16x32_bf16 v[168:171], v[120:123], a[92:95], v[168:171]
  v_mfma_f32_16x16x32_bf16 v[172:175], v[100:103], a[80:83], v[172:175]
  ds_read_b128 v[84:87], v18 offset:16896
  v_mfma_f32_16x16x32_bf16 v[172:175], v[108:111], a[84:87], v[172:175]
  v_mfma_f32_16x16x32_bf16 v[172:175], v[116:119], a[88:91], v[172:175]
  ds_read_b128 v[88:91], v19 offset:512
  v_mfma_f32_16x16x32_bf16 v[172:175], v[124:127], a[92:95], v[172:175]
  v_mfma_f32_16x16x32_bf16 v[176:179], v[96:99], a[144:147], v[176:179]
  ds_read_b128 v[92:95], v19 offset:16896
  v_mfma_f32_16x16x32_bf16 v[176:179], v[104:107], a[148:151], v[176:179]
  v_mfma_f32_16x16x32_bf16 v[176:179], v[112:115], a[152:155], v[176:179]
  s_add_u32 s62, s62, s65
  s_cmp_eq_u32 s63, 15
  s_cselect_b32 s65, s71, 0x2000
  v_mfma_f32_16x16x32_bf16 v[176:179], v[120:123], a[156:159], v[176:179]
  s_add_u32 m0, s66, 0
  s_add_u32 s58, s61, 0
  v_mfma_f32_16x16x32_bf16 v[180:183], v[100:103], a[144:147], v[180:183]
  v_mfma_f32_16x16x32_bf16 v[180:183], v[108:111], a[148:151], v[180:183]
  buffer_load_dwordx4 v8, s[52:55], s58 offen lds
  v_mfma_f32_16x16x32_bf16 v[180:183], v[116:119], a[152:155], v[180:183]
  v_mfma_f32_16x16x32_bf16 v[180:183], v[124:127], a[156:159], v[180:183]
  s_add_u32 m0, s66, 1024
  s_add_u32 s58, s61, 1024
  v_mfma_f32_16x16x32_bf16 v[184:187], v[96:99], a[208:211], v[184:187]
  v_mfma_f32_16x16x32_bf16 v[184:187], v[104:107], a[212:215], v[184:187]
  buffer_load_dwordx4 v9, s[52:55], s58 offen lds
  v_mfma_f32_16x16x32_bf16 v[184:187], v[112:115], a[216:219], v[184:187]
  v_mfma_f32_16x16x32_bf16 v[184:187], v[120:123], a[220:223], v[184:187]
  s_add_u32 m0, s66, 2048
  s_add_u32 s58, s61, 2048
  v_mfma_f32_16x16x32_bf16 v[188:191], v[100:103], a[208:211], v[188:191]
  v_mfma_f32_16x16x32_bf16 v[188:191], v[108:111], a[212:215], v[188:191]
  buffer_load_dwordx4 v10, s[52:55], s58 offen lds
  v_mfma_f32_16x16x32_bf16 v[188:191], v[116:119], a[216:219], v[188:191]
  v_mfma_f32_16x16x32_bf16 v[188:191], v[124:127], a[220:223], v[188:191]
  s_waitcnt lgkmcnt(0)
  s_add_u32 m0, s66, 3072
  s_add_u32 s58, s61, 3072
  v_mfma_f32_16x16x32_bf16 v[160:163], v[64:67], a[32:35], v[160:163]
  v_mfma_f32_16x16x32_bf16 v[160:163], v[72:75], a[36:39], v[160:163]
  buffer_load_dwordx4 v11, s[52:55], s58 offen lds
  v_mfma_f32_16x16x32_bf16 v[160:163], v[80:83], a[40:43], v[160:163]
  ds_read_b128 v[96:99], v16 offset:768
  v_mfma_f32_16x16x32_bf16 v[160:163], v[88:91], a[44:47], v[160:163]
  s_add_u32 m0, s66, 4096
  s_add_u32 s58, s61, 4096
  v_mfma_f32_16x16x32_bf16 v[164:167], v[68:71], a[32:35], v[164:167]
  ds_read_b128 v[100:103], v16 offset:17152
  v_mfma_f32_16x16x32_bf16 v[164:167], v[76:79], a[36:39], v[164:167]
  buffer_load_dwordx4 v12, s[52:55], s58 offen lds
  v_mfma_f32_16x16x32_bf16 v[164:167], v[84:87], a[40:43], v[164:167]
  ds_read_b128 v[104:107], v17 offset:768
  v_mfma_f32_16x16x32_bf16 v[164:167], v[92:95], a[44:47], v[164:167]
  s_add_u32 m0, s66, 5120
  s_add_u32 s58, s61, 5120
  v_mfma_f32_16x16x32_bf16 v[168:171], v[64:67], a[96:99], v[168:171]
  ds_read_b128 v[108:111], v17 offset:17152
  v_mfma_f32_16x16x32_bf16 v[168:171], v[72:75], a[100:103], v[168:171]
  buffer_load_dwordx4 v13, s[52:55], s58 offen lds
  v_mfma_f32_16x16x32_bf16 v[168:171], v[80:83], a[104:107], v[168:171]
  ds_read_b128 v[112:115], v18 offset:768
  v_mfma_f32_16x16x32_bf16 v[168:171], v[88:91], a[108:111], v[168:171]
  s_add_u32 m0, s66, 6144
  s_add_u32 s58, s61, 6144
  v_mfma_f32_16x16x32_bf16 v[172:175], v[68:71], a[96:99], v[172:175]
  ds_read_b128 v[116:119], v18 offset:17152
  v_mfma_f32_16x16x32_bf16 v[172:175], v[76:79], a[100:103], v[172:175]
  buffer_load_dwordx4 v14, s[52:55], s58 offen lds
  v_mfma_f32_16x16x32_bf16 v[172:175], v[84:87], a[104:107], v[172:175]
  ds_read_b128 v[120:123], v19 offset:768
  v_mfma_f32_16x16x32_bf16 v[172:175], v[92:95], a[108:111], v[172:175]
  s_add_u32 m0, s66, 7168
  s_add_u32 s58, s61, 7168
  v_mfma_f32_16x16x32_bf16 v[176:179], v[64:67], a[160:163], v[176:179]
  ds_read_b128 v[124:127], v19 offset:17152
  v_mfma_f32_16x16x32_bf16 v[176:179], v[72:75], a[164:167], v[176:179]
  buffer_load_dwordx4 v15, s[52:55], s58 offen lds
  v_mfma_f32_16x16x32_bf16 v[176:179], v[80:83], a[168:171], v[176:179]
  v_mfma_f32_16x16x32_bf16 v[176:179], v[88:91], a[172:175], v[176:179]
  s_cmp_eq_u32 s63, 12
  s_cselect_b32 s59, s70, 0
  s_add_u32 s61, s61, s59
  v_mfma_f32_16x16x32_bf16 v[180:183], v[68:71], a[160:163], v[180:183]
  v_add_u32 v16, 0x8000, v16
  v_mfma_f32_16x16x32_bf16 v[180:183], v[76:79], a[164:167], v[180:183]
  s_add_u32 s61, s61, 0x8000
  v_and_b32 v16, 0x1ffff, v16
  v_mfma_f32_16x16x32_bf16 v[180:183], v[84:87], a[168:171], v[180:183]
  s_add_u32 s66, s66, 0x8000
  v_add_u32 v17, 0x8000, v17
  v_mfma_f32_16x16x32_bf16 v[180:183], v[92:95], a[172:175], v[180:183]
  s_and_b32 s66, s66, 0x1ffff
  v_and_b32 v17, 0x1ffff, v17
  v_mfma_f32_16x16x32_bf16 v[184:187], v[64:67], a[224:227], v[184:187]
  v_add_u32 v18, 0x8000, v18
  v_mfma_f32_16x16x32_bf16 v[184:187], v[72:75], a[228:231], v[184:187]
  v_and_b32 v18, 0x1ffff, v18
  v_mfma_f32_16x16x32_bf16 v[184:187], v[80:83], a[232:235], v[184:187]
  v_add_u32 v19, 0x8000, v19
  v_mfma_f32_16x16x32_bf16 v[184:187], v[88:91], a[236:239], v[184:187]
  v_and_b32 v19, 0x1ffff, v19
  v_mfma_f32_16x16x32_bf16 v[188:191], v[68:71], a[224:227], v[188:191]
  s_sub_u32 s59, s63, 1
  s_max_i32 s59, s59, 0
  v_mfma_f32_16x16x32_bf16 v[188:191], v[76:79], a[228:231], v[188:191]
  v_mov_b32 v7, s59
  v_mfma_f32_16x16x32_bf16 v[188:191], v[84:87], a[232:235], v[188:191]
  v_mfma_f32_16x16x32_bf16 v[188:191], v[92:95], a[236:239], v[188:191]
  s_waitcnt lgkmcnt(0)
  v_mfma_f32_16x16x32_bf16 v[160:163], v[96:99], a[48:51], v[160:163]
  s_waitcnt vmcnt(20)
  v_mfma_f32_16x16x32_bf16 v[160:163], v[104:107], a[52:55], v[160:163]
  s_barrier
  v_mfma_f32_16x16x32_bf16 v[160:163], v[112:115], a[56:59], v[160:163]
  ds_read_b128 v[64:67], v16 offset:0
  v_mfma_f32_16x16x32_bf16 v[160:163], v[120:123], a[60:63], v[160:163]
  buffer_store_dword v7, v6, s[40:43], s64 offen sc1
  v_mfma_f32_16x16x32_bf16 v[164:167], v[100:103], a[48:51], v[164:167]
  ds_read_b128 v[68:71], v16 offset:16384
  v_mfma_f32_16x16x32_bf16 v[164:167], v[108:111], a[52:55], v[164:167]
  v_mfma_f32_16x16x32_bf16 v[164:167], v[116:119], a[56:59], v[164:167]
  ds_read_b128 v[72:75], v17 offset:0
  v_mfma_f32_16x16x32_bf16 v[164:167], v[124:127], a[60:63], v[164:167]
  v_mfma_f32_16x16x32_bf16 v[168:171], v[96:99], a[112:115], v[168:171]
  ds_read_b128 v[76:79], v17 offset:16384
  v_mfma_f32_16x16x32_bf16 v[168:171], v[104:107], a[116:119], v[168:171]
  v_mfma_f32_16x16x32_bf16 v[168:171], v[112:115], a[120:123], v[168:171]
  ds_read_b128 v[80:83], v18 offset:0
  v_mfma_f32_16x16x32_bf16 v[168:171], v[120:123], a[124:127], v[168:171]
  v_mfma_f32_16x16x32_bf16 v[172:175], v[100:103], a[112:115], v[172:175]
  ds_read_b128 v[84:87], v18 offset:16384
  v_mfma_f32_16x16x32_bf16 v[172:175], v[108:111], a[116:119], v[172:175]
  v_mfma_f32_16x16x32_bf16 v[172:175], v[116:119], a[120:123], v[172:175]
  ds_read_b128 v[88:91], v19 offset:0
  v_mfma_f32_16x16x32_bf16 v[172:175], v[124:127], a[124:127], v[172:175]
  v_mfma_f32_16x16x32_bf16 v[176:179], v[96:99], a[176:179], v[176:179]
  ds_read_b128 v[92:95], v19 offset:16384
  v_mfma_f32_16x16x32_bf16 v[176:179], v[104:107], a[180:183], v[176:179]
  v_mfma_f32_16x16x32_bf16 v[176:179], v[112:115], a[184:187], v[176:179]
  v_mfma_f32_16x16x32_bf16 v[176:179], v[120:123], a[188:191], v[176:179]
  v_mfma_f32_16x16x32_bf16 v[180:183], v[100:103], a[176:179], v[180:183]
  v_mfma_f32_16x16x32_bf16 v[180:183], v[108:111], a[180:183], v[180:183]
  v_mfma_f32_16x16x32_bf16 v[180:183], v[116:119], a[184:187], v[180:183]
  v_mfma_f32_16x16x32_bf16 v[180:183], v[124:127], a[188:191], v[180:183]
  v_mfma_f32_16x16x32_bf16 v[184:187], v[96:99], a[240:243], v[184:187]
  s_add_u32 s63, s63, 1
  v_mfma_f32_16x16x32_bf16 v[184:187], v[104:107], a[244:247], v[184:187]
  v_mfma_f32_16x16x32_bf16 v[184:187], v[112:115], a[248:251], v[184:187]
  v_mfma_f32_16x16x32_bf16 v[184:187], v[120:123], a[252:255], v[184:187]
  v_mfma_f32_16x16x32_bf16 v[188:191], v[100:103], a[240:243], v[188:191]
  v_mfma_f32_16x16x32_bf16 v[188:191], v[108:111], a[244:247], v[188:191]
  v_mfma_f32_16x16x32_bf16 v[188:191], v[116:119], a[248:251], v[188:191]
  s_cmp_lt_u32 s63, s67
  v_mfma_f32_16x16x32_bf16 v[188:191], v[124:127], a[252:255], v[188:191]
  s_waitcnt lgkmcnt(0)
  s_cbranch_scc1 L_f_10
  s_branch L_f_done
L_f_done:
  s_nop 7
  v_mul_f32 v160, s69, v160
  v_mul_f32 v161, s69, v161
  v_mul_f32 v162, s69, v162
  v_mul_f32 v163, s69, v163
  v_mul_f32 v164, s69, v164
  v_mul_f32 v165, s69, v165
  v_mul_f32 v166, s69, v166
  v_mul_f32 v167, s69, v167
  v_cvt_pk_bf16_f32 v192, v160, v161
  v_cvt_pk_bf16_f32 v193, v162, v163
  v_cvt_pk_bf16_f32 v194, v164, v165
  v_cvt_pk_bf16_f32 v195, v166, v167
  buffer_store_dwordx4 v[192:195], v2, s[40:43], s62 offen offset:0 sc1
  v_mul_f32 v168, s69, v168
  v_mul_f32 v169, s69, v169
  v_mul_f32 v170, s69, v170
  v_mul_f32 v171, s69, v171
  v_mul_f32 v172, s69, v172
  v_mul_f32 v173, s69, v173
  v_mul_f32 v174, s69, v174
  v_mul_f32 v175, s69, v175
  v_cvt_pk_bf16_f32 v196, v168, v169
  v_cvt_pk_bf16_f32 v197, v170, v171
  v_cvt_pk_bf16_f32 v198, v172, v173
  v_cvt_pk_bf16_f32 v199, v174, v175
  buffer_store_dwordx4 v[196:199], v2, s[40:43], s62 offen offset:1024 sc1
  v_mul_f32 v176, s69, v176
  v_mul_f32 v177, s69, v177
  v_mul_f32 v178, s69, v178
  v_mul_f32 v179, s69, v179
  v_mul_f32 v180, s69, v180
  v_mul_f32 v181, s69, v181
  v_mul_f32 v182, s69, v182
  v_mul_f32 v183, s69, v183
  v_cvt_pk_bf16_f32 v200, v176, v177
  v_cvt_pk_bf16_f32 v201, v178, v179
  v_cvt_pk_bf16_f32 v202, v180, v181
  v_cvt_pk_bf16_f32 v203, v182, v183
  buffer_store_dwordx4 v[200:203], v2, s[40:43], s62 offen offset:2048 sc1
  v_mul_f32 v184, s69, v184
  v_mul_f32 v185, s69, v185
  v_mul_f32 v186, s69, v186
  v_mul_f32 v187, s69, v187
  v_mul_f32 v188, s69, v188
  v_mul_f32 v189, s69, v189
  v_mul_f32 v190, s69, v190
  v_mul_f32 v191, s69, v191
  v_cvt_pk_bf16_f32 v204, v184, v185
  v_cvt_pk_bf16_f32 v205, v186, v187
  v_cvt_pk_bf16_f32 v206, v188, v189
  v_cvt_pk_bf16_f32 v207, v190, v191
  buffer_store_dwordx4 v[204:207], v2, s[40:43], s62 offen offset:3072 sc1
  v_mov_b32 v7, s67
  s_waitcnt vmcnt(0) lgkmcnt(0)
  s_barrier
  buffer_store_dword v7, v6, s[40:43], s64 offen sc1
  s_branch L_next
L_after_p:
  s_waitcnt vmcnt(0)
  s_endpgm
L_team:
  s_mov_b32 s67, 0
  v_lshrrev_b32 v20, 4, v0
  v_and_b32 v21, 15, v0
  s_lshl_b32 s68, s44, 11
  s_add_u32 s68, s68, 131072
  v_lshl_add_u32 v2, v0, 4, s68
  v_add_u32 v11, 24576, v2
  s_mov_b32 s73, s68
  s_lshl_b32 s68, s44, 12
  v_lshl_add_u32 v3, v0, 4, s68
  s_lshl_b32 s68, s44, 9
  s_add_u32 s68, s68, 131072
  v_bfe_u32 v22, v0, 3, 1
  v_lshl_add_u32 v5, v22, 8, s68
  v_lshl_add_u32 v5, v20, 6, v5
  v_and_b32 v22, 7, v0
  v_lshl_add_u32 v5, v22, 3, v5
  v_lshrrev_b32 v22, 5, v0
  v_lshlrev_b32 v6, 8, v22
  v_and_b32 v22, 3, v0
  v_lshl_add_u32 v6, v22, 6, v6
  v_bfe_u32 v22, v0, 2, 3
  v_lshl_add_u32 v6, v22, 3, v6
  v_add_u32 v6, 131072, v6
  s_lshl_b32 s68, s44, 9
  s_add_u32 s68, s68, 131072
  v_lshrrev_b32 v22, 1, v0
  v_lshl_add_u32 v7, v22, 4, s68
  s_lshl_b32 s68, s44, 14
  s_lshl_b32 s69, s45, 6
  s_add_u32 s68, s68, s69
  v_lshrrev_b32 v22, 3, v0
  v_lshl_add_u32 v8, v22, 11, s68
  v_and_b32 v22, 7, v0
  v_lshl_add_u32 v8, v22, 3, v8
  v_lshlrev_b32 v9, 8, v20
  v_bfe_u32 v22, v0, 2, 1
  v_lshl_add_u32 v9, v22, 7, v9
  v_and_b32 v22, 1, v0
  v_lshl_add_u32 v9, v22, 6, v9
  v_bfe_u32 v22, v0, 3, 1
  v_lshl_add_u32 v9, v22, 5, v9
  v_bfe_u32 v22, v0, 1, 1
  v_lshl_add_u32 v9, v22, 4, v9
  s_lshl_b32 s68, s44, 16
  s_lshl_b32 s69, s45, 11
  s_add_u32 s68, s68, s69
  s_add_u32 s62, s68, 0xd000000
  v_bfe_u32 v22, v0, 3, 1
  v_lshlrev_b32 v10, 13, v22
  v_lshl_add_u32 v10, v20, 3, v10
  v_bfe_u32 v22, v0, 1, 1
  v_lshl_add_u32 v10, v22, 5, v10
  v_bfe_u32 v22, v0, 2, 1
  v_lshl_add_u32 v10, v22, 2, v10
  v_and_b32 v22, 1, v0
  v_lshl_add_u32 v10, v22, 1, v10
  s_lshl_b32 s64, s44, 11
  s_lshr_b32 s68, s45, 3
  s_lshl_b32 s68, s68, 9
  s_add_u32 s64, s64, s68
  s_and_b32 s68, s45, 1
  s_lshl_b32 s68, s68, 8
  s_add_u32 s64, s64, s68
  s_bfe_u32 s68, s45, 0x20001
  s_lshl_b32 s68, s68, 6
  s_add_u32 s64, s64, s68
  s_add_u32 s64, s64, 0xd040000
  s_mov_b32 s63, 0xd01c000
  s_lshl_b32 s60, s45, 7
  s_add_u32 s60, s60, 0xd081000
  s_lshl_b32 s72, s45, 19
  s_add_u32 s72, s72, 0x3fe0000
  s_mov_b32 s94, 0xaaaaaaaa
  s_mov_b32 s95, 0xaaaaaaaa
  v_mov_b32 v17, 0
  v_mov_b32 v18, 0
  v_mov_b32 v16, 0
  v_mov_b32 v12, 0x3f803f80
  v_mov_b32 v13, 0x3f803f80
  v_mov_b32 v14, 0x3f803f80
  v_mov_b32 v15, 0x3f803f80
  s_mov_b32 s78, 0xff00ff00
  s_mov_b32 s79, 0xff00ff00
  s_mov_b32 s88, 0x3e0293ee
  s_mov_b32 s89, 0x21800000
  s_mov_b32 s91, 0x3c000000
  s_mov_b32 s90, 0xfffe
  s_lshl_b32 s68, s44, 11
  s_add_u32 s70, s68, 147456
  s_add_u32 s71, s68, 139264
  s_lshl_b32 s68, s45, 7
  s_add_u32 s68, s68, 0xd084000
  s_cmp_eq_u32 s44, 0
  s_cselect_b32 s66, s68, 0x40000000
  s_mov_b32 s80, 0x3030303
  s_mov_b32 s81, 0x3030303
  s_mov_b32 s74, 0xd000000
  s_mov_b32 s82, 0xc0c0c0c
  s_mov_b32 s83, 0xc0c0c0c
  s_mov_b32 s75, 0xd010000
  s_mov_b32 s84, 0x30303030
  s_mov_b32 s85, 0x30303030
  s_mov_b32 s76, 0xd020000
  s_mov_b32 s86, 0xc0c0c0c0
  s_mov_b32 s87, 0xc0c0c0c0
  s_mov_b32 s77, 0xd030000
  buffer_store_dwordx2 v[16:17], v8, s[40:43], s74 offen sc1
  buffer_store_dwordx2 v[16:17], v8, s[40:43], s75 offen sc1
  buffer_store_dwordx2 v[16:17], v8, s[40:43], s76 offen sc1
  buffer_store_dwordx2 v[16:17], v8, s[40:43], s77 offen sc1
  v_mov_b32 v22, 0xffff
  buffer_store_short v22, v10, s[40:43], s64 offen sc1
  s_mul_i32 s68, s44, 4
  s_lshr_b32 s68, 0x7640, s68
  s_and_b32 s68, s68, 15
  s_lshl_b32 s68, s68, 12
  s_lshl_b32 s69, s45, 7
  s_add_u32 s68, s68, s69
  s_add_u32 s68, s68, 0xd080000
  v_and_b32 v23, 31, v0
  v_lshlrev_b32 v23, 2, v23
  v_lshrrev_b32 v24, 5, v0
  v_lshl_add_u32 v23, v24, 12, v23
  buffer_store_dword v17, v23, s[40:43], s68 offen sc1
  s_mov_b32 s52, s38
  s_and_b32 s53, s39, 0xffff
  s_mov_b32 s54, 0x100
  s_mov_b32 s55, 0x20000
  s_lshl_b32 s68, 1, s46
  v_mov_b32 v22, s68
  s_cmp_eq_u32 s44, 0
  s_cselect_b32 s69, 0, 0x40000000
  s_mov_b64 exec, 1
  buffer_atomic_or v22, v17, s[52:55], s69 offen offset:128
  s_mov_b64 exec, -1
  v_bfe_u32 v22, v0, 4, 1
  v_lshrrev_b32 v23, 5, v0
  s_lshl_b32 s68, s44, 1
  v_or_b32 v24, s68, v22
  v_lshlrev_b32 v24, 1, v24
  v_xor_b32 v24, v24, v21
  v_lshlrev_b32 v24, 4, v24
  v_lshl_add_u32 v25, v22, 4, v23
  v_add_u32 v25, s68, v25
  v_lshl_add_u32 v26, v25, 13, v24
  s_lshl_b32 s69, s45, 8
  v_add_u32 v26, s69, v26
  s_lshl_b32 s68, s44, 4
  v_add_u32 v25, s68, v20
  v_lshl_add_u32 v27, v25, 10, v24
  s_lshl_b32 s69, s45, 17
  v_add_u32 v27, s69, v27
  v_lshrrev_b32 v22, 5, v0
  v_lshlrev_b32 v28, 12, v22
  v_bfe_u32 v22, v0, 3, 1
  v_lshl_add_u32 v28, v22, 11, v28
  v_lshlrev_b32 v24, 2, v22
  v_bfe_u32 v22, v0, 4, 1
  v_lshl_add_u32 v28, v22, 10, v28
  v_lshl_add_u32 v24, v22, 1, v24
  v_bfe_u32 v22, v0, 2, 1
  v_lshl_add_u32 v28, v22, 8, v28
  v_add_u32 v24, v24, v22
  s_lshl_b32 s68, s44, 1
  v_xor_b32 v24, s68, v24
  v_lshl_add_u32 v28, v24, 5, v28
  v_and_b32 v22, 3, v0
  v_lshl_add_u32 v28, v22, 3, v28
  v_xor_b32 v29, 32, v28
  v_bfe_u32 v22, v0, 3, 1
  v_mul_u32_u24 v22, 2208, v22
  v_xor_b32 v32, v22, v28
  v_xor_b32 v33, 2176, v32
  s_mov_b32 s50, 0x400000
  s_mov_b32 s51, 0x20000
  s_lshl_b32 s56, s44, 10
  s_mov_b32 s48, s30
  s_and_b32 s49, s31, 0xffff
  s_add_u32 m0, s56, 0
  s_mov_b32 s68, 0
  buffer_load_dwordx4 v27, s[48:51], s68 offen  lds
  s_add_u32 m0, s56, 4096
  s_mov_b32 s68, 4096
  buffer_load_dwordx4 v27, s[48:51], s68 offen  lds
  s_add_u32 m0, s56, 8192
  s_mov_b32 s68, 8192
  buffer_load_dwordx4 v27, s[48:51], s68 offen  lds
  s_add_u32 m0, s56, 12288
  s_mov_b32 s68, 12288
  buffer_load_dwordx4 v27, s[48:51], s68 offen  lds
  s_add_u32 m0, s56, 16384
  s_mov_b32 s68, 65536
  buffer_load_dwordx4 v27, s[48:51], s68 offen  lds
  s_add_u32 m0, s56, 20480
  s_mov_b32 s68, 69632
  buffer_load_dwordx4 v27, s[48:51], s68 offen  lds
  s_add_u32 m0, s56, 24576
  s_mov_b32 s68, 73728
  buffer_load_dwordx4 v27, s[48:51], s68 offen  lds
  s_add_u32 m0, s56, 28672
  s_mov_b32 s68, 77824
  buffer_load_dwordx4 v27, s[48:51], s68 offen  lds
  s_add_u32 m0, s56, 32768
  s_mov_b32 s68, 256
  buffer_load_dwordx4 v27, s[48:51], s68 offen  lds
  s_add_u32 m0, s56, 36864
  s_mov_b32 s68, 4352
  buffer_load_dwordx4 v27, s[48:51], s68 offen  lds
  s_add_u32 m0, s56, 40960
  s_mov_b32 s68, 8448
  buffer_load_dwordx4 v27, s[48:51], s68 offen  lds
  s_add_u32 m0, s56, 45056
  s_mov_b32 s68, 12544
  buffer_load_dwordx4 v27, s[48:51], s68 offen  lds
  s_add_u32 m0, s56, 49152
  s_mov_b32 s68, 65792
  buffer_load_dwordx4 v27, s[48:51], s68 offen  lds
  s_add_u32 m0, s56, 53248
  s_mov_b32 s68, 69888
  buffer_load_dwordx4 v27, s[48:51], s68 offen  lds
  s_add_u32 m0, s56, 57344
  s_mov_b32 s68, 73984
  buffer_load_dwordx4 v27, s[48:51], s68 offen  lds
  s_add_u32 m0, s56, 61440
  s_mov_b32 s68, 78080
  buffer_load_dwordx4 v27, s[48:51], s68 offen  lds
  s_add_u32 m0, s56, 65536
  s_mov_b32 s68, 512
  buffer_load_dwordx4 v27, s[48:51], s68 offen  lds
  s_add_u32 m0, s56, 69632
  s_mov_b32 s68, 4608
  buffer_load_dwordx4 v27, s[48:51], s68 offen  lds
  s_add_u32 m0, s56, 73728
  s_mov_b32 s68, 8704
  buffer_load_dwordx4 v27, s[48:51], s68 offen  lds
  s_add_u32 m0, s56, 77824
  s_mov_b32 s68, 12800
  buffer_load_dwordx4 v27, s[48:51], s68 offen  lds
  s_add_u32 m0, s56, 81920
  s_mov_b32 s68, 66048
  buffer_load_dwordx4 v27, s[48:51], s68 offen  lds
  s_add_u32 m0, s56, 86016
  s_mov_b32 s68, 70144
  buffer_load_dwordx4 v27, s[48:51], s68 offen  lds
  s_add_u32 m0, s56, 90112
  s_mov_b32 s68, 74240
  buffer_load_dwordx4 v27, s[48:51], s68 offen  lds
  s_add_u32 m0, s56, 94208
  s_mov_b32 s68, 78336
  buffer_load_dwordx4 v27, s[48:51], s68 offen  lds
  s_add_u32 m0, s56, 98304
  s_mov_b32 s68, 768
  buffer_load_dwordx4 v27, s[48:51], s68 offen  lds
  s_add_u32 m0, s56, 102400
  s_mov_b32 s68, 4864
  buffer_load_dwordx4 v27, s[48:51], s68 offen  lds
  s_add_u32 m0, s56, 106496
  s_mov_b32 s68, 8960
  buffer_load_dwordx4 v27, s[48:51], s68 offen  lds
  s_add_u32 m0, s56, 110592
  s_mov_b32 s68, 13056
  buffer_load_dwordx4 v27, s[48:51], s68 offen  lds
  s_waitcnt vmcnt(24)
  s_barrier
  v_mov_b32 v22, 1
  s_cmp_eq_u32 s44, 0
  s_cselect_b32 s69, 0, 0x40000000
  s_mov_b64 exec, 1
  buffer_atomic_add v22, v17, s[52:55], s69 offen
  s_mov_b64 exec, -1
  s_add_u32 m0, s56, 114688
  s_mov_b32 s68, 66304
  buffer_load_dwordx4 v27, s[48:51], s68 offen  lds
  s_add_u32 m0, s56, 118784
  s_mov_b32 s68, 70400
  buffer_load_dwordx4 v27, s[48:51], s68 offen  lds
  s_add_u32 m0, s56, 122880
  s_mov_b32 s68, 74496
  buffer_load_dwordx4 v27, s[48:51], s68 offen  lds
  s_add_u32 m0, s56, 126976
  s_mov_b32 s68, 78592
  buffer_load_dwordx4 v27, s[48:51], s68 offen  lds
  v_add_u32 v30, 0, v32
  v_add_u32 v31, 0, v33
  s_cmp_lg_u32 s44, 0
  s_cbranch_scc1 L_wr_0_1
  ds_read_b64_tr_b16 v[128:129], v30 offset:0
  ds_read_b64_tr_b16 v[130:131], v30 offset:512
  ds_read_b64_tr_b16 v[132:133], v30 offset:8192
  ds_read_b64_tr_b16 v[134:135], v30 offset:8704
  ds_read_b64_tr_b16 v[136:137], v31 offset:0
  ds_read_b64_tr_b16 v[138:139], v31 offset:512
  ds_read_b64_tr_b16 v[140:141], v31 offset:8192
  ds_read_b64_tr_b16 v[142:143], v31 offset:8704
  s_branch L_wr_0_e
L_wr_0_1:
  s_cmp_lg_u32 s44, 1
  s_cbranch_scc1 L_wr_0_2
  ds_read_b64_tr_b16 v[136:137], v30 offset:0
  ds_read_b64_tr_b16 v[138:139], v30 offset:512
  ds_read_b64_tr_b16 v[140:141], v30 offset:8192
  ds_read_b64_tr_b16 v[142:143], v30 offset:8704
  ds_read_b64_tr_b16 v[128:129], v31 offset:0
  ds_read_b64_tr_b16 v[130:131], v31 offset:512
  ds_read_b64_tr_b16 v[132:133], v31 offset:8192
  ds_read_b64_tr_b16 v[134:135], v31 offset:8704
  s_branch L_wr_0_e
L_wr_0_2:
  s_cmp_lg_u32 s44, 2
  s_cbranch_scc1 L_wr_0_3
  ds_read_b64_tr_b16 v[144:145], v30 offset:0
  ds_read_b64_tr_b16 v[146:147], v30 offset:512
  ds_read_b64_tr_b16 v[148:149], v30 offset:8192
  ds_read_b64_tr_b16 v[150:151], v30 offset:8704
  ds_read_b64_tr_b16 v[152:153], v31 offset:0
  ds_read_b64_tr_b16 v[154:155], v31 offset:512
  ds_read_b64_tr_b16 v[156:157], v31 offset:8192
  ds_read_b64_tr_b16 v[158:159], v31 offset:8704
  s_branch L_wr_0_e
L_wr_0_3:
  ds_read_b64_tr_b16 v[152:153], v30 offset:0
  ds_read_b64_tr_b16 v[154:155], v30 offset:512
  ds_read_b64_tr_b16 v[156:157], v30 offset:8192
  ds_read_b64_tr_b16 v[158:159], v30 offset:8704
  ds_read_b64_tr_b16 v[144:145], v31 offset:0
  ds_read_b64_tr_b16 v[146:147], v31 offset:512
  ds_read_b64_tr_b16 v[148:149], v31 offset:8192
  ds_read_b64_tr_b16 v[150:151], v31 offset:8704
L_wr_0_e:
  s_waitcnt lgkmcnt(0)
  s_waitcnt vmcnt(24)
  s_barrier
  s_mov_b32 s48, s24
  s_and_b32 s49, s25, 0xffff
  s_add_u32 m0, s56, 0
  s_mov_b32 s68, 0
  buffer_load_dwordx4 v26, s[48:51], s68 offen  lds
  s_add_u32 m0, s56, 4096
  s_mov_b32 s68, 65536
  buffer_load_dwordx4 v26, s[48:51], s68 offen  lds
  s_add_u32 m0, s56, 8192
  s_mov_b32 s68, 262144
  buffer_load_dwordx4 v26, s[48:51], s68 offen  lds
  s_add_u32 m0, s56, 12288
  s_mov_b32 s68, 327680
  buffer_load_dwordx4 v26, s[48:51], s68 offen  lds
  v_add_u32 v30, 16384, v32
  v_add_u32 v31, 16384, v33
  s_cmp_lg_u32 s44, 0
  s_cbranch_scc1 L_wr_1_1
  ds_read_b64_tr_b16 v[144:145], v30 offset:0
  ds_read_b64_tr_b16 v[146:147], v30 offset:512
  ds_read_b64_tr_b16 v[148:149], v30 offset:8192
  ds_read_b64_tr_b16 v[150:151], v30 offset:8704
  ds_read_b64_tr_b16 v[152:153], v31 offset:0
  ds_read_b64_tr_b16 v[154:155], v31 offset:512
  ds_read_b64_tr_b16 v[156:157], v31 offset:8192
  ds_read_b64_tr_b16 v[158:159], v31 offset:8704
  s_branch L_wr_1_e
L_wr_1_1:
  s_cmp_lg_u32 s44, 1
  s_cbranch_scc1 L_wr_1_2
  ds_read_b64_tr_b16 v[152:153], v30 offset:0
  ds_read_b64_tr_b16 v[154:155], v30 offset:512
  ds_read_b64_tr_b16 v[156:157], v30 offset:8192
  ds_read_b64_tr_b16 v[158:159], v30 offset:8704
  ds_read_b64_tr_b16 v[144:145], v31 offset:0
  ds_read_b64_tr_b16 v[146:147], v31 offset:512
  ds_read_b64_tr_b16 v[148:149], v31 offset:8192
  ds_read_b64_tr_b16 v[150:151], v31 offset:8704
  s_branch L_wr_1_e
L_wr_1_2:
  s_cmp_lg_u32 s44, 2
  s_cbranch_scc1 L_wr_1_3
  ds_read_b64_tr_b16 v[128:129], v30 offset:0
  ds_read_b64_tr_b16 v[130:131], v30 offset:512
  ds_read_b64_tr_b16 v[132:133], v30 offset:8192
  ds_read_b64_tr_b16 v[134:135], v30 offset:8704
  ds_read_b64_tr_b16 v[136:137], v31 offset:0
  ds_read_b64_tr_b16 v[138:139], v31 offset:512
  ds_read_b64_tr_b16 v[140:141], v31 offset:8192
  ds_read_b64_tr_b16 v[142:143], v31 offset:8704
  s_branch L_wr_1_e
L_wr_1_3:
  ds_read_b64_tr_b16 v[136:137], v30 offset:0
  ds_read_b64_tr_b16 v[138:139], v30 offset:512
  ds_read_b64_tr_b16 v[140:141], v30 offset:8192
  ds_read_b64_tr_b16 v[142:143], v30 offset:8704
  ds_read_b64_tr_b16 v[128:129], v31 offset:0
  ds_read_b64_tr_b16 v[130:131], v31 offset:512
  ds_read_b64_tr_b16 v[132:133], v31 offset:8192
  ds_read_b64_tr_b16 v[134:135], v31 offset:8704
L_wr_1_e:
  s_waitcnt lgkmcnt(0)
  s_waitcnt vmcnt(24)
  s_barrier
  s_add_u32 m0, s56, 16384
  s_mov_b32 s68, 524288
  buffer_load_dwordx4 v26, s[48:51], s68 offen  lds
  s_add_u32 m0, s56, 20480
  s_mov_b32 s68, 589824
  buffer_load_dwordx4 v26, s[48:51], s68 offen  lds
  s_add_u32 m0, s56, 24576
  s_mov_b32 s68, 786432
  buffer_load_dwordx4 v26, s[48:51], s68 offen  lds
  s_add_u32 m0, s56, 28672
  s_mov_b32 s68, 851968
  buffer_load_dwordx4 v26, s[48:51], s68 offen  lds
  v_add_u32 v30, 32768, v32
  v_add_u32 v31, 32768, v33
  s_cmp_lg_u32 s44, 0
  s_cbranch_scc1 L_wr_2_1
  ds_read_b64_tr_b16 v[160:161], v30 offset:0
  ds_read_b64_tr_b16 v[162:163], v30 offset:512
  ds_read_b64_tr_b16 v[164:165], v30 offset:8192
  ds_read_b64_tr_b16 v[166:167], v30 offset:8704
  ds_read_b64_tr_b16 v[168:169], v31 offset:0
  ds_read_b64_tr_b16 v[170:171], v31 offset:512
  ds_read_b64_tr_b16 v[172:173], v31 offset:8192
  ds_read_b64_tr_b16 v[174:175], v31 offset:8704
  s_branch L_wr_2_e
L_wr_2_1:
  s_cmp_lg_u32 s44, 1
  s_cbranch_scc1 L_wr_2_2
  ds_read_b64_tr_b16 v[168:169], v30 offset:0
  ds_read_b64_tr_b16 v[170:171], v30 offset:512
  ds_read_b64_tr_b16 v[172:173], v30 offset:8192
  ds_read_b64_tr_b16 v[174:175], v30 offset:8704
  ds_read_b64_tr_b16 v[160:161], v31 offset:0
  ds_read_b64_tr_b16 v[162:163], v31 offset:512
  ds_read_b64_tr_b16 v[164:165], v31 offset:8192
  ds_read_b64_tr_b16 v[166:167], v31 offset:8704
  s_branch L_wr_2_e
L_wr_2_2:
  s_cmp_lg_u32 s44, 2
  s_cbranch_scc1 L_wr_2_3
  ds_read_b64_tr_b16 v[176:177], v30 offset:0
  ds_read_b64_tr_b16 v[178:179], v30 offset:512
  ds_read_b64_tr_b16 v[180:181], v30 offset:8192
  ds_read_b64_tr_b16 v[182:183], v30 offset:8704
  ds_read_b64_tr_b16 v[184:185], v31 offset:0
  ds_read_b64_tr_b16 v[186:187], v31 offset:512
  ds_read_b64_tr_b16 v[188:189], v31 offset:8192
  ds_read_b64_tr_b16 v[190:191], v31 offset:8704
  s_branch L_wr_2_e
L_wr_2_3:
  ds_read_b64_tr_b16 v[184:185], v30 offset:0
  ds_read_b64_tr_b16 v[186:187], v30 offset:512
  ds_read_b64_tr_b16 v[188:189], v30 offset:8192
  ds_read_b64_tr_b16 v[190:191], v30 offset:8704
  ds_read_b64_tr_b16 v[176:177], v31 offset:0
  ds_read_b64_tr_b16 v[178:179], v31 offset:512
  ds_read_b64_tr_b16 v[180:181], v31 offset:8192
  ds_read_b64_tr_b16 v[182:183], v31 offset:8704
L_wr_2_e:
  s_waitcnt lgkmcnt(0)
  s_waitcnt vmcnt(24)
  s_barrier
  s_add_u32 m0, s56, 32768
  s_mov_b32 s68, 1048576
  buffer_load_dwordx4 v26, s[48:51], s68 offen  lds
  s_add_u32 m0, s56, 36864
  s_mov_b32 s68, 1114112
  buffer_load_dwordx4 v26, s[48:51], s68 offen  lds
  s_add_u32 m0, s56, 40960
  s_mov_b32 s68, 1310720
  buffer_load_dwordx4 v26, s[48:51], s68 offen  lds
  s_add_u32 m0, s56, 45056
  s_mov_b32 s68, 1376256
  buffer_load_dwordx4 v26, s[48:51], s68 offen  lds
  v_add_u32 v30, 49152, v32
  v_add_u32 v31, 49152, v33
  s_cmp_lg_u32 s44, 0
  s_cbranch_scc1 L_wr_3_1
  ds_read_b64_tr_b16 v[176:177], v30 offset:0
  ds_read_b64_tr_b16 v[178:179], v30 offset:512
  ds_read_b64_tr_b16 v[180:181], v30 offset:8192
  ds_read_b64_tr_b16 v[182:183], v30 offset:8704
  ds_read_b64_tr_b16 v[184:185], v31 offset:0
  ds_read_b64_tr_b16 v[186:187], v31 offset:512
  ds_read_b64_tr_b16 v[188:189], v31 offset:8192
  ds_read_b64_tr_b16 v[190:191], v31 offset:8704
  s_branch L_wr_3_e
L_wr_3_1:
  s_cmp_lg_u32 s44, 1
  s_cbranch_scc1 L_wr_3_2
  ds_read_b64_tr_b16 v[184:185], v30 offset:0
  ds_read_b64_tr_b16 v[186:187], v30 offset:512
  ds_read_b64_tr_b16 v[188:189], v30 offset:8192
  ds_read_b64_tr_b16 v[190:191], v30 offset:8704
  ds_read_b64_tr_b16 v[176:177], v31 offset:0
  ds_read_b64_tr_b16 v[178:179], v31 offset:512
  ds_read_b64_tr_b16 v[180:181], v31 offset:8192
  ds_read_b64_tr_b16 v[182:183], v31 offset:8704
  s_branch L_wr_3_e
L_wr_3_2:
  s_cmp_lg_u32 s44, 2
  s_cbranch_scc1 L_wr_3_3
  ds_read_b64_tr_b16 v[160:161], v30 offset:0
  ds_read_b64_tr_b16 v[162:163], v30 offset:512
  ds_read_b64_tr_b16 v[164:165], v30 offset:8192
  ds_read_b64_tr_b16 v[166:167], v30 offset:8704
  ds_read_b64_tr_b16 v[168:169], v31 offset:0
  ds_read_b64_tr_b16 v[170:171], v31 offset:512
  ds_read_b64_tr_b16 v[172:173], v31 offset:8192
  ds_read_b64_tr_b16 v[174:175], v31 offset:8704
  s_branch L_wr_3_e
L_wr_3_3:
  ds_read_b64_tr_b16 v[168:169], v30 offset:0
  ds_read_b64_tr_b16 v[170:171], v30 offset:512
  ds_read_b64_tr_b16 v[172:173], v30 offset:8192
  ds_read_b64_tr_b16 v[174:175], v30 offset:8704
  ds_read_b64_tr_b16 v[160:161], v31 offset:0
  ds_read_b64_tr_b16 v[162:163], v31 offset:512
  ds_read_b64_tr_b16 v[164:165], v31 offset:8192
  ds_read_b64_tr_b16 v[166:167], v31 offset:8704
L_wr_3_e:
  s_waitcnt lgkmcnt(0)
  s_waitcnt vmcnt(24)
  s_barrier
  s_add_u32 m0, s56, 49152
  s_mov_b32 s68, 1572864
  buffer_load_dwordx4 v26, s[48:51], s68 offen  lds
  s_add_u32 m0, s56, 53248
  s_mov_b32 s68, 1638400
  buffer_load_dwordx4 v26, s[48:51], s68 offen  lds
  s_add_u32 m0, s56, 57344
  s_mov_b32 s68, 1835008
  buffer_load_dwordx4 v26, s[48:51], s68 offen  lds
  s_add_u32 m0, s56, 61440
  s_mov_b32 s68, 1900544
  buffer_load_dwordx4 v26, s[48:51], s68 offen  lds
  v_add_u32 v30, 65536, v32
  v_add_u32 v31, 65536, v33
  s_cmp_lg_u32 s44, 0
  s_cbranch_scc1 L_wr_4_1
  ds_read_b64_tr_b16 v[192:193], v30 offset:0
  ds_read_b64_tr_b16 v[194:195], v30 offset:512
  ds_read_b64_tr_b16 v[196:197], v30 offset:8192
  ds_read_b64_tr_b16 v[198:199], v30 offset:8704
  ds_read_b64_tr_b16 v[200:201], v31 offset:0
  ds_read_b64_tr_b16 v[202:203], v31 offset:512
  ds_read_b64_tr_b16 v[204:205], v31 offset:8192
  ds_read_b64_tr_b16 v[206:207], v31 offset:8704
  s_branch L_wr_4_e
L_wr_4_1:
  s_cmp_lg_u32 s44, 1
  s_cbranch_scc1 L_wr_4_2
  ds_read_b64_tr_b16 v[200:201], v30 offset:0
  ds_read_b64_tr_b16 v[202:203], v30 offset:512
  ds_read_b64_tr_b16 v[204:205], v30 offset:8192
  ds_read_b64_tr_b16 v[206:207], v30 offset:8704
  ds_read_b64_tr_b16 v[192:193], v31 offset:0
  ds_read_b64_tr_b16 v[194:195], v31 offset:512
  ds_read_b64_tr_b16 v[196:197], v31 offset:8192
  ds_read_b64_tr_b16 v[198:199], v31 offset:8704
  s_branch L_wr_4_e
L_wr_4_2:
  s_cmp_lg_u32 s44, 2
  s_cbranch_scc1 L_wr_4_3
  ds_read_b64_tr_b16 v[208:209], v30 offset:0
  ds_read_b64_tr_b16 v[210:211], v30 offset:512
  ds_read_b64_tr_b16 v[212:213], v30 offset:8192
  ds_read_b64_tr_b16 v[214:215], v30 offset:8704
  ds_read_b64_tr_b16 v[216:217], v31 offset:0
  ds_read_b64_tr_b16 v[218:219], v31 offset:512
  ds_read_b64_tr_b16 v[220:221], v31 offset:8192
  ds_read_b64_tr_b16 v[222:223], v31 offset:8704
  s_branch L_wr_4_e
L_wr_4_3:
  ds_read_b64_tr_b16 v[216:217], v30 offset:0
  ds_read_b64_tr_b16 v[218:219], v30 offset:512
  ds_read_b64_tr_b16 v[220:221], v30 offset:8192
  ds_read_b64_tr_b16 v[222:223], v30 offset:8704
  ds_read_b64_tr_b16 v[208:209], v31 offset:0
  ds_read_b64_tr_b16 v[210:211], v31 offset:512
  ds_read_b64_tr_b16 v[212:213], v31 offset:8192
  ds_read_b64_tr_b16 v[214:215], v31 offset:8704
L_wr_4_e:
  s_waitcnt lgkmcnt(0)
  s_waitcnt vmcnt(24)
  s_barrier
  s_add_u32 m0, s56, 65536
  s_mov_b32 s68, 2097152
  buffer_load_dwordx4 v26, s[48:51], s68 offen  lds
  s_add_u32 m0, s56, 69632
  s_mov_b32 s68, 2162688
  buffer_load_dwordx4 v26, s[48:51], s68 offen  lds
  s_add_u32 m0, s56, 73728
  s_mov_b32 s68, 2359296
  buffer_load_dwordx4 v26, s[48:51], s68 offen  lds
  s_add_u32 m0, s56, 77824
  s_mov_b32 s68, 2424832
  buffer_load_dwordx4 v26, s[48:51], s68 offen  lds
  v_add_u32 v30, 81920, v32
  v_add_u32 v31, 81920, v33
  s_cmp_lg_u32 s44, 0
  s_cbranch_scc1 L_wr_5_1
  ds_read_b64_tr_b16 v[208:209], v30 offset:0
  ds_read_b64_tr_b16 v[210:211], v30 offset:512
  ds_read_b64_tr_b16 v[212:213], v30 offset:8192
  ds_read_b64_tr_b16 v[214:215], v30 offset:8704
  ds_read_b64_tr_b16 v[216:217], v31 offset:0
  ds_read_b64_tr_b16 v[218:219], v31 offset:512
  ds_read_b64_tr_b16 v[220:221], v31 offset:8192
  ds_read_b64_tr_b16 v[222:223], v31 offset:8704
  s_branch L_wr_5_e
L_wr_5_1:
  s_cmp_lg_u32 s44, 1
  s_cbranch_scc1 L_wr_5_2
  ds_read_b64_tr_b16 v[216:217], v30 offset:0
  ds_read_b64_tr_b16 v[218:219], v30 offset:512
  ds_read_b64_tr_b16 v[220:221], v30 offset:8192
  ds_read_b64_tr_b16 v[222:223], v30 offset:8704
  ds_read_b64_tr_b16 v[208:209], v31 offset:0
  ds_read_b64_tr_b16 v[210:211], v31 offset:512
  ds_read_b64_tr_b16 v[212:213], v31 offset:8192
  ds_read_b64_tr_b16 v[214:215], v31 offset:8704
  s_branch L_wr_5_e
L_wr_5_2:
  s_cmp_lg_u32 s44, 2
  s_cbranch_scc1 L_wr_5_3
  ds_read_b64_tr_b16 v[192:193], v30 offset:0
  ds_read_b64_tr_b16 v[194:195], v30 offset:512
  ds_read_b64_tr_b16 v[196:197], v30 offset:8192
  ds_read_b64_tr_b16 v[198:199], v30 offset:8704
  ds_read_b64_tr_b16 v[200:201], v31 offset:0
  ds_read_b64_tr_b16 v[202:203], v31 offset:512
  ds_read_b64_tr_b16 v[204:205], v31 offset:8192
  ds_read_b64_tr_b16 v[206:207], v31 offset:8704
  s_branch L_wr_5_e
L_wr_5_3:
  ds_read_b64_tr_b16 v[200:201], v30 offset:0
  ds_read_b64_tr_b16 v[202:203], v30 offset:512
  ds_read_b64_tr_b16 v[204:205], v30 offset:8192
  ds_read_b64_tr_b16 v[206:207], v30 offset:8704
  ds_read_b64_tr_b16 v[192:193], v31 offset:0
  ds_read_b64_tr_b16 v[194:195], v31 offset:512
  ds_read_b64_tr_b16 v[196:197], v31 offset:8192
  ds_read_b64_tr_b16 v[198:199], v31 offset:8704
L_wr_5_e:
  s_waitcnt lgkmcnt(0)
  s_waitcnt vmcnt(24)
  s_barrier
  s_add_u32 m0, s56, 81920
  s_mov_b32 s68, 2621440
  buffer_load_dwordx4 v26, s[48:51], s68 offen  lds
  s_add_u32 m0, s56, 86016
  s_mov_b32 s68, 2686976
  buffer_load_dwordx4 v26, s[48:51], s68 offen  lds
  s_add_u32 m0, s56, 90112
  s_mov_b32 s68, 2883584
  buffer_load_dwordx4 v26, s[48:51], s68 offen  lds
  s_add_u32 m0, s56, 94208
  s_mov_b32 s68, 2949120
  buffer_load_dwordx4 v26, s[48:51], s68 offen  lds
  v_add_u32 v30, 98304, v32
  v_add_u32 v31, 98304, v33
  s_cmp_lg_u32 s44, 0
  s_cbranch_scc1 L_wr_6_1
  ds_read_b64_tr_b16 v[224:225], v30 offset:0
  ds_read_b64_tr_b16 v[226:227], v30 offset:512
  ds_read_b64_tr_b16 v[228:229], v30 offset:8192
  ds_read_b64_tr_b16 v[230:231], v30 offset:8704
  ds_read_b64_tr_b16 v[232:233], v31 offset:0
  ds_read_b64_tr_b16 v[234:235], v31 offset:512
  ds_read_b64_tr_b16 v[236:237], v31 offset:8192
  ds_read_b64_tr_b16 v[238:239], v31 offset:8704
  s_branch L_wr_6_e
L_wr_6_1:
  s_cmp_lg_u32 s44, 1
  s_cbranch_scc1 L_wr_6_2
  ds_read_b64_tr_b16 v[232:233], v30 offset:0
  ds_read_b64_tr_b16 v[234:235], v30 offset:512
  ds_read_b64_tr_b16 v[236:237], v30 offset:8192
  ds_read_b64_tr_b16 v[238:239], v30 offset:8704
  ds_read_b64_tr_b16 v[224:225], v31 offset:0
  ds_read_b64_tr_b16 v[226:227], v31 offset:512
  ds_read_b64_tr_b16 v[228:229], v31 offset:8192
  ds_read_b64_tr_b16 v[230:231], v31 offset:8704
  s_branch L_wr_6_e
L_wr_6_2:
  s_cmp_lg_u32 s44, 2
  s_cbranch_scc1 L_wr_6_3
  ds_read_b64_tr_b16 v[240:241], v30 offset:0
  ds_read_b64_tr_b16 v[242:243], v30 offset:512
  ds_read_b64_tr_b16 v[244:245], v30 offset:8192
  ds_read_b64_tr_b16 v[246:247], v30 offset:8704
  ds_read_b64_tr_b16 v[248:249], v31 offset:0
  ds_read_b64_tr_b16 v[250:251], v31 offset:512
  ds_read_b64_tr_b16 v[252:253], v31 offset:8192
  ds_read_b64_tr_b16 v[254:255], v31 offset:8704
  s_branch L_wr_6_e
L_wr_6_3:
  ds_read_b64_tr_b16 v[248:249], v30 offset:0
  ds_read_b64_tr_b16 v[250:251], v30 offset:512
  ds_read_b64_tr_b16 v[252:253], v30 offset:8192
  ds_read_b64_tr_b16 v[254:255], v30 offset:8704
  ds_read_b64_tr_b16 v[240:241], v31 offset:0
  ds_read_b64_tr_b16 v[242:243], v31 offset:512
  ds_read_b64_tr_b16 v[244:245], v31 offset:8192
  ds_read_b64_tr_b16 v[246:247], v31 offset:8704
L_wr_6_e:
  s_waitcnt lgkmcnt(0)
  s_waitcnt vmcnt(24)
  s_barrier
  s_add_u32 m0, s56, 98304
  s_mov_b32 s68, 3145728
  buffer_load_dwordx4 v26, s[48:51], s68 offen  lds
  s_add_u32 m0, s56, 102400
  s_mov_b32 s68, 3211264
  buffer_load_dwordx4 v26, s[48:51], s68 offen  lds
  s_add_u32 m0, s56, 106496
  s_mov_b32 s68, 3407872
  buffer_load_dwordx4 v26, s[48:51], s68 offen  lds
  s_add_u32 m0, s56, 110592
  s_mov_b32 s68, 3473408
  buffer_load_dwordx4 v26, s[48:51], s68 offen  lds
  v_add_u32 v30, 114688, v32
  v_add_u32 v31, 114688, v33
  s_cmp_lg_u32 s44, 0
  s_cbranch_scc1 L_wr_7_1
  ds_read_b64_tr_b16 v[240:241], v30 offset:0
  ds_read_b64_tr_b16 v[242:243], v30 offset:512
  ds_read_b64_tr_b16 v[244:245], v30 offset:8192
  ds_read_b64_tr_b16 v[246:247], v30 offset:8704
  ds_read_b64_tr_b16 v[248:249], v31 offset:0
  ds_read_b64_tr_b16 v[250:251], v31 offset:512
  ds_read_b64_tr_b16 v[252:253], v31 offset:8192
  ds_read_b64_tr_b16 v[254:255], v31 offset:8704
  s_branch L_wr_7_e
L_wr_7_1:
  s_cmp_lg_u32 s44, 1
  s_cbranch_scc1 L_wr_7_2
  ds_read_b64_tr_b16 v[248:249], v30 offset:0
  ds_read_b64_tr_b16 v[250:251], v30 offset:512
  ds_read_b64_tr_b16 v[252:253], v30 offset:8192
  ds_read_b64_tr_b16 v[254:255], v30 offset:8704
  ds_read_b64_tr_b16 v[240:241], v31 offset:0
  ds_read_b64_tr_b16 v[242:243], v31 offset:512
  ds_read_b64_tr_b16 v[244:245], v31 offset:8192
  ds_read_b64_tr_b16 v[246:247], v31 offset:8704
  s_branch L_wr_7_e
L_wr_7_2:
  s_cmp_lg_u32 s44, 2
  s_cbranch_scc1 L_wr_7_3
  ds_read_b64_tr_b16 v[224:225], v30 offset:0
  ds_read_b64_tr_b16 v[226:227], v30 offset:512
  ds_read_b64_tr_b16 v[228:229], v30 offset:8192
  ds_read_b64_tr_b16 v[230:231], v30 offset:8704
  ds_read_b64_tr_b16 v[232:233], v31 offset:0
  ds_read_b64_tr_b16 v[234:235], v31 offset:512
  ds_read_b64_tr_b16 v[236:237], v31 offset:8192
  ds_read_b64_tr_b16 v[238:239], v31 offset:8704
  s_branch L_wr_7_e
L_wr_7_3:
  ds_read_b64_tr_b16 v[232:233], v30 offset:0
  ds_read_b64_tr_b16 v[234:235], v30 offset:512
  ds_read_b64_tr_b16 v[236:237], v30 offset:8192
  ds_read_b64_tr_b16 v[238:239], v30 offset:8704
  ds_read_b64_tr_b16 v[224:225], v31 offset:0
  ds_read_b64_tr_b16 v[226:227], v31 offset:512
  ds_read_b64_tr_b16 v[228:229], v31 offset:8192
  ds_read_b64_tr_b16 v[230:231], v31 offset:8704
L_wr_7_e:
  s_waitcnt lgkmcnt(0)
  s_waitcnt vmcnt(24)
  s_barrier
  s_add_u32 m0, s56, 114688
  s_mov_b32 s68, 3670016
  buffer_load_dwordx4 v26, s[48:51], s68 offen  lds
  s_add_u32 m0, s56, 118784
  s_mov_b32 s68, 3735552
  buffer_load_dwordx4 v26, s[48:51], s68 offen  lds
  s_add_u32 m0, s56, 122880
  s_mov_b32 s68, 3932160
  buffer_load_dwordx4 v26, s[48:51], s68 offen  lds
  s_add_u32 m0, s56, 126976
  s_mov_b32 s68, 3997696
  buffer_load_dwordx4 v26, s[48:51], s68 offen  lds
  v_add_u32 v30, 0, v28
  v_add_u32 v31, 0, v29
  s_cmp_lg_u32 s44, 0
  s_cbranch_scc1 L_wr_8_1
  ds_read_b64_tr_b16 a[0:1], v30 offset:0
  ds_read_b64_tr_b16 a[2:3], v30 offset:512
  ds_read_b64_tr_b16 a[4:5], v30 offset:8192
  ds_read_b64_tr_b16 a[6:7], v30 offset:8704
  ds_read_b64_tr_b16 a[64:65], v31 offset:0
  ds_read_b64_tr_b16 a[66:67], v31 offset:512
  ds_read_b64_tr_b16 a[68:69], v31 offset:8192
  ds_read_b64_tr_b16 a[70:71], v31 offset:8704
  s_branch L_wr_8_e
L_wr_8_1:
  s_cmp_lg_u32 s44, 1
  s_cbranch_scc1 L_wr_8_2
  ds_read_b64_tr_b16 a[16:17], v30 offset:0
  ds_read_b64_tr_b16 a[18:19], v30 offset:512
  ds_read_b64_tr_b16 a[20:21], v30 offset:8192
  ds_read_b64_tr_b16 a[22:23], v30 offset:8704
  ds_read_b64_tr_b16 a[80:81], v31 offset:0
  ds_read_b64_tr_b16 a[82:83], v31 offset:512
  ds_read_b64_tr_b16 a[84:85], v31 offset:8192
  ds_read_b64_tr_b16 a[86:87], v31 offset:8704
  s_branch L_wr_8_e
L_wr_8_2:
  s_cmp_lg_u32 s44, 2
  s_cbranch_scc1 L_wr_8_3
  ds_read_b64_tr_b16 a[32:33], v30 offset:0
  ds_read_b64_tr_b16 a[34:35], v30 offset:512
  ds_read_b64_tr_b16 a[36:37], v30 offset:8192
  ds_read_b64_tr_b16 a[38:39], v30 offset:8704
  ds_read_b64_tr_b16 a[96:97], v31 offset:0
  ds_read_b64_tr_b16 a[98:99], v31 offset:512
  ds_read_b64_tr_b16 a[100:101], v31 offset:8192
  ds_read_b64_tr_b16 a[102:103], v31 offset:8704
  s_branch L_wr_8_e
L_wr_8_3:
  ds_read_b64_tr_b16 a[48:49], v30 offset:0
  ds_read_b64_tr_b16 a[50:51], v30 offset:512
  ds_read_b64_tr_b16 a[52:53], v30 offset:8192
  ds_read_b64_tr_b16 a[54:55], v30 offset:8704
  ds_read_b64_tr_b16 a[112:113], v31 offset:0
  ds_read_b64_tr_b16 a[114:115], v31 offset:512
  ds_read_b64_tr_b16 a[116:117], v31 offset:8192
  ds_read_b64_tr_b16 a[118:119], v31 offset:8704
L_wr_8_e:
  s_waitcnt lgkmcnt(0)
  s_waitcnt vmcnt(24)
  s_barrier
  s_mov_b32 s48, s26
  s_and_b32 s49, s27, 0xffff
  s_add_u32 m0, s56, 0
  s_mov_b32 s68, 0
  buffer_load_dwordx4 v26, s[48:51], s68 offen  lds
  s_add_u32 m0, s56, 4096
  s_mov_b32 s68, 65536
  buffer_load_dwordx4 v26, s[48:51], s68 offen  lds
  s_add_u32 m0, s56, 8192
  s_mov_b32 s68, 262144
  buffer_load_dwordx4 v26, s[48:51], s68 offen  lds
  s_add_u32 m0, s56, 12288
  s_mov_b32 s68, 327680
  buffer_load_dwordx4 v26, s[48:51], s68 offen  lds
  v_add_u32 v30, 16384, v28
  v_add_u32 v31, 16384, v29
  s_cmp_lg_u32 s44, 0
  s_cbranch_scc1 L_wr_9_1
  ds_read_b64_tr_b16 a[8:9], v30 offset:0
  ds_read_b64_tr_b16 a[10:11], v30 offset:512
  ds_read_b64_tr_b16 a[12:13], v30 offset:8192
  ds_read_b64_tr_b16 a[14:15], v30 offset:8704
  ds_read_b64_tr_b16 a[72:73], v31 offset:0
  ds_read_b64_tr_b16 a[74:75], v31 offset:512
  ds_read_b64_tr_b16 a[76:77], v31 offset:8192
  ds_read_b64_tr_b16 a[78:79], v31 offset:8704
  s_branch L_wr_9_e
L_wr_9_1:
  s_cmp_lg_u32 s44, 1
  s_cbranch_scc1 L_wr_9_2
  ds_read_b64_tr_b16 a[24:25], v30 offset:0
  ds_read_b64_tr_b16 a[26:27], v30 offset:512
  ds_read_b64_tr_b16 a[28:29], v30 offset:8192
  ds_read_b64_tr_b16 a[30:31], v30 offset:8704
  ds_read_b64_tr_b16 a[88:89], v31 offset:0
  ds_read_b64_tr_b16 a[90:91], v31 offset:512
  ds_read_b64_tr_b16 a[92:93], v31 offset:8192
  ds_read_b64_tr_b16 a[94:95], v31 offset:8704
  s_branch L_wr_9_e
L_wr_9_2:
  s_cmp_lg_u32 s44, 2
  s_cbranch_scc1 L_wr_9_3
  ds_read_b64_tr_b16 a[40:41], v30 offset:0
  ds_read_b64_tr_b16 a[42:43], v30 offset:512
  ds_read_b64_tr_b16 a[44:45], v30 offset:8192
  ds_read_b64_tr_b16 a[46:47], v30 offset:8704
  ds_read_b64_tr_b16 a[104:105], v31 offset:0
  ds_read_b64_tr_b16 a[106:107], v31 offset:512
  ds_read_b64_tr_b16 a[108:109], v31 offset:8192
  ds_read_b64_tr_b16 a[110:111], v31 offset:8704
  s_branch L_wr_9_e
L_wr_9_3:
  ds_read_b64_tr_b16 a[56:57], v30 offset:0
  ds_read_b64_tr_b16 a[58:59], v30 offset:512
  ds_read_b64_tr_b16 a[60:61], v30 offset:8192
  ds_read_b64_tr_b16 a[62:63], v30 offset:8704
  ds_read_b64_tr_b16 a[120:121], v31 offset:0
  ds_read_b64_tr_b16 a[122:123], v31 offset:512
  ds_read_b64_tr_b16 a[124:125], v31 offset:8192
  ds_read_b64_tr_b16 a[126:127], v31 offset:8704
L_wr_9_e:
  s_waitcnt lgkmcnt(0)
  s_waitcnt vmcnt(24)
  s_barrier
  s_add_u32 m0, s56, 16384
  s_mov_b32 s68, 524288
  buffer_load_dwordx4 v26, s[48:51], s68 offen  lds
  s_add_u32 m0, s56, 20480
  s_mov_b32 s68, 589824
  buffer_load_dwordx4 v26, s[48:51], s68 offen  lds
  s_add_u32 m0, s56, 24576
  s_mov_b32 s68, 786432
  buffer_load_dwordx4 v26, s[48:51], s68 offen  lds
  s_add_u32 m0, s56, 28672
  s_mov_b32 s68, 851968
  buffer_load_dwordx4 v26, s[48:51], s68 offen  lds
  v_add_u32 v30, 32768, v28
  v_add_u32 v31, 32768, v29
  s_cmp_lg_u32 s44, 0
  s_cbranch_scc1 L_wr_10_1
  ds_read_b64_tr_b16 a[16:17], v30 offset:0
  ds_read_b64_tr_b16 a[18:19], v30 offset:512
  ds_read_b64_tr_b16 a[20:21], v30 offset:8192
  ds_read_b64_tr_b16 a[22:23], v30 offset:8704
  ds_read_b64_tr_b16 a[80:81], v31 offset:0
  ds_read_b64_tr_b16 a[82:83], v31 offset:512
  ds_read_b64_tr_b16 a[84:85], v31 offset:8192
  ds_read_b64_tr_b16 a[86:87], v31 offset:8704
  s_branch L_wr_10_e
L_wr_10_1:
  s_cmp_lg_u32 s44, 1
  s_cbranch_scc1 L_wr_10_2
  ds_read_b64_tr_b16 a[0:1], v30 offset:0
  ds_read_b64_tr_b16 a[2:3], v30 offset:512
  ds_read_b64_tr_b16 a[4:5], v30 offset:8192
  ds_read_b64_tr_b16 a[6:7], v30 offset:8704
  ds_read_b64_tr_b16 a[64:65], v31 offset:0
  ds_read_b64_tr_b16 a[66:67], v31 offset:512
  ds_read_b64_tr_b16 a[68:69], v31 offset:8192
  ds_read_b64_tr_b16 a[70:71], v31 offset:8704
  s_branch L_wr_10_e
L_wr_10_2:
  s_cmp_lg_u32 s44, 2
  s_cbranch_scc1 L_wr_10_3
  ds_read_b64_tr_b16 a[48:49], v30 offset:0
  ds_read_b64_tr_b16 a[50:51], v30 offset:512
  ds_read_b64_tr_b16 a[52:53], v30 offset:8192
  ds_read_b64_tr_b16 a[54:55], v30 offset:8704
  ds_read_b64_tr_b16 a[112:113], v31 offset:0
  ds_read_b64_tr_b16 a[114:115], v31 offset:512
  ds_read_b64_tr_b16 a[116:117], v31 offset:8192
  ds_read_b64_tr_b16 a[118:119], v31 offset:8704
  s_branch L_wr_10_e
L_wr_10_3:
  ds_read_b64_tr_b16 a[32:33], v30 offset:0
  ds_read_b64_tr_b16 a[34:35], v30 offset:512
  ds_read_b64_tr_b16 a[36:37], v30 offset:8192
  ds_read_b64_tr_b16 a[38:39], v30 offset:8704
  ds_read_b64_tr_b16 a[96:97], v31 offset:0
  ds_read_b64_tr_b16 a[98:99], v31 offset:512
  ds_read_b64_tr_b16 a[100:101], v31 offset:8192
  ds_read_b64_tr_b16 a[102:103], v31 offset:8704
L_wr_10_e:
  s_waitcnt lgkmcnt(0)
  s_waitcnt vmcnt(24)
  s_barrier
  s_add_u32 m0, s56, 32768
  s_mov_b32 s68, 1048576
  buffer_load_dwordx4 v26, s[48:51], s68 offen  lds
  s_add_u32 m0, s56, 36864
  s_mov_b32 s68, 1114112
  buffer_load_dwordx4 v26, s[48:51], s68 offen  lds
  s_add_u32 m0, s56, 40960
  s_mov_b32 s68, 1310720
  buffer_load_dwordx4 v26, s[48:51], s68 offen  lds
  s_add_u32 m0, s56, 45056
  s_mov_b32 s68, 1376256
  buffer_load_dwordx4 v26, s[48:51], s68 offen  lds
  v_add_u32 v30, 49152, v28
  v_add_u32 v31, 49152, v29
  s_cmp_lg_u32 s44, 0
  s_cbranch_scc1 L_wr_11_1
  ds_read_b64_tr_b16 a[24:25], v30 offset:0
  ds_read_b64_tr_b16 a[26:27], v30 offset:512
  ds_read_b64_tr_b16 a[28:29], v30 offset:8192
  ds_read_b64_tr_b16 a[30:31], v30 offset:8704
  ds_read_b64_tr_b16 a[88:89], v31 offset:0
  ds_read_b64_tr_b16 a[90:91], v31 offset:512
  ds_read_b64_tr_b16 a[92:93], v31 offset:8192
  ds_read_b64_tr_b16 a[94:95], v31 offset:8704
  s_branch L_wr_11_e
L_wr_11_1:
  s_cmp_lg_u32 s44, 1
  s_cbranch_scc1 L_wr_11_2
  ds_read_b64_tr_b16 a[8:9], v30 offset:0
  ds_read_b64_tr_b16 a[10:11], v30 offset:512
  ds_read_b64_tr_b16 a[12:13], v30 offset:8192
  ds_read_b64_tr_b16 a[14:15], v30 offset:8704
  ds_read_b64_tr_b16 a[72:73], v31 offset:0
  ds_read_b64_tr_b16 a[74:75], v31 offset:512
  ds_read_b64_tr_b16 a[76:77], v31 offset:8192
  ds_read_b64_tr_b16 a[78:79], v31 offset:8704
  s_branch L_wr_11_e
L_wr_11_2:
  s_cmp_lg_u32 s44, 2
  s_cbranch_scc1 L_wr_11_3
  ds_read_b64_tr_b16 a[56:57], v30 offset:0
  ds_read_b64_tr_b16 a[58:59], v30 offset:512
  ds_read_b64_tr_b16 a[60:61], v30 offset:8192
  ds_read_b64_tr_b16 a[62:63], v30 offset:8704
  ds_read_b64_tr_b16 a[120:121], v31 offset:0
  ds_read_b64_tr_b16 a[122:123], v31 offset:512
  ds_read_b64_tr_b16 a[124:125], v31 offset:8192
  ds_read_b64_tr_b16 a[126:127], v31 offset:8704
  s_branch L_wr_11_e
L_wr_11_3:
  ds_read_b64_tr_b16 a[40:41], v30 offset:0
  ds_read_b64_tr_b16 a[42:43], v30 offset:512
  ds_read_b64_tr_b16 a[44:45], v30 offset:8192
  ds_read_b64_tr_b16 a[46:47], v30 offset:8704
  ds_read_b64_tr_b16 a[104:105], v31 offset:0
  ds_read_b64_tr_b16 a[106:107], v31 offset:512
  ds_read_b64_tr_b16 a[108:109], v31 offset:8192
  ds_read_b64_tr_b16 a[110:111], v31 offset:8704
L_wr_11_e:
  s_waitcnt lgkmcnt(0)
  s_waitcnt vmcnt(24)
  s_barrier
  s_add_u32 m0, s56, 49152
  s_mov_b32 s68, 1572864
  buffer_load_dwordx4 v26, s[48:51], s68 offen  lds
  s_add_u32 m0, s56, 53248
  s_mov_b32 s68, 1638400
  buffer_load_dwordx4 v26, s[48:51], s68 offen  lds
  s_add_u32 m0, s56, 57344
  s_mov_b32 s68, 1835008
  buffer_load_dwordx4 v26, s[48:51], s68 offen  lds
  s_add_u32 m0, s56, 61440
  s_mov_b32 s68, 1900544
  buffer_load_dwordx4 v26, s[48:51], s68 offen  lds
  v_add_u32 v30, 65536, v28
  v_add_u32 v31, 65536, v29
  s_cmp_lg_u32 s44, 0
  s_cbranch_scc1 L_wr_12_1
  ds_read_b64_tr_b16 a[32:33], v30 offset:0
  ds_read_b64_tr_b16 a[34:35], v30 offset:512
  ds_read_b64_tr_b16 a[36:37], v30 offset:8192
  ds_read_b64_tr_b16 a[38:39], v30 offset:8704
  ds_read_b64_tr_b16 a[96:97], v31 offset:0
  ds_read_b64_tr_b16 a[98:99], v31 offset:512
  ds_read_b64_tr_b16 a[100:101], v31 offset:8192
  ds_read_b64_tr_b16 a[102:103], v31 offset:8704
  s_branch L_wr_12_e
L_wr_12_1:
  s_cmp_lg_u32 s44, 1
  s_cbranch_scc1 L_wr_12_2
  ds_read_b64_tr_b16 a[48:49], v30 offset:0
  ds_read_b64_tr_b16 a[50:51], v30 offset:512
  ds_read_b64_tr_b16 a[52:53], v30 offset:8192
  ds_read_b64_tr_b16 a[54:55], v30 offset:8704
  ds_read_b64_tr_b16 a[112:113], v31 offset:0
  ds_read_b64_tr_b16 a[114:115], v31 offset:512
  ds_read_b64_tr_b16 a[116:117], v31 offset:8192
  ds_read_b64_tr_b16 a[118:119], v31 offset:8704
  s_branch L_wr_12_e
L_wr_12_2:
  s_cmp_lg_u32 s44, 2
  s_cbranch_scc1 L_wr_12_3
  ds_read_b64_tr_b16 a[0:1], v30 offset:0
  ds_read_b64_tr_b16 a[2:3], v30 offset:512
  ds_read_b64_tr_b16 a[4:5], v30 offset:8192
  ds_read_b64_tr_b16 a[6:7], v30 offset:8704
  ds_read_b64_tr_b16 a[64:65], v31 offset:0
  ds_read_b64_tr_b16 a[66:67], v31 offset:512
  ds_read_b64_tr_b16 a[68:69], v31 offset:8192
  ds_read_b64_tr_b16 a[70:71], v31 offset:8704
  s_branch L_wr_12_e
L_wr_12_3:
  ds_read_b64_tr_b16 a[16:17], v30 offset:0
  ds_read_b64_tr_b16 a[18:19], v30 offset:512
  ds_read_b64_tr_b16 a[20:21], v30 offset:8192
  ds_read_b64_tr_b16 a[22:23], v30 offset:8704
  ds_read_b64_tr_b16 a[80:81], v31 offset:0
  ds_read_b64_tr_b16 a[82:83], v31 offset:512
  ds_read_b64_tr_b16 a[84:85], v31 offset:8192
  ds_read_b64_tr_b16 a[86:87], v31 offset:8704
L_wr_12_e:
  s_waitcnt lgkmcnt(0)
  s_waitcnt vmcnt(24)
  s_barrier
  s_add_u32 m0, s56, 65536
  s_mov_b32 s68, 2097152
  buffer_load_dwordx4 v26, s[48:51], s68 offen  lds
  s_add_u32 m0, s56, 69632
  s_mov_b32 s68, 2162688
  buffer_load_dwordx4 v26, s[48:51], s68 offen  lds
  s_add_u32 m0, s56, 73728
  s_mov_b32 s68, 2359296
  buffer_load_dwordx4 v26, s[48:51], s68 offen  lds
  s_add_u32 m0, s56, 77824
  s_mov_b32 s68, 2424832
  buffer_load_dwordx4 v26, s[48:51], s68 offen  lds
  v_add_u32 v30, 81920, v28
  v_add_u32 v31, 81920, v29
  s_cmp_lg_u32 s44, 0
  s_cbranch_scc1 L_wr_13_1
  ds_read_b64_tr_b16 a[40:41], v30 offset:0
  ds_read_b64_tr_b16 a[42:43], v30 offset:512
  ds_read_b64_tr_b16 a[44:45], v30 offset:8192
  ds_read_b64_tr_b16 a[46:47], v30 offset:8704
  ds_read_b64_tr_b16 a[104:105], v31 offset:0
  ds_read_b64_tr_b16 a[106:107], v31 offset:512
  ds_read_b64_tr_b16 a[108:109], v31 offset:8192
  ds_read_b64_tr_b16 a[110:111], v31 offset:8704
  s_branch L_wr_13_e
L_wr_13_1:
  s_cmp_lg_u32 s44, 1
  s_cbranch_scc1 L_wr_13_2
  ds_read_b64_tr_b16 a[56:57], v30 offset:0
  ds_read_b64_tr_b16 a[58:59], v30 offset:512
  ds_read_b64_tr_b16 a[60:61], v30 offset:8192
  ds_read_b64_tr_b16 a[62:63], v30 offset:8704
  ds_read_b64_tr_b16 a[120:121], v31 offset:0
  ds_read_b64_tr_b16 a[122:123], v31 offset:512
  ds_read_b64_tr_b16 a[124:125], v31 offset:8192
  ds_read_b64_tr_b16 a[126:127], v31 offset:8704
  s_branch L_wr_13_e
L_wr_13_2:
  s_cmp_lg_u32 s44, 2
  s_cbranch_scc1 L_wr_13_3
  ds_read_b64_tr_b16 a[8:9], v30 offset:0
  ds_read_b64_tr_b16 a[10:11], v30 offset:512
  ds_read_b64_tr_b16 a[12:13], v30 offset:8192
  ds_read_b64_tr_b16 a[14:15], v30 offset:8704
  ds_read_b64_tr_b16 a[72:73], v31 offset:0
  ds_read_b64_tr_b16 a[74:75], v31 offset:512
  ds_read_b64_tr_b16 a[76:77], v31 offset:8192
  ds_read_b64_tr_b16 a[78:79], v31 offset:8704
  s_branch L_wr_13_e
L_wr_13_3:
  ds_read_b64_tr_b16 a[24:25], v30 offset:0
  ds_read_b64_tr_b16 a[26:27], v30 offset:512
  ds_read_b64_tr_b16 a[28:29], v30 offset:8192
  ds_read_b64_tr_b16 a[30:31], v30 offset:8704
  ds_read_b64_tr_b16 a[88:89], v31 offset:0
  ds_read_b64_tr_b16 a[90:91], v31 offset:512
  ds_read_b64_tr_b16 a[92:93], v31 offset:8192
  ds_read_b64_tr_b16 a[94:95], v31 offset:8704
L_wr_13_e:
  s_waitcnt lgkmcnt(0)
  s_waitcnt vmcnt(24)
  s_barrier
  s_add_u32 m0, s56, 81920
  s_mov_b32 s68, 2621440
  buffer_load_dwordx4 v26, s[48:51], s68 offen  lds
  s_add_u32 m0, s56, 86016
  s_mov_b32 s68, 2686976
  buffer_load_dwordx4 v26, s[48:51], s68 offen  lds
  s_add_u32 m0, s56, 90112
  s_mov_b32 s68, 2883584
  buffer_load_dwordx4 v26, s[48:51], s68 offen  lds
  s_add_u32 m0, s56, 94208
  s_mov_b32 s68, 2949120
  buffer_load_dwordx4 v26, s[48:51], s68 offen  lds
  v_add_u32 v30, 98304, v28
  v_add_u32 v31, 98304, v29
  s_cmp_lg_u32 s44, 0
  s_cbranch_scc1 L_wr_14_1
  ds_read_b64_tr_b16 a[48:49], v30 offset:0
  ds_read_b64_tr_b16 a[50:51], v30 offset:512
  ds_read_b64_tr_b16 a[52:53], v30 offset:8192
  ds_read_b64_tr_b16 a[54:55], v30 offset:8704
  ds_read_b64_tr_b16 a[112:113], v31 offset:0
  ds_read_b64_tr_b16 a[114:115], v31 offset:512
  ds_read_b64_tr_b16 a[116:117], v31 offset:8192
  ds_read_b64_tr_b16 a[118:119], v31 offset:8704
  s_branch L_wr_14_e
L_wr_14_1:
  s_cmp_lg_u32 s44, 1
  s_cbranch_scc1 L_wr_14_2
  ds_read_b64_tr_b16 a[32:33], v30 offset:0
  ds_read_b64_tr_b16 a[34:35], v30 offset:512
  ds_read_b64_tr_b16 a[36:37], v30 offset:8192
  ds_read_b64_tr_b16 a[38:39], v30 offset:8704
  ds_read_b64_tr_b16 a[96:97], v31 offset:0
  ds_read_b64_tr_b16 a[98:99], v31 offset:512
  ds_read_b64_tr_b16 a[100:101], v31 offset:8192
  ds_read_b64_tr_b16 a[102:103], v31 offset:8704
  s_branch L_wr_14_e
L_wr_14_2:
  s_cmp_lg_u32 s44, 2
  s_cbranch_scc1 L_wr_14_3
  ds_read_b64_tr_b16 a[16:17], v30 offset:0
  ds_read_b64_tr_b16 a[18:19], v30 offset:512
  ds_read_b64_tr_b16 a[20:21], v30 offset:8192
  ds_read_b64_tr_b16 a[22:23], v30 offset:8704
  ds_read_b64_tr_b16 a[80:81], v31 offset:0
  ds_read_b64_tr_b16 a[82:83], v31 offset:512
  ds_read_b64_tr_b16 a[84:85], v31 offset:8192
  ds_read_b64_tr_b16 a[86:87], v31 offset:8704
  s_branch L_wr_14_e
L_wr_14_3:
  ds_read_b64_tr_b16 a[0:1], v30 offset:0
  ds_read_b64_tr_b16 a[2:3], v30 offset:512
  ds_read_b64_tr_b16 a[4:5], v30 offset:8192
  ds_read_b64_tr_b16 a[6:7], v30 offset:8704
  ds_read_b64_tr_b16 a[64:65], v31 offset:0
  ds_read_b64_tr_b16 a[66:67], v31 offset:512
  ds_read_b64_tr_b16 a[68:69], v31 offset:8192
  ds_read_b64_tr_b16 a[70:71], v31 offset:8704
L_wr_14_e:
  s_waitcnt lgkmcnt(0)
  s_waitcnt vmcnt(24)
  s_barrier
  s_add_u32 m0, s56, 98304
  s_mov_b32 s68, 3145728
  buffer_load_dwordx4 v26, s[48:51], s68 offen  lds
  s_add_u32 m0, s56, 102400
  s_mov_b32 s68, 3211264
  buffer_load_dwordx4 v26, s[48:51], s68 offen  lds
  s_add_u32 m0, s56, 106496
  s_mov_b32 s68, 3407872
  buffer_load_dwordx4 v26, s[48:51], s68 offen  lds
  s_add_u32 m0, s56, 110592
  s_mov_b32 s68, 3473408
  buffer_load_dwordx4 v26, s[48:51], s68 offen  lds
  v_add_u32 v30, 114688, v28
  v_add_u32 v31, 114688, v29
  s_cmp_lg_u32 s44, 0
  s_cbranch_scc1 L_wr_15_1
  ds_read_b64_tr_b16 a[56:57], v30 offset:0
  ds_read_b64_tr_b16 a[58:59], v30 offset:512
  ds_read_b64_tr_b16 a[60:61], v30 offset:8192
  ds_read_b64_tr_b16 a[62:63], v30 offset:8704
  ds_read_b64_tr_b16 a[120:121], v31 offset:0
  ds_read_b64_tr_b16 a[122:123], v31 offset:512
  ds_read_b64_tr_b16 a[124:125], v31 offset:8192
  ds_read_b64_tr_b16 a[126:127], v31 offset:8704
  s_branch L_wr_15_e
L_wr_15_1:
  s_cmp_lg_u32 s44, 1
  s_cbranch_scc1 L_wr_15_2
  ds_read_b64_tr_b16 a[40:41], v30 offset:0
  ds_read_b64_tr_b16 a[42:43], v30 offset:512
  ds_read_b64_tr_b16 a[44:45], v30 offset:8192
  ds_read_b64_tr_b16 a[46:47], v30 offset:8704
  ds_read_b64_tr_b16 a[104:105], v31 offset:0
  ds_read_b64_tr_b16 a[106:107], v31 offset:512
  ds_read_b64_tr_b16 a[108:109], v31 offset:8192
  ds_read_b64_tr_b16 a[110:111], v31 offset:8704
  s_branch L_wr_15_e
L_wr_15_2:
  s_cmp_lg_u32 s44, 2
  s_cbranch_scc1 L_wr_15_3
  ds_read_b64_tr_b16 a[24:25], v30 offset:0
  ds_read_b64_tr_b16 a[26:27], v30 offset:512
  ds_read_b64_tr_b16 a[28:29], v30 offset:8192
  ds_read_b64_tr_b16 a[30:31], v30 offset:8704
  ds_read_b64_tr_b16 a[88:89], v31 offset:0
  ds_read_b64_tr_b16 a[90:91], v31 offset:512
  ds_read_b64_tr_b16 a[92:93], v31 offset:8192
  ds_read_b64_tr_b16 a[94:95], v31 offset:8704
  s_branch L_wr_15_e
L_wr_15_3:
  ds_read_b64_tr_b16 a[8:9], v30 offset:0
  ds_read_b64_tr_b16 a[10:11], v30 offset:512
  ds_read_b64_tr_b16 a[12:13], v30 offset:8192
  ds_read_b64_tr_b16 a[14:15], v30 offset:8704
  ds_read_b64_tr_b16 a[72:73], v31 offset:0
  ds_read_b64_tr_b16 a[74:75], v31 offset:512
  ds_read_b64_tr_b16 a[76:77], v31 offset:8192
  ds_read_b64_tr_b16 a[78:79], v31 offset:8704
L_wr_15_e:
  s_waitcnt lgkmcnt(0)
  s_waitcnt vmcnt(24)
  s_barrier
  s_add_u32 m0, s56, 114688
  s_mov_b32 s68, 3670016
  buffer_load_dwordx4 v26, s[48:51], s68 offen  lds
  s_add_u32 m0, s56, 118784
  s_mov_b32 s68, 3735552
  buffer_load_dwordx4 v26, s[48:51], s68 offen  lds
  s_add_u32 m0, s56, 122880
  s_mov_b32 s68, 3932160
  buffer_load_dwordx4 v26, s[48:51], s68 offen  lds
  s_add_u32 m0, s56, 126976
  s_mov_b32 s68, 3997696
  buffer_load_dwordx4 v26, s[48:51], s68 offen  lds
  v_add_u32 v30, 0, v28
  v_add_u32 v31, 0, v29
  s_cmp_lg_u32 s44, 0
  s_cbranch_scc1 L_wr_16_1
  ds_read_b64_tr_b16 a[128:129], v30 offset:0
  ds_read_b64_tr_b16 a[130:131], v30 offset:512
  ds_read_b64_tr_b16 a[132:133], v30 offset:8192
  ds_read_b64_tr_b16 a[134:135], v30 offset:8704
  ds_read_b64_tr_b16 a[192:193], v31 offset:0
  ds_read_b64_tr_b16 a[194:195], v31 offset:512
  ds_read_b64_tr_b16 a[196:197], v31 offset:8192
  ds_read_b64_tr_b16 a[198:199], v31 offset:8704
  s_branch L_wr_16_e
L_wr_16_1:
  s_cmp_lg_u32 s44, 1
  s_cbranch_scc1 L_wr_16_2
  ds_read_b64_tr_b16 a[144:145], v30 offset:0
  ds_read_b64_tr_b16 a[146:147], v30 offset:512
  ds_read_b64_tr_b16 a[148:149], v30 offset:8192
  ds_read_b64_tr_b16 a[150:151], v30 offset:8704
  ds_read_b64_tr_b16 a[208:209], v31 offset:0
  ds_read_b64_tr_b16 a[210:211], v31 offset:512
  ds_read_b64_tr_b16 a[212:213], v31 offset:8192
  ds_read_b64_tr_b16 a[214:215], v31 offset:8704
  s_branch L_wr_16_e
L_wr_16_2:
  s_cmp_lg_u32 s44, 2
  s_cbranch_scc1 L_wr_16_3
  ds_read_b64_tr_b16 a[160:161], v30 offset:0
  ds_read_b64_tr_b16 a[162:163], v30 offset:512
  ds_read_b64_tr_b16 a[164:165], v30 offset:8192
  ds_read_b64_tr_b16 a[166:167], v30 offset:8704
  ds_read_b64_tr_b16 a[224:225], v31 offset:0
  ds_read_b64_tr_b16 a[226:227], v31 offset:512
  ds_read_b64_tr_b16 a[228:229], v31 offset:8192
  ds_read_b64_tr_b16 a[230:231], v31 offset:8704
  s_branch L_wr_16_e
L_wr_16_3:
  ds_read_b64_tr_b16 a[176:177], v30 offset:0
  ds_read_b64_tr_b16 a[178:179], v30 offset:512
  ds_read_b64_tr_b16 a[180:181], v30 offset:8192
  ds_read_b64_tr_b16 a[182:183], v30 offset:8704
  ds_read_b64_tr_b16 a[240:241], v31 offset:0
  ds_read_b64_tr_b16 a[242:243], v31 offset:512
  ds_read_b64_tr_b16 a[244:245], v31 offset:8192
  ds_read_b64_tr_b16 a[246:247], v31 offset:8704
L_wr_16_e:
  s_waitcnt lgkmcnt(0)
  s_waitcnt vmcnt(24)
  s_barrier
  s_mov_b32 s48, s28
  s_and_b32 s49, s29, 0xffff
  s_add_u32 m0, s56, 0
  s_mov_b32 s68, 0
  buffer_load_dwordx4 v26, s[48:51], s68 offen  lds
  s_add_u32 m0, s56, 4096
  s_mov_b32 s68, 65536
  buffer_load_dwordx4 v26, s[48:51], s68 offen  lds
  s_add_u32 m0, s56, 8192
  s_mov_b32 s68, 262144
  buffer_load_dwordx4 v26, s[48:51], s68 offen  lds
  s_add_u32 m0, s56, 12288
  s_mov_b32 s68, 327680
  buffer_load_dwordx4 v26, s[48:51], s68 offen  lds
  v_add_u32 v30, 16384, v28
  v_add_u32 v31, 16384, v29
  s_cmp_lg_u32 s44, 0
  s_cbranch_scc1 L_wr_17_1
  ds_read_b64_tr_b16 a[136:137], v30 offset:0
  ds_read_b64_tr_b16 a[138:139], v30 offset:512
  ds_read_b64_tr_b16 a[140:141], v30 offset:8192
  ds_read_b64_tr_b16 a[142:143], v30 offset:8704
  ds_read_b64_tr_b16 a[200:201], v31 offset:0
  ds_read_b64_tr_b16 a[202:203], v31 offset:512
  ds_read_b64_tr_b16 a[204:205], v31 offset:8192
  ds_read_b64_tr_b16 a[206:207], v31 offset:8704
  s_branch L_wr_17_e
L_wr_17_1:
  s_cmp_lg_u32 s44, 1
  s_cbranch_scc1 L_wr_17_2
  ds_read_b64_tr_b16 a[152:153], v30 offset:0
  ds_read_b64_tr_b16 a[154:155], v30 offset:512
  ds_read_b64_tr_b16 a[156:157], v30 offset:8192
  ds_read_b64_tr_b16 a[158:159], v30 offset:8704
  ds_read_b64_tr_b16 a[216:217], v31 offset:0
  ds_read_b64_tr_b16 a[218:219], v31 offset:512
  ds_read_b64_tr_b16 a[220:221], v31 offset:8192
  ds_read_b64_tr_b16 a[222:223], v31 offset:8704
  s_branch L_wr_17_e
L_wr_17_2:
  s_cmp_lg_u32 s44, 2
  s_cbranch_scc1 L_wr_17_3
  ds_read_b64_tr_b16 a[168:169], v30 offset:0
  ds_read_b64_tr_b16 a[170:171], v30 offset:512
  ds_read_b64_tr_b16 a[172:173], v30 offset:8192
  ds_read_b64_tr_b16 a[174:175], v30 offset:8704
  ds_read_b64_tr_b16 a[232:233], v31 offset:0
  ds_read_b64_tr_b16 a[234:235], v31 offset:512
  ds_read_b64_tr_b16 a[236:237], v31 offset:8192
  ds_read_b64_tr_b16 a[238:239], v31 offset:8704
  s_branch L_wr_17_e
L_wr_17_3:
  ds_read_b64_tr_b16 a[184:185], v30 offset:0
  ds_read_b64_tr_b16 a[186:187], v30 offset:512
  ds_read_b64_tr_b16 a[188:189], v30 offset:8192
  ds_read_b64_tr_b16 a[190:191], v30 offset:8704
  ds_read_b64_tr_b16 a[248:249], v31 offset:0
  ds_read_b64_tr_b16 a[250:251], v31 offset:512
  ds_read_b64_tr_b16 a[252:253], v31 offset:8192
  ds_read_b64_tr_b16 a[254:255], v31 offset:8704
L_wr_17_e:
  s_waitcnt lgkmcnt(0)
  s_waitcnt vmcnt(24)
  s_barrier
  s_add_u32 m0, s56, 16384
  s_mov_b32 s68, 524288
  buffer_load_dwordx4 v26, s[48:51], s68 offen  lds
  s_add_u32 m0, s56, 20480
  s_mov_b32 s68, 589824
  buffer_load_dwordx4 v26, s[48:51], s68 offen  lds
  s_add_u32 m0, s56, 24576
  s_mov_b32 s68, 786432
  buffer_load_dwordx4 v26, s[48:51], s68 offen  lds
  s_add_u32 m0, s56, 28672
  s_mov_b32 s68, 851968
  buffer_load_dwordx4 v26, s[48:51], s68 offen  lds
  v_add_u32 v30, 32768, v28
  v_add_u32 v31, 32768, v29
  s_cmp_lg_u32 s44, 0
  s_cbranch_scc1 L_wr_18_1
  ds_read_b64_tr_b16 a[144:145], v30 offset:0
  ds_read_b64_tr_b16 a[146:147], v30 offset:512
  ds_read_b64_tr_b16 a[148:149], v30 offset:8192
  ds_read_b64_tr_b16 a[150:151], v30 offset:8704
  ds_read_b64_tr_b16 a[208:209], v31 offset:0
  ds_read_b64_tr_b16 a[210:211], v31 offset:512
  ds_read_b64_tr_b16 a[212:213], v31 offset:8192
  ds_read_b64_tr_b16 a[214:215], v31 offset:8704
  s_branch L_wr_18_e
L_wr_18_1:
  s_cmp_lg_u32 s44, 1
  s_cbranch_scc1 L_wr_18_2
  ds_read_b64_tr_b16 a[128:129], v30 offset:0
  ds_read_b64_tr_b16 a[130:131], v30 offset:512
  ds_read_b64_tr_b16 a[132:133], v30 offset:8192
  ds_read_b64_tr_b16 a[134:135], v30 offset:8704
  ds_read_b64_tr_b16 a[192:193], v31 offset:0
  ds_read_b64_tr_b16 a[194:195], v31 offset:512
  ds_read_b64_tr_b16 a[196:197], v31 offset:8192
  ds_read_b64_tr_b16 a[198:199], v31 offset:8704
  s_branch L_wr_18_e
L_wr_18_2:
  s_cmp_lg_u32 s44, 2
  s_cbranch_scc1 L_wr_18_3
  ds_read_b64_tr_b16 a[176:177], v30 offset:0
  ds_read_b64_tr_b16 a[178:179], v30 offset:512
  ds_read_b64_tr_b16 a[180:181], v30 offset:8192
  ds_read_b64_tr_b16 a[182:183], v30 offset:8704
  ds_read_b64_tr_b16 a[240:241], v31 offset:0
  ds_read_b64_tr_b16 a[242:243], v31 offset:512
  ds_read_b64_tr_b16 a[244:245], v31 offset:8192
  ds_read_b64_tr_b16 a[246:247], v31 offset:8704
  s_branch L_wr_18_e
L_wr_18_3:
  ds_read_b64_tr_b16 a[160:161], v30 offset:0
  ds_read_b64_tr_b16 a[162:163], v30 offset:512
  ds_read_b64_tr_b16 a[164:165], v30 offset:8192
  ds_read_b64_tr_b16 a[166:167], v30 offset:8704
  ds_read_b64_tr_b16 a[224:225], v31 offset:0
  ds_read_b64_tr_b16 a[226:227], v31 offset:512
  ds_read_b64_tr_b16 a[228:229], v31 offset:8192
  ds_read_b64_tr_b16 a[230:231], v31 offset:8704
L_wr_18_e:
  s_waitcnt lgkmcnt(0)
  s_waitcnt vmcnt(24)
  s_barrier
  s_add_u32 m0, s56, 32768
  s_mov_b32 s68, 1048576
  buffer_load_dwordx4 v26, s[48:51], s68 offen  lds
  s_add_u32 m0, s56, 36864
  s_mov_b32 s68, 1114112
  buffer_load_dwordx4 v26, s[48:51], s68 offen  lds
  s_add_u32 m0, s56, 40960
  s_mov_b32 s68, 1310720
  buffer_load_dwordx4 v26, s[48:51], s68 offen  lds
  s_add_u32 m0, s56, 45056
  s_mov_b32 s68, 1376256
  buffer_load_dwordx4 v26, s[48:51], s68 offen  lds
  v_add_u32 v30, 49152, v28
  v_add_u32 v31, 49152, v29
  s_cmp_lg_u32 s44, 0
  s_cbranch_scc1 L_wr_19_1
  ds_read_b64_tr_b16 a[152:153], v30 offset:0
  ds_read_b64_tr_b16 a[154:155], v30 offset:512
  ds_read_b64_tr_b16 a[156:157], v30 offset:8192
  ds_read_b64_tr_b16 a[158:159], v30 offset:8704
  ds_read_b64_tr_b16 a[216:217], v31 offset:0
  ds_read_b64_tr_b16 a[218:219], v31 offset:512
  ds_read_b64_tr_b16 a[220:221], v31 offset:8192
  ds_read_b64_tr_b16 a[222:223], v31 offset:8704
  s_branch L_wr_19_e
L_wr_19_1:
  s_cmp_lg_u32 s44, 1
  s_cbranch_scc1 L_wr_19_2
  ds_read_b64_tr_b16 a[136:137], v30 offset:0
  ds_read_b64_tr_b16 a[138:139], v30 offset:512
  ds_read_b64_tr_b16 a[140:141], v30 offset:8192
  ds_read_b64_tr_b16 a[142:143], v30 offset:8704
  ds_read_b64_tr_b16 a[200:201], v31 offset:0
  ds_read_b64_tr_b16 a[202:203], v31 offset:512
  ds_read_b64_tr_b16 a[204:205], v31 offset:8192
  ds_read_b64_tr_b16 a[206:207], v31 offset:8704
  s_branch L_wr_19_e
L_wr_19_2:
  s_cmp_lg_u32 s44, 2
  s_cbranch_scc1 L_wr_19_3
  ds_read_b64_tr_b16 a[184:185], v30 offset:0
  ds_read_b64_tr_b16 a[186:187], v30 offset:512
  ds_read_b64_tr_b16 a[188:189], v30 offset:8192
  ds_read_b64_tr_b16 a[190:191], v30 offset:8704
  ds_read_b64_tr_b16 a[248:249], v31 offset:0
  ds_read_b64_tr_b16 a[250:251], v31 offset:512
  ds_read_b64_tr_b16 a[252:253], v31 offset:8192
  ds_read_b64_tr_b16 a[254:255], v31 offset:8704
  s_branch L_wr_19_e
L_wr_19_3:
  ds_read_b64_tr_b16 a[168:169], v30 offset:0
  ds_read_b64_tr_b16 a[170:171], v30 offset:512
  ds_read_b64_tr_b16 a[172:173], v30 offset:8192
  ds_read_b64_tr_b16 a[174:175], v30 offset:8704
  ds_read_b64_tr_b16 a[232:233], v31 offset:0
  ds_read_b64_tr_b16 a[234:235], v31 offset:512
  ds_read_b64_tr_b16 a[236:237], v31 offset:8192
  ds_read_b64_tr_b16 a[238:239], v31 offset:8704
L_wr_19_e:
  s_waitcnt lgkmcnt(0)
  s_waitcnt vmcnt(24)
  s_barrier
  s_add_u32 m0, s56, 49152
  s_mov_b32 s68, 1572864
  buffer_load_dwordx4 v26, s[48:51], s68 offen  lds
  s_add_u32 m0, s56, 53248
  s_mov_b32 s68, 1638400
  buffer_load_dwordx4 v26, s[48:51], s68 offen  lds
  s_add_u32 m0, s56, 57344
  s_mov_b32 s68, 1835008
  buffer_load_dwordx4 v26, s[48:51], s68 offen  lds
  s_add_u32 m0, s56, 61440
  s_mov_b32 s68, 1900544
  buffer_load_dwordx4 v26, s[48:51], s68 offen  lds
  v_add_u32 v30, 65536, v28
  v_add_u32 v31, 65536, v29
  s_cmp_lg_u32 s44, 0
  s_cbranch_scc1 L_wr_20_1
  ds_read_b64_tr_b16 a[160:161], v30 offset:0
  ds_read_b64_tr_b16 a[162:163], v30 offset:512
  ds_read_b64_tr_b16 a[164:165], v30 offset:8192
  ds_read_b64_tr_b16 a[166:167], v30 offset:8704
  ds_read_b64_tr_b16 a[224:225], v31 offset:0
  ds_read_b64_tr_b16 a[226:227], v31 offset:512
  ds_read_b64_tr_b16 a[228:229], v31 offset:8192
  ds_read_b64_tr_b16 a[230:231], v31 offset:8704
  s_branch L_wr_20_e
L_wr_20_1:
  s_cmp_lg_u32 s44, 1
  s_cbranch_scc1 L_wr_20_2
  ds_read_b64_tr_b16 a[176:177], v30 offset:0
  ds_read_b64_tr_b16 a[178:179], v30 offset:512
  ds_read_b64_tr_b16 a[180:181], v30 offset:8192
  ds_read_b64_tr_b16 a[182:183], v30 offset:8704
  ds_read_b64_tr_b16 a[240:241], v31 offset:0
  ds_read_b64_tr_b16 a[242:243], v31 offset:512
  ds_read_b64_tr_b16 a[244:245], v31 offset:8192
  ds_read_b64_tr_b16 a[246:247], v31 offset:8704
  s_branch L_wr_20_e
L_wr_20_2:
  s_cmp_lg_u32 s44, 2
  s_cbranch_scc1 L_wr_20_3
  ds_read_b64_tr_b16 a[128:129], v30 offset:0
  ds_read_b64_tr_b16 a[130:131], v30 offset:512
  ds_read_b64_tr_b16 a[132:133], v30 offset:8192
  ds_read_b64_tr_b16 a[134:135], v30 offset:8704
  ds_read_b64_tr_b16 a[192:193], v31 offset:0
  ds_read_b64_tr_b16 a[194:195], v31 offset:512
  ds_read_b64_tr_b16 a[196:197], v31 offset:8192
  ds_read_b64_tr_b16 a[198:199], v31 offset:8704
  s_branch L_wr_20_e
L_wr_20_3:
  ds_read_b64_tr_b16 a[144:145], v30 offset:0
  ds_read_b64_tr_b16 a[146:147], v30 offset:512
  ds_read_b64_tr_b16 a[148:149], v30 offset:8192
  ds_read_b64_tr_b16 a[150:151], v30 offset:8704
  ds_read_b64_tr_b16 a[208:209], v31 offset:0
  ds_read_b64_tr_b16 a[210:211], v31 offset:512
  ds_read_b64_tr_b16 a[212:213], v31 offset:8192
  ds_read_b64_tr_b16 a[214:215], v31 offset:8704
L_wr_20_e:
  s_waitcnt lgkmcnt(0)
  s_waitcnt vmcnt(24)
  s_barrier
  s_add_u32 m0, s56, 65536
  s_mov_b32 s68, 2097152
  buffer_load_dwordx4 v26, s[48:51], s68 offen  lds
  s_add_u32 m0, s56, 69632
  s_mov_b32 s68, 2162688
  buffer_load_dwordx4 v26, s[48:51], s68 offen  lds
  s_add_u32 m0, s56, 73728
  s_mov_b32 s68, 2359296
  buffer_load_dwordx4 v26, s[48:51], s68 offen  lds
  s_add_u32 m0, s56, 77824
  s_mov_b32 s68, 2424832
  buffer_load_dwordx4 v26, s[48:51], s68 offen  lds
  v_add_u32 v30, 81920, v28
  v_add_u32 v31, 81920, v29
  s_cmp_lg_u32 s44, 0
  s_cbranch_scc1 L_wr_21_1
  ds_read_b64_tr_b16 a[168:169], v30 offset:0
  ds_read_b64_tr_b16 a[170:171], v30 offset:512
  ds_read_b64_tr_b16 a[172:173], v30 offset:8192
  ds_read_b64_tr_b16 a[174:175], v30 offset:8704
  ds_read_b64_tr_b16 a[232:233], v31 offset:0
  ds_read_b64_tr_b16 a[234:235], v31 offset:512
  ds_read_b64_tr_b16 a[236:237], v31 offset:8192
  ds_read_b64_tr_b16 a[238:239], v31 offset:8704
  s_branch L_wr_21_e
L_wr_21_1:
  s_cmp_lg_u32 s44, 1
  s_cbranch_scc1 L_wr_21_2
  ds_read_b64_tr_b16 a[184:185], v30 offset:0
  ds_read_b64_tr_b16 a[186:187], v30 offset:512
  ds_read_b64_tr_b16 a[188:189], v30 offset:8192
  ds_read_b64_tr_b16 a[190:191], v30 offset:8704
  ds_read_b64_tr_b16 a[248:249], v31 offset:0
  ds_read_b64_tr_b16 a[250:251], v31 offset:512
  ds_read_b64_tr_b16 a[252:253], v31 offset:8192
  ds_read_b64_tr_b16 a[254:255], v31 offset:8704
  s_branch L_wr_21_e
L_wr_21_2:
  s_cmp_lg_u32 s44, 2
  s_cbranch_scc1 L_wr_21_3
  ds_read_b64_tr_b16 a[136:137], v30 offset:0
  ds_read_b64_tr_b16 a[138:139], v30 offset:512
  ds_read_b64_tr_b16 a[140:141], v30 offset:8192
  ds_read_b64_tr_b16 a[142:143], v30 offset:8704
  ds_read_b64_tr_b16 a[200:201], v31 offset:0
  ds_read_b64_tr_b16 a[202:203], v31 offset:512
  ds_read_b64_tr_b16 a[204:205], v31 offset:8192
  ds_read_b64_tr_b16 a[206:207], v31 offset:8704
  s_branch L_wr_21_e
L_wr_21_3:
  ds_read_b64_tr_b16 a[152:153], v30 offset:0
  ds_read_b64_tr_b16 a[154:155], v30 offset:512
  ds_read_b64_tr_b16 a[156:157], v30 offset:8192
  ds_read_b64_tr_b16 a[158:159], v30 offset:8704
  ds_read_b64_tr_b16 a[216:217], v31 offset:0
  ds_read_b64_tr_b16 a[218:219], v31 offset:512
  ds_read_b64_tr_b16 a[220:221], v31 offset:8192
  ds_read_b64_tr_b16 a[222:223], v31 offset:8704
L_wr_21_e:
  s_waitcnt lgkmcnt(0)
  s_waitcnt vmcnt(24)
  s_barrier
  s_add_u32 m0, s56, 81920
  s_mov_b32 s68, 2621440
  buffer_load_dwordx4 v26, s[48:51], s68 offen  lds
  s_add_u32 m0, s56, 86016
  s_mov_b32 s68, 2686976
  buffer_load_dwordx4 v26, s[48:51], s68 offen  lds
  s_add_u32 m0, s56, 90112
  s_mov_b32 s68, 2883584
  buffer_load_dwordx4 v26, s[48:51], s68 offen  lds
  s_add_u32 m0, s56, 94208
  s_mov_b32 s68, 2949120
  buffer_load_dwordx4 v26, s[48:51], s68 offen  lds
  v_add_u32 v30, 98304, v28
  v_add_u32 v31, 98304, v29
  s_cmp_lg_u32 s44, 0
  s_cbranch_scc1 L_wr_22_1
  ds_read_b64_tr_b16 a[176:177], v30 offset:0
  ds_read_b64_tr_b16 a[178:179], v30 offset:512
  ds_read_b64_tr_b16 a[180:181], v30 offset:8192
  ds_read_b64_tr_b16 a[182:183], v30 offset:8704
  ds_read_b64_tr_b16 a[240:241], v31 offset:0
  ds_read_b64_tr_b16 a[242:243], v31 offset:512
  ds_read_b64_tr_b16 a[244:245], v31 offset:8192
  ds_read_b64_tr_b16 a[246:247], v31 offset:8704
  s_branch L_wr_22_e
L_wr_22_1:
  s_cmp_lg_u32 s44, 1
  s_cbranch_scc1 L_wr_22_2
  ds_read_b64_tr_b16 a[160:161], v30 offset:0
  ds_read_b64_tr_b16 a[162:163], v30 offset:512
  ds_read_b64_tr_b16 a[164:165], v30 offset:8192
  ds_read_b64_tr_b16 a[166:167], v30 offset:8704
  ds_read_b64_tr_b16 a[224:225], v31 offset:0
  ds_read_b64_tr_b16 a[226:227], v31 offset:512
  ds_read_b64_tr_b16 a[228:229], v31 offset:8192
  ds_read_b64_tr_b16 a[230:231], v31 offset:8704
  s_branch L_wr_22_e
L_wr_22_2:
  s_cmp_lg_u32 s44, 2
  s_cbranch_scc1 L_wr_22_3
  ds_read_b64_tr_b16 a[144:145], v30 offset:0
  ds_read_b64_tr_b16 a[146:147], v30 offset:512
  ds_read_b64_tr_b16 a[148:149], v30 offset:8192
  ds_read_b64_tr_b16 a[150:151], v30 offset:8704
  ds_read_b64_tr_b16 a[208:209], v31 offset:0
  ds_read_b64_tr_b16 a[210:211], v31 offset:512
  ds_read_b64_tr_b16 a[212:213], v31 offset:8192
  ds_read_b64_tr_b16 a[214:215], v31 offset:8704
  s_branch L_wr_22_e
L_wr_22_3:
  ds_read_b64_tr_b16 a[128:129], v30 offset:0
  ds_read_b64_tr_b16 a[130:131], v30 offset:512
  ds_read_b64_tr_b16 a[132:133], v30 offset:8192
  ds_read_b64_tr_b16 a[134:135], v30 offset:8704
  ds_read_b64_tr_b16 a[192:193], v31 offset:0
  ds_read_b64_tr_b16 a[194:195], v31 offset:512
  ds_read_b64_tr_b16 a[196:197], v31 offset:8192
  ds_read_b64_tr_b16 a[198:199], v31 offset:8704
L_wr_22_e:
  s_waitcnt lgkmcnt(0)
  s_waitcnt vmcnt(24)
  s_barrier
  s_add_u32 m0, s56, 98304
  s_mov_b32 s68, 3145728
  buffer_load_dwordx4 v26, s[48:51], s68 offen  lds
  s_add_u32 m0, s56, 102400
  s_mov_b32 s68, 3211264
  buffer_load_dwordx4 v26, s[48:51], s68 offen  lds
  s_add_u32 m0, s56, 106496
  s_mov_b32 s68, 3407872
  buffer_load_dwordx4 v26, s[48:51], s68 offen  lds
  s_add_u32 m0, s56, 110592
  s_mov_b32 s68, 3473408
  buffer_load_dwordx4 v26, s[48:51], s68 offen  lds
  v_add_u32 v30, 114688, v28
  v_add_u32 v31, 114688, v29
  s_cmp_lg_u32 s44, 0
  s_cbranch_scc1 L_wr_23_1
  ds_read_b64_tr_b16 a[184:185], v30 offset:0
  ds_read_b64_tr_b16 a[186:187], v30 offset:512
  ds_read_b64_tr_b16 a[188:189], v30 offset:8192
  ds_read_b64_tr_b16 a[190:191], v30 offset:8704
  ds_read_b64_tr_b16 a[248:249], v31 offset:0
  ds_read_b64_tr_b16 a[250:251], v31 offset:512
  ds_read_b64_tr_b16 a[252:253], v31 offset:8192
  ds_read_b64_tr_b16 a[254:255], v31 offset:8704
  s_branch L_wr_23_e
L_wr_23_1:
  s_cmp_lg_u32 s44, 1
  s_cbranch_scc1 L_wr_23_2
  ds_read_b64_tr_b16 a[168:169], v30 offset:0
  ds_read_b64_tr_b16 a[170:171], v30 offset:512
  ds_read_b64_tr_b16 a[172:173], v30 offset:8192
  ds_read_b64_tr_b16 a[174:175], v30 offset:8704
  ds_read_b64_tr_b16 a[232:233], v31 offset:0
  ds_read_b64_tr_b16 a[234:235], v31 offset:512
  ds_read_b64_tr_b16 a[236:237], v31 offset:8192
  ds_read_b64_tr_b16 a[238:239], v31 offset:8704
  s_branch L_wr_23_e
L_wr_23_2:
  s_cmp_lg_u32 s44, 2
  s_cbranch_scc1 L_wr_23_3
  ds_read_b64_tr_b16 a[152:153], v30 offset:0
  ds_read_b64_tr_b16 a[154:155], v30 offset:512
  ds_read_b64_tr_b16 a[156:157], v30 offset:8192
  ds_read_b64_tr_b16 a[158:159], v30 offset:8704
  ds_read_b64_tr_b16 a[216:217], v31 offset:0
  ds_read_b64_tr_b16 a[218:219], v31 offset:512
  ds_read_b64_tr_b16 a[220:221], v31 offset:8192
  ds_read_b64_tr_b16 a[222:223], v31 offset:8704
  s_branch L_wr_23_e
L_wr_23_3:
  ds_read_b64_tr_b16 a[136:137], v30 offset:0
  ds_read_b64_tr_b16 a[138:139], v30 offset:512
  ds_read_b64_tr_b16 a[140:141], v30 offset:8192
  ds_read_b64_tr_b16 a[142:143], v30 offset:8704
  ds_read_b64_tr_b16 a[200:201], v31 offset:0
  ds_read_b64_tr_b16 a[202:203], v31 offset:512
  ds_read_b64_tr_b16 a[204:205], v31 offset:8192
  ds_read_b64_tr_b16 a[206:207], v31 offset:8704
L_wr_23_e:
  s_waitcnt lgkmcnt(0)
  s_waitcnt vmcnt(24)
  s_barrier
  s_add_u32 m0, s56, 114688
  s_mov_b32 s68, 3670016
  buffer_load_dwordx4 v26, s[48:51], s68 offen  lds
  s_add_u32 m0, s56, 118784
  s_mov_b32 s68, 3735552
  buffer_load_dwordx4 v26, s[48:51], s68 offen  lds
  s_add_u32 m0, s56, 122880
  s_mov_b32 s68, 3932160
  buffer_load_dwordx4 v26, s[48:51], s68 offen  lds
  s_add_u32 m0, s56, 126976
  s_mov_b32 s68, 3997696
  buffer_load_dwordx4 v26, s[48:51], s68 offen  lds
  v_add_u32 v30, 0, v28
  v_add_u32 v31, 0, v29
  ds_read_b64_tr_b16 v[108:109], v30 offset:0
  ds_read_b64_tr_b16 v[110:111], v30 offset:512
  ds_read_b64_tr_b16 v[112:113], v30 offset:8192
  ds_read_b64_tr_b16 v[114:115], v30 offset:8704
  ds_read_b64_tr_b16 v[116:117], v31 offset:0
  ds_read_b64_tr_b16 v[118:119], v31 offset:512
  ds_read_b64_tr_b16 v[120:121], v31 offset:8192
  ds_read_b64_tr_b16 v[122:123], v31 offset:8704
  s_waitcnt lgkmcnt(0)
  s_barrier
  v_add_u32 v30, 0, v3
  ds_write_b128 v30, v[108:111] offset:0
  ds_write_b128 v30, v[112:115] offset:1024
  ds_write_b128 v30, v[116:119] offset:2048
  ds_write_b128 v30, v[120:123] offset:3072
  s_waitcnt lgkmcnt(0)
  s_waitcnt vmcnt(24)
  s_barrier
  v_add_u32 v30, 16384, v28
  v_add_u32 v31, 16384, v29
  ds_read_b64_tr_b16 v[108:109], v30 offset:0
  ds_read_b64_tr_b16 v[110:111], v30 offset:512
  ds_read_b64_tr_b16 v[112:113], v30 offset:8192
  ds_read_b64_tr_b16 v[114:115], v30 offset:8704
  ds_read_b64_tr_b16 v[116:117], v31 offset:0
  ds_read_b64_tr_b16 v[118:119], v31 offset:512
  ds_read_b64_tr_b16 v[120:121], v31 offset:8192
  ds_read_b64_tr_b16 v[122:123], v31 offset:8704
  s_waitcnt lgkmcnt(0)
  s_barrier
  v_add_u32 v30, 16384, v3
  ds_write_b128 v30, v[108:111] offset:0
  ds_write_b128 v30, v[112:115] offset:1024
  ds_write_b128 v30, v[116:119] offset:2048
  ds_write_b128 v30, v[120:123] offset:3072
  s_waitcnt lgkmcnt(0)
  s_waitcnt vmcnt(20)
  s_barrier
  v_add_u32 v30, 32768, v28
  v_add_u32 v31, 32768, v29
  ds_read_b64_tr_b16 v[108:109], v30 offset:0
  ds_read_b64_tr_b16 v[110:111], v30 offset:512
  ds_read_b64_tr_b16 v[112:113], v30 offset:8192
  ds_read_b64_tr_b16 v[114:115], v30 offset:8704
  ds_read_b64_tr_b16 v[116:117], v31 offset:0
  ds_read_b64_tr_b16 v[118:119], v31 offset:512
  ds_read_b64_tr_b16 v[120:121], v31 offset:8192
  ds_read_b64_tr_b16 v[122:123], v31 offset:8704
  s_waitcnt lgkmcnt(0)
  s_barrier
  v_add_u32 v30, 32768, v3
  ds_write_b128 v30, v[108:111] offset:0
  ds_write_b128 v30, v[112:115] offset:1024
  ds_write_b128 v30, v[116:119] offset:2048
  ds_write_b128 v30, v[120:123] offset:3072
  s_waitcnt lgkmcnt(0)
  s_waitcnt vmcnt(16)
  s_barrier
  v_add_u32 v30, 49152, v28
  v_add_u32 v31, 49152, v29
  ds_read_b64_tr_b16 v[108:109], v30 offset:0
  ds_read_b64_tr_b16 v[110:111], v30 offset:512
  ds_read_b64_tr_b16 v[112:113], v30 offset:8192
  ds_read_b64_tr_b16 v[114:115], v30 offset:8704
  ds_read_b64_tr_b16 v[116:117], v31 offset:0
  ds_read_b64_tr_b16 v[118:119], v31 offset:512
  ds_read_b64_tr_b16 v[120:121], v31 offset:8192
  ds_read_b64_tr_b16 v[122:123], v31 offset:8704
  s_waitcnt lgkmcnt(0)
  s_barrier
  v_add_u32 v30, 49152, v3
  ds_write_b128 v30, v[108:111] offset:0
  ds_write_b128 v30, v[112:115] offset:1024
  ds_write_b128 v30, v[116:119] offset:2048
  ds_write_b128 v30, v[120:123] offset:3072
  s_waitcnt lgkmcnt(0)
  s_waitcnt vmcnt(12)
  s_barrier
  v_add_u32 v30, 65536, v28
  v_add_u32 v31, 65536, v29
  ds_read_b64_tr_b16 v[108:109], v30 offset:0
  ds_read_b64_tr_b16 v[110:111], v30 offset:512
  ds_read_b64_tr_b16 v[112:113], v30 offset:8192
  ds_read_b64_tr_b16 v[114:115], v30 offset:8704
  ds_read_b64_tr_b16 v[116:117], v31 offset:0
  ds_read_b64_tr_b16 v[118:119], v31 offset:512
  ds_read_b64_tr_b16 v[120:121], v31 offset:8192
  ds_read_b64_tr_b16 v[122:123], v31 offset:8704
  s_waitcnt lgkmcnt(0)
  s_barrier
  v_add_u32 v30, 65536, v3
  ds_write_b128 v30, v[108:111] offset:0
  ds_write_b128 v30, v[112:115] offset:1024
  ds_write_b128 v30, v[116:119] offset:2048
  ds_write_b128 v30, v[120:123] offset:3072
  s_waitcnt lgkmcnt(0)
  s_waitcnt vmcnt(8)
  s_barrier
  v_add_u32 v30, 81920, v28
  v_add_u32 v31, 81920, v29
  ds_read_b64_tr_b16 v[108:109], v30 offset:0
  ds_read_b64_tr_b16 v[110:111], v30 offset:512
  ds_read_b64_tr_b16 v[112:113], v30 offset:8192
  ds_read_b64_tr_b16 v[114:115], v30 offset:8704
  ds_read_b64_tr_b16 v[116:117], v31 offset:0
  ds_read_b64_tr_b16 v[118:119], v31 offset:512
  ds_read_b64_tr_b16 v[120:121], v31 offset:8192
  ds_read_b64_tr_b16 v[122:123], v31 offset:8704
  s_waitcnt lgkmcnt(0)
  s_barrier
  v_add_u32 v30, 81920, v3
  ds_write_b128 v30, v[108:111] offset:0
  ds_write_b128 v30, v[112:115] offset:1024
  ds_write_b128 v30, v[116:119] offset:2048
  ds_write_b128 v30, v[120:123] offset:3072
  s_waitcnt lgkmcnt(0)
  s_waitcnt vmcnt(4)
  s_barrier
  v_add_u32 v30, 98304, v28
  v_add_u32 v31, 98304, v29
  ds_read_b64_tr_b16 v[108:109], v30 offset:0
  ds_read_b64_tr_b16 v[110:111], v30 offset:512
  ds_read_b64_tr_b16 v[112:113], v30 offset:8192
  ds_read_b64_tr_b16 v[114:115], v30 offset:8704
  ds_read_b64_tr_b16 v[116:117], v31 offset:0
  ds_read_b64_tr_b16 v[118:119], v31 offset:512
  ds_read_b64_tr_b16 v[120:121], v31 offset:8192
  ds_read_b64_tr_b16 v[122:123], v31 offset:8704
  s_waitcnt lgkmcnt(0)
  s_barrier
  v_add_u32 v30, 98304, v3
  ds_write_b128 v30, v[108:111] offset:0
  ds_write_b128 v30, v[112:115] offset:1024
  ds_write_b128 v30, v[116:119] offset:2048
  ds_write_b128 v30, v[120:123] offset:3072
  s_waitcnt lgkmcnt(0)
  s_waitcnt vmcnt(0)
  s_barrier
  v_add_u32 v30, 114688, v28
  v_add_u32 v31, 114688, v29
  ds_read_b64_tr_b16 v[108:109], v30 offset:0
  ds_read_b64_tr_b16 v[110:111], v30 offset:512
  ds_read_b64_tr_b16 v[112:113], v30 offset:8192
  ds_read_b64_tr_b16 v[114:115], v30 offset:8704
  ds_read_b64_tr_b16 v[116:117], v31 offset:0
  ds_read_b64_tr_b16 v[118:119], v31 offset:512
  ds_read_b64_tr_b16 v[120:121], v31 offset:8192
  ds_read_b64_tr_b16 v[122:123], v31 offset:8704
  s_waitcnt lgkmcnt(0)
  s_barrier
  v_add_u32 v30, 114688, v3
  ds_write_b128 v30, v[108:111] offset:0
  ds_write_b128 v30, v[112:115] offset:1024
  ds_write_b128 v30, v[116:119] offset:2048
  ds_write_b128 v30, v[120:123] offset:3072
  s_waitcnt lgkmcnt(0)
  s_lshl_b32 s68, s44, 15
  v_add_u32 v3, s68, v3
  v_and_b32 v22, 1, v0
  v_cmp_eq_u32 vcc, 1, v22
  v_mov_b32 v23, 0x44444444
  v_mov_b32 v24, 0xeeeeeeee
  v_cndmask_b32 v1, v23, v24, vcc
  s_mov_b32 s48, s22
  s_and_b32 s49, s23, 0xffff
  s_mov_b32 s50, 0x2000
  s_mov_b32 s51, 0x20000
  v_bfe_u32 v22, v0, 1, 3
  v_lshlrev_b32 v23, 10, v22
  v_lshrrev_b32 v22, 5, v0
  v_lshl_add_u32 v23, v22, 6, v23
  v_bfe_u32 v22, v0, 4, 1
  v_lshl_add_u32 v23, v22, 4, v23
  v_and_b32 v22, 1, v0
  v_lshl_add_u32 v23, v22, 3, v23
  s_lshl_b32 s68, s44, 8
  buffer_load_dwordx2 v[92:93], v23, s[48:51], s68 offen
  buffer_load_dwordx2 v[94:95], v23, s[48:51], s68 offen offset:32
  buffer_load_dwordx2 v[96:97], v23, s[48:51], s68 offen offset:128
  buffer_load_dwordx2 v[98:99], v23, s[48:51], s68 offen offset:160
  v_lshlrev_b32 v0, 4, v0
  v_add_u32 v0, 147456, v0
  s_mov_b32 s68, 0x05040100
  s_mov_b32 s69, 0x07060302
  s_waitcnt vmcnt(0)
  v_perm_b32 v20, v94, v92, s68
  v_perm_b32 v21, v94, v92, s69
  v_perm_b32 v22, v95, v93, s68
  v_perm_b32 v23, v95, v93, s69
  v_min_u32 v20, -2, v20
  v_min_u32 v21, -2, v21
  v_min_u32 v22, -2, v22
  v_min_u32 v23, -2, v23
  v_perm_b32 v24, v98, v96, s68
  v_perm_b32 v25, v98, v96, s69
  v_perm_b32 v26, v99, v97, s68
  v_perm_b32 v27, v99, v97, s69
  v_min_u32 v24, -2, v24
  v_min_u32 v25, -2, v25
  v_min_u32 v26, -2, v26
  v_min_u32 v27, -2, v27
L_team_init:
  buffer_load_dword v52, v17, s[52:55], 0 offen sc1
  s_add_u32 s67, s67, 1
  s_cmp_gt_u32 s67, 1048576
  s_cbranch_scc1 L_exit
  s_waitcnt vmcnt(0)
  v_cmp_gt_u32 vcc, 32, v52
  s_cbranch_vccnz L_team_init
  buffer_load_dword v52, v17, s[52:55], 0 offen offset:128 sc1
  s_mov_b32 s92, 2
L_fs_pre:
  buffer_load_dword v4, v17, s[40:43], s60 offen sc1
  s_add_u32 s67, s67, 1
  s_cmp_gt_u32 s67, 1048576
  s_cbranch_scc1 L_exit
  s_waitcnt vmcnt(0)
  v_cmp_gt_u32 vcc, s92, v4
  s_cbranch_vccnz L_fs_pre
  v_readfirstlane_b32 s69, v52
  s_mov_b32 m0, s70
  s_mov_b32 s57, s72
  buffer_load_dwordx4 v2, s[40:43], s57 offen sc1 lds
  buffer_load_dwordx4 v2, s[40:43], s57 offen offset:1024 sc1 lds
  s_mov_b32 s56, -1
  s_mov_b32 s65, 0
  s_lshl_b32 s61, s45, 12
  s_lshl_b32 s68, s44, 10
  s_sub_u32 s61, s61, s68
  s_add_u32 s61, s61, 0xbfc0000
  s_max_i32 s93, s56, 0
  s_add_u32 s56, s56, 1
  s_xor_b32 s65, s65, 1
  s_add_u32 s58, s57, 0x1000000
  s_add_u32 s68, s56, 1
  s_min_u32 s68, s68, 63
  s_lshl_b32 s68, s68, 13
  s_add_u32 s57, s72, s68
  s_add_u32 s59, s57, s73
  s_add_u32 s68, s56, 3
  s_min_u32 s92, s68, 64
  s_add_u32 s61, s61, 0x20000
  s_xor_b32 s70, s70, 0x2000
  ds_read_b128 v[76:79], v3 offset:0
  ds_read_b128 v[80:83], v3 offset:1024
  ds_read_b128 v[84:87], v3 offset:2048
  ds_read_b128 v[88:91], v3 offset:3072
  ds_read_b128 v[92:95], v3 offset:16384
  ds_read_b128 v[96:99], v3 offset:17408
  ds_read_b128 v[100:103], v3 offset:18432
  ds_read_b128 v[104:107], v3 offset:19456
  v_xor_b32 v3, 0x8000, v3
  ds_read_b128 v[108:111], v3 offset:0
  ds_read_b128 v[112:115], v3 offset:1024
  ds_read_b128 v[116:119], v3 offset:2048
  ds_read_b128 v[120:123], v3 offset:3072
  v_mov_b64 v[52:53], 0
  v_mov_b64 v[54:55], 0
  v_mov_b64 v[56:57], 0
  v_mov_b64 v[58:59], 0
  v_mov_b64 v[60:61], 0
  v_mov_b64 v[62:63], 0
  v_mov_b64 v[64:65], 0
  v_mov_b64 v[66:67], 0
  v_mov_b64 v[68:69], 0
  v_mov_b64 v[70:71], 0
  v_mov_b64 v[72:73], 0
  v_mov_b64 v[74:75], 0
  s_waitcnt vmcnt(0) lgkmcnt(0)
  v_xor_b32 v32, 2048, v11
  v_xor_b32 v40, 4096, v11
  v_xor_b32 v48, 6144, v11
  v_bfe_u32 v45, v2, 9, 1
  v_and_b32 v4, 0x1ff, v2
  v_lshlrev_b32 v4, 2, v4
  v_lshl_add_u32 v4, v45, 24, v4
  s_bcnt1_i32_b32 s69, s69
  s_cmp_eq_u32 s69, 1
  s_cbranch_scc0 L_entry_x
  s_branch L_entry_f
L_poll2_f:
  buffer_load_dwordx4 v[20:23], v11, s[40:43], s63 offen sc1
  buffer_load_dwordx4 v[24:27], v11, s[40:43], s63 offen offset:1024 sc1
  s_add_u32 s67, s67, 1
  s_cmp_gt_u32 s67, 1048576
  s_cbranch_scc1 L_exit
  s_nop 15
  s_nop 3
  buffer_load_dwordx4 v[28:31], v11, s[40:43], s63 offen sc1
  buffer_load_dwordx4 v[36:39], v11, s[40:43], s63 offen offset:1024 sc1
L_entry_f:
  s_waitcnt vmcnt(3)
  ds_write_b128 v11, v[20:23]
  v_smfmac_f32_16x16x64_bf16 v[52:55], v[20:23], a[0:7], v1
  s_waitcnt vmcnt(2)
  ds_write_b128 v11, v[24:27] offset:1024
  v_max3_u32 v44, v20, v21, v22
  v_smfmac_f32_16x16x64_bf16 v[56:59], v[20:23], a[64:71], v1
  v_max3_u32 v45, v23, v24, v25
  v_max3_u32 v44, v44, v26, v27
  v_smfmac_f32_16x16x64_bf16 v[52:55], v[24:27], a[8:15], v1
  v_max_u32 v44, v44, v45
  v_cmp_eq_u32 vcc, -1, v44
  v_smfmac_f32_16x16x64_bf16 v[56:59], v[24:27], a[72:79], v1
  s_mov_b32 m0, s71
  v_smfmac_f32_16x16x64_bf16 v[60:63], v[20:23], a[128:135], v1
  s_cbranch_vccnz L_retry2_f
  s_waitcnt vmcnt(0)
  v_smfmac_f32_16x16x64_bf16 v[64:67], v[20:23], a[192:199], v1
  buffer_load_dwordx4 v2, s[40:43], s58 offen offset:0 sc1 lds
  buffer_load_dwordx4 v2, s[40:43], s58 offen offset:1024 sc1 lds
  v_smfmac_f32_16x16x64_bf16 v[60:63], v[24:27], a[136:143], v1
  s_waitcnt lgkmcnt(0)
  s_barrier
  ds_read_b128 v[28:31], v32 offset:0
  v_smfmac_f32_16x16x64_bf16 v[64:67], v[24:27], a[200:207], v1
  ds_read_b128 v[32:35], v32 offset:1024
  ds_read_b128 v[36:39], v40 offset:0
  v_smfmac_f32_16x16x64_bf16 v[68:71], v[20:23], v[76:83], v1
  ds_read_b128 v[40:43], v40 offset:1024
  ds_read_b128 v[44:47], v48 offset:0
  v_smfmac_f32_16x16x64_bf16 v[72:75], v[20:23], v[84:91], v1
  ds_read_b128 v[48:51], v48 offset:1024
  v_smfmac_f32_16x16x64_bf16 v[68:71], v[24:27], v[92:99], v1
  buffer_load_dword v4, v4, s[40:43], s59 offen sc1
  v_mov_b32 v16, s93
  v_smfmac_f32_16x16x64_bf16 v[72:75], v[24:27], v[100:107], v1
  s_waitcnt lgkmcnt(5)
  ds_read_b128 v[76:79], v3 offset:16384
  v_smfmac_f32_16x16x64_bf16 v[52:55], v[28:31], a[16:23], v1
  s_waitcnt lgkmcnt(5)
  ds_read_b128 v[80:83], v3 offset:17408
  v_smfmac_f32_16x16x64_bf16 v[52:55], v[32:35], a[24:31], v1
  s_waitcnt lgkmcnt(5)
  ds_read_b128 v[84:87], v3 offset:18432
  v_smfmac_f32_16x16x64_bf16 v[52:55], v[36:39], a[32:39], v1
  s_waitcnt lgkmcnt(5)
  ds_read_b128 v[88:91], v3 offset:19456
  v_xor_b32 v3, 0x18000, v3
  v_smfmac_f32_16x16x64_bf16 v[52:55], v[40:43], a[40:47], v1
  s_waitcnt lgkmcnt(4)
  ds_read_b128 v[92:95], v0 offset:0
  buffer_load_dword v4, v17, s[40:43], s60 offen sc1
  v_smfmac_f32_16x16x64_bf16 v[52:55], v[44:47], a[48:55], v1
  ds_read_b128 v[96:99], v0 offset:2048
  v_smfmac_f32_16x16x64_bf16 v[52:55], v[48:51], a[56:63], v1
  ds_read_b128 v[100:103], v0 offset:4096
  buffer_store_dword v16, v17, s[40:43], s66 offen sc1
  v_smfmac_f32_16x16x64_bf16 v[68:71], v[28:31], v[108:115], v1
  s_mov_b32 m0, s70
  ds_read_b128 v[104:107], v0 offset:6144
  v_smfmac_f32_16x16x64_bf16 v[56:59], v[28:31], a[80:87], v1
  s_nop 0
  ds_read_b128 v[108:111], v3 offset:0
  v_add_f32 v52, v52, v53
  v_smfmac_f32_16x16x64_bf16 v[56:59], v[32:35], a[88:95], v1
  ds_read_b128 v[112:115], v3 offset:1024
  v_add_f32 v54, v54, v55
  v_smfmac_f32_16x16x64_bf16 v[72:75], v[28:31], v[116:123], v1
  ds_read_b128 v[20:23], v0 offset:1024
  v_mul_f32 v52, s88, v52
  v_smfmac_f32_16x16x64_bf16 v[56:59], v[36:39], a[96:103], v1
  ds_read_b128 v[116:119], v3 offset:2048
  v_mul_f32 v54, s88, v54
  v_smfmac_f32_16x16x64_bf16 v[56:59], v[40:43], a[104:111], v1
  ds_read_b128 v[120:123], v3 offset:3072
  v_cvt_pk_bf16_f32 v52, v52, v52
  v_smfmac_f32_16x16x64_bf16 v[56:59], v[44:47], a[112:119], v1
  ds_read_b128 v[24:27], v0 offset:3072
  v_cvt_pk_bf16_f32 v53, v54, v54
  v_smfmac_f32_16x16x64_bf16 v[56:59], v[48:51], a[120:127], v1
  s_waitcnt lgkmcnt(10)
  s_nop 0
  v_smfmac_f32_16x16x64_bf16 v[68:71], v[32:35], v[76:83], v1
  s_nop 0
  buffer_store_dwordx4 v[124:127], v2, s[40:43], s61 offen sc1
  v_smfmac_f32_16x16x64_bf16 v[72:75], v[32:35], v[84:91], v1
  s_nop 0
  ds_read_b128 v[76:79], v3 offset:16384
  v_add_f32 v56, v56, v57
  v_smfmac_f32_16x16x64_bf16 v[60:63], v[28:31], a[144:151], v1
  ds_read_b128 v[80:83], v3 offset:17408
  v_add_f32 v58, v58, v59
  v_smfmac_f32_16x16x64_bf16 v[60:63], v[32:35], a[152:159], v1
  s_waitcnt lgkmcnt(3)
  ds_read_b128 v[84:87], v3 offset:18432
  v_mul_f32 v56, s88, v56
  v_smfmac_f32_16x16x64_bf16 v[68:71], v[36:39], v[108:115], v1
  ds_read_b128 v[88:91], v3 offset:19456
  v_mul_f32 v58, s88, v58
  v_smfmac_f32_16x16x64_bf16 v[60:63], v[36:39], a[160:167], v1
  v_xor_b32 v3, 0x8000, v3
  v_cvt_pk_bf16_f32 v56, v56, v56
  v_smfmac_f32_16x16x64_bf16 v[72:75], v[36:39], v[116:123], v1
  ds_read_b128 v[108:111], v3 offset:0
  v_cvt_pk_bf16_f32 v57, v58, v58
  v_smfmac_f32_16x16x64_bf16 v[60:63], v[40:43], a[168:175], v1
  s_waitcnt lgkmcnt(3)
  ds_write2st64_b64 v5, v[52:53], v[56:57] offset0:0 offset1:4
  v_smfmac_f32_16x16x64_bf16 v[68:71], v[40:43], v[76:83], v1
  ds_read_b128 v[112:115], v3 offset:1024
  v_smfmac_f32_16x16x64_bf16 v[60:63], v[44:47], a[176:183], v1
  s_waitcnt lgkmcnt(3)
  ds_read_b128 v[116:119], v3 offset:16384
  v_smfmac_f32_16x16x64_bf16 v[72:75], v[40:43], v[84:91], v1
  ds_read_b128 v[120:123], v3 offset:17408
  v_smfmac_f32_16x16x64_bf16 v[60:63], v[48:51], a[184:191], v1
  v_smfmac_f32_16x16x64_bf16 v[64:67], v[28:31], a[208:215], v1
  s_waitcnt lgkmcnt(3)
  s_barrier
  v_smfmac_f32_16x16x64_bf16 v[64:67], v[32:35], a[216:223], v1
  s_waitcnt lgkmcnt(2)
  ds_read_b64_tr_b16 v[76:77], v6 offset:0
  ds_read_b64_tr_b16 v[78:79], v6 offset:2048
  v_smfmac_f32_16x16x64_bf16 v[68:71], v[44:47], v[108:115], v1
  ds_read_b64_tr_b16 v[80:81], v6 offset:512
  ds_read_b64_tr_b16 v[82:83], v6 offset:2560
  v_smfmac_f32_16x16x64_bf16 v[64:67], v[36:39], a[224:231], v1
  s_waitcnt lgkmcnt(4)
  ds_read_b64_tr_b16 v[84:85], v6 offset:1024
  ds_read_b64_tr_b16 v[86:87], v6 offset:3072
  v_smfmac_f32_16x16x64_bf16 v[68:71], v[48:51], v[116:123], v1
  ds_read_b64_tr_b16 v[88:89], v6 offset:1536
  ds_read_b64_tr_b16 v[90:91], v6 offset:3584
  v_smfmac_f32_16x16x64_bf16 v[64:67], v[40:43], a[232:239], v1
  ds_read_b128 v[28:31], v0 offset:5120
  v_add_f32 v60, v60, v61
  v_smfmac_f32_16x16x64_bf16 v[64:67], v[44:47], a[240:247], v1
  ds_read_b128 v[32:35], v0 offset:7168
  v_add_f32 v62, v62, v63
  v_smfmac_f32_16x16x64_bf16 v[64:67], v[48:51], a[248:255], v1
  s_waitcnt lgkmcnt(8)
  ds_read_b128 v[108:111], v3 offset:2048
  v_cvt_pk_bf16_f32 v124, v60, v62
  v_mfma_f32_16x16x32_bf16 v[52:55], v[92:95], v[76:79], 0
  s_waitcnt lgkmcnt(3)
  ds_read_b128 v[112:115], v3 offset:3072
  buffer_load_dwordx4 v2, s[40:43], s57 offen offset:0 sc1 lds
  v_mfma_f32_16x16x32_bf16 v[52:55], v[96:99], v[80:83], v[52:55]
  v_add_f32 v64, v64, v65
  v_add_f32 v66, v66, v67
  v_mfma_f32_16x16x32_bf16 v[52:55], v[100:103], v[84:87], v[52:55]
  ds_read_b128 v[116:119], v3 offset:18432
  v_cvt_pk_bf16_f32 v125, v64, v66
  v_mfma_f32_16x16x32_bf16 v[52:55], v[104:107], v[88:91], v[52:55]
  ds_write2st64_b32 v5, v124, v125 offset0:16 offset1:24
  v_add_f32 v68, v68, v69
  v_mfma_f32_16x16x32_bf16 v[56:59], v[20:23], v[76:79], 0
  s_waitcnt lgkmcnt(4)
  ds_read_b128 v[120:123], v3 offset:19456
  v_add_f32 v70, v70, v71
  v_mfma_f32_16x16x32_bf16 v[56:59], v[24:27], v[80:83], v[56:59]
  s_nop 0
  v_exp_f32 v20, v52
  v_mfma_f32_16x16x32_bf16 v[56:59], v[28:31], v[84:87], v[56:59]
  s_waitcnt vmcnt(5)
  v_exp_f32 v21, v53
  v_mfma_f32_16x16x32_bf16 v[56:59], v[32:35], v[88:91], v[56:59]
  s_waitcnt lgkmcnt(1)
  s_barrier
  ds_read_b64_tr_b16 v[92:93], v6 offset:4096
  ds_read_b64_tr_b16 v[94:95], v6 offset:6144
  ds_read_b64_tr_b16 v[96:97], v6 offset:4608
  ds_read_b64_tr_b16 v[98:99], v6 offset:6656
  v_smfmac_f32_16x16x64_bf16 v[72:75], v[44:47], v[108:115], v1
  s_waitcnt lgkmcnt(4)
  ds_read_b64_tr_b16 v[100:101], v6 offset:5120
  ds_read_b64_tr_b16 v[102:103], v6 offset:7168
  v_smfmac_f32_16x16x64_bf16 v[72:75], v[48:51], v[116:123], v1
  ds_read_b64_tr_b16 v[104:105], v6 offset:5632
  ds_read_b64_tr_b16 v[106:107], v6 offset:7680
  v_exp_f32 v22, v54
  v_exp_f32 v23, v55
  v_cvt_pk_bf16_f32 v24, v20, v21
  v_exp_f32 v20, v56
  s_waitcnt lgkmcnt(4)
  v_mfma_f32_16x16x32_bf16 v[60:63], v[92:95], v[76:79], 0
  ds_read_b128 v[36:39], v2 offset:8192
  ds_read_b128 v[40:43], v2 offset:9216
  v_mfma_f32_16x16x32_bf16 v[60:63], v[96:99], v[80:83], v[60:63]
  s_waitcnt lgkmcnt(2)
  v_cvt_pk_bf16_f32 v25, v22, v23
  v_exp_f32 v21, v57
  v_mfma_f32_16x16x32_bf16 v[60:63], v[100:103], v[84:87], v[60:63]
  v_exp_f32 v22, v58
  v_mfma_f32_16x16x32_bf16 v[60:63], v[104:107], v[88:91], v[60:63]
  s_cmp_eq_u32 s56, 63
  v_exp_f32 v23, v59
  v_cvt_pk_bf16_f32 v26, v20, v21
  v_cvt_pk_bf16_f32 v27, v22, v23
  v_add_f32 v72, v72, v73
  v_add_f32 v74, v74, v75
  v_mfma_f32_16x16x32_bf16 v[64:67], v[12:15], v[24:27], 0
  s_waitcnt lgkmcnt(0)
  v_exp_f32 v20, v60
  v_mfma_f32_16x16x32_bf16 v[80:83], v[36:39], v[24:27], 0
  v_exp_f32 v21, v61
  v_mfma_f32_16x16x32_bf16 v[84:87], v[40:43], v[24:27], 0
  v_cvt_pk_bf16_f32 v16, v20, v21
  v_cvt_pk_bf16_f32 v126, v68, v70
  v_cvt_pk_bf16_f32 v127, v72, v74
  v_mfma_f32_16x16x16_bf16 v[64:67], v[12:13], v[16:17], v[64:67]
  s_cbranch_scc1 L_team_last
  v_cvt_pk_bf16_f32 v19, v20, v21
  v_xor_b32 v3, 0x18000, v3
  v_mfma_f32_16x16x16_bf16 v[80:83], v[126:127], v[16:17], v[80:83]
  buffer_load_dwordx4 v2, s[40:43], s57 offen offset:1024 sc1 lds
  v_mov_b64 v[44:45], 0
  v_mov_b64 v[46:47], 0
  v_mfma_f32_16x16x16_bf16 v[84:87], v[126:127], v[18:19], v[84:87]
  v_rcp_f32 v65, v64
  v_subrev_u32 v66, s89, v64
  v_cmp_le_u32 vcc, s91, v66
  v_mov_b64 v[48:49], 0
L_smback_f:
  v_mul_f32 v80, v80, v65
  v_mul_f32 v81, v81, v65
  v_mul_f32 v82, v82, v65
  v_mul_f32 v83, v83, v65
  v_cvt_pk_bf16_f32 v88, v80, v81
  v_cvt_pk_bf16_f32 v89, v82, v83
  v_mul_f32 v84, v84, v65
  v_mul_f32 v85, v85, v65
  v_mul_f32 v86, v86, v65
  v_mul_f32 v87, v87, v65
  v_cvt_pk_bf16_f32 v90, v84, v85
  v_cvt_pk_bf16_f32 v91, v86, v87
  s_cbranch_vccnz L_smslow_f
  ds_write_b128 v7, v[88:91]
  v_mov_b64 v[50:51], 0
  v_mov_b64 v[36:37], 0
  v_mov_b64 v[38:39], 0
  v_mov_b64 v[40:41], 0
  v_mov_b64 v[42:43], 0
  v_xor_b32 v96, 512, v7
  v_xor_b32 v100, 1024, v7
  v_xor_b32 v104, 1536, v7
  v_lshrrev_b32 v24, 16, v12
  v_cndmask_b32 v24, v24, 1.0, s[94:95]
  s_waitcnt lgkmcnt(0)
  s_barrier
  ds_read_b128 v[96:99], v96
  ds_read_b128 v[100:103], v100
  ds_read_b128 v[104:107], v104
  v_smfmac_f32_16x16x64_bf16 v[36:39], v[88:91], v[128:135], v1
  v_cndmask_b32 v20, 0, v24, s[80:81]
  v_smfmac_f32_16x16x64_bf16 v[40:43], v[88:91], v[160:167], v1
  v_cndmask_b32 v21, 0, v24, s[82:83]
  v_smfmac_f32_16x16x64_bf16 v[44:47], v[88:91], v[192:199], v1
  v_cndmask_b32 v22, 0, v24, s[84:85]
  v_smfmac_f32_16x16x64_bf16 v[48:51], v[88:91], v[224:231], v1
  v_cndmask_b32 v23, 0, v24, s[86:87]
  s_waitcnt lgkmcnt(2)
  v_smfmac_f32_16x16x64_bf16 v[36:39], v[96:99], v[136:143], v1
  s_waitcnt lgkmcnt(1)
  v_mov_b64 v[52:53], 0
  v_smfmac_f32_16x16x64_bf16 v[36:39], v[100:103], v[144:151], v1
  s_waitcnt lgkmcnt(0)
  v_mov_b64 v[54:55], 0
  v_smfmac_f32_16x16x64_bf16 v[36:39], v[104:107], v[152:159], v1
  s_nop 1
  v_mov_b64 v[56:57], 0
  v_smfmac_f32_16x16x64_bf16 v[40:43], v[96:99], v[168:175], v1
  s_nop 1
  v_mov_b64 v[58:59], 0
  v_smfmac_f32_16x16x64_bf16 v[40:43], v[100:103], v[176:183], v1
  v_cvt_pk_bf16_f32 v36, v36, v37
  v_smfmac_f32_16x16x64_bf16 v[40:43], v[104:107], v[184:191], v1
  s_nop 1
  v_cvt_pk_bf16_f32 v37, v38, v39
  v_smfmac_f32_16x16x64_bf16 v[44:47], v[96:99], v[200:207], v1
  s_nop 1
  v_and_or_b32 v36, v36, -2, s65
  v_smfmac_f32_16x16x64_bf16 v[44:47], v[100:103], v[208:215], v1
  buffer_store_dwordx2 v[36:37], v8, s[40:43], s74 offen
  v_cvt_pk_bf16_f32 v40, v40, v41
  v_smfmac_f32_16x16x64_bf16 v[44:47], v[104:107], v[216:223], v1
  s_nop 1
  v_cvt_pk_bf16_f32 v41, v42, v43
  v_smfmac_f32_16x16x64_bf16 v[48:51], v[96:99], v[232:239], v1
  s_nop 1
  v_and_or_b32 v40, v40, -2, s65
  v_smfmac_f32_16x16x64_bf16 v[48:51], v[100:103], v[240:247], v1
  buffer_store_dwordx2 v[40:41], v8, s[40:43], s75 offen
  v_cvt_pk_bf16_f32 v44, v44, v45
  v_smfmac_f32_16x16x64_bf16 v[48:51], v[104:107], v[248:255], v1
  s_nop 1
  v_cvt_pk_bf16_f32 v45, v46, v47
  v_and_or_b32 v44, v44, -2, s65
  buffer_store_dwordx2 v[44:45], v8, s[40:43], s76 offen
  s_nop 2
  v_cvt_pk_bf16_f32 v48, v48, v49
  v_cvt_pk_bf16_f32 v49, v50, v51
  v_and_or_b32 v48, v48, -2, s65
  buffer_store_dwordx2 v[48:49], v8, s[40:43], s77 offen
  s_nop 15
  s_nop 9
  s_cmp_lt_u32 s44, 1
  s_cbranch_scc1 L_poll1_f
  s_nop 9
  s_cmp_lt_u32 s44, 2
  s_cbranch_scc1 L_poll1_f
  s_nop 9
  s_cmp_lt_u32 s44, 3
  s_cbranch_scc1 L_poll1_f
  s_nop 9
L_poll1_f:
  buffer_load_dwordx4 v[28:31], v9, s[40:43], s62 offen sc1
  buffer_load_dwordx4 v[32:35], v9, s[40:43], s62 offen offset:1024 sc1
  v_mov_b64 v[60:61], 0
  v_mov_b64 v[62:63], 0
  v_mov_b64 v[64:65], 0
  v_mov_b64 v[66:67], 0
  v_mov_b64 v[68:69], 0
  v_mov_b64 v[70:71], 0
  v_mov_b64 v[72:73], 0
  v_mov_b64 v[74:75], 0
  s_nop 15
  s_nop 3
  buffer_load_dwordx4 v[36:39], v9, s[40:43], s62 offen sc1
  buffer_load_dwordx4 v[40:43], v9, s[40:43], s62 offen offset:1024 sc1
L_poll1b_f:
  s_waitcnt vmcnt(3)
  v_mfma_f32_16x16x32_bf16 v[24:27], v[28:31], v[20:23], 0
  v_bitop3_b32 v44, v28, v30, s65 bitop3:0x7e
  s_waitcnt vmcnt(2)
  v_mfma_f32_16x16x32_bf16 v[24:27], v[32:35], v[20:23], v[24:27]
  v_bitop3_b32 v45, v32, v34, s65 bitop3:0x7e
  v_or_b32 v44, v44, v45
  v_and_b32 v44, 1, v44
  v_cmp_ne_u32 vcc, 0, v44
  s_nop 2
  s_cbranch_vccnz L_retry1_f
L_got1_f:
  v_add_f32 v24, v24, v25
  v_add_f32 v26, v26, v27
  s_nop 1
  v_permlane16_swap_b32 v24, v26
  v_add_f32 v24, v24, v26
  v_cvt_pk_bf16_f32 v24, v24, v17
  v_min_u32 v24, s90, v24
  v_cndmask_b32 v24, v24, -1, s[78:79]
  buffer_store_short v24, v10, s[40:43], s64 offen
  ds_read_b128 v[76:79], v3 offset:0
  ds_read_b128 v[80:83], v3 offset:1024
  ds_read_b128 v[84:87], v3 offset:2048
  ds_read_b128 v[88:91], v3 offset:3072
  ds_read_b128 v[92:95], v3 offset:16384
  ds_read_b128 v[96:99], v3 offset:17408
  ds_read_b128 v[100:103], v3 offset:18432
  ds_read_b128 v[104:107], v3 offset:19456
  v_xor_b32 v3, 0x8000, v3
  ds_read_b128 v[108:111], v3 offset:0
  ds_read_b128 v[112:115], v3 offset:1024
  ds_read_b128 v[116:119], v3 offset:2048
  ds_read_b128 v[120:123], v3 offset:3072
  v_cmp_gt_u32 vcc, s92, v4
  v_xor_b32 v10, 0x2000, v10
  v_xor_b32 v11, 0x2000, v11
  v_xor_b32 v0, 0x2000, v0
  s_waitcnt vmcnt(1)
  v_xor_b32 v32, 2048, v11
  v_xor_b32 v40, 4096, v11
  v_xor_b32 v48, 6144, v11
  s_cbranch_vccnz L_fs_f
L_fsback_f:
  v_bfe_u32 v45, v2, 9, 1
  v_and_b32 v4, 0x1ff, v2
  v_lshlrev_b32 v4, 2, v4
  v_lshl_add_u32 v4, v45, 24, v4
  s_max_i32 s93, s56, 0
  s_add_u32 s56, s56, 1
  s_xor_b32 s65, s65, 1
  s_add_u32 s58, s57, 0x1000000
  s_add_u32 s68, s56, 1
  s_min_u32 s68, s68, 63
  s_lshl_b32 s68, s68, 13
  s_add_u32 s57, s72, s68
  s_add_u32 s59, s57, s73
  s_add_u32 s68, s56, 3
  s_min_u32 s92, s68, 64
  s_add_u32 s61, s61, 0x20000
  s_xor_b32 s70, s70, 0x2000
  s_nop 9
  s_branch L_poll2_f
L_retry2_f:
  s_waitcnt vmcnt(0)
  v_max3_u32 v44, v28, v29, v30
  v_max3_u32 v45, v31, v36, v37
  v_max3_u32 v44, v44, v38, v39
  v_max_u32 v44, v44, v45
  v_cmp_eq_u32 vcc, -1, v44
  v_mov_b64 v[20:21], v[28:29]
  v_mov_b64 v[22:23], v[30:31]
  v_mov_b64 v[24:25], v[36:37]
  v_mov_b64 v[26:27], v[38:39]
  v_mov_b64 v[52:53], 0
  v_mov_b64 v[54:55], 0
  v_mov_b64 v[56:57], 0
  v_mov_b64 v[58:59], 0
  v_mov_b64 v[60:61], 0
  v_mov_b64 v[62:63], 0
  s_cbranch_vccnz L_poll2_f
  s_branch L_entry_f
L_retry1_f:
  buffer_load_dwordx4 v[28:31], v9, s[40:43], s62 offen sc1
  buffer_load_dwordx4 v[32:35], v9, s[40:43], s62 offen offset:1024 sc1
  s_add_u32 s67, s67, 1
  s_cmp_gt_u32 s67, 1048576
  s_cbranch_scc1 L_exit
  s_waitcnt vmcnt(3)
  v_mfma_f32_16x16x32_bf16 v[24:27], v[36:39], v[20:23], 0
  v_bitop3_b32 v44, v36, v38, s65 bitop3:0x7e
  s_waitcnt vmcnt(2)
  v_mfma_f32_16x16x32_bf16 v[24:27], v[40:43], v[20:23], v[24:27]
  v_bitop3_b32 v45, v40, v42, s65 bitop3:0x7e
  v_or_b32 v44, v44, v45
  v_and_b32 v44, 1, v44
  v_cmp_ne_u32 vcc, 0, v44
  s_nop 2
  s_cbranch_vccz L_got1_f
  buffer_load_dwordx4 v[36:39], v9, s[40:43], s62 offen sc1
  buffer_load_dwordx4 v[40:43], v9, s[40:43], s62 offen offset:1024 sc1
  s_branch L_poll1b_f
L_smslow_f:
  v_max3_f32 v22, v52, v53, v54
  v_max3_f32 v22, v22, v55, v56
  v_max3_f32 v22, v22, v57, v58
  v_max3_f32 v22, v22, v59, v60
  v_max_f32 v22, v22, v61
  v_mov_b32 v20, v22
  s_nop 1
  v_permlane32_swap_b32 v20, v22
  v_max_f32 v22, v22, v20
  v_mov_b32 v20, v22
  s_nop 1
  v_permlane16_swap_b32 v20, v22
  v_max_f32 v22, v22, v20
  v_sub_f32 v20, v52, v22
  v_sub_f32 v21, v53, v22
  v_exp_f32 v20, v20
  v_exp_f32 v21, v21
  s_nop 0
  v_cvt_pk_bf16_f32 v24, v20, v21
  v_sub_f32 v20, v54, v22
  v_sub_f32 v21, v55, v22
  v_exp_f32 v20, v20
  v_exp_f32 v21, v21
  s_nop 0
  v_cvt_pk_bf16_f32 v25, v20, v21
  v_sub_f32 v20, v56, v22
  v_sub_f32 v21, v57, v22
  v_exp_f32 v20, v20
  v_exp_f32 v21, v21
  s_nop 0
  v_cvt_pk_bf16_f32 v26, v20, v21
  v_sub_f32 v20, v58, v22
  v_sub_f32 v21, v59, v22
  v_exp_f32 v20, v20
  v_exp_f32 v21, v21
  s_nop 0
  v_cvt_pk_bf16_f32 v27, v20, v21
  v_sub_f32 v20, v60, v22
  v_sub_f32 v21, v61, v22
  v_exp_f32 v20, v20
  v_exp_f32 v21, v21
  s_nop 0
  v_cvt_pk_bf16_f32 v16, v20, v21
  v_cvt_pk_bf16_f32 v19, v20, v21
  s_nop 1
  v_mfma_f32_16x16x32_bf16 v[64:67], v[12:15], v[24:27], 0
  v_mfma_f32_16x16x32_bf16 v[80:83], v[36:39], v[24:27], 0
  v_mfma_f32_16x16x32_bf16 v[84:87], v[40:43], v[24:27], 0
  s_nop 3
  v_mfma_f32_16x16x16_bf16 v[64:67], v[12:13], v[16:17], v[64:67]
  v_mfma_f32_16x16x16_bf16 v[80:83], v[126:127], v[16:17], v[80:83]
  v_mfma_f32_16x16x16_bf16 v[84:87], v[126:127], v[18:19], v[84:87]
  s_nop 7
  v_rcp_f32 v65, v64
  s_mov_b64 vcc, 0
  s_branch L_smback_f
L_fs_f:
  buffer_load_dword v4, v17, s[40:43], s60 offen sc1
  s_add_u32 s67, s67, 1
  s_cmp_gt_u32 s67, 1048576
  s_cbranch_scc1 L_exit
  s_waitcnt vmcnt(0)
  v_cmp_gt_u32 vcc, s92, v4
  s_cbranch_vccnz L_fs_f
  s_branch L_fsback_f
L_poll2_x:
  buffer_load_dwordx4 v[20:23], v11, s[40:43], s63 offen sc1
  buffer_load_dwordx4 v[24:27], v11, s[40:43], s63 offen offset:1024 sc1
  s_add_u32 s67, s67, 1
  s_cmp_gt_u32 s67, 1048576
  s_cbranch_scc1 L_exit
  s_nop 15
  s_nop 3
  buffer_load_dwordx4 v[28:31], v11, s[40:43], s63 offen sc1
  buffer_load_dwordx4 v[36:39], v11, s[40:43], s63 offen offset:1024 sc1
L_entry_x:
  s_waitcnt vmcnt(3)
  ds_write_b128 v11, v[20:23]
  v_smfmac_f32_16x16x64_bf16 v[52:55], v[20:23], a[0:7], v1
  s_waitcnt vmcnt(2)
  ds_write_b128 v11, v[24:27] offset:1024
  v_max3_u32 v44, v20, v21, v22
  v_smfmac_f32_16x16x64_bf16 v[56:59], v[20:23], a[64:71], v1
  v_max3_u32 v45, v23, v24, v25
  v_max3_u32 v44, v44, v26, v27
  v_smfmac_f32_16x16x64_bf16 v[52:55], v[24:27], a[8:15], v1
  v_max_u32 v44, v44, v45
  v_cmp_eq_u32 vcc, -1, v44
  v_smfmac_f32_16x16x64_bf16 v[56:59], v[24:27], a[72:79], v1
  s_mov_b32 m0, s71
  v_smfmac_f32_16x16x64_bf16 v[60:63], v[20:23], a[128:135], v1
  s_cbranch_vccnz L_retry2_x
  s_waitcnt vmcnt(0)
  v_smfmac_f32_16x16x64_bf16 v[64:67], v[20:23], a[192:199], v1
  buffer_load_dwordx4 v2, s[40:43], s58 offen offset:0 sc1 lds
  buffer_load_dwordx4 v2, s[40:43], s58 offen offset:1024 sc1 lds
  v_smfmac_f32_16x16x64_bf16 v[60:63], v[24:27], a[136:143], v1
  s_waitcnt lgkmcnt(0)
  s_barrier
  ds_read_b128 v[28:31], v32 offset:0
  v_smfmac_f32_16x16x64_bf16 v[64:67], v[24:27], a[200:207], v1
  ds_read_b128 v[32:35], v32 offset:1024
  ds_read_b128 v[36:39], v40 offset:0
  v_smfmac_f32_16x16x64_bf16 v[68:71], v[20:23], v[76:83], v1
  ds_read_b128 v[40:43], v40 offset:1024
  ds_read_b128 v[44:47], v48 offset:0
  v_smfmac_f32_16x16x64_bf16 v[72:75], v[20:23], v[84:91], v1
  ds_read_b128 v[48:51], v48 offset:1024
  v_smfmac_f32_16x16x64_bf16 v[68:71], v[24:27], v[92:99], v1
  buffer_load_dword v4, v4, s[40:43], s59 offen sc1
  v_mov_b32 v16, s93
  v_smfmac_f32_16x16x64_bf16 v[72:75], v[24:27], v[100:107], v1
  s_waitcnt lgkmcnt(5)
  ds_read_b128 v[76:79], v3 offset:16384
  v_smfmac_f32_16x16x64_bf16 v[52:55], v[28:31], a[16:23], v1
  s_waitcnt lgkmcnt(5)
  ds_read_b128 v[80:83], v3 offset:17408
  v_smfmac_f32_16x16x64_bf16 v[52:55], v[32:35], a[24:31], v1
  s_waitcnt lgkmcnt(5)
  ds_read_b128 v[84:87], v3 offset:18432
  v_smfmac_f32_16x16x64_bf16 v[52:55], v[36:39], a[32:39], v1
  s_waitcnt lgkmcnt(5)
  ds_read_b128 v[88:91], v3 offset:19456
  v_xor_b32 v3, 0x18000, v3
  v_smfmac_f32_16x16x64_bf16 v[52:55], v[40:43], a[40:47], v1
  s_waitcnt lgkmcnt(4)
  ds_read_b128 v[92:95], v0 offset:0
  buffer_load_dword v4, v17, s[40:43], s60 offen sc1
  v_smfmac_f32_16x16x64_bf16 v[52:55], v[44:47], a[48:55], v1
  ds_read_b128 v[96:99], v0 offset:2048
  v_smfmac_f32_16x16x64_bf16 v[52:55], v[48:51], a[56:63], v1
  ds_read_b128 v[100:103], v0 offset:4096
  buffer_store_dword v16, v17, s[40:43], s66 offen sc1
  v_smfmac_f32_16x16x64_bf16 v[68:71], v[28:31], v[108:115], v1
  s_mov_b32 m0, s70
  ds_read_b128 v[104:107], v0 offset:6144
  v_smfmac_f32_16x16x64_bf16 v[56:59], v[28:31], a[80:87], v1
  s_nop 0
  ds_read_b128 v[108:111], v3 offset:0
  v_add_f32 v52, v52, v53
  v_smfmac_f32_16x16x64_bf16 v[56:59], v[32:35], a[88:95], v1
  ds_read_b128 v[112:115], v3 offset:1024
  v_add_f32 v54, v54, v55
  v_smfmac_f32_16x16x64_bf16 v[72:75], v[28:31], v[116:123], v1
  ds_read_b128 v[20:23], v0 offset:1024
  v_mul_f32 v52, s88, v52
  v_smfmac_f32_16x16x64_bf16 v[56:59], v[36:39], a[96:103], v1
  ds_read_b128 v[116:119], v3 offset:2048
  v_mul_f32 v54, s88, v54
  v_smfmac_f32_16x16x64_bf16 v[56:59], v[40:43], a[104:111], v1
  ds_read_b128 v[120:123], v3 offset:3072
  v_cvt_pk_bf16_f32 v52, v52, v52
  v_smfmac_f32_16x16x64_bf16 v[56:59], v[44:47], a[112:119], v1
  ds_read_b128 v[24:27], v0 offset:3072
  v_cvt_pk_bf16_f32 v53, v54, v54
  v_smfmac_f32_16x16x64_bf16 v[56:59], v[48:51], a[120:127], v1
  s_waitcnt lgkmcnt(10)
  s_nop 0
  v_smfmac_f32_16x16x64_bf16 v[68:71], v[32:35], v[76:83], v1
  s_nop 0
  buffer_store_dwordx4 v[124:127], v2, s[40:43], s61 offen sc1
  v_smfmac_f32_16x16x64_bf16 v[72:75], v[32:35], v[84:91], v1
  s_nop 0
  ds_read_b128 v[76:79], v3 offset:16384
  v_add_f32 v56, v56, v57
  v_smfmac_f32_16x16x64_bf16 v[60:63], v[28:31], a[144:151], v1
  ds_read_b128 v[80:83], v3 offset:17408
  v_add_f32 v58, v58, v59
  v_smfmac_f32_16x16x64_bf16 v[60:63], v[32:35], a[152:159], v1
  s_waitcnt lgkmcnt(3)
  ds_read_b128 v[84:87], v3 offset:18432
  v_mul_f32 v56, s88, v56
  v_smfmac_f32_16x16x64_bf16 v[68:71], v[36:39], v[108:115], v1
  ds_read_b128 v[88:91], v3 offset:19456
  v_mul_f32 v58, s88, v58
  v_smfmac_f32_16x16x64_bf16 v[60:63], v[36:39], a[160:167], v1
  v_xor_b32 v3, 0x8000, v3
  v_cvt_pk_bf16_f32 v56, v56, v56
  v_smfmac_f32_16x16x64_bf16 v[72:75], v[36:39], v[116:123], v1
  ds_read_b128 v[108:111], v3 offset:0
  v_cvt_pk_bf16_f32 v57, v58, v58
  v_smfmac_f32_16x16x64_bf16 v[60:63], v[40:43], a[168:175], v1
  s_waitcnt lgkmcnt(3)
  ds_write2st64_b64 v5, v[52:53], v[56:57] offset0:0 offset1:4
  v_smfmac_f32_16x16x64_bf16 v[68:71], v[40:43], v[76:83], v1
  ds_read_b128 v[112:115], v3 offset:1024
  v_smfmac_f32_16x16x64_bf16 v[60:63], v[44:47], a[176:183], v1
  s_waitcnt lgkmcnt(3)
  ds_read_b128 v[116:119], v3 offset:16384
  v_smfmac_f32_16x16x64_bf16 v[72:75], v[40:43], v[84:91], v1
  ds_read_b128 v[120:123], v3 offset:17408
  v_smfmac_f32_16x16x64_bf16 v[60:63], v[48:51], a[184:191], v1
  v_smfmac_f32_16x16x64_bf16 v[64:67], v[28:31], a[208:215], v1
  s_waitcnt lgkmcnt(3)
  s_barrier
  v_smfmac_f32_16x16x64_bf16 v[64:67], v[32:35], a[216:223], v1
  s_waitcnt lgkmcnt(2)
  ds_read_b64_tr_b16 v[76:77], v6 offset:0
  ds_read_b64_tr_b16 v[78:79], v6 offset:2048
  v_smfmac_f32_16x16x64_bf16 v[68:71], v[44:47], v[108:115], v1
  ds_read_b64_tr_b16 v[80:81], v6 offset:512
  ds_read_b64_tr_b16 v[82:83], v6 offset:2560
  v_smfmac_f32_16x16x64_bf16 v[64:67], v[36:39], a[224:231], v1
  s_waitcnt lgkmcnt(4)
  ds_read_b64_tr_b16 v[84:85], v6 offset:1024
  ds_read_b64_tr_b16 v[86:87], v6 offset:3072
  v_smfmac_f32_16x16x64_bf16 v[68:71], v[48:51], v[116:123], v1
  ds_read_b64_tr_b16 v[88:89], v6 offset:1536
  ds_read_b64_tr_b16 v[90:91], v6 offset:3584
  v_smfmac_f32_16x16x64_bf16 v[64:67], v[40:43], a[232:239], v1
  ds_read_b128 v[28:31], v0 offset:5120
  v_add_f32 v60, v60, v61
  v_smfmac_f32_16x16x64_bf16 v[64:67], v[44:47], a[240:247], v1
  ds_read_b128 v[32:35], v0 offset:7168
  v_add_f32 v62, v62, v63
  v_smfmac_f32_16x16x64_bf16 v[64:67], v[48:51], a[248:255], v1
  s_waitcnt lgkmcnt(8)
  ds_read_b128 v[108:111], v3 offset:2048
  v_cvt_pk_bf16_f32 v124, v60, v62
  v_mfma_f32_16x16x32_bf16 v[52:55], v[92:95], v[76:79], 0
  s_waitcnt lgkmcnt(3)
  ds_read_b128 v[112:115], v3 offset:3072
  buffer_load_dwordx4 v2, s[40:43], s57 offen offset:0 sc1 lds
  v_mfma_f32_16x16x32_bf16 v[52:55], v[96:99], v[80:83], v[52:55]
  v_add_f32 v64, v64, v65
  v_add_f32 v66, v66, v67
  v_mfma_f32_16x16x32_bf16 v[52:55], v[100:103], v[84:87], v[52:55]
  ds_read_b128 v[116:119], v3 offset:18432
  v_cvt_pk_bf16_f32 v125, v64, v66
  v_mfma_f32_16x16x32_bf16 v[52:55], v[104:107], v[88:91], v[52:55]
  ds_write2st64_b32 v5, v124, v125 offset0:16 offset1:24
  v_add_f32 v68, v68, v69
  v_mfma_f32_16x16x32_bf16 v[56:59], v[20:23], v[76:79], 0
  s_waitcnt lgkmcnt(4)
  ds_read_b128 v[120:123], v3 offset:19456
  v_add_f32 v70, v70, v71
  v_mfma_f32_16x16x32_bf16 v[56:59], v[24:27], v[80:83], v[56:59]
  s_nop 0
  v_exp_f32 v20, v52
  v_mfma_f32_16x16x32_bf16 v[56:59], v[28:31], v[84:87], v[56:59]
  s_waitcnt vmcnt(5)
  v_exp_f32 v21, v53
  v_mfma_f32_16x16x32_bf16 v[56:59], v[32:35], v[88:91], v[56:59]
  s_waitcnt lgkmcnt(1)
  s_barrier
  ds_read_b64_tr_b16 v[92:93], v6 offset:4096
  ds_read_b64_tr_b16 v[94:95], v6 offset:6144
  ds_read_b64_tr_b16 v[96:97], v6 offset:4608
  ds_read_b64_tr_b16 v[98:99], v6 offset:6656
  v_smfmac_f32_16x16x64_bf16 v[72:75], v[44:47], v[108:115], v1
  s_waitcnt lgkmcnt(4)
  ds_read_b64_tr_b16 v[100:101], v6 offset:5120
  ds_read_b64_tr_b16 v[102:103], v6 offset:7168
  v_smfmac_f32_16x16x64_bf16 v[72:75], v[48:51], v[116:123], v1
  ds_read_b64_tr_b16 v[104:105], v6 offset:5632
  ds_read_b64_tr_b16 v[106:107], v6 offset:7680
  v_exp_f32 v22, v54
  v_exp_f32 v23, v55
  v_cvt_pk_bf16_f32 v24, v20, v21
  v_exp_f32 v20, v56
  s_waitcnt lgkmcnt(4)
  v_mfma_f32_16x16x32_bf16 v[60:63], v[92:95], v[76:79], 0
  ds_read_b128 v[36:39], v2 offset:8192
  ds_read_b128 v[40:43], v2 offset:9216
  v_mfma_f32_16x16x32_bf16 v[60:63], v[96:99], v[80:83], v[60:63]
  s_waitcnt lgkmcnt(2)
  v_cvt_pk_bf16_f32 v25, v22, v23
  v_exp_f32 v21, v57
  v_mfma_f32_16x16x32_bf16 v[60:63], v[100:103], v[84:87], v[60:63]
  v_exp_f32 v22, v58
  v_mfma_f32_16x16x32_bf16 v[60:63], v[104:107], v[88:91], v[60:63]
  s_cmp_eq_u32 s56, 63
  v_exp_f32 v23, v59
  v_cvt_pk_bf16_f32 v26, v20, v21
  v_cvt_pk_bf16_f32 v27, v22, v23
  v_add_f32 v72, v72, v73
  v_add_f32 v74, v74, v75
  v_mfma_f32_16x16x32_bf16 v[64:67], v[12:15], v[24:27], 0
  s_waitcnt lgkmcnt(0)
  v_exp_f32 v20, v60
  v_mfma_f32_16x16x32_bf16 v[80:83], v[36:39], v[24:27], 0
  v_exp_f32 v21, v61
  v_mfma_f32_16x16x32_bf16 v[84:87], v[40:43], v[24:27], 0
  v_cvt_pk_bf16_f32 v16, v20, v21
  v_cvt_pk_bf16_f32 v126, v68, v70
  v_cvt_pk_bf16_f32 v127, v72, v74
  v_mfma_f32_16x16x16_bf16 v[64:67], v[12:13], v[16:17], v[64:67]
  s_cbranch_scc1 L_team_last
  v_cvt_pk_bf16_f32 v19, v20, v21
  v_xor_b32 v3, 0x18000, v3
  v_mfma_f32_16x16x16_bf16 v[80:83], v[126:127], v[16:17], v[80:83]
  buffer_load_dwordx4 v2, s[40:43], s57 offen offset:1024 sc1 lds
  v_mov_b64 v[44:45], 0
  v_mov_b64 v[46:47], 0
  v_mfma_f32_16x16x16_bf16 v[84:87], v[126:127], v[18:19], v[84:87]
  v_rcp_f32 v65, v64
  v_subrev_u32 v66, s89, v64
  v_cmp_le_u32 vcc, s91, v66
  v_mov_b64 v[48:49], 0
L_smback_x:
  v_mul_f32 v80, v80, v65
  v_mul_f32 v81, v81, v65
  v_mul_f32 v82, v82, v65
  v_mul_f32 v83, v83, v65
  v_cvt_pk_bf16_f32 v88, v80, v81
  v_cvt_pk_bf16_f32 v89, v82, v83
  v_mul_f32 v84, v84, v65
  v_mul_f32 v85, v85, v65
  v_mul_f32 v86, v86, v65
  v_mul_f32 v87, v87, v65
  v_cvt_pk_bf16_f32 v90, v84, v85
  v_cvt_pk_bf16_f32 v91, v86, v87
  s_cbranch_vccnz L_smslow_x
  ds_write_b128 v7, v[88:91]
  v_mov_b64 v[50:51], 0
  v_mov_b64 v[36:37], 0
  v_mov_b64 v[38:39], 0
  v_mov_b64 v[40:41], 0
  v_mov_b64 v[42:43], 0
  v_xor_b32 v96, 512, v7
  v_xor_b32 v100, 1024, v7
  v_xor_b32 v104, 1536, v7
  v_lshrrev_b32 v24, 16, v12
  v_cndmask_b32 v24, v24, 1.0, s[94:95]
  s_waitcnt lgkmcnt(0)
  s_barrier
  ds_read_b128 v[96:99], v96
  ds_read_b128 v[100:103], v100
  ds_read_b128 v[104:107], v104
  v_smfmac_f32_16x16x64_bf16 v[36:39], v[88:91], v[128:135], v1
  v_cndmask_b32 v20, 0, v24, s[80:81]
  v_smfmac_f32_16x16x64_bf16 v[40:43], v[88:91], v[160:167], v1
  v_cndmask_b32 v21, 0, v24, s[82:83]
  v_smfmac_f32_16x16x64_bf16 v[44:47], v[88:91], v[192:199], v1
  v_cndmask_b32 v22, 0, v24, s[84:85]
  v_smfmac_f32_16x16x64_bf16 v[48:51], v[88:91], v[224:231], v1
  v_cndmask_b32 v23, 0, v24, s[86:87]
  s_waitcnt lgkmcnt(2)
  v_smfmac_f32_16x16x64_bf16 v[36:39], v[96:99], v[136:143], v1
  s_waitcnt lgkmcnt(1)
  v_mov_b64 v[52:53], 0
  v_smfmac_f32_16x16x64_bf16 v[36:39], v[100:103], v[144:151], v1
  s_waitcnt lgkmcnt(0)
  v_mov_b64 v[54:55], 0
  v_smfmac_f32_16x16x64_bf16 v[36:39], v[104:107], v[152:159], v1
  s_nop 1
  v_mov_b64 v[56:57], 0
  v_smfmac_f32_16x16x64_bf16 v[40:43], v[96:99], v[168:175], v1
  s_nop 1
  v_mov_b64 v[58:59], 0
  v_smfmac_f32_16x16x64_bf16 v[40:43], v[100:103], v[176:183], v1
  v_cvt_pk_bf16_f32 v36, v36, v37
  v_smfmac_f32_16x16x64_bf16 v[40:43], v[104:107], v[184:191], v1
  s_nop 1
  v_cvt_pk_bf16_f32 v37, v38, v39
  v_smfmac_f32_16x16x64_bf16 v[44:47], v[96:99], v[200:207], v1
  s_nop 1
  v_and_or_b32 v36, v36, -2, s65
  v_smfmac_f32_16x16x64_bf16 v[44:47], v[100:103], v[208:215], v1
  buffer_store_dwordx2 v[36:37], v8, s[40:43], s74 offen sc1
  v_cvt_pk_bf16_f32 v40, v40, v41
  v_smfmac_f32_16x16x64_bf16 v[44:47], v[104:107], v[216:223], v1
  s_nop 1
  v_cvt_pk_bf16_f32 v41, v42, v43
  v_smfmac_f32_16x16x64_bf16 v[48:51], v[96:99], v[232:239], v1
  s_nop 1
  v_and_or_b32 v40, v40, -2, s65
  v_smfmac_f32_16x16x64_bf16 v[48:51], v[100:103], v[240:247], v1
  buffer_store_dwordx2 v[40:41], v8, s[40:43], s75 offen sc1
  v_cvt_pk_bf16_f32 v44, v44, v45
  v_smfmac_f32_16x16x64_bf16 v[48:51], v[104:107], v[248:255], v1
  s_nop 1
  v_cvt_pk_bf16_f32 v45, v46, v47
  v_and_or_b32 v44, v44, -2, s65
  buffer_store_dwordx2 v[44:45], v8, s[40:43], s76 offen sc1
  s_nop 2
  v_cvt_pk_bf16_f32 v48, v48, v49
  v_cvt_pk_bf16_f32 v49, v50, v51
  v_and_or_b32 v48, v48, -2, s65
  buffer_store_dwordx2 v[48:49], v8, s[40:43], s77 offen sc1
  s_nop 15
  s_nop 9
  s_cmp_lt_u32 s44, 1
  s_cbranch_scc1 L_poll1_x
  s_nop 9
  s_cmp_lt_u32 s44, 2
  s_cbranch_scc1 L_poll1_x
  s_nop 9
  s_cmp_lt_u32 s44, 3
  s_cbranch_scc1 L_poll1_x
  s_nop 9
L_poll1_x:
  buffer_load_dwordx4 v[28:31], v9, s[40:43], s62 offen sc1
  buffer_load_dwordx4 v[32:35], v9, s[40:43], s62 offen offset:1024 sc1
  v_mov_b64 v[60:61], 0
  v_mov_b64 v[62:63], 0
  v_mov_b64 v[64:65], 0
  v_mov_b64 v[66:67], 0
  v_mov_b64 v[68:69], 0
  v_mov_b64 v[70:71], 0
  v_mov_b64 v[72:73], 0
  v_mov_b64 v[74:75], 0
  s_nop 15
  s_nop 3
  buffer_load_dwordx4 v[36:39], v9, s[40:43], s62 offen sc1
  buffer_load_dwordx4 v[40:43], v9, s[40:43], s62 offen offset:1024 sc1
L_poll1b_x:
  s_waitcnt vmcnt(3)
  v_mfma_f32_16x16x32_bf16 v[24:27], v[28:31], v[20:23], 0
  v_bitop3_b32 v44, v28, v30, s65 bitop3:0x7e
  s_waitcnt vmcnt(2)
  v_mfma_f32_16x16x32_bf16 v[24:27], v[32:35], v[20:23], v[24:27]
  v_bitop3_b32 v45, v32, v34, s65 bitop3:0x7e
  v_or_b32 v44, v44, v45
  v_and_b32 v44, 1, v44
  v_cmp_ne_u32 vcc, 0, v44
  s_nop 2
  s_cbranch_vccnz L_retry1_x
L_got1_x:
  v_add_f32 v24, v24, v25
  v_add_f32 v26, v26, v27
  s_nop 1
  v_permlane16_swap_b32 v24, v26
  v_add_f32 v24, v24, v26
  v_cvt_pk_bf16_f32 v24, v24, v17
  v_min_u32 v24, s90, v24
  v_cndmask_b32 v24, v24, -1, s[78:79]
  buffer_store_short v24, v10, s[40:43], s64 offen sc1
  ds_read_b128 v[76:79], v3 offset:0
  ds_read_b128 v[80:83], v3 offset:1024
  ds_read_b128 v[84:87], v3 offset:2048
  ds_read_b128 v[88:91], v3 offset:3072
  ds_read_b128 v[92:95], v3 offset:16384
  ds_read_b128 v[96:99], v3 offset:17408
  ds_read_b128 v[100:103], v3 offset:18432
  ds_read_b128 v[104:107], v3 offset:19456
  v_xor_b32 v3, 0x8000, v3
  ds_read_b128 v[108:111], v3 offset:0
  ds_read_b128 v[112:115], v3 offset:1024
  ds_read_b128 v[116:119], v3 offset:2048
  ds_read_b128 v[120:123], v3 offset:3072
  v_cmp_gt_u32 vcc, s92, v4
  v_xor_b32 v10, 0x2000, v10
  v_xor_b32 v11, 0x2000, v11
  v_xor_b32 v0, 0x2000, v0
  s_waitcnt vmcnt(1)
  v_xor_b32 v32, 2048, v11
  v_xor_b32 v40, 4096, v11
  v_xor_b32 v48, 6144, v11
  s_cbranch_vccnz L_fs_x
L_fsback_x:
  v_bfe_u32 v45, v2, 9, 1
  v_and_b32 v4, 0x1ff, v2
  v_lshlrev_b32 v4, 2, v4
  v_lshl_add_u32 v4, v45, 24, v4
  s_max_i32 s93, s56, 0
  s_add_u32 s56, s56, 1
  s_xor_b32 s65, s65, 1
  s_add_u32 s58, s57, 0x1000000
  s_add_u32 s68, s56, 1
  s_min_u32 s68, s68, 63
  s_lshl_b32 s68, s68, 13
  s_add_u32 s57, s72, s68
  s_add_u32 s59, s57, s73
  s_add_u32 s68, s56, 3
  s_min_u32 s92, s68, 64
  s_add_u32 s61, s61, 0x20000
  s_xor_b32 s70, s70, 0x2000
  s_nop 9
  s_branch L_poll2_x
L_retry2_x:
  s_waitcnt vmcnt(0)
  v_max3_u32 v44, v28, v29, v30
  v_max3_u32 v45, v31, v36, v37
  v_max3_u32 v44, v44, v38, v39
  v_max_u32 v44, v44, v45
  v_cmp_eq_u32 vcc, -1, v44
  v_mov_b64 v[20:21], v[28:29]
  v_mov_b64 v[22:23], v[30:31]
  v_mov_b64 v[24:25], v[36:37]
  v_mov_b64 v[26:27], v[38:39]
  v_mov_b64 v[52:53], 0
  v_mov_b64 v[54:55], 0
  v_mov_b64 v[56:57], 0
  v_mov_b64 v[58:59], 0
  v_mov_b64 v[60:61], 0
  v_mov_b64 v[62:63], 0
  s_cbranch_vccnz L_poll2_x
  s_branch L_entry_x
L_retry1_x:
  buffer_load_dwordx4 v[28:31], v9, s[40:43], s62 offen sc1
  buffer_load_dwordx4 v[32:35], v9, s[40:43], s62 offen offset:1024 sc1
  s_add_u32 s67, s67, 1
  s_cmp_gt_u32 s67, 1048576
  s_cbranch_scc1 L_exit
  s_waitcnt vmcnt(3)
  v_mfma_f32_16x16x32_bf16 v[24:27], v[36:39], v[20:23], 0
  v_bitop3_b32 v44, v36, v38, s65 bitop3:0x7e
  s_waitcnt vmcnt(2)
  v_mfma_f32_16x16x32_bf16 v[24:27], v[40:43], v[20:23], v[24:27]
  v_bitop3_b32 v45, v40, v42, s65 bitop3:0x7e
  v_or_b32 v44, v44, v45
  v_and_b32 v44, 1, v44
  v_cmp_ne_u32 vcc, 0, v44
  s_nop 2
  s_cbranch_vccz L_got1_x
  buffer_load_dwordx4 v[36:39], v9, s[40:43], s62 offen sc1
  buffer_load_dwordx4 v[40:43], v9, s[40:43], s62 offen offset:1024 sc1
  s_branch L_poll1b_x
L_smslow_x:
  v_max3_f32 v22, v52, v53, v54
  v_max3_f32 v22, v22, v55, v56
  v_max3_f32 v22, v22, v57, v58
  v_max3_f32 v22, v22, v59, v60
  v_max_f32 v22, v22, v61
  v_mov_b32 v20, v22
  s_nop 1
  v_permlane32_swap_b32 v20, v22
  v_max_f32 v22, v22, v20
  v_mov_b32 v20, v22
  s_nop 1
  v_permlane16_swap_b32 v20, v22
  v_max_f32 v22, v22, v20
  v_sub_f32 v20, v52, v22
  v_sub_f32 v21, v53, v22
  v_exp_f32 v20, v20
  v_exp_f32 v21, v21
  s_nop 0
  v_cvt_pk_bf16_f32 v24, v20, v21
  v_sub_f32 v20, v54, v22
  v_sub_f32 v21, v55, v22
  v_exp_f32 v20, v20
  v_exp_f32 v21, v21
  s_nop 0
  v_cvt_pk_bf16_f32 v25, v20, v21
  v_sub_f32 v20, v56, v22
  v_sub_f32 v21, v57, v22
  v_exp_f32 v20, v20
  v_exp_f32 v21, v21
  s_nop 0
  v_cvt_pk_bf16_f32 v26, v20, v21
  v_sub_f32 v20, v58, v22
  v_sub_f32 v21, v59, v22
  v_exp_f32 v20, v20
  v_exp_f32 v21, v21
  s_nop 0
  v_cvt_pk_bf16_f32 v27, v20, v21
  v_sub_f32 v20, v60, v22
  v_sub_f32 v21, v61, v22
  v_exp_f32 v20, v20
  v_exp_f32 v21, v21
  s_nop 0
  v_cvt_pk_bf16_f32 v16, v20, v21
  v_cvt_pk_bf16_f32 v19, v20, v21
  s_nop 1
  v_mfma_f32_16x16x32_bf16 v[64:67], v[12:15], v[24:27], 0
  v_mfma_f32_16x16x32_bf16 v[80:83], v[36:39], v[24:27], 0
  v_mfma_f32_16x16x32_bf16 v[84:87], v[40:43], v[24:27], 0
  s_nop 3
  v_mfma_f32_16x16x16_bf16 v[64:67], v[12:13], v[16:17], v[64:67]
  v_mfma_f32_16x16x16_bf16 v[80:83], v[126:127], v[16:17], v[80:83]
  v_mfma_f32_16x16x16_bf16 v[84:87], v[126:127], v[18:19], v[84:87]
  s_nop 7
  v_rcp_f32 v65, v64
  s_mov_b64 vcc, 0
  s_branch L_smback_x
L_fs_x:
  buffer_load_dword v4, v17, s[40:43], s60 offen sc1
  s_add_u32 s67, s67, 1
  s_cmp_gt_u32 s67, 1048576
  s_cbranch_scc1 L_exit
  s_waitcnt vmcnt(0)
  v_cmp_gt_u32 vcc, s92, v4
  s_cbranch_vccnz L_fs_x
  s_branch L_fsback_x
L_team_last:
  s_waitcnt vmcnt(0)
  s_add_u32 s61, s61, 0x20000
  v_mov_b32 v4, 64
  buffer_store_dwordx4 v[124:127], v2, s[40:43], s61 offen sc1
  s_waitcnt vmcnt(0)
  s_barrier
  buffer_store_dword v4, v17, s[40:43], s66 offen sc1
  s_waitcnt vmcnt(0)
  s_endpgm
L_exit:
  s_endpgm
.p2align 8
.type L_ptab,@object
L_ptab:
.long 0xd,0x7005,0xe,0,0xc0,0x1e,0x180,0x240,4,4,4,4,4,4,4,4,4,4,4,4,4,4,4,4,4,4,4,4,4,4,4,4
.long 0x100d,0x6005,6,0x20,0x80,0xe0,0x140,0x1a0,0x200,0x260,0x2c0,0x320,0x380,0x3e0,4,4,4,4,4,4,4,4,4,4,4,4,4,4,4,4,4,4
.long 0x200d,0x5005,5,0xe,0x10,0xd0,0x1e,0x190,0x250,4,4,4,4,4,4,4,4,4,4,4,4,4,4,4,4,4,4,4,4,4,4,4
.long 0x300d,0x4005,0x1005,0xe,0x20,0xe0,0x1e,0x1a0,0x260,4,4,4,4,4,4,4,4,4,4,4,4,4,4,4,4,4,4,4,4,4,4,4
.long 0x400d,0x3005,6,0x40,0xa0,0x100,0x160,0x1c0,0x220,0x280,0x2e0,0x340,0x3a0,4,4,4,4,4,4,4,4,4,4,4,4,4,4,4,4,4,4,4
.long 0x500d,0x2005,6,0,0x60,0xc0,0x120,0x180,0x1e0,0x240,0x2a0,0x300,0x360,0x3c0,4,4,4,4,4,4,4,4,4,4,4,4,4,4,4,4,4,4
.long 0x600d,0x1e,0x300,0x340,0x380,0x3c0,4,4,4,4,4,4,4,4,4,4,4,4,4,4,4,4,4,4,4,4,4,4,4,4,4,4
.long 0x1d,0x7015,0xe,0x1000,0x10c0,0x1e,0x1180,0x1240,4,4,4,4,4,4,4,4,4,4,4,4,4,4,4,4,4,4,4,4,4,4,4,4
.long 0x101d,0x6015,0x16,0x20,0x80,0xe0,0x140,0x1a0,0x200,0x260,0x2c0,0x320,0x380,0x3e0,4,4,4,4,4,4,4,4,4,4,4,4,4,4,4,4,4,4
.long 0x201d,0x5015,0x15,0xe,0x1010,0x10d0,0x1e,0x1190,0x1250,4,4,4,4,4,4,4,4,4,4,4,4,4,4,4,4,4,4,4,4,4,4,4
.long 0x301d,0x4015,0x1015,0xe,0x1020,0x10e0,0x1e,0x11a0,0x1260,4,4,4,4,4,4,4,4,4,4,4,4,4,4,4,4,4,4,4,4,4,4,4
.long 0x401d,0x3015,0x16,0x40,0xa0,0x100,0x160,0x1c0,0x220,0x280,0x2e0,0x340,0x3a0,4,4,4,4,4,4,4,4,4,4,4,4,4,4,4,4,4,4,4
.long 0x501d,0x2015,0x16,0,0x60,0xc0,0x120,0x180,0x1e0,0x240,0x2a0,0x300,0x360,0x3c0,4,4,4,4,4,4,4,4,4,4,4,4,4,4,4,4,4,4
.long 0x601d,0x1e,0x1300,0x1340,0x1380,0x13c0,4,4,4,4,4,4,4,4,4,4,4,4,4,4,4,4,4,4,4,4,4,4,4,4,4,4
.long 0x2d,0x7025,0xe,0x2000,0x20c0,0x1e,0x2180,0x2240,4,4,4,4,4,4,4,4,4,4,4,4,4,4,4,4,4,4,4,4,4,4,4,4
.long 0x102d,0x6025,0x26,0x20,0x80,0xe0,0x140,0x1a0,0x200,0x260,0x2c0,0x320,0x380,0x3e0,4,4,4,4,4,4,4,4,4,4,4,4,4,4,4,4,4,4
.long 0x202d,0x5025,0x25,0xe,0x2010,0x20d0,0x1e,0x2190,0x2250,4,4,4,4,4,4,4,4,4,4,4,4,4,4,4,4,4,4,4,4,4,4,4
.long 0x302d,0x4025,0x1025,0xe,0x2020,0x20e0,0x1e,0x21a0,0x2260,4,4,4,4,4,4,4,4,4,4,4,4,4,4,4,4,4,4,4,4,4,4,4
.long 0x402d,0x3025,0x26,0x40,0xa0,0x100,0x160,0x1c0,0x220,0x280,0x2e0,0x340,0x3a0,4,4,4,4,4,4,4,4,4,4,4,4,4,4,4,4,4,4,4
.long 0x502d,0x2025,0x26,0,0x60,0xc0,0x120,0x180,0x1e0,0x240,0x2a0,0x300,0x360,0x3c0,4,4,4,4,4,4,4,4,4,4,4,4,4,4,4,4,4,4
.long 0x602d,0x1e,0x2300,0x2340,0x2380,0x23c0,4,4,4,4,4,4,4,4,4,4,4,4,4,4,4,4,4,4,4,4,4,4,4,4,4,4
.long 0x3d,0x7035,0xe,0x3000,0x30c0,0x1e,0x3180,0x3240,4,4,4,4,4,4,4,4,4,4,4,4,4,4,4,4,4,4,4,4,4,4,4,4
.long 0x103d,0x6035,0x36,0x20,0x80,0xe0,0x140,0x1a0,0x200,0x260,0x2c0,0x320,0x380,0x3e0,4,4,4,4,4,4,4,4,4,4,4,4,4,4,4,4,4,4
.long 0x203d,0x5035,0x35,0xe,0x3010,0x30d0,0x1e,0x3190,0x3250,4,4,4,4,4,4,4,4,4,4,4,4,4,4,4,4,4,4,4,4,4,4,4
.long 0x303d,0x4035,0x1035,0xe,0x3020,0x30e0,0x1e,0x31a0,0x3260,4,4,4,4,4,4,4,4,4,4,4,4,4,4,4,4,4,4,4,4,4,4,4
.long 0x403d,0x3035,0x36,0x40,0xa0,0x100,0x160,0x1c0,0x220,0x280,0x2e0,0x340,0x3a0,4,4,4,4,4,4,4,4,4,4,4,4,4,4,4,4,4,4,4
.long 0x503d,0x2035,0x36,0,0x60,0xc0,0x120,0x180,0x1e0,0x240,0x2a0,0x300,0x360,0x3c0,4,4,4,4,4,4,4,4,4,4,4,4,4,4,4,4,4,4
.long 0x603d,0x1e,0x3300,0x3340,0x3380,0x33c0,4,4,4,4,4,4,4,4,4,4,4,4,4,4,4,4,4,4,4,4,4,4,4,4,4,4
.long 0x4d,0x7045,0xe,0x4000,0x40c0,0x1e,0x4180,0x4240,4,4,4,4,4,4,4,4,4,4,4,4,4,4,4,4,4,4,4,4,4,4,4,4
.long 0x104d,0x6045,0x46,0x20,0x80,0xe0,0x140,0x1a0,0x200,0x260,0x2c0,0x320,0x380,0x3e0,4,4,4,4,4,4,4,4,4,4,4,4,4,4,4,4,4,4
.long 0x204d,0x5045,0x45,0xe,0x4010,0x40d0,0x1e,0x4190,0x4250,4,4,4,4,4,4,4,4,4,4,4,4,4,4,4,4,4,4,4,4,4,4,4
.long 0x304d,0x4045,0x1045,0xe,0x4020,0x40e0,0x1e,0x41a0,0x4260,4,4,4,4,4,4,4,4,4,4,4,4,4,4,4,4,4,4,4,4,4,4,4
.long 0x404d,0x3045,0x46,0x40,0xa0,0x100,0x160,0x1c0,0x220,0x280,0x2e0,0x340,0x3a0,4,4,4,4,4,4,4,4,4,4,4,4,4,4,4,4,4,4,4
.long 0x504d,0x2045,0x46,0,0x60,0xc0,0x120,0x180,0x1e0,0x240,0x2a0,0x300,0x360,0x3c0,4,4,4,4,4,4,4,4,4,4,4,4,4,4,4,4,4,4
.long 0x604d,0x1e,0x4300,0x4340,0x4380,0x43c0,4,4,4,4,4,4,4,4,4,4,4,4,4,4,4,4,4,4,4,4,4,4,4,4,4,4
.long 0x5d,0x7055,0xe,0x5000,0x50c0,0x1e,0x5180,0x5240,4,4,4,4,4,4,4,4,4,4,4,4,4,4,4,4,4,4,4,4,4,4,4,4
.long 0x105d,0x6055,0x56,0x20,0x80,0xe0,0x140,0x1a0,0x200,0x260,0x2c0,0x320,0x380,0x3e0,4,4,4,4,4,4,4,4,4,4,4,4,4,4,4,4,4,4
.long 0x205d,0x5055,0x55,0xe,0x5010,0x50d0,0x1e,0x5190,0x5250,4,4,4,4,4,4,4,4,4,4,4,4,4,4,4,4,4,4,4,4,4,4,4
.long 0x305d,0x4055,0x1055,0xe,0x5020,0x50e0,0x1e,0x51a0,0x5260,4,4,4,4,4,4,4,4,4,4,4,4,4,4,4,4,4,4,4,4,4,4,4
.long 0x405d,0x3055,0x56,0x40,0xa0,0x100,0x160,0x1c0,0x220,0x280,0x2e0,0x340,0x3a0,4,4,4,4,4,4,4,4,4,4,4,4,4,4,4,4,4,4,4
.long 0x505d,0x2055,0x56,0,0x60,0xc0,0x120,0x180,0x1e0,0x240,0x2a0,0x300,0x360,0x3c0,4,4,4,4,4,4,4,4,4,4,4,4,4,4,4,4,4,4
.long 0x605d,0x1e,0x5300,0x5340,0x5380,0x53c0,4,4,4,4,4,4,4,4,4,4,4,4,4,4,4,4,4,4,4,4,4,4,4,4,4,4
.long 0x6d,0x7065,0xe,0x6000,0x60c0,0x1e,0x6180,0x6240,4,4,4,4,4,4,4,4,4,4,4,4,4,4,4,4,4,4,4,4,4,4,4,4
.long 0x106d,0x6065,0x66,0x20,0x80,0xe0,0x140,0x1a0,0x200,0x260,0x2c0,0x320,0x380,0x3e0,4,4,4,4,4,4,4,4,4,4,4,4,4,4,4,4,4,4
.long 0x206d,0x5065,0x65,0xe,0x6010,0x60d0,0x1e,0x6190,0x6250,4,4,4,4,4,4,4,4,4,4,4,4,4,4,4,4,4,4,4,4,4,4,4
.long 0x306d,0x4065,0x1065,0xe,0x6020,0x60e0,0x1e,0x61a0,0x6260,4,4,4,4,4,4,4,4,4,4,4,4,4,4,4,4,4,4,4,4,4,4,4
.long 0x406d,0x3065,0x66,0x40,0xa0,0x100,0x160,0x1c0,0x220,0x280,0x2e0,0x340,0x3a0,4,4,4,4,4,4,4,4,4,4,4,4,4,4,4,4,4,4,4
.long 0x506d,0x2065,0x66,0,0x60,0xc0,0x120,0x180,0x1e0,0x240,0x2a0,0x300,0x360,0x3c0,4,4,4,4,4,4,4,4,4,4,4,4,4,4,4,4,4,4
.long 0x606d,0x1e,0x6300,0x6340,0x6380,0x63c0,4,4,4,4,4,4,4,4,4,4,4,4,4,4,4,4,4,4,4,4,4,4,4,4,4,4
.long 0x7d,0x7075,0xe,0x7000,0x70c0,0x1e,0x7180,0x7240,4,4,4,4,4,4,4,4,4,4,4,4,4,4,4,4,4,4,4,4,4,4,4,4
.long 0x107d,0x6075,0x76,0x20,0x80,0xe0,0x140,0x1a0,0x200,0x260,0x2c0,0x320,0x380,0x3e0,4,4,4,4,4,4,4,4,4,4,4,4,4,4,4,4,4,4
.long 0x207d,0x5075,0x75,0xe,0x7010,0x70d0,0x1e,0x7190,0x7250,4,4,4,4,4,4,4,4,4,4,4,4,4,4,4,4,4,4,4,4,4,4,4
.long 0x307d,0x4075,0x1075,0xe,0x7020,0x70e0,0x1e,0x71a0,0x7260,4,4,4,4,4,4,4,4,4,4,4,4,4,4,4,4,4,4,4,4,4,4,4
.long 0x407d,0x3075,0x76,0x40,0xa0,0x100,0x160,0x1c0,0x220,0x280,0x2e0,0x340,0x3a0,4,4,4,4,4,4,4,4,4,4,4,4,4,4,4,4,4,4,4
.long 0x507d,0x2075,0x76,0,0x60,0xc0,0x120,0x180,0x1e0,0x240,0x2a0,0x300,0x360,0x3c0,4,4,4,4,4,4,4,4,4,4,4,4,4,4,4,4,4,4
.long 0x607d,0x1e,0x7300,0x7340,0x7380,0x73c0,4,4,4,4,4,4,4,4,4,4,4,4,4,4,4,4,4,4,4,4,4,4,4,4,4,4
.long 0x8d,0x7085,0xe,0x30,0xf0,0x1e,0x1b0,0x270,4,4,4,4,4,4,4,4,4,4,4,4,4,4,4,4,4,4,4,4,4,4,4,4
.long 0x108d,0x6085,0x86,0x20,0x80,0xe0,0x140,0x1a0,0x200,0x260,0x2c0,0x320,0x380,0x3e0,4,4,4,4,4,4,4,4,4,4,4,4,4,4,4,4,4,4
.long 0x208d,0x5085,0x85,0xe,0x40,0x100,0x1e,0x1c0,0x280,4,4,4,4,4,4,4,4,4,4,4,4,4,4,4,4,4,4,4,4,4,4,4
.long 0x308d,0x4085,0x1085,0xe,0x50,0x110,0x1e,0x1d0,0x290,4,4,4,4,4,4,4,4,4,4,4,4,4,4,4,4,4,4,4,4,4,4,4
.long 0x408d,0x3085,0x86,0x40,0xa0,0x100,0x160,0x1c0,0x220,0x280,0x2e0,0x340,0x3a0,4,4,4,4,4,4,4,4,4,4,4,4,4,4,4,4,4,4,4
.long 0x508d,0x2085,0x86,0,0x60,0xc0,0x120,0x180,0x1e0,0x240,0x2a0,0x300,0x360,0x3c0,4,4,4,4,4,4,4,4,4,4,4,4,4,4,4,4,4,4
.long 0x608d,0x1e,0x310,0x350,0x390,0x3d0,4,4,4,4,4,4,4,4,4,4,4,4,4,4,4,4,4,4,4,4,4,4,4,4,4,4
.long 0x9d,0x7095,0xe,0x1030,0x10f0,0x1e,0x11b0,0x1270,4,4,4,4,4,4,4,4,4,4,4,4,4,4,4,4,4,4,4,4,4,4,4,4
.long 0x109d,0x6095,0x96,0x20,0x80,0xe0,0x140,0x1a0,0x200,0x260,0x2c0,0x320,0x380,0x3e0,4,4,4,4,4,4,4,4,4,4,4,4,4,4,4,4,4,4
.long 0x209d,0x5095,0x95,0xe,0x1040,0x1100,0x1e,0x11c0,0x1280,4,4,4,4,4,4,4,4,4,4,4,4,4,4,4,4,4,4,4,4,4,4,4
.long 0x309d,0x4095,0x1095,0xe,0x1050,0x1110,0x1e,0x11d0,0x1290,4,4,4,4,4,4,4,4,4,4,4,4,4,4,4,4,4,4,4,4,4,4,4
.long 0x409d,0x3095,0x96,0x40,0xa0,0x100,0x160,0x1c0,0x220,0x280,0x2e0,0x340,0x3a0,4,4,4,4,4,4,4,4,4,4,4,4,4,4,4,4,4,4,4
.long 0x509d,0x2095,0x96,0,0x60,0xc0,0x120,0x180,0x1e0,0x240,0x2a0,0x300,0x360,0x3c0,4,4,4,4,4,4,4,4,4,4,4,4,4,4,4,4,4,4
.long 0x609d,0x1e,0x1310,0x1350,0x1390,0x13d0,4,4,4,4,4,4,4,4,4,4,4,4,4,4,4,4,4,4,4,4,4,4,4,4,4,4
.long 0xad,0x70a5,0xe,0x2030,0x20f0,0x1e,0x21b0,0x2270,4,4,4,4,4,4,4,4,4,4,4,4,4,4,4,4,4,4,4,4,4,4,4,4
.long 0x10ad,0x60a5,0xa6,0x20,0x80,0xe0,0x140,0x1a0,0x200,0x260,0x2c0,0x320,0x380,0x3e0,4,4,4,4,4,4,4,4,4,4,4,4,4,4,4,4,4,4
.long 0x20ad,0x50a5,0xa5,0xe,0x2040,0x2100,0x1e,0x21c0,0x2280,4,4,4,4,4,4,4,4,4,4,4,4,4,4,4,4,4,4,4,4,4,4,4
.long 0x30ad,0x40a5,0x10a5,0xe,0x2050,0x2110,0x1e,0x21d0,0x2290,4,4,4,4,4,4,4,4,4,4,4,4,4,4,4,4,4,4,4,4,4,4,4
.long 0x40ad,0x30a5,0xa6,0x40,0xa0,0x100,0x160,0x1c0,0x220,0x280,0x2e0,0x340,0x3a0,4,4,4,4,4,4,4,4,4,4,4,4,4,4,4,4,4,4,4
.long 0x50ad,0x20a5,0xa6,0,0x60,0xc0,0x120,0x180,0x1e0,0x240,0x2a0,0x300,0x360,0x3c0,4,4,4,4,4,4,4,4,4,4,4,4,4,4,4,4,4,4
.long 0x60ad,0x1e,0x2310,0x2350,0x2390,0x23d0,4,4,4,4,4,4,4,4,4,4,4,4,4,4,4,4,4,4,4,4,4,4,4,4,4,4
.long 0xbd,0x70b5,0xe,0x3030,0x30f0,0x1e,0x31b0,0x3270,4,4,4,4,4,4,4,4,4,4,4,4,4,4,4,4,4,4,4,4,4,4,4,4
.long 0x10bd,0x60b5,0xb6,0x20,0x80,0xe0,0x140,0x1a0,0x200,0x260,0x2c0,0x320,0x380,0x3e0,4,4,4,4,4,4,4,4,4,4,4,4,4,4,4,4,4,4
.long 0x20bd,0x50b5,0xb5,0xe,0x3040,0x3100,0x1e,0x31c0,0x3280,4,4,4,4,4,4,4,4,4,4,4,4,4,4,4,4,4,4,4,4,4,4,4
.long 0x30bd,0x40b5,0x10b5,0xe,0x3050,0x3110,0x1e,0x31d0,0x3290,4,4,4,4,4,4,4,4,4,4,4,4,4,4,4,4,4,4,4,4,4,4,4
.long 0x40bd,0x30b5,0xb6,0x40,0xa0,0x100,0x160,0x1c0,0x220,0x280,0x2e0,0x340,0x3a0,4,4,4,4,4,4,4,4,4,4,4,4,4,4,4,4,4,4,4
.long 0x50bd,0x20b5,0xb6,0,0x60,0xc0,0x120,0x180,0x1e0,0x240,0x2a0,0x300,0x360,0x3c0,4,4,4,4,4,4,4,4,4,4,4,4,4,4,4,4,4,4
.long 0x60bd,0x1e,0x3310,0x3350,0x3390,0x33d0,4,4,4,4,4,4,4,4,4,4,4,4,4,4,4,4,4,4,4,4,4,4,4,4,4,4
.long 0xcd,0x70c5,0xe,0x4030,0x40f0,0x1e,0x41b0,0x4270,4,4,4,4,4,4,4,4,4,4,4,4,4,4,4,4,4,4,4,4,4,4,4,4
.long 0x10cd,0x60c5,0xc6,0x20,0x80,0xe0,0x140,0x1a0,0x200,0x260,0x2c0,0x320,0x380,0x3e0,4,4,4,4,4,4,4,4,4,4,4,4,4,4,4,4,4,4
.long 0x20cd,0x50c5,0xc5,0xe,0x4040,0x4100,0x1e,0x41c0,0x4280,4,4,4,4,4,4,4,4,4,4,4,4,4,4,4,4,4,4,4,4,4,4,4
.long 0x30cd,0x40c5,0x10c5,0xe,0x4050,0x4110,0x1e,0x41d0,0x4290,4,4,4,4,4,4,4,4,4,4,4,4,4,4,4,4,4,4,4,4,4,4,4
.long 0x40cd,0x30c5,0xc6,0x40,0xa0,0x100,0x160,0x1c0,0x220,0x280,0x2e0,0x340,0x3a0,4,4,4,4,4,4,4,4,4,4,4,4,4,4,4,4,4,4,4
.long 0x50cd,0x20c5,0xc6,0,0x60,0xc0,0x120,0x180,0x1e0,0x240,0x2a0,0x300,0x360,0x3c0,4,4,4,4,4,4,4,4,4,4,4,4,4,4,4,4,4,4
.long 0x60cd,0x1e,0x4310,0x4350,0x4390,0x43d0,4,4,4,4,4,4,4,4,4,4,4,4,4,4,4,4,4,4,4,4,4,4,4,4,4,4
.long 0xdd,0x70d5,0xe,0x5030,0x50f0,0x1e,0x51b0,0x5270,4,4,4,4,4,4,4,4,4,4,4,4,4,4,4,4,4,4,4,4,4,4,4,4
.long 0x10dd,0x60d5,0xd6,0x20,0x80,0xe0,0x140,0x1a0,0x200,0x260,0x2c0,0x320,0x380,0x3e0,4,4,4,4,4,4,4,4,4,4,4,4,4,4,4,4,4,4
.long 0x20dd,0x50d5,0xd5,0xe,0x5040,0x5100,0x1e,0x51c0,0x5280,4,4,4,4,4,4,4,4,4,4,4,4,4,4,4,4,4,4,4,4,4,4,4
.long 0x30dd,0x40d5,0x10d5,0xe,0x5050,0x5110,0x1e,0x51d0,0x5290,4,4,4,4,4,4,4,4,4,4,4,4,4,4,4,4,4,4,4,4,4,4,4
.long 0x40dd,0x30d5,0xd6,0x40,0xa0,0x100,0x160,0x1c0,0x220,0x280,0x2e0,0x340,0x3a0,4,4,4,4,4,4,4,4,4,4,4,4,4,4,4,4,4,4,4
.long 0x50dd,0x20d5,0xd6,0,0x60,0xc0,0x120,0x180,0x1e0,0x240,0x2a0,0x300,0x360,0x3c0,4,4,4,4,4,4,4,4,4,4,4,4,4,4,4,4,4,4
.long 0x60dd,0x1e,0x5310,0x5350,0x5390,0x53d0,4,4,4,4,4,4,4,4,4,4,4,4,4,4,4,4,4,4,4,4,4,4,4,4,4,4
.long 0xed,0x70e5,0xe,0x6030,0x60f0,0x1e,0x61b0,0x6270,4,4,4,4,4,4,4,4,4,4,4,4,4,4,4,4,4,4,4,4,4,4,4,4
.long 0x10ed,0x60e5,0xe6,0x20,0x80,0xe0,0x140,0x1a0,0x200,0x260,0x2c0,0x320,0x380,0x3e0,4,4,4,4,4,4,4,4,4,4,4,4,4,4,4,4,4,4
.long 0x20ed,0x50e5,0xe5,0xe,0x6040,0x6100,0x1e,0x61c0,0x6280,4,4,4,4,4,4,4,4,4,4,4,4,4,4,4,4,4,4,4,4,4,4,4
.long 0x30ed,0x40e5,0x10e5,0xe,0x6050,0x6110,0x1e,0x61d0,0x6290,4,4,4,4,4,4,4,4,4,4,4,4,4,4,4,4,4,4,4,4,4,4,4
.long 0x40ed,0x30e5,0xe6,0x40,0xa0,0x100,0x160,0x1c0,0x220,0x280,0x2e0,0x340,0x3a0,4,4,4,4,4,4,4,4,4,4,4,4,4,4,4,4,4,4,4
.long 0x50ed,0x20e5,0xe6,0,0x60,0xc0,0x120,0x180,0x1e0,0x240,0x2a0,0x300,0x360,0x3c0,4,4,4,4,4,4,4,4,4,4,4,4,4,4,4,4,4,4
.long 0x60ed,0x1e,0x6310,0x6350,0x6390,0x63d0,4,4,4,4,4,4,4,4,4,4,4,4,4,4,4,4,4,4,4,4,4,4,4,4,4,4
.long 0xfd,0x70f5,0xe,0x7030,0x70f0,0x1e,0x71b0,0x7270,4,4,4,4,4,4,4,4,4,4,4,4,4,4,4,4,4,4,4,4,4,4,4,4
.long 0x10fd,0x60f5,0xf6,0x20,0x80,0xe0,0x140,0x1a0,0x200,0x260,0x2c0,0x320,0x380,0x3e0,4,4,4,4,4,4,4,4,4,4,4,4,4,4,4,4,4,4
.long 0x20fd,0x50f5,0xf5,0xe,0x7040,0x7100,0x1e,0x71c0,0x7280,4,4,4,4,4,4,4,4,4,4,4,4,4,4,4,4,4,4,4,4,4,4,4
.long 0x30fd,0x40f5,0x10f5,0xe,0x7050,0x7110,0x1e,0x71d0,0x7290,4,4,4,4,4,4,4,4,4,4,4,4,4,4,4,4,4,4,4,4,4,4,4
.long 0x40fd,0x30f5,0xf6,0x40,0xa0,0x100,0x160,0x1c0,0x220,0x280,0x2e0,0x340,0x3a0,4,4,4,4,4,4,4,4,4,4,4,4,4,4,4,4,4,4,4
.long 0x50fd,0x20f5,0xf6,0,0x60,0xc0,0x120,0x180,0x1e0,0x240,0x2a0,0x300,0x360,0x3c0,4,4,4,4,4,4,4,4,4,4,4,4,4,4,4,4,4,4
.long 0x60fd,0x1e,0x7310,0x7350,0x7390,0x73d0,4,4,4,4,4,4,4,4,4,4,4,4,4,4,4,4,4,4,4,4,4,4,4,4,4,4
.long 0x10d,0x7105,0xe,0x60,0x120,0x1e,0x1e0,0x2a0,4,4,4,4,4,4,4,4,4,4,4,4,4,4,4,4,4,4,4,4,4,4,4,4
.long 0x110d,0x6105,6,0x30,0x90,0xf0,0x150,0x1b0,0x210,0x270,0x2d0,0x330,0x390,0x3f0,4,4,4,4,4,4,4,4,4,4,4,4,4,4,4,4,4,4
.long 0x210d,0x5105,0x105,0xe,0x70,0x130,0x1e,0x1f0,0x2b0,4,4,4,4,4,4,4,4,4,4,4,4,4,4,4,4,4,4,4,4,4,4,4
.long 0x310d,0x4105,0x1105,0xe,0x80,0x140,0x1e,0x200,0x2c0,4,4,4,4,4,4,4,4,4,4,4,4,4,4,4,4,4,4,4,4,4,4,4
.long 0x410d,0x3105,6,0x50,0xb0,0x110,0x170,0x1d0,0x230,0x290,0x2f0,0x350,0x3b0,4,4,4,4,4,4,4,4,4,4,4,4,4,4,4,4,4,4,4
.long 0x510d,0x2105,6,0x10,0x70,0xd0,0x130,0x190,0x1f0,0x250,0x2b0,0x310,0x370,0x3d0,4,4,4,4,4,4,4,4,4,4,4,4,4,4,4,4,4,4
.long 0x610d,0x1e,0x320,0x360,0x3a0,0x3e0,4,4,4,4,4,4,4,4,4,4,4,4,4,4,4,4,4,4,4,4,4,4,4,4,4,4
.long 0x11d,0x7115,0xe,0x1060,0x1120,0x1e,0x11e0,0x12a0,4,4,4,4,4,4,4,4,4,4,4,4,4,4,4,4,4,4,4,4,4,4,4,4
.long 0x111d,0x6115,0x16,0x30,0x90,0xf0,0x150,0x1b0,0x210,0x270,0x2d0,0x330,0x390,0x3f0,4,4,4,4,4,4,4,4,4,4,4,4,4,4,4,4,4,4
.long 0x211d,0x5115,0x115,0xe,0x1070,0x1130,0x1e,0x11f0,0x12b0,4,4,4,4,4,4,4,4,4,4,4,4,4,4,4,4,4,4,4,4,4,4,4
.long 0x311d,0x4115,0x1115,0xe,0x1080,0x1140,0x1e,0x1200,0x12c0,4,4,4,4,4,4,4,4,4,4,4,4,4,4,4,4,4,4,4,4,4,4,4
.long 0x411d,0x3115,0x16,0x50,0xb0,0x110,0x170,0x1d0,0x230,0x290,0x2f0,0x350,0x3b0,4,4,4,4,4,4,4,4,4,4,4,4,4,4,4,4,4,4,4
.long 0x511d,0x2115,0x16,0x10,0x70,0xd0,0x130,0x190,0x1f0,0x250,0x2b0,0x310,0x370,0x3d0,4,4,4,4,4,4,4,4,4,4,4,4,4,4,4,4,4,4
.long 0x611d,0x1e,0x1320,0x1360,0x13a0,0x13e0,4,4,4,4,4,4,4,4,4,4,4,4,4,4,4,4,4,4,4,4,4,4,4,4,4,4
.long 0x12d,0x7125,0xe,0x2060,0x2120,0x1e,0x21e0,0x22a0,4,4,4,4,4,4,4,4,4,4,4,4,4,4,4,4,4,4,4,4,4,4,4,4
.long 0x112d,0x6125,0x26,0x30,0x90,0xf0,0x150,0x1b0,0x210,0x270,0x2d0,0x330,0x390,0x3f0,4,4,4,4,4,4,4,4,4,4,4,4,4,4,4,4,4,4
.long 0x212d,0x5125,0x125,0xe,0x2070,0x2130,0x1e,0x21f0,0x22b0,4,4,4,4,4,4,4,4,4,4,4,4,4,4,4,4,4,4,4,4,4,4,4
.long 0x312d,0x4125,0x1125,0xe,0x2080,0x2140,0x1e,0x2200,0x22c0,4,4,4,4,4,4,4,4,4,4,4,4,4,4,4,4,4,4,4,4,4,4,4
.long 0x412d,0x3125,0x26,0x50,0xb0,0x110,0x170,0x1d0,0x230,0x290,0x2f0,0x350,0x3b0,4,4,4,4,4,4,4,4,4,4,4,4,4,4,4,4,4,4,4
.long 0x512d,0x2125,0x26,0x10,0x70,0xd0,0x130,0x190,0x1f0,0x250,0x2b0,0x310,0x370,0x3d0,4,4,4,4,4,4,4,4,4,4,4,4,4,4,4,4,4,4
.long 0x612d,0x1e,0x2320,0x2360,0x23a0,0x23e0,4,4,4,4,4,4,4,4,4,4,4,4,4,4,4,4,4,4,4,4,4,4,4,4,4,4
.long 0x13d,0x7135,0xe,0x3060,0x3120,0x1e,0x31e0,0x32a0,4,4,4,4,4,4,4,4,4,4,4,4,4,4,4,4,4,4,4,4,4,4,4,4
.long 0x113d,0x6135,0x36,0x30,0x90,0xf0,0x150,0x1b0,0x210,0x270,0x2d0,0x330,0x390,0x3f0,4,4,4,4,4,4,4,4,4,4,4,4,4,4,4,4,4,4
.long 0x213d,0x5135,0x135,0xe,0x3070,0x3130,0x1e,0x31f0,0x32b0,4,4,4,4,4,4,4,4,4,4,4,4,4,4,4,4,4,4,4,4,4,4,4
.long 0x313d,0x4135,0x1135,0xe,0x3080,0x3140,0x1e,0x3200,0x32c0,4,4,4,4,4,4,4,4,4,4,4,4,4,4,4,4,4,4,4,4,4,4,4
.long 0x413d,0x3135,0x36,0x50,0xb0,0x110,0x170,0x1d0,0x230,0x290,0x2f0,0x350,0x3b0,4,4,4,4,4,4,4,4,4,4,4,4,4,4,4,4,4,4,4
.long 0x513d,0x2135,0x36,0x10,0x70,0xd0,0x130,0x190,0x1f0,0x250,0x2b0,0x310,0x370,0x3d0,4,4,4,4,4,4,4,4,4,4,4,4,4,4,4,4,4,4
.long 0x613d,0x1e,0x3320,0x3360,0x33a0,0x33e0,4,4,4,4,4,4,4,4,4,4,4,4,4,4,4,4,4,4,4,4,4,4,4,4,4,4
.long 0x14d,0x7145,0xe,0x4060,0x4120,0x1e,0x41e0,0x42a0,4,4,4,4,4,4,4,4,4,4,4,4,4,4,4,4,4,4,4,4,4,4,4,4
.long 0x114d,0x6145,0x46,0x30,0x90,0xf0,0x150,0x1b0,0x210,0x270,0x2d0,0x330,0x390,0x3f0,4,4,4,4,4,4,4,4,4,4,4,4,4,4,4,4,4,4
.long 0x214d,0x5145,0x145,0xe,0x4070,0x4130,0x1e,0x41f0,0x42b0,4,4,4,4,4,4,4,4,4,4,4,4,4,4,4,4,4,4,4,4,4,4,4
.long 0x314d,0x4145,0x1145,0xe,0x4080,0x4140,0x1e,0x4200,0x42c0,4,4,4,4,4,4,4,4,4,4,4,4,4,4,4,4,4,4,4,4,4,4,4
.long 0x414d,0x3145,0x46,0x50,0xb0,0x110,0x170,0x1d0,0x230,0x290,0x2f0,0x350,0x3b0,4,4,4,4,4,4,4,4,4,4,4,4,4,4,4,4,4,4,4
.long 0x514d,0x2145,0x46,0x10,0x70,0xd0,0x130,0x190,0x1f0,0x250,0x2b0,0x310,0x370,0x3d0,4,4,4,4,4,4,4,4,4,4,4,4,4,4,4,4,4,4
.long 0x614d,0x1e,0x4320,0x4360,0x43a0,0x43e0,4,4,4,4,4,4,4,4,4,4,4,4,4,4,4,4,4,4,4,4,4,4,4,4,4,4
.long 0x15d,0x7155,0xe,0x5060,0x5120,0x1e,0x51e0,0x52a0,4,4,4,4,4,4,4,4,4,4,4,4,4,4,4,4,4,4,4,4,4,4,4,4
.long 0x115d,0x6155,0x56,0x30,0x90,0xf0,0x150,0x1b0,0x210,0x270,0x2d0,0x330,0x390,0x3f0,4,4,4,4,4,4,4,4,4,4,4,4,4,4,4,4,4,4
.long 0x215d,0x5155,0x155,0xe,0x5070,0x5130,0x1e,0x51f0,0x52b0,4,4,4,4,4,4,4,4,4,4,4,4,4,4,4,4,4,4,4,4,4,4,4
.long 0x315d,0x4155,0x1155,0xe,0x5080,0x5140,0x1e,0x5200,0x52c0,4,4,4,4,4,4,4,4,4,4,4,4,4,4,4,4,4,4,4,4,4,4,4
.long 0x415d,0x3155,0x56,0x50,0xb0,0x110,0x170,0x1d0,0x230,0x290,0x2f0,0x350,0x3b0,4,4,4,4,4,4,4,4,4,4,4,4,4,4,4,4,4,4,4
.long 0x515d,0x2155,0x56,0x10,0x70,0xd0,0x130,0x190,0x1f0,0x250,0x2b0,0x310,0x370,0x3d0,4,4,4,4,4,4,4,4,4,4,4,4,4,4,4,4,4,4
.long 0x615d,0x1e,0x5320,0x5360,0x53a0,0x53e0,4,4,4,4,4,4,4,4,4,4,4,4,4,4,4,4,4,4,4,4,4,4,4,4,4,4
.long 0x16d,0x7165,0xe,0x6060,0x6120,0x1e,0x61e0,0x62a0,4,4,4,4,4,4,4,4,4,4,4,4,4,4,4,4,4,4,4,4,4,4,4,4
.long 0x116d,0x6165,0x66,0x30,0x90,0xf0,0x150,0x1b0,0x210,0x270,0x2d0,0x330,0x390,0x3f0,4,4,4,4,4,4,4,4,4,4,4,4,4,4,4,4,4,4
.long 0x216d,0x5165,0x165,0xe,0x6070,0x6130,0x1e,0x61f0,0x62b0,4,4,4,4,4,4,4,4,4,4,4,4,4,4,4,4,4,4,4,4,4,4,4
.long 0x316d,0x4165,0x1165,0xe,0x6080,0x6140,0x1e,0x6200,0x62c0,4,4,4,4,4,4,4,4,4,4,4,4,4,4,4,4,4,4,4,4,4,4,4
.long 0x416d,0x3165,0x66,0x50,0xb0,0x110,0x170,0x1d0,0x230,0x290,0x2f0,0x350,0x3b0,4,4,4,4,4,4,4,4,4,4,4,4,4,4,4,4,4,4,4
.long 0x516d,0x2165,0x66,0x10,0x70,0xd0,0x130,0x190,0x1f0,0x250,0x2b0,0x310,0x370,0x3d0,4,4,4,4,4,4,4,4,4,4,4,4,4,4,4,4,4,4
.long 0x616d,0x1e,0x6320,0x6360,0x63a0,0x63e0,4,4,4,4,4,4,4,4,4,4,4,4,4,4,4,4,4,4,4,4,4,4,4,4,4,4
.long 0x17d,0x7175,0xe,0x7060,0x7120,0x1e,0x71e0,0x72a0,4,4,4,4,4,4,4,4,4,4,4,4,4,4,4,4,4,4,4,4,4,4,4,4
.long 0x117d,0x6175,0x76,0x30,0x90,0xf0,0x150,0x1b0,0x210,0x270,0x2d0,0x330,0x390,0x3f0,4,4,4,4,4,4,4,4,4,4,4,4,4,4,4,4,4,4
.long 0x217d,0x5175,0x175,0xe,0x7070,0x7130,0x1e,0x71f0,0x72b0,4,4,4,4,4,4,4,4,4,4,4,4,4,4,4,4,4,4,4,4,4,4,4
.long 0x317d,0x4175,0x1175,0xe,0x7080,0x7140,0x1e,0x7200,0x72c0,4,4,4,4,4,4,4,4,4,4,4,4,4,4,4,4,4,4,4,4,4,4,4
.long 0x417d,0x3175,0x76,0x50,0xb0,0x110,0x170,0x1d0,0x230,0x290,0x2f0,0x350,0x3b0,4,4,4,4,4,4,4,4,4,4,4,4,4,4,4,4,4,4,4
.long 0x517d,0x2175,0x76,0x10,0x70,0xd0,0x130,0x190,0x1f0,0x250,0x2b0,0x310,0x370,0x3d0,4,4,4,4,4,4,4,4,4,4,4,4,4,4,4,4,4,4
.long 0x617d,0x1e,0x7320,0x7360,0x73a0,0x73e0,4,4,4,4,4,4,4,4,4,4,4,4,4,4,4,4,4,4,4,4,4,4,4,4,4,4
.long 0x18d,0x7185,0xe,0x90,0x150,0x1e,0x210,0x2d0,4,4,4,4,4,4,4,4,4,4,4,4,4,4,4,4,4,4,4,4,4,4,4,4
.long 0x118d,0x6185,0x86,0x30,0x90,0xf0,0x150,0x1b0,0x210,0x270,0x2d0,0x330,0x390,0x3f0,4,4,4,4,4,4,4,4,4,4,4,4,4,4,4,4,4,4
.long 0x218d,0x5185,0x185,0xe,0xa0,0x160,0x1e,0x220,0x2e0,4,4,4,4,4,4,4,4,4,4,4,4,4,4,4,4,4,4,4,4,4,4,4
.long 0x318d,0x4185,0x1185,0xe,0xb0,0x170,0x1e,0x230,0x2f0,4,4,4,4,4,4,4,4,4,4,4,4,4,4,4,4,4,4,4,4,4,4,4
.long 0x418d,0x3185,0x86,0x50,0xb0,0x110,0x170,0x1d0,0x230,0x290,0x2f0,0x350,0x3b0,4,4,4,4,4,4,4,4,4,4,4,4,4,4,4,4,4,4,4
.long 0x518d,0x2185,0x86,0x10,0x70,0xd0,0x130,0x190,0x1f0,0x250,0x2b0,0x310,0x370,0x3d0,4,4,4,4,4,4,4,4,4,4,4,4,4,4,4,4,4,4
.long 0x618d,0x1e,0x330,0x370,0x3b0,0x3f0,4,4,4,4,4,4,4,4,4,4,4,4,4,4,4,4,4,4,4,4,4,4,4,4,4,4
.long 0x19d,0x7195,0xe,0x1090,0x1150,0x1e,0x1210,0x12d0,4,4,4,4,4,4,4,4,4,4,4,4,4,4,4,4,4,4,4,4,4,4,4,4
.long 0x119d,0x6195,0x96,0x30,0x90,0xf0,0x150,0x1b0,0x210,0x270,0x2d0,0x330,0x390,0x3f0,4,4,4,4,4,4,4,4,4,4,4,4,4,4,4,4,4,4
.long 0x219d,0x5195,0x195,0xe,0x10a0,0x1160,0x1e,0x1220,0x12e0,4,4,4,4,4,4,4,4,4,4,4,4,4,4,4,4,4,4,4,4,4,4,4
.long 0x319d,0x4195,0x1195,0xe,0x10b0,0x1170,0x1e,0x1230,0x12f0,4,4,4,4,4,4,4,4,4,4,4,4,4,4,4,4,4,4,4,4,4,4,4
.long 0x419d,0x3195,0x96,0x50,0xb0,0x110,0x170,0x1d0,0x230,0x290,0x2f0,0x350,0x3b0,4,4,4,4,4,4,4,4,4,4,4,4,4,4,4,4,4,4,4
.long 0x519d,0x2195,0x96,0x10,0x70,0xd0,0x130,0x190,0x1f0,0x250,0x2b0,0x310,0x370,0x3d0,4,4,4,4,4,4,4,4,4,4,4,4,4,4,4,4,4,4
.long 0x619d,0x1e,0x1330,0x1370,0x13b0,0x13f0,4,4,4,4,4,4,4,4,4,4,4,4,4,4,4,4,4,4,4,4,4,4,4,4,4,4
.long 0x1ad,0x71a5,0xe,0x2090,0x2150,0x1e,0x2210,0x22d0,4,4,4,4,4,4,4,4,4,4,4,4,4,4,4,4,4,4,4,4,4,4,4,4
.long 0x11ad,0x61a5,0xa6,0x30,0x90,0xf0,0x150,0x1b0,0x210,0x270,0x2d0,0x330,0x390,0x3f0,4,4,4,4,4,4,4,4,4,4,4,4,4,4,4,4,4,4
.long 0x21ad,0x51a5,0x1a5,0xe,0x20a0,0x2160,0x1e,0x2220,0x22e0,4,4,4,4,4,4,4,4,4,4,4,4,4,4,4,4,4,4,4,4,4,4,4
.long 0x31ad,0x41a5,0x11a5,0xe,0x20b0,0x2170,0x1e,0x2230,0x22f0,4,4,4,4,4,4,4,4,4,4,4,4,4,4,4,4,4,4,4,4,4,4,4
.long 0x41ad,0x31a5,0xa6,0x50,0xb0,0x110,0x170,0x1d0,0x230,0x290,0x2f0,0x350,0x3b0,4,4,4,4,4,4,4,4,4,4,4,4,4,4,4,4,4,4,4
.long 0x51ad,0x21a5,0xa6,0x10,0x70,0xd0,0x130,0x190,0x1f0,0x250,0x2b0,0x310,0x370,0x3d0,4,4,4,4,4,4,4,4,4,4,4,4,4,4,4,4,4,4
.long 0x61ad,0x1e,0x2330,0x2370,0x23b0,0x23f0,4,4,4,4,4,4,4,4,4,4,4,4,4,4,4,4,4,4,4,4,4,4,4,4,4,4
.long 0x1bd,0x71b5,0xe,0x3090,0x3150,0x1e,0x3210,0x32d0,4,4,4,4,4,4,4,4,4,4,4,4,4,4,4,4,4,4,4,4,4,4,4,4
.long 0x11bd,0x61b5,0xb6,0x30,0x90,0xf0,0x150,0x1b0,0x210,0x270,0x2d0,0x330,0x390,0x3f0,4,4,4,4,4,4,4,4,4,4,4,4,4,4,4,4,4,4
.long 0x21bd,0x51b5,0x1b5,0xe,0x30a0,0x3160,0x1e,0x3220,0x32e0,4,4,4,4,4,4,4,4,4,4,4,4,4,4,4,4,4,4,4,4,4,4,4
.long 0x31bd,0x41b5,0x11b5,0xe,0x30b0,0x3170,0x1e,0x3230,0x32f0,4,4,4,4,4,4,4,4,4,4,4,4,4,4,4,4,4,4,4,4,4,4,4
.long 0x41bd,0x31b5,0xb6,0x50,0xb0,0x110,0x170,0x1d0,0x230,0x290,0x2f0,0x350,0x3b0,4,4,4,4,4,4,4,4,4,4,4,4,4,4,4,4,4,4,4
.long 0x51bd,0x21b5,0xb6,0x10,0x70,0xd0,0x130,0x190,0x1f0,0x250,0x2b0,0x310,0x370,0x3d0,4,4,4,4,4,4,4,4,4,4,4,4,4,4,4,4,4,4
.long 0x61bd,0x1e,0x3330,0x3370,0x33b0,0x33f0,4,4,4,4,4,4,4,4,4,4,4,4,4,4,4,4,4,4,4,4,4,4,4,4,4,4
.long 0x1cd,0x71c5,0xe,0x4090,0x4150,0x1e,0x4210,0x42d0,4,4,4,4,4,4,4,4,4,4,4,4,4,4,4,4,4,4,4,4,4,4,4,4
.long 0x11cd,0x61c5,0xc6,0x30,0x90,0xf0,0x150,0x1b0,0x210,0x270,0x2d0,0x330,0x390,0x3f0,4,4,4,4,4,4,4,4,4,4,4,4,4,4,4,4,4,4
.long 0x21cd,0x51c5,0x1c5,0xe,0x40a0,0x4160,0x1e,0x4220,0x42e0,4,4,4,4,4,4,4,4,4,4,4,4,4,4,4,4,4,4,4,4,4,4,4
.long 0x31cd,0x41c5,0x11c5,0xe,0x40b0,0x4170,0x1e,0x4230,0x42f0,4,4,4,4,4,4,4,4,4,4,4,4,4,4,4,4,4,4,4,4,4,4,4
.long 0x41cd,0x31c5,0xc6,0x50,0xb0,0x110,0x170,0x1d0,0x230,0x290,0x2f0,0x350,0x3b0,4,4,4,4,4,4,4,4,4,4,4,4,4,4,4,4,4,4,4
.long 0x51cd,0x21c5,0xc6,0x10,0x70,0xd0,0x130,0x190,0x1f0,0x250,0x2b0,0x310,0x370,0x3d0,4,4,4,4,4,4,4,4,4,4,4,4,4,4,4,4,4,4
.long 0x61cd,0x1e,0x4330,0x4370,0x43b0,0x43f0,4,4,4,4,4,4,4,4,4,4,4,4,4,4,4,4,4,4,4,4,4,4,4,4,4,4
.long 0x1dd,0x71d5,0xe,0x5090,0x5150,0x1e,0x5210,0x52d0,4,4,4,4,4,4,4,4,4,4,4,4,4,4,4,4,4,4,4,4,4,4,4,4
.long 0x11dd,0x61d5,0xd6,0x30,0x90,0xf0,0x150,0x1b0,0x210,0x270,0x2d0,0x330,0x390,0x3f0,4,4,4,4,4,4,4,4,4,4,4,4,4,4,4,4,4,4
.long 0x21dd,0x51d5,0x1d5,0xe,0x50a0,0x5160,0x1e,0x5220,0x52e0,4,4,4,4,4,4,4,4,4,4,4,4,4,4,4,4,4,4,4,4,4,4,4
.long 0x31dd,0x41d5,0x11d5,0xe,0x50b0,0x5170,0x1e,0x5230,0x52f0,4,4,4,4,4,4,4,4,4,4,4,4,4,4,4,4,4,4,4,4,4,4,4
.long 0x41dd,0x31d5,0xd6,0x50,0xb0,0x110,0x170,0x1d0,0x230,0x290,0x2f0,0x350,0x3b0,4,4,4,4,4,4,4,4,4,4,4,4,4,4,4,4,4,4,4
.long 0x51dd,0x21d5,0xd6,0x10,0x70,0xd0,0x130,0x190,0x1f0,0x250,0x2b0,0x310,0x370,0x3d0,4,4,4,4,4,4,4,4,4,4,4,4,4,4,4,4,4,4
.long 0x61dd,0x1e,0x5330,0x5370,0x53b0,0x53f0,4,4,4,4,4,4,4,4,4,4,4,4,4,4,4,4,4,4,4,4,4,4,4,4,4,4
.long 0x1ed,0x71e5,0xe,0x6090,0x6150,0x1e,0x6210,0x62d0,4,4,4,4,4,4,4,4,4,4,4,4,4,4,4,4,4,4,4,4,4,4,4,4
.long 0x11ed,0x61e5,0xe6,0x30,0x90,0xf0,0x150,0x1b0,0x210,0x270,0x2d0,0x330,0x390,0x3f0,4,4,4,4,4,4,4,4,4,4,4,4,4,4,4,4,4,4
.long 0x21ed,0x51e5,0x1e5,0xe,0x60a0,0x6160,0x1e,0x6220,0x62e0,4,4,4,4,4,4,4,4,4,4,4,4,4,4,4,4,4,4,4,4,4,4,4
.long 0x31ed,0x41e5,0x11e5,0xe,0x60b0,0x6170,0x1e,0x6230,0x62f0,4,4,4,4,4,4,4,4,4,4,4,4,4,4,4,4,4,4,4,4,4,4,4
.long 0x41ed,0x31e5,0xe6,0x50,0xb0,0x110,0x170,0x1d0,0x230,0x290,0x2f0,0x350,0x3b0,4,4,4,4,4,4,4,4,4,4,4,4,4,4,4,4,4,4,4
.long 0x51ed,0x21e5,0xe6,0x10,0x70,0xd0,0x130,0x190,0x1f0,0x250,0x2b0,0x310,0x370,0x3d0,4,4,4,4,4,4,4,4,4,4,4,4,4,4,4,4,4,4
.long 0x61ed,0x1e,0x6330,0x6370,0x63b0,0x63f0,4,4,4,4,4,4,4,4,4,4,4,4,4,4,4,4,4,4,4,4,4,4,4,4,4,4
.long 0x1fd,0x71f5,0xe,0x7090,0x7150,0x1e,0x7210,0x72d0,4,4,4,4,4,4,4,4,4,4,4,4,4,4,4,4,4,4,4,4,4,4,4,4
.long 0x11fd,0x61f5,0xf6,0x30,0x90,0xf0,0x150,0x1b0,0x210,0x270,0x2d0,0x330,0x390,0x3f0,4,4,4,4,4,4,4,4,4,4,4,4,4,4,4,4,4,4
.long 0x21fd,0x51f5,0x1f5,0xe,0x70a0,0x7160,0x1e,0x7220,0x72e0,4,4,4,4,4,4,4,4,4,4,4,4,4,4,4,4,4,4,4,4,4,4,4
.long 0x31fd,0x41f5,0x11f5,0xe,0x70b0,0x7170,0x1e,0x7230,0x72f0,4,4,4,4,4,4,4,4,4,4,4,4,4,4,4,4,4,4,4,4,4,4,4
.long 0x41fd,0x31f5,0xf6,0x50,0xb0,0x110,0x170,0x1d0,0x230,0x290,0x2f0,0x350,0x3b0,4,4,4,4,4,4,4,4,4,4,4,4,4,4,4,4,4,4,4
.long 0x51fd,0x21f5,0xf6,0x10,0x70,0xd0,0x130,0x190,0x1f0,0x250,0x2b0,0x310,0x370,0x3d0,4,4,4,4,4,4,4,4,4,4,4,4,4,4,4,4,4,4
.long 0x61fd,0x1e,0x7330,0x7370,0x73b0,0x73f0,4,4,4,4,4,4,4,4,4,4,4,4,4,4,4,4,4,4,4,4,4,4,4,4,4,4
.section .rodata,"a"
.p2align 6
.amdhsa_kernel gated_mix__compressed_kv_cla__memory_aug_recurrent_mem_tr__prompt_kernel
  .amdhsa_next_free_vgpr 512
  .amdhsa_next_free_sgpr 102
  .amdhsa_accum_offset 256
  .amdhsa_group_segment_fixed_size 0
  .amdhsa_kernarg_size 136
  .amdhsa_user_sgpr_count 2
  .amdhsa_user_sgpr_kernarg_segment_ptr 1
  .amdhsa_system_sgpr_workgroup_id_x 1
  .amdhsa_float_denorm_mode_32 3
.end_amdhsa_kernel
```

```asm
; @launch grid=(256,1,1) block=(256,1,1) lds=163840
.amdgcn_target "amdgcn-amd-amdhsa--gfx950"
.text
.globl gated_mix__compressed_kv_cla__memory_aug_recurrent_mem_tr__prompt_kernel
.p2align 8
.type gated_mix__compressed_kv_cla__memory_aug_recurrent_mem_tr__prompt_kernel,@function
gated_mix__compressed_kv_cla__memory_aug_recurrent_mem_tr__prompt_kernel:
  s_cmp_ge_u32 s2, 256
  s_cbranch_scc1 L_exit
  s_load_dwordx16 s[8:23], s[0:1], 0
  s_load_dwordx16 s[24:39], s[0:1], 64
  s_load_dwordx2 s[40:41], s[0:1], 128
  s_and_b32 s47, s2, 7
  s_lshr_b32 s45, s2, 3
  s_max_u32 s3, s47, 1
  s_sub_u32 s3, s3, 1
  s_lshl_b32 s3, s3, 5
  s_add_u32 s94, s3, s45
  s_getpc_b64 s[4:5]
L_pc0:
  s_add_u32 s4, s4, L_ptab-L_pc0
  s_addc_u32 s5, s5, 0
  s_lshl_b32 s3, s94, 7
  v_and_b32 v2, 31, v0
  v_lshl_add_u32 v2, v2, 2, s3
  global_load_dword v1, v2, s[4:5]
  s_getreg_b32 s46, hwreg(HW_REG_XCC_ID, 0, 4)
  v_lshrrev_b32 v3, 6, v0
  v_and_b32 v0, 63, v0
  v_readfirstlane_b32 s44, v3
  s_sub_u32 s4, s4, L_ptab-L_pc0
  s_subb_u32 s5, s5, 0
  s_and_b32 s3, s45, 15
  s_lshl_b32 s3, s3, 13
  v_lshl_add_u32 v2, v0, 7, s3
  v_min_u32 v2, L_ptab-L_pc0, v2
  s_cmp_lg_u32 s44, 3
  s_cbranch_scc1 L_nocodepf
  global_load_dword v31, v2, s[4:5]
L_nocodepf:
  s_and_b32 s46, s46, 7
  s_waitcnt lgkmcnt(0)
  s_and_b32 s41, s41, 0xffff
  s_mov_b32 s42, 0x10000000
  s_mov_b32 s43, 0x20000
  s_cmp_eq_u32 s47, 0
  s_cbranch_scc1 L_team
  s_lshl2_add_u32 s3, s94, s44
  v_lshlrev_b32 v2, 7, v0
  s_mov_b32 s95, 0
  s_mov_b32 s50, 0x200000
  s_mov_b32 s51, 0x20000
  s_add_u32 s4, s3, 0
  s_lshr_b32 s5, s4, 8
  s_and_b32 s4, s4, 255
  s_lshl_b32 s4, s4, 13
  s_mov_b64 s[48:49], s[8:9]
  s_mov_b32 s6, 0
  s_cmp_eq_u32 s5, 0
  s_cselect_b64 s[48:49], s[8:9], s[48:49]
  s_cselect_b32 s6, 0x0, s6
  s_cmp_eq_u32 s5, 1
  s_cselect_b64 s[48:49], s[10:11], s[48:49]
  s_cselect_b32 s6, 0x0, s6
  s_add_u32 s48, s48, s6
  s_addc_u32 s49, s49, 0
  s_and_b32 s49, s49, 0xffff
  s_cmp_lt_u32 s5, 2
  s_cselect_b32 s4, s4, 0x40000000
  buffer_load_dword v31, v2, s[48:51], s4 offen
  s_waitcnt vmcnt(1)
L_next:
  v_readlane_b32 s3, v1, s95
  s_add_u32 s95, s95, 1
  s_nop 0
  s_and_b32 s4, s3, 3
  s_cmp_eq_u32 s4, 0
  s_cbranch_scc1 L_after_p
  s_cmp_eq_u32 s4, 2
  s_cbranch_scc1 L_go_outx
L_go_att:
  s_bfe_u32 s56, s3, 0x50004
  s_bfe_u32 s57, s3, 0x3000c
  s_bitcmp1_b32 s3, 3
  s_cbranch_scc1 L_feed
L_att:
  v_lshlrev_b32 v2, 4, v0
  s_lshl_b32 s65, s44, 11
  v_add_u32 v3, s65, v2
  s_mov_b32 s74, 0
  v_and_b32 v6, 7, v0
  s_lshl3_add_u32 s67, s57, 8
  v_lshlrev_b32 v7, 4, v6
  v_sub_u32 v7, s67, v7
  v_med3_i32 v7, v7, 0, 16
  s_lshl_b32 s66, s56, 7
  s_add_u32 s66, s66, 0xd080000
  v_lshl_add_u32 v6, v6, 2, s66
  s_bfe_u32 s66, s57, 0x10001
  s_sub_u32 m0, 5, s66
  s_and_b32 s66, s57, 1
  s_lshl3_add_u32 s66, s66, 8
  s_cmp_lt_u32 s57, 4
  s_cselect_b32 s67, 16, 0
  s_add_u32 s67, s67, s66
  v_writelane_b32 v7, s67, m0
  s_lshl_b32 s66, s57, 7
  s_add_u32 s66, s66, 0xd086400
  v_writelane_b32 v6, s66, 63
  v_writelane_b32 v7, 16, 63
  buffer_load_dword v24, v6, s[40:43], 0 offen sc1
  v_mov_b64 v[128:129], 0
  v_mov_b64 v[130:131], 0
  v_mov_b64 v[132:133], 0
  v_mov_b64 v[134:135], 0
  v_mov_b64 v[136:137], 0
  v_mov_b64 v[138:139], 0
  v_mov_b64 v[140:141], 0
  v_mov_b64 v[142:143], 0
  v_mov_b64 v[144:145], 0
  v_mov_b64 v[146:147], 0
  v_mov_b64 v[148:149], 0
  v_mov_b64 v[150:151], 0
  v_mov_b64 v[152:153], 0
  v_mov_b64 v[154:155], 0
  v_mov_b64 v[156:157], 0
  v_mov_b64 v[158:159], 0
  v_mov_b64 v[160:161], 0
  v_mov_b64 v[162:163], 0
  v_mov_b64 v[164:165], 0
  v_mov_b64 v[166:167], 0
  v_mov_b64 v[168:169], 0
  v_mov_b64 v[170:171], 0
  v_mov_b64 v[172:173], 0
  v_mov_b64 v[174:175], 0
  v_mov_b64 v[176:177], 0
  v_mov_b64 v[178:179], 0
  v_mov_b64 v[180:181], 0
  v_mov_b64 v[182:183], 0
  v_mov_b64 v[184:185], 0
  v_mov_b64 v[186:187], 0
  v_mov_b64 v[188:189], 0
  v_mov_b64 v[190:191], 0
  v_mov_b64 v[192:193], 0
  v_mov_b64 v[194:195], 0
  v_mov_b64 v[196:197], 0
  v_mov_b64 v[198:199], 0
  v_mov_b64 v[200:201], 0
  v_mov_b64 v[202:203], 0
  v_mov_b64 v[204:205], 0
  v_mov_b64 v[206:207], 0
  v_mov_b64 v[208:209], 0
  v_mov_b64 v[210:211], 0
  v_mov_b64 v[212:213], 0
  v_mov_b64 v[214:215], 0
  v_mov_b64 v[216:217], 0
  v_mov_b64 v[218:219], 0
  v_mov_b64 v[220:221], 0
  v_mov_b64 v[222:223], 0
  v_mov_b64 v[224:225], 0
  v_mov_b64 v[226:227], 0
  v_mov_b64 v[228:229], 0
  v_mov_b64 v[230:231], 0
  v_mov_b64 v[232:233], 0
  v_mov_b64 v[234:235], 0
  v_mov_b64 v[236:237], 0
  v_mov_b64 v[238:239], 0
  v_mov_b64 v[240:241], 0
  v_mov_b64 v[242:243], 0
  v_mov_b64 v[244:245], 0
  v_mov_b64 v[246:247], 0
  v_mov_b64 v[248:249], 0
  v_mov_b64 v[250:251], 0
  v_mov_b64 v[252:253], 0
  v_mov_b64 v[254:255], 0
  v_mov_b64 v[96:97], 0
  v_accvgpr_write_b32 a128, 0
  v_mov_b64 v[98:99], 0
  v_accvgpr_write_b32 a129, 0
  v_mov_b64 v[100:101], 0
  v_accvgpr_write_b32 a130, 0
  v_mov_b64 v[102:103], 0
  v_accvgpr_write_b32 a131, 0
  v_mov_b64 v[104:105], 0
  v_accvgpr_write_b32 a132, 0
  v_mov_b64 v[106:107], 0
  v_accvgpr_write_b32 a133, 0
  v_mov_b64 v[108:109], 0
  v_accvgpr_write_b32 a134, 0
  v_mov_b64 v[110:111], 0
  v_accvgpr_write_b32 a135, 0
  v_mov_b64 v[112:113], 0
  v_accvgpr_write_b32 a136, 0
  v_mov_b64 v[114:115], 0
  v_accvgpr_write_b32 a137, 0
  v_mov_b64 v[116:117], 0
  v_accvgpr_write_b32 a138, 0
  v_mov_b64 v[118:119], 0
  v_accvgpr_write_b32 a139, 0
  v_mov_b64 v[120:121], 0
  v_accvgpr_write_b32 a140, 0
  v_mov_b64 v[122:123], 0
  v_accvgpr_write_b32 a141, 0
  v_mov_b64 v[124:125], 0
  v_accvgpr_write_b32 a142, 0
  v_mov_b64 v[126:127], 0
  v_accvgpr_write_b32 a143, 0
  v_mov_b32 v16, 0x3f803f80
  v_mov_b32 v17, 0x3f803f80
  v_mov_b32 v18, 0x3f803f80
  v_mov_b32 v19, 0x3f803f80
  s_mov_b32 s48, s18
  s_and_b32 s49, s19, 0xffff
  s_mov_b32 s50, 0x400000
  s_mov_b32 s51, 0x20000
  s_lshl_b32 s66, s56, 19
  s_add_u32 s60, s66, 0x1000000
  s_add_u32 s61, s66, 0x2000000
  s_lshl_b32 s59, s57, 3
  s_lshr_b32 s67, s44, 1
  s_add_u32 s67, s67, s59
  s_lshl_b32 s68, s67, 13
  s_add_u32 s68, s68, s66
  s_and_b32 s67, s44, 1
  s_lshl_b32 s67, s67, 10
  s_add_u32 s68, s68, s67
  s_lshl4_add_u32 s69, s57, s44
  s_add_u32 s63, s59, 7
  s_lshl_b32 s63, s63, 13
  s_add_u32 s63, s63, s60
  s_sub_u32 s59, s59, 1
  s_add_u32 s62, s60, 0x4000
  s_mov_b32 s64, 0
  s_mov_b32 s70, 0x40004000
  s_lshl_b32 s73, s44, 12
  s_lshl_b32 s72, s56, 17
  s_lshl_b32 s67, s44, 15
  s_add_u32 s72, s72, s67
  v_lshrrev_b32 v8, 4, v0
  v_and_b32 v9, 15, v0
  s_lshl_b32 s67, s44, 4
  v_add_u32 v25, s67, v9
  v_lshlrev_b32 v10, 2, v8
  v_sub_u32 v25, v25, v10
  v_lshlrev_b32 v8, 1, v8
  v_and_b32 v10, 7, v0
  v_xor_b32 v8, v8, v10
  v_lshlrev_b32 v8, 4, v8
  v_lshrrev_b32 v10, 3, v0
  v_lshl_add_u32 v26, v10, 10, v8
  v_lshlrev_b32 v9, 2, v9
  v_add_u32 v4, 122880, v2
L_a_wait:
  s_waitcnt vmcnt(0)
  v_cmp_gt_u32 vcc, v7, v24
  s_cbranch_vccz L_a_go
  buffer_load_dword v24, v6, s[40:43], 0 offen sc1
  s_add_u32 s74, s74, 1
  s_cmp_gt_u32 s74, 1048576
  s_cbranch_scc1 L_exit
  s_branch L_a_wait
L_a_go:
  s_add_u32 m0, s65, 131072
  s_add_u32 s66, s60, 0x2000
  buffer_load_dwordx4 v3, s[40:43], s60 offen sc1 lds
  buffer_load_dwordx4 v3, s[40:43], s60 offen offset:1024 sc1 lds
  s_add_u32 m0, s65, 139264
  s_lshl_b32 s67, s69, 6
  buffer_load_dwordx4 v3, s[40:43], s66 offen sc1 lds
  buffer_load_dwordx4 v3, s[40:43], s66 offen offset:1024 sc1 lds
  s_add_u32 s67, s67, 0xd0c0000
  s_add_u32 s58, s68, 0x1000
  buffer_load_dwordx4 a[0:3], v2, s[40:43], s68 offen offset:0 sc1
  buffer_load_dwordx4 a[4:7], v2, s[40:43], s68 offen offset:2048 sc1
  buffer_load_dwordx4 a[8:11], v2, s[40:43], s58 offen offset:0 sc1
  buffer_load_dwordx4 a[12:15], v2, s[40:43], s58 offen offset:2048 sc1
  s_add_u32 s68, s68, 0x4000
  s_add_u32 s58, s68, 0x1000
  buffer_load_dwordx4 a[16:19], v2, s[40:43], s68 offen offset:0 sc1
  buffer_load_dwordx4 a[20:23], v2, s[40:43], s68 offen offset:2048 sc1
  buffer_load_dwordx4 a[24:27], v2, s[40:43], s58 offen offset:0 sc1
  buffer_load_dwordx4 a[28:31], v2, s[40:43], s58 offen offset:2048 sc1
  s_add_u32 s68, s68, 0x4000
  s_add_u32 s58, s68, 0x1000
  buffer_load_dwordx4 a[32:35], v2, s[40:43], s68 offen offset:0 sc1
  buffer_load_dwordx4 a[36:39], v2, s[40:43], s68 offen offset:2048 sc1
  buffer_load_dwordx4 a[40:43], v2, s[40:43], s58 offen offset:0 sc1
  buffer_load_dwordx4 a[44:47], v2, s[40:43], s58 offen offset:2048 sc1
  s_add_u32 s68, s68, 0x4000
  s_add_u32 s58, s68, 0x1000
  buffer_load_dwordx4 a[48:51], v2, s[40:43], s68 offen offset:0 sc1
  buffer_load_dwordx4 a[52:55], v2, s[40:43], s68 offen offset:2048 sc1
  buffer_load_dwordx4 a[56:59], v2, s[40:43], s58 offen offset:0 sc1
  buffer_load_dwordx4 a[60:63], v2, s[40:43], s58 offen offset:2048 sc1
  s_add_u32 s68, s68, 0x4000
  buffer_load_dword v20, v9, s[40:43], s67 offen offset:0 sc1
  buffer_load_dword v21, v9, s[40:43], s67 offen offset:256 sc1
  buffer_load_dword v22, v9, s[40:43], s67 offen offset:512 sc1
  buffer_load_dword v23, v9, s[40:43], s67 offen offset:768 sc1
  s_add_u32 m0, s64, s65
  s_nop 0
  buffer_load_dwordx4 v3, s[40:43], s61 offen sc1 lds
  s_min_u32 s66, s62, s63
  s_nop 0
  buffer_load_dwordx4 v3, s[40:43], s61 offen offset:1024 sc1 lds
  s_add_u32 m0, m0, 0x2000
  s_nop 0
  buffer_load_dwordx4 v3, s[40:43], s66 offen sc1 lds
  s_add_u32 s61, s61, 0x2000
  s_nop 0
  buffer_load_dwordx4 v3, s[40:43], s66 offen offset:1024 sc1 lds
  s_add_u32 s62, s62, 0x2000
  s_add_u32 s64, s64, 0x4000
  s_and_b32 s64, s64, 0x1ffff
  s_add_u32 m0, s64, s65
  s_nop 0
  buffer_load_dwordx4 v3, s[40:43], s61 offen sc1 lds
  s_min_u32 s66, s62, s63
  s_nop 0
  buffer_load_dwordx4 v3, s[40:43], s61 offen offset:1024 sc1 lds
  s_add_u32 m0, m0, 0x2000
  s_nop 0
  buffer_load_dwordx4 v3, s[40:43], s66 offen sc1 lds
  s_add_u32 s61, s61, 0x2000
  s_nop 0
  buffer_load_dwordx4 v3, s[40:43], s66 offen offset:1024 sc1 lds
  s_add_u32 s62, s62, 0x2000
  s_add_u32 s64, s64, 0x4000
  s_and_b32 s64, s64, 0x1ffff
  s_mul_i32 s69, s69, 786432
  s_lshl_b32 s67, s56, 14
  s_add_u32 s69, s69, s67
  s_add_u32 s76, s69, 0x6000000
  s_add_u32 s77, s69, 0x6300000
  s_add_u32 s78, s69, 0x6600000
  s_add_u32 s79, s69, 0x6900000
  v_mov_b32 v24, 0xff800000
  s_cmp_lg_u32 s57, 0
  s_cbranch_scc1 L_a_nomask0
  v_cmp_gt_i32 s[80:81], 0, v25
  v_cmp_gt_i32 s[82:83], 1, v25
  v_cmp_gt_i32 s[84:85], 2, v25
  v_cmp_gt_i32 s[86:87], 3, v25
  v_cndmask_b32 v96, v96, v24, s[80:81]
  v_cndmask_b32 v97, v97, v24, s[82:83]
  v_cndmask_b32 v98, v98, v24, s[84:85]
  v_cndmask_b32 v99, v99, v24, s[86:87]
  v_cmp_gt_i32 s[80:81], 16, v25
  v_cmp_gt_i32 s[82:83], 17, v25
  v_cmp_gt_i32 s[84:85], 18, v25
  v_cmp_gt_i32 s[86:87], 19, v25
  v_cndmask_b32 v100, v100, v24, s[80:81]
  v_cndmask_b32 v101, v101, v24, s[82:83]
  v_cndmask_b32 v102, v102, v24, s[84:85]
  v_cndmask_b32 v103, v103, v24, s[86:87]
L_a_nomask0:
  s_waitcnt vmcnt(28)
  s_barrier
  ds_read_b128 a[64:67], v4 offset:8192
  ds_read_b128 a[68:71], v4 offset:9216
  ds_read_b128 a[72:75], v4 offset:10240
  ds_read_b128 a[76:79], v4 offset:11264
  ds_read_b128 a[80:83], v4 offset:12288
  ds_read_b128 a[84:87], v4 offset:13312
  ds_read_b128 a[88:91], v4 offset:14336
  ds_read_b128 a[92:95], v4 offset:15360
  v_add_u32 v4, 0x2000, v4
  s_waitcnt vmcnt(24) lgkmcnt(0)
  v_mfma_f32_16x16x32_bf16 v[32:35], a[64:67], a[0:3], v[96:99]
  v_mfma_f32_16x16x32_bf16 v[32:35], a[72:75], a[4:7], v[32:35]
  v_mfma_f32_16x16x32_bf16 v[32:35], a[80:83], a[8:11], v[32:35]
  v_mfma_f32_16x16x32_bf16 v[32:35], a[88:91], a[12:15], v[32:35]
  v_mfma_f32_16x16x32_bf16 v[36:39], a[68:71], a[0:3], v[100:103]
  v_mfma_f32_16x16x32_bf16 v[36:39], a[76:79], a[4:7], v[36:39]
  v_mfma_f32_16x16x32_bf16 v[36:39], a[84:87], a[8:11], v[36:39]
  v_mfma_f32_16x16x32_bf16 v[36:39], a[92:95], a[12:15], v[36:39]
  s_waitcnt vmcnt(20) lgkmcnt(0)
  v_mfma_f32_16x16x32_bf16 v[40:43], a[64:67], a[16:19], v[104:107]
  v_mfma_f32_16x16x32_bf16 v[40:43], a[72:75], a[20:23], v[40:43]
  v_mfma_f32_16x16x32_bf16 v[40:43], a[80:83], a[24:27], v[40:43]
  v_mfma_f32_16x16x32_bf16 v[40:43], a[88:91], a[28:31], v[40:43]
  v_mfma_f32_16x16x32_bf16 v[44:47], a[68:71], a[16:19], v[108:111]
  v_mfma_f32_16x16x32_bf16 v[44:47], a[76:79], a[20:23], v[44:47]
  v_mfma_f32_16x16x32_bf16 v[44:47], a[84:87], a[24:27], v[44:47]
  v_mfma_f32_16x16x32_bf16 v[44:47], a[92:95], a[28:31], v[44:47]
  s_waitcnt vmcnt(16) lgkmcnt(0)
  v_mfma_f32_16x16x32_bf16 v[48:51], a[64:67], a[32:35], v[112:115]
  v_mfma_f32_16x16x32_bf16 v[48:51], a[72:75], a[36:39], v[48:51]
  v_mfma_f32_16x16x32_bf16 v[48:51], a[80:83], a[40:43], v[48:51]
  v_mfma_f32_16x16x32_bf16 v[48:51], a[88:91], a[44:47], v[48:51]
  v_mfma_f32_16x16x32_bf16 v[52:55], a[68:71], a[32:35], v[116:119]
  v_mfma_f32_16x16x32_bf16 v[52:55], a[76:79], a[36:39], v[52:55]
  v_mfma_f32_16x16x32_bf16 v[52:55], a[84:87], a[40:43], v[52:55]
  v_mfma_f32_16x16x32_bf16 v[52:55], a[92:95], a[44:47], v[52:55]
  s_waitcnt vmcnt(12) lgkmcnt(0)
  v_mfma_f32_16x16x32_bf16 v[56:59], a[64:67], a[48:51], v[120:123]
  v_mfma_f32_16x16x32_bf16 v[56:59], a[72:75], a[52:55], v[56:59]
  v_mfma_f32_16x16x32_bf16 v[56:59], a[80:83], a[56:59], v[56:59]
  v_mfma_f32_16x16x32_bf16 v[56:59], a[88:91], a[60:63], v[56:59]
  v_mfma_f32_16x16x32_bf16 v[60:63], a[68:71], a[48:51], v[124:127]
  v_mfma_f32_16x16x32_bf16 v[60:63], a[76:79], a[52:55], v[60:63]
  v_mfma_f32_16x16x32_bf16 v[60:63], a[84:87], a[56:59], v[60:63]
  v_mfma_f32_16x16x32_bf16 v[60:63], a[92:95], a[60:63], v[60:63]
  ds_read_b128 a[64:67], v4 offset:8192
  ds_read_b128 a[68:71], v4 offset:9216
  ds_read_b128 a[72:75], v4 offset:10240
  ds_read_b128 a[76:79], v4 offset:11264
  ds_read_b128 a[80:83], v4 offset:12288
  ds_read_b128 a[84:87], v4 offset:13312
  ds_read_b128 a[88:91], v4 offset:14336
  ds_read_b128 a[92:95], v4 offset:15360
  v_mov_b32 v4, v2
  s_add_u32 m0, s64, s65
  s_nop 0
  buffer_load_dwordx4 v3, s[40:43], s61 offen sc1 lds
  s_min_u32 s66, s62, s63
  s_nop 0
  buffer_load_dwordx4 v3, s[40:43], s61 offen offset:1024 sc1 lds
  s_add_u32 m0, m0, 0x2000
  s_nop 0
  buffer_load_dwordx4 v3, s[40:43], s66 offen sc1 lds
  s_add_u32 s61, s61, 0x2000
  s_nop 0
  buffer_load_dwordx4 v3, s[40:43], s66 offen offset:1024 sc1 lds
  s_add_u32 s62, s62, 0x2000
  s_add_u32 s64, s64, 0x4000
  s_and_b32 s64, s64, 0x1ffff
  v_max3_f32 v6, v32, v33, v34
  v_max3_f32 v7, v35, v36, v37
  v_max3_f32 v6, v6, v38, v39
  v_max_f32 v6, v6, v7
  v_mov_b32 v7, v6
  s_nop 1
  v_permlane32_swap_b32 v7, v6
  v_max_f32 v6, v6, v7
  v_mov_b32 v7, v6
  s_nop 1
  v_permlane16_swap_b32 v7, v6
  v_max_f32 v6, v6, v7
  v_add_f32 v6, 0x41800000, v6
  v_sub_f32 v96, v96, v6
  v_sub_f32 v97, v97, v6
  v_sub_f32 v98, v98, v6
  v_sub_f32 v99, v99, v6
  v_sub_f32 v100, v100, v6
  v_sub_f32 v101, v101, v6
  v_sub_f32 v102, v102, v6
  v_sub_f32 v103, v103, v6
  v_sub_f32 v8, v32, v6
  v_sub_f32 v9, v33, v6
  v_sub_f32 v10, v34, v6
  v_sub_f32 v11, v35, v6
  v_sub_f32 v12, v36, v6
  v_sub_f32 v13, v37, v6
  v_sub_f32 v14, v38, v6
  v_sub_f32 v15, v39, v6
  v_exp_f32 v8, v8
  v_exp_f32 v9, v9
  v_exp_f32 v10, v10
  v_exp_f32 v11, v11
  v_exp_f32 v12, v12
  v_exp_f32 v13, v13
  v_exp_f32 v14, v14
  v_exp_f32 v15, v15
  v_cvt_pk_bf16_f32 v64, v8, v9
  v_cvt_pk_bf16_f32 v65, v10, v11
  v_cvt_pk_bf16_f32 v66, v12, v13
  v_cvt_pk_bf16_f32 v67, v14, v15
  s_add_u32 m0, s64, s65
  s_nop 0
  buffer_load_dwordx4 v3, s[40:43], s61 offen sc1 lds
  s_min_u32 s66, s62, s63
  s_nop 0
  buffer_load_dwordx4 v3, s[40:43], s61 offen offset:1024 sc1 lds
  s_add_u32 m0, m0, 0x2000
  s_nop 0
  buffer_load_dwordx4 v3, s[40:43], s66 offen sc1 lds
  s_add_u32 s61, s61, 0x2000
  s_nop 0
  buffer_load_dwordx4 v3, s[40:43], s66 offen offset:1024 sc1 lds
  s_add_u32 s62, s62, 0x2000
  s_add_u32 s64, s64, 0x4000
  s_and_b32 s64, s64, 0x1ffff
  v_max3_f32 v6, v40, v41, v42
  v_max3_f32 v7, v43, v44, v45
  v_max3_f32 v6, v6, v46, v47
  v_max_f32 v6, v6, v7
  v_mov_b32 v7, v6
  s_nop 1
  v_permlane32_swap_b32 v7, v6
  v_max_f32 v6, v6, v7
  v_mov_b32 v7, v6
  s_nop 1
  v_permlane16_swap_b32 v7, v6
  v_max_f32 v6, v6, v7
  v_add_f32 v6, 0x41800000, v6
  v_sub_f32 v104, v104, v6
  v_sub_f32 v105, v105, v6
  v_sub_f32 v106, v106, v6
  v_sub_f32 v107, v107, v6
  v_sub_f32 v108, v108, v6
  v_sub_f32 v109, v109, v6
  v_sub_f32 v110, v110, v6
  v_sub_f32 v111, v111, v6
  v_sub_f32 v8, v40, v6
  v_sub_f32 v9, v41, v6
  v_sub_f32 v10, v42, v6
  v_sub_f32 v11, v43, v6
  v_sub_f32 v12, v44, v6
  v_sub_f32 v13, v45, v6
  v_sub_f32 v14, v46, v6
  v_sub_f32 v15, v47, v6
  v_exp_f32 v8, v8
  v_exp_f32 v9, v9
  v_exp_f32 v10, v10
  v_exp_f32 v11, v11
  v_exp_f32 v12, v12
  v_exp_f32 v13, v13
  v_exp_f32 v14, v14
  v_exp_f32 v15, v15
  v_cvt_pk_bf16_f32 v68, v8, v9
  v_cvt_pk_bf16_f32 v69, v10, v11
  v_cvt_pk_bf16_f32 v70, v12, v13
  v_cvt_pk_bf16_f32 v71, v14, v15
  s_add_u32 m0, s64, s65
  s_nop 0
  buffer_load_dwordx4 v3, s[40:43], s61 offen sc1 lds
  s_min_u32 s66, s62, s63
  s_nop 0
  buffer_load_dwordx4 v3, s[40:43], s61 offen offset:1024 sc1 lds
  s_add_u32 m0, m0, 0x2000
  s_nop 0
  buffer_load_dwordx4 v3, s[40:43], s66 offen sc1 lds
  s_add_u32 s61, s61, 0x2000
  s_nop 0
  buffer_load_dwordx4 v3, s[40:43], s66 offen offset:1024 sc1 lds
  s_add_u32 s62, s62, 0x2000
  s_add_u32 s64, s64, 0x4000
  s_and_b32 s64, s64, 0x1ffff
  v_max3_f32 v6, v48, v49, v50
  v_max3_f32 v7, v51, v52, v53
  v_max3_f32 v6, v6, v54, v55
  v_max_f32 v6, v6, v7
  v_mov_b32 v7, v6
  s_nop 1
  v_permlane32_swap_b32 v7, v6
  v_max_f32 v6, v6, v7
  v_mov_b32 v7, v6
  s_nop 1
  v_permlane16_swap_b32 v7, v6
  v_max_f32 v6, v6, v7
  v_add_f32 v6, 0x41800000, v6
  v_sub_f32 v112, v112, v6
  v_sub_f32 v113, v113, v6
  v_sub_f32 v114, v114, v6
  v_sub_f32 v115, v115, v6
  v_sub_f32 v116, v116, v6
  v_sub_f32 v117, v117, v6
  v_sub_f32 v118, v118, v6
  v_sub_f32 v119, v119, v6
  v_sub_f32 v8, v48, v6
  v_sub_f32 v9, v49, v6
  v_sub_f32 v10, v50, v6
  v_sub_f32 v11, v51, v6
  v_sub_f32 v12, v52, v6
  v_sub_f32 v13, v53, v6
  v_sub_f32 v14, v54, v6
  v_sub_f32 v15, v55, v6
  v_exp_f32 v8, v8
  v_exp_f32 v9, v9
  v_exp_f32 v10, v10
  v_exp_f32 v11, v11
  v_exp_f32 v12, v12
  v_exp_f32 v13, v13
  v_exp_f32 v14, v14
  v_exp_f32 v15, v15
  v_cvt_pk_bf16_f32 v72, v8, v9
  v_cvt_pk_bf16_f32 v73, v10, v11
  v_cvt_pk_bf16_f32 v74, v12, v13
  v_cvt_pk_bf16_f32 v75, v14, v15
  s_add_u32 m0, s64, s65
  s_nop 0
  buffer_load_dwordx4 v3, s[40:43], s61 offen sc1 lds
  s_min_u32 s66, s62, s63
  s_nop 0
  buffer_load_dwordx4 v3, s[40:43], s61 offen offset:1024 sc1 lds
  s_add_u32 m0, m0, 0x2000
  s_nop 0
  buffer_load_dwordx4 v3, s[40:43], s66 offen sc1 lds
  s_add_u32 s61, s61, 0x2000
  s_nop 0
  buffer_load_dwordx4 v3, s[40:43], s66 offen offset:1024 sc1 lds
  s_add_u32 s62, s62, 0x2000
  s_add_u32 s64, s64, 0x4000
  s_and_b32 s64, s64, 0x1ffff
  v_max3_f32 v6, v56, v57, v58
  v_max3_f32 v7, v59, v60, v61
  v_max3_f32 v6, v6, v62, v63
  v_max_f32 v6, v6, v7
  v_mov_b32 v7, v6
  s_nop 1
  v_permlane32_swap_b32 v7, v6
  v_max_f32 v6, v6, v7
  v_mov_b32 v7, v6
  s_nop 1
  v_permlane16_swap_b32 v7, v6
  v_max_f32 v6, v6, v7
  v_add_f32 v6, 0x41800000, v6
  v_sub_f32 v120, v120, v6
  v_sub_f32 v121, v121, v6
  v_sub_f32 v122, v122, v6
  v_sub_f32 v123, v123, v6
  v_sub_f32 v124, v124, v6
  v_sub_f32 v125, v125, v6
  v_sub_f32 v126, v126, v6
  v_sub_f32 v127, v127, v6
  v_sub_f32 v8, v56, v6
  v_sub_f32 v9, v57, v6
  v_sub_f32 v10, v58, v6
  v_sub_f32 v11, v59, v6
  v_sub_f32 v12, v60, v6
  v_sub_f32 v13, v61, v6
  v_sub_f32 v14, v62, v6
  v_sub_f32 v15, v63, v6
  v_exp_f32 v8, v8
  v_exp_f32 v9, v9
  v_exp_f32 v10, v10
  v_exp_f32 v11, v11
  v_exp_f32 v12, v12
  v_exp_f32 v13, v13
  v_exp_f32 v14, v14
  v_exp_f32 v15, v15
  v_cvt_pk_bf16_f32 v76, v8, v9
  v_cvt_pk_bf16_f32 v77, v10, v11
  v_cvt_pk_bf16_f32 v78, v12, v13
  v_cvt_pk_bf16_f32 v79, v14, v15
  s_add_u32 m0, s64, s65
  s_nop 0
  buffer_load_dwordx4 v3, s[40:43], s61 offen sc1 lds
  s_min_u32 s66, s62, s63
  s_nop 0
  buffer_load_dwordx4 v3, s[40:43], s61 offen offset:1024 sc1 lds
  s_add_u32 m0, m0, 0x2000
  s_nop 0
  buffer_load_dwordx4 v3, s[40:43], s66 offen sc1 lds
  s_add_u32 s61, s61, 0x2000
  s_nop 0
  buffer_load_dwordx4 v3, s[40:43], s66 offen offset:1024 sc1 lds
  s_add_u32 s62, s62, 0x2000
  s_add_u32 s64, s64, 0x4000
  s_and_b32 s64, s64, 0x1ffff
  s_mov_b32 s58, 0
  s_cmp_lg_u32 s57, 0
  s_cbranch_scc1 L_a_s0
  v_cmp_gt_i32 s[80:81], 32, v25
  v_cmp_gt_i32 s[82:83], 33, v25
  v_cmp_gt_i32 s[84:85], 34, v25
  v_cmp_gt_i32 s[86:87], 35, v25
  v_cndmask_b32 v96, v96, v24, s[80:81]
  v_cndmask_b32 v97, v97, v24, s[82:83]
  v_cndmask_b32 v98, v98, v24, s[84:85]
  v_cndmask_b32 v99, v99, v24, s[86:87]
  v_cmp_gt_i32 s[80:81], 48, v25
  v_cmp_gt_i32 s[82:83], 49, v25
  v_cmp_gt_i32 s[84:85], 50, v25
  v_cmp_gt_i32 s[86:87], 51, v25
  v_cndmask_b32 v100, v100, v24, s[80:81]
  v_cndmask_b32 v101, v101, v24, s[82:83]
  v_cndmask_b32 v102, v102, v24, s[84:85]
  v_cndmask_b32 v103, v103, v24, s[86:87]
  s_branch L_a_d1
L_a_s1:
  s_waitcnt vmcnt(24) lgkmcnt(0)
  v_mfma_f32_16x16x32_bf16 v[32:35], a[64:67], a[0:3], v[96:99]
  s_barrier
  ds_read_b128 a[96:99], v4 offset:0
  v_mfma_f32_16x16x32_bf16 v[32:35], a[72:75], a[4:7], v[32:35]
  s_nop 0
  ds_read_b128 a[100:103], v4 offset:1024
  v_mfma_f32_16x16x32_bf16 v[32:35], a[80:83], a[8:11], v[32:35]
  s_nop 0
  ds_read_b128 a[104:107], v4 offset:2048
  v_mfma_f32_16x16x32_bf16 v[32:35], a[88:91], a[12:15], v[32:35]
  s_nop 0
  ds_read_b128 a[108:111], v4 offset:3072
  v_mfma_f32_16x16x32_bf16 v[36:39], a[68:71], a[0:3], v[100:103]
  s_nop 0
  ds_read_b128 a[112:115], v4 offset:4096
  v_mfma_f32_16x16x32_bf16 v[36:39], a[76:79], a[4:7], v[36:39]
  s_nop 0
  ds_read_b128 a[116:119], v4 offset:5120
  v_mfma_f32_16x16x32_bf16 v[36:39], a[84:87], a[8:11], v[36:39]
  s_nop 0
  ds_read_b128 a[120:123], v4 offset:6144
  v_mfma_f32_16x16x32_bf16 v[36:39], a[92:95], a[12:15], v[36:39]
  s_nop 0
  ds_read_b128 a[124:127], v4 offset:7168
  v_mfma_f32_16x16x32_bf16 v[40:43], a[64:67], a[16:19], v[104:107]
  s_nop 0
  v_exp_f32 v8, v32
  v_mfma_f32_16x16x32_bf16 v[40:43], a[72:75], a[20:23], v[40:43]
  s_nop 0
  v_exp_f32 v9, v33
  v_mfma_f32_16x16x32_bf16 v[40:43], a[80:83], a[24:27], v[40:43]
  s_nop 0
  v_exp_f32 v10, v34
  v_mfma_f32_16x16x32_bf16 v[40:43], a[88:91], a[28:31], v[40:43]
  s_nop 0
  v_exp_f32 v11, v35
  v_mfma_f32_16x16x32_bf16 v[44:47], a[68:71], a[16:19], v[108:111]
  s_nop 0
  v_cvt_pk_bf16_f32 v64, v8, v9
  v_cvt_pk_bf16_f32 v65, v10, v11
  v_mfma_f32_16x16x32_bf16 v[44:47], a[76:79], a[20:23], v[44:47]
  s_nop 0
  v_or_b32 v5, v64, v65
  v_mfma_f32_16x16x32_bf16 v[44:47], a[84:87], a[24:27], v[44:47]
  s_nop 0
  v_exp_f32 v12, v36
  v_mfma_f32_16x16x32_bf16 v[44:47], a[92:95], a[28:31], v[44:47]
  s_nop 0
  v_exp_f32 v13, v37
  v_mfma_f32_16x16x32_bf16 v[48:51], a[64:67], a[32:35], v[112:115]
  s_nop 0
  v_exp_f32 v14, v38
  v_mfma_f32_16x16x32_bf16 v[48:51], a[72:75], a[36:39], v[48:51]
  s_nop 0
  v_exp_f32 v15, v39
  v_mfma_f32_16x16x32_bf16 v[48:51], a[80:83], a[40:43], v[48:51]
  s_nop 0
  v_cvt_pk_bf16_f32 v66, v12, v13
  v_cvt_pk_bf16_f32 v67, v14, v15
  v_mfma_f32_16x16x32_bf16 v[48:51], a[88:91], a[44:47], v[48:51]
  s_add_u32 m0, s64, s65
  s_nop 0
  buffer_load_dwordx4 v3, s[40:43], s61 offen sc1 lds
  v_or3_b32 v5, v5, v66, v67
  v_mfma_f32_16x16x32_bf16 v[52:55], a[68:71], a[32:35], v[116:119]
  s_nop 0
  v_exp_f32 v8, v40
  v_mfma_f32_16x16x32_bf16 v[52:55], a[76:79], a[36:39], v[52:55]
  s_nop 0
  v_exp_f32 v9, v41
  v_mfma_f32_16x16x32_bf16 v[52:55], a[84:87], a[40:43], v[52:55]
  s_min_u32 s66, s62, s63
  buffer_load_dwordx4 v3, s[40:43], s61 offen offset:1024 sc1 lds
  v_mfma_f32_16x16x32_bf16 v[52:55], a[92:95], a[44:47], v[52:55]
  s_nop 0
  v_exp_f32 v10, v42
  v_mfma_f32_16x16x32_bf16 v[56:59], a[64:67], a[48:51], v[120:123]
  s_nop 0
  v_exp_f32 v11, v43
  v_mfma_f32_16x16x32_bf16 v[56:59], a[72:75], a[52:55], v[56:59]
  s_add_u32 m0, m0, 0x2000
  s_nop 0
  buffer_load_dwordx4 v3, s[40:43], s66 offen sc1 lds
  v_cvt_pk_bf16_f32 v68, v8, v9
  v_mfma_f32_16x16x32_bf16 v[56:59], a[80:83], a[56:59], v[56:59]
  s_nop 0
  v_cvt_pk_bf16_f32 v69, v10, v11
  v_or3_b32 v5, v5, v68, v69
  v_mfma_f32_16x16x32_bf16 v[56:59], a[88:91], a[60:63], v[56:59]
  s_nop 0
  v_exp_f32 v12, v44
  v_mfma_f32_16x16x32_bf16 v[60:63], a[68:71], a[48:51], v[124:127]
  s_add_u32 s61, s61, 0x2000
  buffer_load_dwordx4 v3, s[40:43], s66 offen offset:1024 sc1 lds
  v_mfma_f32_16x16x32_bf16 v[60:63], a[76:79], a[52:55], v[60:63]
  s_add_u32 s62, s62, 0x2000
  v_exp_f32 v13, v45
  v_mfma_f32_16x16x32_bf16 v[60:63], a[84:87], a[56:59], v[60:63]
  s_add_u32 s64, s64, 0x4000
  v_exp_f32 v14, v46
  v_mfma_f32_16x16x32_bf16 v[60:63], a[92:95], a[60:63], v[60:63]
  s_and_b32 s64, s64, 0x1ffff
  v_exp_f32 v15, v47
  v_mfma_f32_16x16x32_bf16 a[128:131], v[16:19], v[80:83], a[128:131]
  s_add_u32 s58, s58, 1
  v_cvt_pk_bf16_f32 v70, v12, v13
  v_cvt_pk_bf16_f32 v71, v14, v15
  v_mfma_f32_16x16x32_bf16 a[132:135], v[16:19], v[84:87], a[132:135]
  s_nop 0
  ds_read_b128 a[64:67], v4 offset:8192
  v_or3_b32 v5, v5, v70, v71
  v_mfma_f32_16x16x32_bf16 a[136:139], v[16:19], v[88:91], a[136:139]
  s_nop 0
  v_exp_f32 v8, v48
  v_mfma_f32_16x16x32_bf16 a[140:143], v[16:19], v[92:95], a[140:143]
  s_nop 0
  v_exp_f32 v9, v49
  s_waitcnt lgkmcnt(1)
  v_mfma_f32_16x16x32_bf16 v[128:131], a[96:99], v[80:83], v[128:131]
  ds_read_b128 a[68:71], v4 offset:9216
  v_mfma_f32_16x16x32_bf16 v[160:163], a[96:99], v[84:87], v[160:163]
  v_exp_f32 v10, v50
  v_mfma_f32_16x16x32_bf16 v[192:195], a[96:99], v[88:91], v[192:195]
  v_exp_f32 v11, v51
  v_mfma_f32_16x16x32_bf16 v[224:227], a[96:99], v[92:95], v[224:227]
  ds_read_b128 a[72:75], v4 offset:10240
  v_cvt_pk_bf16_f32 v72, v8, v9
  v_mfma_f32_16x16x32_bf16 v[132:135], a[100:103], v[80:83], v[132:135]
  v_cvt_pk_bf16_f32 v73, v10, v11
  v_or3_b32 v5, v5, v72, v73
  v_mfma_f32_16x16x32_bf16 v[164:167], a[100:103], v[84:87], v[164:167]
  v_exp_f32 v12, v52
  v_mfma_f32_16x16x32_bf16 v[196:199], a[100:103], v[88:91], v[196:199]
  ds_read_b128 a[76:79], v4 offset:11264
  v_mfma_f32_16x16x32_bf16 v[228:231], a[100:103], v[92:95], v[228:231]
  v_exp_f32 v13, v53
  v_mfma_f32_16x16x32_bf16 v[136:139], a[104:107], v[80:83], v[136:139]
  v_exp_f32 v14, v54
  v_mfma_f32_16x16x32_bf16 v[168:171], a[104:107], v[84:87], v[168:171]
  ds_read_b128 a[80:83], v4 offset:12288
  v_mfma_f32_16x16x32_bf16 v[200:203], a[104:107], v[88:91], v[200:203]
  v_exp_f32 v15, v55
  v_mfma_f32_16x16x32_bf16 v[232:235], a[104:107], v[92:95], v[232:235]
  v_cvt_pk_bf16_f32 v74, v12, v13
  v_cvt_pk_bf16_f32 v75, v14, v15
  v_mfma_f32_16x16x32_bf16 v[140:143], a[108:111], v[80:83], v[140:143]
  ds_read_b128 a[84:87], v4 offset:13312
  v_or3_b32 v5, v5, v74, v75
  v_mfma_f32_16x16x32_bf16 v[172:175], a[108:111], v[84:87], v[172:175]
  v_exp_f32 v8, v56
  v_mfma_f32_16x16x32_bf16 v[204:207], a[108:111], v[88:91], v[204:207]
  v_exp_f32 v9, v57
  v_mfma_f32_16x16x32_bf16 v[236:239], a[108:111], v[92:95], v[236:239]
  ds_read_b128 a[88:91], v4 offset:14336
  v_mfma_f32_16x16x32_bf16 v[144:147], a[112:115], v[80:83], v[144:147]
  v_exp_f32 v10, v58
  v_mfma_f32_16x16x32_bf16 v[176:179], a[112:115], v[84:87], v[176:179]
  v_exp_f32 v11, v59
  v_mfma_f32_16x16x32_bf16 v[208:211], a[112:115], v[88:91], v[208:211]
  ds_read_b128 a[92:95], v4 offset:15360
  v_cvt_pk_bf16_f32 v76, v8, v9
  v_mfma_f32_16x16x32_bf16 v[240:243], a[112:115], v[92:95], v[240:243]
  v_cvt_pk_bf16_f32 v77, v10, v11
  v_or3_b32 v5, v5, v76, v77
  v_mfma_f32_16x16x32_bf16 v[148:151], a[116:119], v[80:83], v[148:151]
  v_exp_f32 v12, v60
  v_mfma_f32_16x16x32_bf16 v[180:183], a[116:119], v[84:87], v[180:183]
  v_exp_f32 v13, v61
  v_mfma_f32_16x16x32_bf16 v[212:215], a[116:119], v[88:91], v[212:215]
  v_exp_f32 v14, v62
  v_mfma_f32_16x16x32_bf16 v[244:247], a[116:119], v[92:95], v[244:247]
  v_exp_f32 v15, v63
  v_mfma_f32_16x16x32_bf16 v[152:155], a[120:123], v[80:83], v[152:155]
  v_cvt_pk_bf16_f32 v78, v12, v13
  v_cvt_pk_bf16_f32 v79, v14, v15
  v_mfma_f32_16x16x32_bf16 v[184:187], a[120:123], v[84:87], v[184:187]
  v_or3_b32 v5, v5, v78, v79
  v_and_b32 v5, s70, v5
  v_mfma_f32_16x16x32_bf16 v[216:219], a[120:123], v[88:91], v[216:219]
  v_cmp_ne_u32 vcc, 0, v5
  v_add_u32 v4, 0x4000, v4
  v_mfma_f32_16x16x32_bf16 v[248:251], a[120:123], v[92:95], v[248:251]
  v_and_b32 v4, 0x1ffff, v4
  v_mfma_f32_16x16x32_bf16 v[156:159], a[124:127], v[80:83], v[156:159]
  v_mfma_f32_16x16x32_bf16 v[188:191], a[124:127], v[84:87], v[188:191]
  v_mfma_f32_16x16x32_bf16 v[220:223], a[124:127], v[88:91], v[220:223]
  v_mfma_f32_16x16x32_bf16 v[252:255], a[124:127], v[92:95], v[252:255]
  s_cbranch_vccnz L_a_s1_t
L_a_s1_r:
L_a_s0:
  s_waitcnt vmcnt(24) lgkmcnt(0)
  v_mfma_f32_16x16x32_bf16 v[32:35], a[64:67], a[0:3], v[96:99]
  s_barrier
  ds_read_b128 a[96:99], v4 offset:0
  v_mfma_f32_16x16x32_bf16 v[32:35], a[72:75], a[4:7], v[32:35]
  s_nop 0
  ds_read_b128 a[100:103], v4 offset:1024
  v_mfma_f32_16x16x32_bf16 v[32:35], a[80:83], a[8:11], v[32:35]
  s_nop 0
  ds_read_b128 a[104:107], v4 offset:2048
  v_mfma_f32_16x16x32_bf16 v[32:35], a[88:91], a[12:15], v[32:35]
  s_nop 0
  ds_read_b128 a[108:111], v4 offset:3072
  v_mfma_f32_16x16x32_bf16 v[36:39], a[68:71], a[0:3], v[100:103]
  s_nop 0
  ds_read_b128 a[112:115], v4 offset:4096
  v_mfma_f32_16x16x32_bf16 v[36:39], a[76:79], a[4:7], v[36:39]
  s_nop 0
  ds_read_b128 a[116:119], v4 offset:5120
  v_mfma_f32_16x16x32_bf16 v[36:39], a[84:87], a[8:11], v[36:39]
  s_nop 0
  ds_read_b128 a[120:123], v4 offset:6144
  v_mfma_f32_16x16x32_bf16 v[36:39], a[92:95], a[12:15], v[36:39]
  s_nop 0
  ds_read_b128 a[124:127], v4 offset:7168
  v_mfma_f32_16x16x32_bf16 v[40:43], a[64:67], a[16:19], v[104:107]
  s_nop 0
  v_exp_f32 v8, v32
  v_mfma_f32_16x16x32_bf16 v[40:43], a[72:75], a[20:23], v[40:43]
  s_nop 0
  v_exp_f32 v9, v33
  v_mfma_f32_16x16x32_bf16 v[40:43], a[80:83], a[24:27], v[40:43]
  s_nop 0
  v_exp_f32 v10, v34
  v_mfma_f32_16x16x32_bf16 v[40:43], a[88:91], a[28:31], v[40:43]
  s_nop 0
  v_exp_f32 v11, v35
  v_mfma_f32_16x16x32_bf16 v[44:47], a[68:71], a[16:19], v[108:111]
  s_nop 0
  v_cvt_pk_bf16_f32 v80, v8, v9
  v_cvt_pk_bf16_f32 v81, v10, v11
  v_mfma_f32_16x16x32_bf16 v[44:47], a[76:79], a[20:23], v[44:47]
  s_nop 0
  v_or_b32 v5, v80, v81
  v_mfma_f32_16x16x32_bf16 v[44:47], a[84:87], a[24:27], v[44:47]
  s_nop 0
  v_exp_f32 v12, v36
  v_mfma_f32_16x16x32_bf16 v[44:47], a[92:95], a[28:31], v[44:47]
  s_nop 0
  v_exp_f32 v13, v37
  v_mfma_f32_16x16x32_bf16 v[48:51], a[64:67], a[32:35], v[112:115]
  s_nop 0
  v_exp_f32 v14, v38
  v_mfma_f32_16x16x32_bf16 v[48:51], a[72:75], a[36:39], v[48:51]
  s_nop 0
  v_exp_f32 v15, v39
  v_mfma_f32_16x16x32_bf16 v[48:51], a[80:83], a[40:43], v[48:51]
  s_nop 0
  v_cvt_pk_bf16_f32 v82, v12, v13
  v_cvt_pk_bf16_f32 v83, v14, v15
  v_mfma_f32_16x16x32_bf16 v[48:51], a[88:91], a[44:47], v[48:51]
  s_add_u32 m0, s64, s65
  s_nop 0
  buffer_load_dwordx4 v3, s[40:43], s61 offen sc1 lds
  v_or3_b32 v5, v5, v82, v83
  v_mfma_f32_16x16x32_bf16 v[52:55], a[68:71], a[32:35], v[116:119]
  s_nop 0
  v_exp_f32 v8, v40
  v_mfma_f32_16x16x32_bf16 v[52:55], a[76:79], a[36:39], v[52:55]
  s_nop 0
  v_exp_f32 v9, v41
  v_mfma_f32_16x16x32_bf16 v[52:55], a[84:87], a[40:43], v[52:55]
  s_min_u32 s66, s62, s63
  buffer_load_dwordx4 v3, s[40:43], s61 offen offset:1024 sc1 lds
  v_mfma_f32_16x16x32_bf16 v[52:55], a[92:95], a[44:47], v[52:55]
  s_nop 0
  v_exp_f32 v10, v42
  v_mfma_f32_16x16x32_bf16 v[56:59], a[64:67], a[48:51], v[120:123]
  s_nop 0
  v_exp_f32 v11, v43
  v_mfma_f32_16x16x32_bf16 v[56:59], a[72:75], a[52:55], v[56:59]
  s_add_u32 m0, m0, 0x2000
  s_nop 0
  buffer_load_dwordx4 v3, s[40:43], s66 offen sc1 lds
  v_cvt_pk_bf16_f32 v84, v8, v9
  v_mfma_f32_16x16x32_bf16 v[56:59], a[80:83], a[56:59], v[56:59]
  s_nop 0
  v_cvt_pk_bf16_f32 v85, v10, v11
  v_or3_b32 v5, v5, v84, v85
  v_mfma_f32_16x16x32_bf16 v[56:59], a[88:91], a[60:63], v[56:59]
  s_nop 0
  v_exp_f32 v12, v44
  v_mfma_f32_16x16x32_bf16 v[60:63], a[68:71], a[48:51], v[124:127]
  s_add_u32 s61, s61, 0x2000
  buffer_load_dwordx4 v3, s[40:43], s66 offen offset:1024 sc1 lds
  v_mfma_f32_16x16x32_bf16 v[60:63], a[76:79], a[52:55], v[60:63]
  s_add_u32 s62, s62, 0x2000
  v_exp_f32 v13, v45
  v_mfma_f32_16x16x32_bf16 v[60:63], a[84:87], a[56:59], v[60:63]
  s_add_u32 s64, s64, 0x4000
  v_exp_f32 v14, v46
  v_mfma_f32_16x16x32_bf16 v[60:63], a[92:95], a[60:63], v[60:63]
  s_and_b32 s64, s64, 0x1ffff
  v_exp_f32 v15, v47
  v_mfma_f32_16x16x32_bf16 a[128:131], v[16:19], v[64:67], a[128:131]
  s_add_u32 s58, s58, 1
  v_cvt_pk_bf16_f32 v86, v12, v13
  v_cvt_pk_bf16_f32 v87, v14, v15
  v_mfma_f32_16x16x32_bf16 a[132:135], v[16:19], v[68:71], a[132:135]
  s_nop 0
  ds_read_b128 a[64:67], v4 offset:8192
  v_or3_b32 v5, v5, v86, v87
  v_mfma_f32_16x16x32_bf16 a[136:139], v[16:19], v[72:75], a[136:139]
  s_nop 0
  v_exp_f32 v8, v48
  v_mfma_f32_16x16x32_bf16 a[140:143], v[16:19], v[76:79], a[140:143]
  s_nop 0
  v_exp_f32 v9, v49
  s_waitcnt lgkmcnt(1)
  v_mfma_f32_16x16x32_bf16 v[128:131], a[96:99], v[64:67], v[128:131]
  ds_read_b128 a[68:71], v4 offset:9216
  v_mfma_f32_16x16x32_bf16 v[160:163], a[96:99], v[68:71], v[160:163]
  v_exp_f32 v10, v50
  v_mfma_f32_16x16x32_bf16 v[192:195], a[96:99], v[72:75], v[192:195]
  v_exp_f32 v11, v51
  v_mfma_f32_16x16x32_bf16 v[224:227], a[96:99], v[76:79], v[224:227]
  ds_read_b128 a[72:75], v4 offset:10240
  v_cvt_pk_bf16_f32 v88, v8, v9
  v_mfma_f32_16x16x32_bf16 v[132:135], a[100:103], v[64:67], v[132:135]
  v_cvt_pk_bf16_f32 v89, v10, v11
  v_or3_b32 v5, v5, v88, v89
  v_mfma_f32_16x16x32_bf16 v[164:167], a[100:103], v[68:71], v[164:167]
  v_exp_f32 v12, v52
  v_mfma_f32_16x16x32_bf16 v[196:199], a[100:103], v[72:75], v[196:199]
  ds_read_b128 a[76:79], v4 offset:11264
  v_mfma_f32_16x16x32_bf16 v[228:231], a[100:103], v[76:79], v[228:231]
  v_exp_f32 v13, v53
  v_mfma_f32_16x16x32_bf16 v[136:139], a[104:107], v[64:67], v[136:139]
  v_exp_f32 v14, v54
  v_mfma_f32_16x16x32_bf16 v[168:171], a[104:107], v[68:71], v[168:171]
  ds_read_b128 a[80:83], v4 offset:12288
  v_mfma_f32_16x16x32_bf16 v[200:203], a[104:107], v[72:75], v[200:203]
  v_exp_f32 v15, v55
  v_mfma_f32_16x16x32_bf16 v[232:235], a[104:107], v[76:79], v[232:235]
  v_cvt_pk_bf16_f32 v90, v12, v13
  v_cvt_pk_bf16_f32 v91, v14, v15
  v_mfma_f32_16x16x32_bf16 v[140:143], a[108:111], v[64:67], v[140:143]
  ds_read_b128 a[84:87], v4 offset:13312
  v_or3_b32 v5, v5, v90, v91
  v_mfma_f32_16x16x32_bf16 v[172:175], a[108:111], v[68:71], v[172:175]
  v_exp_f32 v8, v56
  v_mfma_f32_16x16x32_bf16 v[204:207], a[108:111], v[72:75], v[204:207]
  v_exp_f32 v9, v57
  v_mfma_f32_16x16x32_bf16 v[236:239], a[108:111], v[76:79], v[236:239]
  ds_read_b128 a[88:91], v4 offset:14336
  v_mfma_f32_16x16x32_bf16 v[144:147], a[112:115], v[64:67], v[144:147]
  v_exp_f32 v10, v58
  v_mfma_f32_16x16x32_bf16 v[176:179], a[112:115], v[68:71], v[176:179]
  v_exp_f32 v11, v59
  v_mfma_f32_16x16x32_bf16 v[208:211], a[112:115], v[72:75], v[208:211]
  ds_read_b128 a[92:95], v4 offset:15360
  v_cvt_pk_bf16_f32 v92, v8, v9
  v_mfma_f32_16x16x32_bf16 v[240:243], a[112:115], v[76:79], v[240:243]
  v_cvt_pk_bf16_f32 v93, v10, v11
  v_or3_b32 v5, v5, v92, v93
  v_mfma_f32_16x16x32_bf16 v[148:151], a[116:119], v[64:67], v[148:151]
  v_exp_f32 v12, v60
  v_mfma_f32_16x16x32_bf16 v[180:183], a[116:119], v[68:71], v[180:183]
  v_exp_f32 v13, v61
  v_mfma_f32_16x16x32_bf16 v[212:215], a[116:119], v[72:75], v[212:215]
  v_exp_f32 v14, v62
  v_mfma_f32_16x16x32_bf16 v[244:247], a[116:119], v[76:79], v[244:247]
  v_exp_f32 v15, v63
  v_mfma_f32_16x16x32_bf16 v[152:155], a[120:123], v[64:67], v[152:155]
  v_cvt_pk_bf16_f32 v94, v12, v13
  v_cvt_pk_bf16_f32 v95, v14, v15
  v_mfma_f32_16x16x32_bf16 v[184:187], a[120:123], v[68:71], v[184:187]
  v_or3_b32 v5, v5, v94, v95
  v_and_b32 v5, s70, v5
  v_mfma_f32_16x16x32_bf16 v[216:219], a[120:123], v[72:75], v[216:219]
  v_cmp_ne_u32 vcc, 0, v5
  v_add_u32 v4, 0x4000, v4
  v_mfma_f32_16x16x32_bf16 v[248:251], a[120:123], v[76:79], v[248:251]
  v_and_b32 v4, 0x1ffff, v4
  v_mfma_f32_16x16x32_bf16 v[156:159], a[124:127], v[64:67], v[156:159]
  v_mfma_f32_16x16x32_bf16 v[188:191], a[124:127], v[68:71], v[188:191]
  v_mfma_f32_16x16x32_bf16 v[220:223], a[124:127], v[72:75], v[220:223]
  v_mfma_f32_16x16x32_bf16 v[252:255], a[124:127], v[76:79], v[252:255]
  s_cbranch_vccnz L_a_s0_t
L_a_s0_r:
  s_cmp_eq_u32 s58, s59
  s_cbranch_scc0 L_a_s1
  v_cmp_gt_i32 s[80:81], 0, v25
  v_cmp_gt_i32 s[82:83], 1, v25
  v_cmp_gt_i32 s[84:85], 2, v25
  v_cmp_gt_i32 s[86:87], 3, v25
  v_cndmask_b32 v96, v96, v24, s[80:81]
  v_cndmask_b32 v97, v97, v24, s[82:83]
  v_cndmask_b32 v98, v98, v24, s[84:85]
  v_cndmask_b32 v99, v99, v24, s[86:87]
  v_cmp_gt_i32 s[80:81], 16, v25
  v_cmp_gt_i32 s[82:83], 17, v25
  v_cmp_gt_i32 s[84:85], 18, v25
  v_cmp_gt_i32 s[86:87], 19, v25
  v_cndmask_b32 v100, v100, v24, s[80:81]
  v_cndmask_b32 v101, v101, v24, s[82:83]
  v_cndmask_b32 v102, v102, v24, s[84:85]
  v_cndmask_b32 v103, v103, v24, s[86:87]
  s_nop 0
L_a_d0:
  s_waitcnt vmcnt(24) lgkmcnt(0)
  v_mfma_f32_16x16x32_bf16 v[32:35], a[64:67], a[0:3], v[96:99]
  s_barrier
  ds_read_b128 a[96:99], v4 offset:0
  v_mfma_f32_16x16x32_bf16 v[32:35], a[72:75], a[4:7], v[32:35]
  s_nop 0
  ds_read_b128 a[100:103], v4 offset:1024
  v_mfma_f32_16x16x32_bf16 v[32:35], a[80:83], a[8:11], v[32:35]
  s_nop 0
  ds_read_b128 a[104:107], v4 offset:2048
  v_mfma_f32_16x16x32_bf16 v[32:35], a[88:91], a[12:15], v[32:35]
  s_nop 0
  ds_read_b128 a[108:111], v4 offset:3072
  v_mfma_f32_16x16x32_bf16 v[36:39], a[68:71], a[0:3], v[100:103]
  s_nop 0
  ds_read_b128 a[112:115], v4 offset:4096
  v_mfma_f32_16x16x32_bf16 v[36:39], a[76:79], a[4:7], v[36:39]
  s_nop 0
  ds_read_b128 a[116:119], v4 offset:5120
  v_mfma_f32_16x16x32_bf16 v[36:39], a[84:87], a[8:11], v[36:39]
  s_nop 0
  ds_read_b128 a[120:123], v4 offset:6144
  v_mfma_f32_16x16x32_bf16 v[36:39], a[92:95], a[12:15], v[36:39]
  s_nop 0
  ds_read_b128 a[124:127], v4 offset:7168
  v_mfma_f32_16x16x32_bf16 v[40:43], a[64:67], a[16:19], v[104:107]
  s_nop 0
  v_exp_f32 v8, v32
  v_mfma_f32_16x16x32_bf16 v[40:43], a[72:75], a[20:23], v[40:43]
  s_nop 0
  v_exp_f32 v9, v33
  v_mfma_f32_16x16x32_bf16 v[40:43], a[80:83], a[24:27], v[40:43]
  s_nop 0
  v_exp_f32 v10, v34
  v_mfma_f32_16x16x32_bf16 v[40:43], a[88:91], a[28:31], v[40:43]
  s_nop 0
  v_exp_f32 v11, v35
  v_mfma_f32_16x16x32_bf16 v[44:47], a[68:71], a[16:19], v[108:111]
  s_nop 0
  v_cvt_pk_bf16_f32 v64, v8, v9
  v_cvt_pk_bf16_f32 v65, v10, v11
  v_mfma_f32_16x16x32_bf16 v[44:47], a[76:79], a[20:23], v[44:47]
  s_nop 0
  v_or_b32 v5, v64, v65
  v_mfma_f32_16x16x32_bf16 v[44:47], a[84:87], a[24:27], v[44:47]
  s_nop 0
  v_exp_f32 v12, v36
  v_mfma_f32_16x16x32_bf16 v[44:47], a[92:95], a[28:31], v[44:47]
  s_nop 0
  v_exp_f32 v13, v37
  v_mfma_f32_16x16x32_bf16 v[48:51], a[64:67], a[32:35], v[112:115]
  s_nop 0
  v_exp_f32 v14, v38
  v_mfma_f32_16x16x32_bf16 v[48:51], a[72:75], a[36:39], v[48:51]
  s_nop 0
  v_exp_f32 v15, v39
  v_mfma_f32_16x16x32_bf16 v[48:51], a[80:83], a[40:43], v[48:51]
  s_nop 0
  v_cvt_pk_bf16_f32 v66, v12, v13
  v_cvt_pk_bf16_f32 v67, v14, v15
  v_mfma_f32_16x16x32_bf16 v[48:51], a[88:91], a[44:47], v[48:51]
  s_add_u32 m0, s64, s65
  s_nop 0
  buffer_load_dwordx4 v3, s[40:43], s61 offen sc1 lds
  v_or3_b32 v5, v5, v66, v67
  v_mfma_f32_16x16x32_bf16 v[52:55], a[68:71], a[32:35], v[116:119]
  s_nop 0
  v_exp_f32 v8, v40
  v_mfma_f32_16x16x32_bf16 v[52:55], a[76:79], a[36:39], v[52:55]
  s_nop 0
  v_exp_f32 v9, v41
  v_mfma_f32_16x16x32_bf16 v[52:55], a[84:87], a[40:43], v[52:55]
  s_min_u32 s66, s62, s63
  buffer_load_dwordx4 v3, s[40:43], s61 offen offset:1024 sc1 lds
  v_mfma_f32_16x16x32_bf16 v[52:55], a[92:95], a[44:47], v[52:55]
  s_nop 0
  v_exp_f32 v10, v42
  v_mfma_f32_16x16x32_bf16 v[56:59], a[64:67], a[48:51], v[120:123]
  s_nop 0
  v_exp_f32 v11, v43
  v_mfma_f32_16x16x32_bf16 v[56:59], a[72:75], a[52:55], v[56:59]
  s_add_u32 m0, m0, 0x2000
  s_nop 0
  buffer_load_dwordx4 v3, s[40:43], s66 offen sc1 lds
  v_cvt_pk_bf16_f32 v68, v8, v9
  v_mfma_f32_16x16x32_bf16 v[56:59], a[80:83], a[56:59], v[56:59]
  s_nop 0
  v_cvt_pk_bf16_f32 v69, v10, v11
  v_or3_b32 v5, v5, v68, v69
  v_mfma_f32_16x16x32_bf16 v[56:59], a[88:91], a[60:63], v[56:59]
  s_nop 0
  v_exp_f32 v12, v44
  v_mfma_f32_16x16x32_bf16 v[60:63], a[68:71], a[48:51], v[124:127]
  s_add_u32 s61, s61, 0x2000
  buffer_load_dwordx4 v3, s[40:43], s66 offen offset:1024 sc1 lds
  v_mfma_f32_16x16x32_bf16 v[60:63], a[76:79], a[52:55], v[60:63]
  s_add_u32 s62, s62, 0x2000
  v_exp_f32 v13, v45
  v_mfma_f32_16x16x32_bf16 v[60:63], a[84:87], a[56:59], v[60:63]
  s_add_u32 s64, s64, 0x4000
  v_exp_f32 v14, v46
  v_mfma_f32_16x16x32_bf16 v[60:63], a[92:95], a[60:63], v[60:63]
  s_and_b32 s64, s64, 0x1ffff
  v_exp_f32 v15, v47
  v_mfma_f32_16x16x32_bf16 a[128:131], v[16:19], v[80:83], a[128:131]
  s_add_u32 s58, s58, 1
  v_cvt_pk_bf16_f32 v70, v12, v13
  v_cvt_pk_bf16_f32 v71, v14, v15
  v_mfma_f32_16x16x32_bf16 a[132:135], v[16:19], v[84:87], a[132:135]
  s_nop 0
  ds_read_b128 a[64:67], v4 offset:8192
  v_or3_b32 v5, v5, v70, v71
  v_mfma_f32_16x16x32_bf16 a[136:139], v[16:19], v[88:91], a[136:139]
  s_nop 0
  v_exp_f32 v8, v48
  v_mfma_f32_16x16x32_bf16 a[140:143], v[16:19], v[92:95], a[140:143]
  s_nop 0
  v_exp_f32 v9, v49
  s_waitcnt lgkmcnt(1)
  v_mfma_f32_16x16x32_bf16 v[128:131], a[96:99], v[80:83], v[128:131]
  ds_read_b128 a[68:71], v4 offset:9216
  v_mfma_f32_16x16x32_bf16 v[160:163], a[96:99], v[84:87], v[160:163]
  v_exp_f32 v10, v50
  v_mfma_f32_16x16x32_bf16 v[192:195], a[96:99], v[88:91], v[192:195]
  v_exp_f32 v11, v51
  v_mfma_f32_16x16x32_bf16 v[224:227], a[96:99], v[92:95], v[224:227]
  ds_read_b128 a[72:75], v4 offset:10240
  v_cvt_pk_bf16_f32 v72, v8, v9
  v_mfma_f32_16x16x32_bf16 v[132:135], a[100:103], v[80:83], v[132:135]
  v_cvt_pk_bf16_f32 v73, v10, v11
  v_or3_b32 v5, v5, v72, v73
  v_mfma_f32_16x16x32_bf16 v[164:167], a[100:103], v[84:87], v[164:167]
  v_exp_f32 v12, v52
  v_mfma_f32_16x16x32_bf16 v[196:199], a[100:103], v[88:91], v[196:199]
  ds_read_b128 a[76:79], v4 offset:11264
  v_mfma_f32_16x16x32_bf16 v[228:231], a[100:103], v[92:95], v[228:231]
  v_exp_f32 v13, v53
  v_mfma_f32_16x16x32_bf16 v[136:139], a[104:107], v[80:83], v[136:139]
  v_exp_f32 v14, v54
  v_mfma_f32_16x16x32_bf16 v[168:171], a[104:107], v[84:87], v[168:171]
  ds_read_b128 a[80:83], v4 offset:12288
  v_mfma_f32_16x16x32_bf16 v[200:203], a[104:107], v[88:91], v[200:203]
  v_exp_f32 v15, v55
  v_mfma_f32_16x16x32_bf16 v[232:235], a[104:107], v[92:95], v[232:235]
  v_cvt_pk_bf16_f32 v74, v12, v13
  v_cvt_pk_bf16_f32 v75, v14, v15
  v_mfma_f32_16x16x32_bf16 v[140:143], a[108:111], v[80:83], v[140:143]
  ds_read_b128 a[84:87], v4 offset:13312
  v_or3_b32 v5, v5, v74, v75
  v_mfma_f32_16x16x32_bf16 v[172:175], a[108:111], v[84:87], v[172:175]
  v_exp_f32 v8, v56
  v_mfma_f32_16x16x32_bf16 v[204:207], a[108:111], v[88:91], v[204:207]
  v_exp_f32 v9, v57
  v_mfma_f32_16x16x32_bf16 v[236:239], a[108:111], v[92:95], v[236:239]
  ds_read_b128 a[88:91], v4 offset:14336
  v_mfma_f32_16x16x32_bf16 v[144:147], a[112:115], v[80:83], v[144:147]
  v_exp_f32 v10, v58
  v_mfma_f32_16x16x32_bf16 v[176:179], a[112:115], v[84:87], v[176:179]
  v_exp_f32 v11, v59
  v_mfma_f32_16x16x32_bf16 v[208:211], a[112:115], v[88:91], v[208:211]
  ds_read_b128 a[92:95], v4 offset:15360
  v_cvt_pk_bf16_f32 v76, v8, v9
  v_mfma_f32_16x16x32_bf16 v[240:243], a[112:115], v[92:95], v[240:243]
  v_cvt_pk_bf16_f32 v77, v10, v11
  v_or3_b32 v5, v5, v76, v77
  v_mfma_f32_16x16x32_bf16 v[148:151], a[116:119], v[80:83], v[148:151]
  v_exp_f32 v12, v60
  v_mfma_f32_16x16x32_bf16 v[180:183], a[116:119], v[84:87], v[180:183]
  v_exp_f32 v13, v61
  v_mfma_f32_16x16x32_bf16 v[212:215], a[116:119], v[88:91], v[212:215]
  v_exp_f32 v14, v62
  v_mfma_f32_16x16x32_bf16 v[244:247], a[116:119], v[92:95], v[244:247]
  v_exp_f32 v15, v63
  v_mfma_f32_16x16x32_bf16 v[152:155], a[120:123], v[80:83], v[152:155]
  v_cvt_pk_bf16_f32 v78, v12, v13
  v_cvt_pk_bf16_f32 v79, v14, v15
  v_mfma_f32_16x16x32_bf16 v[184:187], a[120:123], v[84:87], v[184:187]
  v_or3_b32 v5, v5, v78, v79
  v_and_b32 v5, s70, v5
  v_mfma_f32_16x16x32_bf16 v[216:219], a[120:123], v[88:91], v[216:219]
  v_cmp_ne_u32 vcc, 0, v5
  v_cmp_gt_i32 s[80:81], 32, v25
  v_mfma_f32_16x16x32_bf16 v[248:251], a[120:123], v[92:95], v[248:251]
  v_cmp_gt_i32 s[82:83], 33, v25
  v_cmp_gt_i32 s[84:85], 34, v25
  v_mfma_f32_16x16x32_bf16 v[156:159], a[124:127], v[80:83], v[156:159]
  v_cmp_gt_i32 s[86:87], 35, v25
  v_cndmask_b32 v96, v96, v24, s[80:81]
  v_mfma_f32_16x16x32_bf16 v[188:191], a[124:127], v[84:87], v[188:191]
  v_cndmask_b32 v97, v97, v24, s[82:83]
  v_cndmask_b32 v98, v98, v24, s[84:85]
  v_mfma_f32_16x16x32_bf16 v[220:223], a[124:127], v[88:91], v[220:223]
  v_cndmask_b32 v99, v99, v24, s[86:87]
  v_cmp_gt_i32 s[80:81], 48, v25
  v_mfma_f32_16x16x32_bf16 v[252:255], a[124:127], v[92:95], v[252:255]
  v_cmp_gt_i32 s[82:83], 49, v25
  v_cmp_gt_i32 s[84:85], 50, v25
  v_cmp_gt_i32 s[86:87], 51, v25
  v_cndmask_b32 v100, v100, v24, s[80:81]
  v_cndmask_b32 v101, v101, v24, s[82:83]
  v_cndmask_b32 v102, v102, v24, s[84:85]
  v_cndmask_b32 v103, v103, v24, s[86:87]
  v_add_u32 v4, 0x4000, v4
  v_and_b32 v4, 0x1ffff, v4
  s_cbranch_vccnz L_a_d0_t
L_a_d0_r:
L_a_d1:
  s_waitcnt vmcnt(24) lgkmcnt(0)
  v_mfma_f32_16x16x32_bf16 v[32:35], a[64:67], a[0:3], v[96:99]
  s_barrier
  ds_read_b128 a[96:99], v4 offset:0
  v_mfma_f32_16x16x32_bf16 v[32:35], a[72:75], a[4:7], v[32:35]
  s_nop 0
  ds_read_b128 a[100:103], v4 offset:1024
  v_mfma_f32_16x16x32_bf16 v[32:35], a[80:83], a[8:11], v[32:35]
  s_nop 0
  ds_read_b128 a[104:107], v4 offset:2048
  v_mfma_f32_16x16x32_bf16 v[32:35], a[88:91], a[12:15], v[32:35]
  s_nop 0
  ds_read_b128 a[108:111], v4 offset:3072
  v_mfma_f32_16x16x32_bf16 v[36:39], a[68:71], a[0:3], v[100:103]
  s_nop 0
  ds_read_b128 a[112:115], v4 offset:4096
  v_mfma_f32_16x16x32_bf16 v[36:39], a[76:79], a[4:7], v[36:39]
  s_nop 0
  ds_read_b128 a[116:119], v4 offset:5120
  v_mfma_f32_16x16x32_bf16 v[36:39], a[84:87], a[8:11], v[36:39]
  s_nop 0
  ds_read_b128 a[120:123], v4 offset:6144
  v_mfma_f32_16x16x32_bf16 v[36:39], a[92:95], a[12:15], v[36:39]
  s_nop 0
  ds_read_b128 a[124:127], v4 offset:7168
  v_mfma_f32_16x16x32_bf16 v[40:43], a[64:67], a[16:19], v[104:107]
  s_nop 0
  v_exp_f32 v8, v32
  v_mfma_f32_16x16x32_bf16 v[40:43], a[72:75], a[20:23], v[40:43]
  s_nop 0
  v_exp_f32 v9, v33
  v_mfma_f32_16x16x32_bf16 v[40:43], a[80:83], a[24:27], v[40:43]
  s_nop 0
  v_exp_f32 v10, v34
  v_mfma_f32_16x16x32_bf16 v[40:43], a[88:91], a[28:31], v[40:43]
  s_nop 0
  v_exp_f32 v11, v35
  v_mfma_f32_16x16x32_bf16 v[44:47], a[68:71], a[16:19], v[108:111]
  s_nop 0
  v_cvt_pk_bf16_f32 v80, v8, v9
  v_cvt_pk_bf16_f32 v81, v10, v11
  v_mfma_f32_16x16x32_bf16 v[44:47], a[76:79], a[20:23], v[44:47]
  s_nop 0
  v_or_b32 v5, v80, v81
  v_mfma_f32_16x16x32_bf16 v[44:47], a[84:87], a[24:27], v[44:47]
  s_nop 0
  v_exp_f32 v12, v36
  v_mfma_f32_16x16x32_bf16 v[44:47], a[92:95], a[28:31], v[44:47]
  s_nop 0
  v_exp_f32 v13, v37
  v_mfma_f32_16x16x32_bf16 v[48:51], a[64:67], a[32:35], v[112:115]
  s_nop 0
  v_exp_f32 v14, v38
  v_mfma_f32_16x16x32_bf16 v[48:51], a[72:75], a[36:39], v[48:51]
  s_nop 0
  v_exp_f32 v15, v39
  v_mfma_f32_16x16x32_bf16 v[48:51], a[80:83], a[40:43], v[48:51]
  s_nop 0
  v_cvt_pk_bf16_f32 v82, v12, v13
  v_cvt_pk_bf16_f32 v83, v14, v15
  v_mfma_f32_16x16x32_bf16 v[48:51], a[88:91], a[44:47], v[48:51]
  s_add_u32 m0, s64, s65
  s_nop 0
  buffer_load_dwordx4 v3, s[40:43], s61 offen sc1 lds
  v_or3_b32 v5, v5, v82, v83
  v_mfma_f32_16x16x32_bf16 v[52:55], a[68:71], a[32:35], v[116:119]
  s_nop 0
  v_exp_f32 v8, v40
  v_mfma_f32_16x16x32_bf16 v[52:55], a[76:79], a[36:39], v[52:55]
  s_nop 0
  v_exp_f32 v9, v41
  v_mfma_f32_16x16x32_bf16 v[52:55], a[84:87], a[40:43], v[52:55]
  s_min_u32 s66, s62, s63
  buffer_load_dwordx4 v3, s[40:43], s61 offen offset:1024 sc1 lds
  v_mfma_f32_16x16x32_bf16 v[52:55], a[92:95], a[44:47], v[52:55]
  s_nop 0
  v_exp_f32 v10, v42
  v_mfma_f32_16x16x32_bf16 v[56:59], a[64:67], a[48:51], v[120:123]
  s_nop 0
  v_exp_f32 v11, v43
  v_mfma_f32_16x16x32_bf16 v[56:59], a[72:75], a[52:55], v[56:59]
  s_add_u32 m0, m0, 0x2000
  s_nop 0
  buffer_load_dwordx4 v3, s[40:43], s66 offen sc1 lds
  v_cvt_pk_bf16_f32 v84, v8, v9
  v_mfma_f32_16x16x32_bf16 v[56:59], a[80:83], a[56:59], v[56:59]
  s_nop 0
  v_cvt_pk_bf16_f32 v85, v10, v11
  v_or3_b32 v5, v5, v84, v85
  v_mfma_f32_16x16x32_bf16 v[56:59], a[88:91], a[60:63], v[56:59]
  s_nop 0
  v_exp_f32 v12, v44
  v_mfma_f32_16x16x32_bf16 v[60:63], a[68:71], a[48:51], v[124:127]
  s_add_u32 s61, s61, 0x2000
  buffer_load_dwordx4 v3, s[40:43], s66 offen offset:1024 sc1 lds
  v_mfma_f32_16x16x32_bf16 v[60:63], a[76:79], a[52:55], v[60:63]
  s_add_u32 s62, s62, 0x2000
  v_exp_f32 v13, v45
  v_mfma_f32_16x16x32_bf16 v[60:63], a[84:87], a[56:59], v[60:63]
  s_add_u32 s64, s64, 0x4000
  v_exp_f32 v14, v46
  v_mfma_f32_16x16x32_bf16 v[60:63], a[92:95], a[60:63], v[60:63]
  s_and_b32 s64, s64, 0x1ffff
  v_exp_f32 v15, v47
  v_mfma_f32_16x16x32_bf16 a[128:131], v[16:19], v[64:67], a[128:131]
  s_add_u32 s58, s58, 1
  v_cvt_pk_bf16_f32 v86, v12, v13
  v_cvt_pk_bf16_f32 v87, v14, v15
  v_mfma_f32_16x16x32_bf16 a[132:135], v[16:19], v[68:71], a[132:135]
  s_nop 0
  ds_read_b128 a[64:67], v4 offset:8192
  v_or3_b32 v5, v5, v86, v87
  v_mfma_f32_16x16x32_bf16 a[136:139], v[16:19], v[72:75], a[136:139]
  s_nop 0
  v_exp_f32 v8, v48
  v_mfma_f32_16x16x32_bf16 a[140:143], v[16:19], v[76:79], a[140:143]
  s_nop 0
  v_exp_f32 v9, v49
  s_waitcnt lgkmcnt(1)
  v_mfma_f32_16x16x32_bf16 v[128:131], a[96:99], v[64:67], v[128:131]
  ds_read_b128 a[68:71], v4 offset:9216
  v_mfma_f32_16x16x32_bf16 v[160:163], a[96:99], v[68:71], v[160:163]
  v_exp_f32 v10, v50
  v_mfma_f32_16x16x32_bf16 v[192:195], a[96:99], v[72:75], v[192:195]
  v_exp_f32 v11, v51
  v_mfma_f32_16x16x32_bf16 v[224:227], a[96:99], v[76:79], v[224:227]
  ds_read_b128 a[72:75], v4 offset:10240
  v_cvt_pk_bf16_f32 v88, v8, v9
  v_mfma_f32_16x16x32_bf16 v[132:135], a[100:103], v[64:67], v[132:135]
  v_cvt_pk_bf16_f32 v89, v10, v11
  v_or3_b32 v5, v5, v88, v89
  v_mfma_f32_16x16x32_bf16 v[164:167], a[100:103], v[68:71], v[164:167]
  v_exp_f32 v12, v52
  v_mfma_f32_16x16x32_bf16 v[196:199], a[100:103], v[72:75], v[196:199]
  ds_read_b128 a[76:79], v4 offset:11264
  v_mfma_f32_16x16x32_bf16 v[228:231], a[100:103], v[76:79], v[228:231]
  v_exp_f32 v13, v53
  v_mfma_f32_16x16x32_bf16 v[136:139], a[104:107], v[64:67], v[136:139]
  v_exp_f32 v14, v54
  v_mfma_f32_16x16x32_bf16 v[168:171], a[104:107], v[68:71], v[168:171]
  ds_read_b128 a[80:83], v4 offset:12288
  v_mfma_f32_16x16x32_bf16 v[200:203], a[104:107], v[72:75], v[200:203]
  v_exp_f32 v15, v55
  v_mfma_f32_16x16x32_bf16 v[232:235], a[104:107], v[76:79], v[232:235]
  v_cvt_pk_bf16_f32 v90, v12, v13
  v_cvt_pk_bf16_f32 v91, v14, v15
  v_mfma_f32_16x16x32_bf16 v[140:143], a[108:111], v[64:67], v[140:143]
  ds_read_b128 a[84:87], v4 offset:13312
  v_or3_b32 v5, v5, v90, v91
  v_mfma_f32_16x16x32_bf16 v[172:175], a[108:111], v[68:71], v[172:175]
  v_exp_f32 v8, v56
  v_mfma_f32_16x16x32_bf16 v[204:207], a[108:111], v[72:75], v[204:207]
  v_exp_f32 v9, v57
  v_mfma_f32_16x16x32_bf16 v[236:239], a[108:111], v[76:79], v[236:239]
  ds_read_b128 a[88:91], v4 offset:14336
  v_mfma_f32_16x16x32_bf16 v[144:147], a[112:115], v[64:67], v[144:147]
  v_exp_f32 v10, v58
  v_mfma_f32_16x16x32_bf16 v[176:179], a[112:115], v[68:71], v[176:179]
  v_exp_f32 v11, v59
  v_mfma_f32_16x16x32_bf16 v[208:211], a[112:115], v[72:75], v[208:211]
  ds_read_b128 a[92:95], v4 offset:15360
  v_cvt_pk_bf16_f32 v92, v8, v9
  v_mfma_f32_16x16x32_bf16 v[240:243], a[112:115], v[76:79], v[240:243]
  v_cvt_pk_bf16_f32 v93, v10, v11
  v_or3_b32 v5, v5, v92, v93
  v_mfma_f32_16x16x32_bf16 v[148:151], a[116:119], v[64:67], v[148:151]
  v_exp_f32 v12, v60
  v_mfma_f32_16x16x32_bf16 v[180:183], a[116:119], v[68:71], v[180:183]
  v_exp_f32 v13, v61
  v_mfma_f32_16x16x32_bf16 v[212:215], a[116:119], v[72:75], v[212:215]
  v_exp_f32 v14, v62
  v_mfma_f32_16x16x32_bf16 v[244:247], a[116:119], v[76:79], v[244:247]
  v_exp_f32 v15, v63
  v_mfma_f32_16x16x32_bf16 v[152:155], a[120:123], v[64:67], v[152:155]
  v_cvt_pk_bf16_f32 v94, v12, v13
  v_cvt_pk_bf16_f32 v95, v14, v15
  v_mfma_f32_16x16x32_bf16 v[184:187], a[120:123], v[68:71], v[184:187]
  v_or3_b32 v5, v5, v94, v95
  v_and_b32 v5, s70, v5
  v_mfma_f32_16x16x32_bf16 v[216:219], a[120:123], v[72:75], v[216:219]
  v_cmp_ne_u32 vcc, 0, v5
  v_cmp_gt_i32 s[80:81], 0, v25
  v_mfma_f32_16x16x32_bf16 v[248:251], a[120:123], v[76:79], v[248:251]
  v_cmp_gt_i32 s[82:83], 1, v25
  v_cmp_gt_i32 s[84:85], 2, v25
  v_mfma_f32_16x16x32_bf16 v[156:159], a[124:127], v[64:67], v[156:159]
  v_cmp_gt_i32 s[86:87], 3, v25
  v_cndmask_b32 v104, v104, v24, s[80:81]
  v_mfma_f32_16x16x32_bf16 v[188:191], a[124:127], v[68:71], v[188:191]
  v_cndmask_b32 v105, v105, v24, s[82:83]
  v_cndmask_b32 v106, v106, v24, s[84:85]
  v_mfma_f32_16x16x32_bf16 v[220:223], a[124:127], v[72:75], v[220:223]
  v_cndmask_b32 v107, v107, v24, s[86:87]
  v_cmp_gt_i32 s[80:81], 16, v25
  v_mfma_f32_16x16x32_bf16 v[252:255], a[124:127], v[76:79], v[252:255]
  v_cmp_gt_i32 s[82:83], 17, v25
  v_cmp_gt_i32 s[84:85], 18, v25
  v_cmp_gt_i32 s[86:87], 19, v25
  v_cndmask_b32 v108, v108, v24, s[80:81]
  v_cndmask_b32 v109, v109, v24, s[82:83]
  v_cndmask_b32 v110, v110, v24, s[84:85]
  v_cndmask_b32 v111, v111, v24, s[86:87]
  v_add_u32 v4, 0x4000, v4
  v_and_b32 v4, 0x1ffff, v4
  s_cbranch_vccnz L_a_d1_t
L_a_d1_r:
L_a_d2:
  s_waitcnt vmcnt(24) lgkmcnt(0)
  v_mfma_f32_16x16x32_bf16 v[40:43], a[64:67], a[16:19], v[104:107]
  s_barrier
  ds_read_b128 a[96:99], v4 offset:0
  v_mfma_f32_16x16x32_bf16 v[40:43], a[72:75], a[20:23], v[40:43]
  s_nop 0
  ds_read_b128 a[100:103], v4 offset:1024
  v_mfma_f32_16x16x32_bf16 v[40:43], a[80:83], a[24:27], v[40:43]
  s_nop 0
  ds_read_b128 a[104:107], v4 offset:2048
  v_mfma_f32_16x16x32_bf16 v[40:43], a[88:91], a[28:31], v[40:43]
  s_nop 0
  ds_read_b128 a[108:111], v4 offset:3072
  v_mfma_f32_16x16x32_bf16 v[44:47], a[68:71], a[16:19], v[108:111]
  s_nop 0
  ds_read_b128 a[112:115], v4 offset:4096
  v_mfma_f32_16x16x32_bf16 v[44:47], a[76:79], a[20:23], v[44:47]
  s_nop 0
  ds_read_b128 a[116:119], v4 offset:5120
  v_mfma_f32_16x16x32_bf16 v[44:47], a[84:87], a[24:27], v[44:47]
  s_nop 0
  ds_read_b128 a[120:123], v4 offset:6144
  v_mfma_f32_16x16x32_bf16 v[44:47], a[92:95], a[28:31], v[44:47]
  s_nop 0
  ds_read_b128 a[124:127], v4 offset:7168
  v_mfma_f32_16x16x32_bf16 v[48:51], a[64:67], a[32:35], v[112:115]
  s_add_u32 m0, s73, 0
  s_add_u32 s66, s72, 0
  buffer_load_dwordx4 v26, s[48:51], s66 offen lds
  v_mfma_f32_16x16x32_bf16 v[48:51], a[72:75], a[36:39], v[48:51]
  s_add_u32 m0, s73, 1024
  s_add_u32 s66, s72, 8192
  buffer_load_dwordx4 v26, s[48:51], s66 offen lds
  v_mfma_f32_16x16x32_bf16 v[48:51], a[80:83], a[40:43], v[48:51]
  s_add_u32 m0, s73, 2048
  s_add_u32 s66, s72, 16384
  buffer_load_dwordx4 v26, s[48:51], s66 offen lds
  v_mfma_f32_16x16x32_bf16 v[48:51], a[88:91], a[44:47], v[48:51]
  s_add_u32 m0, s73, 3072
  s_add_u32 s66, s72, 24576
  buffer_load_dwordx4 v26, s[48:51], s66 offen lds
  v_mfma_f32_16x16x32_bf16 v[52:55], a[68:71], a[32:35], v[116:119]
  s_add_u32 s58, s58, 1
  v_exp_f32 v8, v40
  v_mfma_f32_16x16x32_bf16 v[52:55], a[76:79], a[36:39], v[52:55]
  s_nop 0
  v_exp_f32 v9, v41
  v_mfma_f32_16x16x32_bf16 v[52:55], a[84:87], a[40:43], v[52:55]
  s_nop 0
  v_exp_f32 v10, v42
  v_mfma_f32_16x16x32_bf16 v[52:55], a[92:95], a[44:47], v[52:55]
  s_nop 0
  v_exp_f32 v11, v43
  v_mfma_f32_16x16x32_bf16 v[56:59], a[64:67], a[48:51], v[120:123]
  s_nop 0
  v_cvt_pk_bf16_f32 v68, v8, v9
  v_cvt_pk_bf16_f32 v69, v10, v11
  v_mfma_f32_16x16x32_bf16 v[56:59], a[72:75], a[52:55], v[56:59]
  s_nop 0
  v_or_b32 v5, v68, v69
  v_mfma_f32_16x16x32_bf16 v[56:59], a[80:83], a[56:59], v[56:59]
  s_nop 0
  v_exp_f32 v12, v44
  v_mfma_f32_16x16x32_bf16 v[56:59], a[88:91], a[60:63], v[56:59]
  s_nop 0
  v_exp_f32 v13, v45
  v_mfma_f32_16x16x32_bf16 v[60:63], a[68:71], a[48:51], v[124:127]
  s_nop 0
  v_exp_f32 v14, v46
  v_mfma_f32_16x16x32_bf16 v[60:63], a[76:79], a[52:55], v[60:63]
  s_nop 0
  v_exp_f32 v15, v47
  v_mfma_f32_16x16x32_bf16 v[60:63], a[84:87], a[56:59], v[60:63]
  s_nop 0
  v_cvt_pk_bf16_f32 v70, v12, v13
  v_cvt_pk_bf16_f32 v71, v14, v15
  v_mfma_f32_16x16x32_bf16 v[60:63], a[92:95], a[60:63], v[60:63]
  s_nop 0
  v_or3_b32 v5, v5, v70, v71
  v_mfma_f32_16x16x32_bf16 a[128:131], v[16:19], v[80:83], a[128:131]
  s_nop 0
  v_exp_f32 v8, v48
  v_mfma_f32_16x16x32_bf16 a[132:135], v[16:19], v[84:87], a[132:135]
  s_nop 0
  ds_read_b128 a[64:67], v4 offset:8192
  v_mfma_f32_16x16x32_bf16 a[136:139], v[16:19], v[88:91], a[136:139]
  s_nop 0
  v_exp_f32 v9, v49
  v_mfma_f32_16x16x32_bf16 a[140:143], v[16:19], v[92:95], a[140:143]
  s_nop 0
  v_exp_f32 v10, v50
  s_waitcnt lgkmcnt(1)
  v_mfma_f32_16x16x32_bf16 v[128:131], a[96:99], v[80:83], v[128:131]
  ds_read_b128 a[68:71], v4 offset:9216
  v_mfma_f32_16x16x32_bf16 v[160:163], a[96:99], v[84:87], v[160:163]
  v_exp_f32 v11, v51
  v_mfma_f32_16x16x32_bf16 v[192:195], a[96:99], v[88:91], v[192:195]
  v_cvt_pk_bf16_f32 v72, v8, v9
  v_cvt_pk_bf16_f32 v73, v10, v11
  v_mfma_f32_16x16x32_bf16 v[224:227], a[96:99], v[92:95], v[224:227]
  ds_read_b128 a[72:75], v4 offset:10240
  v_or3_b32 v5, v5, v72, v73
  v_mfma_f32_16x16x32_bf16 v[132:135], a[100:103], v[80:83], v[132:135]
  v_exp_f32 v12, v52
  v_mfma_f32_16x16x32_bf16 v[164:167], a[100:103], v[84:87], v[164:167]
  v_exp_f32 v13, v53
  v_mfma_f32_16x16x32_bf16 v[196:199], a[100:103], v[88:91], v[196:199]
  ds_read_b128 a[76:79], v4 offset:11264
  v_mfma_f32_16x16x32_bf16 v[228:231], a[100:103], v[92:95], v[228:231]
  v_exp_f32 v14, v54
  v_mfma_f32_16x16x32_bf16 v[136:139], a[104:107], v[80:83], v[136:139]
  v_exp_f32 v15, v55
  v_mfma_f32_16x16x32_bf16 v[168:171], a[104:107], v[84:87], v[168:171]
  ds_read_b128 a[80:83], v4 offset:12288
  v_cvt_pk_bf16_f32 v74, v12, v13
  v_mfma_f32_16x16x32_bf16 v[200:203], a[104:107], v[88:91], v[200:203]
  v_cvt_pk_bf16_f32 v75, v14, v15
  v_or3_b32 v5, v5, v74, v75
  v_mfma_f32_16x16x32_bf16 v[232:235], a[104:107], v[92:95], v[232:235]
  v_exp_f32 v8, v56
  v_mfma_f32_16x16x32_bf16 v[140:143], a[108:111], v[80:83], v[140:143]
  ds_read_b128 a[84:87], v4 offset:13312
  v_mfma_f32_16x16x32_bf16 v[172:175], a[108:111], v[84:87], v[172:175]
  v_exp_f32 v9, v57
  v_mfma_f32_16x16x32_bf16 v[204:207], a[108:111], v[88:91], v[204:207]
  v_exp_f32 v10, v58
  v_mfma_f32_16x16x32_bf16 v[236:239], a[108:111], v[92:95], v[236:239]
  ds_read_b128 a[88:91], v4 offset:14336
  v_mfma_f32_16x16x32_bf16 v[144:147], a[112:115], v[80:83], v[144:147]
  v_exp_f32 v11, v59
  v_mfma_f32_16x16x32_bf16 v[176:179], a[112:115], v[84:87], v[176:179]
  v_cvt_pk_bf16_f32 v76, v8, v9
  v_cvt_pk_bf16_f32 v77, v10, v11
  v_mfma_f32_16x16x32_bf16 v[208:211], a[112:115], v[88:91], v[208:211]
  ds_read_b128 a[92:95], v4 offset:15360
  v_or3_b32 v5, v5, v76, v77
  v_mfma_f32_16x16x32_bf16 v[240:243], a[112:115], v[92:95], v[240:243]
  v_exp_f32 v12, v60
  v_mfma_f32_16x16x32_bf16 v[148:151], a[116:119], v[80:83], v[148:151]
  v_exp_f32 v13, v61
  v_mfma_f32_16x16x32_bf16 v[180:183], a[116:119], v[84:87], v[180:183]
  v_exp_f32 v14, v62
  v_mfma_f32_16x16x32_bf16 v[212:215], a[116:119], v[88:91], v[212:215]
  v_exp_f32 v15, v63
  v_mfma_f32_16x16x32_bf16 v[244:247], a[116:119], v[92:95], v[244:247]
  v_cvt_pk_bf16_f32 v78, v12, v13
  v_cvt_pk_bf16_f32 v79, v14, v15
  v_mfma_f32_16x16x32_bf16 v[152:155], a[120:123], v[80:83], v[152:155]
  v_or3_b32 v5, v5, v78, v79
  v_and_b32 v5, s70, v5
  v_mfma_f32_16x16x32_bf16 v[184:187], a[120:123], v[84:87], v[184:187]
  v_cmp_ne_u32 vcc, 0, v5
  v_cmp_gt_i32 s[80:81], 32, v25
  v_mfma_f32_16x16x32_bf16 v[216:219], a[120:123], v[88:91], v[216:219]
  v_cmp_gt_i32 s[82:83], 33, v25
  v_cmp_gt_i32 s[84:85], 34, v25
  v_mfma_f32_16x16x32_bf16 v[248:251], a[120:123], v[92:95], v[248:251]
  v_cmp_gt_i32 s[86:87], 35, v25
  v_cndmask_b32 v104, v104, v24, s[80:81]
  v_mfma_f32_16x16x32_bf16 v[156:159], a[124:127], v[80:83], v[156:159]
  v_cndmask_b32 v105, v105, v24, s[82:83]
  v_cndmask_b32 v106, v106, v24, s[84:85]
  v_mfma_f32_16x16x32_bf16 v[188:191], a[124:127], v[84:87], v[188:191]
  v_cndmask_b32 v107, v107, v24, s[86:87]
  v_cmp_gt_i32 s[80:81], 48, v25
  v_mfma_f32_16x16x32_bf16 v[220:223], a[124:127], v[88:91], v[220:223]
  v_cmp_gt_i32 s[82:83], 49, v25
  v_cmp_gt_i32 s[84:85], 50, v25
  v_mfma_f32_16x16x32_bf16 v[252:255], a[124:127], v[92:95], v[252:255]
  v_cmp_gt_i32 s[86:87], 51, v25
  v_cndmask_b32 v108, v108, v24, s[80:81]
  v_cndmask_b32 v109, v109, v24, s[82:83]
  v_cndmask_b32 v110, v110, v24, s[84:85]
  v_cndmask_b32 v111, v111, v24, s[86:87]
  v_add_u32 v4, 0x4000, v4
  v_and_b32 v4, 0x1ffff, v4
  s_cbranch_vccnz L_a_d2_t
L_a_d2_r:
L_a_d3:
  s_waitcnt vmcnt(24) lgkmcnt(0)
  v_mfma_f32_16x16x32_bf16 v[40:43], a[64:67], a[16:19], v[104:107]
  s_barrier
  ds_read_b128 a[96:99], v4 offset:0
  v_mfma_f32_16x16x32_bf16 v[40:43], a[72:75], a[20:23], v[40:43]
  s_nop 0
  ds_read_b128 a[100:103], v4 offset:1024
  v_mfma_f32_16x16x32_bf16 v[40:43], a[80:83], a[24:27], v[40:43]
  s_nop 0
  ds_read_b128 a[104:107], v4 offset:2048
  v_mfma_f32_16x16x32_bf16 v[40:43], a[88:91], a[28:31], v[40:43]
  s_nop 0
  ds_read_b128 a[108:111], v4 offset:3072
  v_mfma_f32_16x16x32_bf16 v[44:47], a[68:71], a[16:19], v[108:111]
  s_nop 0
  ds_read_b128 a[112:115], v4 offset:4096
  v_mfma_f32_16x16x32_bf16 v[44:47], a[76:79], a[20:23], v[44:47]
  s_nop 0
  ds_read_b128 a[116:119], v4 offset:5120
  v_mfma_f32_16x16x32_bf16 v[44:47], a[84:87], a[24:27], v[44:47]
  s_nop 0
  ds_read_b128 a[120:123], v4 offset:6144
  v_mfma_f32_16x16x32_bf16 v[44:47], a[92:95], a[28:31], v[44:47]
  s_nop 0
  ds_read_b128 a[124:127], v4 offset:7168
  v_mfma_f32_16x16x32_bf16 v[48:51], a[64:67], a[32:35], v[112:115]
  s_add_u32 m0, s73, 16384
  s_add_u32 s66, s72, 128
  buffer_load_dwordx4 v26, s[48:51], s66 offen lds
  v_mfma_f32_16x16x32_bf16 v[48:51], a[72:75], a[36:39], v[48:51]
  s_add_u32 m0, s73, 17408
  s_add_u32 s66, s72, 8320
  buffer_load_dwordx4 v26, s[48:51], s66 offen lds
  v_mfma_f32_16x16x32_bf16 v[48:51], a[80:83], a[40:43], v[48:51]
  s_add_u32 m0, s73, 18432
  s_add_u32 s66, s72, 16512
  buffer_load_dwordx4 v26, s[48:51], s66 offen lds
  v_mfma_f32_16x16x32_bf16 v[48:51], a[88:91], a[44:47], v[48:51]
  s_add_u32 m0, s73, 19456
  s_add_u32 s66, s72, 24704
  buffer_load_dwordx4 v26, s[48:51], s66 offen lds
  v_mfma_f32_16x16x32_bf16 v[52:55], a[68:71], a[32:35], v[116:119]
  s_add_u32 s58, s58, 1
  v_exp_f32 v8, v40
  v_mfma_f32_16x16x32_bf16 v[52:55], a[76:79], a[36:39], v[52:55]
  s_nop 0
  v_exp_f32 v9, v41
  v_mfma_f32_16x16x32_bf16 v[52:55], a[84:87], a[40:43], v[52:55]
  s_nop 0
  v_exp_f32 v10, v42
  v_mfma_f32_16x16x32_bf16 v[52:55], a[92:95], a[44:47], v[52:55]
  s_nop 0
  v_exp_f32 v11, v43
  v_mfma_f32_16x16x32_bf16 v[56:59], a[64:67], a[48:51], v[120:123]
  s_nop 0
  v_cvt_pk_bf16_f32 v84, v8, v9
  v_cvt_pk_bf16_f32 v85, v10, v11
  v_mfma_f32_16x16x32_bf16 v[56:59], a[72:75], a[52:55], v[56:59]
  s_nop 0
  v_or_b32 v5, v84, v85
  v_mfma_f32_16x16x32_bf16 v[56:59], a[80:83], a[56:59], v[56:59]
  s_nop 0
  v_exp_f32 v12, v44
  v_mfma_f32_16x16x32_bf16 v[56:59], a[88:91], a[60:63], v[56:59]
  s_nop 0
  v_exp_f32 v13, v45
  v_mfma_f32_16x16x32_bf16 v[60:63], a[68:71], a[48:51], v[124:127]
  s_nop 0
  v_exp_f32 v14, v46
  v_mfma_f32_16x16x32_bf16 v[60:63], a[76:79], a[52:55], v[60:63]
  s_nop 0
  v_exp_f32 v15, v47
  v_mfma_f32_16x16x32_bf16 v[60:63], a[84:87], a[56:59], v[60:63]
  s_nop 0
  v_cvt_pk_bf16_f32 v86, v12, v13
  v_cvt_pk_bf16_f32 v87, v14, v15
  v_mfma_f32_16x16x32_bf16 v[60:63], a[92:95], a[60:63], v[60:63]
  s_nop 0
  v_or3_b32 v5, v5, v86, v87
  v_mfma_f32_16x16x32_bf16 a[132:135], v[16:19], v[68:71], a[132:135]
  s_nop 0
  ds_read_b128 a[64:67], v4 offset:8192
  v_mfma_f32_16x16x32_bf16 a[136:139], v[16:19], v[72:75], a[136:139]
  s_nop 0
  ds_read_b128 a[68:71], v4 offset:9216
  v_mfma_f32_16x16x32_bf16 a[140:143], v[16:19], v[76:79], a[140:143]
  s_nop 0
  ds_read_b128 a[72:75], v4 offset:10240
  s_waitcnt lgkmcnt(3)
  v_mfma_f32_16x16x32_bf16 v[160:163], a[96:99], v[68:71], v[160:163]
  s_nop 0
  ds_read_b128 a[76:79], v4 offset:11264
  v_mfma_f32_16x16x32_bf16 v[192:195], a[96:99], v[72:75], v[192:195]
  ds_read_b128 a[80:83], v4 offset:12288
  v_mfma_f32_16x16x32_bf16 v[224:227], a[96:99], v[76:79], v[224:227]
  ds_read_b128 a[84:87], v4 offset:13312
  v_mfma_f32_16x16x32_bf16 v[164:167], a[100:103], v[68:71], v[164:167]
  ds_read_b128 a[88:91], v4 offset:14336
  v_mfma_f32_16x16x32_bf16 v[196:199], a[100:103], v[72:75], v[196:199]
  ds_read_b128 a[92:95], v4 offset:15360
  v_mfma_f32_16x16x32_bf16 v[228:231], a[100:103], v[76:79], v[228:231]
  v_exp_f32 v8, v48
  v_mfma_f32_16x16x32_bf16 v[168:171], a[104:107], v[68:71], v[168:171]
  v_exp_f32 v9, v49
  v_mfma_f32_16x16x32_bf16 v[200:203], a[104:107], v[72:75], v[200:203]
  v_exp_f32 v10, v50
  v_mfma_f32_16x16x32_bf16 v[232:235], a[104:107], v[76:79], v[232:235]
  v_exp_f32 v11, v51
  v_mfma_f32_16x16x32_bf16 v[172:175], a[108:111], v[68:71], v[172:175]
  v_cvt_pk_bf16_f32 v88, v8, v9
  v_cvt_pk_bf16_f32 v89, v10, v11
  v_mfma_f32_16x16x32_bf16 v[204:207], a[108:111], v[72:75], v[204:207]
  v_or3_b32 v5, v5, v88, v89
  v_mfma_f32_16x16x32_bf16 v[236:239], a[108:111], v[76:79], v[236:239]
  v_exp_f32 v12, v52
  v_mfma_f32_16x16x32_bf16 v[176:179], a[112:115], v[68:71], v[176:179]
  v_exp_f32 v13, v53
  v_mfma_f32_16x16x32_bf16 v[208:211], a[112:115], v[72:75], v[208:211]
  v_exp_f32 v14, v54
  v_mfma_f32_16x16x32_bf16 v[240:243], a[112:115], v[76:79], v[240:243]
  v_exp_f32 v15, v55
  v_mfma_f32_16x16x32_bf16 v[180:183], a[116:119], v[68:71], v[180:183]
  v_cvt_pk_bf16_f32 v90, v12, v13
  v_cvt_pk_bf16_f32 v91, v14, v15
  v_mfma_f32_16x16x32_bf16 v[212:215], a[116:119], v[72:75], v[212:215]
  v_or3_b32 v5, v5, v90, v91
  v_mfma_f32_16x16x32_bf16 v[244:247], a[116:119], v[76:79], v[244:247]
  v_exp_f32 v8, v56
  v_mfma_f32_16x16x32_bf16 v[184:187], a[120:123], v[68:71], v[184:187]
  v_exp_f32 v9, v57
  v_mfma_f32_16x16x32_bf16 v[216:219], a[120:123], v[72:75], v[216:219]
  v_exp_f32 v10, v58
  v_mfma_f32_16x16x32_bf16 v[248:251], a[120:123], v[76:79], v[248:251]
  v_exp_f32 v11, v59
  v_mfma_f32_16x16x32_bf16 v[188:191], a[124:127], v[68:71], v[188:191]
  v_cvt_pk_bf16_f32 v92, v8, v9
  v_cvt_pk_bf16_f32 v93, v10, v11
  v_mfma_f32_16x16x32_bf16 v[220:223], a[124:127], v[72:75], v[220:223]
  v_or3_b32 v5, v5, v92, v93
  v_mfma_f32_16x16x32_bf16 v[252:255], a[124:127], v[76:79], v[252:255]
  v_exp_f32 v12, v60
  v_exp_f32 v13, v61
  v_exp_f32 v14, v62
  v_exp_f32 v15, v63
  s_nop 0
  v_cvt_pk_bf16_f32 v94, v12, v13
  v_cvt_pk_bf16_f32 v95, v14, v15
  v_or3_b32 v5, v5, v94, v95
  v_and_b32 v5, s70, v5
  v_cmp_ne_u32 vcc, 0, v5
  v_cmp_gt_i32 s[80:81], 0, v25
  v_cmp_gt_i32 s[82:83], 1, v25
  v_cmp_gt_i32 s[84:85], 2, v25
  v_cmp_gt_i32 s[86:87], 3, v25
  v_cndmask_b32 v112, v112, v24, s[80:81]
  v_cndmask_b32 v113, v113, v24, s[82:83]
  v_cndmask_b32 v114, v114, v24, s[84:85]
  v_cndmask_b32 v115, v115, v24, s[86:87]
  v_cmp_gt_i32 s[80:81], 16, v25
  v_cmp_gt_i32 s[82:83], 17, v25
  v_cmp_gt_i32 s[84:85], 18, v25
  v_cmp_gt_i32 s[86:87], 19, v25
  v_cndmask_b32 v116, v116, v24, s[80:81]
  v_cndmask_b32 v117, v117, v24, s[82:83]
  v_cndmask_b32 v118, v118, v24, s[84:85]
  v_cndmask_b32 v119, v119, v24, s[86:87]
  v_add_u32 v4, 0x4000, v4
  v_and_b32 v4, 0x1ffff, v4
  s_cbranch_vccnz L_a_d3_t
L_a_d3_r:
L_a_d4:
  s_waitcnt vmcnt(24) lgkmcnt(0)
  v_mfma_f32_16x16x32_bf16 v[48:51], a[64:67], a[32:35], v[112:115]
  s_barrier
  ds_read_b128 a[96:99], v4 offset:0
  v_mfma_f32_16x16x32_bf16 v[48:51], a[72:75], a[36:39], v[48:51]
  s_nop 0
  ds_read_b128 a[100:103], v4 offset:1024
  v_mfma_f32_16x16x32_bf16 v[48:51], a[80:83], a[40:43], v[48:51]
  s_nop 0
  ds_read_b128 a[104:107], v4 offset:2048
  v_mfma_f32_16x16x32_bf16 v[48:51], a[88:91], a[44:47], v[48:51]
  s_nop 0
  ds_read_b128 a[108:111], v4 offset:3072
  v_mfma_f32_16x16x32_bf16 v[52:55], a[68:71], a[32:35], v[116:119]
  s_nop 0
  ds_read_b128 a[112:115], v4 offset:4096
  v_mfma_f32_16x16x32_bf16 v[52:55], a[76:79], a[36:39], v[52:55]
  s_nop 0
  ds_read_b128 a[116:119], v4 offset:5120
  v_mfma_f32_16x16x32_bf16 v[52:55], a[84:87], a[40:43], v[52:55]
  s_nop 0
  ds_read_b128 a[120:123], v4 offset:6144
  v_mfma_f32_16x16x32_bf16 v[52:55], a[92:95], a[44:47], v[52:55]
  s_nop 0
  ds_read_b128 a[124:127], v4 offset:7168
  v_mfma_f32_16x16x32_bf16 v[56:59], a[64:67], a[48:51], v[120:123]
  s_add_u32 m0, s73, 32768
  s_add_u32 s66, s72, 256
  buffer_load_dwordx4 v26, s[48:51], s66 offen lds
  v_mfma_f32_16x16x32_bf16 v[56:59], a[72:75], a[52:55], v[56:59]
  s_add_u32 m0, s73, 33792
  s_add_u32 s66, s72, 8448
  buffer_load_dwordx4 v26, s[48:51], s66 offen lds
  v_mfma_f32_16x16x32_bf16 v[56:59], a[80:83], a[56:59], v[56:59]
  s_add_u32 m0, s73, 34816
  s_add_u32 s66, s72, 16640
  buffer_load_dwordx4 v26, s[48:51], s66 offen lds
  v_mfma_f32_16x16x32_bf16 v[56:59], a[88:91], a[60:63], v[56:59]
  s_add_u32 m0, s73, 35840
  s_add_u32 s66, s72, 24832
  buffer_load_dwordx4 v26, s[48:51], s66 offen lds
  v_mfma_f32_16x16x32_bf16 v[60:63], a[68:71], a[48:51], v[124:127]
  s_add_u32 s58, s58, 1
  v_exp_f32 v8, v48
  v_mfma_f32_16x16x32_bf16 v[60:63], a[76:79], a[52:55], v[60:63]
  s_nop 0
  v_exp_f32 v9, v49
  v_mfma_f32_16x16x32_bf16 v[60:63], a[84:87], a[56:59], v[60:63]
  s_nop 0
  v_exp_f32 v10, v50
  v_mfma_f32_16x16x32_bf16 v[60:63], a[92:95], a[60:63], v[60:63]
  s_nop 0
  v_exp_f32 v11, v51
  v_mfma_f32_16x16x32_bf16 a[132:135], v[16:19], v[84:87], a[132:135]
  s_nop 0
  ds_read_b128 a[64:67], v4 offset:8192
  v_cvt_pk_bf16_f32 v72, v8, v9
  v_mfma_f32_16x16x32_bf16 a[136:139], v[16:19], v[88:91], a[136:139]
  s_nop 0
  ds_read_b128 a[68:71], v4 offset:9216
  v_cvt_pk_bf16_f32 v73, v10, v11
  v_mfma_f32_16x16x32_bf16 a[140:143], v[16:19], v[92:95], a[140:143]
  s_nop 0
  ds_read_b128 a[72:75], v4 offset:10240
  v_or_b32 v5, v72, v73
  s_waitcnt lgkmcnt(3)
  v_mfma_f32_16x16x32_bf16 v[160:163], a[96:99], v[84:87], v[160:163]
  s_nop 0
  ds_read_b128 a[76:79], v4 offset:11264
  v_mfma_f32_16x16x32_bf16 v[192:195], a[96:99], v[88:91], v[192:195]
  ds_read_b128 a[80:83], v4 offset:12288
  v_mfma_f32_16x16x32_bf16 v[224:227], a[96:99], v[92:95], v[224:227]
  ds_read_b128 a[84:87], v4 offset:13312
  v_mfma_f32_16x16x32_bf16 v[164:167], a[100:103], v[84:87], v[164:167]
  ds_read_b128 a[88:91], v4 offset:14336
  v_mfma_f32_16x16x32_bf16 v[196:199], a[100:103], v[88:91], v[196:199]
  ds_read_b128 a[92:95], v4 offset:15360
  v_mfma_f32_16x16x32_bf16 v[228:231], a[100:103], v[92:95], v[228:231]
  v_exp_f32 v12, v52
  v_mfma_f32_16x16x32_bf16 v[168:171], a[104:107], v[84:87], v[168:171]
  v_exp_f32 v13, v53
  v_mfma_f32_16x16x32_bf16 v[200:203], a[104:107], v[88:91], v[200:203]
  v_exp_f32 v14, v54
  v_mfma_f32_16x16x32_bf16 v[232:235], a[104:107], v[92:95], v[232:235]
  v_exp_f32 v15, v55
  v_mfma_f32_16x16x32_bf16 v[172:175], a[108:111], v[84:87], v[172:175]
  v_cvt_pk_bf16_f32 v74, v12, v13
  v_cvt_pk_bf16_f32 v75, v14, v15
  v_mfma_f32_16x16x32_bf16 v[204:207], a[108:111], v[88:91], v[204:207]
  v_or3_b32 v5, v5, v74, v75
  v_mfma_f32_16x16x32_bf16 v[236:239], a[108:111], v[92:95], v[236:239]
  v_exp_f32 v8, v56
  v_mfma_f32_16x16x32_bf16 v[176:179], a[112:115], v[84:87], v[176:179]
  v_exp_f32 v9, v57
  v_mfma_f32_16x16x32_bf16 v[208:211], a[112:115], v[88:91], v[208:211]
  v_exp_f32 v10, v58
  v_mfma_f32_16x16x32_bf16 v[240:243], a[112:115], v[92:95], v[240:243]
  v_exp_f32 v11, v59
  v_mfma_f32_16x16x32_bf16 v[180:183], a[116:119], v[84:87], v[180:183]
  v_cvt_pk_bf16_f32 v76, v8, v9
  v_cvt_pk_bf16_f32 v77, v10, v11
  v_mfma_f32_16x16x32_bf16 v[212:215], a[116:119], v[88:91], v[212:215]
  v_or3_b32 v5, v5, v76, v77
  v_mfma_f32_16x16x32_bf16 v[244:247], a[116:119], v[92:95], v[244:247]
  v_exp_f32 v12, v60
  v_mfma_f32_16x16x32_bf16 v[184:187], a[120:123], v[84:87], v[184:187]
  v_exp_f32 v13, v61
  v_mfma_f32_16x16x32_bf16 v[216:219], a[120:123], v[88:91], v[216:219]
  v_exp_f32 v14, v62
  v_mfma_f32_16x16x32_bf16 v[248:251], a[120:123], v[92:95], v[248:251]
  v_exp_f32 v15, v63
  v_mfma_f32_16x16x32_bf16 v[188:191], a[124:127], v[84:87], v[188:191]
  v_cvt_pk_bf16_f32 v78, v12, v13
  v_cvt_pk_bf16_f32 v79, v14, v15
  v_mfma_f32_16x16x32_bf16 v[220:223], a[124:127], v[88:91], v[220:223]
  v_or3_b32 v5, v5, v78, v79
  v_and_b32 v5, s70, v5
  v_mfma_f32_16x16x32_bf16 v[252:255], a[124:127], v[92:95], v[252:255]
  v_cmp_ne_u32 vcc, 0, v5
  v_cmp_gt_i32 s[80:81], 32, v25
  v_cmp_gt_i32 s[82:83], 33, v25
  v_cmp_gt_i32 s[84:85], 34, v25
  v_cmp_gt_i32 s[86:87], 35, v25
  v_cndmask_b32 v112, v112, v24, s[80:81]
  v_cndmask_b32 v113, v113, v24, s[82:83]
  v_cndmask_b32 v114, v114, v24, s[84:85]
  v_cndmask_b32 v115, v115, v24, s[86:87]
  v_cmp_gt_i32 s[80:81], 48, v25
  v_cmp_gt_i32 s[82:83], 49, v25
  v_cmp_gt_i32 s[84:85], 50, v25
  v_cmp_gt_i32 s[86:87], 51, v25
  v_cndmask_b32 v116, v116, v24, s[80:81]
  v_cndmask_b32 v117, v117, v24, s[82:83]
  v_cndmask_b32 v118, v118, v24, s[84:85]
  v_cndmask_b32 v119, v119, v24, s[86:87]
  v_add_u32 v4, 0x4000, v4
  v_and_b32 v4, 0x1ffff, v4
  s_cbranch_vccnz L_a_d4_t
L_a_d4_r:
L_a_d5:
  s_waitcnt vmcnt(24) lgkmcnt(0)
  v_mfma_f32_16x16x32_bf16 v[48:51], a[64:67], a[32:35], v[112:115]
  s_barrier
  ds_read_b128 a[96:99], v4 offset:0
  v_mfma_f32_16x16x32_bf16 v[48:51], a[72:75], a[36:39], v[48:51]
  s_nop 0
  ds_read_b128 a[100:103], v4 offset:1024
  v_mfma_f32_16x16x32_bf16 v[48:51], a[80:83], a[40:43], v[48:51]
  s_nop 0
  ds_read_b128 a[104:107], v4 offset:2048
  v_mfma_f32_16x16x32_bf16 v[48:51], a[88:91], a[44:47], v[48:51]
  s_nop 0
  ds_read_b128 a[108:111], v4 offset:3072
  v_mfma_f32_16x16x32_bf16 v[52:55], a[68:71], a[32:35], v[116:119]
  s_nop 0
  ds_read_b128 a[112:115], v4 offset:4096
  v_mfma_f32_16x16x32_bf16 v[52:55], a[76:79], a[36:39], v[52:55]
  s_nop 0
  ds_read_b128 a[116:119], v4 offset:5120
  v_mfma_f32_16x16x32_bf16 v[52:55], a[84:87], a[40:43], v[52:55]
  s_nop 0
  ds_read_b128 a[120:123], v4 offset:6144
  v_mfma_f32_16x16x32_bf16 v[52:55], a[92:95], a[44:47], v[52:55]
  s_nop 0
  ds_read_b128 a[124:127], v4 offset:7168
  v_mfma_f32_16x16x32_bf16 v[56:59], a[64:67], a[48:51], v[120:123]
  s_add_u32 m0, s73, 49152
  s_add_u32 s66, s72, 384
  buffer_load_dwordx4 v26, s[48:51], s66 offen lds
  v_mfma_f32_16x16x32_bf16 v[56:59], a[72:75], a[52:55], v[56:59]
  s_add_u32 m0, s73, 50176
  s_add_u32 s66, s72, 8576
  buffer_load_dwordx4 v26, s[48:51], s66 offen lds
  v_mfma_f32_16x16x32_bf16 v[56:59], a[80:83], a[56:59], v[56:59]
  s_add_u32 m0, s73, 51200
  s_add_u32 s66, s72, 16768
  buffer_load_dwordx4 v26, s[48:51], s66 offen lds
  v_mfma_f32_16x16x32_bf16 v[56:59], a[88:91], a[60:63], v[56:59]
  s_add_u32 m0, s73, 52224
  s_add_u32 s66, s72, 24960
  buffer_load_dwordx4 v26, s[48:51], s66 offen lds
  v_mfma_f32_16x16x32_bf16 v[60:63], a[68:71], a[48:51], v[124:127]
  s_add_u32 s58, s58, 1
  v_exp_f32 v8, v48
  v_mfma_f32_16x16x32_bf16 v[60:63], a[76:79], a[52:55], v[60:63]
  s_nop 0
  v_exp_f32 v9, v49
  v_mfma_f32_16x16x32_bf16 v[60:63], a[84:87], a[56:59], v[60:63]
  s_nop 0
  v_exp_f32 v10, v50
  v_mfma_f32_16x16x32_bf16 v[60:63], a[92:95], a[60:63], v[60:63]
  s_nop 0
  v_exp_f32 v11, v51
  v_mfma_f32_16x16x32_bf16 a[136:139], v[16:19], v[72:75], a[136:139]
  s_nop 0
  ds_read_b128 a[64:67], v4 offset:8192
  v_cvt_pk_bf16_f32 v88, v8, v9
  v_mfma_f32_16x16x32_bf16 a[140:143], v[16:19], v[76:79], a[140:143]
  s_nop 0
  ds_read_b128 a[68:71], v4 offset:9216
  v_cvt_pk_bf16_f32 v89, v10, v11
  s_waitcnt lgkmcnt(2)
  v_mfma_f32_16x16x32_bf16 v[192:195], a[96:99], v[72:75], v[192:195]
  s_nop 0
  ds_read_b128 a[72:75], v4 offset:10240
  v_or_b32 v5, v88, v89
  v_mfma_f32_16x16x32_bf16 v[224:227], a[96:99], v[76:79], v[224:227]
  s_nop 0
  ds_read_b128 a[76:79], v4 offset:11264
  v_mfma_f32_16x16x32_bf16 v[196:199], a[100:103], v[72:75], v[196:199]
  ds_read_b128 a[80:83], v4 offset:12288
  v_mfma_f32_16x16x32_bf16 v[228:231], a[100:103], v[76:79], v[228:231]
  ds_read_b128 a[84:87], v4 offset:13312
  v_mfma_f32_16x16x32_bf16 v[200:203], a[104:107], v[72:75], v[200:203]
  ds_read_b128 a[88:91], v4 offset:14336
  v_mfma_f32_16x16x32_bf16 v[232:235], a[104:107], v[76:79], v[232:235]
  ds_read_b128 a[92:95], v4 offset:15360
  v_mfma_f32_16x16x32_bf16 v[204:207], a[108:111], v[72:75], v[204:207]
  v_exp_f32 v12, v52
  v_mfma_f32_16x16x32_bf16 v[236:239], a[108:111], v[76:79], v[236:239]
  v_exp_f32 v13, v53
  v_mfma_f32_16x16x32_bf16 v[208:211], a[112:115], v[72:75], v[208:211]
  v_exp_f32 v14, v54
  v_mfma_f32_16x16x32_bf16 v[240:243], a[112:115], v[76:79], v[240:243]
  v_exp_f32 v15, v55
  v_mfma_f32_16x16x32_bf16 v[212:215], a[116:119], v[72:75], v[212:215]
  v_cvt_pk_bf16_f32 v90, v12, v13
  v_cvt_pk_bf16_f32 v91, v14, v15
  v_mfma_f32_16x16x32_bf16 v[244:247], a[116:119], v[76:79], v[244:247]
  v_or3_b32 v5, v5, v90, v91
  v_mfma_f32_16x16x32_bf16 v[216:219], a[120:123], v[72:75], v[216:219]
  v_exp_f32 v8, v56
  v_mfma_f32_16x16x32_bf16 v[248:251], a[120:123], v[76:79], v[248:251]
  v_exp_f32 v9, v57
  v_mfma_f32_16x16x32_bf16 v[220:223], a[124:127], v[72:75], v[220:223]
  v_exp_f32 v10, v58
  v_mfma_f32_16x16x32_bf16 v[252:255], a[124:127], v[76:79], v[252:255]
  v_exp_f32 v11, v59
  s_nop 0
  v_cvt_pk_bf16_f32 v92, v8, v9
  v_cvt_pk_bf16_f32 v93, v10, v11
  v_or3_b32 v5, v5, v92, v93
  v_exp_f32 v12, v60
  v_exp_f32 v13, v61
  v_exp_f32 v14, v62
  v_exp_f32 v15, v63
  s_nop 0
  v_cvt_pk_bf16_f32 v94, v12, v13
  v_cvt_pk_bf16_f32 v95, v14, v15
  v_or3_b32 v5, v5, v94, v95
  v_and_b32 v5, s70, v5
  v_cmp_ne_u32 vcc, 0, v5
  v_cmp_gt_i32 s[80:81], 0, v25
  v_cmp_gt_i32 s[82:83], 1, v25
  v_cmp_gt_i32 s[84:85], 2, v25
  v_cmp_gt_i32 s[86:87], 3, v25
  v_cndmask_b32 v120, v120, v24, s[80:81]
  v_cndmask_b32 v121, v121, v24, s[82:83]
  v_cndmask_b32 v122, v122, v24, s[84:85]
  v_cndmask_b32 v123, v123, v24, s[86:87]
  v_cmp_gt_i32 s[80:81], 16, v25
  v_cmp_gt_i32 s[82:83], 17, v25
  v_cmp_gt_i32 s[84:85], 18, v25
  v_cmp_gt_i32 s[86:87], 19, v25
  v_cndmask_b32 v124, v124, v24, s[80:81]
  v_cndmask_b32 v125, v125, v24, s[82:83]
  v_cndmask_b32 v126, v126, v24, s[84:85]
  v_cndmask_b32 v127, v127, v24, s[86:87]
  v_add_u32 v4, 0x4000, v4
  v_and_b32 v4, 0x1ffff, v4
  s_cbranch_vccnz L_a_d5_t
L_a_d5_r:
L_a_d6:
  s_waitcnt vmcnt(24) lgkmcnt(0)
  v_mfma_f32_16x16x32_bf16 v[56:59], a[64:67], a[48:51], v[120:123]
  s_barrier
  ds_read_b128 a[96:99], v4 offset:0
  v_mfma_f32_16x16x32_bf16 v[56:59], a[72:75], a[52:55], v[56:59]
  s_nop 0
  ds_read_b128 a[100:103], v4 offset:1024
  v_mfma_f32_16x16x32_bf16 v[56:59], a[80:83], a[56:59], v[56:59]
  s_nop 0
  ds_read_b128 a[104:107], v4 offset:2048
  v_mfma_f32_16x16x32_bf16 v[56:59], a[88:91], a[60:63], v[56:59]
  s_nop 0
  ds_read_b128 a[108:111], v4 offset:3072
  v_mfma_f32_16x16x32_bf16 v[60:63], a[68:71], a[48:51], v[124:127]
  s_nop 0
  ds_read_b128 a[112:115], v4 offset:4096
  v_mfma_f32_16x16x32_bf16 v[60:63], a[76:79], a[52:55], v[60:63]
  s_nop 0
  ds_read_b128 a[116:119], v4 offset:5120
  v_mfma_f32_16x16x32_bf16 v[60:63], a[84:87], a[56:59], v[60:63]
  s_nop 0
  ds_read_b128 a[120:123], v4 offset:6144
  v_mfma_f32_16x16x32_bf16 v[60:63], a[92:95], a[60:63], v[60:63]
  s_nop 0
  ds_read_b128 a[124:127], v4 offset:7168
  v_mfma_f32_16x16x32_bf16 a[136:139], v[16:19], v[88:91], a[136:139]
  s_add_u32 m0, s73, 65536
  s_add_u32 s66, s72, 512
  buffer_load_dwordx4 v26, s[48:51], s66 offen lds
  v_mfma_f32_16x16x32_bf16 a[140:143], v[16:19], v[92:95], a[140:143]
  s_add_u32 m0, s73, 66560
  s_add_u32 s66, s72, 8704
  buffer_load_dwordx4 v26, s[48:51], s66 offen lds
  s_waitcnt lgkmcnt(0)
  v_mfma_f32_16x16x32_bf16 v[192:195], a[96:99], v[88:91], v[192:195]
  s_add_u32 m0, s73, 67584
  s_add_u32 s66, s72, 16896
  buffer_load_dwordx4 v26, s[48:51], s66 offen lds
  v_mfma_f32_16x16x32_bf16 v[224:227], a[96:99], v[92:95], v[224:227]
  s_add_u32 m0, s73, 68608
  s_add_u32 s66, s72, 25088
  buffer_load_dwordx4 v26, s[48:51], s66 offen lds
  v_mfma_f32_16x16x32_bf16 v[196:199], a[100:103], v[88:91], v[196:199]
  s_add_u32 s58, s58, 1
  ds_read_b128 a[64:67], v4 offset:8192
  v_mfma_f32_16x16x32_bf16 v[228:231], a[100:103], v[92:95], v[228:231]
  ds_read_b128 a[68:71], v4 offset:9216
  v_mfma_f32_16x16x32_bf16 v[200:203], a[104:107], v[88:91], v[200:203]
  ds_read_b128 a[72:75], v4 offset:10240
  v_mfma_f32_16x16x32_bf16 v[232:235], a[104:107], v[92:95], v[232:235]
  ds_read_b128 a[76:79], v4 offset:11264
  v_mfma_f32_16x16x32_bf16 v[204:207], a[108:111], v[88:91], v[204:207]
  ds_read_b128 a[80:83], v4 offset:12288
  v_mfma_f32_16x16x32_bf16 v[236:239], a[108:111], v[92:95], v[236:239]
  ds_read_b128 a[84:87], v4 offset:13312
  v_mfma_f32_16x16x32_bf16 v[208:211], a[112:115], v[88:91], v[208:211]
  ds_read_b128 a[88:91], v4 offset:14336
  v_mfma_f32_16x16x32_bf16 v[240:243], a[112:115], v[92:95], v[240:243]
  ds_read_b128 a[92:95], v4 offset:15360
  v_mfma_f32_16x16x32_bf16 v[212:215], a[116:119], v[88:91], v[212:215]
  v_exp_f32 v8, v56
  v_mfma_f32_16x16x32_bf16 v[244:247], a[116:119], v[92:95], v[244:247]
  v_exp_f32 v9, v57
  v_mfma_f32_16x16x32_bf16 v[216:219], a[120:123], v[88:91], v[216:219]
  v_exp_f32 v10, v58
  v_mfma_f32_16x16x32_bf16 v[248:251], a[120:123], v[92:95], v[248:251]
  v_exp_f32 v11, v59
  v_mfma_f32_16x16x32_bf16 v[220:223], a[124:127], v[88:91], v[220:223]
  v_cvt_pk_bf16_f32 v76, v8, v9
  v_cvt_pk_bf16_f32 v77, v10, v11
  v_mfma_f32_16x16x32_bf16 v[252:255], a[124:127], v[92:95], v[252:255]
  v_or_b32 v5, v76, v77
  v_exp_f32 v12, v60
  v_exp_f32 v13, v61
  v_exp_f32 v14, v62
  v_exp_f32 v15, v63
  s_nop 0
  v_cvt_pk_bf16_f32 v78, v12, v13
  v_cvt_pk_bf16_f32 v79, v14, v15
  v_or3_b32 v5, v5, v78, v79
  v_and_b32 v5, s70, v5
  v_cmp_ne_u32 vcc, 0, v5
  v_cmp_gt_i32 s[80:81], 32, v25
  v_cmp_gt_i32 s[82:83], 33, v25
  v_cmp_gt_i32 s[84:85], 34, v25
  v_cmp_gt_i32 s[86:87], 35, v25
  v_cndmask_b32 v120, v120, v24, s[80:81]
  v_cndmask_b32 v121, v121, v24, s[82:83]
  v_cndmask_b32 v122, v122, v24, s[84:85]
  v_cndmask_b32 v123, v123, v24, s[86:87]
  v_cmp_gt_i32 s[80:81], 48, v25
  v_cmp_gt_i32 s[82:83], 49, v25
  v_cmp_gt_i32 s[84:85], 50, v25
  v_cmp_gt_i32 s[86:87], 51, v25
  v_cndmask_b32 v124, v124, v24, s[80:81]
  v_cndmask_b32 v125, v125, v24, s[82:83]
  v_cndmask_b32 v126, v126, v24, s[84:85]
  v_cndmask_b32 v127, v127, v24, s[86:87]
  v_add_u32 v4, 0x4000, v4
  v_and_b32 v4, 0x1ffff, v4
  s_cbranch_vccnz L_a_d6_t
L_a_d6_r:
L_a_d7:
  s_waitcnt vmcnt(24) lgkmcnt(0)
  v_mfma_f32_16x16x32_bf16 v[56:59], a[64:67], a[48:51], v[120:123]
  s_barrier
  ds_read_b128 a[96:99], v4 offset:0
  v_mfma_f32_16x16x32_bf16 v[56:59], a[72:75], a[52:55], v[56:59]
  s_nop 0
  ds_read_b128 a[100:103], v4 offset:1024
  v_mfma_f32_16x16x32_bf16 v[56:59], a[80:83], a[56:59], v[56:59]
  s_nop 0
  ds_read_b128 a[104:107], v4 offset:2048
  v_mfma_f32_16x16x32_bf16 v[56:59], a[88:91], a[60:63], v[56:59]
  s_nop 0
  ds_read_b128 a[108:111], v4 offset:3072
  v_mfma_f32_16x16x32_bf16 v[60:63], a[68:71], a[48:51], v[124:127]
  s_nop 0
  ds_read_b128 a[112:115], v4 offset:4096
  v_mfma_f32_16x16x32_bf16 v[60:63], a[76:79], a[52:55], v[60:63]
  s_nop 0
  ds_read_b128 a[116:119], v4 offset:5120
  v_mfma_f32_16x16x32_bf16 v[60:63], a[84:87], a[56:59], v[60:63]
  s_nop 0
  ds_read_b128 a[120:123], v4 offset:6144
  v_mfma_f32_16x16x32_bf16 v[60:63], a[92:95], a[60:63], v[60:63]
  s_nop 0
  ds_read_b128 a[124:127], v4 offset:7168
  v_mfma_f32_16x16x32_bf16 a[140:143], v[16:19], v[76:79], a[140:143]
  s_add_u32 m0, s73, 81920
  s_add_u32 s66, s72, 640
  buffer_load_dwordx4 v26, s[48:51], s66 offen lds
  s_waitcnt lgkmcnt(0)
  v_mfma_f32_16x16x32_bf16 v[224:227], a[96:99], v[76:79], v[224:227]
  s_add_u32 m0, s73, 82944
  s_add_u32 s66, s72, 8832
  buffer_load_dwordx4 v26, s[48:51], s66 offen lds
  v_mfma_f32_16x16x32_bf16 v[228:231], a[100:103], v[76:79], v[228:231]
  s_add_u32 m0, s73, 83968
  s_add_u32 s66, s72, 17024
  buffer_load_dwordx4 v26, s[48:51], s66 offen lds
  v_mfma_f32_16x16x32_bf16 v[232:235], a[104:107], v[76:79], v[232:235]
  s_add_u32 m0, s73, 84992
  s_add_u32 s66, s72, 25216
  buffer_load_dwordx4 v26, s[48:51], s66 offen lds
  v_mfma_f32_16x16x32_bf16 v[236:239], a[108:111], v[76:79], v[236:239]
  s_add_u32 s58, s58, 1
  v_exp_f32 v8, v56
  v_mfma_f32_16x16x32_bf16 v[240:243], a[112:115], v[76:79], v[240:243]
  v_exp_f32 v9, v57
  v_mfma_f32_16x16x32_bf16 v[244:247], a[116:119], v[76:79], v[244:247]
  v_exp_f32 v10, v58
  v_mfma_f32_16x16x32_bf16 v[248:251], a[120:123], v[76:79], v[248:251]
  v_exp_f32 v11, v59
  v_mfma_f32_16x16x32_bf16 v[252:255], a[124:127], v[76:79], v[252:255]
  v_cvt_pk_bf16_f32 v92, v8, v9
  v_cvt_pk_bf16_f32 v93, v10, v11
  v_or_b32 v5, v92, v93
  v_exp_f32 v12, v60
  v_exp_f32 v13, v61
  v_exp_f32 v14, v62
  v_exp_f32 v15, v63
  s_nop 0
  v_cvt_pk_bf16_f32 v94, v12, v13
  v_cvt_pk_bf16_f32 v95, v14, v15
  v_or3_b32 v5, v5, v94, v95
  v_and_b32 v5, s70, v5
  v_cmp_ne_u32 vcc, 0, v5
  v_add_u32 v4, 0x4000, v4
  v_and_b32 v4, 0x1ffff, v4
  s_cbranch_vccnz L_a_d7_t
L_a_d7_r:
  s_waitcnt vmcnt(24)
  s_barrier
  ds_read_b128 a[96:99], v4 offset:0
  ds_read_b128 a[100:103], v4 offset:1024
  ds_read_b128 a[104:107], v4 offset:2048
  ds_read_b128 a[108:111], v4 offset:3072
  ds_read_b128 a[112:115], v4 offset:4096
  ds_read_b128 a[116:119], v4 offset:5120
  ds_read_b128 a[120:123], v4 offset:6144
  ds_read_b128 a[124:127], v4 offset:7168
  s_add_u32 m0, s73, 98304
  s_add_u32 s66, s72, 768
  buffer_load_dwordx4 v26, s[48:51], s66 offen lds
  s_add_u32 m0, s73, 99328
  s_add_u32 s66, s72, 8960
  buffer_load_dwordx4 v26, s[48:51], s66 offen lds
  s_add_u32 m0, s73, 100352
  s_add_u32 s66, s72, 17152
  buffer_load_dwordx4 v26, s[48:51], s66 offen lds
  s_add_u32 m0, s73, 101376
  s_add_u32 s66, s72, 25344
  buffer_load_dwordx4 v26, s[48:51], s66 offen lds
  v_mfma_f32_16x16x32_bf16 a[140:143], v[16:19], v[92:95], a[140:143]
  s_waitcnt lgkmcnt(7)
  v_mfma_f32_16x16x32_bf16 v[224:227], a[96:99], v[92:95], v[224:227]
  s_waitcnt lgkmcnt(6)
  v_mfma_f32_16x16x32_bf16 v[228:231], a[100:103], v[92:95], v[228:231]
  s_waitcnt lgkmcnt(5)
  v_mfma_f32_16x16x32_bf16 v[232:235], a[104:107], v[92:95], v[232:235]
  s_waitcnt lgkmcnt(4)
  v_mfma_f32_16x16x32_bf16 v[236:239], a[108:111], v[92:95], v[236:239]
  s_waitcnt lgkmcnt(3)
  v_mfma_f32_16x16x32_bf16 v[240:243], a[112:115], v[92:95], v[240:243]
  s_waitcnt lgkmcnt(2)
  v_mfma_f32_16x16x32_bf16 v[244:247], a[116:119], v[92:95], v[244:247]
  s_waitcnt lgkmcnt(1)
  v_mfma_f32_16x16x32_bf16 v[248:251], a[120:123], v[92:95], v[248:251]
  s_waitcnt lgkmcnt(0)
  v_mfma_f32_16x16x32_bf16 v[252:255], a[124:127], v[92:95], v[252:255]
  s_barrier
  s_add_u32 m0, s73, 114688
  s_add_u32 s66, s72, 896
  buffer_load_dwordx4 v26, s[48:51], s66 offen lds
  s_add_u32 m0, s73, 115712
  s_add_u32 s66, s72, 9088
  buffer_load_dwordx4 v26, s[48:51], s66 offen lds
  s_add_u32 m0, s73, 116736
  s_add_u32 s66, s72, 17280
  buffer_load_dwordx4 v26, s[48:51], s66 offen lds
  s_add_u32 m0, s73, 117760
  s_add_u32 s66, s72, 25472
  buffer_load_dwordx4 v26, s[48:51], s66 offen lds
  v_accvgpr_read_b32 v6, a128
  v_rcp_f32 v6, v6
  s_nop 0
  v_mul_f32 v20, v20, v6
  v_accvgpr_read_b32 v6, a132
  v_rcp_f32 v6, v6
  s_nop 0
  v_mul_f32 v21, v21, v6
  v_accvgpr_read_b32 v6, a136
  v_rcp_f32 v6, v6
  s_nop 0
  v_mul_f32 v22, v22, v6
  v_accvgpr_read_b32 v6, a140
  v_rcp_f32 v6, v6
  s_nop 0
  v_mul_f32 v23, v23, v6
  v_mul_f32 v128, v128, v20
  v_mul_f32 v129, v129, v20
  v_mul_f32 v130, v130, v20
  v_mul_f32 v131, v131, v20
  v_mul_f32 v132, v132, v20
  v_mul_f32 v133, v133, v20
  v_mul_f32 v134, v134, v20
  v_mul_f32 v135, v135, v20
  v_cvt_pk_bf16_f32 v32, v128, v129
  v_cvt_pk_bf16_f32 v33, v130, v131
  v_cvt_pk_bf16_f32 v34, v132, v133
  v_cvt_pk_bf16_f32 v35, v134, v135
  v_mul_f32 v136, v136, v20
  v_mul_f32 v137, v137, v20
  v_mul_f32 v138, v138, v20
  v_mul_f32 v139, v139, v20
  v_mul_f32 v140, v140, v20
  v_mul_f32 v141, v141, v20
  v_mul_f32 v142, v142, v20
  v_mul_f32 v143, v143, v20
  v_cvt_pk_bf16_f32 v36, v136, v137
  v_cvt_pk_bf16_f32 v37, v138, v139
  v_cvt_pk_bf16_f32 v38, v140, v141
  v_cvt_pk_bf16_f32 v39, v142, v143
  v_mul_f32 v144, v144, v20
  v_mul_f32 v145, v145, v20
  v_mul_f32 v146, v146, v20
  v_mul_f32 v147, v147, v20
  v_mul_f32 v148, v148, v20
  v_mul_f32 v149, v149, v20
  v_mul_f32 v150, v150, v20
  v_mul_f32 v151, v151, v20
  v_cvt_pk_bf16_f32 v40, v144, v145
  v_cvt_pk_bf16_f32 v41, v146, v147
  v_cvt_pk_bf16_f32 v42, v148, v149
  v_cvt_pk_bf16_f32 v43, v150, v151
  v_mul_f32 v152, v152, v20
  v_mul_f32 v153, v153, v20
  v_mul_f32 v154, v154, v20
  v_mul_f32 v155, v155, v20
  v_mul_f32 v156, v156, v20
  v_mul_f32 v157, v157, v20
  v_mul_f32 v158, v158, v20
  v_mul_f32 v159, v159, v20
  v_cvt_pk_bf16_f32 v44, v152, v153
  v_cvt_pk_bf16_f32 v45, v154, v155
  v_cvt_pk_bf16_f32 v46, v156, v157
  v_cvt_pk_bf16_f32 v47, v158, v159
  v_mul_f32 v160, v160, v21
  v_mul_f32 v161, v161, v21
  v_mul_f32 v162, v162, v21
  v_mul_f32 v163, v163, v21
  v_mul_f32 v164, v164, v21
  v_mul_f32 v165, v165, v21
  v_mul_f32 v166, v166, v21
  v_mul_f32 v167, v167, v21
  v_cvt_pk_bf16_f32 v48, v160, v161
  v_cvt_pk_bf16_f32 v49, v162, v163
  v_cvt_pk_bf16_f32 v50, v164, v165
  v_cvt_pk_bf16_f32 v51, v166, v167
  v_mul_f32 v168, v168, v21
  v_mul_f32 v169, v169, v21
  v_mul_f32 v170, v170, v21
  v_mul_f32 v171, v171, v21
  v_mul_f32 v172, v172, v21
  v_mul_f32 v173, v173, v21
  v_mul_f32 v174, v174, v21
  v_mul_f32 v175, v175, v21
  v_cvt_pk_bf16_f32 v52, v168, v169
  v_cvt_pk_bf16_f32 v53, v170, v171
  v_cvt_pk_bf16_f32 v54, v172, v173
  v_cvt_pk_bf16_f32 v55, v174, v175
  v_mul_f32 v176, v176, v21
  v_mul_f32 v177, v177, v21
  v_mul_f32 v178, v178, v21
  v_mul_f32 v179, v179, v21
  v_mul_f32 v180, v180, v21
  v_mul_f32 v181, v181, v21
  v_mul_f32 v182, v182, v21
  v_mul_f32 v183, v183, v21
  v_cvt_pk_bf16_f32 v56, v176, v177
  v_cvt_pk_bf16_f32 v57, v178, v179
  v_cvt_pk_bf16_f32 v58, v180, v181
  v_cvt_pk_bf16_f32 v59, v182, v183
  v_mul_f32 v184, v184, v21
  v_mul_f32 v185, v185, v21
  v_mul_f32 v186, v186, v21
  v_mul_f32 v187, v187, v21
  v_mul_f32 v188, v188, v21
  v_mul_f32 v189, v189, v21
  v_mul_f32 v190, v190, v21
  v_mul_f32 v191, v191, v21
  v_cvt_pk_bf16_f32 v60, v184, v185
  v_cvt_pk_bf16_f32 v61, v186, v187
  v_cvt_pk_bf16_f32 v62, v188, v189
  v_cvt_pk_bf16_f32 v63, v190, v191
  v_mul_f32 v192, v192, v22
  v_mul_f32 v193, v193, v22
  v_mul_f32 v194, v194, v22
  v_mul_f32 v195, v195, v22
  v_mul_f32 v196, v196, v22
  v_mul_f32 v197, v197, v22
  v_mul_f32 v198, v198, v22
  v_mul_f32 v199, v199, v22
  v_cvt_pk_bf16_f32 v64, v192, v193
  v_cvt_pk_bf16_f32 v65, v194, v195
  v_cvt_pk_bf16_f32 v66, v196, v197
  v_cvt_pk_bf16_f32 v67, v198, v199
  v_mul_f32 v200, v200, v22
  v_mul_f32 v201, v201, v22
  v_mul_f32 v202, v202, v22
  v_mul_f32 v203, v203, v22
  v_mul_f32 v204, v204, v22
  v_mul_f32 v205, v205, v22
  v_mul_f32 v206, v206, v22
  v_mul_f32 v207, v207, v22
  v_cvt_pk_bf16_f32 v68, v200, v201
  v_cvt_pk_bf16_f32 v69, v202, v203
  v_cvt_pk_bf16_f32 v70, v204, v205
  v_cvt_pk_bf16_f32 v71, v206, v207
  v_mul_f32 v208, v208, v22
  v_mul_f32 v209, v209, v22
  v_mul_f32 v210, v210, v22
  v_mul_f32 v211, v211, v22
  v_mul_f32 v212, v212, v22
  v_mul_f32 v213, v213, v22
  v_mul_f32 v214, v214, v22
  v_mul_f32 v215, v215, v22
  v_cvt_pk_bf16_f32 v72, v208, v209
  v_cvt_pk_bf16_f32 v73, v210, v211
  v_cvt_pk_bf16_f32 v74, v212, v213
  v_cvt_pk_bf16_f32 v75, v214, v215
  v_mul_f32 v216, v216, v22
  v_mul_f32 v217, v217, v22
  v_mul_f32 v218, v218, v22
  v_mul_f32 v219, v219, v22
  v_mul_f32 v220, v220, v22
  v_mul_f32 v221, v221, v22
  v_mul_f32 v222, v222, v22
  v_mul_f32 v223, v223, v22
  v_cvt_pk_bf16_f32 v76, v216, v217
  v_cvt_pk_bf16_f32 v77, v218, v219
  v_cvt_pk_bf16_f32 v78, v220, v221
  v_cvt_pk_bf16_f32 v79, v222, v223
  v_mul_f32 v224, v224, v23
  v_mul_f32 v225, v225, v23
  v_mul_f32 v226, v226, v23
  v_mul_f32 v227, v227, v23
  v_mul_f32 v228, v228, v23
  v_mul_f32 v229, v229, v23
  v_mul_f32 v230, v230, v23
  v_mul_f32 v231, v231, v23
  v_cvt_pk_bf16_f32 v80, v224, v225
  v_cvt_pk_bf16_f32 v81, v226, v227
  v_cvt_pk_bf16_f32 v82, v228, v229
  v_cvt_pk_bf16_f32 v83, v230, v231
  v_mul_f32 v232, v232, v23
  v_mul_f32 v233, v233, v23
  v_mul_f32 v234, v234, v23
  v_mul_f32 v235, v235, v23
  v_mul_f32 v236, v236, v23
  v_mul_f32 v237, v237, v23
  v_mul_f32 v238, v238, v23
  v_mul_f32 v239, v239, v23
  v_cvt_pk_bf16_f32 v84, v232, v233
  v_cvt_pk_bf16_f32 v85, v234, v235
  v_cvt_pk_bf16_f32 v86, v236, v237
  v_cvt_pk_bf16_f32 v87, v238, v239
  v_mul_f32 v240, v240, v23
  v_mul_f32 v241, v241, v23
  v_mul_f32 v242, v242, v23
  v_mul_f32 v243, v243, v23
  v_mul_f32 v244, v244, v23
  v_mul_f32 v245, v245, v23
  v_mul_f32 v246, v246, v23
  v_mul_f32 v247, v247, v23
  v_cvt_pk_bf16_f32 v88, v240, v241
  v_cvt_pk_bf16_f32 v89, v242, v243
  v_cvt_pk_bf16_f32 v90, v244, v245
  v_cvt_pk_bf16_f32 v91, v246, v247
  v_mul_f32 v248, v248, v23
  v_mul_f32 v249, v249, v23
  v_mul_f32 v250, v250, v23
  v_mul_f32 v251, v251, v23
  v_mul_f32 v252, v252, v23
  v_mul_f32 v253, v253, v23
  v_mul_f32 v254, v254, v23
  v_mul_f32 v255, v255, v23
  v_cvt_pk_bf16_f32 v92, v248, v249
  v_cvt_pk_bf16_f32 v93, v250, v251
  v_cvt_pk_bf16_f32 v94, v252, v253
  v_cvt_pk_bf16_f32 v95, v254, v255
  v_lshrrev_b32 v6, 2, v0
  v_lshlrev_b32 v8, 7, v6
  v_bfe_u32 v6, v0, 3, 2
  v_lshl_add_u32 v8, v6, 5, v8
  v_and_b32 v6, 3, v0
  v_lshl_add_u32 v8, v6, 3, v8
  v_xor_b32 v9, 32, v8
  v_xor_b32 v10, 64, v8
  v_xor_b32 v11, 96, v8
  v_add_u32 v12, 0x10000, v8
  v_add_u32 v13, 0x10000, v9
  v_add_u32 v14, 0x10000, v10
  v_add_u32 v15, 0x10000, v11
  s_waitcnt vmcnt(4)
  s_barrier
  ds_read_b64_tr_b16 a[64:65], v8 offset:0
  ds_read_b64_tr_b16 a[66:67], v8 offset:2048
  ds_read_b64_tr_b16 a[68:69], v8 offset:4096
  ds_read_b64_tr_b16 a[70:71], v8 offset:6144
  ds_read_b64_tr_b16 a[72:73], v8 offset:8192
  ds_read_b64_tr_b16 a[74:75], v8 offset:10240
  ds_read_b64_tr_b16 a[76:77], v8 offset:12288
  ds_read_b64_tr_b16 a[78:79], v8 offset:14336
  ds_read_b64_tr_b16 a[80:81], v9 offset:0
  ds_read_b64_tr_b16 a[82:83], v9 offset:2048
  ds_read_b64_tr_b16 a[84:85], v9 offset:4096
  ds_read_b64_tr_b16 a[86:87], v9 offset:6144
  ds_read_b64_tr_b16 a[88:89], v9 offset:8192
  ds_read_b64_tr_b16 a[90:91], v9 offset:10240
  ds_read_b64_tr_b16 a[92:93], v9 offset:12288
  ds_read_b64_tr_b16 a[94:95], v9 offset:14336
  s_waitcnt lgkmcnt(8)
  v_mfma_f32_16x16x32_bf16 v[128:131], a[64:67], v[32:35], 0
  ds_read_b64_tr_b16 a[96:97], v10 offset:0
  v_mfma_f32_16x16x32_bf16 v[128:131], a[68:71], v[36:39], v[128:131]
  v_mfma_f32_16x16x32_bf16 v[128:131], a[72:75], v[40:43], v[128:131]
  ds_read_b64_tr_b16 a[98:99], v10 offset:2048
  v_mfma_f32_16x16x32_bf16 v[128:131], a[76:79], v[44:47], v[128:131]
  v_mfma_f32_16x16x32_bf16 v[136:139], a[64:67], v[48:51], 0
  ds_read_b64_tr_b16 a[100:101], v10 offset:4096
  v_mfma_f32_16x16x32_bf16 v[136:139], a[68:71], v[52:55], v[136:139]
  v_mfma_f32_16x16x32_bf16 v[136:139], a[72:75], v[56:59], v[136:139]
  ds_read_b64_tr_b16 a[102:103], v10 offset:6144
  v_mfma_f32_16x16x32_bf16 v[136:139], a[76:79], v[60:63], v[136:139]
  v_mfma_f32_16x16x32_bf16 v[144:147], a[64:67], v[64:67], 0
  ds_read_b64_tr_b16 a[104:105], v10 offset:8192
  v_mfma_f32_16x16x32_bf16 v[144:147], a[68:71], v[68:71], v[144:147]
  v_mfma_f32_16x16x32_bf16 v[144:147], a[72:75], v[72:75], v[144:147]
  ds_read_b64_tr_b16 a[106:107], v10 offset:10240
  v_mfma_f32_16x16x32_bf16 v[144:147], a[76:79], v[76:79], v[144:147]
  v_mfma_f32_16x16x32_bf16 v[152:155], a[64:67], v[80:83], 0
  ds_read_b64_tr_b16 a[108:109], v10 offset:12288
  v_mfma_f32_16x16x32_bf16 v[152:155], a[68:71], v[84:87], v[152:155]
  v_mfma_f32_16x16x32_bf16 v[152:155], a[72:75], v[88:91], v[152:155]
  ds_read_b64_tr_b16 a[110:111], v10 offset:14336
  v_mfma_f32_16x16x32_bf16 v[152:155], a[76:79], v[92:95], v[152:155]
  s_waitcnt lgkmcnt(8)
  v_mfma_f32_16x16x32_bf16 v[132:135], a[80:83], v[32:35], 0
  ds_read_b64_tr_b16 a[112:113], v11 offset:0
  v_mfma_f32_16x16x32_bf16 v[132:135], a[84:87], v[36:39], v[132:135]
  v_mfma_f32_16x16x32_bf16 v[132:135], a[88:91], v[40:43], v[132:135]
  ds_read_b64_tr_b16 a[114:115], v11 offset:2048
  v_mfma_f32_16x16x32_bf16 v[132:135], a[92:95], v[44:47], v[132:135]
  v_mfma_f32_16x16x32_bf16 v[140:143], a[80:83], v[48:51], 0
  ds_read_b64_tr_b16 a[116:117], v11 offset:4096
  v_mfma_f32_16x16x32_bf16 v[140:143], a[84:87], v[52:55], v[140:143]
  v_mfma_f32_16x16x32_bf16 v[140:143], a[88:91], v[56:59], v[140:143]
  ds_read_b64_tr_b16 a[118:119], v11 offset:6144
  v_mfma_f32_16x16x32_bf16 v[140:143], a[92:95], v[60:63], v[140:143]
  v_mfma_f32_16x16x32_bf16 v[148:151], a[80:83], v[64:67], 0
  ds_read_b64_tr_b16 a[120:121], v11 offset:8192
  v_mfma_f32_16x16x32_bf16 v[148:151], a[84:87], v[68:71], v[148:151]
  v_mfma_f32_16x16x32_bf16 v[148:151], a[88:91], v[72:75], v[148:151]
  ds_read_b64_tr_b16 a[122:123], v11 offset:10240
  v_mfma_f32_16x16x32_bf16 v[148:151], a[92:95], v[76:79], v[148:151]
  v_mfma_f32_16x16x32_bf16 v[156:159], a[80:83], v[80:83], 0
  ds_read_b64_tr_b16 a[124:125], v11 offset:12288
  v_mfma_f32_16x16x32_bf16 v[156:159], a[84:87], v[84:87], v[156:159]
  v_mfma_f32_16x16x32_bf16 v[156:159], a[88:91], v[88:91], v[156:159]
  ds_read_b64_tr_b16 a[126:127], v11 offset:14336
  v_mfma_f32_16x16x32_bf16 v[156:159], a[92:95], v[92:95], v[156:159]
  s_waitcnt lgkmcnt(8)
  v_mfma_f32_16x16x32_bf16 v[160:163], a[96:99], v[32:35], 0
  ds_read_b64_tr_b16 a[64:65], v8 offset:16384
  v_mfma_f32_16x16x32_bf16 v[160:163], a[100:103], v[36:39], v[160:163]
  s_nop 1
  v_mfma_f32_16x16x32_bf16 v[160:163], a[104:107], v[40:43], v[160:163]
  ds_read_b64_tr_b16 a[66:67], v8 offset:18432
  v_mfma_f32_16x16x32_bf16 v[160:163], a[108:111], v[44:47], v[160:163]
  v_cvt_pk_bf16_f32 v96, v128, v129
  v_cvt_pk_bf16_f32 v97, v130, v131
  v_mfma_f32_16x16x32_bf16 v[168:171], a[96:99], v[48:51], 0
  ds_read_b64_tr_b16 a[68:69], v8 offset:20480
  v_mfma_f32_16x16x32_bf16 v[168:171], a[100:103], v[52:55], v[168:171]
  v_cvt_pk_bf16_f32 v98, v132, v133
  v_cvt_pk_bf16_f32 v99, v134, v135
  v_mfma_f32_16x16x32_bf16 v[168:171], a[104:107], v[56:59], v[168:171]
  ds_read_b64_tr_b16 a[70:71], v8 offset:22528
  v_mfma_f32_16x16x32_bf16 v[168:171], a[108:111], v[60:63], v[168:171]
  buffer_store_dwordx4 v[96:99], v2, s[40:43], s76 offen offset:0 sc1
  v_mfma_f32_16x16x32_bf16 v[176:179], a[96:99], v[64:67], 0
  ds_read_b64_tr_b16 a[72:73], v8 offset:24576
  v_mfma_f32_16x16x32_bf16 v[176:179], a[100:103], v[68:71], v[176:179]
  v_cvt_pk_bf16_f32 v100, v136, v137
  v_cvt_pk_bf16_f32 v101, v138, v139
  v_mfma_f32_16x16x32_bf16 v[176:179], a[104:107], v[72:75], v[176:179]
  ds_read_b64_tr_b16 a[74:75], v8 offset:26624
  v_mfma_f32_16x16x32_bf16 v[176:179], a[108:111], v[76:79], v[176:179]
  v_cvt_pk_bf16_f32 v102, v140, v141
  v_cvt_pk_bf16_f32 v103, v142, v143
  v_mfma_f32_16x16x32_bf16 v[184:187], a[96:99], v[80:83], 0
  ds_read_b64_tr_b16 a[76:77], v8 offset:28672
  v_mfma_f32_16x16x32_bf16 v[184:187], a[100:103], v[84:87], v[184:187]
  buffer_store_dwordx4 v[100:103], v2, s[40:43], s77 offen offset:0 sc1
  v_mfma_f32_16x16x32_bf16 v[184:187], a[104:107], v[88:91], v[184:187]
  ds_read_b64_tr_b16 a[78:79], v8 offset:30720
  v_mfma_f32_16x16x32_bf16 v[184:187], a[108:111], v[92:95], v[184:187]
  s_waitcnt lgkmcnt(8)
  v_cvt_pk_bf16_f32 v104, v144, v145
  v_cvt_pk_bf16_f32 v105, v146, v147
  v_mfma_f32_16x16x32_bf16 v[164:167], a[112:115], v[32:35], 0
  ds_read_b64_tr_b16 a[80:81], v9 offset:16384
  v_mfma_f32_16x16x32_bf16 v[164:167], a[116:119], v[36:39], v[164:167]
  v_cvt_pk_bf16_f32 v106, v148, v149
  v_cvt_pk_bf16_f32 v107, v150, v151
  v_mfma_f32_16x16x32_bf16 v[164:167], a[120:123], v[40:43], v[164:167]
  ds_read_b64_tr_b16 a[82:83], v9 offset:18432
  v_mfma_f32_16x16x32_bf16 v[164:167], a[124:127], v[44:47], v[164:167]
  buffer_store_dwordx4 v[104:107], v2, s[40:43], s78 offen offset:0 sc1
  v_mfma_f32_16x16x32_bf16 v[172:175], a[112:115], v[48:51], 0
  ds_read_b64_tr_b16 a[84:85], v9 offset:20480
  v_mfma_f32_16x16x32_bf16 v[172:175], a[116:119], v[52:55], v[172:175]
  v_cvt_pk_bf16_f32 v108, v152, v153
  v_cvt_pk_bf16_f32 v109, v154, v155
  v_mfma_f32_16x16x32_bf16 v[172:175], a[120:123], v[56:59], v[172:175]
  ds_read_b64_tr_b16 a[86:87], v9 offset:22528
  v_mfma_f32_16x16x32_bf16 v[172:175], a[124:127], v[60:63], v[172:175]
  v_cvt_pk_bf16_f32 v110, v156, v157
  v_cvt_pk_bf16_f32 v111, v158, v159
  v_mfma_f32_16x16x32_bf16 v[180:183], a[112:115], v[64:67], 0
  ds_read_b64_tr_b16 a[88:89], v9 offset:24576
  v_mfma_f32_16x16x32_bf16 v[180:183], a[116:119], v[68:71], v[180:183]
  buffer_store_dwordx4 v[108:111], v2, s[40:43], s79 offen offset:0 sc1
  v_mfma_f32_16x16x32_bf16 v[180:183], a[120:123], v[72:75], v[180:183]
  ds_read_b64_tr_b16 a[90:91], v9 offset:26624
  v_mfma_f32_16x16x32_bf16 v[180:183], a[124:127], v[76:79], v[180:183]
  v_mfma_f32_16x16x32_bf16 v[188:191], a[112:115], v[80:83], 0
  ds_read_b64_tr_b16 a[92:93], v9 offset:28672
  v_mfma_f32_16x16x32_bf16 v[188:191], a[116:119], v[84:87], v[188:191]
  v_mfma_f32_16x16x32_bf16 v[188:191], a[120:123], v[88:91], v[188:191]
  ds_read_b64_tr_b16 a[94:95], v9 offset:30720
  v_mfma_f32_16x16x32_bf16 v[188:191], a[124:127], v[92:95], v[188:191]
  s_waitcnt lgkmcnt(8)
  v_mfma_f32_16x16x32_bf16 v[128:131], a[64:67], v[32:35], 0
  ds_read_b64_tr_b16 a[96:97], v10 offset:16384
  v_mfma_f32_16x16x32_bf16 v[128:131], a[68:71], v[36:39], v[128:131]
  s_nop 1
  v_mfma_f32_16x16x32_bf16 v[128:131], a[72:75], v[40:43], v[128:131]
  ds_read_b64_tr_b16 a[98:99], v10 offset:18432
  v_mfma_f32_16x16x32_bf16 v[128:131], a[76:79], v[44:47], v[128:131]
  v_cvt_pk_bf16_f32 v112, v160, v161
  v_cvt_pk_bf16_f32 v113, v162, v163
  v_mfma_f32_16x16x32_bf16 v[136:139], a[64:67], v[48:51], 0
  ds_read_b64_tr_b16 a[100:101], v10 offset:20480
  v_mfma_f32_16x16x32_bf16 v[136:139], a[68:71], v[52:55], v[136:139]
  v_cvt_pk_bf16_f32 v114, v164, v165
  v_cvt_pk_bf16_f32 v115, v166, v167
  v_mfma_f32_16x16x32_bf16 v[136:139], a[72:75], v[56:59], v[136:139]
  ds_read_b64_tr_b16 a[102:103], v10 offset:22528
  v_mfma_f32_16x16x32_bf16 v[136:139], a[76:79], v[60:63], v[136:139]
  buffer_store_dwordx4 v[112:115], v2, s[40:43], s76 offen offset:1024 sc1
  v_mfma_f32_16x16x32_bf16 v[144:147], a[64:67], v[64:67], 0
  ds_read_b64_tr_b16 a[104:105], v10 offset:24576
  v_mfma_f32_16x16x32_bf16 v[144:147], a[68:71], v[68:71], v[144:147]
  v_cvt_pk_bf16_f32 v116, v168, v169
  v_cvt_pk_bf16_f32 v117, v170, v171
  v_mfma_f32_16x16x32_bf16 v[144:147], a[72:75], v[72:75], v[144:147]
  ds_read_b64_tr_b16 a[106:107], v10 offset:26624
  v_mfma_f32_16x16x32_bf16 v[144:147], a[76:79], v[76:79], v[144:147]
  v_cvt_pk_bf16_f32 v118, v172, v173
  v_cvt_pk_bf16_f32 v119, v174, v175
  v_mfma_f32_16x16x32_bf16 v[152:155], a[64:67], v[80:83], 0
  ds_read_b64_tr_b16 a[108:109], v10 offset:28672
  v_mfma_f32_16x16x32_bf16 v[152:155], a[68:71], v[84:87], v[152:155]
  buffer_store_dwordx4 v[116:119], v2, s[40:43], s77 offen offset:1024 sc1
  v_mfma_f32_16x16x32_bf16 v[152:155], a[72:75], v[88:91], v[152:155]
  ds_read_b64_tr_b16 a[110:111], v10 offset:30720
  v_mfma_f32_16x16x32_bf16 v[152:155], a[76:79], v[92:95], v[152:155]
  s_waitcnt lgkmcnt(8)
  v_cvt_pk_bf16_f32 v120, v176, v177
  v_cvt_pk_bf16_f32 v121, v178, v179
  v_mfma_f32_16x16x32_bf16 v[132:135], a[80:83], v[32:35], 0
  ds_read_b64_tr_b16 a[112:113], v11 offset:16384
  v_mfma_f32_16x16x32_bf16 v[132:135], a[84:87], v[36:39], v[132:135]
  v_cvt_pk_bf16_f32 v122, v180, v181
  v_cvt_pk_bf16_f32 v123, v182, v183
  v_mfma_f32_16x16x32_bf16 v[132:135], a[88:91], v[40:43], v[132:135]
  ds_read_b64_tr_b16 a[114:115], v11 offset:18432
  v_mfma_f32_16x16x32_bf16 v[132:135], a[92:95], v[44:47], v[132:135]
  buffer_store_dwordx4 v[120:123], v2, s[40:43], s78 offen offset:1024 sc1
  v_mfma_f32_16x16x32_bf16 v[140:143], a[80:83], v[48:51], 0
  ds_read_b64_tr_b16 a[116:117], v11 offset:20480
  v_mfma_f32_16x16x32_bf16 v[140:143], a[84:87], v[52:55], v[140:143]
  v_cvt_pk_bf16_f32 v124, v184, v185
  v_cvt_pk_bf16_f32 v125, v186, v187
  v_mfma_f32_16x16x32_bf16 v[140:143], a[88:91], v[56:59], v[140:143]
  ds_read_b64_tr_b16 a[118:119], v11 offset:22528
  v_mfma_f32_16x16x32_bf16 v[140:143], a[92:95], v[60:63], v[140:143]
  v_cvt_pk_bf16_f32 v126, v188, v189
  v_cvt_pk_bf16_f32 v127, v190, v191
  v_mfma_f32_16x16x32_bf16 v[148:151], a[80:83], v[64:67], 0
  ds_read_b64_tr_b16 a[120:121], v11 offset:24576
  v_mfma_f32_16x16x32_bf16 v[148:151], a[84:87], v[68:71], v[148:151]
  buffer_store_dwordx4 v[124:127], v2, s[40:43], s79 offen offset:1024 sc1
  v_mfma_f32_16x16x32_bf16 v[148:151], a[88:91], v[72:75], v[148:151]
  ds_read_b64_tr_b16 a[122:123], v11 offset:26624
  v_mfma_f32_16x16x32_bf16 v[148:151], a[92:95], v[76:79], v[148:151]
  v_mfma_f32_16x16x32_bf16 v[156:159], a[80:83], v[80:83], 0
  ds_read_b64_tr_b16 a[124:125], v11 offset:28672
  v_mfma_f32_16x16x32_bf16 v[156:159], a[84:87], v[84:87], v[156:159]
  v_mfma_f32_16x16x32_bf16 v[156:159], a[88:91], v[88:91], v[156:159]
  ds_read_b64_tr_b16 a[126:127], v11 offset:30720
  v_mfma_f32_16x16x32_bf16 v[156:159], a[92:95], v[92:95], v[156:159]
  s_waitcnt lgkmcnt(8)
  v_mfma_f32_16x16x32_bf16 v[160:163], a[96:99], v[32:35], 0
  ds_read_b64_tr_b16 a[64:65], v8 offset:32768
  v_mfma_f32_16x16x32_bf16 v[160:163], a[100:103], v[36:39], v[160:163]
  s_nop 1
  v_mfma_f32_16x16x32_bf16 v[160:163], a[104:107], v[40:43], v[160:163]
  ds_read_b64_tr_b16 a[66:67], v8 offset:34816
  v_mfma_f32_16x16x32_bf16 v[160:163], a[108:111], v[44:47], v[160:163]
  v_cvt_pk_bf16_f32 v96, v128, v129
  v_cvt_pk_bf16_f32 v97, v130, v131
  v_mfma_f32_16x16x32_bf16 v[168:171], a[96:99], v[48:51], 0
  ds_read_b64_tr_b16 a[68:69], v8 offset:36864
  v_mfma_f32_16x16x32_bf16 v[168:171], a[100:103], v[52:55], v[168:171]
  v_cvt_pk_bf16_f32 v98, v132, v133
  v_cvt_pk_bf16_f32 v99, v134, v135
  v_mfma_f32_16x16x32_bf16 v[168:171], a[104:107], v[56:59], v[168:171]
  ds_read_b64_tr_b16 a[70:71], v8 offset:38912
  v_mfma_f32_16x16x32_bf16 v[168:171], a[108:111], v[60:63], v[168:171]
  buffer_store_dwordx4 v[96:99], v2, s[40:43], s76 offen offset:2048 sc1
  v_mfma_f32_16x16x32_bf16 v[176:179], a[96:99], v[64:67], 0
  ds_read_b64_tr_b16 a[72:73], v8 offset:40960
  v_mfma_f32_16x16x32_bf16 v[176:179], a[100:103], v[68:71], v[176:179]
  v_cvt_pk_bf16_f32 v100, v136, v137
  v_cvt_pk_bf16_f32 v101, v138, v139
  v_mfma_f32_16x16x32_bf16 v[176:179], a[104:107], v[72:75], v[176:179]
  ds_read_b64_tr_b16 a[74:75], v8 offset:43008
  v_mfma_f32_16x16x32_bf16 v[176:179], a[108:111], v[76:79], v[176:179]
  v_cvt_pk_bf16_f32 v102, v140, v141
  v_cvt_pk_bf16_f32 v103, v142, v143
  v_mfma_f32_16x16x32_bf16 v[184:187], a[96:99], v[80:83], 0
  ds_read_b64_tr_b16 a[76:77], v8 offset:45056
  v_mfma_f32_16x16x32_bf16 v[184:187], a[100:103], v[84:87], v[184:187]
  buffer_store_dwordx4 v[100:103], v2, s[40:43], s77 offen offset:2048 sc1
  v_mfma_f32_16x16x32_bf16 v[184:187], a[104:107], v[88:91], v[184:187]
  ds_read_b64_tr_b16 a[78:79], v8 offset:47104
  v_mfma_f32_16x16x32_bf16 v[184:187], a[108:111], v[92:95], v[184:187]
  s_waitcnt lgkmcnt(8)
  v_cvt_pk_bf16_f32 v104, v144, v145
  v_cvt_pk_bf16_f32 v105, v146, v147
  v_mfma_f32_16x16x32_bf16 v[164:167], a[112:115], v[32:35], 0
  ds_read_b64_tr_b16 a[80:81], v9 offset:32768
  v_mfma_f32_16x16x32_bf16 v[164:167], a[116:119], v[36:39], v[164:167]
  v_cvt_pk_bf16_f32 v106, v148, v149
  v_cvt_pk_bf16_f32 v107, v150, v151
  v_mfma_f32_16x16x32_bf16 v[164:167], a[120:123], v[40:43], v[164:167]
  ds_read_b64_tr_b16 a[82:83], v9 offset:34816
  v_mfma_f32_16x16x32_bf16 v[164:167], a[124:127], v[44:47], v[164:167]
  buffer_store_dwordx4 v[104:107], v2, s[40:43], s78 offen offset:2048 sc1
  v_mfma_f32_16x16x32_bf16 v[172:175], a[112:115], v[48:51], 0
  ds_read_b64_tr_b16 a[84:85], v9 offset:36864
  v_mfma_f32_16x16x32_bf16 v[172:175], a[116:119], v[52:55], v[172:175]
  v_cvt_pk_bf16_f32 v108, v152, v153
  v_cvt_pk_bf16_f32 v109, v154, v155
  v_mfma_f32_16x16x32_bf16 v[172:175], a[120:123], v[56:59], v[172:175]
  ds_read_b64_tr_b16 a[86:87], v9 offset:38912
  v_mfma_f32_16x16x32_bf16 v[172:175], a[124:127], v[60:63], v[172:175]
  v_cvt_pk_bf16_f32 v110, v156, v157
  v_cvt_pk_bf16_f32 v111, v158, v159
  v_mfma_f32_16x16x32_bf16 v[180:183], a[112:115], v[64:67], 0
  ds_read_b64_tr_b16 a[88:89], v9 offset:40960
  v_mfma_f32_16x16x32_bf16 v[180:183], a[116:119], v[68:71], v[180:183]
  buffer_store_dwordx4 v[108:111], v2, s[40:43], s79 offen offset:2048 sc1
  v_mfma_f32_16x16x32_bf16 v[180:183], a[120:123], v[72:75], v[180:183]
  ds_read_b64_tr_b16 a[90:91], v9 offset:43008
  v_mfma_f32_16x16x32_bf16 v[180:183], a[124:127], v[76:79], v[180:183]
  v_mfma_f32_16x16x32_bf16 v[188:191], a[112:115], v[80:83], 0
  ds_read_b64_tr_b16 a[92:93], v9 offset:45056
  v_mfma_f32_16x16x32_bf16 v[188:191], a[116:119], v[84:87], v[188:191]
  v_mfma_f32_16x16x32_bf16 v[188:191], a[120:123], v[88:91], v[188:191]
  ds_read_b64_tr_b16 a[94:95], v9 offset:47104
  v_mfma_f32_16x16x32_bf16 v[188:191], a[124:127], v[92:95], v[188:191]
  s_waitcnt lgkmcnt(8)
  v_mfma_f32_16x16x32_bf16 v[128:131], a[64:67], v[32:35], 0
  ds_read_b64_tr_b16 a[96:97], v10 offset:32768
  v_mfma_f32_16x16x32_bf16 v[128:131], a[68:71], v[36:39], v[128:131]
  s_nop 1
  v_mfma_f32_16x16x32_bf16 v[128:131], a[72:75], v[40:43], v[128:131]
  ds_read_b64_tr_b16 a[98:99], v10 offset:34816
  v_mfma_f32_16x16x32_bf16 v[128:131], a[76:79], v[44:47], v[128:131]
  v_cvt_pk_bf16_f32 v112, v160, v161
  v_cvt_pk_bf16_f32 v113, v162, v163
  v_mfma_f32_16x16x32_bf16 v[136:139], a[64:67], v[48:51], 0
  ds_read_b64_tr_b16 a[100:101], v10 offset:36864
  v_mfma_f32_16x16x32_bf16 v[136:139], a[68:71], v[52:55], v[136:139]
  v_cvt_pk_bf16_f32 v114, v164, v165
  v_cvt_pk_bf16_f32 v115, v166, v167
  v_mfma_f32_16x16x32_bf16 v[136:139], a[72:75], v[56:59], v[136:139]
  ds_read_b64_tr_b16 a[102:103], v10 offset:38912
  v_mfma_f32_16x16x32_bf16 v[136:139], a[76:79], v[60:63], v[136:139]
  buffer_store_dwordx4 v[112:115], v2, s[40:43], s76 offen offset:3072 sc1
  v_mfma_f32_16x16x32_bf16 v[144:147], a[64:67], v[64:67], 0
  ds_read_b64_tr_b16 a[104:105], v10 offset:40960
  v_mfma_f32_16x16x32_bf16 v[144:147], a[68:71], v[68:71], v[144:147]
  v_cvt_pk_bf16_f32 v116, v168, v169
  v_cvt_pk_bf16_f32 v117, v170, v171
  v_mfma_f32_16x16x32_bf16 v[144:147], a[72:75], v[72:75], v[144:147]
  ds_read_b64_tr_b16 a[106:107], v10 offset:43008
  v_mfma_f32_16x16x32_bf16 v[144:147], a[76:79], v[76:79], v[144:147]
  v_cvt_pk_bf16_f32 v118, v172, v173
  v_cvt_pk_bf16_f32 v119, v174, v175
  v_mfma_f32_16x16x32_bf16 v[152:155], a[64:67], v[80:83], 0
  ds_read_b64_tr_b16 a[108:109], v10 offset:45056
  v_mfma_f32_16x16x32_bf16 v[152:155], a[68:71], v[84:87], v[152:155]
  buffer_store_dwordx4 v[116:119], v2, s[40:43], s77 offen offset:3072 sc1
  v_mfma_f32_16x16x32_bf16 v[152:155], a[72:75], v[88:91], v[152:155]
  ds_read_b64_tr_b16 a[110:111], v10 offset:47104
  v_mfma_f32_16x16x32_bf16 v[152:155], a[76:79], v[92:95], v[152:155]
  s_waitcnt lgkmcnt(8)
  v_cvt_pk_bf16_f32 v120, v176, v177
  v_cvt_pk_bf16_f32 v121, v178, v179
  v_mfma_f32_16x16x32_bf16 v[132:135], a[80:83], v[32:35], 0
  ds_read_b64_tr_b16 a[112:113], v11 offset:32768
  v_mfma_f32_16x16x32_bf16 v[132:135], a[84:87], v[36:39], v[132:135]
  v_cvt_pk_bf16_f32 v122, v180, v181
  v_cvt_pk_bf16_f32 v123, v182, v183
  v_mfma_f32_16x16x32_bf16 v[132:135], a[88:91], v[40:43], v[132:135]
  ds_read_b64_tr_b16 a[114:115], v11 offset:34816
  v_mfma_f32_16x16x32_bf16 v[132:135], a[92:95], v[44:47], v[132:135]
  buffer_store_dwordx4 v[120:123], v2, s[40:43], s78 offen offset:3072 sc1
  v_mfma_f32_16x16x32_bf16 v[140:143], a[80:83], v[48:51], 0
  ds_read_b64_tr_b16 a[116:117], v11 offset:36864
  v_mfma_f32_16x16x32_bf16 v[140:143], a[84:87], v[52:55], v[140:143]
  v_cvt_pk_bf16_f32 v124, v184, v185
  v_cvt_pk_bf16_f32 v125, v186, v187
  v_mfma_f32_16x16x32_bf16 v[140:143], a[88:91], v[56:59], v[140:143]
  ds_read_b64_tr_b16 a[118:119], v11 offset:38912
  v_mfma_f32_16x16x32_bf16 v[140:143], a[92:95], v[60:63], v[140:143]
  v_cvt_pk_bf16_f32 v126, v188, v189
  v_cvt_pk_bf16_f32 v127, v190, v191
  v_mfma_f32_16x16x32_bf16 v[148:151], a[80:83], v[64:67], 0
  ds_read_b64_tr_b16 a[120:121], v11 offset:40960
  v_mfma_f32_16x16x32_bf16 v[148:151], a[84:87], v[68:71], v[148:151]
  buffer_store_dwordx4 v[124:127], v2, s[40:43], s79 offen offset:3072 sc1
  v_mfma_f32_16x16x32_bf16 v[148:151], a[88:91], v[72:75], v[148:151]
  ds_read_b64_tr_b16 a[122:123], v11 offset:43008
  v_mfma_f32_16x16x32_bf16 v[148:151], a[92:95], v[76:79], v[148:151]
  v_mfma_f32_16x16x32_bf16 v[156:159], a[80:83], v[80:83], 0
  ds_read_b64_tr_b16 a[124:125], v11 offset:45056
  v_mfma_f32_16x16x32_bf16 v[156:159], a[84:87], v[84:87], v[156:159]
  v_mfma_f32_16x16x32_bf16 v[156:159], a[88:91], v[88:91], v[156:159]
  ds_read_b64_tr_b16 a[126:127], v11 offset:47104
  v_mfma_f32_16x16x32_bf16 v[156:159], a[92:95], v[92:95], v[156:159]
  s_waitcnt lgkmcnt(8)
  v_mfma_f32_16x16x32_bf16 v[160:163], a[96:99], v[32:35], 0
  ds_read_b64_tr_b16 a[64:65], v8 offset:49152
  v_mfma_f32_16x16x32_bf16 v[160:163], a[100:103], v[36:39], v[160:163]
  s_add_u32 s76, s76, 0x1000
  s_add_u32 s77, s77, 0x1000
  s_add_u32 s78, s78, 0x1000
  s_add_u32 s79, s79, 0x1000
  v_mfma_f32_16x16x32_bf16 v[160:163], a[104:107], v[40:43], v[160:163]
  ds_read_b64_tr_b16 a[66:67], v8 offset:51200
  v_mfma_f32_16x16x32_bf16 v[160:163], a[108:111], v[44:47], v[160:163]
  v_cvt_pk_bf16_f32 v96, v128, v129
  v_cvt_pk_bf16_f32 v97, v130, v131
  v_mfma_f32_16x16x32_bf16 v[168:171], a[96:99], v[48:51], 0
  ds_read_b64_tr_b16 a[68:69], v8 offset:53248
  v_mfma_f32_16x16x32_bf16 v[168:171], a[100:103], v[52:55], v[168:171]
  v_cvt_pk_bf16_f32 v98, v132, v133
  v_cvt_pk_bf16_f32 v99, v134, v135
  v_mfma_f32_16x16x32_bf16 v[168:171], a[104:107], v[56:59], v[168:171]
  ds_read_b64_tr_b16 a[70:71], v8 offset:55296
  v_mfma_f32_16x16x32_bf16 v[168:171], a[108:111], v[60:63], v[168:171]
  buffer_store_dwordx4 v[96:99], v2, s[40:43], s76 offen offset:0 sc1
  v_mfma_f32_16x16x32_bf16 v[176:179], a[96:99], v[64:67], 0
  ds_read_b64_tr_b16 a[72:73], v8 offset:57344
  v_mfma_f32_16x16x32_bf16 v[176:179], a[100:103], v[68:71], v[176:179]
  v_cvt_pk_bf16_f32 v100, v136, v137
  v_cvt_pk_bf16_f32 v101, v138, v139
  v_mfma_f32_16x16x32_bf16 v[176:179], a[104:107], v[72:75], v[176:179]
  ds_read_b64_tr_b16 a[74:75], v8 offset:59392
  v_mfma_f32_16x16x32_bf16 v[176:179], a[108:111], v[76:79], v[176:179]
  v_cvt_pk_bf16_f32 v102, v140, v141
  v_cvt_pk_bf16_f32 v103, v142, v143
  v_mfma_f32_16x16x32_bf16 v[184:187], a[96:99], v[80:83], 0
  ds_read_b64_tr_b16 a[76:77], v8 offset:61440
  v_mfma_f32_16x16x32_bf16 v[184:187], a[100:103], v[84:87], v[184:187]
  buffer_store_dwordx4 v[100:103], v2, s[40:43], s77 offen offset:0 sc1
  v_mfma_f32_16x16x32_bf16 v[184:187], a[104:107], v[88:91], v[184:187]
  ds_read_b64_tr_b16 a[78:79], v8 offset:63488
  v_mfma_f32_16x16x32_bf16 v[184:187], a[108:111], v[92:95], v[184:187]
  s_waitcnt lgkmcnt(8)
  v_cvt_pk_bf16_f32 v104, v144, v145
  v_cvt_pk_bf16_f32 v105, v146, v147
  v_mfma_f32_16x16x32_bf16 v[164:167], a[112:115], v[32:35], 0
  ds_read_b64_tr_b16 a[80:81], v9 offset:49152
  v_mfma_f32_16x16x32_bf16 v[164:167], a[116:119], v[36:39], v[164:167]
  v_cvt_pk_bf16_f32 v106, v148, v149
  v_cvt_pk_bf16_f32 v107, v150, v151
  v_mfma_f32_16x16x32_bf16 v[164:167], a[120:123], v[40:43], v[164:167]
  ds_read_b64_tr_b16 a[82:83], v9 offset:51200
  v_mfma_f32_16x16x32_bf16 v[164:167], a[124:127], v[44:47], v[164:167]
  buffer_store_dwordx4 v[104:107], v2, s[40:43], s78 offen offset:0 sc1
  v_mfma_f32_16x16x32_bf16 v[172:175], a[112:115], v[48:51], 0
  ds_read_b64_tr_b16 a[84:85], v9 offset:53248
  v_mfma_f32_16x16x32_bf16 v[172:175], a[116:119], v[52:55], v[172:175]
  v_cvt_pk_bf16_f32 v108, v152, v153
  v_cvt_pk_bf16_f32 v109, v154, v155
  v_mfma_f32_16x16x32_bf16 v[172:175], a[120:123], v[56:59], v[172:175]
  ds_read_b64_tr_b16 a[86:87], v9 offset:55296
  v_mfma_f32_16x16x32_bf16 v[172:175], a[124:127], v[60:63], v[172:175]
  v_cvt_pk_bf16_f32 v110, v156, v157
  v_cvt_pk_bf16_f32 v111, v158, v159
  v_mfma_f32_16x16x32_bf16 v[180:183], a[112:115], v[64:67], 0
  ds_read_b64_tr_b16 a[88:89], v9 offset:57344
  v_mfma_f32_16x16x32_bf16 v[180:183], a[116:119], v[68:71], v[180:183]
  buffer_store_dwordx4 v[108:111], v2, s[40:43], s79 offen offset:0 sc1
  v_mfma_f32_16x16x32_bf16 v[180:183], a[120:123], v[72:75], v[180:183]
  ds_read_b64_tr_b16 a[90:91], v9 offset:59392
  v_mfma_f32_16x16x32_bf16 v[180:183], a[124:127], v[76:79], v[180:183]
  v_mfma_f32_16x16x32_bf16 v[188:191], a[112:115], v[80:83], 0
  ds_read_b64_tr_b16 a[92:93], v9 offset:61440
  v_mfma_f32_16x16x32_bf16 v[188:191], a[116:119], v[84:87], v[188:191]
  v_mfma_f32_16x16x32_bf16 v[188:191], a[120:123], v[88:91], v[188:191]
  ds_read_b64_tr_b16 a[94:95], v9 offset:63488
  v_mfma_f32_16x16x32_bf16 v[188:191], a[124:127], v[92:95], v[188:191]
  s_waitcnt lgkmcnt(8)
  v_mfma_f32_16x16x32_bf16 v[128:131], a[64:67], v[32:35], 0
  ds_read_b64_tr_b16 a[96:97], v10 offset:49152
  v_mfma_f32_16x16x32_bf16 v[128:131], a[68:71], v[36:39], v[128:131]
  s_nop 1
  v_mfma_f32_16x16x32_bf16 v[128:131], a[72:75], v[40:43], v[128:131]
  ds_read_b64_tr_b16 a[98:99], v10 offset:51200
  v_mfma_f32_16x16x32_bf16 v[128:131], a[76:79], v[44:47], v[128:131]
  v_cvt_pk_bf16_f32 v112, v160, v161
  v_cvt_pk_bf16_f32 v113, v162, v163
  v_mfma_f32_16x16x32_bf16 v[136:139], a[64:67], v[48:51], 0
  ds_read_b64_tr_b16 a[100:101], v10 offset:53248
  v_mfma_f32_16x16x32_bf16 v[136:139], a[68:71], v[52:55], v[136:139]
  v_cvt_pk_bf16_f32 v114, v164, v165
  v_cvt_pk_bf16_f32 v115, v166, v167
  v_mfma_f32_16x16x32_bf16 v[136:139], a[72:75], v[56:59], v[136:139]
  ds_read_b64_tr_b16 a[102:103], v10 offset:55296
  v_mfma_f32_16x16x32_bf16 v[136:139], a[76:79], v[60:63], v[136:139]
  buffer_store_dwordx4 v[112:115], v2, s[40:43], s76 offen offset:1024 sc1
  v_mfma_f32_16x16x32_bf16 v[144:147], a[64:67], v[64:67], 0
  ds_read_b64_tr_b16 a[104:105], v10 offset:57344
  v_mfma_f32_16x16x32_bf16 v[144:147], a[68:71], v[68:71], v[144:147]
  v_cvt_pk_bf16_f32 v116, v168, v169
  v_cvt_pk_bf16_f32 v117, v170, v171
  v_mfma_f32_16x16x32_bf16 v[144:147], a[72:75], v[72:75], v[144:147]
  ds_read_b64_tr_b16 a[106:107], v10 offset:59392
  v_mfma_f32_16x16x32_bf16 v[144:147], a[76:79], v[76:79], v[144:147]
  v_cvt_pk_bf16_f32 v118, v172, v173
  v_cvt_pk_bf16_f32 v119, v174, v175
  v_mfma_f32_16x16x32_bf16 v[152:155], a[64:67], v[80:83], 0
  ds_read_b64_tr_b16 a[108:109], v10 offset:61440
  v_mfma_f32_16x16x32_bf16 v[152:155], a[68:71], v[84:87], v[152:155]
  buffer_store_dwordx4 v[116:119], v2, s[40:43], s77 offen offset:1024 sc1
  v_mfma_f32_16x16x32_bf16 v[152:155], a[72:75], v[88:91], v[152:155]
  ds_read_b64_tr_b16 a[110:111], v10 offset:63488
  v_mfma_f32_16x16x32_bf16 v[152:155], a[76:79], v[92:95], v[152:155]
  s_waitcnt lgkmcnt(8)
  v_cvt_pk_bf16_f32 v120, v176, v177
  v_cvt_pk_bf16_f32 v121, v178, v179
  v_mfma_f32_16x16x32_bf16 v[132:135], a[80:83], v[32:35], 0
  ds_read_b64_tr_b16 a[112:113], v11 offset:49152
  v_mfma_f32_16x16x32_bf16 v[132:135], a[84:87], v[36:39], v[132:135]
  v_cvt_pk_bf16_f32 v122, v180, v181
  v_cvt_pk_bf16_f32 v123, v182, v183
  v_mfma_f32_16x16x32_bf16 v[132:135], a[88:91], v[40:43], v[132:135]
  ds_read_b64_tr_b16 a[114:115], v11 offset:51200
  v_mfma_f32_16x16x32_bf16 v[132:135], a[92:95], v[44:47], v[132:135]
  buffer_store_dwordx4 v[120:123], v2, s[40:43], s78 offen offset:1024 sc1
  v_mfma_f32_16x16x32_bf16 v[140:143], a[80:83], v[48:51], 0
  ds_read_b64_tr_b16 a[116:117], v11 offset:53248
  v_mfma_f32_16x16x32_bf16 v[140:143], a[84:87], v[52:55], v[140:143]
  v_cvt_pk_bf16_f32 v124, v184, v185
  v_cvt_pk_bf16_f32 v125, v186, v187
  v_mfma_f32_16x16x32_bf16 v[140:143], a[88:91], v[56:59], v[140:143]
  ds_read_b64_tr_b16 a[118:119], v11 offset:55296
  v_mfma_f32_16x16x32_bf16 v[140:143], a[92:95], v[60:63], v[140:143]
  v_cvt_pk_bf16_f32 v126, v188, v189
  v_cvt_pk_bf16_f32 v127, v190, v191
  v_mfma_f32_16x16x32_bf16 v[148:151], a[80:83], v[64:67], 0
  ds_read_b64_tr_b16 a[120:121], v11 offset:57344
  v_mfma_f32_16x16x32_bf16 v[148:151], a[84:87], v[68:71], v[148:151]
  buffer_store_dwordx4 v[124:127], v2, s[40:43], s79 offen offset:1024 sc1
  v_mfma_f32_16x16x32_bf16 v[148:151], a[88:91], v[72:75], v[148:151]
  ds_read_b64_tr_b16 a[122:123], v11 offset:59392
  v_mfma_f32_16x16x32_bf16 v[148:151], a[92:95], v[76:79], v[148:151]
  v_mfma_f32_16x16x32_bf16 v[156:159], a[80:83], v[80:83], 0
  ds_read_b64_tr_b16 a[124:125], v11 offset:61440
  v_mfma_f32_16x16x32_bf16 v[156:159], a[84:87], v[84:87], v[156:159]
  v_mfma_f32_16x16x32_bf16 v[156:159], a[88:91], v[88:91], v[156:159]
  ds_read_b64_tr_b16 a[126:127], v11 offset:63488
  v_mfma_f32_16x16x32_bf16 v[156:159], a[92:95], v[92:95], v[156:159]
  s_waitcnt lgkmcnt(8)
  v_mfma_f32_16x16x32_bf16 v[160:163], a[96:99], v[32:35], 0
  ds_read_b64_tr_b16 a[64:65], v12 offset:0
  v_mfma_f32_16x16x32_bf16 v[160:163], a[100:103], v[36:39], v[160:163]
  s_nop 1
  v_mfma_f32_16x16x32_bf16 v[160:163], a[104:107], v[40:43], v[160:163]
  ds_read_b64_tr_b16 a[66:67], v12 offset:2048
  v_mfma_f32_16x16x32_bf16 v[160:163], a[108:111], v[44:47], v[160:163]
  v_cvt_pk_bf16_f32 v96, v128, v129
  v_cvt_pk_bf16_f32 v97, v130, v131
  v_mfma_f32_16x16x32_bf16 v[168:171], a[96:99], v[48:51], 0
  ds_read_b64_tr_b16 a[68:69], v12 offset:4096
  v_mfma_f32_16x16x32_bf16 v[168:171], a[100:103], v[52:55], v[168:171]
  v_cvt_pk_bf16_f32 v98, v132, v133
  v_cvt_pk_bf16_f32 v99, v134, v135
  v_mfma_f32_16x16x32_bf16 v[168:171], a[104:107], v[56:59], v[168:171]
  ds_read_b64_tr_b16 a[70:71], v12 offset:6144
  v_mfma_f32_16x16x32_bf16 v[168:171], a[108:111], v[60:63], v[168:171]
  buffer_store_dwordx4 v[96:99], v2, s[40:43], s76 offen offset:2048 sc1
  v_mfma_f32_16x16x32_bf16 v[176:179], a[96:99], v[64:67], 0
  ds_read_b64_tr_b16 a[72:73], v12 offset:8192
  v_mfma_f32_16x16x32_bf16 v[176:179], a[100:103], v[68:71], v[176:179]
  v_cvt_pk_bf16_f32 v100, v136, v137
  v_cvt_pk_bf16_f32 v101, v138, v139
  v_mfma_f32_16x16x32_bf16 v[176:179], a[104:107], v[72:75], v[176:179]
  ds_read_b64_tr_b16 a[74:75], v12 offset:10240
  v_mfma_f32_16x16x32_bf16 v[176:179], a[108:111], v[76:79], v[176:179]
  v_cvt_pk_bf16_f32 v102, v140, v141
  v_cvt_pk_bf16_f32 v103, v142, v143
  v_mfma_f32_16x16x32_bf16 v[184:187], a[96:99], v[80:83], 0
  ds_read_b64_tr_b16 a[76:77], v12 offset:12288
  v_mfma_f32_16x16x32_bf16 v[184:187], a[100:103], v[84:87], v[184:187]
  buffer_store_dwordx4 v[100:103], v2, s[40:43], s77 offen offset:2048 sc1
  v_mfma_f32_16x16x32_bf16 v[184:187], a[104:107], v[88:91], v[184:187]
  ds_read_b64_tr_b16 a[78:79], v12 offset:14336
  v_mfma_f32_16x16x32_bf16 v[184:187], a[108:111], v[92:95], v[184:187]
  s_waitcnt lgkmcnt(8)
  v_cvt_pk_bf16_f32 v104, v144, v145
  v_cvt_pk_bf16_f32 v105, v146, v147
  v_mfma_f32_16x16x32_bf16 v[164:167], a[112:115], v[32:35], 0
  ds_read_b64_tr_b16 a[80:81], v13 offset:0
  v_mfma_f32_16x16x32_bf16 v[164:167], a[116:119], v[36:39], v[164:167]
  v_cvt_pk_bf16_f32 v106, v148, v149
  v_cvt_pk_bf16_f32 v107, v150, v151
  v_mfma_f32_16x16x32_bf16 v[164:167], a[120:123], v[40:43], v[164:167]
  ds_read_b64_tr_b16 a[82:83], v13 offset:2048
  v_mfma_f32_16x16x32_bf16 v[164:167], a[124:127], v[44:47], v[164:167]
  buffer_store_dwordx4 v[104:107], v2, s[40:43], s78 offen offset:2048 sc1
  v_mfma_f32_16x16x32_bf16 v[172:175], a[112:115], v[48:51], 0
  ds_read_b64_tr_b16 a[84:85], v13 offset:4096
  v_mfma_f32_16x16x32_bf16 v[172:175], a[116:119], v[52:55], v[172:175]
  v_cvt_pk_bf16_f32 v108, v152, v153
  v_cvt_pk_bf16_f32 v109, v154, v155
  v_mfma_f32_16x16x32_bf16 v[172:175], a[120:123], v[56:59], v[172:175]
  ds_read_b64_tr_b16 a[86:87], v13 offset:6144
  v_mfma_f32_16x16x32_bf16 v[172:175], a[124:127], v[60:63], v[172:175]
  v_cvt_pk_bf16_f32 v110, v156, v157
  v_cvt_pk_bf16_f32 v111, v158, v159
  v_mfma_f32_16x16x32_bf16 v[180:183], a[112:115], v[64:67], 0
  ds_read_b64_tr_b16 a[88:89], v13 offset:8192
  v_mfma_f32_16x16x32_bf16 v[180:183], a[116:119], v[68:71], v[180:183]
  buffer_store_dwordx4 v[108:111], v2, s[40:43], s79 offen offset:2048 sc1
  v_mfma_f32_16x16x32_bf16 v[180:183], a[120:123], v[72:75], v[180:183]
  ds_read_b64_tr_b16 a[90:91], v13 offset:10240
  v_mfma_f32_16x16x32_bf16 v[180:183], a[124:127], v[76:79], v[180:183]
  v_mfma_f32_16x16x32_bf16 v[188:191], a[112:115], v[80:83], 0
  ds_read_b64_tr_b16 a[92:93], v13 offset:12288
  v_mfma_f32_16x16x32_bf16 v[188:191], a[116:119], v[84:87], v[188:191]
  v_mfma_f32_16x16x32_bf16 v[188:191], a[120:123], v[88:91], v[188:191]
  ds_read_b64_tr_b16 a[94:95], v13 offset:14336
  v_mfma_f32_16x16x32_bf16 v[188:191], a[124:127], v[92:95], v[188:191]
  s_waitcnt lgkmcnt(8)
  v_mfma_f32_16x16x32_bf16 v[128:131], a[64:67], v[32:35], 0
  ds_read_b64_tr_b16 a[96:97], v14 offset:0
  v_mfma_f32_16x16x32_bf16 v[128:131], a[68:71], v[36:39], v[128:131]
  s_nop 1
  v_mfma_f32_16x16x32_bf16 v[128:131], a[72:75], v[40:43], v[128:131]
  ds_read_b64_tr_b16 a[98:99], v14 offset:2048
  v_mfma_f32_16x16x32_bf16 v[128:131], a[76:79], v[44:47], v[128:131]
  v_cvt_pk_bf16_f32 v112, v160, v161
  v_cvt_pk_bf16_f32 v113, v162, v163
  v_mfma_f32_16x16x32_bf16 v[136:139], a[64:67], v[48:51], 0
  ds_read_b64_tr_b16 a[100:101], v14 offset:4096
  v_mfma_f32_16x16x32_bf16 v[136:139], a[68:71], v[52:55], v[136:139]
  v_cvt_pk_bf16_f32 v114, v164, v165
  v_cvt_pk_bf16_f32 v115, v166, v167
  v_mfma_f32_16x16x32_bf16 v[136:139], a[72:75], v[56:59], v[136:139]
  ds_read_b64_tr_b16 a[102:103], v14 offset:6144
  v_mfma_f32_16x16x32_bf16 v[136:139], a[76:79], v[60:63], v[136:139]
  buffer_store_dwordx4 v[112:115], v2, s[40:43], s76 offen offset:3072 sc1
  v_mfma_f32_16x16x32_bf16 v[144:147], a[64:67], v[64:67], 0
  ds_read_b64_tr_b16 a[104:105], v14 offset:8192
  v_mfma_f32_16x16x32_bf16 v[144:147], a[68:71], v[68:71], v[144:147]
  v_cvt_pk_bf16_f32 v116, v168, v169
  v_cvt_pk_bf16_f32 v117, v170, v171
  v_mfma_f32_16x16x32_bf16 v[144:147], a[72:75], v[72:75], v[144:147]
  ds_read_b64_tr_b16 a[106:107], v14 offset:10240
  v_mfma_f32_16x16x32_bf16 v[144:147], a[76:79], v[76:79], v[144:147]
  v_cvt_pk_bf16_f32 v118, v172, v173
  v_cvt_pk_bf16_f32 v119, v174, v175
  v_mfma_f32_16x16x32_bf16 v[152:155], a[64:67], v[80:83], 0
  ds_read_b64_tr_b16 a[108:109], v14 offset:12288
  v_mfma_f32_16x16x32_bf16 v[152:155], a[68:71], v[84:87], v[152:155]
  buffer_store_dwordx4 v[116:119], v2, s[40:43], s77 offen offset:3072 sc1
  v_mfma_f32_16x16x32_bf16 v[152:155], a[72:75], v[88:91], v[152:155]
  ds_read_b64_tr_b16 a[110:111], v14 offset:14336
  v_mfma_f32_16x16x32_bf16 v[152:155], a[76:79], v[92:95], v[152:155]
  s_waitcnt lgkmcnt(8)
  v_cvt_pk_bf16_f32 v120, v176, v177
  v_cvt_pk_bf16_f32 v121, v178, v179
  v_mfma_f32_16x16x32_bf16 v[132:135], a[80:83], v[32:35], 0
  ds_read_b64_tr_b16 a[112:113], v15 offset:0
  v_mfma_f32_16x16x32_bf16 v[132:135], a[84:87], v[36:39], v[132:135]
  v_cvt_pk_bf16_f32 v122, v180, v181
  v_cvt_pk_bf16_f32 v123, v182, v183
  v_mfma_f32_16x16x32_bf16 v[132:135], a[88:91], v[40:43], v[132:135]
  ds_read_b64_tr_b16 a[114:115], v15 offset:2048
  v_mfma_f32_16x16x32_bf16 v[132:135], a[92:95], v[44:47], v[132:135]
  buffer_store_dwordx4 v[120:123], v2, s[40:43], s78 offen offset:3072 sc1
  v_mfma_f32_16x16x32_bf16 v[140:143], a[80:83], v[48:51], 0
  ds_read_b64_tr_b16 a[116:117], v15 offset:4096
  v_mfma_f32_16x16x32_bf16 v[140:143], a[84:87], v[52:55], v[140:143]
  v_cvt_pk_bf16_f32 v124, v184, v185
  v_cvt_pk_bf16_f32 v125, v186, v187
  v_mfma_f32_16x16x32_bf16 v[140:143], a[88:91], v[56:59], v[140:143]
  ds_read_b64_tr_b16 a[118:119], v15 offset:6144
  v_mfma_f32_16x16x32_bf16 v[140:143], a[92:95], v[60:63], v[140:143]
  v_cvt_pk_bf16_f32 v126, v188, v189
  v_cvt_pk_bf16_f32 v127, v190, v191
  v_mfma_f32_16x16x32_bf16 v[148:151], a[80:83], v[64:67], 0
  ds_read_b64_tr_b16 a[120:121], v15 offset:8192
  v_mfma_f32_16x16x32_bf16 v[148:151], a[84:87], v[68:71], v[148:151]
  buffer_store_dwordx4 v[124:127], v2, s[40:43], s79 offen offset:3072 sc1
  v_mfma_f32_16x16x32_bf16 v[148:151], a[88:91], v[72:75], v[148:151]
  ds_read_b64_tr_b16 a[122:123], v15 offset:10240
  v_mfma_f32_16x16x32_bf16 v[148:151], a[92:95], v[76:79], v[148:151]
  v_mfma_f32_16x16x32_bf16 v[156:159], a[80:83], v[80:83], 0
  ds_read_b64_tr_b16 a[124:125], v15 offset:12288
  v_mfma_f32_16x16x32_bf16 v[156:159], a[84:87], v[84:87], v[156:159]
  v_mfma_f32_16x16x32_bf16 v[156:159], a[88:91], v[88:91], v[156:159]
  ds_read_b64_tr_b16 a[126:127], v15 offset:14336
  v_mfma_f32_16x16x32_bf16 v[156:159], a[92:95], v[92:95], v[156:159]
  s_waitcnt lgkmcnt(8)
  v_mfma_f32_16x16x32_bf16 v[160:163], a[96:99], v[32:35], 0
  ds_read_b64_tr_b16 a[64:65], v12 offset:16384
  v_mfma_f32_16x16x32_bf16 v[160:163], a[100:103], v[36:39], v[160:163]
  s_add_u32 s76, s76, 0x1000
  s_add_u32 s77, s77, 0x1000
  s_add_u32 s78, s78, 0x1000
  s_add_u32 s79, s79, 0x1000
  v_mfma_f32_16x16x32_bf16 v[160:163], a[104:107], v[40:43], v[160:163]
  ds_read_b64_tr_b16 a[66:67], v12 offset:18432
  v_mfma_f32_16x16x32_bf16 v[160:163], a[108:111], v[44:47], v[160:163]
  v_cvt_pk_bf16_f32 v96, v128, v129
  v_cvt_pk_bf16_f32 v97, v130, v131
  v_mfma_f32_16x16x32_bf16 v[168:171], a[96:99], v[48:51], 0
  ds_read_b64_tr_b16 a[68:69], v12 offset:20480
  v_mfma_f32_16x16x32_bf16 v[168:171], a[100:103], v[52:55], v[168:171]
  v_cvt_pk_bf16_f32 v98, v132, v133
  v_cvt_pk_bf16_f32 v99, v134, v135
  v_mfma_f32_16x16x32_bf16 v[168:171], a[104:107], v[56:59], v[168:171]
  ds_read_b64_tr_b16 a[70:71], v12 offset:22528
  v_mfma_f32_16x16x32_bf16 v[168:171], a[108:111], v[60:63], v[168:171]
  buffer_store_dwordx4 v[96:99], v2, s[40:43], s76 offen offset:0 sc1
  v_mfma_f32_16x16x32_bf16 v[176:179], a[96:99], v[64:67], 0
  ds_read_b64_tr_b16 a[72:73], v12 offset:24576
  v_mfma_f32_16x16x32_bf16 v[176:179], a[100:103], v[68:71], v[176:179]
  v_cvt_pk_bf16_f32 v100, v136, v137
  v_cvt_pk_bf16_f32 v101, v138, v139
  v_mfma_f32_16x16x32_bf16 v[176:179], a[104:107], v[72:75], v[176:179]
  ds_read_b64_tr_b16 a[74:75], v12 offset:26624
  v_mfma_f32_16x16x32_bf16 v[176:179], a[108:111], v[76:79], v[176:179]
  v_cvt_pk_bf16_f32 v102, v140, v141
  v_cvt_pk_bf16_f32 v103, v142, v143
  v_mfma_f32_16x16x32_bf16 v[184:187], a[96:99], v[80:83], 0
  ds_read_b64_tr_b16 a[76:77], v12 offset:28672
  v_mfma_f32_16x16x32_bf16 v[184:187], a[100:103], v[84:87], v[184:187]
  buffer_store_dwordx4 v[100:103], v2, s[40:43], s77 offen offset:0 sc1
  v_mfma_f32_16x16x32_bf16 v[184:187], a[104:107], v[88:91], v[184:187]
  ds_read_b64_tr_b16 a[78:79], v12 offset:30720
  v_mfma_f32_16x16x32_bf16 v[184:187], a[108:111], v[92:95], v[184:187]
  s_waitcnt lgkmcnt(8)
  v_cvt_pk_bf16_f32 v104, v144, v145
  v_cvt_pk_bf16_f32 v105, v146, v147
  v_mfma_f32_16x16x32_bf16 v[164:167], a[112:115], v[32:35], 0
  ds_read_b64_tr_b16 a[80:81], v13 offset:16384
  v_mfma_f32_16x16x32_bf16 v[164:167], a[116:119], v[36:39], v[164:167]
  v_cvt_pk_bf16_f32 v106, v148, v149
  v_cvt_pk_bf16_f32 v107, v150, v151
  v_mfma_f32_16x16x32_bf16 v[164:167], a[120:123], v[40:43], v[164:167]
  ds_read_b64_tr_b16 a[82:83], v13 offset:18432
  v_mfma_f32_16x16x32_bf16 v[164:167], a[124:127], v[44:47], v[164:167]
  buffer_store_dwordx4 v[104:107], v2, s[40:43], s78 offen offset:0 sc1
  v_mfma_f32_16x16x32_bf16 v[172:175], a[112:115], v[48:51], 0
  ds_read_b64_tr_b16 a[84:85], v13 offset:20480
  v_mfma_f32_16x16x32_bf16 v[172:175], a[116:119], v[52:55], v[172:175]
  v_cvt_pk_bf16_f32 v108, v152, v153
  v_cvt_pk_bf16_f32 v109, v154, v155
  v_mfma_f32_16x16x32_bf16 v[172:175], a[120:123], v[56:59], v[172:175]
  ds_read_b64_tr_b16 a[86:87], v13 offset:22528
  v_mfma_f32_16x16x32_bf16 v[172:175], a[124:127], v[60:63], v[172:175]
  v_cvt_pk_bf16_f32 v110, v156, v157
  v_cvt_pk_bf16_f32 v111, v158, v159
  v_mfma_f32_16x16x32_bf16 v[180:183], a[112:115], v[64:67], 0
  ds_read_b64_tr_b16 a[88:89], v13 offset:24576
  v_mfma_f32_16x16x32_bf16 v[180:183], a[116:119], v[68:71], v[180:183]
  buffer_store_dwordx4 v[108:111], v2, s[40:43], s79 offen offset:0 sc1
  v_mfma_f32_16x16x32_bf16 v[180:183], a[120:123], v[72:75], v[180:183]
  ds_read_b64_tr_b16 a[90:91], v13 offset:26624
  v_mfma_f32_16x16x32_bf16 v[180:183], a[124:127], v[76:79], v[180:183]
  v_mfma_f32_16x16x32_bf16 v[188:191], a[112:115], v[80:83], 0
  ds_read_b64_tr_b16 a[92:93], v13 offset:28672
  v_mfma_f32_16x16x32_bf16 v[188:191], a[116:119], v[84:87], v[188:191]
  v_mfma_f32_16x16x32_bf16 v[188:191], a[120:123], v[88:91], v[188:191]
  ds_read_b64_tr_b16 a[94:95], v13 offset:30720
  v_mfma_f32_16x16x32_bf16 v[188:191], a[124:127], v[92:95], v[188:191]
  s_waitcnt lgkmcnt(8)
  v_mfma_f32_16x16x32_bf16 v[128:131], a[64:67], v[32:35], 0
  ds_read_b64_tr_b16 a[96:97], v14 offset:16384
  v_mfma_f32_16x16x32_bf16 v[128:131], a[68:71], v[36:39], v[128:131]
  s_nop 1
  v_mfma_f32_16x16x32_bf16 v[128:131], a[72:75], v[40:43], v[128:131]
  ds_read_b64_tr_b16 a[98:99], v14 offset:18432
  v_mfma_f32_16x16x32_bf16 v[128:131], a[76:79], v[44:47], v[128:131]
  v_cvt_pk_bf16_f32 v112, v160, v161
  v_cvt_pk_bf16_f32 v113, v162, v163
  v_mfma_f32_16x16x32_bf16 v[136:139], a[64:67], v[48:51], 0
  ds_read_b64_tr_b16 a[100:101], v14 offset:20480
  v_mfma_f32_16x16x32_bf16 v[136:139], a[68:71], v[52:55], v[136:139]
  v_cvt_pk_bf16_f32 v114, v164, v165
  v_cvt_pk_bf16_f32 v115, v166, v167
  v_mfma_f32_16x16x32_bf16 v[136:139], a[72:75], v[56:59], v[136:139]
  ds_read_b64_tr_b16 a[102:103], v14 offset:22528
  v_mfma_f32_16x16x32_bf16 v[136:139], a[76:79], v[60:63], v[136:139]
  buffer_store_dwordx4 v[112:115], v2, s[40:43], s76 offen offset:1024 sc1
  v_mfma_f32_16x16x32_bf16 v[144:147], a[64:67], v[64:67], 0
  ds_read_b64_tr_b16 a[104:105], v14 offset:24576
  v_mfma_f32_16x16x32_bf16 v[144:147], a[68:71], v[68:71], v[144:147]
  v_cvt_pk_bf16_f32 v116, v168, v169
  v_cvt_pk_bf16_f32 v117, v170, v171
  v_mfma_f32_16x16x32_bf16 v[144:147], a[72:75], v[72:75], v[144:147]
  ds_read_b64_tr_b16 a[106:107], v14 offset:26624
  v_mfma_f32_16x16x32_bf16 v[144:147], a[76:79], v[76:79], v[144:147]
  v_cvt_pk_bf16_f32 v118, v172, v173
  v_cvt_pk_bf16_f32 v119, v174, v175
  v_mfma_f32_16x16x32_bf16 v[152:155], a[64:67], v[80:83], 0
  ds_read_b64_tr_b16 a[108:109], v14 offset:28672
  v_mfma_f32_16x16x32_bf16 v[152:155], a[68:71], v[84:87], v[152:155]
  buffer_store_dwordx4 v[116:119], v2, s[40:43], s77 offen offset:1024 sc1
  v_mfma_f32_16x16x32_bf16 v[152:155], a[72:75], v[88:91], v[152:155]
  ds_read_b64_tr_b16 a[110:111], v14 offset:30720
  v_mfma_f32_16x16x32_bf16 v[152:155], a[76:79], v[92:95], v[152:155]
  s_waitcnt lgkmcnt(8)
  v_cvt_pk_bf16_f32 v120, v176, v177
  v_cvt_pk_bf16_f32 v121, v178, v179
  v_mfma_f32_16x16x32_bf16 v[132:135], a[80:83], v[32:35], 0
  ds_read_b64_tr_b16 a[112:113], v15 offset:16384
  v_mfma_f32_16x16x32_bf16 v[132:135], a[84:87], v[36:39], v[132:135]
  v_cvt_pk_bf16_f32 v122, v180, v181
  v_cvt_pk_bf16_f32 v123, v182, v183
  v_mfma_f32_16x16x32_bf16 v[132:135], a[88:91], v[40:43], v[132:135]
  ds_read_b64_tr_b16 a[114:115], v15 offset:18432
  v_mfma_f32_16x16x32_bf16 v[132:135], a[92:95], v[44:47], v[132:135]
  buffer_store_dwordx4 v[120:123], v2, s[40:43], s78 offen offset:1024 sc1
  v_mfma_f32_16x16x32_bf16 v[140:143], a[80:83], v[48:51], 0
  ds_read_b64_tr_b16 a[116:117], v15 offset:20480
  v_mfma_f32_16x16x32_bf16 v[140:143], a[84:87], v[52:55], v[140:143]
  v_cvt_pk_bf16_f32 v124, v184, v185
  v_cvt_pk_bf16_f32 v125, v186, v187
  v_mfma_f32_16x16x32_bf16 v[140:143], a[88:91], v[56:59], v[140:143]
  ds_read_b64_tr_b16 a[118:119], v15 offset:22528
  v_mfma_f32_16x16x32_bf16 v[140:143], a[92:95], v[60:63], v[140:143]
  v_cvt_pk_bf16_f32 v126, v188, v189
  v_cvt_pk_bf16_f32 v127, v190, v191
  v_mfma_f32_16x16x32_bf16 v[148:151], a[80:83], v[64:67], 0
  ds_read_b64_tr_b16 a[120:121], v15 offset:24576
  v_mfma_f32_16x16x32_bf16 v[148:151], a[84:87], v[68:71], v[148:151]
  buffer_store_dwordx4 v[124:127], v2, s[40:43], s79 offen offset:1024 sc1
  v_mfma_f32_16x16x32_bf16 v[148:151], a[88:91], v[72:75], v[148:151]
  ds_read_b64_tr_b16 a[122:123], v15 offset:26624
  v_mfma_f32_16x16x32_bf16 v[148:151], a[92:95], v[76:79], v[148:151]
  v_mfma_f32_16x16x32_bf16 v[156:159], a[80:83], v[80:83], 0
  ds_read_b64_tr_b16 a[124:125], v15 offset:28672
  v_mfma_f32_16x16x32_bf16 v[156:159], a[84:87], v[84:87], v[156:159]
  v_mfma_f32_16x16x32_bf16 v[156:159], a[88:91], v[88:91], v[156:159]
  ds_read_b64_tr_b16 a[126:127], v15 offset:30720
  v_mfma_f32_16x16x32_bf16 v[156:159], a[92:95], v[92:95], v[156:159]
  s_waitcnt lgkmcnt(8)
  v_mfma_f32_16x16x32_bf16 v[160:163], a[96:99], v[32:35], 0
  ds_read_b64_tr_b16 a[64:65], v12 offset:32768
  v_mfma_f32_16x16x32_bf16 v[160:163], a[100:103], v[36:39], v[160:163]
  s_nop 1
  v_mfma_f32_16x16x32_bf16 v[160:163], a[104:107], v[40:43], v[160:163]
  ds_read_b64_tr_b16 a[66:67], v12 offset:34816
  v_mfma_f32_16x16x32_bf16 v[160:163], a[108:111], v[44:47], v[160:163]
  v_cvt_pk_bf16_f32 v96, v128, v129
  v_cvt_pk_bf16_f32 v97, v130, v131
  v_mfma_f32_16x16x32_bf16 v[168:171], a[96:99], v[48:51], 0
  ds_read_b64_tr_b16 a[68:69], v12 offset:36864
  v_mfma_f32_16x16x32_bf16 v[168:171], a[100:103], v[52:55], v[168:171]
  v_cvt_pk_bf16_f32 v98, v132, v133
  v_cvt_pk_bf16_f32 v99, v134, v135
  v_mfma_f32_16x16x32_bf16 v[168:171], a[104:107], v[56:59], v[168:171]
  ds_read_b64_tr_b16 a[70:71], v12 offset:38912
  v_mfma_f32_16x16x32_bf16 v[168:171], a[108:111], v[60:63], v[168:171]
  buffer_store_dwordx4 v[96:99], v2, s[40:43], s76 offen offset:2048 sc1
  v_mfma_f32_16x16x32_bf16 v[176:179], a[96:99], v[64:67], 0
  ds_read_b64_tr_b16 a[72:73], v12 offset:40960
  v_mfma_f32_16x16x32_bf16 v[176:179], a[100:103], v[68:71], v[176:179]
  v_cvt_pk_bf16_f32 v100, v136, v137
  v_cvt_pk_bf16_f32 v101, v138, v139
  v_mfma_f32_16x16x32_bf16 v[176:179], a[104:107], v[72:75], v[176:179]
  ds_read_b64_tr_b16 a[74:75], v12 offset:43008
  v_mfma_f32_16x16x32_bf16 v[176:179], a[108:111], v[76:79], v[176:179]
  v_cvt_pk_bf16_f32 v102, v140, v141
  v_cvt_pk_bf16_f32 v103, v142, v143
  v_mfma_f32_16x16x32_bf16 v[184:187], a[96:99], v[80:83], 0
  ds_read_b64_tr_b16 a[76:77], v12 offset:45056
  v_mfma_f32_16x16x32_bf16 v[184:187], a[100:103], v[84:87], v[184:187]
  buffer_store_dwordx4 v[100:103], v2, s[40:43], s77 offen offset:2048 sc1
  v_mfma_f32_16x16x32_bf16 v[184:187], a[104:107], v[88:91], v[184:187]
  ds_read_b64_tr_b16 a[78:79], v12 offset:47104
  v_mfma_f32_16x16x32_bf16 v[184:187], a[108:111], v[92:95], v[184:187]
  s_waitcnt lgkmcnt(8)
  v_cvt_pk_bf16_f32 v104, v144, v145
  v_cvt_pk_bf16_f32 v105, v146, v147
  v_mfma_f32_16x16x32_bf16 v[164:167], a[112:115], v[32:35], 0
  ds_read_b64_tr_b16 a[80:81], v13 offset:32768
  v_mfma_f32_16x16x32_bf16 v[164:167], a[116:119], v[36:39], v[164:167]
  v_cvt_pk_bf16_f32 v106, v148, v149
  v_cvt_pk_bf16_f32 v107, v150, v151
  v_mfma_f32_16x16x32_bf16 v[164:167], a[120:123], v[40:43], v[164:167]
  ds_read_b64_tr_b16 a[82:83], v13 offset:34816
  v_mfma_f32_16x16x32_bf16 v[164:167], a[124:127], v[44:47], v[164:167]
  buffer_store_dwordx4 v[104:107], v2, s[40:43], s78 offen offset:2048 sc1
  v_mfma_f32_16x16x32_bf16 v[172:175], a[112:115], v[48:51], 0
  ds_read_b64_tr_b16 a[84:85], v13 offset:36864
  v_mfma_f32_16x16x32_bf16 v[172:175], a[116:119], v[52:55], v[172:175]
  v_cvt_pk_bf16_f32 v108, v152, v153
  v_cvt_pk_bf16_f32 v109, v154, v155
  v_mfma_f32_16x16x32_bf16 v[172:175], a[120:123], v[56:59], v[172:175]
  ds_read_b64_tr_b16 a[86:87], v13 offset:38912
  v_mfma_f32_16x16x32_bf16 v[172:175], a[124:127], v[60:63], v[172:175]
  v_cvt_pk_bf16_f32 v110, v156, v157
  v_cvt_pk_bf16_f32 v111, v158, v159
  v_mfma_f32_16x16x32_bf16 v[180:183], a[112:115], v[64:67], 0
  ds_read_b64_tr_b16 a[88:89], v13 offset:40960
  v_mfma_f32_16x16x32_bf16 v[180:183], a[116:119], v[68:71], v[180:183]
  buffer_store_dwordx4 v[108:111], v2, s[40:43], s79 offen offset:2048 sc1
  v_mfma_f32_16x16x32_bf16 v[180:183], a[120:123], v[72:75], v[180:183]
  ds_read_b64_tr_b16 a[90:91], v13 offset:43008
  v_mfma_f32_16x16x32_bf16 v[180:183], a[124:127], v[76:79], v[180:183]
  v_mfma_f32_16x16x32_bf16 v[188:191], a[112:115], v[80:83], 0
  ds_read_b64_tr_b16 a[92:93], v13 offset:45056
  v_mfma_f32_16x16x32_bf16 v[188:191], a[116:119], v[84:87], v[188:191]
  v_mfma_f32_16x16x32_bf16 v[188:191], a[120:123], v[88:91], v[188:191]
  ds_read_b64_tr_b16 a[94:95], v13 offset:47104
  v_mfma_f32_16x16x32_bf16 v[188:191], a[124:127], v[92:95], v[188:191]
  s_waitcnt lgkmcnt(8)
  v_mfma_f32_16x16x32_bf16 v[128:131], a[64:67], v[32:35], 0
  ds_read_b64_tr_b16 a[96:97], v14 offset:32768
  v_mfma_f32_16x16x32_bf16 v[128:131], a[68:71], v[36:39], v[128:131]
  s_nop 1
  v_mfma_f32_16x16x32_bf16 v[128:131], a[72:75], v[40:43], v[128:131]
  ds_read_b64_tr_b16 a[98:99], v14 offset:34816
  v_mfma_f32_16x16x32_bf16 v[128:131], a[76:79], v[44:47], v[128:131]
  v_cvt_pk_bf16_f32 v112, v160, v161
  v_cvt_pk_bf16_f32 v113, v162, v163
  v_mfma_f32_16x16x32_bf16 v[136:139], a[64:67], v[48:51], 0
  ds_read_b64_tr_b16 a[100:101], v14 offset:36864
  v_mfma_f32_16x16x32_bf16 v[136:139], a[68:71], v[52:55], v[136:139]
  v_cvt_pk_bf16_f32 v114, v164, v165
  v_cvt_pk_bf16_f32 v115, v166, v167
  v_mfma_f32_16x16x32_bf16 v[136:139], a[72:75], v[56:59], v[136:139]
  ds_read_b64_tr_b16 a[102:103], v14 offset:38912
  v_mfma_f32_16x16x32_bf16 v[136:139], a[76:79], v[60:63], v[136:139]
  buffer_store_dwordx4 v[112:115], v2, s[40:43], s76 offen offset:3072 sc1
  v_mfma_f32_16x16x32_bf16 v[144:147], a[64:67], v[64:67], 0
  ds_read_b64_tr_b16 a[104:105], v14 offset:40960
  v_mfma_f32_16x16x32_bf16 v[144:147], a[68:71], v[68:71], v[144:147]
  v_cvt_pk_bf16_f32 v116, v168, v169
  v_cvt_pk_bf16_f32 v117, v170, v171
  v_mfma_f32_16x16x32_bf16 v[144:147], a[72:75], v[72:75], v[144:147]
  ds_read_b64_tr_b16 a[106:107], v14 offset:43008
  v_mfma_f32_16x16x32_bf16 v[144:147], a[76:79], v[76:79], v[144:147]
  v_cvt_pk_bf16_f32 v118, v172, v173
  v_cvt_pk_bf16_f32 v119, v174, v175
  v_mfma_f32_16x16x32_bf16 v[152:155], a[64:67], v[80:83], 0
  ds_read_b64_tr_b16 a[108:109], v14 offset:45056
  v_mfma_f32_16x16x32_bf16 v[152:155], a[68:71], v[84:87], v[152:155]
  buffer_store_dwordx4 v[116:119], v2, s[40:43], s77 offen offset:3072 sc1
  v_mfma_f32_16x16x32_bf16 v[152:155], a[72:75], v[88:91], v[152:155]
  ds_read_b64_tr_b16 a[110:111], v14 offset:47104
  v_mfma_f32_16x16x32_bf16 v[152:155], a[76:79], v[92:95], v[152:155]
  s_waitcnt lgkmcnt(8)
  v_cvt_pk_bf16_f32 v120, v176, v177
  v_cvt_pk_bf16_f32 v121, v178, v179
  v_mfma_f32_16x16x32_bf16 v[132:135], a[80:83], v[32:35], 0
  ds_read_b64_tr_b16 a[112:113], v15 offset:32768
  v_mfma_f32_16x16x32_bf16 v[132:135], a[84:87], v[36:39], v[132:135]
  v_cvt_pk_bf16_f32 v122, v180, v181
  v_cvt_pk_bf16_f32 v123, v182, v183
  v_mfma_f32_16x16x32_bf16 v[132:135], a[88:91], v[40:43], v[132:135]
  ds_read_b64_tr_b16 a[114:115], v15 offset:34816
  v_mfma_f32_16x16x32_bf16 v[132:135], a[92:95], v[44:47], v[132:135]
  buffer_store_dwordx4 v[120:123], v2, s[40:43], s78 offen offset:3072 sc1
  v_mfma_f32_16x16x32_bf16 v[140:143], a[80:83], v[48:51], 0
  ds_read_b64_tr_b16 a[116:117], v15 offset:36864
  v_mfma_f32_16x16x32_bf16 v[140:143], a[84:87], v[52:55], v[140:143]
  v_cvt_pk_bf16_f32 v124, v184, v185
  v_cvt_pk_bf16_f32 v125, v186, v187
  v_mfma_f32_16x16x32_bf16 v[140:143], a[88:91], v[56:59], v[140:143]
  ds_read_b64_tr_b16 a[118:119], v15 offset:38912
  v_mfma_f32_16x16x32_bf16 v[140:143], a[92:95], v[60:63], v[140:143]
  v_cvt_pk_bf16_f32 v126, v188, v189
  v_cvt_pk_bf16_f32 v127, v190, v191
  v_mfma_f32_16x16x32_bf16 v[148:151], a[80:83], v[64:67], 0
  ds_read_b64_tr_b16 a[120:121], v15 offset:40960
  v_mfma_f32_16x16x32_bf16 v[148:151], a[84:87], v[68:71], v[148:151]
  buffer_store_dwordx4 v[124:127], v2, s[40:43], s79 offen offset:3072 sc1
  v_mfma_f32_16x16x32_bf16 v[148:151], a[88:91], v[72:75], v[148:151]
  ds_read_b64_tr_b16 a[122:123], v15 offset:43008
  v_mfma_f32_16x16x32_bf16 v[148:151], a[92:95], v[76:79], v[148:151]
  v_mfma_f32_16x16x32_bf16 v[156:159], a[80:83], v[80:83], 0
  ds_read_b64_tr_b16 a[124:125], v15 offset:45056
  v_mfma_f32_16x16x32_bf16 v[156:159], a[84:87], v[84:87], v[156:159]
  v_mfma_f32_16x16x32_bf16 v[156:159], a[88:91], v[88:91], v[156:159]
  s_waitcnt vmcnt(32)
  s_barrier
  ds_read_b64_tr_b16 a[126:127], v15 offset:47104
  v_mfma_f32_16x16x32_bf16 v[156:159], a[92:95], v[92:95], v[156:159]
  s_waitcnt lgkmcnt(8)
  v_mfma_f32_16x16x32_bf16 v[160:163], a[96:99], v[32:35], 0
  ds_read_b64_tr_b16 a[64:65], v12 offset:49152
  v_mfma_f32_16x16x32_bf16 v[160:163], a[100:103], v[36:39], v[160:163]
  s_add_u32 s76, s76, 0x1000
  s_add_u32 s77, s77, 0x1000
  s_add_u32 s78, s78, 0x1000
  s_add_u32 s79, s79, 0x1000
  v_mfma_f32_16x16x32_bf16 v[160:163], a[104:107], v[40:43], v[160:163]
  ds_read_b64_tr_b16 a[66:67], v12 offset:51200
  v_mfma_f32_16x16x32_bf16 v[160:163], a[108:111], v[44:47], v[160:163]
  v_cvt_pk_bf16_f32 v96, v128, v129
  v_cvt_pk_bf16_f32 v97, v130, v131
  v_mfma_f32_16x16x32_bf16 v[168:171], a[96:99], v[48:51], 0
  ds_read_b64_tr_b16 a[68:69], v12 offset:53248
  v_mfma_f32_16x16x32_bf16 v[168:171], a[100:103], v[52:55], v[168:171]
  v_cvt_pk_bf16_f32 v98, v132, v133
  v_cvt_pk_bf16_f32 v99, v134, v135
  v_mfma_f32_16x16x32_bf16 v[168:171], a[104:107], v[56:59], v[168:171]
  ds_read_b64_tr_b16 a[70:71], v12 offset:55296
  v_mfma_f32_16x16x32_bf16 v[168:171], a[108:111], v[60:63], v[168:171]
  buffer_store_dwordx4 v[96:99], v2, s[40:43], s76 offen offset:0 sc1
  v_mfma_f32_16x16x32_bf16 v[176:179], a[96:99], v[64:67], 0
  ds_read_b64_tr_b16 a[72:73], v12 offset:57344
  v_mfma_f32_16x16x32_bf16 v[176:179], a[100:103], v[68:71], v[176:179]
  v_cvt_pk_bf16_f32 v100, v136, v137
  v_cvt_pk_bf16_f32 v101, v138, v139
  v_mfma_f32_16x16x32_bf16 v[176:179], a[104:107], v[72:75], v[176:179]
  ds_read_b64_tr_b16 a[74:75], v12 offset:59392
  v_mfma_f32_16x16x32_bf16 v[176:179], a[108:111], v[76:79], v[176:179]
  v_cvt_pk_bf16_f32 v102, v140, v141
  v_cvt_pk_bf16_f32 v103, v142, v143
  v_mfma_f32_16x16x32_bf16 v[184:187], a[96:99], v[80:83], 0
  ds_read_b64_tr_b16 a[76:77], v12 offset:61440
  v_mfma_f32_16x16x32_bf16 v[184:187], a[100:103], v[84:87], v[184:187]
  buffer_store_dwordx4 v[100:103], v2, s[40:43], s77 offen offset:0 sc1
  v_mfma_f32_16x16x32_bf16 v[184:187], a[104:107], v[88:91], v[184:187]
  ds_read_b64_tr_b16 a[78:79], v12 offset:63488
  v_mfma_f32_16x16x32_bf16 v[184:187], a[108:111], v[92:95], v[184:187]
  s_waitcnt lgkmcnt(8)
  v_cvt_pk_bf16_f32 v104, v144, v145
  v_cvt_pk_bf16_f32 v105, v146, v147
  v_mfma_f32_16x16x32_bf16 v[164:167], a[112:115], v[32:35], 0
  ds_read_b64_tr_b16 a[80:81], v13 offset:49152
  v_mfma_f32_16x16x32_bf16 v[164:167], a[116:119], v[36:39], v[164:167]
  v_cvt_pk_bf16_f32 v106, v148, v149
  v_cvt_pk_bf16_f32 v107, v150, v151
  v_mfma_f32_16x16x32_bf16 v[164:167], a[120:123], v[40:43], v[164:167]
  ds_read_b64_tr_b16 a[82:83], v13 offset:51200
  v_mfma_f32_16x16x32_bf16 v[164:167], a[124:127], v[44:47], v[164:167]
  buffer_store_dwordx4 v[104:107], v2, s[40:43], s78 offen offset:0 sc1
  v_mfma_f32_16x16x32_bf16 v[172:175], a[112:115], v[48:51], 0
  ds_read_b64_tr_b16 a[84:85], v13 offset:53248
  v_mfma_f32_16x16x32_bf16 v[172:175], a[116:119], v[52:55], v[172:175]
  v_cvt_pk_bf16_f32 v108, v152, v153
  v_cvt_pk_bf16_f32 v109, v154, v155
  v_mfma_f32_16x16x32_bf16 v[172:175], a[120:123], v[56:59], v[172:175]
  ds_read_b64_tr_b16 a[86:87], v13 offset:55296
  v_mfma_f32_16x16x32_bf16 v[172:175], a[124:127], v[60:63], v[172:175]
  v_cvt_pk_bf16_f32 v110, v156, v157
  v_cvt_pk_bf16_f32 v111, v158, v159
  v_mfma_f32_16x16x32_bf16 v[180:183], a[112:115], v[64:67], 0
  ds_read_b64_tr_b16 a[88:89], v13 offset:57344
  v_mfma_f32_16x16x32_bf16 v[180:183], a[116:119], v[68:71], v[180:183]
  buffer_store_dwordx4 v[108:111], v2, s[40:43], s79 offen offset:0 sc1
  v_mfma_f32_16x16x32_bf16 v[180:183], a[120:123], v[72:75], v[180:183]
  ds_read_b64_tr_b16 a[90:91], v13 offset:59392
  v_mfma_f32_16x16x32_bf16 v[180:183], a[124:127], v[76:79], v[180:183]
  v_mfma_f32_16x16x32_bf16 v[188:191], a[112:115], v[80:83], 0
  ds_read_b64_tr_b16 a[92:93], v13 offset:61440
  v_mfma_f32_16x16x32_bf16 v[188:191], a[116:119], v[84:87], v[188:191]
  v_mfma_f32_16x16x32_bf16 v[188:191], a[120:123], v[88:91], v[188:191]
  ds_read_b64_tr_b16 a[94:95], v13 offset:63488
  v_mfma_f32_16x16x32_bf16 v[188:191], a[124:127], v[92:95], v[188:191]
  s_waitcnt lgkmcnt(8)
  v_mfma_f32_16x16x32_bf16 v[128:131], a[64:67], v[32:35], 0
  ds_read_b64_tr_b16 a[96:97], v14 offset:49152
  v_mfma_f32_16x16x32_bf16 v[128:131], a[68:71], v[36:39], v[128:131]
  s_nop 1
  v_mfma_f32_16x16x32_bf16 v[128:131], a[72:75], v[40:43], v[128:131]
  ds_read_b64_tr_b16 a[98:99], v14 offset:51200
  v_mfma_f32_16x16x32_bf16 v[128:131], a[76:79], v[44:47], v[128:131]
  v_cvt_pk_bf16_f32 v112, v160, v161
  v_cvt_pk_bf16_f32 v113, v162, v163
  v_mfma_f32_16x16x32_bf16 v[136:139], a[64:67], v[48:51], 0
  ds_read_b64_tr_b16 a[100:101], v14 offset:53248
  v_mfma_f32_16x16x32_bf16 v[136:139], a[68:71], v[52:55], v[136:139]
  v_cvt_pk_bf16_f32 v114, v164, v165
  v_cvt_pk_bf16_f32 v115, v166, v167
  v_mfma_f32_16x16x32_bf16 v[136:139], a[72:75], v[56:59], v[136:139]
  ds_read_b64_tr_b16 a[102:103], v14 offset:55296
  v_mfma_f32_16x16x32_bf16 v[136:139], a[76:79], v[60:63], v[136:139]
  buffer_store_dwordx4 v[112:115], v2, s[40:43], s76 offen offset:1024 sc1
  v_mfma_f32_16x16x32_bf16 v[144:147], a[64:67], v[64:67], 0
  ds_read_b64_tr_b16 a[104:105], v14 offset:57344
  v_mfma_f32_16x16x32_bf16 v[144:147], a[68:71], v[68:71], v[144:147]
  v_cvt_pk_bf16_f32 v116, v168, v169
  v_cvt_pk_bf16_f32 v117, v170, v171
  v_mfma_f32_16x16x32_bf16 v[144:147], a[72:75], v[72:75], v[144:147]
  ds_read_b64_tr_b16 a[106:107], v14 offset:59392
  v_mfma_f32_16x16x32_bf16 v[144:147], a[76:79], v[76:79], v[144:147]
  v_cvt_pk_bf16_f32 v118, v172, v173
  v_cvt_pk_bf16_f32 v119, v174, v175
  v_mfma_f32_16x16x32_bf16 v[152:155], a[64:67], v[80:83], 0
  ds_read_b64_tr_b16 a[108:109], v14 offset:61440
  v_mfma_f32_16x16x32_bf16 v[152:155], a[68:71], v[84:87], v[152:155]
  buffer_store_dwordx4 v[116:119], v2, s[40:43], s77 offen offset:1024 sc1
  v_mfma_f32_16x16x32_bf16 v[152:155], a[72:75], v[88:91], v[152:155]
  ds_read_b64_tr_b16 a[110:111], v14 offset:63488
  v_mfma_f32_16x16x32_bf16 v[152:155], a[76:79], v[92:95], v[152:155]
  s_waitcnt lgkmcnt(8)
  v_cvt_pk_bf16_f32 v120, v176, v177
  v_cvt_pk_bf16_f32 v121, v178, v179
  v_mfma_f32_16x16x32_bf16 v[132:135], a[80:83], v[32:35], 0
  ds_read_b64_tr_b16 a[112:113], v15 offset:49152
  v_mfma_f32_16x16x32_bf16 v[132:135], a[84:87], v[36:39], v[132:135]
  v_cvt_pk_bf16_f32 v122, v180, v181
  v_cvt_pk_bf16_f32 v123, v182, v183
  v_mfma_f32_16x16x32_bf16 v[132:135], a[88:91], v[40:43], v[132:135]
  ds_read_b64_tr_b16 a[114:115], v15 offset:51200
  v_mfma_f32_16x16x32_bf16 v[132:135], a[92:95], v[44:47], v[132:135]
  buffer_store_dwordx4 v[120:123], v2, s[40:43], s78 offen offset:1024 sc1
  v_mfma_f32_16x16x32_bf16 v[140:143], a[80:83], v[48:51], 0
  ds_read_b64_tr_b16 a[116:117], v15 offset:53248
  v_mfma_f32_16x16x32_bf16 v[140:143], a[84:87], v[52:55], v[140:143]
  v_cvt_pk_bf16_f32 v124, v184, v185
  v_cvt_pk_bf16_f32 v125, v186, v187
  v_mfma_f32_16x16x32_bf16 v[140:143], a[88:91], v[56:59], v[140:143]
  ds_read_b64_tr_b16 a[118:119], v15 offset:55296
  v_mfma_f32_16x16x32_bf16 v[140:143], a[92:95], v[60:63], v[140:143]
  v_cvt_pk_bf16_f32 v126, v188, v189
  v_cvt_pk_bf16_f32 v127, v190, v191
  v_mfma_f32_16x16x32_bf16 v[148:151], a[80:83], v[64:67], 0
  ds_read_b64_tr_b16 a[120:121], v15 offset:57344
  v_mfma_f32_16x16x32_bf16 v[148:151], a[84:87], v[68:71], v[148:151]
  buffer_store_dwordx4 v[124:127], v2, s[40:43], s79 offen offset:1024 sc1
  v_mfma_f32_16x16x32_bf16 v[148:151], a[88:91], v[72:75], v[148:151]
  ds_read_b64_tr_b16 a[122:123], v15 offset:59392
  v_mfma_f32_16x16x32_bf16 v[148:151], a[92:95], v[76:79], v[148:151]
  v_mfma_f32_16x16x32_bf16 v[156:159], a[80:83], v[80:83], 0
  ds_read_b64_tr_b16 a[124:125], v15 offset:61440
  v_mfma_f32_16x16x32_bf16 v[156:159], a[84:87], v[84:87], v[156:159]
  v_mfma_f32_16x16x32_bf16 v[156:159], a[88:91], v[88:91], v[156:159]
  ds_read_b64_tr_b16 a[126:127], v15 offset:63488
  v_mfma_f32_16x16x32_bf16 v[156:159], a[92:95], v[92:95], v[156:159]
  s_waitcnt lgkmcnt(8)
  v_mfma_f32_16x16x32_bf16 v[160:163], a[96:99], v[32:35], 0
  v_mfma_f32_16x16x32_bf16 v[160:163], a[100:103], v[36:39], v[160:163]
  s_nop 1
  v_mfma_f32_16x16x32_bf16 v[160:163], a[104:107], v[40:43], v[160:163]
  v_mfma_f32_16x16x32_bf16 v[160:163], a[108:111], v[44:47], v[160:163]
  v_cvt_pk_bf16_f32 v96, v128, v129
  v_cvt_pk_bf16_f32 v97, v130, v131
  v_mfma_f32_16x16x32_bf16 v[168:171], a[96:99], v[48:51], 0
  v_mfma_f32_16x16x32_bf16 v[168:171], a[100:103], v[52:55], v[168:171]
  v_cvt_pk_bf16_f32 v98, v132, v133
  v_cvt_pk_bf16_f32 v99, v134, v135
  v_mfma_f32_16x16x32_bf16 v[168:171], a[104:107], v[56:59], v[168:171]
  v_mfma_f32_16x16x32_bf16 v[168:171], a[108:111], v[60:63], v[168:171]
  buffer_store_dwordx4 v[96:99], v2, s[40:43], s76 offen offset:2048 sc1
  v_mfma_f32_16x16x32_bf16 v[176:179], a[96:99], v[64:67], 0
  v_mfma_f32_16x16x32_bf16 v[176:179], a[100:103], v[68:71], v[176:179]
  v_cvt_pk_bf16_f32 v100, v136, v137
  v_cvt_pk_bf16_f32 v101, v138, v139
  v_mfma_f32_16x16x32_bf16 v[176:179], a[104:107], v[72:75], v[176:179]
  v_mfma_f32_16x16x32_bf16 v[176:179], a[108:111], v[76:79], v[176:179]
  v_cvt_pk_bf16_f32 v102, v140, v141
  v_cvt_pk_bf16_f32 v103, v142, v143
  v_mfma_f32_16x16x32_bf16 v[184:187], a[96:99], v[80:83], 0
  v_mfma_f32_16x16x32_bf16 v[184:187], a[100:103], v[84:87], v[184:187]
  buffer_store_dwordx4 v[100:103], v2, s[40:43], s77 offen offset:2048 sc1
  v_mfma_f32_16x16x32_bf16 v[184:187], a[104:107], v[88:91], v[184:187]
  v_mfma_f32_16x16x32_bf16 v[184:187], a[108:111], v[92:95], v[184:187]
  s_waitcnt lgkmcnt(0)
  v_cvt_pk_bf16_f32 v104, v144, v145
  v_cvt_pk_bf16_f32 v105, v146, v147
  v_mfma_f32_16x16x32_bf16 v[164:167], a[112:115], v[32:35], 0
  v_mfma_f32_16x16x32_bf16 v[164:167], a[116:119], v[36:39], v[164:167]
  v_cvt_pk_bf16_f32 v106, v148, v149
  v_cvt_pk_bf16_f32 v107, v150, v151
  v_mfma_f32_16x16x32_bf16 v[164:167], a[120:123], v[40:43], v[164:167]
  v_mfma_f32_16x16x32_bf16 v[164:167], a[124:127], v[44:47], v[164:167]
  buffer_store_dwordx4 v[104:107], v2, s[40:43], s78 offen offset:2048 sc1
  v_mfma_f32_16x16x32_bf16 v[172:175], a[112:115], v[48:51], 0
  v_mfma_f32_16x16x32_bf16 v[172:175], a[116:119], v[52:55], v[172:175]
  v_cvt_pk_bf16_f32 v108, v152, v153
  v_cvt_pk_bf16_f32 v109, v154, v155
  v_mfma_f32_16x16x32_bf16 v[172:175], a[120:123], v[56:59], v[172:175]
  v_mfma_f32_16x16x32_bf16 v[172:175], a[124:127], v[60:63], v[172:175]
  v_cvt_pk_bf16_f32 v110, v156, v157
  v_cvt_pk_bf16_f32 v111, v158, v159
  v_mfma_f32_16x16x32_bf16 v[180:183], a[112:115], v[64:67], 0
  v_mfma_f32_16x16x32_bf16 v[180:183], a[116:119], v[68:71], v[180:183]
  buffer_store_dwordx4 v[108:111], v2, s[40:43], s79 offen offset:2048 sc1
  v_mfma_f32_16x16x32_bf16 v[180:183], a[120:123], v[72:75], v[180:183]
  v_mfma_f32_16x16x32_bf16 v[180:183], a[124:127], v[76:79], v[180:183]
  v_mfma_f32_16x16x32_bf16 v[188:191], a[112:115], v[80:83], 0
  v_mfma_f32_16x16x32_bf16 v[188:191], a[116:119], v[84:87], v[188:191]
  v_mfma_f32_16x16x32_bf16 v[188:191], a[120:123], v[88:91], v[188:191]
  v_mfma_f32_16x16x32_bf16 v[188:191], a[124:127], v[92:95], v[188:191]
  s_nop 7
  v_cvt_pk_bf16_f32 v112, v160, v161
  v_cvt_pk_bf16_f32 v113, v162, v163
  v_cvt_pk_bf16_f32 v114, v164, v165
  v_cvt_pk_bf16_f32 v115, v166, v167
  buffer_store_dwordx4 v[112:115], v2, s[40:43], s76 offen offset:3072 sc1
  v_cvt_pk_bf16_f32 v116, v168, v169
  v_cvt_pk_bf16_f32 v117, v170, v171
  v_cvt_pk_bf16_f32 v118, v172, v173
  v_cvt_pk_bf16_f32 v119, v174, v175
  buffer_store_dwordx4 v[116:119], v2, s[40:43], s77 offen offset:3072 sc1
  v_cvt_pk_bf16_f32 v120, v176, v177
  v_cvt_pk_bf16_f32 v121, v178, v179
  v_cvt_pk_bf16_f32 v122, v180, v181
  v_cvt_pk_bf16_f32 v123, v182, v183
  buffer_store_dwordx4 v[120:123], v2, s[40:43], s78 offen offset:3072 sc1
  v_cvt_pk_bf16_f32 v124, v184, v185
  v_cvt_pk_bf16_f32 v125, v186, v187
  v_cvt_pk_bf16_f32 v126, v188, v189
  v_cvt_pk_bf16_f32 v127, v190, v191
  buffer_store_dwordx4 v[124:127], v2, s[40:43], s79 offen offset:3072 sc1
  s_lshl_b32 s66, s57, 7
  s_add_u32 s66, s66, 0xd086000
  s_cmp_eq_u32 s44, 0
  s_cselect_b32 s66, s66, 0x40000000
  v_mov_b32 v6, 1
  s_waitcnt vmcnt(0)
  s_barrier
  s_mov_b64 exec, 1
  buffer_atomic_add v6, v2, s[40:43], s66 offen
  s_mov_b64 exec, -1
  s_branch L_att_end
L_a_s1_t:
  s_mov_b32 s71, 0
  s_nop 6
  s_branch L_a_slow0_0
L_a_s0_t:
  s_mov_b32 s71, 1
  s_nop 6
  s_branch L_a_slow1_0
L_a_d0_t:
  s_mov_b32 s71, 2
  s_nop 6
  s_branch L_a_slow0_0
L_a_d1_t:
  s_mov_b32 s71, 3
  s_nop 6
  s_branch L_a_slow1_0
L_a_d2_t:
  s_mov_b32 s71, 4
  s_nop 6
  s_branch L_a_slow0_1
L_a_d3_t:
  s_mov_b32 s71, 5
  s_nop 6
  s_branch L_a_slow1_1
L_a_d4_t:
  s_mov_b32 s71, 6
  s_nop 6
  s_branch L_a_slow0_2
L_a_d5_t:
  s_mov_b32 s71, 7
  s_nop 6
  s_branch L_a_slow1_2
L_a_d6_t:
  s_mov_b32 s71, 8
  s_nop 6
  s_branch L_a_slow0_3
L_a_d7_t:
  s_mov_b32 s71, 9
  s_nop 6
  s_branch L_a_slow1_3
L_a_slow0_0:
  v_max3_f32 v6, v32, v33, v34
  v_max3_f32 v7, v35, v36, v37
  v_max3_f32 v6, v6, v38, v39
  v_max_f32 v6, v6, v7
  v_mov_b32 v7, v6
  s_nop 1
  v_permlane32_swap_b32 v7, v6
  v_max_f32 v6, v6, v7
  v_mov_b32 v7, v6
  s_nop 1
  v_permlane16_swap_b32 v7, v6
  v_max_f32 v6, v6, v7
  v_add_f32 v6, 0x41800000, v6
  v_max_f32 v6, 0, v6
  v_exp_f32 v7, -v6
  v_sub_f32 v96, v96, v6
  v_sub_f32 v97, v97, v6
  v_sub_f32 v98, v98, v6
  v_sub_f32 v99, v99, v6
  v_sub_f32 v100, v100, v6
  v_sub_f32 v101, v101, v6
  v_sub_f32 v102, v102, v6
  v_sub_f32 v103, v103, v6
  v_mul_f32 v128, v128, v7
  v_mul_f32 v129, v129, v7
  v_mul_f32 v130, v130, v7
  v_mul_f32 v131, v131, v7
  v_mul_f32 v132, v132, v7
  v_mul_f32 v133, v133, v7
  v_mul_f32 v134, v134, v7
  v_mul_f32 v135, v135, v7
  v_mul_f32 v136, v136, v7
  v_mul_f32 v137, v137, v7
  v_mul_f32 v138, v138, v7
  v_mul_f32 v139, v139, v7
  v_mul_f32 v140, v140, v7
  v_mul_f32 v141, v141, v7
  v_mul_f32 v142, v142, v7
  v_mul_f32 v143, v143, v7
  v_mul_f32 v144, v144, v7
  v_mul_f32 v145, v145, v7
  v_mul_f32 v146, v146, v7
  v_mul_f32 v147, v147, v7
  v_mul_f32 v148, v148, v7
  v_mul_f32 v149, v149, v7
  v_mul_f32 v150, v150, v7
  v_mul_f32 v151, v151, v7
  v_mul_f32 v152, v152, v7
  v_mul_f32 v153, v153, v7
  v_mul_f32 v154, v154, v7
  v_mul_f32 v155, v155, v7
  v_mul_f32 v156, v156, v7
  v_mul_f32 v157, v157, v7
  v_mul_f32 v158, v158, v7
  v_mul_f32 v159, v159, v7
  v_accvgpr_read_b32 v8, a128
  v_mul_f32 v8, v8, v7
  v_accvgpr_write_b32 a128, v8
  v_accvgpr_read_b32 v8, a129
  v_mul_f32 v8, v8, v7
  v_accvgpr_write_b32 a129, v8
  v_accvgpr_read_b32 v8, a130
  v_mul_f32 v8, v8, v7
  v_accvgpr_write_b32 a130, v8
  v_accvgpr_read_b32 v8, a131
  v_mul_f32 v8, v8, v7
  v_accvgpr_write_b32 a131, v8
  v_sub_f32 v8, v32, v6
  v_sub_f32 v9, v33, v6
  v_sub_f32 v10, v34, v6
  v_sub_f32 v11, v35, v6
  v_sub_f32 v12, v36, v6
  v_sub_f32 v13, v37, v6
  v_sub_f32 v14, v38, v6
  v_sub_f32 v15, v39, v6
  v_exp_f32 v8, v8
  v_exp_f32 v9, v9
  v_exp_f32 v10, v10
  v_exp_f32 v11, v11
  v_exp_f32 v12, v12
  v_exp_f32 v13, v13
  v_exp_f32 v14, v14
  v_exp_f32 v15, v15
  v_cvt_pk_bf16_f32 v64, v8, v9
  v_cvt_pk_bf16_f32 v65, v10, v11
  v_cvt_pk_bf16_f32 v66, v12, v13
  v_cvt_pk_bf16_f32 v67, v14, v15
L_a_slow0_1:
  v_max3_f32 v6, v40, v41, v42
  v_max3_f32 v7, v43, v44, v45
  v_max3_f32 v6, v6, v46, v47
  v_max_f32 v6, v6, v7
  v_mov_b32 v7, v6
  s_nop 1
  v_permlane32_swap_b32 v7, v6
  v_max_f32 v6, v6, v7
  v_mov_b32 v7, v6
  s_nop 1
  v_permlane16_swap_b32 v7, v6
  v_max_f32 v6, v6, v7
  v_add_f32 v6, 0x41800000, v6
  v_max_f32 v6, 0, v6
  v_exp_f32 v7, -v6
  v_sub_f32 v104, v104, v6
  v_sub_f32 v105, v105, v6
  v_sub_f32 v106, v106, v6
  v_sub_f32 v107, v107, v6
  v_sub_f32 v108, v108, v6
  v_sub_f32 v109, v109, v6
  v_sub_f32 v110, v110, v6
  v_sub_f32 v111, v111, v6
  v_mul_f32 v160, v160, v7
  v_mul_f32 v161, v161, v7
  v_mul_f32 v162, v162, v7
  v_mul_f32 v163, v163, v7
  v_mul_f32 v164, v164, v7
  v_mul_f32 v165, v165, v7
  v_mul_f32 v166, v166, v7
  v_mul_f32 v167, v167, v7
  v_mul_f32 v168, v168, v7
  v_mul_f32 v169, v169, v7
  v_mul_f32 v170, v170, v7
  v_mul_f32 v171, v171, v7
  v_mul_f32 v172, v172, v7
  v_mul_f32 v173, v173, v7
  v_mul_f32 v174, v174, v7
  v_mul_f32 v175, v175, v7
  v_mul_f32 v176, v176, v7
  v_mul_f32 v177, v177, v7
  v_mul_f32 v178, v178, v7
  v_mul_f32 v179, v179, v7
  v_mul_f32 v180, v180, v7
  v_mul_f32 v181, v181, v7
  v_mul_f32 v182, v182, v7
  v_mul_f32 v183, v183, v7
  v_mul_f32 v184, v184, v7
  v_mul_f32 v185, v185, v7
  v_mul_f32 v186, v186, v7
  v_mul_f32 v187, v187, v7
  v_mul_f32 v188, v188, v7
  v_mul_f32 v189, v189, v7
  v_mul_f32 v190, v190, v7
  v_mul_f32 v191, v191, v7
  v_accvgpr_read_b32 v8, a132
  v_mul_f32 v8, v8, v7
  v_accvgpr_write_b32 a132, v8
  v_accvgpr_read_b32 v8, a133
  v_mul_f32 v8, v8, v7
  v_accvgpr_write_b32 a133, v8
  v_accvgpr_read_b32 v8, a134
  v_mul_f32 v8, v8, v7
  v_accvgpr_write_b32 a134, v8
  v_accvgpr_read_b32 v8, a135
  v_mul_f32 v8, v8, v7
  v_accvgpr_write_b32 a135, v8
  v_sub_f32 v8, v40, v6
  v_sub_f32 v9, v41, v6
  v_sub_f32 v10, v42, v6
  v_sub_f32 v11, v43, v6
  v_sub_f32 v12, v44, v6
  v_sub_f32 v13, v45, v6
  v_sub_f32 v14, v46, v6
  v_sub_f32 v15, v47, v6
  v_exp_f32 v8, v8
  v_exp_f32 v9, v9
  v_exp_f32 v10, v10
  v_exp_f32 v11, v11
  v_exp_f32 v12, v12
  v_exp_f32 v13, v13
  v_exp_f32 v14, v14
  v_exp_f32 v15, v15
  v_cvt_pk_bf16_f32 v68, v8, v9
  v_cvt_pk_bf16_f32 v69, v10, v11
  v_cvt_pk_bf16_f32 v70, v12, v13
  v_cvt_pk_bf16_f32 v71, v14, v15
L_a_slow0_2:
  v_max3_f32 v6, v48, v49, v50
  v_max3_f32 v7, v51, v52, v53
  v_max3_f32 v6, v6, v54, v55
  v_max_f32 v6, v6, v7
  v_mov_b32 v7, v6
  s_nop 1
  v_permlane32_swap_b32 v7, v6
  v_max_f32 v6, v6, v7
  v_mov_b32 v7, v6
  s_nop 1
  v_permlane16_swap_b32 v7, v6
  v_max_f32 v6, v6, v7
  v_add_f32 v6, 0x41800000, v6
  v_max_f32 v6, 0, v6
  v_exp_f32 v7, -v6
  v_sub_f32 v112, v112, v6
  v_sub_f32 v113, v113, v6
  v_sub_f32 v114, v114, v6
  v_sub_f32 v115, v115, v6
  v_sub_f32 v116, v116, v6
  v_sub_f32 v117, v117, v6
  v_sub_f32 v118, v118, v6
  v_sub_f32 v119, v119, v6
  v_mul_f32 v192, v192, v7
  v_mul_f32 v193, v193, v7
  v_mul_f32 v194, v194, v7
  v_mul_f32 v195, v195, v7
  v_mul_f32 v196, v196, v7
  v_mul_f32 v197, v197, v7
  v_mul_f32 v198, v198, v7
  v_mul_f32 v199, v199, v7
  v_mul_f32 v200, v200, v7
  v_mul_f32 v201, v201, v7
  v_mul_f32 v202, v202, v7
  v_mul_f32 v203, v203, v7
  v_mul_f32 v204, v204, v7
  v_mul_f32 v205, v205, v7
  v_mul_f32 v206, v206, v7
  v_mul_f32 v207, v207, v7
  v_mul_f32 v208, v208, v7
  v_mul_f32 v209, v209, v7
  v_mul_f32 v210, v210, v7
  v_mul_f32 v211, v211, v7
  v_mul_f32 v212, v212, v7
  v_mul_f32 v213, v213, v7
  v_mul_f32 v214, v214, v7
  v_mul_f32 v215, v215, v7
  v_mul_f32 v216, v216, v7
  v_mul_f32 v217, v217, v7
  v_mul_f32 v218, v218, v7
  v_mul_f32 v219, v219, v7
  v_mul_f32 v220, v220, v7
  v_mul_f32 v221, v221, v7
  v_mul_f32 v222, v222, v7
  v_mul_f32 v223, v223, v7
  v_accvgpr_read_b32 v8, a136
  v_mul_f32 v8, v8, v7
  v_accvgpr_write_b32 a136, v8
  v_accvgpr_read_b32 v8, a137
  v_mul_f32 v8, v8, v7
  v_accvgpr_write_b32 a137, v8
  v_accvgpr_read_b32 v8, a138
  v_mul_f32 v8, v8, v7
  v_accvgpr_write_b32 a138, v8
  v_accvgpr_read_b32 v8, a139
  v_mul_f32 v8, v8, v7
  v_accvgpr_write_b32 a139, v8
  v_sub_f32 v8, v48, v6
  v_sub_f32 v9, v49, v6
  v_sub_f32 v10, v50, v6
  v_sub_f32 v11, v51, v6
  v_sub_f32 v12, v52, v6
  v_sub_f32 v13, v53, v6
  v_sub_f32 v14, v54, v6
  v_sub_f32 v15, v55, v6
  v_exp_f32 v8, v8
  v_exp_f32 v9, v9
  v_exp_f32 v10, v10
  v_exp_f32 v11, v11
  v_exp_f32 v12, v12
  v_exp_f32 v13, v13
  v_exp_f32 v14, v14
  v_exp_f32 v15, v15
  v_cvt_pk_bf16_f32 v72, v8, v9
  v_cvt_pk_bf16_f32 v73, v10, v11
  v_cvt_pk_bf16_f32 v74, v12, v13
  v_cvt_pk_bf16_f32 v75, v14, v15
L_a_slow0_3:
  v_max3_f32 v6, v56, v57, v58
  v_max3_f32 v7, v59, v60, v61
  v_max3_f32 v6, v6, v62, v63
  v_max_f32 v6, v6, v7
  v_mov_b32 v7, v6
  s_nop 1
  v_permlane32_swap_b32 v7, v6
  v_max_f32 v6, v6, v7
  v_mov_b32 v7, v6
  s_nop 1
  v_permlane16_swap_b32 v7, v6
  v_max_f32 v6, v6, v7
  v_add_f32 v6, 0x41800000, v6
  v_max_f32 v6, 0, v6
  v_exp_f32 v7, -v6
  v_sub_f32 v120, v120, v6
  v_sub_f32 v121, v121, v6
  v_sub_f32 v122, v122, v6
  v_sub_f32 v123, v123, v6
  v_sub_f32 v124, v124, v6
  v_sub_f32 v125, v125, v6
  v_sub_f32 v126, v126, v6
  v_sub_f32 v127, v127, v6
  v_mul_f32 v224, v224, v7
  v_mul_f32 v225, v225, v7
  v_mul_f32 v226, v226, v7
  v_mul_f32 v227, v227, v7
  v_mul_f32 v228, v228, v7
  v_mul_f32 v229, v229, v7
  v_mul_f32 v230, v230, v7
  v_mul_f32 v231, v231, v7
  v_mul_f32 v232, v232, v7
  v_mul_f32 v233, v233, v7
  v_mul_f32 v234, v234, v7
  v_mul_f32 v235, v235, v7
  v_mul_f32 v236, v236, v7
  v_mul_f32 v237, v237, v7
  v_mul_f32 v238, v238, v7
  v_mul_f32 v239, v239, v7
  v_mul_f32 v240, v240, v7
  v_mul_f32 v241, v241, v7
  v_mul_f32 v242, v242, v7
  v_mul_f32 v243, v243, v7
  v_mul_f32 v244, v244, v7
  v_mul_f32 v245, v245, v7
  v_mul_f32 v246, v246, v7
  v_mul_f32 v247, v247, v7
  v_mul_f32 v248, v248, v7
  v_mul_f32 v249, v249, v7
  v_mul_f32 v250, v250, v7
  v_mul_f32 v251, v251, v7
  v_mul_f32 v252, v252, v7
  v_mul_f32 v253, v253, v7
  v_mul_f32 v254, v254, v7
  v_mul_f32 v255, v255, v7
  v_accvgpr_read_b32 v8, a140
  v_mul_f32 v8, v8, v7
  v_accvgpr_write_b32 a140, v8
  v_accvgpr_read_b32 v8, a141
  v_mul_f32 v8, v8, v7
  v_accvgpr_write_b32 a141, v8
  v_accvgpr_read_b32 v8, a142
  v_mul_f32 v8, v8, v7
  v_accvgpr_write_b32 a142, v8
  v_accvgpr_read_b32 v8, a143
  v_mul_f32 v8, v8, v7
  v_accvgpr_write_b32 a143, v8
  v_sub_f32 v8, v56, v6
  v_sub_f32 v9, v57, v6
  v_sub_f32 v10, v58, v6
  v_sub_f32 v11, v59, v6
  v_sub_f32 v12, v60, v6
  v_sub_f32 v13, v61, v6
  v_sub_f32 v14, v62, v6
  v_sub_f32 v15, v63, v6
  v_exp_f32 v8, v8
  v_exp_f32 v9, v9
  v_exp_f32 v10, v10
  v_exp_f32 v11, v11
  v_exp_f32 v12, v12
  v_exp_f32 v13, v13
  v_exp_f32 v14, v14
  v_exp_f32 v15, v15
  v_cvt_pk_bf16_f32 v76, v8, v9
  v_cvt_pk_bf16_f32 v77, v10, v11
  v_cvt_pk_bf16_f32 v78, v12, v13
  v_cvt_pk_bf16_f32 v79, v14, v15
  s_cmp_eq_u32 s71, 0
  s_cbranch_scc1 L_a_s1_r
  s_cmp_eq_u32 s71, 2
  s_cbranch_scc1 L_a_d0_r
  s_cmp_eq_u32 s71, 4
  s_cbranch_scc1 L_a_d2_r
  s_cmp_eq_u32 s71, 6
  s_cbranch_scc1 L_a_d4_r
  s_branch L_a_d6_r
L_a_slow1_0:
  v_max3_f32 v6, v32, v33, v34
  v_max3_f32 v7, v35, v36, v37
  v_max3_f32 v6, v6, v38, v39
  v_max_f32 v6, v6, v7
  v_mov_b32 v7, v6
  s_nop 1
  v_permlane32_swap_b32 v7, v6
  v_max_f32 v6, v6, v7
  v_mov_b32 v7, v6
  s_nop 1
  v_permlane16_swap_b32 v7, v6
  v_max_f32 v6, v6, v7
  v_add_f32 v6, 0x41800000, v6
  v_max_f32 v6, 0, v6
  v_exp_f32 v7, -v6
  v_sub_f32 v96, v96, v6
  v_sub_f32 v97, v97, v6
  v_sub_f32 v98, v98, v6
  v_sub_f32 v99, v99, v6
  v_sub_f32 v100, v100, v6
  v_sub_f32 v101, v101, v6
  v_sub_f32 v102, v102, v6
  v_sub_f32 v103, v103, v6
  v_mul_f32 v128, v128, v7
  v_mul_f32 v129, v129, v7
  v_mul_f32 v130, v130, v7
  v_mul_f32 v131, v131, v7
  v_mul_f32 v132, v132, v7
  v_mul_f32 v133, v133, v7
  v_mul_f32 v134, v134, v7
  v_mul_f32 v135, v135, v7
  v_mul_f32 v136, v136, v7
  v_mul_f32 v137, v137, v7
  v_mul_f32 v138, v138, v7
  v_mul_f32 v139, v139, v7
  v_mul_f32 v140, v140, v7
  v_mul_f32 v141, v141, v7
  v_mul_f32 v142, v142, v7
  v_mul_f32 v143, v143, v7
  v_mul_f32 v144, v144, v7
  v_mul_f32 v145, v145, v7
  v_mul_f32 v146, v146, v7
  v_mul_f32 v147, v147, v7
  v_mul_f32 v148, v148, v7
  v_mul_f32 v149, v149, v7
  v_mul_f32 v150, v150, v7
  v_mul_f32 v151, v151, v7
  v_mul_f32 v152, v152, v7
  v_mul_f32 v153, v153, v7
  v_mul_f32 v154, v154, v7
  v_mul_f32 v155, v155, v7
  v_mul_f32 v156, v156, v7
  v_mul_f32 v157, v157, v7
  v_mul_f32 v158, v158, v7
  v_mul_f32 v159, v159, v7
  v_accvgpr_read_b32 v8, a128
  v_mul_f32 v8, v8, v7
  v_accvgpr_write_b32 a128, v8
  v_accvgpr_read_b32 v8, a129
  v_mul_f32 v8, v8, v7
  v_accvgpr_write_b32 a129, v8
  v_accvgpr_read_b32 v8, a130
  v_mul_f32 v8, v8, v7
  v_accvgpr_write_b32 a130, v8
  v_accvgpr_read_b32 v8, a131
  v_mul_f32 v8, v8, v7
  v_accvgpr_write_b32 a131, v8
  v_sub_f32 v8, v32, v6
  v_sub_f32 v9, v33, v6
  v_sub_f32 v10, v34, v6
  v_sub_f32 v11, v35, v6
  v_sub_f32 v12, v36, v6
  v_sub_f32 v13, v37, v6
  v_sub_f32 v14, v38, v6
  v_sub_f32 v15, v39, v6
  v_exp_f32 v8, v8
  v_exp_f32 v9, v9
  v_exp_f32 v10, v10
  v_exp_f32 v11, v11
  v_exp_f32 v12, v12
  v_exp_f32 v13, v13
  v_exp_f32 v14, v14
  v_exp_f32 v15, v15
  v_cvt_pk_bf16_f32 v80, v8, v9
  v_cvt_pk_bf16_f32 v81, v10, v11
  v_cvt_pk_bf16_f32 v82, v12, v13
  v_cvt_pk_bf16_f32 v83, v14, v15
L_a_slow1_1:
  v_max3_f32 v6, v40, v41, v42
  v_max3_f32 v7, v43, v44, v45
  v_max3_f32 v6, v6, v46, v47
  v_max_f32 v6, v6, v7
  v_mov_b32 v7, v6
  s_nop 1
  v_permlane32_swap_b32 v7, v6
  v_max_f32 v6, v6, v7
  v_mov_b32 v7, v6
  s_nop 1
  v_permlane16_swap_b32 v7, v6
  v_max_f32 v6, v6, v7
  v_add_f32 v6, 0x41800000, v6
  v_max_f32 v6, 0, v6
  v_exp_f32 v7, -v6
  v_sub_f32 v104, v104, v6
  v_sub_f32 v105, v105, v6
  v_sub_f32 v106, v106, v6
  v_sub_f32 v107, v107, v6
  v_sub_f32 v108, v108, v6
  v_sub_f32 v109, v109, v6
  v_sub_f32 v110, v110, v6
  v_sub_f32 v111, v111, v6
  v_mul_f32 v160, v160, v7
  v_mul_f32 v161, v161, v7
  v_mul_f32 v162, v162, v7
  v_mul_f32 v163, v163, v7
  v_mul_f32 v164, v164, v7
  v_mul_f32 v165, v165, v7
  v_mul_f32 v166, v166, v7
  v_mul_f32 v167, v167, v7
  v_mul_f32 v168, v168, v7
  v_mul_f32 v169, v169, v7
  v_mul_f32 v170, v170, v7
  v_mul_f32 v171, v171, v7
  v_mul_f32 v172, v172, v7
  v_mul_f32 v173, v173, v7
  v_mul_f32 v174, v174, v7
  v_mul_f32 v175, v175, v7
  v_mul_f32 v176, v176, v7
  v_mul_f32 v177, v177, v7
  v_mul_f32 v178, v178, v7
  v_mul_f32 v179, v179, v7
  v_mul_f32 v180, v180, v7
  v_mul_f32 v181, v181, v7
  v_mul_f32 v182, v182, v7
  v_mul_f32 v183, v183, v7
  v_mul_f32 v184, v184, v7
  v_mul_f32 v185, v185, v7
  v_mul_f32 v186, v186, v7
  v_mul_f32 v187, v187, v7
  v_mul_f32 v188, v188, v7
  v_mul_f32 v189, v189, v7
  v_mul_f32 v190, v190, v7
  v_mul_f32 v191, v191, v7
  v_accvgpr_read_b32 v8, a132
  v_mul_f32 v8, v8, v7
  v_accvgpr_write_b32 a132, v8
  v_accvgpr_read_b32 v8, a133
  v_mul_f32 v8, v8, v7
  v_accvgpr_write_b32 a133, v8
  v_accvgpr_read_b32 v8, a134
  v_mul_f32 v8, v8, v7
  v_accvgpr_write_b32 a134, v8
  v_accvgpr_read_b32 v8, a135
  v_mul_f32 v8, v8, v7
  v_accvgpr_write_b32 a135, v8
  v_sub_f32 v8, v40, v6
  v_sub_f32 v9, v41, v6
  v_sub_f32 v10, v42, v6
  v_sub_f32 v11, v43, v6
  v_sub_f32 v12, v44, v6
  v_sub_f32 v13, v45, v6
  v_sub_f32 v14, v46, v6
  v_sub_f32 v15, v47, v6
  v_exp_f32 v8, v8
  v_exp_f32 v9, v9
  v_exp_f32 v10, v10
  v_exp_f32 v11, v11
  v_exp_f32 v12, v12
  v_exp_f32 v13, v13
  v_exp_f32 v14, v14
  v_exp_f32 v15, v15
  v_cvt_pk_bf16_f32 v84, v8, v9
  v_cvt_pk_bf16_f32 v85, v10, v11
  v_cvt_pk_bf16_f32 v86, v12, v13
  v_cvt_pk_bf16_f32 v87, v14, v15
L_a_slow1_2:
  v_max3_f32 v6, v48, v49, v50
  v_max3_f32 v7, v51, v52, v53
  v_max3_f32 v6, v6, v54, v55
  v_max_f32 v6, v6, v7
  v_mov_b32 v7, v6
  s_nop 1
  v_permlane32_swap_b32 v7, v6
  v_max_f32 v6, v6, v7
  v_mov_b32 v7, v6
  s_nop 1
  v_permlane16_swap_b32 v7, v6
  v_max_f32 v6, v6, v7
  v_add_f32 v6, 0x41800000, v6
  v_max_f32 v6, 0, v6
  v_exp_f32 v7, -v6
  v_sub_f32 v112, v112, v6
  v_sub_f32 v113, v113, v6
  v_sub_f32 v114, v114, v6
  v_sub_f32 v115, v115, v6
  v_sub_f32 v116, v116, v6
  v_sub_f32 v117, v117, v6
  v_sub_f32 v118, v118, v6
  v_sub_f32 v119, v119, v6
  v_mul_f32 v192, v192, v7
  v_mul_f32 v193, v193, v7
  v_mul_f32 v194, v194, v7
  v_mul_f32 v195, v195, v7
  v_mul_f32 v196, v196, v7
  v_mul_f32 v197, v197, v7
  v_mul_f32 v198, v198, v7
  v_mul_f32 v199, v199, v7
  v_mul_f32 v200, v200, v7
  v_mul_f32 v201, v201, v7
  v_mul_f32 v202, v202, v7
  v_mul_f32 v203, v203, v7
  v_mul_f32 v204, v204, v7
  v_mul_f32 v205, v205, v7
  v_mul_f32 v206, v206, v7
  v_mul_f32 v207, v207, v7
  v_mul_f32 v208, v208, v7
  v_mul_f32 v209, v209, v7
  v_mul_f32 v210, v210, v7
  v_mul_f32 v211, v211, v7
  v_mul_f32 v212, v212, v7
  v_mul_f32 v213, v213, v7
  v_mul_f32 v214, v214, v7
  v_mul_f32 v215, v215, v7
  v_mul_f32 v216, v216, v7
  v_mul_f32 v217, v217, v7
  v_mul_f32 v218, v218, v7
  v_mul_f32 v219, v219, v7
  v_mul_f32 v220, v220, v7
  v_mul_f32 v221, v221, v7
  v_mul_f32 v222, v222, v7
  v_mul_f32 v223, v223, v7
  v_accvgpr_read_b32 v8, a136
  v_mul_f32 v8, v8, v7
  v_accvgpr_write_b32 a136, v8
  v_accvgpr_read_b32 v8, a137
  v_mul_f32 v8, v8, v7
  v_accvgpr_write_b32 a137, v8
  v_accvgpr_read_b32 v8, a138
  v_mul_f32 v8, v8, v7
  v_accvgpr_write_b32 a138, v8
  v_accvgpr_read_b32 v8, a139
  v_mul_f32 v8, v8, v7
  v_accvgpr_write_b32 a139, v8
  v_sub_f32 v8, v48, v6
  v_sub_f32 v9, v49, v6
  v_sub_f32 v10, v50, v6
  v_sub_f32 v11, v51, v6
  v_sub_f32 v12, v52, v6
  v_sub_f32 v13, v53, v6
  v_sub_f32 v14, v54, v6
  v_sub_f32 v15, v55, v6
  v_exp_f32 v8, v8
  v_exp_f32 v9, v9
  v_exp_f32 v10, v10
  v_exp_f32 v11, v11
  v_exp_f32 v12, v12
  v_exp_f32 v13, v13
  v_exp_f32 v14, v14
  v_exp_f32 v15, v15
  v_cvt_pk_bf16_f32 v88, v8, v9
  v_cvt_pk_bf16_f32 v89, v10, v11
  v_cvt_pk_bf16_f32 v90, v12, v13
  v_cvt_pk_bf16_f32 v91, v14, v15
L_a_slow1_3:
  v_max3_f32 v6, v56, v57, v58
  v_max3_f32 v7, v59, v60, v61
  v_max3_f32 v6, v6, v62, v63
  v_max_f32 v6, v6, v7
  v_mov_b32 v7, v6
  s_nop 1
  v_permlane32_swap_b32 v7, v6
  v_max_f32 v6, v6, v7
  v_mov_b32 v7, v6
  s_nop 1
  v_permlane16_swap_b32 v7, v6
  v_max_f32 v6, v6, v7
  v_add_f32 v6, 0x41800000, v6
  v_max_f32 v6, 0, v6
  v_exp_f32 v7, -v6
  v_sub_f32 v120, v120, v6
  v_sub_f32 v121, v121, v6
  v_sub_f32 v122, v122, v6
  v_sub_f32 v123, v123, v6
  v_sub_f32 v124, v124, v6
  v_sub_f32 v125, v125, v6
  v_sub_f32 v126, v126, v6
  v_sub_f32 v127, v127, v6
  v_mul_f32 v224, v224, v7
  v_mul_f32 v225, v225, v7
  v_mul_f32 v226, v226, v7
  v_mul_f32 v227, v227, v7
  v_mul_f32 v228, v228, v7
  v_mul_f32 v229, v229, v7
  v_mul_f32 v230, v230, v7
  v_mul_f32 v231, v231, v7
  v_mul_f32 v232, v232, v7
  v_mul_f32 v233, v233, v7
  v_mul_f32 v234, v234, v7
  v_mul_f32 v235, v235, v7
  v_mul_f32 v236, v236, v7
  v_mul_f32 v237, v237, v7
  v_mul_f32 v238, v238, v7
  v_mul_f32 v239, v239, v7
  v_mul_f32 v240, v240, v7
  v_mul_f32 v241, v241, v7
  v_mul_f32 v242, v242, v7
  v_mul_f32 v243, v243, v7
  v_mul_f32 v244, v244, v7
  v_mul_f32 v245, v245, v7
  v_mul_f32 v246, v246, v7
  v_mul_f32 v247, v247, v7
  v_mul_f32 v248, v248, v7
  v_mul_f32 v249, v249, v7
  v_mul_f32 v250, v250, v7
  v_mul_f32 v251, v251, v7
  v_mul_f32 v252, v252, v7
  v_mul_f32 v253, v253, v7
  v_mul_f32 v254, v254, v7
  v_mul_f32 v255, v255, v7
  v_accvgpr_read_b32 v8, a140
  v_mul_f32 v8, v8, v7
  v_accvgpr_write_b32 a140, v8
  v_accvgpr_read_b32 v8, a141
  v_mul_f32 v8, v8, v7
  v_accvgpr_write_b32 a141, v8
  v_accvgpr_read_b32 v8, a142
  v_mul_f32 v8, v8, v7
  v_accvgpr_write_b32 a142, v8
  v_accvgpr_read_b32 v8, a143
  v_mul_f32 v8, v8, v7
  v_accvgpr_write_b32 a143, v8
  v_sub_f32 v8, v56, v6
  v_sub_f32 v9, v57, v6
  v_sub_f32 v10, v58, v6
  v_sub_f32 v11, v59, v6
  v_sub_f32 v12, v60, v6
  v_sub_f32 v13, v61, v6
  v_sub_f32 v14, v62, v6
  v_sub_f32 v15, v63, v6
  v_exp_f32 v8, v8
  v_exp_f32 v9, v9
  v_exp_f32 v10, v10
  v_exp_f32 v11, v11
  v_exp_f32 v12, v12
  v_exp_f32 v13, v13
  v_exp_f32 v14, v14
  v_exp_f32 v15, v15
  v_cvt_pk_bf16_f32 v92, v8, v9
  v_cvt_pk_bf16_f32 v93, v10, v11
  v_cvt_pk_bf16_f32 v94, v12, v13
  v_cvt_pk_bf16_f32 v95, v14, v15
  s_cmp_eq_u32 s71, 1
  s_cbranch_scc1 L_a_s0_r
  s_cmp_eq_u32 s71, 3
  s_cbranch_scc1 L_a_d1_r
  s_cmp_eq_u32 s71, 5
  s_cbranch_scc1 L_a_d3_r
  s_cmp_eq_u32 s71, 7
  s_cbranch_scc1 L_a_d5_r
  s_branch L_a_d7_r
L_att_end:
  s_branch L_next
L_go_outx:
  s_bfe_u32 s56, s3, 0x40004
  s_bfe_u32 s62, s3, 0x10004
  s_bitcmp1_b32 s3, 3
  s_cbranch_scc1 L_red
L_barr:
  s_mov_b32 s48, s30
  s_and_b32 s49, s31, 0xffff
  s_mov_b32 s50, 0x400000
  s_mov_b32 s51, 0x20000
  v_lshlrev_b32 v2, 4, v0
  v_mov_b32 v7, 0
  s_mov_b32 s57, 0
  v_lshrrev_b32 v3, 4, v0
  v_and_b32 v4, 15, v0
  v_lshlrev_b32 v5, 1, v3
  v_xor_b32 v5, v5, v4
  v_lshlrev_b32 v5, 4, v5
  v_lshl_add_u32 v88, v3, 10, v5
  v_xor_b32 v89, 128, v88
  s_lshl_b32 s66, s44, 15
  s_lshl_b32 s60, s56, 18
  s_lshl_b32 s58, s44, 8
  s_add_u32 s60, s60, s58
  s_add_u32 m0, s66, 0
  s_add_u32 s58, s60, 0
  buffer_load_dwordx4 v88, s[48:51], s58 offen lds
  s_add_u32 m0, s66, 1024
  s_add_u32 s58, s60, 4096
  buffer_load_dwordx4 v89, s[48:51], s58 offen lds
  s_add_u32 m0, s66, 2048
  s_add_u32 s58, s60, 8192
  buffer_load_dwordx4 v88, s[48:51], s58 offen lds
  s_add_u32 m0, s66, 3072
  s_add_u32 s58, s60, 12288
  buffer_load_dwordx4 v89, s[48:51], s58 offen lds
  s_add_u32 m0, s66, 4096
  s_add_u32 s58, s60, 16384
  buffer_load_dwordx4 v88, s[48:51], s58 offen lds
  s_add_u32 m0, s66, 5120
  s_add_u32 s58, s60, 20480
  buffer_load_dwordx4 v89, s[48:51], s58 offen lds
  s_add_u32 m0, s66, 6144
  s_add_u32 s58, s60, 24576
  buffer_load_dwordx4 v88, s[48:51], s58 offen lds
  s_add_u32 m0, s66, 7168
  s_add_u32 s58, s60, 28672
  buffer_load_dwordx4 v89, s[48:51], s58 offen lds
  s_add_u32 m0, s66, 8192
  s_add_u32 s58, s60, 32768
  buffer_load_dwordx4 v88, s[48:51], s58 offen lds
  s_add_u32 m0, s66, 9216
  s_add_u32 s58, s60, 36864
  buffer_load_dwordx4 v89, s[48:51], s58 offen lds
  s_add_u32 m0, s66, 10240
  s_add_u32 s58, s60, 40960
  buffer_load_dwordx4 v88, s[48:51], s58 offen lds
  s_add_u32 m0, s66, 11264
  s_add_u32 s58, s60, 45056
  buffer_load_dwordx4 v89, s[48:51], s58 offen lds
  s_add_u32 m0, s66, 12288
  s_add_u32 s58, s60, 49152
  buffer_load_dwordx4 v88, s[48:51], s58 offen lds
  s_add_u32 m0, s66, 13312
  s_add_u32 s58, s60, 53248
  buffer_load_dwordx4 v89, s[48:51], s58 offen lds
  s_add_u32 m0, s66, 14336
  s_add_u32 s58, s60, 57344
  buffer_load_dwordx4 v88, s[48:51], s58 offen lds
  s_add_u32 m0, s66, 15360
  s_add_u32 s58, s60, 61440
  buffer_load_dwordx4 v89, s[48:51], s58 offen lds
  s_add_u32 m0, s66, 16384
  s_add_u32 s58, s60, 65536
  buffer_load_dwordx4 v88, s[48:51], s58 offen lds
  s_add_u32 m0, s66, 17408
  s_add_u32 s58, s60, 69632
  buffer_load_dwordx4 v89, s[48:51], s58 offen lds
  s_add_u32 m0, s66, 18432
  s_add_u32 s58, s60, 73728
  buffer_load_dwordx4 v88, s[48:51], s58 offen lds
  s_add_u32 m0, s66, 19456
  s_add_u32 s58, s60, 77824
  buffer_load_dwordx4 v89, s[48:51], s58 offen lds
  s_add_u32 m0, s66, 20480
  s_add_u32 s58, s60, 81920
  buffer_load_dwordx4 v88, s[48:51], s58 offen lds
  s_add_u32 m0, s66, 21504
  s_add_u32 s58, s60, 86016
  buffer_load_dwordx4 v89, s[48:51], s58 offen lds
  s_add_u32 m0, s66, 22528
  s_add_u32 s58, s60, 90112
  buffer_load_dwordx4 v88, s[48:51], s58 offen lds
  s_add_u32 m0, s66, 23552
  s_add_u32 s58, s60, 94208
  buffer_load_dwordx4 v89, s[48:51], s58 offen lds
  s_add_u32 m0, s66, 24576
  s_add_u32 s58, s60, 98304
  buffer_load_dwordx4 v88, s[48:51], s58 offen lds
  s_add_u32 m0, s66, 25600
  s_add_u32 s58, s60, 102400
  buffer_load_dwordx4 v89, s[48:51], s58 offen lds
  s_add_u32 m0, s66, 26624
  s_add_u32 s58, s60, 106496
  buffer_load_dwordx4 v88, s[48:51], s58 offen lds
  s_add_u32 m0, s66, 27648
  s_add_u32 s58, s60, 110592
  buffer_load_dwordx4 v89, s[48:51], s58 offen lds
  s_add_u32 m0, s66, 28672
  s_add_u32 s58, s60, 114688
  buffer_load_dwordx4 v88, s[48:51], s58 offen lds
  s_add_u32 m0, s66, 29696
  s_add_u32 s58, s60, 118784
  buffer_load_dwordx4 v89, s[48:51], s58 offen lds
  s_add_u32 m0, s66, 30720
  s_add_u32 s58, s60, 122880
  buffer_load_dwordx4 v88, s[48:51], s58 offen lds
  s_add_u32 m0, s66, 31744
  s_add_u32 s58, s60, 126976
  buffer_load_dwordx4 v89, s[48:51], s58 offen lds
  v_lshrrev_b32 v5, 2, v0
  v_lshl_add_u32 v104, v5, 8, s66
  v_and_b32 v5, 7, v5
  v_lshl_add_u32 v104, v5, 5, v104
  v_and_b32 v5, 3, v0
  v_lshl_add_u32 v104, v5, 3, v104
  v_xor_b32 v105, 32, v104
  v_xor_b32 v106, 64, v104
  v_xor_b32 v107, 96, v104
  v_xor_b32 v108, 128, v104
  v_xor_b32 v109, 160, v104
  v_xor_b32 v110, 192, v104
  v_xor_b32 v111, 224, v104
  s_waitcnt vmcnt(24)
  ds_read_b64_tr_b16 a[0:1], v104 offset:0
  ds_read_b64_tr_b16 a[2:3], v104 offset:4096
  ds_read_b64_tr_b16 a[32:33], v105 offset:0
  ds_read_b64_tr_b16 a[34:35], v105 offset:4096
  ds_read_b64_tr_b16 a[64:65], v106 offset:0
  ds_read_b64_tr_b16 a[66:67], v106 offset:4096
  ds_read_b64_tr_b16 a[96:97], v107 offset:0
  ds_read_b64_tr_b16 a[98:99], v107 offset:4096
  ds_read_b64_tr_b16 a[128:129], v108 offset:0
  ds_read_b64_tr_b16 a[130:131], v108 offset:4096
  ds_read_b64_tr_b16 a[160:161], v109 offset:0
  ds_read_b64_tr_b16 a[162:163], v109 offset:4096
  ds_read_b64_tr_b16 a[192:193], v110 offset:0
  ds_read_b64_tr_b16 a[194:195], v110 offset:4096
  ds_read_b64_tr_b16 a[224:225], v111 offset:0
  ds_read_b64_tr_b16 a[226:227], v111 offset:4096
  s_waitcnt vmcnt(16)
  ds_read_b64_tr_b16 a[4:5], v104 offset:8192
  ds_read_b64_tr_b16 a[6:7], v104 offset:12288
  ds_read_b64_tr_b16 a[36:37], v105 offset:8192
  ds_read_b64_tr_b16 a[38:39], v105 offset:12288
  ds_read_b64_tr_b16 a[68:69], v106 offset:8192
  ds_read_b64_tr_b16 a[70:71], v106 offset:12288
  ds_read_b64_tr_b16 a[100:101], v107 offset:8192
  ds_read_b64_tr_b16 a[102:103], v107 offset:12288
  ds_read_b64_tr_b16 a[132:133], v108 offset:8192
  ds_read_b64_tr_b16 a[134:135], v108 offset:12288
  ds_read_b64_tr_b16 a[164:165], v109 offset:8192
  ds_read_b64_tr_b16 a[166:167], v109 offset:12288
  ds_read_b64_tr_b16 a[196:197], v110 offset:8192
  ds_read_b64_tr_b16 a[198:199], v110 offset:12288
  ds_read_b64_tr_b16 a[228:229], v111 offset:8192
  ds_read_b64_tr_b16 a[230:231], v111 offset:12288
  s_waitcnt vmcnt(8)
  ds_read_b64_tr_b16 a[8:9], v104 offset:16384
  ds_read_b64_tr_b16 a[10:11], v104 offset:20480
  ds_read_b64_tr_b16 a[40:41], v105 offset:16384
  ds_read_b64_tr_b16 a[42:43], v105 offset:20480
  ds_read_b64_tr_b16 a[72:73], v106 offset:16384
  ds_read_b64_tr_b16 a[74:75], v106 offset:20480
  ds_read_b64_tr_b16 a[104:105], v107 offset:16384
  ds_read_b64_tr_b16 a[106:107], v107 offset:20480
  ds_read_b64_tr_b16 a[136:137], v108 offset:16384
  ds_read_b64_tr_b16 a[138:139], v108 offset:20480
  ds_read_b64_tr_b16 a[168:169], v109 offset:16384
  ds_read_b64_tr_b16 a[170:171], v109 offset:20480
  ds_read_b64_tr_b16 a[200:201], v110 offset:16384
  ds_read_b64_tr_b16 a[202:203], v110 offset:20480
  ds_read_b64_tr_b16 a[232:233], v111 offset:16384
  ds_read_b64_tr_b16 a[234:235], v111 offset:20480
  s_waitcnt vmcnt(0)
  ds_read_b64_tr_b16 a[12:13], v104 offset:24576
  ds_read_b64_tr_b16 a[14:15], v104 offset:28672
  ds_read_b64_tr_b16 a[44:45], v105 offset:24576
  ds_read_b64_tr_b16 a[46:47], v105 offset:28672
  ds_read_b64_tr_b16 a[76:77], v106 offset:24576
  ds_read_b64_tr_b16 a[78:79], v106 offset:28672
  ds_read_b64_tr_b16 a[108:109], v107 offset:24576
  ds_read_b64_tr_b16 a[110:111], v107 offset:28672
  ds_read_b64_tr_b16 a[140:141], v108 offset:24576
  ds_read_b64_tr_b16 a[142:143], v108 offset:28672
  ds_read_b64_tr_b16 a[172:173], v109 offset:24576
  ds_read_b64_tr_b16 a[174:175], v109 offset:28672
  ds_read_b64_tr_b16 a[204:205], v110 offset:24576
  ds_read_b64_tr_b16 a[206:207], v110 offset:28672
  ds_read_b64_tr_b16 a[236:237], v111 offset:24576
  ds_read_b64_tr_b16 a[238:239], v111 offset:28672
  s_waitcnt lgkmcnt(0)
  s_add_u32 m0, s66, 0
  s_add_u32 s58, s60, 131072
  buffer_load_dwordx4 v88, s[48:51], s58 offen lds
  s_add_u32 m0, s66, 1024
  s_add_u32 s58, s60, 135168
  buffer_load_dwordx4 v89, s[48:51], s58 offen lds
  s_add_u32 m0, s66, 2048
  s_add_u32 s58, s60, 139264
  buffer_load_dwordx4 v88, s[48:51], s58 offen lds
  s_add_u32 m0, s66, 3072
  s_add_u32 s58, s60, 143360
  buffer_load_dwordx4 v89, s[48:51], s58 offen lds
  s_add_u32 m0, s66, 4096
  s_add_u32 s58, s60, 147456
  buffer_load_dwordx4 v88, s[48:51], s58 offen lds
  s_add_u32 m0, s66, 5120
  s_add_u32 s58, s60, 151552
  buffer_load_dwordx4 v89, s[48:51], s58 offen lds
  s_add_u32 m0, s66, 6144
  s_add_u32 s58, s60, 155648
  buffer_load_dwordx4 v88, s[48:51], s58 offen lds
  s_add_u32 m0, s66, 7168
  s_add_u32 s58, s60, 159744
  buffer_load_dwordx4 v89, s[48:51], s58 offen lds
  s_add_u32 m0, s66, 8192
  s_add_u32 s58, s60, 163840
  buffer_load_dwordx4 v88, s[48:51], s58 offen lds
  s_add_u32 m0, s66, 9216
  s_add_u32 s58, s60, 167936
  buffer_load_dwordx4 v89, s[48:51], s58 offen lds
  s_add_u32 m0, s66, 10240
  s_add_u32 s58, s60, 172032
  buffer_load_dwordx4 v88, s[48:51], s58 offen lds
  s_add_u32 m0, s66, 11264
  s_add_u32 s58, s60, 176128
  buffer_load_dwordx4 v89, s[48:51], s58 offen lds
  s_add_u32 m0, s66, 12288
  s_add_u32 s58, s60, 180224
  buffer_load_dwordx4 v88, s[48:51], s58 offen lds
  s_add_u32 m0, s66, 13312
  s_add_u32 s58, s60, 184320
  buffer_load_dwordx4 v89, s[48:51], s58 offen lds
  s_add_u32 m0, s66, 14336
  s_add_u32 s58, s60, 188416
  buffer_load_dwordx4 v88, s[48:51], s58 offen lds
  s_add_u32 m0, s66, 15360
  s_add_u32 s58, s60, 192512
  buffer_load_dwordx4 v89, s[48:51], s58 offen lds
  s_add_u32 m0, s66, 16384
  s_add_u32 s58, s60, 196608
  buffer_load_dwordx4 v88, s[48:51], s58 offen lds
  s_add_u32 m0, s66, 17408
  s_add_u32 s58, s60, 200704
  buffer_load_dwordx4 v89, s[48:51], s58 offen lds
  s_add_u32 m0, s66, 18432
  s_add_u32 s58, s60, 204800
  buffer_load_dwordx4 v88, s[48:51], s58 offen lds
  s_add_u32 m0, s66, 19456
  s_add_u32 s58, s60, 208896
  buffer_load_dwordx4 v89, s[48:51], s58 offen lds
  s_add_u32 m0, s66, 20480
  s_add_u32 s58, s60, 212992
  buffer_load_dwordx4 v88, s[48:51], s58 offen lds
  s_add_u32 m0, s66, 21504
  s_add_u32 s58, s60, 217088
  buffer_load_dwordx4 v89, s[48:51], s58 offen lds
  s_add_u32 m0, s66, 22528
  s_add_u32 s58, s60, 221184
  buffer_load_dwordx4 v88, s[48:51], s58 offen lds
  s_add_u32 m0, s66, 23552
  s_add_u32 s58, s60, 225280
  buffer_load_dwordx4 v89, s[48:51], s58 offen lds
  s_add_u32 m0, s66, 24576
  s_add_u32 s58, s60, 229376
  buffer_load_dwordx4 v88, s[48:51], s58 offen lds
  s_add_u32 m0, s66, 25600
  s_add_u32 s58, s60, 233472
  buffer_load_dwordx4 v89, s[48:51], s58 offen lds
  s_add_u32 m0, s66, 26624
  s_add_u32 s58, s60, 237568
  buffer_load_dwordx4 v88, s[48:51], s58 offen lds
  s_add_u32 m0, s66, 27648
  s_add_u32 s58, s60, 241664
  buffer_load_dwordx4 v89, s[48:51], s58 offen lds
  s_add_u32 m0, s66, 28672
  s_add_u32 s58, s60, 245760
  buffer_load_dwordx4 v88, s[48:51], s58 offen lds
  s_add_u32 m0, s66, 29696
  s_add_u32 s58, s60, 249856
  buffer_load_dwordx4 v89, s[48:51], s58 offen lds
  s_add_u32 m0, s66, 30720
  s_add_u32 s58, s60, 253952
  buffer_load_dwordx4 v88, s[48:51], s58 offen lds
  s_add_u32 m0, s66, 31744
  s_add_u32 s58, s60, 258048
  buffer_load_dwordx4 v89, s[48:51], s58 offen lds
  s_lshr_b32 s58, s44, 1
  s_lshl1_add_u32 s61, s56, s58
  s_and_b32 s59, s44, 1
  s_lshl_b32 s60, s44, 12
  s_add_u32 s60, s60, 131072
  v_bfe_u32 v6, v0, 3, 1
  v_lshl_add_u32 v8, v6, 8, s60
  v_lshl_add_u32 v8, v3, 6, v8
  v_and_b32 v6, 7, v0
  v_lshl_add_u32 v8, v6, 3, v8
  v_lshrrev_b32 v6, 5, v0
  v_lshl_add_u32 v9, v6, 8, s60
  v_and_b32 v6, 3, v0
  v_lshl_add_u32 v9, v6, 6, v9
  v_bfe_u32 v6, v0, 2, 3
  v_lshl_add_u32 v9, v6, 3, v9
  s_mul_i32 s60, s58, 24576
  v_add_u32 v12, s60, v2
  s_lshl_b32 s66, s59, 12
  s_lshl_b32 s67, s61, 19
  s_add_u32 s67, s67, s66
  s_add_u32 s67, s67, 0x3000000
  s_add_u32 s66, s66, s60
  s_lshl1_add_u32 s60, s59, s58
  s_lshl_b32 s60, s60, 12
  s_add_u32 s60, s60, 98304
  v_add_u32 v13, s60, v2
  v_add_u32 v14, 98304, v2
  s_lshl_b32 s60, s59, 4
  v_add_u32 v4, s60, v4
  v_lshlrev_b32 v31, 2, v4
  v_add_u32 v31, 0xd0c0000, v31
  v_lshlrev_b32 v3, 2, v3
  v_sub_u32 v4, v4, v3
  v_mov_b32 v6, 0xff800000
  s_lshl_b32 s68, s61, 7
  s_add_u32 s73, s68, 0xd081000
  s_add_u32 s68, s68, 0xd084000
  s_lshl_b32 s69, s61, 12
  s_add_u32 s69, s69, 0xc020000
  s_lshl2_add_u32 s70, s56, s44
  s_lshl_b32 s70, s70, 12
  s_add_u32 s70, s70, 0x6080000
  s_cmp_eq_u32 s44, 0
  s_mov_b32 s72, 0x40000000
  s_cmov_b32 s72, 0xd087000
  v_cmp_gt_i32 vcc, 0, v4
  v_mov_b32 v16, 0x3f803f80
  s_nop 0
  v_cndmask_b32 v20, 0, v6, vcc
  v_cmp_gt_i32 vcc, 1, v4
  v_mov_b32 v17, 0x3f803f80
  s_nop 0
  v_cndmask_b32 v21, 0, v6, vcc
  v_cmp_gt_i32 vcc, 2, v4
  v_mov_b32 v18, 0x3f803f80
  s_nop 0
  v_cndmask_b32 v22, 0, v6, vcc
  v_cmp_gt_i32 vcc, 3, v4
  v_mov_b32 v19, 0x3f803f80
  s_nop 0
  v_cndmask_b32 v23, 0, v6, vcc
  v_cmp_gt_i32 vcc, 16, v4
  v_mov_b32 v16, 0x3f803f80
  s_nop 0
  v_cndmask_b32 v24, 0, v6, vcc
  v_cmp_gt_i32 vcc, 17, v4
  v_mov_b32 v17, 0x3f803f80
  s_nop 0
  v_cndmask_b32 v25, 0, v6, vcc
  v_cmp_gt_i32 vcc, 18, v4
  v_mov_b32 v18, 0x3f803f80
  s_nop 0
  v_cndmask_b32 v26, 0, v6, vcc
  v_cmp_gt_i32 vcc, 19, v4
  v_mov_b32 v19, 0x3f803f80
  s_nop 0
  v_cndmask_b32 v27, 0, v6, vcc
  v_mov_b32 v33, 0
  v_mov_b32 v34, 0
  s_waitcnt vmcnt(24)
  ds_read_b64_tr_b16 a[16:17], v104 offset:0
  ds_read_b64_tr_b16 a[18:19], v104 offset:4096
  ds_read_b64_tr_b16 a[48:49], v105 offset:0
  ds_read_b64_tr_b16 a[50:51], v105 offset:4096
  ds_read_b64_tr_b16 a[80:81], v106 offset:0
  ds_read_b64_tr_b16 a[82:83], v106 offset:4096
  ds_read_b64_tr_b16 a[112:113], v107 offset:0
  ds_read_b64_tr_b16 a[114:115], v107 offset:4096
  ds_read_b64_tr_b16 a[144:145], v108 offset:0
  ds_read_b64_tr_b16 a[146:147], v108 offset:4096
  ds_read_b64_tr_b16 a[176:177], v109 offset:0
  ds_read_b64_tr_b16 a[178:179], v109 offset:4096
  ds_read_b64_tr_b16 a[208:209], v110 offset:0
  ds_read_b64_tr_b16 a[210:211], v110 offset:4096
  ds_read_b64_tr_b16 a[240:241], v111 offset:0
  ds_read_b64_tr_b16 a[242:243], v111 offset:4096
  s_waitcnt vmcnt(16)
  ds_read_b64_tr_b16 a[20:21], v104 offset:8192
  ds_read_b64_tr_b16 a[22:23], v104 offset:12288
  ds_read_b64_tr_b16 a[52:53], v105 offset:8192
  ds_read_b64_tr_b16 a[54:55], v105 offset:12288
  ds_read_b64_tr_b16 a[84:85], v106 offset:8192
  ds_read_b64_tr_b16 a[86:87], v106 offset:12288
  ds_read_b64_tr_b16 a[116:117], v107 offset:8192
  ds_read_b64_tr_b16 a[118:119], v107 offset:12288
  ds_read_b64_tr_b16 a[148:149], v108 offset:8192
  ds_read_b64_tr_b16 a[150:151], v108 offset:12288
  ds_read_b64_tr_b16 a[180:181], v109 offset:8192
  ds_read_b64_tr_b16 a[182:183], v109 offset:12288
  ds_read_b64_tr_b16 a[212:213], v110 offset:8192
  ds_read_b64_tr_b16 a[214:215], v110 offset:12288
  ds_read_b64_tr_b16 a[244:245], v111 offset:8192
  ds_read_b64_tr_b16 a[246:247], v111 offset:12288
  s_waitcnt vmcnt(8)
  ds_read_b64_tr_b16 a[24:25], v104 offset:16384
  ds_read_b64_tr_b16 a[26:27], v104 offset:20480
  ds_read_b64_tr_b16 a[56:57], v105 offset:16384
  ds_read_b64_tr_b16 a[58:59], v105 offset:20480
  ds_read_b64_tr_b16 a[88:89], v106 offset:16384
  ds_read_b64_tr_b16 a[90:91], v106 offset:20480
  ds_read_b64_tr_b16 a[120:121], v107 offset:16384
  ds_read_b64_tr_b16 a[122:123], v107 offset:20480
  ds_read_b64_tr_b16 a[152:153], v108 offset:16384
  ds_read_b64_tr_b16 a[154:155], v108 offset:20480
  ds_read_b64_tr_b16 a[184:185], v109 offset:16384
  ds_read_b64_tr_b16 a[186:187], v109 offset:20480
  ds_read_b64_tr_b16 a[216:217], v110 offset:16384
  ds_read_b64_tr_b16 a[218:219], v110 offset:20480
  ds_read_b64_tr_b16 a[248:249], v111 offset:16384
  ds_read_b64_tr_b16 a[250:251], v111 offset:20480
  s_waitcnt vmcnt(0)
  ds_read_b64_tr_b16 a[28:29], v104 offset:24576
  ds_read_b64_tr_b16 a[30:31], v104 offset:28672
  ds_read_b64_tr_b16 a[60:61], v105 offset:24576
  ds_read_b64_tr_b16 a[62:63], v105 offset:28672
  ds_read_b64_tr_b16 a[92:93], v106 offset:24576
  ds_read_b64_tr_b16 a[94:95], v106 offset:28672
  ds_read_b64_tr_b16 a[124:125], v107 offset:24576
  ds_read_b64_tr_b16 a[126:127], v107 offset:28672
  ds_read_b64_tr_b16 a[156:157], v108 offset:24576
  ds_read_b64_tr_b16 a[158:159], v108 offset:28672
  ds_read_b64_tr_b16 a[188:189], v109 offset:24576
  ds_read_b64_tr_b16 a[190:191], v109 offset:28672
  ds_read_b64_tr_b16 a[220:221], v110 offset:24576
  ds_read_b64_tr_b16 a[222:223], v110 offset:28672
  ds_read_b64_tr_b16 a[252:253], v111 offset:24576
  ds_read_b64_tr_b16 a[254:255], v111 offset:28672
  s_waitcnt lgkmcnt(0)
  s_lshl_b32 s58, s61, 7
  s_add_u32 s58, s58, 0xd080010
  v_lshl_add_u32 v3, v0, 2, s58
  v_and_b32 v4, 7, v0
  v_lshlrev_b32 v4, 7, v4
  v_add_u32 v4, 0xd086400, v4
  v_cmp_gt_u32 vcc, 2, v0
  v_mov_b32 v249, 0
  s_nop 0
  v_cndmask_b32 v3, v4, v3, vcc
  v_cndmask_b32 v4, 16, 32, vcc
L_b_w0:
  buffer_load_dword v5, v3, s[40:43], 0 offen sc1
  s_add_u32 s57, s57, 1
  s_cmp_gt_u32 s57, 1048576
  s_cbranch_scc1 L_exit
  s_waitcnt vmcnt(0)
  v_cmp_ne_u32 vcc, v4, v5
  s_cbranch_vccnz L_b_w0
  v_readlane_b32 s63, v1, s95
  s_mov_b32 s62, 4
  s_mov_b32 s65, 0
  s_barrier
  s_bitcmp1_b32 s63, 2
  s_cbranch_scc1 L_b_nodma_1
  s_lshr_b32 s59, s63, 4
L_b_nodma_1_c:
  v_cmp_lt_u32 vcc, s59, v249
  s_cbranch_vccnz L_b_nodma_1_go
  buffer_load_dword v249, v7, s[40:43], s73 offen sc1
  buffer_load_dword v248, v7, s[40:43], s68 offen sc1
  s_add_u32 s57, s57, 1
  s_cmp_gt_u32 s57, 1048576
  s_cbranch_scc1 L_exit
  s_waitcnt vmcnt(0)
  s_branch L_b_nodma_1_c
L_b_nodma_1_go:
  s_lshl_b32 s58, s63, 9
  s_add_u32 s58, s58, s67
  s_add_u32 m0, s66, 0
  s_add_u32 s59, s58, 0x0
  buffer_load_dwordx4 v2, s[40:43], s59 offen offset:0 sc1 lds
  buffer_load_dwordx4 v2, s[40:43], s59 offen offset:1024 sc1 lds
  buffer_load_dwordx4 v2, s[40:43], s59 offen offset:2048 sc1 lds
  buffer_load_dwordx4 v2, s[40:43], s59 offen offset:3072 sc1 lds
  s_add_u32 m0, s66, 8192
  s_add_u32 s59, s58, 0x1000000
  buffer_load_dwordx4 v2, s[40:43], s59 offen offset:0 sc1 lds
  buffer_load_dwordx4 v2, s[40:43], s59 offen offset:1024 sc1 lds
  buffer_load_dwordx4 v2, s[40:43], s59 offen offset:2048 sc1 lds
  buffer_load_dwordx4 v2, s[40:43], s59 offen offset:3072 sc1 lds
  s_add_u32 m0, s66, 16384
  s_add_u32 s59, s58, 0x2000000
  buffer_load_dwordx4 v2, s[40:43], s59 offen offset:0 sc1 lds
  buffer_load_dwordx4 v2, s[40:43], s59 offen offset:1024 sc1 lds
  buffer_load_dwordx4 v2, s[40:43], s59 offen offset:2048 sc1 lds
  buffer_load_dwordx4 v2, s[40:43], s59 offen offset:3072 sc1 lds
  s_lshl_b32 s58, s63, 3
  buffer_load_dword v11, v31, s[40:43], s58 offen sc1
L_b_nodma_1:
L_b_round:
  s_mov_b32 s64, s62
  s_mov_b32 s62, s63
  s_add_u32 s95, s95, 1
  v_readlane_b32 s63, v1, s95
  s_cmp_ge_u32 s66, 49152
  s_mov_b32 s60, 49152
  s_cmov_b32 s60, -49152
  s_add_u32 s66, s66, s60
  s_waitcnt vmcnt(0)
  s_barrier
  v_sub_f32 v10, 1.0, v11
  s_and_b32 s59, s44, 1
  s_lshl_b32 s59, s59, 10
  v_add_u32 v4, s59, v12
  ds_read_b128 v[88:91], v4 offset:0
  ds_read_b128 v[104:107], v12 offset:8192
  ds_read_b128 v[108:111], v12 offset:9216
  ds_read_b128 v[92:95], v4 offset:2048
  ds_read_b128 v[112:115], v12 offset:10240
  ds_read_b128 v[116:119], v12 offset:11264
  ds_read_b128 v[96:99], v4 offset:4096
  ds_read_b128 v[120:123], v12 offset:12288
  ds_read_b128 v[124:127], v12 offset:13312
  ds_read_b128 v[100:103], v4 offset:6144
  ds_read_b128 v[128:131], v12 offset:14336
  ds_read_b128 v[132:135], v12 offset:15360
  s_lshl_b32 s58, s64, 2
  s_add_u32 s58, s58, s72
  s_bitcmp1_b32 s64, 2
  s_cselect_b32 s58, 0x40000000, s58
  v_mov_b32 v3, 1
  s_mov_b64 exec, 1
  buffer_atomic_add v3, v7, s[40:43], s58 offen
  s_mov_b64 exec, -1
  s_cmp_eq_u32 s65, 0
  s_cbranch_scc1 L_b_late
L_b_have:
  ds_write2st64_b32 v8, v56, v57 offset0:0 offset1:8
  ds_write2st64_b32 v8, v60, v61 offset0:2 offset1:10
  ds_write2st64_b32 v8, v64, v65 offset0:4 offset1:12
  ds_write2st64_b32 v8, v68, v69 offset0:6 offset1:14
  s_waitcnt lgkmcnt(4)
  v_mfma_f32_16x16x32_bf16 v[40:43], v[104:107], v[88:91], v[20:23]
  ds_read_b64_tr_b16 v[72:73], v9 offset:0
  v_mfma_f32_16x16x32_bf16 v[44:47], v[108:111], v[88:91], v[24:27]
  ds_read_b64_tr_b16 v[74:75], v9 offset:2048
  v_mfma_f32_16x16x32_bf16 v[40:43], v[112:115], v[92:95], v[40:43]
  ds_read_b64_tr_b16 v[76:77], v9 offset:512
  v_mfma_f32_16x16x32_bf16 v[44:47], v[116:119], v[92:95], v[44:47]
  ds_read_b64_tr_b16 v[78:79], v9 offset:2560
  v_mfma_f32_16x16x32_bf16 v[40:43], v[120:123], v[96:99], v[40:43]
  ds_read_b64_tr_b16 v[80:81], v9 offset:1024
  v_mfma_f32_16x16x32_bf16 v[44:47], v[124:127], v[96:99], v[44:47]
  ds_read_b64_tr_b16 v[82:83], v9 offset:3072
  v_mfma_f32_16x16x32_bf16 v[40:43], v[128:131], v[100:103], v[40:43]
  ds_read_b64_tr_b16 v[84:85], v9 offset:1536
  v_mfma_f32_16x16x32_bf16 v[44:47], v[132:135], v[100:103], v[44:47]
  ds_read_b64_tr_b16 v[86:87], v9 offset:3584
  ds_read_b128 v[136:139], v12 offset:16384
  ds_read_b128 v[140:143], v12 offset:17408
  ds_read_b128 v[144:147], v12 offset:18432
  ds_read_b128 v[148:151], v12 offset:19456
  ds_read_b128 v[152:155], v12 offset:20480
  ds_read_b128 v[156:159], v12 offset:21504
  s_bitcmp1_b32 s63, 2
  s_cbranch_scc1 L_b_nodma_2
  s_lshr_b32 s59, s63, 4
L_b_nodma_2_c:
  v_cmp_lt_u32 vcc, s59, v249
  s_cbranch_vccnz L_b_nodma_2_go
  buffer_load_dword v249, v7, s[40:43], s73 offen sc1
  buffer_load_dword v248, v7, s[40:43], s68 offen sc1
  s_add_u32 s57, s57, 1
  s_cmp_gt_u32 s57, 1048576
  s_cbranch_scc1 L_exit
  s_waitcnt vmcnt(0)
  s_branch L_b_nodma_2_c
L_b_nodma_2_go:
  s_lshl_b32 s58, s63, 9
  s_add_u32 s58, s58, s67
  s_add_u32 m0, s66, 0
  s_add_u32 s59, s58, 0x0
  buffer_load_dwordx4 v2, s[40:43], s59 offen offset:0 sc1 lds
  buffer_load_dwordx4 v2, s[40:43], s59 offen offset:1024 sc1 lds
  buffer_load_dwordx4 v2, s[40:43], s59 offen offset:2048 sc1 lds
  buffer_load_dwordx4 v2, s[40:43], s59 offen offset:3072 sc1 lds
  s_add_u32 m0, s66, 8192
  s_add_u32 s59, s58, 0x1000000
  buffer_load_dwordx4 v2, s[40:43], s59 offen offset:0 sc1 lds
  buffer_load_dwordx4 v2, s[40:43], s59 offen offset:1024 sc1 lds
  buffer_load_dwordx4 v2, s[40:43], s59 offen offset:2048 sc1 lds
  buffer_load_dwordx4 v2, s[40:43], s59 offen offset:3072 sc1 lds
  s_add_u32 m0, s66, 16384
  s_add_u32 s59, s58, 0x2000000
  buffer_load_dwordx4 v2, s[40:43], s59 offen offset:0 sc1 lds
  buffer_load_dwordx4 v2, s[40:43], s59 offen offset:1024 sc1 lds
  buffer_load_dwordx4 v2, s[40:43], s59 offen offset:2048 sc1 lds
  buffer_load_dwordx4 v2, s[40:43], s59 offen offset:3072 sc1 lds
  s_lshl_b32 s58, s63, 3
  buffer_load_dword v11, v31, s[40:43], s58 offen sc1
L_b_nodma_2:
  s_waitcnt lgkmcnt(6)
  v_mfma_f32_16x16x32_bf16 v[48:51], v[72:75], v[88:91], 0
  ds_read_b128 v[160:163], v12 offset:22528
  v_mfma_f32_16x16x32_bf16 v[48:51], v[76:79], v[92:95], v[48:51]
  ds_read_b128 v[164:167], v12 offset:23552
  v_mfma_f32_16x16x32_bf16 v[48:51], v[80:83], v[96:99], v[48:51]
  v_mfma_f32_16x16x32_bf16 v[48:51], v[84:87], v[100:103], v[48:51]
  v_add_u32 v12, s60, v12
  v_max_f32 v3, v40, v41
  v_max3_f32 v3, v3, v42, v43
  v_max3_f32 v3, v3, v44, v45
  v_max3_f32 v3, v3, v46, v47
  s_nop 2
  v_max3_f32 v3, v3, v48, v49
  v_mov_b32 v4, v3
  s_nop 1
  v_permlane32_swap_b32 v4, v3
  v_max_f32 v3, v3, v4
  v_mov_b32 v4, v3
  s_nop 1
  v_permlane16_swap_b32 v4, v3
  v_max_f32 v3, v3, v4
  v_sub_f32 v40, v40, v3
  v_sub_f32 v41, v41, v3
  v_sub_f32 v42, v42, v3
  v_sub_f32 v43, v43, v3
  v_sub_f32 v44, v44, v3
  v_sub_f32 v45, v45, v3
  v_sub_f32 v46, v46, v3
  v_sub_f32 v47, v47, v3
  v_sub_f32 v48, v48, v3
  v_sub_f32 v49, v49, v3
  v_exp_f32 v40, v40
  v_exp_f32 v41, v41
  v_exp_f32 v42, v42
  v_exp_f32 v43, v43
  v_exp_f32 v44, v44
  v_exp_f32 v45, v45
  v_exp_f32 v46, v46
  v_exp_f32 v47, v47
  v_exp_f32 v48, v48
  v_exp_f32 v49, v49
  v_cvt_pk_bf16_f32 v36, v40, v41
  v_cvt_pk_bf16_f32 v37, v42, v43
  v_cvt_pk_bf16_f32 v38, v44, v45
  v_cvt_pk_bf16_f32 v39, v46, v47
  v_cvt_pk_bf16_f32 v32, v48, v49
  v_cvt_pk_bf16_f32 v35, v48, v49
  s_waitcnt lgkmcnt(0)
  v_mfma_f32_16x16x32_bf16 v[52:55], v[16:19], v[36:39], 0
  v_mfma_f32_16x16x32_bf16 v[168:171], v[136:139], v[36:39], 0
  v_mfma_f32_16x16x32_bf16 v[172:175], v[140:143], v[36:39], 0
  v_mfma_f32_16x16x32_bf16 v[176:179], v[144:147], v[36:39], 0
  v_mfma_f32_16x16x32_bf16 v[180:183], v[148:151], v[36:39], 0
  v_mfma_f32_16x16x32_bf16 v[184:187], v[152:155], v[36:39], 0
  v_mfma_f32_16x16x32_bf16 v[188:191], v[156:159], v[36:39], 0
  v_mfma_f32_16x16x16_bf16 v[52:55], v[16:17], v[32:33], v[52:55]
  v_mfma_f32_16x16x32_bf16 v[192:195], v[160:163], v[36:39], 0
  v_mfma_f32_16x16x32_bf16 v[196:199], v[164:167], v[36:39], 0
  v_mfma_f32_16x16x16_bf16 v[168:171], v[58:59], v[32:33], v[168:171]
  v_mfma_f32_16x16x16_bf16 v[172:175], v[58:59], v[34:35], v[172:175]
  v_mfma_f32_16x16x16_bf16 v[176:179], v[62:63], v[32:33], v[176:179]
  v_mfma_f32_16x16x16_bf16 v[180:183], v[62:63], v[34:35], v[180:183]
  v_mfma_f32_16x16x16_bf16 v[184:187], v[66:67], v[32:33], v[184:187]
  v_mfma_f32_16x16x16_bf16 v[188:191], v[66:67], v[34:35], v[188:191]
  v_rcp_f32 v3, v52
  v_mfma_f32_16x16x16_bf16 v[192:195], v[70:71], v[32:33], v[192:195]
  v_mul_f32 v3, v3, v10
  v_mfma_f32_16x16x16_bf16 v[196:199], v[70:71], v[34:35], v[196:199]
  v_mul_f32 v168, v168, v3
  v_mul_f32 v169, v169, v3
  v_mul_f32 v170, v170, v3
  v_mul_f32 v171, v171, v3
  v_mul_f32 v172, v172, v3
  v_mul_f32 v173, v173, v3
  v_mul_f32 v174, v174, v3
  v_mul_f32 v175, v175, v3
  v_cvt_pk_bf16_f32 v232, v168, v169
  v_cvt_pk_bf16_f32 v233, v170, v171
  v_cvt_pk_bf16_f32 v234, v172, v173
  v_cvt_pk_bf16_f32 v235, v174, v175
  ds_write_b128 v13, v[232:235] offset:0
  v_mul_f32 v176, v176, v3
  v_mul_f32 v177, v177, v3
  v_mul_f32 v178, v178, v3
  v_mul_f32 v179, v179, v3
  v_mul_f32 v180, v180, v3
  v_mul_f32 v181, v181, v3
  v_mul_f32 v182, v182, v3
  v_mul_f32 v183, v183, v3
  v_cvt_pk_bf16_f32 v236, v176, v177
  v_cvt_pk_bf16_f32 v237, v178, v179
  v_cvt_pk_bf16_f32 v238, v180, v181
  v_cvt_pk_bf16_f32 v239, v182, v183
  ds_write_b128 v13, v[236:239] offset:1024
  v_mul_f32 v184, v184, v3
  v_mul_f32 v185, v185, v3
  v_mul_f32 v186, v186, v3
  v_mul_f32 v187, v187, v3
  v_mul_f32 v188, v188, v3
  v_mul_f32 v189, v189, v3
  v_mul_f32 v190, v190, v3
  v_mul_f32 v191, v191, v3
  v_cvt_pk_bf16_f32 v240, v184, v185
  v_cvt_pk_bf16_f32 v241, v186, v187
  v_cvt_pk_bf16_f32 v242, v188, v189
  v_cvt_pk_bf16_f32 v243, v190, v191
  ds_write_b128 v13, v[240:243] offset:2048
  v_mul_f32 v192, v192, v3
  v_mul_f32 v193, v193, v3
  v_mul_f32 v194, v194, v3
  v_mul_f32 v195, v195, v3
  v_mul_f32 v196, v196, v3
  v_mul_f32 v197, v197, v3
  v_mul_f32 v198, v198, v3
  v_mul_f32 v199, v199, v3
  v_cvt_pk_bf16_f32 v244, v192, v193
  v_cvt_pk_bf16_f32 v245, v194, v195
  v_cvt_pk_bf16_f32 v246, v196, v197
  v_cvt_pk_bf16_f32 v247, v198, v199
  ds_write_b128 v13, v[244:247] offset:3072
  buffer_load_dword v249, v7, s[40:43], s73 offen sc1
  buffer_load_dword v248, v7, s[40:43], s68 offen sc1
  v_xor_b32 v13, 0x4000, v13
  s_mul_i32 s71, s62, 98304
  s_add_u32 s71, s71, s70
  s_waitcnt lgkmcnt(0)
  s_barrier
  ds_read_b128 v[104:107], v14 offset:0
  ds_read_b128 v[108:111], v14 offset:1024
  ds_read_b128 v[112:115], v14 offset:2048
  ds_read_b128 v[116:119], v14 offset:3072
  ds_read_b128 v[120:123], v14 offset:4096
  ds_read_b128 v[124:127], v14 offset:5120
  ds_read_b128 v[128:131], v14 offset:6144
  ds_read_b128 v[132:135], v14 offset:7168
  s_waitcnt lgkmcnt(7)
  v_mfma_f32_16x16x32_bf16 v[200:203], a[0:3], v[104:107], 0
  s_waitcnt lgkmcnt(6)
  v_mfma_f32_16x16x32_bf16 v[200:203], a[4:7], v[108:111], v[200:203]
  s_waitcnt lgkmcnt(5)
  v_mfma_f32_16x16x32_bf16 v[200:203], a[8:11], v[112:115], v[200:203]
  s_waitcnt lgkmcnt(4)
  v_mfma_f32_16x16x32_bf16 v[200:203], a[12:15], v[116:119], v[200:203]
  s_waitcnt lgkmcnt(3)
  v_mfma_f32_16x16x32_bf16 v[200:203], a[16:19], v[120:123], v[200:203]
  s_waitcnt lgkmcnt(2)
  v_mfma_f32_16x16x32_bf16 v[200:203], a[20:23], v[124:127], v[200:203]
  s_waitcnt lgkmcnt(1)
  v_mfma_f32_16x16x32_bf16 v[200:203], a[24:27], v[128:131], v[200:203]
  s_waitcnt lgkmcnt(0)
  v_mfma_f32_16x16x32_bf16 v[200:203], a[28:31], v[132:135], v[200:203]
  v_mfma_f32_16x16x32_bf16 v[204:207], a[32:35], v[104:107], 0
  ds_read_b128 v[136:139], v14 offset:8192
  v_mfma_f32_16x16x32_bf16 v[204:207], a[36:39], v[108:111], v[204:207]
  ds_read_b128 v[140:143], v14 offset:9216
  v_mfma_f32_16x16x32_bf16 v[204:207], a[40:43], v[112:115], v[204:207]
  ds_read_b128 v[144:147], v14 offset:10240
  v_mfma_f32_16x16x32_bf16 v[204:207], a[44:47], v[116:119], v[204:207]
  ds_read_b128 v[148:151], v14 offset:11264
  v_mfma_f32_16x16x32_bf16 v[204:207], a[48:51], v[120:123], v[204:207]
  ds_read_b128 v[152:155], v14 offset:12288
  v_mfma_f32_16x16x32_bf16 v[204:207], a[52:55], v[124:127], v[204:207]
  ds_read_b128 v[156:159], v14 offset:13312
  v_mfma_f32_16x16x32_bf16 v[204:207], a[56:59], v[128:131], v[204:207]
  ds_read_b128 v[160:163], v14 offset:14336
  v_mfma_f32_16x16x32_bf16 v[204:207], a[60:63], v[132:135], v[204:207]
  ds_read_b128 v[164:167], v14 offset:15360
  v_mfma_f32_16x16x32_bf16 v[208:211], a[64:67], v[104:107], 0
  v_mfma_f32_16x16x32_bf16 v[208:211], a[68:71], v[108:111], v[208:211]
  v_mfma_f32_16x16x32_bf16 v[208:211], a[72:75], v[112:115], v[208:211]
  v_mfma_f32_16x16x32_bf16 v[208:211], a[76:79], v[116:119], v[208:211]
  v_mfma_f32_16x16x32_bf16 v[208:211], a[80:83], v[120:123], v[208:211]
  v_mfma_f32_16x16x32_bf16 v[208:211], a[84:87], v[124:127], v[208:211]
  v_mfma_f32_16x16x32_bf16 v[208:211], a[88:91], v[128:131], v[208:211]
  v_mfma_f32_16x16x32_bf16 v[208:211], a[92:95], v[132:135], v[208:211]
  v_cvt_pk_bf16_f32 v232, v200, v201
  v_cvt_pk_bf16_f32 v233, v202, v203
  v_mfma_f32_16x16x32_bf16 v[212:215], a[96:99], v[104:107], 0
  v_cvt_pk_bf16_f32 v234, v204, v205
  v_cvt_pk_bf16_f32 v235, v206, v207
  v_mfma_f32_16x16x32_bf16 v[212:215], a[100:103], v[108:111], v[212:215]
  buffer_store_dwordx4 v[232:235], v2, s[40:43], s71 offen offset:0 sc1
  v_mfma_f32_16x16x32_bf16 v[212:215], a[104:107], v[112:115], v[212:215]
  v_mfma_f32_16x16x32_bf16 v[212:215], a[108:111], v[116:119], v[212:215]
  v_mfma_f32_16x16x32_bf16 v[212:215], a[112:115], v[120:123], v[212:215]
  v_mfma_f32_16x16x32_bf16 v[212:215], a[116:119], v[124:127], v[212:215]
  v_mfma_f32_16x16x32_bf16 v[212:215], a[120:123], v[128:131], v[212:215]
  v_mfma_f32_16x16x32_bf16 v[212:215], a[124:127], v[132:135], v[212:215]
  v_mfma_f32_16x16x32_bf16 v[216:219], a[128:131], v[104:107], 0
  v_mfma_f32_16x16x32_bf16 v[216:219], a[132:135], v[108:111], v[216:219]
  v_mfma_f32_16x16x32_bf16 v[216:219], a[136:139], v[112:115], v[216:219]
  v_mfma_f32_16x16x32_bf16 v[216:219], a[140:143], v[116:119], v[216:219]
  v_mfma_f32_16x16x32_bf16 v[216:219], a[144:147], v[120:123], v[216:219]
  v_mfma_f32_16x16x32_bf16 v[216:219], a[148:151], v[124:127], v[216:219]
  v_mfma_f32_16x16x32_bf16 v[216:219], a[152:155], v[128:131], v[216:219]
  v_mfma_f32_16x16x32_bf16 v[216:219], a[156:159], v[132:135], v[216:219]
  v_cvt_pk_bf16_f32 v236, v208, v209
  v_cvt_pk_bf16_f32 v237, v210, v211
  v_mfma_f32_16x16x32_bf16 v[220:223], a[160:163], v[104:107], 0
  s_waitcnt lgkmcnt(0)
  v_xor_b32 v14, 0x4000, v14
  v_cvt_pk_bf16_f32 v238, v212, v213
  v_cvt_pk_bf16_f32 v239, v214, v215
  v_mfma_f32_16x16x32_bf16 v[220:223], a[164:167], v[108:111], v[220:223]
  buffer_store_dwordx4 v[236:239], v2, s[40:43], s71 offen offset:1024 sc1
  v_mfma_f32_16x16x32_bf16 v[220:223], a[168:171], v[112:115], v[220:223]
  v_mfma_f32_16x16x32_bf16 v[220:223], a[172:175], v[116:119], v[220:223]
  v_mfma_f32_16x16x32_bf16 v[220:223], a[176:179], v[120:123], v[220:223]
  v_mfma_f32_16x16x32_bf16 v[220:223], a[180:183], v[124:127], v[220:223]
  v_mfma_f32_16x16x32_bf16 v[220:223], a[184:187], v[128:131], v[220:223]
  v_mfma_f32_16x16x32_bf16 v[220:223], a[188:191], v[132:135], v[220:223]
  v_mfma_f32_16x16x32_bf16 v[224:227], a[192:195], v[104:107], 0
  v_mfma_f32_16x16x32_bf16 v[224:227], a[196:199], v[108:111], v[224:227]
  v_mfma_f32_16x16x32_bf16 v[224:227], a[200:203], v[112:115], v[224:227]
  v_mfma_f32_16x16x32_bf16 v[224:227], a[204:207], v[116:119], v[224:227]
  v_mfma_f32_16x16x32_bf16 v[224:227], a[208:211], v[120:123], v[224:227]
  v_mfma_f32_16x16x32_bf16 v[224:227], a[212:215], v[124:127], v[224:227]
  v_mfma_f32_16x16x32_bf16 v[224:227], a[216:219], v[128:131], v[224:227]
  v_mfma_f32_16x16x32_bf16 v[224:227], a[220:223], v[132:135], v[224:227]
  v_cvt_pk_bf16_f32 v240, v216, v217
  v_cvt_pk_bf16_f32 v241, v218, v219
  v_mfma_f32_16x16x32_bf16 v[228:231], a[224:227], v[104:107], 0
  v_cvt_pk_bf16_f32 v242, v220, v221
  v_cvt_pk_bf16_f32 v243, v222, v223
  v_mfma_f32_16x16x32_bf16 v[228:231], a[228:231], v[108:111], v[228:231]
  buffer_store_dwordx4 v[240:243], v2, s[40:43], s71 offen offset:2048 sc1
  v_mfma_f32_16x16x32_bf16 v[228:231], a[232:235], v[112:115], v[228:231]
  v_mfma_f32_16x16x32_bf16 v[228:231], a[236:239], v[116:119], v[228:231]
  v_mfma_f32_16x16x32_bf16 v[228:231], a[240:243], v[120:123], v[228:231]
  s_waitcnt vmcnt(3)
  s_lshr_b32 s59, s63, 4
  v_mfma_f32_16x16x32_bf16 v[228:231], a[244:247], v[124:127], v[228:231]
  v_cmp_lt_u32 vcc, s59, v248
  v_mfma_f32_16x16x32_bf16 v[228:231], a[248:251], v[128:131], v[228:231]
  v_mfma_f32_16x16x32_bf16 v[228:231], a[252:255], v[132:135], v[228:231]
  v_mfma_f32_16x16x32_bf16 v[200:203], a[0:3], v[136:139], 0
  s_mov_b32 s65, 0
  s_cbranch_vccz L_b_nofetch
  s_lshl_b32 s58, s63, 13
  s_add_u32 s58, s58, s69
  buffer_load_dwordx4 v[56:59], v2, s[40:43], s58 offen offset:0 sc1
  buffer_load_dwordx4 v[60:63], v2, s[40:43], s58 offen offset:1024 sc1
  buffer_load_dwordx4 v[64:67], v2, s[40:43], s58 offen offset:2048 sc1
  buffer_load_dwordx4 v[68:71], v2, s[40:43], s58 offen offset:3072 sc1
  s_mov_b32 s65, 1
L_b_nofetch:
  v_mfma_f32_16x16x32_bf16 v[200:203], a[4:7], v[140:143], v[200:203]
  v_mfma_f32_16x16x32_bf16 v[200:203], a[8:11], v[144:147], v[200:203]
  v_mfma_f32_16x16x32_bf16 v[200:203], a[12:15], v[148:151], v[200:203]
  v_mfma_f32_16x16x32_bf16 v[200:203], a[16:19], v[152:155], v[200:203]
  v_mfma_f32_16x16x32_bf16 v[200:203], a[20:23], v[156:159], v[200:203]
  v_mfma_f32_16x16x32_bf16 v[200:203], a[24:27], v[160:163], v[200:203]
  v_mfma_f32_16x16x32_bf16 v[200:203], a[28:31], v[164:167], v[200:203]
  v_cvt_pk_bf16_f32 v244, v224, v225
  v_cvt_pk_bf16_f32 v245, v226, v227
  v_mfma_f32_16x16x32_bf16 v[204:207], a[32:35], v[136:139], 0
  v_cvt_pk_bf16_f32 v246, v228, v229
  v_cvt_pk_bf16_f32 v247, v230, v231
  v_mfma_f32_16x16x32_bf16 v[204:207], a[36:39], v[140:143], v[204:207]
  buffer_store_dwordx4 v[244:247], v2, s[40:43], s71 offen offset:3072 sc1
  v_mfma_f32_16x16x32_bf16 v[204:207], a[40:43], v[144:147], v[204:207]
  v_mfma_f32_16x16x32_bf16 v[204:207], a[44:47], v[148:151], v[204:207]
  v_mfma_f32_16x16x32_bf16 v[204:207], a[48:51], v[152:155], v[204:207]
  v_mfma_f32_16x16x32_bf16 v[204:207], a[52:55], v[156:159], v[204:207]
  v_mfma_f32_16x16x32_bf16 v[204:207], a[56:59], v[160:163], v[204:207]
  v_mfma_f32_16x16x32_bf16 v[204:207], a[60:63], v[164:167], v[204:207]
  v_mfma_f32_16x16x32_bf16 v[208:211], a[64:67], v[136:139], 0
  v_mfma_f32_16x16x32_bf16 v[208:211], a[68:71], v[140:143], v[208:211]
  v_mfma_f32_16x16x32_bf16 v[208:211], a[72:75], v[144:147], v[208:211]
  v_mfma_f32_16x16x32_bf16 v[208:211], a[76:79], v[148:151], v[208:211]
  v_mfma_f32_16x16x32_bf16 v[208:211], a[80:83], v[152:155], v[208:211]
  v_mfma_f32_16x16x32_bf16 v[208:211], a[84:87], v[156:159], v[208:211]
  v_mfma_f32_16x16x32_bf16 v[208:211], a[88:91], v[160:163], v[208:211]
  s_add_u32 s71, s71, 786432
  v_mfma_f32_16x16x32_bf16 v[208:211], a[92:95], v[164:167], v[208:211]
  v_cvt_pk_bf16_f32 v232, v200, v201
  v_cvt_pk_bf16_f32 v233, v202, v203
  v_mfma_f32_16x16x32_bf16 v[212:215], a[96:99], v[136:139], 0
  v_cvt_pk_bf16_f32 v234, v204, v205
  v_cvt_pk_bf16_f32 v235, v206, v207
  v_mfma_f32_16x16x32_bf16 v[212:215], a[100:103], v[140:143], v[212:215]
  buffer_store_dwordx4 v[232:235], v2, s[40:43], s71 offen offset:0 sc1
  v_mfma_f32_16x16x32_bf16 v[212:215], a[104:107], v[144:147], v[212:215]
  v_mfma_f32_16x16x32_bf16 v[212:215], a[108:111], v[148:151], v[212:215]
  v_mfma_f32_16x16x32_bf16 v[212:215], a[112:115], v[152:155], v[212:215]
  v_mfma_f32_16x16x32_bf16 v[212:215], a[116:119], v[156:159], v[212:215]
  v_mfma_f32_16x16x32_bf16 v[212:215], a[120:123], v[160:163], v[212:215]
  v_mfma_f32_16x16x32_bf16 v[212:215], a[124:127], v[164:167], v[212:215]
  v_mfma_f32_16x16x32_bf16 v[216:219], a[128:131], v[136:139], 0
  v_mfma_f32_16x16x32_bf16 v[216:219], a[132:135], v[140:143], v[216:219]
  v_mfma_f32_16x16x32_bf16 v[216:219], a[136:139], v[144:147], v[216:219]
  v_mfma_f32_16x16x32_bf16 v[216:219], a[140:143], v[148:151], v[216:219]
  v_mfma_f32_16x16x32_bf16 v[216:219], a[144:147], v[152:155], v[216:219]
  v_mfma_f32_16x16x32_bf16 v[216:219], a[148:151], v[156:159], v[216:219]
  v_mfma_f32_16x16x32_bf16 v[216:219], a[152:155], v[160:163], v[216:219]
  v_mfma_f32_16x16x32_bf16 v[216:219], a[156:159], v[164:167], v[216:219]
  v_cvt_pk_bf16_f32 v236, v208, v209
  v_cvt_pk_bf16_f32 v237, v210, v211
  v_mfma_f32_16x16x32_bf16 v[220:223], a[160:163], v[136:139], 0
  v_cvt_pk_bf16_f32 v238, v212, v213
  v_cvt_pk_bf16_f32 v239, v214, v215
  v_mfma_f32_16x16x32_bf16 v[220:223], a[164:167], v[140:143], v[220:223]
  buffer_store_dwordx4 v[236:239], v2, s[40:43], s71 offen offset:1024 sc1
  v_mfma_f32_16x16x32_bf16 v[220:223], a[168:171], v[144:147], v[220:223]
  v_mfma_f32_16x16x32_bf16 v[220:223], a[172:175], v[148:151], v[220:223]
  v_mfma_f32_16x16x32_bf16 v[220:223], a[176:179], v[152:155], v[220:223]
  v_mfma_f32_16x16x32_bf16 v[220:223], a[180:183], v[156:159], v[220:223]
  v_mfma_f32_16x16x32_bf16 v[220:223], a[184:187], v[160:163], v[220:223]
  v_mfma_f32_16x16x32_bf16 v[220:223], a[188:191], v[164:167], v[220:223]
  v_mfma_f32_16x16x32_bf16 v[224:227], a[192:195], v[136:139], 0
  v_mfma_f32_16x16x32_bf16 v[224:227], a[196:199], v[140:143], v[224:227]
  v_mfma_f32_16x16x32_bf16 v[224:227], a[200:203], v[144:147], v[224:227]
  v_mfma_f32_16x16x32_bf16 v[224:227], a[204:207], v[148:151], v[224:227]
  v_mfma_f32_16x16x32_bf16 v[224:227], a[208:211], v[152:155], v[224:227]
  v_mfma_f32_16x16x32_bf16 v[224:227], a[212:215], v[156:159], v[224:227]
  v_mfma_f32_16x16x32_bf16 v[224:227], a[216:219], v[160:163], v[224:227]
  v_mfma_f32_16x16x32_bf16 v[224:227], a[220:223], v[164:167], v[224:227]
  v_cvt_pk_bf16_f32 v240, v216, v217
  v_cvt_pk_bf16_f32 v241, v218, v219
  v_mfma_f32_16x16x32_bf16 v[228:231], a[224:227], v[136:139], 0
  v_cvt_pk_bf16_f32 v242, v220, v221
  v_cvt_pk_bf16_f32 v243, v222, v223
  v_mfma_f32_16x16x32_bf16 v[228:231], a[228:231], v[140:143], v[228:231]
  buffer_store_dwordx4 v[240:243], v2, s[40:43], s71 offen offset:2048 sc1
  v_mfma_f32_16x16x32_bf16 v[228:231], a[232:235], v[144:147], v[228:231]
  v_mfma_f32_16x16x32_bf16 v[228:231], a[236:239], v[148:151], v[228:231]
  v_mfma_f32_16x16x32_bf16 v[228:231], a[240:243], v[152:155], v[228:231]
  v_mfma_f32_16x16x32_bf16 v[228:231], a[244:247], v[156:159], v[228:231]
  v_mfma_f32_16x16x32_bf16 v[228:231], a[248:251], v[160:163], v[228:231]
  v_mfma_f32_16x16x32_bf16 v[228:231], a[252:255], v[164:167], v[228:231]
  s_nop 7
  v_cvt_pk_bf16_f32 v244, v224, v225
  v_cvt_pk_bf16_f32 v245, v226, v227
  v_cvt_pk_bf16_f32 v246, v228, v229
  v_cvt_pk_bf16_f32 v247, v230, v231
  buffer_store_dwordx4 v[244:247], v2, s[40:43], s71 offen offset:3072 sc1
  s_bitcmp1_b32 s63, 2
  s_cbranch_scc0 L_b_round
  s_mov_b32 s64, s62
  s_waitcnt vmcnt(0)
  s_barrier
  s_lshl_b32 s58, s64, 2
  s_add_u32 s58, s58, s72
  s_bitcmp1_b32 s64, 2
  s_cselect_b32 s58, 0x40000000, s58
  v_mov_b32 v3, 1
  s_mov_b64 exec, 1
  buffer_atomic_add v3, v7, s[40:43], s58 offen
  s_mov_b64 exec, -1
  s_branch L_next
L_b_late:
  s_lshr_b32 s59, s62, 4
L_b_late2:
  buffer_load_dword v249, v7, s[40:43], s73 offen sc1
  buffer_load_dword v248, v7, s[40:43], s68 offen sc1
  s_add_u32 s57, s57, 1
  s_cmp_gt_u32 s57, 1048576
  s_cbranch_scc1 L_exit
  s_waitcnt vmcnt(0)
  v_cmp_lt_u32 vcc, s59, v248
  s_cbranch_vccz L_b_late2
  s_lshl_b32 s58, s62, 13
  s_add_u32 s58, s58, s69
  buffer_load_dwordx4 v[56:59], v2, s[40:43], s58 offen offset:0 sc1
  buffer_load_dwordx4 v[60:63], v2, s[40:43], s58 offen offset:1024 sc1
  buffer_load_dwordx4 v[64:67], v2, s[40:43], s58 offen offset:2048 sc1
  buffer_load_dwordx4 v[68:71], v2, s[40:43], s58 offen offset:3072 sc1
  s_waitcnt vmcnt(0)
  s_branch L_b_have
L_red:
  s_mov_b32 s48, s36
  s_and_b32 s49, s37, 0xffff
  s_mov_b32 s50, 0x200000
  s_mov_b32 s51, 0x20000
  v_lshlrev_b32 v2, 4, v0
  v_mov_b32 v7, 0
  s_mov_b32 s57, 0
  v_and_b32 v3, 4, v1
  v_cmp_ne_u32 vcc, 0, v3
  v_bfe_u32 v3, v1, 4, 6
  v_lshrrev_b32 v4, 3, v3
  s_lshr_b32 s58, vcc_lo, s95
  s_ff1_i32_b32 s58, s58
  s_bfm_b32 s58, s58, s95
  s_cmp_eq_u32 s62, 0
  s_cselect_b32 s59, s58, 0
  v_lshlrev_b32 v4, 7, v4
  v_add_u32 v4, 0xd086000, v4
  v_lshlrev_b32 v3, 6, v3
  v_add_u32 v3, 0xd087000, v3
  v_cmp_gt_u32 vcc, 32, v0
  v_and_b32 v5, 15, v0
  v_lshrrev_b32 v6, 4, v0
  v_cndmask_b32 v3, v3, v4, vcc
  v_cndmask_b32 v4, 16, 32, vcc
  buffer_load_dword v16, v3, s[40:43], 0 offen sc1
  v_lshlrev_b32 v24, 10, v5
  v_lshl_add_u32 v24, v6, 4, v24
  v_bfe_u32 v17, v0, 2, 1
  v_lshlrev_b32 v17, 1, v17
  v_sub_u32 v17, v6, v17
  v_bfe_u32 v18, v0, 3, 1
  v_bfe_u32 v19, v0, 1, 1
  v_lshl_add_u32 v18, v18, 1, v19
  v_lshl_add_u32 v17, v17, 2, v18
  v_and_b32 v18, 1, v0
  v_lshlrev_b32 v18, 4, v18
  v_mov_b32 v19, 0x3f80
  v_lshlrev_b32 v18, v18, v19
  v_cmp_eq_u32 vcc, 0, v17
  s_nop 1
  v_cndmask_b32 v8, 0, v18, vcc
  v_cmp_eq_u32 vcc, 1, v17
  s_nop 1
  v_cndmask_b32 v9, 0, v18, vcc
  v_cmp_eq_u32 vcc, 2, v17
  s_nop 1
  v_cndmask_b32 v10, 0, v18, vcc
  v_cmp_eq_u32 vcc, 3, v17
  s_nop 1
  v_cndmask_b32 v11, 0, v18, vcc
  v_cmp_eq_u32 vcc, 4, v17
  s_nop 1
  v_cndmask_b32 v12, 0, v18, vcc
  v_cmp_eq_u32 vcc, 5, v17
  s_nop 1
  v_cndmask_b32 v13, 0, v18, vcc
  v_cmp_eq_u32 vcc, 6, v17
  s_nop 1
  v_cndmask_b32 v14, 0, v18, vcc
  v_cmp_eq_u32 vcc, 7, v17
  s_nop 1
  v_cndmask_b32 v15, 0, v18, vcc
  v_readlane_b32 s63, v1, s95
L_r_wait:
  s_waitcnt vmcnt(0)
  v_cmp_gt_u32 vcc, v4, v16
  s_nop 0
  s_and_b64 vcc, vcc, s[58:59]
  s_cbranch_scc0 L_r_go
  buffer_load_dword v16, v3, s[40:43], 0 offen sc1
  s_add_u32 s57, s57, 1
  s_cmp_gt_u32 s57, 1048576
  s_cbranch_scc1 L_exit
  s_branch L_r_wait
L_r_go:
  s_bfe_u32 s58, s63, 0x60004
  s_bfe_u32 s59, s63, 0x1000e
  s_lshl1_add_u32 s58, s58, s59
  s_mul_i32 s64, s58, 786432
  s_bfe_u32 s59, s63, 0x2000c
  s_lshl2_add_u32 s59, s59, s44
  s_lshl_b32 s58, s58, 14
  s_lshl_b32 s71, s59, 6
  s_add_u32 s71, s71, s58
  s_lshl_b32 s59, s59, 10
  s_add_u32 s64, s64, s59
  s_add_u32 s64, s64, 0x6000000
  s_bitcmp1_b32 s63, 2
  s_cselect_b32 s64, 0x40000000, s64
  buffer_load_dwordx4 v[64:67], v2, s[40:43], s64 offen sc1
  s_add_u32 s64, s64, 0x4000
  buffer_load_dwordx4 v[68:71], v2, s[40:43], s64 offen sc1
  s_add_u32 s64, s64, 0x4000
  buffer_load_dwordx4 v[72:75], v2, s[40:43], s64 offen sc1
  s_add_u32 s64, s64, 0x4000
  buffer_load_dwordx4 v[76:79], v2, s[40:43], s64 offen sc1
  s_add_u32 s64, s64, 0x4000
  buffer_load_dwordx4 v[80:83], v2, s[40:43], s64 offen sc1
  s_add_u32 s64, s64, 0x4000
  buffer_load_dwordx4 v[84:87], v2, s[40:43], s64 offen sc1
  s_add_u32 s64, s64, 0x4000
  buffer_load_dwordx4 v[88:91], v2, s[40:43], s64 offen sc1
  s_add_u32 s64, s64, 0x4000
  buffer_load_dwordx4 v[92:95], v2, s[40:43], s64 offen sc1
  s_add_u32 s64, s64, 0x4000
  buffer_load_dwordx4 v[96:99], v2, s[40:43], s64 offen sc1
  s_add_u32 s64, s64, 0x4000
  buffer_load_dwordx4 v[100:103], v2, s[40:43], s64 offen sc1
  s_add_u32 s64, s64, 0x4000
  buffer_load_dwordx4 v[104:107], v2, s[40:43], s64 offen sc1
  s_add_u32 s64, s64, 0x4000
  buffer_load_dwordx4 v[108:111], v2, s[40:43], s64 offen sc1
  s_add_u32 s64, s64, 0x4000
  buffer_load_dwordx4 v[112:115], v2, s[40:43], s64 offen sc1
  s_add_u32 s64, s64, 0x4000
  buffer_load_dwordx4 v[116:119], v2, s[40:43], s64 offen sc1
  s_add_u32 s64, s64, 0x4000
  buffer_load_dwordx4 v[120:123], v2, s[40:43], s64 offen sc1
  s_add_u32 s64, s64, 0x4000
L_r_loop:
  s_mov_b32 s61, s63
  s_mov_b32 s65, s71
  s_add_u32 s95, s95, 1
  s_nop 0
  v_readlane_b32 s63, v1, s95
  buffer_load_dwordx4 v[124:127], v2, s[40:43], s64 offen sc1
  s_add_u32 s64, s64, 0x4000
  s_waitcnt vmcnt(15)
  v_mfma_f32_16x16x32_bf16 v[16:19], v[8:11], v[64:67], 0
  v_mfma_f32_16x16x32_bf16 v[20:23], v[12:15], v[64:67], 0
  buffer_load_dwordx4 v[64:67], v2, s[40:43], s64 offen sc1
  s_add_u32 s64, s64, 0x4000
  s_waitcnt vmcnt(15)
  v_mfma_f32_16x16x32_bf16 v[16:19], v[8:11], v[68:71], v[16:19]
  v_mfma_f32_16x16x32_bf16 v[20:23], v[12:15], v[68:71], v[20:23]
  buffer_load_dwordx4 v[68:71], v2, s[40:43], s64 offen sc1
  s_add_u32 s64, s64, 0x4000
  s_waitcnt vmcnt(15)
  v_mfma_f32_16x16x32_bf16 v[16:19], v[8:11], v[72:75], v[16:19]
  v_mfma_f32_16x16x32_bf16 v[20:23], v[12:15], v[72:75], v[20:23]
  buffer_load_dwordx4 v[72:75], v2, s[40:43], s64 offen sc1
  s_add_u32 s64, s64, 0x4000
  s_waitcnt vmcnt(15)
  v_mfma_f32_16x16x32_bf16 v[16:19], v[8:11], v[76:79], v[16:19]
  v_mfma_f32_16x16x32_bf16 v[20:23], v[12:15], v[76:79], v[20:23]
  buffer_load_dwordx4 v[76:79], v2, s[40:43], s64 offen sc1
  s_add_u32 s64, s64, 0x4000
  s_waitcnt vmcnt(15)
  v_mfma_f32_16x16x32_bf16 v[16:19], v[8:11], v[80:83], v[16:19]
  v_mfma_f32_16x16x32_bf16 v[20:23], v[12:15], v[80:83], v[20:23]
  buffer_load_dwordx4 v[80:83], v2, s[40:43], s64 offen sc1
  s_add_u32 s64, s64, 0x4000
  s_waitcnt vmcnt(15)
  v_mfma_f32_16x16x32_bf16 v[16:19], v[8:11], v[84:87], v[16:19]
  v_mfma_f32_16x16x32_bf16 v[20:23], v[12:15], v[84:87], v[20:23]
  buffer_load_dwordx4 v[84:87], v2, s[40:43], s64 offen sc1
  s_add_u32 s64, s64, 0x4000
  s_waitcnt vmcnt(15)
  v_mfma_f32_16x16x32_bf16 v[16:19], v[8:11], v[88:91], v[16:19]
  v_mfma_f32_16x16x32_bf16 v[20:23], v[12:15], v[88:91], v[20:23]
  buffer_load_dwordx4 v[88:91], v2, s[40:43], s64 offen sc1
  s_add_u32 s64, s64, 0x4000
  s_waitcnt vmcnt(15)
  v_mfma_f32_16x16x32_bf16 v[16:19], v[8:11], v[92:95], v[16:19]
  v_mfma_f32_16x16x32_bf16 v[20:23], v[12:15], v[92:95], v[20:23]
  buffer_load_dwordx4 v[92:95], v2, s[40:43], s64 offen sc1
  s_add_u32 s64, s64, 0x4000
  s_waitcnt vmcnt(15)
  v_mfma_f32_16x16x32_bf16 v[16:19], v[8:11], v[96:99], v[16:19]
  v_mfma_f32_16x16x32_bf16 v[20:23], v[12:15], v[96:99], v[20:23]
  buffer_load_dwordx4 v[96:99], v2, s[40:43], s64 offen sc1
  s_add_u32 s64, s64, 0x4000
  s_waitcnt vmcnt(15)
  v_mfma_f32_16x16x32_bf16 v[16:19], v[8:11], v[100:103], v[16:19]
  v_mfma_f32_16x16x32_bf16 v[20:23], v[12:15], v[100:103], v[20:23]
  buffer_load_dwordx4 v[100:103], v2, s[40:43], s64 offen sc1
  s_add_u32 s64, s64, 0x4000
  s_waitcnt vmcnt(15)
  v_mfma_f32_16x16x32_bf16 v[16:19], v[8:11], v[104:107], v[16:19]
  v_mfma_f32_16x16x32_bf16 v[20:23], v[12:15], v[104:107], v[20:23]
  buffer_load_dwordx4 v[104:107], v2, s[40:43], s64 offen sc1
  s_add_u32 s64, s64, 0x4000
  s_waitcnt vmcnt(15)
  v_mfma_f32_16x16x32_bf16 v[16:19], v[8:11], v[108:111], v[16:19]
  v_mfma_f32_16x16x32_bf16 v[20:23], v[12:15], v[108:111], v[20:23]
  buffer_load_dwordx4 v[108:111], v2, s[40:43], s64 offen sc1
  s_add_u32 s64, s64, 0x4000
  s_waitcnt vmcnt(15)
  v_mfma_f32_16x16x32_bf16 v[16:19], v[8:11], v[112:115], v[16:19]
  v_mfma_f32_16x16x32_bf16 v[20:23], v[12:15], v[112:115], v[20:23]
  buffer_load_dwordx4 v[112:115], v2, s[40:43], s64 offen sc1
  s_add_u32 s64, s64, 0x4000
  s_waitcnt vmcnt(15)
  v_mfma_f32_16x16x32_bf16 v[16:19], v[8:11], v[116:119], v[16:19]
  v_mfma_f32_16x16x32_bf16 v[20:23], v[12:15], v[116:119], v[20:23]
  buffer_load_dwordx4 v[116:119], v2, s[40:43], s64 offen sc1
  s_add_u32 s64, s64, 0x4000
  s_waitcnt vmcnt(15)
  v_mfma_f32_16x16x32_bf16 v[16:19], v[8:11], v[120:123], v[16:19]
  v_mfma_f32_16x16x32_bf16 v[20:23], v[12:15], v[120:123], v[20:23]
  buffer_load_dwordx4 v[120:123], v2, s[40:43], s64 offen sc1
  s_add_u32 s64, s64, 0x4000
  s_waitcnt vmcnt(15)
  v_mfma_f32_16x16x32_bf16 v[16:19], v[8:11], v[124:127], v[16:19]
  v_mfma_f32_16x16x32_bf16 v[20:23], v[12:15], v[124:127], v[20:23]
  buffer_load_dwordx4 v[124:127], v2, s[40:43], s64 offen sc1
  s_add_u32 s64, s64, 0x4000
  s_waitcnt vmcnt(15)
  v_mfma_f32_16x16x32_bf16 v[16:19], v[8:11], v[64:67], v[16:19]
  v_mfma_f32_16x16x32_bf16 v[20:23], v[12:15], v[64:67], v[20:23]
  s_cmp_lg_u32 s62, 0
  s_cbranch_scc1 L_r_stage
L_r_stageback:
  buffer_load_dwordx4 v[64:67], v2, s[40:43], s64 offen sc1
  s_add_u32 s64, s64, 0x4000
  s_waitcnt vmcnt(15)
  v_mfma_f32_16x16x32_bf16 v[16:19], v[8:11], v[68:71], v[16:19]
  v_mfma_f32_16x16x32_bf16 v[20:23], v[12:15], v[68:71], v[20:23]
  buffer_load_dwordx4 v[68:71], v2, s[40:43], s64 offen sc1
  s_add_u32 s64, s64, 0x4000
  s_waitcnt vmcnt(15)
  v_mfma_f32_16x16x32_bf16 v[16:19], v[8:11], v[72:75], v[16:19]
  v_mfma_f32_16x16x32_bf16 v[20:23], v[12:15], v[72:75], v[20:23]
  buffer_load_dwordx4 v[72:75], v2, s[40:43], s64 offen sc1
  s_add_u32 s64, s64, 0x4000
  s_waitcnt vmcnt(15)
  v_mfma_f32_16x16x32_bf16 v[16:19], v[8:11], v[76:79], v[16:19]
  v_mfma_f32_16x16x32_bf16 v[20:23], v[12:15], v[76:79], v[20:23]
  buffer_load_dwordx4 v[76:79], v2, s[40:43], s64 offen sc1
  s_add_u32 s64, s64, 0x4000
  s_waitcnt vmcnt(15)
  v_mfma_f32_16x16x32_bf16 v[16:19], v[8:11], v[80:83], v[16:19]
  v_mfma_f32_16x16x32_bf16 v[20:23], v[12:15], v[80:83], v[20:23]
  buffer_load_dwordx4 v[80:83], v2, s[40:43], s64 offen sc1
  s_add_u32 s64, s64, 0x4000
  s_waitcnt vmcnt(15)
  v_mfma_f32_16x16x32_bf16 v[16:19], v[8:11], v[84:87], v[16:19]
  v_mfma_f32_16x16x32_bf16 v[20:23], v[12:15], v[84:87], v[20:23]
  buffer_load_dwordx4 v[84:87], v2, s[40:43], s64 offen sc1
  s_add_u32 s64, s64, 0x4000
  s_waitcnt vmcnt(15)
  v_mfma_f32_16x16x32_bf16 v[16:19], v[8:11], v[88:91], v[16:19]
  v_mfma_f32_16x16x32_bf16 v[20:23], v[12:15], v[88:91], v[20:23]
  buffer_load_dwordx4 v[88:91], v2, s[40:43], s64 offen sc1
  s_add_u32 s64, s64, 0x4000
  s_waitcnt vmcnt(15)
  v_mfma_f32_16x16x32_bf16 v[16:19], v[8:11], v[92:95], v[16:19]
  v_mfma_f32_16x16x32_bf16 v[20:23], v[12:15], v[92:95], v[20:23]
  buffer_load_dwordx4 v[92:95], v2, s[40:43], s64 offen sc1
  s_add_u32 s64, s64, 0x4000
  s_waitcnt vmcnt(15)
  v_mfma_f32_16x16x32_bf16 v[16:19], v[8:11], v[96:99], v[16:19]
  v_mfma_f32_16x16x32_bf16 v[20:23], v[12:15], v[96:99], v[20:23]
  buffer_load_dwordx4 v[96:99], v2, s[40:43], s64 offen sc1
  s_add_u32 s64, s64, 0x4000
  s_waitcnt vmcnt(15)
  v_mfma_f32_16x16x32_bf16 v[16:19], v[8:11], v[100:103], v[16:19]
  v_mfma_f32_16x16x32_bf16 v[20:23], v[12:15], v[100:103], v[20:23]
  buffer_load_dwordx4 v[100:103], v2, s[40:43], s64 offen sc1
  s_add_u32 s64, s64, 0x4000
  s_waitcnt vmcnt(15)
  v_mfma_f32_16x16x32_bf16 v[16:19], v[8:11], v[104:107], v[16:19]
  v_mfma_f32_16x16x32_bf16 v[20:23], v[12:15], v[104:107], v[20:23]
  buffer_load_dwordx4 v[104:107], v2, s[40:43], s64 offen sc1
  s_add_u32 s64, s64, 0x4000
  s_waitcnt vmcnt(15)
  v_mfma_f32_16x16x32_bf16 v[16:19], v[8:11], v[108:111], v[16:19]
  v_mfma_f32_16x16x32_bf16 v[20:23], v[12:15], v[108:111], v[20:23]
  buffer_load_dwordx4 v[108:111], v2, s[40:43], s64 offen sc1
  s_add_u32 s64, s64, 0x4000
  s_waitcnt vmcnt(15)
  v_mfma_f32_16x16x32_bf16 v[16:19], v[8:11], v[112:115], v[16:19]
  v_mfma_f32_16x16x32_bf16 v[20:23], v[12:15], v[112:115], v[20:23]
  buffer_load_dwordx4 v[112:115], v2, s[40:43], s64 offen sc1
  s_add_u32 s64, s64, 0x4000
  s_waitcnt vmcnt(15)
  v_mfma_f32_16x16x32_bf16 v[16:19], v[8:11], v[116:119], v[16:19]
  v_mfma_f32_16x16x32_bf16 v[20:23], v[12:15], v[116:119], v[20:23]
  buffer_load_dwordx4 v[116:119], v2, s[40:43], s64 offen sc1
  s_add_u32 s64, s64, 0x4000
  s_waitcnt vmcnt(15)
  v_mfma_f32_16x16x32_bf16 v[16:19], v[8:11], v[120:123], v[16:19]
  v_mfma_f32_16x16x32_bf16 v[20:23], v[12:15], v[120:123], v[20:23]
  buffer_load_dwordx4 v[120:123], v2, s[40:43], s64 offen sc1
  s_add_u32 s64, s64, 0x4000
  s_waitcnt vmcnt(15)
  v_mfma_f32_16x16x32_bf16 v[16:19], v[8:11], v[124:127], v[16:19]
  v_mfma_f32_16x16x32_bf16 v[20:23], v[12:15], v[124:127], v[20:23]
  buffer_load_dwordx4 v[124:127], v2, s[40:43], s64 offen sc1
  s_add_u32 s64, s64, 0x4000
  s_waitcnt vmcnt(15)
  v_mfma_f32_16x16x32_bf16 v[16:19], v[8:11], v[64:67], v[16:19]
  v_mfma_f32_16x16x32_bf16 v[20:23], v[12:15], v[64:67], v[20:23]
  s_bfe_u32 s58, s63, 0x60004
  s_bfe_u32 s59, s63, 0x1000e
  s_lshl1_add_u32 s58, s58, s59
  s_mul_i32 s64, s58, 786432
  s_bfe_u32 s59, s63, 0x2000c
  s_lshl2_add_u32 s59, s59, s44
  s_lshl_b32 s58, s58, 14
  s_lshl_b32 s71, s59, 6
  s_add_u32 s71, s71, s58
  s_lshl_b32 s59, s59, 10
  s_add_u32 s64, s64, s59
  s_add_u32 s64, s64, 0x6000000
  s_bitcmp1_b32 s63, 2
  s_cselect_b32 s64, 0x40000000, s64
  buffer_load_dwordx4 v[64:67], v2, s[40:43], s64 offen sc1
  s_add_u32 s64, s64, 0x4000
  s_waitcnt vmcnt(15)
  v_mfma_f32_16x16x32_bf16 v[16:19], v[8:11], v[68:71], v[16:19]
  v_mfma_f32_16x16x32_bf16 v[20:23], v[12:15], v[68:71], v[20:23]
  buffer_load_dwordx4 v[68:71], v2, s[40:43], s64 offen sc1
  s_add_u32 s64, s64, 0x4000
  s_waitcnt vmcnt(15)
  v_mfma_f32_16x16x32_bf16 v[16:19], v[8:11], v[72:75], v[16:19]
  v_mfma_f32_16x16x32_bf16 v[20:23], v[12:15], v[72:75], v[20:23]
  buffer_load_dwordx4 v[72:75], v2, s[40:43], s64 offen sc1
  s_add_u32 s64, s64, 0x4000
  s_waitcnt vmcnt(15)
  v_mfma_f32_16x16x32_bf16 v[16:19], v[8:11], v[76:79], v[16:19]
  v_mfma_f32_16x16x32_bf16 v[20:23], v[12:15], v[76:79], v[20:23]
  buffer_load_dwordx4 v[76:79], v2, s[40:43], s64 offen sc1
  s_add_u32 s64, s64, 0x4000
  s_waitcnt vmcnt(15)
  v_mfma_f32_16x16x32_bf16 v[16:19], v[8:11], v[80:83], v[16:19]
  v_mfma_f32_16x16x32_bf16 v[20:23], v[12:15], v[80:83], v[20:23]
  buffer_load_dwordx4 v[80:83], v2, s[40:43], s64 offen sc1
  s_add_u32 s64, s64, 0x4000
  s_waitcnt vmcnt(15)
  v_mfma_f32_16x16x32_bf16 v[16:19], v[8:11], v[84:87], v[16:19]
  v_mfma_f32_16x16x32_bf16 v[20:23], v[12:15], v[84:87], v[20:23]
  buffer_load_dwordx4 v[84:87], v2, s[40:43], s64 offen sc1
  s_add_u32 s64, s64, 0x4000
  s_waitcnt vmcnt(15)
  v_mfma_f32_16x16x32_bf16 v[16:19], v[8:11], v[88:91], v[16:19]
  v_mfma_f32_16x16x32_bf16 v[20:23], v[12:15], v[88:91], v[20:23]
  buffer_load_dwordx4 v[88:91], v2, s[40:43], s64 offen sc1
  s_add_u32 s64, s64, 0x4000
  s_waitcnt vmcnt(15)
  v_mfma_f32_16x16x32_bf16 v[16:19], v[8:11], v[92:95], v[16:19]
  v_mfma_f32_16x16x32_bf16 v[20:23], v[12:15], v[92:95], v[20:23]
  buffer_load_dwordx4 v[92:95], v2, s[40:43], s64 offen sc1
  s_add_u32 s64, s64, 0x4000
  s_waitcnt vmcnt(15)
  v_mfma_f32_16x16x32_bf16 v[16:19], v[8:11], v[96:99], v[16:19]
  v_mfma_f32_16x16x32_bf16 v[20:23], v[12:15], v[96:99], v[20:23]
  buffer_load_dwordx4 v[96:99], v2, s[40:43], s64 offen sc1
  s_add_u32 s64, s64, 0x4000
  s_waitcnt vmcnt(15)
  v_mfma_f32_16x16x32_bf16 v[16:19], v[8:11], v[100:103], v[16:19]
  v_mfma_f32_16x16x32_bf16 v[20:23], v[12:15], v[100:103], v[20:23]
  buffer_load_dwordx4 v[100:103], v2, s[40:43], s64 offen sc1
  s_add_u32 s64, s64, 0x4000
  s_waitcnt vmcnt(15)
  v_mfma_f32_16x16x32_bf16 v[16:19], v[8:11], v[104:107], v[16:19]
  v_mfma_f32_16x16x32_bf16 v[20:23], v[12:15], v[104:107], v[20:23]
  buffer_load_dwordx4 v[104:107], v2, s[40:43], s64 offen sc1
  s_add_u32 s64, s64, 0x4000
  s_waitcnt vmcnt(15)
  v_mfma_f32_16x16x32_bf16 v[16:19], v[8:11], v[108:111], v[16:19]
  v_mfma_f32_16x16x32_bf16 v[20:23], v[12:15], v[108:111], v[20:23]
  buffer_load_dwordx4 v[108:111], v2, s[40:43], s64 offen sc1
  s_add_u32 s64, s64, 0x4000
  s_waitcnt vmcnt(15)
  v_mfma_f32_16x16x32_bf16 v[16:19], v[8:11], v[112:115], v[16:19]
  v_mfma_f32_16x16x32_bf16 v[20:23], v[12:15], v[112:115], v[20:23]
  buffer_load_dwordx4 v[112:115], v2, s[40:43], s64 offen sc1
  s_add_u32 s64, s64, 0x4000
  s_waitcnt vmcnt(15)
  v_mfma_f32_16x16x32_bf16 v[16:19], v[8:11], v[116:119], v[16:19]
  v_mfma_f32_16x16x32_bf16 v[20:23], v[12:15], v[116:119], v[20:23]
  buffer_load_dwordx4 v[116:119], v2, s[40:43], s64 offen sc1
  s_add_u32 s64, s64, 0x4000
  s_waitcnt vmcnt(15)
  v_mfma_f32_16x16x32_bf16 v[16:19], v[8:11], v[120:123], v[16:19]
  v_mfma_f32_16x16x32_bf16 v[20:23], v[12:15], v[120:123], v[20:23]
  buffer_load_dwordx4 v[120:123], v2, s[40:43], s64 offen sc1
  s_add_u32 s64, s64, 0x4000
  s_waitcnt vmcnt(15)
  v_mfma_f32_16x16x32_bf16 v[16:19], v[8:11], v[124:127], v[16:19]
  v_mfma_f32_16x16x32_bf16 v[20:23], v[12:15], v[124:127], v[20:23]
  s_nop 6
  v_cvt_pk_bf16_f32 v32, v16, v17
  v_cvt_pk_bf16_f32 v33, v18, v19
  v_cvt_pk_bf16_f32 v34, v20, v21
  v_cvt_pk_bf16_f32 v35, v22, v23
  buffer_store_dwordx4 v[32:35], v24, s[48:51], s65 offen
  s_bitcmp1_b32 s63, 2
  s_cbranch_scc0 L_r_loop
  s_waitcnt vmcnt(1)
  s_branch L_next
L_r_stage:
  s_bfe_u32 s66, s61, 0x60004
  s_lshl_b32 s66, s66, 6
  s_add_u32 s66, s66, 0xd087000
L_r_st2:
  buffer_load_dword v3, v7, s[40:43], s66 offen sc1
  s_add_u32 s57, s57, 1
  s_cmp_gt_u32 s57, 1048576
  s_cbranch_scc1 L_exit
  s_waitcnt vmcnt(0)
  v_cmp_gt_u32 vcc, 16, v3
  s_cbranch_vccnz L_r_st2
  s_branch L_r_stageback
L_feed:
  s_cmp_lt_u32 s57, 4
  s_cselect_b64 s[52:53], s[10:11], s[8:9]
  s_cselect_b64 s[48:49], s[14:15], s[12:13]
  s_cselect_b64 s[4:5], s[16:17], s[24:25]
  s_cselect_b32 s72, 0x21, 0x30
  s_cselect_b32 s67, 16, 32
  s_cselect_b32 s69, 1.0, 0x3e0293ee
  s_cselect_b32 s70, 0, 0xffe80000
  s_cselect_b32 s74, 2, 4
  s_cmp_eq_u32 s57, 6
  s_cselect_b64 s[48:49], s[26:27], s[48:49]
  s_cselect_b64 s[4:5], s[28:29], s[4:5]
  s_cselect_b32 s72, 0x54, s72
  s_cselect_b32 s67, 64, s67
  s_cselect_b32 s69, 1.0, s69
  s_cselect_b32 s70, 0, s70
  s_cselect_b32 s74, 2, s74
  s_lshl_b32 s58, s57, 2
  s_lshr_b32 s73, 0x0233210, s58
  s_and_b32 s73, s73, 15
  s_ashr_i32 s71, s70, 2
  s_add_u32 s71, s71, 0x2000
  s_and_b32 s53, s53, 0xffff
  s_mov_b32 s54, 0x200000
  s_mov_b32 s55, 0x20000
  s_cmp_lt_u32 s44, 2
  s_cselect_b64 s[48:49], s[48:49], s[4:5]
  s_cselect_b32 s58, 0, 4
  s_lshr_b32 s72, s72, s58
  s_and_b32 s72, s72, 15
  s_and_b32 s49, s49, 0xffff
  s_mov_b32 s50, 0x400000
  s_mov_b32 s51, 0x20000
  v_lshlrev_b32 v2, 4, v0
  v_mov_b32 v6, 0
  v_lshrrev_b32 v3, 3, v0
  v_lshlrev_b32 v20, 13, v3
  v_and_b32 v3, 2, v3
  v_and_b32 v4, 7, v0
  v_xor_b32 v3, v3, v4
  v_lshl_add_u32 v20, v3, 4, v20
  v_xor_b32 v21, 64, v20
  s_lshl_b32 s60, s44, 14
  s_add_u32 s60, s60, 0x18000
  s_and_b32 s59, s44, 1
  s_lshl1_add_u32 s75, s56, s59
  s_lshl_b32 s75, s75, 7
  s_lshl_b32 s58, s57, 2
  s_lshr_b32 s78, 0, s58
  s_and_b32 s78, s78, 15
  s_lshl_b32 s58, s78, 20
  s_or_b32 s75, s75, s58
  s_cmp_lt_u32 s72, 3
  s_cbranch_scc1 L_f_w_3
  s_add_u32 m0, s60, 0
  s_xor_b32 s58, s75, 0
  buffer_load_dwordx4 v20, s[48:51], s58 offen  lds
  s_add_u32 m0, s60, 1024
  s_xor_b32 s58, s75, 65536
  buffer_load_dwordx4 v21, s[48:51], s58 offen  lds
  s_add_u32 m0, s60, 2048
  s_xor_b32 s58, s75, 131072
  buffer_load_dwordx4 v20, s[48:51], s58 offen  lds
  s_add_u32 m0, s60, 3072
  s_xor_b32 s58, s75, 196608
  buffer_load_dwordx4 v21, s[48:51], s58 offen  lds
  s_branch L_f_w_3e
L_f_w_3:
  s_add_u32 m0, s60, 0
  s_xor_b32 s58, s75, 0
  buffer_load_dwordx4 v20, s[48:51], s58 offen nt lds
  s_add_u32 m0, s60, 1024
  s_xor_b32 s58, s75, 65536
  buffer_load_dwordx4 v21, s[48:51], s58 offen nt lds
  s_add_u32 m0, s60, 2048
  s_xor_b32 s58, s75, 131072
  buffer_load_dwordx4 v20, s[48:51], s58 offen nt lds
  s_add_u32 m0, s60, 3072
  s_xor_b32 s58, s75, 196608
  buffer_load_dwordx4 v21, s[48:51], s58 offen nt lds
L_f_w_3e:
  s_cmp_lt_u32 s72, 3
  s_cbranch_scc1 L_f_w_4
  s_add_u32 m0, s60, 4096
  s_xor_b32 s58, s75, 262144
  buffer_load_dwordx4 v20, s[48:51], s58 offen  lds
  s_add_u32 m0, s60, 5120
  s_xor_b32 s58, s75, 327680
  buffer_load_dwordx4 v21, s[48:51], s58 offen  lds
  s_add_u32 m0, s60, 6144
  s_xor_b32 s58, s75, 393216
  buffer_load_dwordx4 v20, s[48:51], s58 offen  lds
  s_add_u32 m0, s60, 7168
  s_xor_b32 s58, s75, 458752
  buffer_load_dwordx4 v21, s[48:51], s58 offen  lds
  s_branch L_f_w_4e
L_f_w_4:
  s_add_u32 m0, s60, 4096
  s_xor_b32 s58, s75, 262144
  buffer_load_dwordx4 v20, s[48:51], s58 offen nt lds
  s_add_u32 m0, s60, 5120
  s_xor_b32 s58, s75, 327680
  buffer_load_dwordx4 v21, s[48:51], s58 offen nt lds
  s_add_u32 m0, s60, 6144
  s_xor_b32 s58, s75, 393216
  buffer_load_dwordx4 v20, s[48:51], s58 offen nt lds
  s_add_u32 m0, s60, 7168
  s_xor_b32 s58, s75, 458752
  buffer_load_dwordx4 v21, s[48:51], s58 offen nt lds
L_f_w_4e:
  s_cmp_lt_u32 s72, 3
  s_cbranch_scc1 L_f_w_5
  s_add_u32 m0, s60, 8192
  s_xor_b32 s58, s75, 524288
  buffer_load_dwordx4 v20, s[48:51], s58 offen  lds
  s_add_u32 m0, s60, 9216
  s_xor_b32 s58, s75, 589824
  buffer_load_dwordx4 v21, s[48:51], s58 offen  lds
  s_add_u32 m0, s60, 10240
  s_xor_b32 s58, s75, 655360
  buffer_load_dwordx4 v20, s[48:51], s58 offen  lds
  s_add_u32 m0, s60, 11264
  s_xor_b32 s58, s75, 720896
  buffer_load_dwordx4 v21, s[48:51], s58 offen  lds
  s_branch L_f_w_5e
L_f_w_5:
  s_add_u32 m0, s60, 8192
  s_xor_b32 s58, s75, 524288
  buffer_load_dwordx4 v20, s[48:51], s58 offen nt lds
  s_add_u32 m0, s60, 9216
  s_xor_b32 s58, s75, 589824
  buffer_load_dwordx4 v21, s[48:51], s58 offen nt lds
  s_add_u32 m0, s60, 10240
  s_xor_b32 s58, s75, 655360
  buffer_load_dwordx4 v20, s[48:51], s58 offen nt lds
  s_add_u32 m0, s60, 11264
  s_xor_b32 s58, s75, 720896
  buffer_load_dwordx4 v21, s[48:51], s58 offen nt lds
L_f_w_5e:
  s_cmp_lt_u32 s72, 3
  s_cbranch_scc1 L_f_w_6
  s_add_u32 m0, s60, 12288
  s_xor_b32 s58, s75, 786432
  buffer_load_dwordx4 v20, s[48:51], s58 offen  lds
  s_add_u32 m0, s60, 13312
  s_xor_b32 s58, s75, 851968
  buffer_load_dwordx4 v21, s[48:51], s58 offen  lds
  s_add_u32 m0, s60, 14336
  s_xor_b32 s58, s75, 917504
  buffer_load_dwordx4 v20, s[48:51], s58 offen  lds
  s_add_u32 m0, s60, 15360
  s_xor_b32 s58, s75, 983040
  buffer_load_dwordx4 v21, s[48:51], s58 offen  lds
  s_branch L_f_w_6e
L_f_w_6:
  s_add_u32 m0, s60, 12288
  s_xor_b32 s58, s75, 786432
  buffer_load_dwordx4 v20, s[48:51], s58 offen nt lds
  s_add_u32 m0, s60, 13312
  s_xor_b32 s58, s75, 851968
  buffer_load_dwordx4 v21, s[48:51], s58 offen nt lds
  s_add_u32 m0, s60, 14336
  s_xor_b32 s58, s75, 917504
  buffer_load_dwordx4 v20, s[48:51], s58 offen nt lds
  s_add_u32 m0, s60, 15360
  s_xor_b32 s58, s75, 983040
  buffer_load_dwordx4 v21, s[48:51], s58 offen nt lds
L_f_w_6e:
  s_mov_b32 s76, 0x40000000
  v_and_b32 v32, 15, v0
  v_mov_b32 v33, 1
  s_lshl2_add_u32 s58, s44, s57
  s_cmp_ge_u32 s58, 4
  s_cbranch_scc1 L_f_nogate
  s_mov_b64 s[4:5], s[8:9]
  s_mov_b64 s[6:7], s[34:35]
  v_lshrrev_b32 v4, 4, v0
  v_lshlrev_b32 v4, 4, v4
  v_lshl_add_u32 v5, v32, 10, v4
  s_lshl2_add_u32 s77, s56, s57
  s_lshl_b32 s58, s77, 14
  v_add_u32 v5, s58, v5
  global_load_dwordx4 v[64:67], v5, s[4:5] offset:0
  global_load_dwordx4 v[128:131], v4, s[6:7] offset:0
  global_load_dwordx4 v[68:71], v5, s[4:5] offset:64
  global_load_dwordx4 v[132:135], v4, s[6:7] offset:64
  global_load_dwordx4 v[72:75], v5, s[4:5] offset:128
  global_load_dwordx4 v[136:139], v4, s[6:7] offset:128
  global_load_dwordx4 v[76:79], v5, s[4:5] offset:192
  global_load_dwordx4 v[140:143], v4, s[6:7] offset:192
  global_load_dwordx4 v[80:83], v5, s[4:5] offset:256
  global_load_dwordx4 v[144:147], v4, s[6:7] offset:256
  global_load_dwordx4 v[84:87], v5, s[4:5] offset:320
  global_load_dwordx4 v[148:151], v4, s[6:7] offset:320
  global_load_dwordx4 v[88:91], v5, s[4:5] offset:384
  global_load_dwordx4 v[152:155], v4, s[6:7] offset:384
  global_load_dwordx4 v[92:95], v5, s[4:5] offset:448
  global_load_dwordx4 v[156:159], v4, s[6:7] offset:448
  global_load_dwordx4 v[96:99], v5, s[4:5] offset:512
  global_load_dwordx4 v[160:163], v4, s[6:7] offset:512
  global_load_dwordx4 v[100:103], v5, s[4:5] offset:576
  global_load_dwordx4 v[164:167], v4, s[6:7] offset:576
  global_load_dwordx4 v[104:107], v5, s[4:5] offset:640
  global_load_dwordx4 v[168:171], v4, s[6:7] offset:640
  global_load_dwordx4 v[108:111], v5, s[4:5] offset:704
  global_load_dwordx4 v[172:175], v4, s[6:7] offset:704
  global_load_dwordx4 v[112:115], v5, s[4:5] offset:768
  global_load_dwordx4 v[176:179], v4, s[6:7] offset:768
  global_load_dwordx4 v[116:119], v5, s[4:5] offset:832
  global_load_dwordx4 v[180:183], v4, s[6:7] offset:832
  global_load_dwordx4 v[120:123], v5, s[4:5] offset:896
  global_load_dwordx4 v[184:187], v4, s[6:7] offset:896
  global_load_dwordx4 v[124:127], v5, s[4:5] offset:960
  global_load_dwordx4 v[188:191], v4, s[6:7] offset:960
  v_lshlrev_b32 v32, 2, v32
  s_lshl_b32 s77, s77, 6
  s_add_u32 s77, s77, 0xd0c0000
  s_lshr_b32 s76, s56, 2
  s_lshl_b32 s76, s76, 7
  s_add_u32 s76, s76, 0xd086400
L_f_nogate:
  v_lshrrev_b32 v3, 4, v0
  v_lshl_add_u32 v24, v3, 10, s60
  v_bfe_u32 v4, v0, 2, 2
  v_lshl_add_u32 v24, v4, 7, v24
  v_bfe_u32 v4, v0, 3, 2
  v_lshl_add_u32 v24, v4, 5, v24
  v_and_b32 v4, 3, v0
  v_lshl_add_u32 v24, v4, 3, v24
  v_and_b32 v4, 15, v0
  v_xor_b32 v3, v3, v4
  v_lshlrev_b32 v3, 4, v3
  v_lshl_add_u32 v16, v4, 10, v3
  s_lshl1_add_u32 s58, s78, s59
  s_lshl_b32 s58, s58, 7
  v_xor_b32 v8, s58, v2
  s_lshl_b32 s62, s72, 24
  s_lshl_b32 s58, s56, 19
  s_add_u32 s62, s62, s58
  s_lshl_b32 s58, s73, 17
  s_add_u32 s62, s62, s58
  s_lshl_b32 s58, s59, 12
  s_add_u32 s62, s62, s58
  s_add_u32 s62, s62, 0x40000000
  s_mov_b32 s65, 0xc0000000
  s_lshl_b32 s58, s57, 2
  s_cmp_eq_u32 s57, 6
  s_cselect_b32 s58, 0x1000, s58
  s_lshl_b32 s64, s56, 7
  s_add_u32 s64, s64, s58
  s_add_u32 s64, s64, 0xd080000
  s_cmp_eq_u32 s44, 0
  s_cselect_b32 s64, s64, 0x40000000
  v_xor_b32 v25, 32, v24
  v_xor_b32 v17, 64, v16
  v_xor_b32 v26, 64, v24
  v_xor_b32 v18, 128, v16
  v_xor_b32 v27, 96, v24
  v_xor_b32 v19, 192, v16
  v_xor_b32 v9, 16, v8
  v_xor_b32 v10, 32, v8
  v_xor_b32 v11, 48, v8
  v_xor_b32 v12, 64, v8
  v_xor_b32 v13, 80, v8
  v_xor_b32 v14, 96, v8
  v_xor_b32 v15, 112, v8
  s_lshl_b32 s66, s44, 13
  s_lshl_b32 s61, s73, 19
  s_add_u32 s61, s61, s66
  s_mov_b32 s63, 0
  s_mov_b32 s68, 0
  s_waitcnt vmcnt(12)
  ds_read_b64_tr_b16 a[0:1], v24 offset:0
  ds_read_b64_tr_b16 a[2:3], v24 offset:512
  ds_read_b64_tr_b16 a[64:65], v25 offset:0
  ds_read_b64_tr_b16 a[66:67], v25 offset:512
  ds_read_b64_tr_b16 a[128:129], v26 offset:0
  ds_read_b64_tr_b16 a[130:131], v26 offset:512
  ds_read_b64_tr_b16 a[192:193], v27 offset:0
  ds_read_b64_tr_b16 a[194:195], v27 offset:512
  s_waitcnt lgkmcnt(0)
  s_cmp_lt_u32 s72, 3
  s_cbranch_scc1 L_f_w_7
  s_add_u32 m0, s60, 0
  s_xor_b32 s58, s75, 1048576
  buffer_load_dwordx4 v20, s[48:51], s58 offen  lds
  s_add_u32 m0, s60, 1024
  s_xor_b32 s58, s75, 1114112
  buffer_load_dwordx4 v21, s[48:51], s58 offen  lds
  s_add_u32 m0, s60, 2048
  s_xor_b32 s58, s75, 1179648
  buffer_load_dwordx4 v20, s[48:51], s58 offen  lds
  s_add_u32 m0, s60, 3072
  s_xor_b32 s58, s75, 1245184
  buffer_load_dwordx4 v21, s[48:51], s58 offen  lds
  s_branch L_f_w_7e
L_f_w_7:
  s_add_u32 m0, s60, 0
  s_xor_b32 s58, s75, 1048576
  buffer_load_dwordx4 v20, s[48:51], s58 offen nt lds
  s_add_u32 m0, s60, 1024
  s_xor_b32 s58, s75, 1114112
  buffer_load_dwordx4 v21, s[48:51], s58 offen nt lds
  s_add_u32 m0, s60, 2048
  s_xor_b32 s58, s75, 1179648
  buffer_load_dwordx4 v20, s[48:51], s58 offen nt lds
  s_add_u32 m0, s60, 3072
  s_xor_b32 s58, s75, 1245184
  buffer_load_dwordx4 v21, s[48:51], s58 offen nt lds
L_f_w_7e:
  s_waitcnt vmcnt(12)
  ds_read_b64_tr_b16 a[4:5], v24 offset:4096
  ds_read_b64_tr_b16 a[6:7], v24 offset:4608
  ds_read_b64_tr_b16 a[68:69], v25 offset:4096
  ds_read_b64_tr_b16 a[70:71], v25 offset:4608
  ds_read_b64_tr_b16 a[132:133], v26 offset:4096
  ds_read_b64_tr_b16 a[134:135], v26 offset:4608
  ds_read_b64_tr_b16 a[196:197], v27 offset:4096
  ds_read_b64_tr_b16 a[198:199], v27 offset:4608
  s_waitcnt lgkmcnt(0)
  s_cmp_lt_u32 s72, 3
  s_cbranch_scc1 L_f_w_8
  s_add_u32 m0, s60, 4096
  s_xor_b32 s58, s75, 1310720
  buffer_load_dwordx4 v20, s[48:51], s58 offen  lds
  s_add_u32 m0, s60, 5120
  s_xor_b32 s58, s75, 1376256
  buffer_load_dwordx4 v21, s[48:51], s58 offen  lds
  s_add_u32 m0, s60, 6144
  s_xor_b32 s58, s75, 1441792
  buffer_load_dwordx4 v20, s[48:51], s58 offen  lds
  s_add_u32 m0, s60, 7168
  s_xor_b32 s58, s75, 1507328
  buffer_load_dwordx4 v21, s[48:51], s58 offen  lds
  s_branch L_f_w_8e
L_f_w_8:
  s_add_u32 m0, s60, 4096
  s_xor_b32 s58, s75, 1310720
  buffer_load_dwordx4 v20, s[48:51], s58 offen nt lds
  s_add_u32 m0, s60, 5120
  s_xor_b32 s58, s75, 1376256
  buffer_load_dwordx4 v21, s[48:51], s58 offen nt lds
  s_add_u32 m0, s60, 6144
  s_xor_b32 s58, s75, 1441792
  buffer_load_dwordx4 v20, s[48:51], s58 offen nt lds
  s_add_u32 m0, s60, 7168
  s_xor_b32 s58, s75, 1507328
  buffer_load_dwordx4 v21, s[48:51], s58 offen nt lds
L_f_w_8e:
  s_waitcnt vmcnt(12)
  ds_read_b64_tr_b16 a[8:9], v24 offset:8192
  ds_read_b64_tr_b16 a[10:11], v24 offset:8704
  ds_read_b64_tr_b16 a[72:73], v25 offset:8192
  ds_read_b64_tr_b16 a[74:75], v25 offset:8704
  ds_read_b64_tr_b16 a[136:137], v26 offset:8192
  ds_read_b64_tr_b16 a[138:139], v26 offset:8704
  ds_read_b64_tr_b16 a[200:201], v27 offset:8192
  ds_read_b64_tr_b16 a[202:203], v27 offset:8704
  s_waitcnt lgkmcnt(0)
  s_cmp_lt_u32 s72, 3
  s_cbranch_scc1 L_f_w_9
  s_add_u32 m0, s60, 8192
  s_xor_b32 s58, s75, 1572864
  buffer_load_dwordx4 v20, s[48:51], s58 offen  lds
  s_add_u32 m0, s60, 9216
  s_xor_b32 s58, s75, 1638400
  buffer_load_dwordx4 v21, s[48:51], s58 offen  lds
  s_add_u32 m0, s60, 10240
  s_xor_b32 s58, s75, 1703936
  buffer_load_dwordx4 v20, s[48:51], s58 offen  lds
  s_add_u32 m0, s60, 11264
  s_xor_b32 s58, s75, 1769472
  buffer_load_dwordx4 v21, s[48:51], s58 offen  lds
  s_branch L_f_w_9e
L_f_w_9:
  s_add_u32 m0, s60, 8192
  s_xor_b32 s58, s75, 1572864
  buffer_load_dwordx4 v20, s[48:51], s58 offen nt lds
  s_add_u32 m0, s60, 9216
  s_xor_b32 s58, s75, 1638400
  buffer_load_dwordx4 v21, s[48:51], s58 offen nt lds
  s_add_u32 m0, s60, 10240
  s_xor_b32 s58, s75, 1703936
  buffer_load_dwordx4 v20, s[48:51], s58 offen nt lds
  s_add_u32 m0, s60, 11264
  s_xor_b32 s58, s75, 1769472
  buffer_load_dwordx4 v21, s[48:51], s58 offen nt lds
L_f_w_9e:
  s_waitcnt vmcnt(12)
  ds_read_b64_tr_b16 a[12:13], v24 offset:12288
  ds_read_b64_tr_b16 a[14:15], v24 offset:12800
  ds_read_b64_tr_b16 a[76:77], v25 offset:12288
  ds_read_b64_tr_b16 a[78:79], v25 offset:12800
  ds_read_b64_tr_b16 a[140:141], v26 offset:12288
  ds_read_b64_tr_b16 a[142:143], v26 offset:12800
  ds_read_b64_tr_b16 a[204:205], v27 offset:12288
  ds_read_b64_tr_b16 a[206:207], v27 offset:12800
  s_waitcnt lgkmcnt(0)
  s_cmp_lt_u32 s72, 3
  s_cbranch_scc1 L_f_w_10
  s_add_u32 m0, s60, 12288
  s_xor_b32 s58, s75, 1835008
  buffer_load_dwordx4 v20, s[48:51], s58 offen  lds
  s_add_u32 m0, s60, 13312
  s_xor_b32 s58, s75, 1900544
  buffer_load_dwordx4 v21, s[48:51], s58 offen  lds
  s_add_u32 m0, s60, 14336
  s_xor_b32 s58, s75, 1966080
  buffer_load_dwordx4 v20, s[48:51], s58 offen  lds
  s_add_u32 m0, s60, 15360
  s_xor_b32 s58, s75, 2031616
  buffer_load_dwordx4 v21, s[48:51], s58 offen  lds
  s_branch L_f_w_10e
L_f_w_10:
  s_add_u32 m0, s60, 12288
  s_xor_b32 s58, s75, 1835008
  buffer_load_dwordx4 v20, s[48:51], s58 offen nt lds
  s_add_u32 m0, s60, 13312
  s_xor_b32 s58, s75, 1900544
  buffer_load_dwordx4 v21, s[48:51], s58 offen nt lds
  s_add_u32 m0, s60, 14336
  s_xor_b32 s58, s75, 1966080
  buffer_load_dwordx4 v20, s[48:51], s58 offen nt lds
  s_add_u32 m0, s60, 15360
  s_xor_b32 s58, s75, 2031616
  buffer_load_dwordx4 v21, s[48:51], s58 offen nt lds
L_f_w_10e:
  s_waitcnt vmcnt(12)
  ds_read_b64_tr_b16 a[16:17], v24 offset:0
  ds_read_b64_tr_b16 a[18:19], v24 offset:512
  ds_read_b64_tr_b16 a[80:81], v25 offset:0
  ds_read_b64_tr_b16 a[82:83], v25 offset:512
  ds_read_b64_tr_b16 a[144:145], v26 offset:0
  ds_read_b64_tr_b16 a[146:147], v26 offset:512
  ds_read_b64_tr_b16 a[208:209], v27 offset:0
  ds_read_b64_tr_b16 a[210:211], v27 offset:512
  s_waitcnt lgkmcnt(0)
  s_cmp_lt_u32 s72, 3
  s_cbranch_scc1 L_f_w_11
  s_add_u32 m0, s60, 0
  s_xor_b32 s58, s75, 2097152
  buffer_load_dwordx4 v20, s[48:51], s58 offen  lds
  s_add_u32 m0, s60, 1024
  s_xor_b32 s58, s75, 2162688
  buffer_load_dwordx4 v21, s[48:51], s58 offen  lds
  s_add_u32 m0, s60, 2048
  s_xor_b32 s58, s75, 2228224
  buffer_load_dwordx4 v20, s[48:51], s58 offen  lds
  s_add_u32 m0, s60, 3072
  s_xor_b32 s58, s75, 2293760
  buffer_load_dwordx4 v21, s[48:51], s58 offen  lds
  s_branch L_f_w_11e
L_f_w_11:
  s_add_u32 m0, s60, 0
  s_xor_b32 s58, s75, 2097152
  buffer_load_dwordx4 v20, s[48:51], s58 offen nt lds
  s_add_u32 m0, s60, 1024
  s_xor_b32 s58, s75, 2162688
  buffer_load_dwordx4 v21, s[48:51], s58 offen nt lds
  s_add_u32 m0, s60, 2048
  s_xor_b32 s58, s75, 2228224
  buffer_load_dwordx4 v20, s[48:51], s58 offen nt lds
  s_add_u32 m0, s60, 3072
  s_xor_b32 s58, s75, 2293760
  buffer_load_dwordx4 v21, s[48:51], s58 offen nt lds
L_f_w_11e:
  s_waitcnt vmcnt(12)
  ds_read_b64_tr_b16 a[20:21], v24 offset:4096
  ds_read_b64_tr_b16 a[22:23], v24 offset:4608
  ds_read_b64_tr_b16 a[84:85], v25 offset:4096
  ds_read_b64_tr_b16 a[86:87], v25 offset:4608
  ds_read_b64_tr_b16 a[148:149], v26 offset:4096
  ds_read_b64_tr_b16 a[150:151], v26 offset:4608
  ds_read_b64_tr_b16 a[212:213], v27 offset:4096
  ds_read_b64_tr_b16 a[214:215], v27 offset:4608
  s_waitcnt lgkmcnt(0)
  s_cmp_lt_u32 s72, 3
  s_cbranch_scc1 L_f_w_12
  s_add_u32 m0, s60, 4096
  s_xor_b32 s58, s75, 2359296
  buffer_load_dwordx4 v20, s[48:51], s58 offen  lds
  s_add_u32 m0, s60, 5120
  s_xor_b32 s58, s75, 2424832
  buffer_load_dwordx4 v21, s[48:51], s58 offen  lds
  s_add_u32 m0, s60, 6144
  s_xor_b32 s58, s75, 2490368
  buffer_load_dwordx4 v20, s[48:51], s58 offen  lds
  s_add_u32 m0, s60, 7168
  s_xor_b32 s58, s75, 2555904
  buffer_load_dwordx4 v21, s[48:51], s58 offen  lds
  s_branch L_f_w_12e
L_f_w_12:
  s_add_u32 m0, s60, 4096
  s_xor_b32 s58, s75, 2359296
  buffer_load_dwordx4 v20, s[48:51], s58 offen nt lds
  s_add_u32 m0, s60, 5120
  s_xor_b32 s58, s75, 2424832
  buffer_load_dwordx4 v21, s[48:51], s58 offen nt lds
  s_add_u32 m0, s60, 6144
  s_xor_b32 s58, s75, 2490368
  buffer_load_dwordx4 v20, s[48:51], s58 offen nt lds
  s_add_u32 m0, s60, 7168
  s_xor_b32 s58, s75, 2555904
  buffer_load_dwordx4 v21, s[48:51], s58 offen nt lds
L_f_w_12e:
  s_waitcnt vmcnt(12)
  ds_read_b64_tr_b16 a[24:25], v24 offset:8192
  ds_read_b64_tr_b16 a[26:27], v24 offset:8704
  ds_read_b64_tr_b16 a[88:89], v25 offset:8192
  ds_read_b64_tr_b16 a[90:91], v25 offset:8704
  ds_read_b64_tr_b16 a[152:153], v26 offset:8192
  ds_read_b64_tr_b16 a[154:155], v26 offset:8704
  ds_read_b64_tr_b16 a[216:217], v27 offset:8192
  ds_read_b64_tr_b16 a[218:219], v27 offset:8704
  s_waitcnt lgkmcnt(0)
  s_cmp_lt_u32 s72, 3
  s_cbranch_scc1 L_f_w_13
  s_add_u32 m0, s60, 8192
  s_xor_b32 s58, s75, 2621440
  buffer_load_dwordx4 v20, s[48:51], s58 offen  lds
  s_add_u32 m0, s60, 9216
  s_xor_b32 s58, s75, 2686976
  buffer_load_dwordx4 v21, s[48:51], s58 offen  lds
  s_add_u32 m0, s60, 10240
  s_xor_b32 s58, s75, 2752512
  buffer_load_dwordx4 v20, s[48:51], s58 offen  lds
  s_add_u32 m0, s60, 11264
  s_xor_b32 s58, s75, 2818048
  buffer_load_dwordx4 v21, s[48:51], s58 offen  lds
  s_branch L_f_w_13e
L_f_w_13:
  s_add_u32 m0, s60, 8192
  s_xor_b32 s58, s75, 2621440
  buffer_load_dwordx4 v20, s[48:51], s58 offen nt lds
  s_add_u32 m0, s60, 9216
  s_xor_b32 s58, s75, 2686976
  buffer_load_dwordx4 v21, s[48:51], s58 offen nt lds
  s_add_u32 m0, s60, 10240
  s_xor_b32 s58, s75, 2752512
  buffer_load_dwordx4 v20, s[48:51], s58 offen nt lds
  s_add_u32 m0, s60, 11264
  s_xor_b32 s58, s75, 2818048
  buffer_load_dwordx4 v21, s[48:51], s58 offen nt lds
L_f_w_13e:
  s_waitcnt vmcnt(12)
  ds_read_b64_tr_b16 a[28:29], v24 offset:12288
  ds_read_b64_tr_b16 a[30:31], v24 offset:12800
  ds_read_b64_tr_b16 a[92:93], v25 offset:12288
  ds_read_b64_tr_b16 a[94:95], v25 offset:12800
  ds_read_b64_tr_b16 a[156:157], v26 offset:12288
  ds_read_b64_tr_b16 a[158:159], v26 offset:12800
  ds_read_b64_tr_b16 a[220:221], v27 offset:12288
  ds_read_b64_tr_b16 a[222:223], v27 offset:12800
  s_waitcnt lgkmcnt(0)
  s_cmp_lt_u32 s72, 3
  s_cbranch_scc1 L_f_w_14
  s_add_u32 m0, s60, 12288
  s_xor_b32 s58, s75, 2883584
  buffer_load_dwordx4 v20, s[48:51], s58 offen  lds
  s_add_u32 m0, s60, 13312
  s_xor_b32 s58, s75, 2949120
  buffer_load_dwordx4 v21, s[48:51], s58 offen  lds
  s_add_u32 m0, s60, 14336
  s_xor_b32 s58, s75, 3014656
  buffer_load_dwordx4 v20, s[48:51], s58 offen  lds
  s_add_u32 m0, s60, 15360
  s_xor_b32 s58, s75, 3080192
  buffer_load_dwordx4 v21, s[48:51], s58 offen  lds
  s_branch L_f_w_14e
L_f_w_14:
  s_add_u32 m0, s60, 12288
  s_xor_b32 s58, s75, 2883584
  buffer_load_dwordx4 v20, s[48:51], s58 offen nt lds
  s_add_u32 m0, s60, 13312
  s_xor_b32 s58, s75, 2949120
  buffer_load_dwordx4 v21, s[48:51], s58 offen nt lds
  s_add_u32 m0, s60, 14336
  s_xor_b32 s58, s75, 3014656
  buffer_load_dwordx4 v20, s[48:51], s58 offen nt lds
  s_add_u32 m0, s60, 15360
  s_xor_b32 s58, s75, 3080192
  buffer_load_dwordx4 v21, s[48:51], s58 offen nt lds
L_f_w_14e:
  s_waitcnt vmcnt(12)
  ds_read_b64_tr_b16 a[32:33], v24 offset:0
  ds_read_b64_tr_b16 a[34:35], v24 offset:512
  ds_read_b64_tr_b16 a[96:97], v25 offset:0
  ds_read_b64_tr_b16 a[98:99], v25 offset:512
  ds_read_b64_tr_b16 a[160:161], v26 offset:0
  ds_read_b64_tr_b16 a[162:163], v26 offset:512
  ds_read_b64_tr_b16 a[224:225], v27 offset:0
  ds_read_b64_tr_b16 a[226:227], v27 offset:512
  s_waitcnt lgkmcnt(0)
  s_cmp_lt_u32 s72, 3
  s_cbranch_scc1 L_f_w_15
  s_add_u32 m0, s60, 0
  s_xor_b32 s58, s75, 3145728
  buffer_load_dwordx4 v20, s[48:51], s58 offen  lds
  s_add_u32 m0, s60, 1024
  s_xor_b32 s58, s75, 3211264
  buffer_load_dwordx4 v21, s[48:51], s58 offen  lds
  s_add_u32 m0, s60, 2048
  s_xor_b32 s58, s75, 3276800
  buffer_load_dwordx4 v20, s[48:51], s58 offen  lds
  s_add_u32 m0, s60, 3072
  s_xor_b32 s58, s75, 3342336
  buffer_load_dwordx4 v21, s[48:51], s58 offen  lds
  s_branch L_f_w_15e
L_f_w_15:
  s_add_u32 m0, s60, 0
  s_xor_b32 s58, s75, 3145728
  buffer_load_dwordx4 v20, s[48:51], s58 offen nt lds
  s_add_u32 m0, s60, 1024
  s_xor_b32 s58, s75, 3211264
  buffer_load_dwordx4 v21, s[48:51], s58 offen nt lds
  s_add_u32 m0, s60, 2048
  s_xor_b32 s58, s75, 3276800
  buffer_load_dwordx4 v20, s[48:51], s58 offen nt lds
  s_add_u32 m0, s60, 3072
  s_xor_b32 s58, s75, 3342336
  buffer_load_dwordx4 v21, s[48:51], s58 offen nt lds
L_f_w_15e:
  s_waitcnt vmcnt(12)
  ds_read_b64_tr_b16 a[36:37], v24 offset:4096
  ds_read_b64_tr_b16 a[38:39], v24 offset:4608
  ds_read_b64_tr_b16 a[100:101], v25 offset:4096
  ds_read_b64_tr_b16 a[102:103], v25 offset:4608
  ds_read_b64_tr_b16 a[164:165], v26 offset:4096
  ds_read_b64_tr_b16 a[166:167], v26 offset:4608
  ds_read_b64_tr_b16 a[228:229], v27 offset:4096
  ds_read_b64_tr_b16 a[230:231], v27 offset:4608
  s_waitcnt lgkmcnt(0)
  s_cmp_lt_u32 s72, 3
  s_cbranch_scc1 L_f_w_16
  s_add_u32 m0, s60, 4096
  s_xor_b32 s58, s75, 3407872
  buffer_load_dwordx4 v20, s[48:51], s58 offen  lds
  s_add_u32 m0, s60, 5120
  s_xor_b32 s58, s75, 3473408
  buffer_load_dwordx4 v21, s[48:51], s58 offen  lds
  s_add_u32 m0, s60, 6144
  s_xor_b32 s58, s75, 3538944
  buffer_load_dwordx4 v20, s[48:51], s58 offen  lds
  s_add_u32 m0, s60, 7168
  s_xor_b32 s58, s75, 3604480
  buffer_load_dwordx4 v21, s[48:51], s58 offen  lds
  s_branch L_f_w_16e
L_f_w_16:
  s_add_u32 m0, s60, 4096
  s_xor_b32 s58, s75, 3407872
  buffer_load_dwordx4 v20, s[48:51], s58 offen nt lds
  s_add_u32 m0, s60, 5120
  s_xor_b32 s58, s75, 3473408
  buffer_load_dwordx4 v21, s[48:51], s58 offen nt lds
  s_add_u32 m0, s60, 6144
  s_xor_b32 s58, s75, 3538944
  buffer_load_dwordx4 v20, s[48:51], s58 offen nt lds
  s_add_u32 m0, s60, 7168
  s_xor_b32 s58, s75, 3604480
  buffer_load_dwordx4 v21, s[48:51], s58 offen nt lds
L_f_w_16e:
  s_waitcnt vmcnt(12)
  ds_read_b64_tr_b16 a[40:41], v24 offset:8192
  ds_read_b64_tr_b16 a[42:43], v24 offset:8704
  ds_read_b64_tr_b16 a[104:105], v25 offset:8192
  ds_read_b64_tr_b16 a[106:107], v25 offset:8704
  ds_read_b64_tr_b16 a[168:169], v26 offset:8192
  ds_read_b64_tr_b16 a[170:171], v26 offset:8704
  ds_read_b64_tr_b16 a[232:233], v27 offset:8192
  ds_read_b64_tr_b16 a[234:235], v27 offset:8704
  s_waitcnt lgkmcnt(0)
  s_cmp_lt_u32 s72, 3
  s_cbranch_scc1 L_f_w_17
  s_add_u32 m0, s60, 8192
  s_xor_b32 s58, s75, 3670016
  buffer_load_dwordx4 v20, s[48:51], s58 offen  lds
  s_add_u32 m0, s60, 9216
  s_xor_b32 s58, s75, 3735552
  buffer_load_dwordx4 v21, s[48:51], s58 offen  lds
  s_add_u32 m0, s60, 10240
  s_xor_b32 s58, s75, 3801088
  buffer_load_dwordx4 v20, s[48:51], s58 offen  lds
  s_add_u32 m0, s60, 11264
  s_xor_b32 s58, s75, 3866624
  buffer_load_dwordx4 v21, s[48:51], s58 offen  lds
  s_branch L_f_w_17e
L_f_w_17:
  s_add_u32 m0, s60, 8192
  s_xor_b32 s58, s75, 3670016
  buffer_load_dwordx4 v20, s[48:51], s58 offen nt lds
  s_add_u32 m0, s60, 9216
  s_xor_b32 s58, s75, 3735552
  buffer_load_dwordx4 v21, s[48:51], s58 offen nt lds
  s_add_u32 m0, s60, 10240
  s_xor_b32 s58, s75, 3801088
  buffer_load_dwordx4 v20, s[48:51], s58 offen nt lds
  s_add_u32 m0, s60, 11264
  s_xor_b32 s58, s75, 3866624
  buffer_load_dwordx4 v21, s[48:51], s58 offen nt lds
L_f_w_17e:
  s_waitcnt vmcnt(12)
  ds_read_b64_tr_b16 a[44:45], v24 offset:12288
  ds_read_b64_tr_b16 a[46:47], v24 offset:12800
  ds_read_b64_tr_b16 a[108:109], v25 offset:12288
  ds_read_b64_tr_b16 a[110:111], v25 offset:12800
  ds_read_b64_tr_b16 a[172:173], v26 offset:12288
  ds_read_b64_tr_b16 a[174:175], v26 offset:12800
  ds_read_b64_tr_b16 a[236:237], v27 offset:12288
  ds_read_b64_tr_b16 a[238:239], v27 offset:12800
  s_waitcnt lgkmcnt(0)
  s_cmp_lt_u32 s72, 3
  s_cbranch_scc1 L_f_w_18
  s_add_u32 m0, s60, 12288
  s_xor_b32 s58, s75, 3932160
  buffer_load_dwordx4 v20, s[48:51], s58 offen  lds
  s_add_u32 m0, s60, 13312
  s_xor_b32 s58, s75, 3997696
  buffer_load_dwordx4 v21, s[48:51], s58 offen  lds
  s_add_u32 m0, s60, 14336
  s_xor_b32 s58, s75, 4063232
  buffer_load_dwordx4 v20, s[48:51], s58 offen  lds
  s_add_u32 m0, s60, 15360
  s_xor_b32 s58, s75, 4128768
  buffer_load_dwordx4 v21, s[48:51], s58 offen  lds
  s_branch L_f_w_18e
L_f_w_18:
  s_add_u32 m0, s60, 12288
  s_xor_b32 s58, s75, 3932160
  buffer_load_dwordx4 v20, s[48:51], s58 offen nt lds
  s_add_u32 m0, s60, 13312
  s_xor_b32 s58, s75, 3997696
  buffer_load_dwordx4 v21, s[48:51], s58 offen nt lds
  s_add_u32 m0, s60, 14336
  s_xor_b32 s58, s75, 4063232
  buffer_load_dwordx4 v20, s[48:51], s58 offen nt lds
  s_add_u32 m0, s60, 15360
  s_xor_b32 s58, s75, 4128768
  buffer_load_dwordx4 v21, s[48:51], s58 offen nt lds
L_f_w_18e:
  s_waitcnt vmcnt(12)
  ds_read_b64_tr_b16 a[48:49], v24 offset:0
  ds_read_b64_tr_b16 a[50:51], v24 offset:512
  ds_read_b64_tr_b16 a[112:113], v25 offset:0
  ds_read_b64_tr_b16 a[114:115], v25 offset:512
  ds_read_b64_tr_b16 a[176:177], v26 offset:0
  ds_read_b64_tr_b16 a[178:179], v26 offset:512
  ds_read_b64_tr_b16 a[240:241], v27 offset:0
  ds_read_b64_tr_b16 a[242:243], v27 offset:512
  s_mov_b32 s48, s38
  s_and_b32 s49, s39, 0xffff
  s_mov_b32 s50, 0x100
  s_mov_b32 s51, 0x20000
  buffer_load_dword v3, v6, s[48:51], 0 offen sc1
  s_add_u32 m0, s66, 0
  s_add_u32 s58, s61, 0
  buffer_load_dwordx4 v8, s[52:55], s58 offen lds
  s_add_u32 m0, s66, 1024
  s_add_u32 s58, s61, 1024
  buffer_load_dwordx4 v9, s[52:55], s58 offen lds
  s_add_u32 m0, s66, 2048
  s_add_u32 s58, s61, 2048
  buffer_load_dwordx4 v10, s[52:55], s58 offen lds
  s_add_u32 m0, s66, 3072
  s_add_u32 s58, s61, 3072
  buffer_load_dwordx4 v11, s[52:55], s58 offen lds
  s_add_u32 m0, s66, 4096
  s_add_u32 s58, s61, 4096
  buffer_load_dwordx4 v12, s[52:55], s58 offen lds
  s_add_u32 m0, s66, 5120
  s_add_u32 s58, s61, 5120
  buffer_load_dwordx4 v13, s[52:55], s58 offen lds
  s_add_u32 m0, s66, 6144
  s_add_u32 s58, s61, 6144
  buffer_load_dwordx4 v14, s[52:55], s58 offen lds
  s_add_u32 m0, s66, 7168
  s_add_u32 s58, s61, 7168
  buffer_load_dwordx4 v15, s[52:55], s58 offen lds
  s_add_u32 s61, s61, 0x8000
  s_add_u32 s66, s66, 0x8000
  s_and_b32 s66, s66, 0x1ffff
  s_waitcnt vmcnt(17)
  ds_read_b64_tr_b16 a[52:53], v24 offset:4096
  ds_read_b64_tr_b16 a[54:55], v24 offset:4608
  ds_read_b64_tr_b16 a[116:117], v25 offset:4096
  ds_read_b64_tr_b16 a[118:119], v25 offset:4608
  ds_read_b64_tr_b16 a[180:181], v26 offset:4096
  ds_read_b64_tr_b16 a[182:183], v26 offset:4608
  ds_read_b64_tr_b16 a[244:245], v27 offset:4096
  ds_read_b64_tr_b16 a[246:247], v27 offset:4608
  s_add_u32 m0, s66, 0
  s_add_u32 s58, s61, 0
  buffer_load_dwordx4 v8, s[52:55], s58 offen lds
  s_add_u32 m0, s66, 1024
  s_add_u32 s58, s61, 1024
  buffer_load_dwordx4 v9, s[52:55], s58 offen lds
  s_add_u32 m0, s66, 2048
  s_add_u32 s58, s61, 2048
  buffer_load_dwordx4 v10, s[52:55], s58 offen lds
  s_add_u32 m0, s66, 3072
  s_add_u32 s58, s61, 3072
  buffer_load_dwordx4 v11, s[52:55], s58 offen lds
  s_add_u32 m0, s66, 4096
  s_add_u32 s58, s61, 4096
  buffer_load_dwordx4 v12, s[52:55], s58 offen lds
  s_add_u32 m0, s66, 5120
  s_add_u32 s58, s61, 5120
  buffer_load_dwordx4 v13, s[52:55], s58 offen lds
  s_add_u32 m0, s66, 6144
  s_add_u32 s58, s61, 6144
  buffer_load_dwordx4 v14, s[52:55], s58 offen lds
  s_add_u32 m0, s66, 7168
  s_add_u32 s58, s61, 7168
  buffer_load_dwordx4 v15, s[52:55], s58 offen lds
  s_add_u32 s61, s61, 0x8000
  s_add_u32 s66, s66, 0x8000
  s_and_b32 s66, s66, 0x1ffff
  s_waitcnt vmcnt(21)
  ds_read_b64_tr_b16 a[56:57], v24 offset:8192
  ds_read_b64_tr_b16 a[58:59], v24 offset:8704
  ds_read_b64_tr_b16 a[120:121], v25 offset:8192
  ds_read_b64_tr_b16 a[122:123], v25 offset:8704
  ds_read_b64_tr_b16 a[184:185], v26 offset:8192
  ds_read_b64_tr_b16 a[186:187], v26 offset:8704
  ds_read_b64_tr_b16 a[248:249], v27 offset:8192
  ds_read_b64_tr_b16 a[250:251], v27 offset:8704
  s_add_u32 m0, s66, 0
  s_add_u32 s58, s61, 0
  buffer_load_dwordx4 v8, s[52:55], s58 offen lds
  s_add_u32 m0, s66, 1024
  s_add_u32 s58, s61, 1024
  buffer_load_dwordx4 v9, s[52:55], s58 offen lds
  s_add_u32 m0, s66, 2048
  s_add_u32 s58, s61, 2048
  buffer_load_dwordx4 v10, s[52:55], s58 offen lds
  s_add_u32 m0, s66, 3072
  s_add_u32 s58, s61, 3072
  buffer_load_dwordx4 v11, s[52:55], s58 offen lds
  s_add_u32 m0, s66, 4096
  s_add_u32 s58, s61, 4096
  buffer_load_dwordx4 v12, s[52:55], s58 offen lds
  s_add_u32 m0, s66, 5120
  s_add_u32 s58, s61, 5120
  buffer_load_dwordx4 v13, s[52:55], s58 offen lds
  s_add_u32 m0, s66, 6144
  s_add_u32 s58, s61, 6144
  buffer_load_dwordx4 v14, s[52:55], s58 offen lds
  s_add_u32 m0, s66, 7168
  s_add_u32 s58, s61, 7168
  buffer_load_dwordx4 v15, s[52:55], s58 offen lds
  s_add_u32 s61, s61, 0x8000
  s_add_u32 s66, s66, 0x8000
  s_and_b32 s66, s66, 0x1ffff
  s_waitcnt vmcnt(25)
  ds_read_b64_tr_b16 a[60:61], v24 offset:12288
  ds_read_b64_tr_b16 a[62:63], v24 offset:12800
  ds_read_b64_tr_b16 a[124:125], v25 offset:12288
  ds_read_b64_tr_b16 a[126:127], v25 offset:12800
  ds_read_b64_tr_b16 a[188:189], v26 offset:12288
  ds_read_b64_tr_b16 a[190:191], v26 offset:12800
  ds_read_b64_tr_b16 a[252:253], v27 offset:12288
  ds_read_b64_tr_b16 a[254:255], v27 offset:12800
  s_cmp_eq_u32 s76, 0x40000000
  s_cbranch_scc1 L_f_nogate2
  v_mfma_f32_16x16x32_bf16 v[192:195], v[128:131], v[64:67], 0
  v_mfma_f32_16x16x32_bf16 v[192:195], v[132:135], v[68:71], v[192:195]
  v_mfma_f32_16x16x32_bf16 v[192:195], v[136:139], v[72:75], v[192:195]
  v_mfma_f32_16x16x32_bf16 v[192:195], v[140:143], v[76:79], v[192:195]
  v_mfma_f32_16x16x32_bf16 v[192:195], v[144:147], v[80:83], v[192:195]
  v_mfma_f32_16x16x32_bf16 v[192:195], v[148:151], v[84:87], v[192:195]
  v_mfma_f32_16x16x32_bf16 v[192:195], v[152:155], v[88:91], v[192:195]
  v_mfma_f32_16x16x32_bf16 v[192:195], v[156:159], v[92:95], v[192:195]
  v_mfma_f32_16x16x32_bf16 v[192:195], v[160:163], v[96:99], v[192:195]
  v_mfma_f32_16x16x32_bf16 v[192:195], v[164:167], v[100:103], v[192:195]
  v_mfma_f32_16x16x32_bf16 v[192:195], v[168:171], v[104:107], v[192:195]
  v_mfma_f32_16x16x32_bf16 v[192:195], v[172:175], v[108:111], v[192:195]
  v_mfma_f32_16x16x32_bf16 v[192:195], v[176:179], v[112:115], v[192:195]
  v_mfma_f32_16x16x32_bf16 v[192:195], v[180:183], v[116:119], v[192:195]
  v_mfma_f32_16x16x32_bf16 v[192:195], v[184:187], v[120:123], v[192:195]
  v_mfma_f32_16x16x32_bf16 v[192:195], v[188:191], v[124:127], v[192:195]
  s_nop 7
  v_mul_f32 v192, 0xbfb8aa3b, v192
  v_exp_f32 v192, v192
  s_nop 0
  v_add_f32 v192, 1.0, v192
  v_rcp_f32 v192, v192
  s_nop 0
  buffer_store_dword v192, v32, s[40:43], s77 offen sc1
L_f_nogate2:
  s_waitcnt vmcnt(16) lgkmcnt(0)
L_f_init:
  v_cmp_gt_u32 vcc, 32, v3
  s_cbranch_vccz L_f_go
  buffer_load_dword v3, v6, s[48:51], 0 offen sc1
  s_add_u32 s68, s68, 1
  s_cmp_gt_u32 s68, 1048576
  s_cbranch_scc1 L_exit
  s_waitcnt vmcnt(0)
  s_branch L_f_init
L_f_go:
  s_barrier
  ds_read_b128 v[64:67], v16 offset:0
  ds_read_b128 v[68:71], v16 offset:16384
  ds_read_b128 v[72:75], v17 offset:0
  ds_read_b128 v[76:79], v17 offset:16384
  ds_read_b128 v[80:83], v18 offset:0
  ds_read_b128 v[84:87], v18 offset:16384
  ds_read_b128 v[88:91], v19 offset:0
  ds_read_b128 v[92:95], v19 offset:16384
  s_cmp_lt_u32 s44, s74
  s_waitcnt lgkmcnt(0)
  s_cbranch_scc0 L_f_10
L_f_00:
  v_mfma_f32_16x16x32_bf16 v[128:131], a[0:3], v[64:67], 0
  v_mfma_f32_16x16x32_bf16 v[128:131], a[4:7], v[72:75], v[128:131]
  v_mfma_f32_16x16x32_bf16 v[128:131], a[8:11], v[80:83], v[128:131]
  ds_read_b128 v[96:99], v16 offset:256
  v_mfma_f32_16x16x32_bf16 v[128:131], a[12:15], v[88:91], v[128:131]
  v_mfma_f32_16x16x32_bf16 v[136:139], a[0:3], v[68:71], 0
  ds_read_b128 v[100:103], v16 offset:16640
  v_mfma_f32_16x16x32_bf16 v[136:139], a[4:7], v[76:79], v[136:139]
  v_mfma_f32_16x16x32_bf16 v[136:139], a[8:11], v[84:87], v[136:139]
  ds_read_b128 v[104:107], v17 offset:256
  v_mfma_f32_16x16x32_bf16 v[136:139], a[12:15], v[92:95], v[136:139]
  v_mfma_f32_16x16x32_bf16 v[132:135], a[64:67], v[64:67], 0
  ds_read_b128 v[108:111], v17 offset:16640
  v_mfma_f32_16x16x32_bf16 v[132:135], a[68:71], v[72:75], v[132:135]
  v_mul_f32 v160, s69, v160
  v_mul_f32 v161, s69, v161
  v_mfma_f32_16x16x32_bf16 v[132:135], a[72:75], v[80:83], v[132:135]
  ds_read_b128 v[112:115], v18 offset:256
  v_mul_f32 v162, s69, v162
  v_mfma_f32_16x16x32_bf16 v[132:135], a[76:79], v[88:91], v[132:135]
  v_mul_f32 v163, s69, v163
  v_mul_f32 v164, s69, v164
  v_mfma_f32_16x16x32_bf16 v[140:143], a[64:67], v[68:71], 0
  ds_read_b128 v[116:119], v18 offset:16640
  v_mul_f32 v165, s69, v165
  v_mfma_f32_16x16x32_bf16 v[140:143], a[68:71], v[76:79], v[140:143]
  v_mul_f32 v166, s69, v166
  v_mul_f32 v167, s69, v167
  v_mfma_f32_16x16x32_bf16 v[140:143], a[72:75], v[84:87], v[140:143]
  ds_read_b128 v[120:123], v19 offset:256
  v_cvt_pk_bf16_f32 v192, v160, v161
  v_mfma_f32_16x16x32_bf16 v[140:143], a[76:79], v[92:95], v[140:143]
  v_cvt_pk_bf16_f32 v193, v162, v163
  v_cvt_pk_bf16_f32 v194, v164, v165
  v_mfma_f32_16x16x32_bf16 v[144:147], a[128:131], v[64:67], 0
  ds_read_b128 v[124:127], v19 offset:16640
  v_cvt_pk_bf16_f32 v195, v166, v167
  v_mfma_f32_16x16x32_bf16 v[144:147], a[132:135], v[72:75], v[144:147]
  buffer_store_dwordx4 v[192:195], v2, s[40:43], s62 offen offset:0 sc1
  v_mfma_f32_16x16x32_bf16 v[144:147], a[136:139], v[80:83], v[144:147]
  v_mul_f32 v168, s69, v168
  v_mul_f32 v169, s69, v169
  v_mfma_f32_16x16x32_bf16 v[144:147], a[140:143], v[88:91], v[144:147]
  v_mul_f32 v170, s69, v170
  v_mul_f32 v171, s69, v171
  v_mfma_f32_16x16x32_bf16 v[152:155], a[128:131], v[68:71], 0
  v_mul_f32 v172, s69, v172
  v_mul_f32 v173, s69, v173
  v_mfma_f32_16x16x32_bf16 v[152:155], a[132:135], v[76:79], v[152:155]
  v_mul_f32 v174, s69, v174
  v_mul_f32 v175, s69, v175
  v_mfma_f32_16x16x32_bf16 v[152:155], a[136:139], v[84:87], v[152:155]
  v_cvt_pk_bf16_f32 v196, v168, v169
  v_cvt_pk_bf16_f32 v197, v170, v171
  v_mfma_f32_16x16x32_bf16 v[152:155], a[140:143], v[92:95], v[152:155]
  v_cvt_pk_bf16_f32 v198, v172, v173
  v_cvt_pk_bf16_f32 v199, v174, v175
  v_mfma_f32_16x16x32_bf16 v[148:151], a[192:195], v[64:67], 0
  buffer_store_dwordx4 v[196:199], v2, s[40:43], s62 offen offset:1024 sc1
  v_mfma_f32_16x16x32_bf16 v[148:151], a[196:199], v[72:75], v[148:151]
  v_mul_f32 v176, s69, v176
  v_mul_f32 v177, s69, v177
  v_mfma_f32_16x16x32_bf16 v[148:151], a[200:203], v[80:83], v[148:151]
  v_mul_f32 v178, s69, v178
  v_mul_f32 v179, s69, v179
  v_mfma_f32_16x16x32_bf16 v[148:151], a[204:207], v[88:91], v[148:151]
  v_mul_f32 v180, s69, v180
  v_mul_f32 v181, s69, v181
  v_mfma_f32_16x16x32_bf16 v[156:159], a[192:195], v[68:71], 0
  v_mul_f32 v182, s69, v182
  v_mul_f32 v183, s69, v183
  v_mfma_f32_16x16x32_bf16 v[156:159], a[196:199], v[76:79], v[156:159]
  v_cvt_pk_bf16_f32 v200, v176, v177
  v_cvt_pk_bf16_f32 v201, v178, v179
  v_mfma_f32_16x16x32_bf16 v[156:159], a[200:203], v[84:87], v[156:159]
  v_cvt_pk_bf16_f32 v202, v180, v181
  v_cvt_pk_bf16_f32 v203, v182, v183
  v_mfma_f32_16x16x32_bf16 v[156:159], a[204:207], v[92:95], v[156:159]
  s_waitcnt lgkmcnt(0)
  buffer_store_dwordx4 v[200:203], v2, s[40:43], s62 offen offset:2048 sc1
  v_mfma_f32_16x16x32_bf16 v[128:131], a[16:19], v[96:99], v[128:131]
  v_mul_f32 v184, s69, v184
  v_mul_f32 v185, s69, v185
  v_mfma_f32_16x16x32_bf16 v[128:131], a[20:23], v[104:107], v[128:131]
  v_mul_f32 v186, s69, v186
  v_mul_f32 v187, s69, v187
  v_mfma_f32_16x16x32_bf16 v[128:131], a[24:27], v[112:115], v[128:131]
  ds_read_b128 v[64:67], v16 offset:512
  v_mul_f32 v188, s69, v188
  v_mfma_f32_16x16x32_bf16 v[128:131], a[28:31], v[120:123], v[128:131]
  v_mul_f32 v189, s69, v189
  v_mul_f32 v190, s69, v190
  v_mfma_f32_16x16x32_bf16 v[136:139], a[16:19], v[100:103], v[136:139]
  ds_read_b128 v[68:71], v16 offset:16896
  v_mul_f32 v191, s69, v191
  v_mfma_f32_16x16x32_bf16 v[136:139], a[20:23], v[108:111], v[136:139]
  v_cvt_pk_bf16_f32 v204, v184, v185
  v_cvt_pk_bf16_f32 v205, v186, v187
  v_mfma_f32_16x16x32_bf16 v[136:139], a[24:27], v[116:119], v[136:139]
  ds_read_b128 v[72:75], v17 offset:512
  v_cvt_pk_bf16_f32 v206, v188, v189
  v_mfma_f32_16x16x32_bf16 v[136:139], a[28:31], v[124:127], v[136:139]
  v_cvt_pk_bf16_f32 v207, v190, v191
  v_mfma_f32_16x16x32_bf16 v[132:135], a[80:83], v[96:99], v[132:135]
  ds_read_b128 v[76:79], v17 offset:16896
  v_mfma_f32_16x16x32_bf16 v[132:135], a[84:87], v[104:107], v[132:135]
  buffer_store_dwordx4 v[204:207], v2, s[40:43], s62 offen offset:3072 sc1
  v_mfma_f32_16x16x32_bf16 v[132:135], a[88:91], v[112:115], v[132:135]
  ds_read_b128 v[80:83], v18 offset:512
  v_mfma_f32_16x16x32_bf16 v[132:135], a[92:95], v[120:123], v[132:135]
  v_mfma_f32_16x16x32_bf16 v[140:143], a[80:83], v[100:103], v[140:143]
  ds_read_b128 v[84:87], v18 offset:16896
  v_mfma_f32_16x16x32_bf16 v[140:143], a[84:87], v[108:111], v[140:143]
  v_mfma_f32_16x16x32_bf16 v[140:143], a[88:91], v[116:119], v[140:143]
  ds_read_b128 v[88:91], v19 offset:512
  v_mfma_f32_16x16x32_bf16 v[140:143], a[92:95], v[124:127], v[140:143]
  v_mfma_f32_16x16x32_bf16 v[144:147], a[144:147], v[96:99], v[144:147]
  ds_read_b128 v[92:95], v19 offset:16896
  v_mfma_f32_16x16x32_bf16 v[144:147], a[148:151], v[104:107], v[144:147]
  v_mfma_f32_16x16x32_bf16 v[144:147], a[152:155], v[112:115], v[144:147]
  s_add_u32 s62, s62, s65
  s_cmp_eq_u32 s63, 15
  s_cselect_b32 s65, s71, 0x2000
  v_mfma_f32_16x16x32_bf16 v[144:147], a[156:159], v[120:123], v[144:147]
  s_add_u32 m0, s66, 0
  s_add_u32 s58, s61, 0
  v_mfma_f32_16x16x32_bf16 v[152:155], a[144:147], v[100:103], v[152:155]
  v_mfma_f32_16x16x32_bf16 v[152:155], a[148:151], v[108:111], v[152:155]
  buffer_load_dwordx4 v8, s[52:55], s58 offen lds
  v_mfma_f32_16x16x32_bf16 v[152:155], a[152:155], v[116:119], v[152:155]
  v_mfma_f32_16x16x32_bf16 v[152:155], a[156:159], v[124:127], v[152:155]
  s_add_u32 m0, s66, 1024
  s_add_u32 s58, s61, 1024
  v_mfma_f32_16x16x32_bf16 v[148:151], a[208:211], v[96:99], v[148:151]
  v_mfma_f32_16x16x32_bf16 v[148:151], a[212:215], v[104:107], v[148:151]
  buffer_load_dwordx4 v9, s[52:55], s58 offen lds
  v_mfma_f32_16x16x32_bf16 v[148:151], a[216:219], v[112:115], v[148:151]
  v_mfma_f32_16x16x32_bf16 v[148:151], a[220:223], v[120:123], v[148:151]
  s_add_u32 m0, s66, 2048
  s_add_u32 s58, s61, 2048
  v_mfma_f32_16x16x32_bf16 v[156:159], a[208:211], v[100:103], v[156:159]
  v_mfma_f32_16x16x32_bf16 v[156:159], a[212:215], v[108:111], v[156:159]
  buffer_load_dwordx4 v10, s[52:55], s58 offen lds
  v_mfma_f32_16x16x32_bf16 v[156:159], a[216:219], v[116:119], v[156:159]
  v_mfma_f32_16x16x32_bf16 v[156:159], a[220:223], v[124:127], v[156:159]
  s_waitcnt lgkmcnt(0)
  s_add_u32 m0, s66, 3072
  s_add_u32 s58, s61, 3072
  v_mfma_f32_16x16x32_bf16 v[128:131], a[32:35], v[64:67], v[128:131]
  v_mfma_f32_16x16x32_bf16 v[128:131], a[36:39], v[72:75], v[128:131]
  buffer_load_dwordx4 v11, s[52:55], s58 offen lds
  v_mfma_f32_16x16x32_bf16 v[128:131], a[40:43], v[80:83], v[128:131]
  ds_read_b128 v[96:99], v16 offset:768
  v_mfma_f32_16x16x32_bf16 v[128:131], a[44:47], v[88:91], v[128:131]
  s_add_u32 m0, s66, 4096
  s_add_u32 s58, s61, 4096
  v_mfma_f32_16x16x32_bf16 v[136:139], a[32:35], v[68:71], v[136:139]
  ds_read_b128 v[100:103], v16 offset:17152
  v_mfma_f32_16x16x32_bf16 v[136:139], a[36:39], v[76:79], v[136:139]
  buffer_load_dwordx4 v12, s[52:55], s58 offen lds
  v_mfma_f32_16x16x32_bf16 v[136:139], a[40:43], v[84:87], v[136:139]
  ds_read_b128 v[104:107], v17 offset:768
  v_mfma_f32_16x16x32_bf16 v[136:139], a[44:47], v[92:95], v[136:139]
  s_add_u32 m0, s66, 5120
  s_add_u32 s58, s61, 5120
  v_mfma_f32_16x16x32_bf16 v[132:135], a[96:99], v[64:67], v[132:135]
  ds_read_b128 v[108:111], v17 offset:17152
  v_mfma_f32_16x16x32_bf16 v[132:135], a[100:103], v[72:75], v[132:135]
  buffer_load_dwordx4 v13, s[52:55], s58 offen lds
  v_mfma_f32_16x16x32_bf16 v[132:135], a[104:107], v[80:83], v[132:135]
  ds_read_b128 v[112:115], v18 offset:768
  v_mfma_f32_16x16x32_bf16 v[132:135], a[108:111], v[88:91], v[132:135]
  s_add_u32 m0, s66, 6144
  s_add_u32 s58, s61, 6144
  v_mfma_f32_16x16x32_bf16 v[140:143], a[96:99], v[68:71], v[140:143]
  ds_read_b128 v[116:119], v18 offset:17152
  v_mfma_f32_16x16x32_bf16 v[140:143], a[100:103], v[76:79], v[140:143]
  buffer_load_dwordx4 v14, s[52:55], s58 offen lds
  v_mfma_f32_16x16x32_bf16 v[140:143], a[104:107], v[84:87], v[140:143]
  ds_read_b128 v[120:123], v19 offset:768
  v_mfma_f32_16x16x32_bf16 v[140:143], a[108:111], v[92:95], v[140:143]
  s_add_u32 m0, s66, 7168
  s_add_u32 s58, s61, 7168
  v_mfma_f32_16x16x32_bf16 v[144:147], a[160:163], v[64:67], v[144:147]
  ds_read_b128 v[124:127], v19 offset:17152
  v_mfma_f32_16x16x32_bf16 v[144:147], a[164:167], v[72:75], v[144:147]
  buffer_load_dwordx4 v15, s[52:55], s58 offen lds
  v_mfma_f32_16x16x32_bf16 v[144:147], a[168:171], v[80:83], v[144:147]
  v_mfma_f32_16x16x32_bf16 v[144:147], a[172:175], v[88:91], v[144:147]
  s_cmp_eq_u32 s63, 12
  s_cselect_b32 s59, s70, 0
  s_add_u32 s61, s61, s59
  v_mfma_f32_16x16x32_bf16 v[152:155], a[160:163], v[68:71], v[152:155]
  v_add_u32 v16, 0x8000, v16
  v_mfma_f32_16x16x32_bf16 v[152:155], a[164:167], v[76:79], v[152:155]
  s_add_u32 s61, s61, 0x8000
  v_and_b32 v16, 0x1ffff, v16
  v_mfma_f32_16x16x32_bf16 v[152:155], a[168:171], v[84:87], v[152:155]
  s_add_u32 s66, s66, 0x8000
  v_add_u32 v17, 0x8000, v17
  v_mfma_f32_16x16x32_bf16 v[152:155], a[172:175], v[92:95], v[152:155]
  s_and_b32 s66, s66, 0x1ffff
  v_and_b32 v17, 0x1ffff, v17
  v_mfma_f32_16x16x32_bf16 v[148:151], a[224:227], v[64:67], v[148:151]
  v_add_u32 v18, 0x8000, v18
  v_mfma_f32_16x16x32_bf16 v[148:151], a[228:231], v[72:75], v[148:151]
  v_and_b32 v18, 0x1ffff, v18
  v_mfma_f32_16x16x32_bf16 v[148:151], a[232:235], v[80:83], v[148:151]
  v_add_u32 v19, 0x8000, v19
  v_mfma_f32_16x16x32_bf16 v[148:151], a[236:239], v[88:91], v[148:151]
  v_and_b32 v19, 0x1ffff, v19
  v_mfma_f32_16x16x32_bf16 v[156:159], a[224:227], v[68:71], v[156:159]
  s_sub_u32 s59, s63, 1
  s_max_i32 s59, s59, 0
  v_mfma_f32_16x16x32_bf16 v[156:159], a[228:231], v[76:79], v[156:159]
  v_mov_b32 v7, s59
  v_mfma_f32_16x16x32_bf16 v[156:159], a[232:235], v[84:87], v[156:159]
  v_mfma_f32_16x16x32_bf16 v[156:159], a[236:239], v[92:95], v[156:159]
  s_waitcnt lgkmcnt(0)
  v_mfma_f32_16x16x32_bf16 v[128:131], a[48:51], v[96:99], v[128:131]
  s_waitcnt vmcnt(20)
  v_mfma_f32_16x16x32_bf16 v[128:131], a[52:55], v[104:107], v[128:131]
  s_barrier
  v_mfma_f32_16x16x32_bf16 v[128:131], a[56:59], v[112:115], v[128:131]
  ds_read_b128 v[64:67], v16 offset:0
  v_mfma_f32_16x16x32_bf16 v[128:131], a[60:63], v[120:123], v[128:131]
  buffer_store_dword v7, v6, s[40:43], s64 offen sc1
  v_mfma_f32_16x16x32_bf16 v[136:139], a[48:51], v[100:103], v[136:139]
  ds_read_b128 v[68:71], v16 offset:16384
  v_mfma_f32_16x16x32_bf16 v[136:139], a[52:55], v[108:111], v[136:139]
  v_mfma_f32_16x16x32_bf16 v[136:139], a[56:59], v[116:119], v[136:139]
  ds_read_b128 v[72:75], v17 offset:0
  v_mfma_f32_16x16x32_bf16 v[136:139], a[60:63], v[124:127], v[136:139]
  v_mfma_f32_16x16x32_bf16 v[132:135], a[112:115], v[96:99], v[132:135]
  ds_read_b128 v[76:79], v17 offset:16384
  v_mfma_f32_16x16x32_bf16 v[132:135], a[116:119], v[104:107], v[132:135]
  v_mfma_f32_16x16x32_bf16 v[132:135], a[120:123], v[112:115], v[132:135]
  ds_read_b128 v[80:83], v18 offset:0
  v_mfma_f32_16x16x32_bf16 v[132:135], a[124:127], v[120:123], v[132:135]
  v_mfma_f32_16x16x32_bf16 v[140:143], a[112:115], v[100:103], v[140:143]
  ds_read_b128 v[84:87], v18 offset:16384
  v_mfma_f32_16x16x32_bf16 v[140:143], a[116:119], v[108:111], v[140:143]
  v_mfma_f32_16x16x32_bf16 v[140:143], a[120:123], v[116:119], v[140:143]
  ds_read_b128 v[88:91], v19 offset:0
  v_mfma_f32_16x16x32_bf16 v[140:143], a[124:127], v[124:127], v[140:143]
  v_mfma_f32_16x16x32_bf16 v[144:147], a[176:179], v[96:99], v[144:147]
  ds_read_b128 v[92:95], v19 offset:16384
  v_mfma_f32_16x16x32_bf16 v[144:147], a[180:183], v[104:107], v[144:147]
  v_mfma_f32_16x16x32_bf16 v[144:147], a[184:187], v[112:115], v[144:147]
  v_mfma_f32_16x16x32_bf16 v[144:147], a[188:191], v[120:123], v[144:147]
  v_mfma_f32_16x16x32_bf16 v[152:155], a[176:179], v[100:103], v[152:155]
  v_mfma_f32_16x16x32_bf16 v[152:155], a[180:183], v[108:111], v[152:155]
  v_mfma_f32_16x16x32_bf16 v[152:155], a[184:187], v[116:119], v[152:155]
  v_mfma_f32_16x16x32_bf16 v[152:155], a[188:191], v[124:127], v[152:155]
  v_mfma_f32_16x16x32_bf16 v[148:151], a[240:243], v[96:99], v[148:151]
  s_add_u32 s63, s63, 1
  v_mfma_f32_16x16x32_bf16 v[148:151], a[244:247], v[104:107], v[148:151]
  v_mfma_f32_16x16x32_bf16 v[148:151], a[248:251], v[112:115], v[148:151]
  v_mfma_f32_16x16x32_bf16 v[148:151], a[252:255], v[120:123], v[148:151]
  v_mfma_f32_16x16x32_bf16 v[156:159], a[240:243], v[100:103], v[156:159]
  v_mfma_f32_16x16x32_bf16 v[156:159], a[244:247], v[108:111], v[156:159]
  v_mfma_f32_16x16x32_bf16 v[156:159], a[248:251], v[116:119], v[156:159]
  s_cmp_lt_u32 s63, s67
  v_mfma_f32_16x16x32_bf16 v[156:159], a[252:255], v[124:127], v[156:159]
  s_waitcnt lgkmcnt(0)
L_f_01:
  v_mfma_f32_16x16x32_bf16 v[160:163], a[0:3], v[64:67], 0
  v_mfma_f32_16x16x32_bf16 v[160:163], a[4:7], v[72:75], v[160:163]
  v_mfma_f32_16x16x32_bf16 v[160:163], a[8:11], v[80:83], v[160:163]
  ds_read_b128 v[96:99], v16 offset:256
  v_mfma_f32_16x16x32_bf16 v[160:163], a[12:15], v[88:91], v[160:163]
  v_mfma_f32_16x16x32_bf16 v[168:171], a[0:3], v[68:71], 0
  ds_read_b128 v[100:103], v16 offset:16640
  v_mfma_f32_16x16x32_bf16 v[168:171], a[4:7], v[76:79], v[168:171]
  v_mfma_f32_16x16x32_bf16 v[168:171], a[8:11], v[84:87], v[168:171]
  ds_read_b128 v[104:107], v17 offset:256
  v_mfma_f32_16x16x32_bf16 v[168:171], a[12:15], v[92:95], v[168:171]
  v_mfma_f32_16x16x32_bf16 v[164:167], a[64:67], v[64:67], 0
  ds_read_b128 v[108:111], v17 offset:16640
  v_mfma_f32_16x16x32_bf16 v[164:167], a[68:71], v[72:75], v[164:167]
  v_mul_f32 v128, s69, v128
  v_mul_f32 v129, s69, v129
  v_mfma_f32_16x16x32_bf16 v[164:167], a[72:75], v[80:83], v[164:167]
  ds_read_b128 v[112:115], v18 offset:256
  v_mul_f32 v130, s69, v130
  v_mfma_f32_16x16x32_bf16 v[164:167], a[76:79], v[88:91], v[164:167]
  v_mul_f32 v131, s69, v131
  v_mul_f32 v132, s69, v132
  v_mfma_f32_16x16x32_bf16 v[172:175], a[64:67], v[68:71], 0
  ds_read_b128 v[116:119], v18 offset:16640
  v_mul_f32 v133, s69, v133
  v_mfma_f32_16x16x32_bf16 v[172:175], a[68:71], v[76:79], v[172:175]
  v_mul_f32 v134, s69, v134
  v_mul_f32 v135, s69, v135
  v_mfma_f32_16x16x32_bf16 v[172:175], a[72:75], v[84:87], v[172:175]
  ds_read_b128 v[120:123], v19 offset:256
  v_cvt_pk_bf16_f32 v192, v128, v129
  v_mfma_f32_16x16x32_bf16 v[172:175], a[76:79], v[92:95], v[172:175]
  v_cvt_pk_bf16_f32 v193, v130, v131
  v_cvt_pk_bf16_f32 v194, v132, v133
  v_mfma_f32_16x16x32_bf16 v[176:179], a[128:131], v[64:67], 0
  ds_read_b128 v[124:127], v19 offset:16640
  v_cvt_pk_bf16_f32 v195, v134, v135
  v_mfma_f32_16x16x32_bf16 v[176:179], a[132:135], v[72:75], v[176:179]
  buffer_store_dwordx4 v[192:195], v2, s[40:43], s62 offen offset:0 sc1
  v_mfma_f32_16x16x32_bf16 v[176:179], a[136:139], v[80:83], v[176:179]
  v_mul_f32 v136, s69, v136
  v_mul_f32 v137, s69, v137
  v_mfma_f32_16x16x32_bf16 v[176:179], a[140:143], v[88:91], v[176:179]
  v_mul_f32 v138, s69, v138
  v_mul_f32 v139, s69, v139
  v_mfma_f32_16x16x32_bf16 v[184:187], a[128:131], v[68:71], 0
  v_mul_f32 v140, s69, v140
  v_mul_f32 v141, s69, v141
  v_mfma_f32_16x16x32_bf16 v[184:187], a[132:135], v[76:79], v[184:187]
  v_mul_f32 v142, s69, v142
  v_mul_f32 v143, s69, v143
  v_mfma_f32_16x16x32_bf16 v[184:187], a[136:139], v[84:87], v[184:187]
  v_cvt_pk_bf16_f32 v196, v136, v137
  v_cvt_pk_bf16_f32 v197, v138, v139
  v_mfma_f32_16x16x32_bf16 v[184:187], a[140:143], v[92:95], v[184:187]
  v_cvt_pk_bf16_f32 v198, v140, v141
  v_cvt_pk_bf16_f32 v199, v142, v143
  v_mfma_f32_16x16x32_bf16 v[180:183], a[192:195], v[64:67], 0
  buffer_store_dwordx4 v[196:199], v2, s[40:43], s62 offen offset:1024 sc1
  v_mfma_f32_16x16x32_bf16 v[180:183], a[196:199], v[72:75], v[180:183]
  v_mul_f32 v144, s69, v144
  v_mul_f32 v145, s69, v145
  v_mfma_f32_16x16x32_bf16 v[180:183], a[200:203], v[80:83], v[180:183]
  v_mul_f32 v146, s69, v146
  v_mul_f32 v147, s69, v147
  v_mfma_f32_16x16x32_bf16 v[180:183], a[204:207], v[88:91], v[180:183]
  v_mul_f32 v148, s69, v148
  v_mul_f32 v149, s69, v149
  v_mfma_f32_16x16x32_bf16 v[188:191], a[192:195], v[68:71], 0
  v_mul_f32 v150, s69, v150
  v_mul_f32 v151, s69, v151
  v_mfma_f32_16x16x32_bf16 v[188:191], a[196:199], v[76:79], v[188:191]
  v_cvt_pk_bf16_f32 v200, v144, v145
  v_cvt_pk_bf16_f32 v201, v146, v147
  v_mfma_f32_16x16x32_bf16 v[188:191], a[200:203], v[84:87], v[188:191]
  v_cvt_pk_bf16_f32 v202, v148, v149
  v_cvt_pk_bf16_f32 v203, v150, v151
  v_mfma_f32_16x16x32_bf16 v[188:191], a[204:207], v[92:95], v[188:191]
  s_waitcnt lgkmcnt(0)
  buffer_store_dwordx4 v[200:203], v2, s[40:43], s62 offen offset:2048 sc1
  v_mfma_f32_16x16x32_bf16 v[160:163], a[16:19], v[96:99], v[160:163]
  v_mul_f32 v152, s69, v152
  v_mul_f32 v153, s69, v153
  v_mfma_f32_16x16x32_bf16 v[160:163], a[20:23], v[104:107], v[160:163]
  v_mul_f32 v154, s69, v154
  v_mul_f32 v155, s69, v155
  v_mfma_f32_16x16x32_bf16 v[160:163], a[24:27], v[112:115], v[160:163]
  ds_read_b128 v[64:67], v16 offset:512
  v_mul_f32 v156, s69, v156
  v_mfma_f32_16x16x32_bf16 v[160:163], a[28:31], v[120:123], v[160:163]
  v_mul_f32 v157, s69, v157
  v_mul_f32 v158, s69, v158
  v_mfma_f32_16x16x32_bf16 v[168:171], a[16:19], v[100:103], v[168:171]
  ds_read_b128 v[68:71], v16 offset:16896
  v_mul_f32 v159, s69, v159
  v_mfma_f32_16x16x32_bf16 v[168:171], a[20:23], v[108:111], v[168:171]
  v_cvt_pk_bf16_f32 v204, v152, v153
  v_cvt_pk_bf16_f32 v205, v154, v155
  v_mfma_f32_16x16x32_bf16 v[168:171], a[24:27], v[116:119], v[168:171]
  ds_read_b128 v[72:75], v17 offset:512
  v_cvt_pk_bf16_f32 v206, v156, v157
  v_mfma_f32_16x16x32_bf16 v[168:171], a[28:31], v[124:127], v[168:171]
  v_cvt_pk_bf16_f32 v207, v158, v159
  v_mfma_f32_16x16x32_bf16 v[164:167], a[80:83], v[96:99], v[164:167]
  ds_read_b128 v[76:79], v17 offset:16896
  v_mfma_f32_16x16x32_bf16 v[164:167], a[84:87], v[104:107], v[164:167]
  buffer_store_dwordx4 v[204:207], v2, s[40:43], s62 offen offset:3072 sc1
  v_mfma_f32_16x16x32_bf16 v[164:167], a[88:91], v[112:115], v[164:167]
  ds_read_b128 v[80:83], v18 offset:512
  v_mfma_f32_16x16x32_bf16 v[164:167], a[92:95], v[120:123], v[164:167]
  v_mfma_f32_16x16x32_bf16 v[172:175], a[80:83], v[100:103], v[172:175]
  ds_read_b128 v[84:87], v18 offset:16896
  v_mfma_f32_16x16x32_bf16 v[172:175], a[84:87], v[108:111], v[172:175]
  v_mfma_f32_16x16x32_bf16 v[172:175], a[88:91], v[116:119], v[172:175]
  ds_read_b128 v[88:91], v19 offset:512
  v_mfma_f32_16x16x32_bf16 v[172:175], a[92:95], v[124:127], v[172:175]
  v_mfma_f32_16x16x32_bf16 v[176:179], a[144:147], v[96:99], v[176:179]
  ds_read_b128 v[92:95], v19 offset:16896
  v_mfma_f32_16x16x32_bf16 v[176:179], a[148:151], v[104:107], v[176:179]
  v_mfma_f32_16x16x32_bf16 v[176:179], a[152:155], v[112:115], v[176:179]
  s_add_u32 s62, s62, s65
  s_cmp_eq_u32 s63, 15
  s_cselect_b32 s65, s71, 0x2000
  v_mfma_f32_16x16x32_bf16 v[176:179], a[156:159], v[120:123], v[176:179]
  s_add_u32 m0, s66, 0
  s_add_u32 s58, s61, 0
  v_mfma_f32_16x16x32_bf16 v[184:187], a[144:147], v[100:103], v[184:187]
  v_mfma_f32_16x16x32_bf16 v[184:187], a[148:151], v[108:111], v[184:187]
  buffer_load_dwordx4 v8, s[52:55], s58 offen lds
  v_mfma_f32_16x16x32_bf16 v[184:187], a[152:155], v[116:119], v[184:187]
  v_mfma_f32_16x16x32_bf16 v[184:187], a[156:159], v[124:127], v[184:187]
  s_add_u32 m0, s66, 1024
  s_add_u32 s58, s61, 1024
  v_mfma_f32_16x16x32_bf16 v[180:183], a[208:211], v[96:99], v[180:183]
  v_mfma_f32_16x16x32_bf16 v[180:183], a[212:215], v[104:107], v[180:183]
  buffer_load_dwordx4 v9, s[52:55], s58 offen lds
  v_mfma_f32_16x16x32_bf16 v[180:183], a[216:219], v[112:115], v[180:183]
  v_mfma_f32_16x16x32_bf16 v[180:183], a[220:223], v[120:123], v[180:183]
  s_add_u32 m0, s66, 2048
  s_add_u32 s58, s61, 2048
  v_mfma_f32_16x16x32_bf16 v[188:191], a[208:211], v[100:103], v[188:191]
  v_mfma_f32_16x16x32_bf16 v[188:191], a[212:215], v[108:111], v[188:191]
  buffer_load_dwordx4 v10, s[52:55], s58 offen lds
  v_mfma_f32_16x16x32_bf16 v[188:191], a[216:219], v[116:119], v[188:191]
  v_mfma_f32_16x16x32_bf16 v[188:191], a[220:223], v[124:127], v[188:191]
  s_waitcnt lgkmcnt(0)
  s_add_u32 m0, s66, 3072
  s_add_u32 s58, s61, 3072
  v_mfma_f32_16x16x32_bf16 v[160:163], a[32:35], v[64:67], v[160:163]
  v_mfma_f32_16x16x32_bf16 v[160:163], a[36:39], v[72:75], v[160:163]
  buffer_load_dwordx4 v11, s[52:55], s58 offen lds
  v_mfma_f32_16x16x32_bf16 v[160:163], a[40:43], v[80:83], v[160:163]
  ds_read_b128 v[96:99], v16 offset:768
  v_mfma_f32_16x16x32_bf16 v[160:163], a[44:47], v[88:91], v[160:163]
  s_add_u32 m0, s66, 4096
  s_add_u32 s58, s61, 4096
  v_mfma_f32_16x16x32_bf16 v[168:171], a[32:35], v[68:71], v[168:171]
  ds_read_b128 v[100:103], v16 offset:17152
  v_mfma_f32_16x16x32_bf16 v[168:171], a[36:39], v[76:79], v[168:171]
  buffer_load_dwordx4 v12, s[52:55], s58 offen lds
  v_mfma_f32_16x16x32_bf16 v[168:171], a[40:43], v[84:87], v[168:171]
  ds_read_b128 v[104:107], v17 offset:768
  v_mfma_f32_16x16x32_bf16 v[168:171], a[44:47], v[92:95], v[168:171]
  s_add_u32 m0, s66, 5120
  s_add_u32 s58, s61, 5120
  v_mfma_f32_16x16x32_bf16 v[164:167], a[96:99], v[64:67], v[164:167]
  ds_read_b128 v[108:111], v17 offset:17152
  v_mfma_f32_16x16x32_bf16 v[164:167], a[100:103], v[72:75], v[164:167]
  buffer_load_dwordx4 v13, s[52:55], s58 offen lds
  v_mfma_f32_16x16x32_bf16 v[164:167], a[104:107], v[80:83], v[164:167]
  ds_read_b128 v[112:115], v18 offset:768
  v_mfma_f32_16x16x32_bf16 v[164:167], a[108:111], v[88:91], v[164:167]
  s_add_u32 m0, s66, 6144
  s_add_u32 s58, s61, 6144
  v_mfma_f32_16x16x32_bf16 v[172:175], a[96:99], v[68:71], v[172:175]
  ds_read_b128 v[116:119], v18 offset:17152
  v_mfma_f32_16x16x32_bf16 v[172:175], a[100:103], v[76:79], v[172:175]
  buffer_load_dwordx4 v14, s[52:55], s58 offen lds
  v_mfma_f32_16x16x32_bf16 v[172:175], a[104:107], v[84:87], v[172:175]
  ds_read_b128 v[120:123], v19 offset:768
  v_mfma_f32_16x16x32_bf16 v[172:175], a[108:111], v[92:95], v[172:175]
  s_add_u32 m0, s66, 7168
  s_add_u32 s58, s61, 7168
  v_mfma_f32_16x16x32_bf16 v[176:179], a[160:163], v[64:67], v[176:179]
  ds_read_b128 v[124:127], v19 offset:17152
  v_mfma_f32_16x16x32_bf16 v[176:179], a[164:167], v[72:75], v[176:179]
  buffer_load_dwordx4 v15, s[52:55], s58 offen lds
  v_mfma_f32_16x16x32_bf16 v[176:179], a[168:171], v[80:83], v[176:179]
  v_mfma_f32_16x16x32_bf16 v[176:179], a[172:175], v[88:91], v[176:179]
  s_cmp_eq_u32 s63, 12
  s_cselect_b32 s59, s70, 0
  s_add_u32 s61, s61, s59
  v_mfma_f32_16x16x32_bf16 v[184:187], a[160:163], v[68:71], v[184:187]
  v_add_u32 v16, 0x8000, v16
  v_mfma_f32_16x16x32_bf16 v[184:187], a[164:167], v[76:79], v[184:187]
  s_add_u32 s61, s61, 0x8000
  v_and_b32 v16, 0x1ffff, v16
  v_mfma_f32_16x16x32_bf16 v[184:187], a[168:171], v[84:87], v[184:187]
  s_add_u32 s66, s66, 0x8000
  v_add_u32 v17, 0x8000, v17
  v_mfma_f32_16x16x32_bf16 v[184:187], a[172:175], v[92:95], v[184:187]
  s_and_b32 s66, s66, 0x1ffff
  v_and_b32 v17, 0x1ffff, v17
  v_mfma_f32_16x16x32_bf16 v[180:183], a[224:227], v[64:67], v[180:183]
  v_add_u32 v18, 0x8000, v18
  v_mfma_f32_16x16x32_bf16 v[180:183], a[228:231], v[72:75], v[180:183]
  v_and_b32 v18, 0x1ffff, v18
  v_mfma_f32_16x16x32_bf16 v[180:183], a[232:235], v[80:83], v[180:183]
  v_add_u32 v19, 0x8000, v19
  v_mfma_f32_16x16x32_bf16 v[180:183], a[236:239], v[88:91], v[180:183]
  v_and_b32 v19, 0x1ffff, v19
  v_mfma_f32_16x16x32_bf16 v[188:191], a[224:227], v[68:71], v[188:191]
  s_sub_u32 s59, s63, 1
  s_max_i32 s59, s59, 0
  v_mfma_f32_16x16x32_bf16 v[188:191], a[228:231], v[76:79], v[188:191]
  v_mov_b32 v7, s59
  v_mfma_f32_16x16x32_bf16 v[188:191], a[232:235], v[84:87], v[188:191]
  v_mfma_f32_16x16x32_bf16 v[188:191], a[236:239], v[92:95], v[188:191]
  s_waitcnt lgkmcnt(0)
  v_mfma_f32_16x16x32_bf16 v[160:163], a[48:51], v[96:99], v[160:163]
  s_waitcnt vmcnt(20)
  v_mfma_f32_16x16x32_bf16 v[160:163], a[52:55], v[104:107], v[160:163]
  s_barrier
  v_mfma_f32_16x16x32_bf16 v[160:163], a[56:59], v[112:115], v[160:163]
  ds_read_b128 v[64:67], v16 offset:0
  v_mfma_f32_16x16x32_bf16 v[160:163], a[60:63], v[120:123], v[160:163]
  buffer_store_dword v7, v6, s[40:43], s64 offen sc1
  v_mfma_f32_16x16x32_bf16 v[168:171], a[48:51], v[100:103], v[168:171]
  ds_read_b128 v[68:71], v16 offset:16384
  v_mfma_f32_16x16x32_bf16 v[168:171], a[52:55], v[108:111], v[168:171]
  v_mfma_f32_16x16x32_bf16 v[168:171], a[56:59], v[116:119], v[168:171]
  ds_read_b128 v[72:75], v17 offset:0
  v_mfma_f32_16x16x32_bf16 v[168:171], a[60:63], v[124:127], v[168:171]
  v_mfma_f32_16x16x32_bf16 v[164:167], a[112:115], v[96:99], v[164:167]
  ds_read_b128 v[76:79], v17 offset:16384
  v_mfma_f32_16x16x32_bf16 v[164:167], a[116:119], v[104:107], v[164:167]
  v_mfma_f32_16x16x32_bf16 v[164:167], a[120:123], v[112:115], v[164:167]
  ds_read_b128 v[80:83], v18 offset:0
  v_mfma_f32_16x16x32_bf16 v[164:167], a[124:127], v[120:123], v[164:167]
  v_mfma_f32_16x16x32_bf16 v[172:175], a[112:115], v[100:103], v[172:175]
  ds_read_b128 v[84:87], v18 offset:16384
  v_mfma_f32_16x16x32_bf16 v[172:175], a[116:119], v[108:111], v[172:175]
  v_mfma_f32_16x16x32_bf16 v[172:175], a[120:123], v[116:119], v[172:175]
  ds_read_b128 v[88:91], v19 offset:0
  v_mfma_f32_16x16x32_bf16 v[172:175], a[124:127], v[124:127], v[172:175]
  v_mfma_f32_16x16x32_bf16 v[176:179], a[176:179], v[96:99], v[176:179]
  ds_read_b128 v[92:95], v19 offset:16384
  v_mfma_f32_16x16x32_bf16 v[176:179], a[180:183], v[104:107], v[176:179]
  v_mfma_f32_16x16x32_bf16 v[176:179], a[184:187], v[112:115], v[176:179]
  v_mfma_f32_16x16x32_bf16 v[176:179], a[188:191], v[120:123], v[176:179]
  s_mov_b64 exec, 1
  buffer_atomic_add v33, v6, s[40:43], s76 offen
  s_mov_b64 exec, -1
  v_mfma_f32_16x16x32_bf16 v[184:187], a[176:179], v[100:103], v[184:187]
  s_mov_b32 s76, 0x40000000
  v_mfma_f32_16x16x32_bf16 v[184:187], a[180:183], v[108:111], v[184:187]
  v_mfma_f32_16x16x32_bf16 v[184:187], a[184:187], v[116:119], v[184:187]
  v_mfma_f32_16x16x32_bf16 v[184:187], a[188:191], v[124:127], v[184:187]
  v_mfma_f32_16x16x32_bf16 v[180:183], a[240:243], v[96:99], v[180:183]
  s_add_u32 s63, s63, 1
  v_mfma_f32_16x16x32_bf16 v[180:183], a[244:247], v[104:107], v[180:183]
  v_mfma_f32_16x16x32_bf16 v[180:183], a[248:251], v[112:115], v[180:183]
  v_mfma_f32_16x16x32_bf16 v[180:183], a[252:255], v[120:123], v[180:183]
  v_mfma_f32_16x16x32_bf16 v[188:191], a[240:243], v[100:103], v[188:191]
  v_mfma_f32_16x16x32_bf16 v[188:191], a[244:247], v[108:111], v[188:191]
  v_mfma_f32_16x16x32_bf16 v[188:191], a[248:251], v[116:119], v[188:191]
  s_cmp_lt_u32 s63, s67
  v_mfma_f32_16x16x32_bf16 v[188:191], a[252:255], v[124:127], v[188:191]
  s_waitcnt lgkmcnt(0)
  s_cbranch_scc1 L_f_00
  s_branch L_f_done
L_f_10:
  v_mfma_f32_16x16x32_bf16 v[128:131], v[64:67], a[0:3], 0
  v_mfma_f32_16x16x32_bf16 v[128:131], v[72:75], a[4:7], v[128:131]
  v_mfma_f32_16x16x32_bf16 v[128:131], v[80:83], a[8:11], v[128:131]
  ds_read_b128 v[96:99], v16 offset:256
  v_mfma_f32_16x16x32_bf16 v[128:131], v[88:91], a[12:15], v[128:131]
  v_mfma_f32_16x16x32_bf16 v[132:135], v[68:71], a[0:3], 0
  ds_read_b128 v[100:103], v16 offset:16640
  v_mfma_f32_16x16x32_bf16 v[132:135], v[76:79], a[4:7], v[132:135]
  v_mfma_f32_16x16x32_bf16 v[132:135], v[84:87], a[8:11], v[132:135]
  ds_read_b128 v[104:107], v17 offset:256
  v_mfma_f32_16x16x32_bf16 v[132:135], v[92:95], a[12:15], v[132:135]
  v_mfma_f32_16x16x32_bf16 v[136:139], v[64:67], a[64:67], 0
  ds_read_b128 v[108:111], v17 offset:16640
  v_mfma_f32_16x16x32_bf16 v[136:139], v[72:75], a[68:71], v[136:139]
  v_cvt_pk_bf16_f32 v192, v160, v161
  v_cvt_pk_bf16_f32 v193, v162, v163
  v_mfma_f32_16x16x32_bf16 v[136:139], v[80:83], a[72:75], v[136:139]
  ds_read_b128 v[112:115], v18 offset:256
  v_cvt_pk_bf16_f32 v194, v164, v165
  v_mfma_f32_16x16x32_bf16 v[136:139], v[88:91], a[76:79], v[136:139]
  v_cvt_pk_bf16_f32 v195, v166, v167
  v_mfma_f32_16x16x32_bf16 v[140:143], v[68:71], a[64:67], 0
  ds_read_b128 v[116:119], v18 offset:16640
  v_mfma_f32_16x16x32_bf16 v[140:143], v[76:79], a[68:71], v[140:143]
  buffer_store_dwordx4 v[192:195], v2, s[40:43], s62 offen offset:0 sc1
  v_mfma_f32_16x16x32_bf16 v[140:143], v[84:87], a[72:75], v[140:143]
  ds_read_b128 v[120:123], v19 offset:256
  v_cvt_pk_bf16_f32 v196, v168, v169
  v_mfma_f32_16x16x32_bf16 v[140:143], v[92:95], a[76:79], v[140:143]
  v_cvt_pk_bf16_f32 v197, v170, v171
  v_cvt_pk_bf16_f32 v198, v172, v173
  v_mfma_f32_16x16x32_bf16 v[144:147], v[64:67], a[128:131], 0
  ds_read_b128 v[124:127], v19 offset:16640
  v_cvt_pk_bf16_f32 v199, v174, v175
  v_mfma_f32_16x16x32_bf16 v[144:147], v[72:75], a[132:135], v[144:147]
  buffer_store_dwordx4 v[196:199], v2, s[40:43], s62 offen offset:1024 sc1
  v_mfma_f32_16x16x32_bf16 v[144:147], v[80:83], a[136:139], v[144:147]
  v_cvt_pk_bf16_f32 v200, v176, v177
  v_cvt_pk_bf16_f32 v201, v178, v179
  v_mfma_f32_16x16x32_bf16 v[144:147], v[88:91], a[140:143], v[144:147]
  v_cvt_pk_bf16_f32 v202, v180, v181
  v_cvt_pk_bf16_f32 v203, v182, v183
  v_mfma_f32_16x16x32_bf16 v[148:151], v[68:71], a[128:131], 0
  buffer_store_dwordx4 v[200:203], v2, s[40:43], s62 offen offset:2048 sc1
  v_mfma_f32_16x16x32_bf16 v[148:151], v[76:79], a[132:135], v[148:151]
  v_cvt_pk_bf16_f32 v204, v184, v185
  v_cvt_pk_bf16_f32 v205, v186, v187
  v_mfma_f32_16x16x32_bf16 v[148:151], v[84:87], a[136:139], v[148:151]
  v_cvt_pk_bf16_f32 v206, v188, v189
  v_cvt_pk_bf16_f32 v207, v190, v191
  v_mfma_f32_16x16x32_bf16 v[148:151], v[92:95], a[140:143], v[148:151]
  buffer_store_dwordx4 v[204:207], v2, s[40:43], s62 offen offset:3072 sc1
  v_mfma_f32_16x16x32_bf16 v[152:155], v[64:67], a[192:195], 0
  v_mfma_f32_16x16x32_bf16 v[152:155], v[72:75], a[196:199], v[152:155]
  v_mfma_f32_16x16x32_bf16 v[152:155], v[80:83], a[200:203], v[152:155]
  v_mfma_f32_16x16x32_bf16 v[152:155], v[88:91], a[204:207], v[152:155]
  v_mfma_f32_16x16x32_bf16 v[156:159], v[68:71], a[192:195], 0
  v_mfma_f32_16x16x32_bf16 v[156:159], v[76:79], a[196:199], v[156:159]
  v_mfma_f32_16x16x32_bf16 v[156:159], v[84:87], a[200:203], v[156:159]
  v_mfma_f32_16x16x32_bf16 v[156:159], v[92:95], a[204:207], v[156:159]
  s_waitcnt lgkmcnt(0)
  v_mfma_f32_16x16x32_bf16 v[128:131], v[96:99], a[16:19], v[128:131]
  v_mfma_f32_16x16x32_bf16 v[128:131], v[104:107], a[20:23], v[128:131]
  v_mfma_f32_16x16x32_bf16 v[128:131], v[112:115], a[24:27], v[128:131]
  ds_read_b128 v[64:67], v16 offset:512
  v_mfma_f32_16x16x32_bf16 v[128:131], v[120:123], a[28:31], v[128:131]
  v_mfma_f32_16x16x32_bf16 v[132:135], v[100:103], a[16:19], v[132:135]
  ds_read_b128 v[68:71], v16 offset:16896
  v_mfma_f32_16x16x32_bf16 v[132:135], v[108:111], a[20:23], v[132:135]
  v_mfma_f32_16x16x32_bf16 v[132:135], v[116:119], a[24:27], v[132:135]
  ds_read_b128 v[72:75], v17 offset:512
  v_mfma_f32_16x16x32_bf16 v[132:135], v[124:127], a[28:31], v[132:135]
  v_mfma_f32_16x16x32_bf16 v[136:139], v[96:99], a[80:83], v[136:139]
  ds_read_b128 v[76:79], v17 offset:16896
  v_mfma_f32_16x16x32_bf16 v[136:139], v[104:107], a[84:87], v[136:139]
  v_mfma_f32_16x16x32_bf16 v[136:139], v[112:115], a[88:91], v[136:139]
  ds_read_b128 v[80:83], v18 offset:512
  v_mfma_f32_16x16x32_bf16 v[136:139], v[120:123], a[92:95], v[136:139]
  v_mfma_f32_16x16x32_bf16 v[140:143], v[100:103], a[80:83], v[140:143]
  ds_read_b128 v[84:87], v18 offset:16896
  v_mfma_f32_16x16x32_bf16 v[140:143], v[108:111], a[84:87], v[140:143]
  v_mfma_f32_16x16x32_bf16 v[140:143], v[116:119], a[88:91], v[140:143]
  ds_read_b128 v[88:91], v19 offset:512
  v_mfma_f32_16x16x32_bf16 v[140:143], v[124:127], a[92:95], v[140:143]
  v_mfma_f32_16x16x32_bf16 v[144:147], v[96:99], a[144:147], v[144:147]
  ds_read_b128 v[92:95], v19 offset:16896
  v_mfma_f32_16x16x32_bf16 v[144:147], v[104:107], a[148:151], v[144:147]
  v_mfma_f32_16x16x32_bf16 v[144:147], v[112:115], a[152:155], v[144:147]
  s_add_u32 s62, s62, s65
  s_cmp_eq_u32 s63, 15
  s_cselect_b32 s65, s71, 0x2000
  v_mfma_f32_16x16x32_bf16 v[144:147], v[120:123], a[156:159], v[144:147]
  s_add_u32 m0, s66, 0
  s_add_u32 s58, s61, 0
  v_mfma_f32_16x16x32_bf16 v[148:151], v[100:103], a[144:147], v[148:151]
  v_mfma_f32_16x16x32_bf16 v[148:151], v[108:111], a[148:151], v[148:151]
  buffer_load_dwordx4 v8, s[52:55], s58 offen lds
  v_mfma_f32_16x16x32_bf16 v[148:151], v[116:119], a[152:155], v[148:151]
  v_mfma_f32_16x16x32_bf16 v[148:151], v[124:127], a[156:159], v[148:151]
  s_add_u32 m0, s66, 1024
  s_add_u32 s58, s61, 1024
  v_mfma_f32_16x16x32_bf16 v[152:155], v[96:99], a[208:211], v[152:155]
  v_mfma_f32_16x16x32_bf16 v[152:155], v[104:107], a[212:215], v[152:155]
  buffer_load_dwordx4 v9, s[52:55], s58 offen lds
  v_mfma_f32_16x16x32_bf16 v[152:155], v[112:115], a[216:219], v[152:155]
  v_mfma_f32_16x16x32_bf16 v[152:155], v[120:123], a[220:223], v[152:155]
  s_add_u32 m0, s66, 2048
  s_add_u32 s58, s61, 2048
  v_mfma_f32_16x16x32_bf16 v[156:159], v[100:103], a[208:211], v[156:159]
  v_mfma_f32_16x16x32_bf16 v[156:159], v[108:111], a[212:215], v[156:159]
  buffer_load_dwordx4 v10, s[52:55], s58 offen lds
  v_mfma_f32_16x16x32_bf16 v[156:159], v[116:119], a[216:219], v[156:159]
  v_mfma_f32_16x16x32_bf16 v[156:159], v[124:127], a[220:223], v[156:159]
  s_waitcnt lgkmcnt(0)
  s_add_u32 m0, s66, 3072
  s_add_u32 s58, s61, 3072
  v_mfma_f32_16x16x32_bf16 v[128:131], v[64:67], a[32:35], v[128:131]
  v_mfma_f32_16x16x32_bf16 v[128:131], v[72:75], a[36:39], v[128:131]
  buffer_load_dwordx4 v11, s[52:55], s58 offen lds
  v_mfma_f32_16x16x32_bf16 v[128:131], v[80:83], a[40:43], v[128:131]
  ds_read_b128 v[96:99], v16 offset:768
  v_mfma_f32_16x16x32_bf16 v[128:131], v[88:91], a[44:47], v[128:131]
  s_add_u32 m0, s66, 4096
  s_add_u32 s58, s61, 4096
  v_mfma_f32_16x16x32_bf16 v[132:135], v[68:71], a[32:35], v[132:135]
  ds_read_b128 v[100:103], v16 offset:17152
  v_mfma_f32_16x16x32_bf16 v[132:135], v[76:79], a[36:39], v[132:135]
  buffer_load_dwordx4 v12, s[52:55], s58 offen lds
  v_mfma_f32_16x16x32_bf16 v[132:135], v[84:87], a[40:43], v[132:135]
  ds_read_b128 v[104:107], v17 offset:768
  v_mfma_f32_16x16x32_bf16 v[132:135], v[92:95], a[44:47], v[132:135]
  s_add_u32 m0, s66, 5120
  s_add_u32 s58, s61, 5120
  v_mfma_f32_16x16x32_bf16 v[136:139], v[64:67], a[96:99], v[136:139]
  ds_read_b128 v[108:111], v17 offset:17152
  v_mfma_f32_16x16x32_bf16 v[136:139], v[72:75], a[100:103], v[136:139]
  buffer_load_dwordx4 v13, s[52:55], s58 offen lds
  v_mfma_f32_16x16x32_bf16 v[136:139], v[80:83], a[104:107], v[136:139]
  ds_read_b128 v[112:115], v18 offset:768
  v_mfma_f32_16x16x32_bf16 v[136:139], v[88:91], a[108:111], v[136:139]
  s_add_u32 m0, s66, 6144
  s_add_u32 s58, s61, 6144
  v_mfma_f32_16x16x32_bf16 v[140:143], v[68:71], a[96:99], v[140:143]
  ds_read_b128 v[116:119], v18 offset:17152
  v_mfma_f32_16x16x32_bf16 v[140:143], v[76:79], a[100:103], v[140:143]
  buffer_load_dwordx4 v14, s[52:55], s58 offen lds
  v_mfma_f32_16x16x32_bf16 v[140:143], v[84:87], a[104:107], v[140:143]
  ds_read_b128 v[120:123], v19 offset:768
  v_mfma_f32_16x16x32_bf16 v[140:143], v[92:95], a[108:111], v[140:143]
  s_add_u32 m0, s66, 7168
  s_add_u32 s58, s61, 7168
  v_mfma_f32_16x16x32_bf16 v[144:147], v[64:67], a[160:163], v[144:147]
  ds_read_b128 v[124:127], v19 offset:17152
  v_mfma_f32_16x16x32_bf16 v[144:147], v[72:75], a[164:167], v[144:147]
  buffer_load_dwordx4 v15, s[52:55], s58 offen lds
  v_mfma_f32_16x16x32_bf16 v[144:147], v[80:83], a[168:171], v[144:147]
  v_mfma_f32_16x16x32_bf16 v[144:147], v[88:91], a[172:175], v[144:147]
  s_cmp_eq_u32 s63, 12
  s_cselect_b32 s59, s70, 0
  s_add_u32 s61, s61, s59
  v_mfma_f32_16x16x32_bf16 v[148:151], v[68:71], a[160:163], v[148:151]
  v_add_u32 v16, 0x8000, v16
  v_mfma_f32_16x16x32_bf16 v[148:151], v[76:79], a[164:167], v[148:151]
  s_add_u32 s61, s61, 0x8000
  v_and_b32 v16, 0x1ffff, v16
  v_mfma_f32_16x16x32_bf16 v[148:151], v[84:87], a[168:171], v[148:151]
  s_add_u32 s66, s66, 0x8000
  v_add_u32 v17, 0x8000, v17
  v_mfma_f32_16x16x32_bf16 v[148:151], v[92:95], a[172:175], v[148:151]
  s_and_b32 s66, s66, 0x1ffff
  v_and_b32 v17, 0x1ffff, v17
  v_mfma_f32_16x16x32_bf16 v[152:155], v[64:67], a[224:227], v[152:155]
  v_add_u32 v18, 0x8000, v18
  v_mfma_f32_16x16x32_bf16 v[152:155], v[72:75], a[228:231], v[152:155]
  v_and_b32 v18, 0x1ffff, v18
  v_mfma_f32_16x16x32_bf16 v[152:155], v[80:83], a[232:235], v[152:155]
  v_add_u32 v19, 0x8000, v19
  v_mfma_f32_16x16x32_bf16 v[152:155], v[88:91], a[236:239], v[152:155]
  v_and_b32 v19, 0x1ffff, v19
  v_mfma_f32_16x16x32_bf16 v[156:159], v[68:71], a[224:227], v[156:159]
  s_sub_u32 s59, s63, 1
  s_max_i32 s59, s59, 0
  v_mfma_f32_16x16x32_bf16 v[156:159], v[76:79], a[228:231], v[156:159]
  v_mov_b32 v7, s59
  v_mfma_f32_16x16x32_bf16 v[156:159], v[84:87], a[232:235], v[156:159]
  v_mfma_f32_16x16x32_bf16 v[156:159], v[92:95], a[236:239], v[156:159]
  s_waitcnt lgkmcnt(0)
  v_mfma_f32_16x16x32_bf16 v[128:131], v[96:99], a[48:51], v[128:131]
  s_waitcnt vmcnt(20)
  v_mfma_f32_16x16x32_bf16 v[128:131], v[104:107], a[52:55], v[128:131]
  s_barrier
  v_mfma_f32_16x16x32_bf16 v[128:131], v[112:115], a[56:59], v[128:131]
  ds_read_b128 v[64:67], v16 offset:0
  v_mfma_f32_16x16x32_bf16 v[128:131], v[120:123], a[60:63], v[128:131]
  buffer_store_dword v7, v6, s[40:43], s64 offen sc1
  v_mfma_f32_16x16x32_bf16 v[132:135], v[100:103], a[48:51], v[132:135]
  ds_read_b128 v[68:71], v16 offset:16384
  v_mfma_f32_16x16x32_bf16 v[132:135], v[108:111], a[52:55], v[132:135]
  v_mfma_f32_16x16x32_bf16 v[132:135], v[116:119], a[56:59], v[132:135]
  ds_read_b128 v[72:75], v17 offset:0
  v_mfma_f32_16x16x32_bf16 v[132:135], v[124:127], a[60:63], v[132:135]
  v_mfma_f32_16x16x32_bf16 v[136:139], v[96:99], a[112:115], v[136:139]
  ds_read_b128 v[76:79], v17 offset:16384
  v_mfma_f32_16x16x32_bf16 v[136:139], v[104:107], a[116:119], v[136:139]
  v_mfma_f32_16x16x32_bf16 v[136:139], v[112:115], a[120:123], v[136:139]
  ds_read_b128 v[80:83], v18 offset:0
  v_mfma_f32_16x16x32_bf16 v[136:139], v[120:123], a[124:127], v[136:139]
  v_mfma_f32_16x16x32_bf16 v[140:143], v[100:103], a[112:115], v[140:143]
  ds_read_b128 v[84:87], v18 offset:16384
  v_mfma_f32_16x16x32_bf16 v[140:143], v[108:111], a[116:119], v[140:143]
  v_mfma_f32_16x16x32_bf16 v[140:143], v[116:119], a[120:123], v[140:143]
  ds_read_b128 v[88:91], v19 offset:0
  v_mfma_f32_16x16x32_bf16 v[140:143], v[124:127], a[124:127], v[140:143]
  v_mfma_f32_16x16x32_bf16 v[144:147], v[96:99], a[176:179], v[144:147]
  ds_read_b128 v[92:95], v19 offset:16384
  v_mfma_f32_16x16x32_bf16 v[144:147], v[104:107], a[180:183], v[144:147]
  v_mfma_f32_16x16x32_bf16 v[144:147], v[112:115], a[184:187], v[144:147]
  v_mfma_f32_16x16x32_bf16 v[144:147], v[120:123], a[188:191], v[144:147]
  v_mfma_f32_16x16x32_bf16 v[148:151], v[100:103], a[176:179], v[148:151]
  v_mfma_f32_16x16x32_bf16 v[148:151], v[108:111], a[180:183], v[148:151]
  v_mfma_f32_16x16x32_bf16 v[148:151], v[116:119], a[184:187], v[148:151]
  v_mfma_f32_16x16x32_bf16 v[148:151], v[124:127], a[188:191], v[148:151]
  v_mfma_f32_16x16x32_bf16 v[152:155], v[96:99], a[240:243], v[152:155]
  s_add_u32 s63, s63, 1
  v_mfma_f32_16x16x32_bf16 v[152:155], v[104:107], a[244:247], v[152:155]
  v_mfma_f32_16x16x32_bf16 v[152:155], v[112:115], a[248:251], v[152:155]
  v_mfma_f32_16x16x32_bf16 v[152:155], v[120:123], a[252:255], v[152:155]
  v_mfma_f32_16x16x32_bf16 v[156:159], v[100:103], a[240:243], v[156:159]
  v_mfma_f32_16x16x32_bf16 v[156:159], v[108:111], a[244:247], v[156:159]
  v_mfma_f32_16x16x32_bf16 v[156:159], v[116:119], a[248:251], v[156:159]
  s_cmp_lt_u32 s63, s67
  v_mfma_f32_16x16x32_bf16 v[156:159], v[124:127], a[252:255], v[156:159]
  s_waitcnt lgkmcnt(0)
L_f_11:
  v_mfma_f32_16x16x32_bf16 v[160:163], v[64:67], a[0:3], 0
  v_mfma_f32_16x16x32_bf16 v[160:163], v[72:75], a[4:7], v[160:163]
  v_mfma_f32_16x16x32_bf16 v[160:163], v[80:83], a[8:11], v[160:163]
  ds_read_b128 v[96:99], v16 offset:256
  v_mfma_f32_16x16x32_bf16 v[160:163], v[88:91], a[12:15], v[160:163]
  v_mfma_f32_16x16x32_bf16 v[164:167], v[68:71], a[0:3], 0
  ds_read_b128 v[100:103], v16 offset:16640
  v_mfma_f32_16x16x32_bf16 v[164:167], v[76:79], a[4:7], v[164:167]
  v_mfma_f32_16x16x32_bf16 v[164:167], v[84:87], a[8:11], v[164:167]
  ds_read_b128 v[104:107], v17 offset:256
  v_mfma_f32_16x16x32_bf16 v[164:167], v[92:95], a[12:15], v[164:167]
  v_mfma_f32_16x16x32_bf16 v[168:171], v[64:67], a[64:67], 0
  ds_read_b128 v[108:111], v17 offset:16640
  v_mfma_f32_16x16x32_bf16 v[168:171], v[72:75], a[68:71], v[168:171]
  v_cvt_pk_bf16_f32 v192, v128, v129
  v_cvt_pk_bf16_f32 v193, v130, v131
  v_mfma_f32_16x16x32_bf16 v[168:171], v[80:83], a[72:75], v[168:171]
  ds_read_b128 v[112:115], v18 offset:256
  v_cvt_pk_bf16_f32 v194, v132, v133
  v_mfma_f32_16x16x32_bf16 v[168:171], v[88:91], a[76:79], v[168:171]
  v_cvt_pk_bf16_f32 v195, v134, v135
  v_mfma_f32_16x16x32_bf16 v[172:175], v[68:71], a[64:67], 0
  ds_read_b128 v[116:119], v18 offset:16640
  v_mfma_f32_16x16x32_bf16 v[172:175], v[76:79], a[68:71], v[172:175]
  buffer_store_dwordx4 v[192:195], v2, s[40:43], s62 offen offset:0 sc1
  v_mfma_f32_16x16x32_bf16 v[172:175], v[84:87], a[72:75], v[172:175]
  ds_read_b128 v[120:123], v19 offset:256
  v_cvt_pk_bf16_f32 v196, v136, v137
  v_mfma_f32_16x16x32_bf16 v[172:175], v[92:95], a[76:79], v[172:175]
  v_cvt_pk_bf16_f32 v197, v138, v139
  v_cvt_pk_bf16_f32 v198, v140, v141
  v_mfma_f32_16x16x32_bf16 v[176:179], v[64:67], a[128:131], 0
  ds_read_b128 v[124:127], v19 offset:16640
  v_cvt_pk_bf16_f32 v199, v142, v143
  v_mfma_f32_16x16x32_bf16 v[176:179], v[72:75], a[132:135], v[176:179]
  buffer_store_dwordx4 v[196:199], v2, s[40:43], s62 offen offset:1024 sc1
  v_mfma_f32_16x16x32_bf16 v[176:179], v[80:83], a[136:139], v[176:179]
  v_cvt_pk_bf16_f32 v200, v144, v145
  v_cvt_pk_bf16_f32 v201, v146, v147
  v_mfma_f32_16x16x32_bf16 v[176:179], v[88:91], a[140:143], v[176:179]
  v_cvt_pk_bf16_f32 v202, v148, v149
  v_cvt_pk_bf16_f32 v203, v150, v151
  v_mfma_f32_16x16x32_bf16 v[180:183], v[68:71], a[128:131], 0
  buffer_store_dwordx4 v[200:203], v2, s[40:43], s62 offen offset:2048 sc1
  v_mfma_f32_16x16x32_bf16 v[180:183], v[76:79], a[132:135], v[180:183]
  v_cvt_pk_bf16_f32 v204, v152, v153
  v_cvt_pk_bf16_f32 v205, v154, v155
  v_mfma_f32_16x16x32_bf16 v[180:183], v[84:87], a[136:139], v[180:183]
  v_cvt_pk_bf16_f32 v206, v156, v157
  v_cvt_pk_bf16_f32 v207, v158, v159
  v_mfma_f32_16x16x32_bf16 v[180:183], v[92:95], a[140:143], v[180:183]
  buffer_store_dwordx4 v[204:207], v2, s[40:43], s62 offen offset:3072 sc1
  v_mfma_f32_16x16x32_bf16 v[184:187], v[64:67], a[192:195], 0
  v_mfma_f32_16x16x32_bf16 v[184:187], v[72:75], a[196:199], v[184:187]
  v_mfma_f32_16x16x32_bf16 v[184:187], v[80:83], a[200:203], v[184:187]
  v_mfma_f32_16x16x32_bf16 v[184:187], v[88:91], a[204:207], v[184:187]
  v_mfma_f32_16x16x32_bf16 v[188:191], v[68:71], a[192:195], 0
  v_mfma_f32_16x16x32_bf16 v[188:191], v[76:79], a[196:199], v[188:191]
  v_mfma_f32_16x16x32_bf16 v[188:191], v[84:87], a[200:203], v[188:191]
  v_mfma_f32_16x16x32_bf16 v[188:191], v[92:95], a[204:207], v[188:191]
  s_waitcnt lgkmcnt(0)
  v_mfma_f32_16x16x32_bf16 v[160:163], v[96:99], a[16:19], v[160:163]
  v_mfma_f32_16x16x32_bf16 v[160:163], v[104:107], a[20:23], v[160:163]
  v_mfma_f32_16x16x32_bf16 v[160:163], v[112:115], a[24:27], v[160:163]
  ds_read_b128 v[64:67], v16 offset:512
  v_mfma_f32_16x16x32_bf16 v[160:163], v[120:123], a[28:31], v[160:163]
  v_mfma_f32_16x16x32_bf16 v[164:167], v[100:103], a[16:19], v[164:167]
  ds_read_b128 v[68:71], v16 offset:16896
  v_mfma_f32_16x16x32_bf16 v[164:167], v[108:111], a[20:23], v[164:167]
  v_mfma_f32_16x16x32_bf16 v[164:167], v[116:119], a[24:27], v[164:167]
  ds_read_b128 v[72:75], v17 offset:512
  v_mfma_f32_16x16x32_bf16 v[164:167], v[124:127], a[28:31], v[164:167]
  v_mfma_f32_16x16x32_bf16 v[168:171], v[96:99], a[80:83], v[168:171]
  ds_read_b128 v[76:79], v17 offset:16896
  v_mfma_f32_16x16x32_bf16 v[168:171], v[104:107], a[84:87], v[168:171]
  v_mfma_f32_16x16x32_bf16 v[168:171], v[112:115], a[88:91], v[168:171]
  ds_read_b128 v[80:83], v18 offset:512
  v_mfma_f32_16x16x32_bf16 v[168:171], v[120:123], a[92:95], v[168:171]
  v_mfma_f32_16x16x32_bf16 v[172:175], v[100:103], a[80:83], v[172:175]
  ds_read_b128 v[84:87], v18 offset:16896
  v_mfma_f32_16x16x32_bf16 v[172:175], v[108:111], a[84:87], v[172:175]
  v_mfma_f32_16x16x32_bf16 v[172:175], v[116:119], a[88:91], v[172:175]
  ds_read_b128 v[88:91], v19 offset:512
  v_mfma_f32_16x16x32_bf16 v[172:175], v[124:127], a[92:95], v[172:175]
  v_mfma_f32_16x16x32_bf16 v[176:179], v[96:99], a[144:147], v[176:179]
  ds_read_b128 v[92:95], v19 offset:16896
  v_mfma_f32_16x16x32_bf16 v[176:179], v[104:107], a[148:151], v[176:179]
  v_mfma_f32_16x16x32_bf16 v[176:179], v[112:115], a[152:155], v[176:179]
  s_add_u32 s62, s62, s65
  s_cmp_eq_u32 s63, 15
  s_cselect_b32 s65, s71, 0x2000
  v_mfma_f32_16x16x32_bf16 v[176:179], v[120:123], a[156:159], v[176:179]
  s_add_u32 m0, s66, 0
  s_add_u32 s58, s61, 0
  v_mfma_f32_16x16x32_bf16 v[180:183], v[100:103], a[144:147], v[180:183]
  v_mfma_f32_16x16x32_bf16 v[180:183], v[108:111], a[148:151], v[180:183]
  buffer_load_dwordx4 v8, s[52:55], s58 offen lds
  v_mfma_f32_16x16x32_bf16 v[180:183], v[116:119], a[152:155], v[180:183]
  v_mfma_f32_16x16x32_bf16 v[180:183], v[124:127], a[156:159], v[180:183]
  s_add_u32 m0, s66, 1024
  s_add_u32 s58, s61, 1024
  v_mfma_f32_16x16x32_bf16 v[184:187], v[96:99], a[208:211], v[184:187]
  v_mfma_f32_16x16x32_bf16 v[184:187], v[104:107], a[212:215], v[184:187]
  buffer_load_dwordx4 v9, s[52:55], s58 offen lds
  v_mfma_f32_16x16x32_bf16 v[184:187], v[112:115], a[216:219], v[184:187]
  v_mfma_f32_16x16x32_bf16 v[184:187], v[120:123], a[220:223], v[184:187]
  s_add_u32 m0, s66, 2048
  s_add_u32 s58, s61, 2048
  v_mfma_f32_16x16x32_bf16 v[188:191], v[100:103], a[208:211], v[188:191]
  v_mfma_f32_16x16x32_bf16 v[188:191], v[108:111], a[212:215], v[188:191]
  buffer_load_dwordx4 v10, s[52:55], s58 offen lds
  v_mfma_f32_16x16x32_bf16 v[188:191], v[116:119], a[216:219], v[188:191]
  v_mfma_f32_16x16x32_bf16 v[188:191], v[124:127], a[220:223], v[188:191]
  s_waitcnt lgkmcnt(0)
  s_add_u32 m0, s66, 3072
  s_add_u32 s58, s61, 3072
  v_mfma_f32_16x16x32_bf16 v[160:163], v[64:67], a[32:35], v[160:163]
  v_mfma_f32_16x16x32_bf16 v[160:163], v[72:75], a[36:39], v[160:163]
  buffer_load_dwordx4 v11, s[52:55], s58 offen lds
  v_mfma_f32_16x16x32_bf16 v[160:163], v[80:83], a[40:43], v[160:163]
  ds_read_b128 v[96:99], v16 offset:768
  v_mfma_f32_16x16x32_bf16 v[160:163], v[88:91], a[44:47], v[160:163]
  s_add_u32 m0, s66, 4096
  s_add_u32 s58, s61, 4096
  v_mfma_f32_16x16x32_bf16 v[164:167], v[68:71], a[32:35], v[164:167]
  ds_read_b128 v[100:103], v16 offset:17152
  v_mfma_f32_16x16x32_bf16 v[164:167], v[76:79], a[36:39], v[164:167]
  buffer_load_dwordx4 v12, s[52:55], s58 offen lds
  v_mfma_f32_16x16x32_bf16 v[164:167], v[84:87], a[40:43], v[164:167]
  ds_read_b128 v[104:107], v17 offset:768
  v_mfma_f32_16x16x32_bf16 v[164:167], v[92:95], a[44:47], v[164:167]
  s_add_u32 m0, s66, 5120
  s_add_u32 s58, s61, 5120
  v_mfma_f32_16x16x32_bf16 v[168:171], v[64:67], a[96:99], v[168:171]
  ds_read_b128 v[108:111], v17 offset:17152
  v_mfma_f32_16x16x32_bf16 v[168:171], v[72:75], a[100:103], v[168:171]
  buffer_load_dwordx4 v13, s[52:55], s58 offen lds
  v_mfma_f32_16x16x32_bf16 v[168:171], v[80:83], a[104:107], v[168:171]
  ds_read_b128 v[112:115], v18 offset:768
  v_mfma_f32_16x16x32_bf16 v[168:171], v[88:91], a[108:111], v[168:171]
  s_add_u32 m0, s66, 6144
  s_add_u32 s58, s61, 6144
  v_mfma_f32_16x16x32_bf16 v[172:175], v[68:71], a[96:99], v[172:175]
  ds_read_b128 v[116:119], v18 offset:17152
  v_mfma_f32_16x16x32_bf16 v[172:175], v[76:79], a[100:103], v[172:175]
  buffer_load_dwordx4 v14, s[52:55], s58 offen lds
  v_mfma_f32_16x16x32_bf16 v[172:175], v[84:87], a[104:107], v[172:175]
  ds_read_b128 v[120:123], v19 offset:768
  v_mfma_f32_16x16x32_bf16 v[172:175], v[92:95], a[108:111], v[172:175]
  s_add_u32 m0, s66, 7168
  s_add_u32 s58, s61, 7168
  v_mfma_f32_16x16x32_bf16 v[176:179], v[64:67], a[160:163], v[176:179]
  ds_read_b128 v[124:127], v19 offset:17152
  v_mfma_f32_16x16x32_bf16 v[176:179], v[72:75], a[164:167], v[176:179]
  buffer_load_dwordx4 v15, s[52:55], s58 offen lds
  v_mfma_f32_16x16x32_bf16 v[176:179], v[80:83], a[168:171], v[176:179]
  v_mfma_f32_16x16x32_bf16 v[176:179], v[88:91], a[172:175], v[176:179]
  s_cmp_eq_u32 s63, 12
  s_cselect_b32 s59, s70, 0
  s_add_u32 s61, s61, s59
  v_mfma_f32_16x16x32_bf16 v[180:183], v[68:71], a[160:163], v[180:183]
  v_add_u32 v16, 0x8000, v16
  v_mfma_f32_16x16x32_bf16 v[180:183], v[76:79], a[164:167], v[180:183]
  s_add_u32 s61, s61, 0x8000
  v_and_b32 v16, 0x1ffff, v16
  v_mfma_f32_16x16x32_bf16 v[180:183], v[84:87], a[168:171], v[180:183]
  s_add_u32 s66, s66, 0x8000
  v_add_u32 v17, 0x8000, v17
  v_mfma_f32_16x16x32_bf16 v[180:183], v[92:95], a[172:175], v[180:183]
  s_and_b32 s66, s66, 0x1ffff
  v_and_b32 v17, 0x1ffff, v17
  v_mfma_f32_16x16x32_bf16 v[184:187], v[64:67], a[224:227], v[184:187]
  v_add_u32 v18, 0x8000, v18
  v_mfma_f32_16x16x32_bf16 v[184:187], v[72:75], a[228:231], v[184:187]
  v_and_b32 v18, 0x1ffff, v18
  v_mfma_f32_16x16x32_bf16 v[184:187], v[80:83], a[232:235], v[184:187]
  v_add_u32 v19, 0x8000, v19
  v_mfma_f32_16x16x32_bf16 v[184:187], v[88:91], a[236:239], v[184:187]
  v_and_b32 v19, 0x1ffff, v19
  v_mfma_f32_16x16x32_bf16 v[188:191], v[68:71], a[224:227], v[188:191]
  s_sub_u32 s59, s63, 1
  s_max_i32 s59, s59, 0
  v_mfma_f32_16x16x32_bf16 v[188:191], v[76:79], a[228:231], v[188:191]
  v_mov_b32 v7, s59
  v_mfma_f32_16x16x32_bf16 v[188:191], v[84:87], a[232:235], v[188:191]
  v_mfma_f32_16x16x32_bf16 v[188:191], v[92:95], a[236:239], v[188:191]
  s_waitcnt lgkmcnt(0)
  v_mfma_f32_16x16x32_bf16 v[160:163], v[96:99], a[48:51], v[160:163]
  s_waitcnt vmcnt(20)
  v_mfma_f32_16x16x32_bf16 v[160:163], v[104:107], a[52:55], v[160:163]
  s_barrier
  v_mfma_f32_16x16x32_bf16 v[160:163], v[112:115], a[56:59], v[160:163]
  ds_read_b128 v[64:67], v16 offset:0
  v_mfma_f32_16x16x32_bf16 v[160:163], v[120:123], a[60:63], v[160:163]
  buffer_store_dword v7, v6, s[40:43], s64 offen sc1
  v_mfma_f32_16x16x32_bf16 v[164:167], v[100:103], a[48:51], v[164:167]
  ds_read_b128 v[68:71], v16 offset:16384
  v_mfma_f32_16x16x32_bf16 v[164:167], v[108:111], a[52:55], v[164:167]
  v_mfma_f32_16x16x32_bf16 v[164:167], v[116:119], a[56:59], v[164:167]
  ds_read_b128 v[72:75], v17 offset:0
  v_mfma_f32_16x16x32_bf16 v[164:167], v[124:127], a[60:63], v[164:167]
  v_mfma_f32_16x16x32_bf16 v[168:171], v[96:99], a[112:115], v[168:171]
  ds_read_b128 v[76:79], v17 offset:16384
  v_mfma_f32_16x16x32_bf16 v[168:171], v[104:107], a[116:119], v[168:171]
  v_mfma_f32_16x16x32_bf16 v[168:171], v[112:115], a[120:123], v[168:171]
  ds_read_b128 v[80:83], v18 offset:0
  v_mfma_f32_16x16x32_bf16 v[168:171], v[120:123], a[124:127], v[168:171]
  v_mfma_f32_16x16x32_bf16 v[172:175], v[100:103], a[112:115], v[172:175]
  ds_read_b128 v[84:87], v18 offset:16384
  v_mfma_f32_16x16x32_bf16 v[172:175], v[108:111], a[116:119], v[172:175]
  v_mfma_f32_16x16x32_bf16 v[172:175], v[116:119], a[120:123], v[172:175]
  ds_read_b128 v[88:91], v19 offset:0
  v_mfma_f32_16x16x32_bf16 v[172:175], v[124:127], a[124:127], v[172:175]
  v_mfma_f32_16x16x32_bf16 v[176:179], v[96:99], a[176:179], v[176:179]
  ds_read_b128 v[92:95], v19 offset:16384
  v_mfma_f32_16x16x32_bf16 v[176:179], v[104:107], a[180:183], v[176:179]
  v_mfma_f32_16x16x32_bf16 v[176:179], v[112:115], a[184:187], v[176:179]
  v_mfma_f32_16x16x32_bf16 v[176:179], v[120:123], a[188:191], v[176:179]
  v_mfma_f32_16x16x32_bf16 v[180:183], v[100:103], a[176:179], v[180:183]
  v_mfma_f32_16x16x32_bf16 v[180:183], v[108:111], a[180:183], v[180:183]
  v_mfma_f32_16x16x32_bf16 v[180:183], v[116:119], a[184:187], v[180:183]
  v_mfma_f32_16x16x32_bf16 v[180:183], v[124:127], a[188:191], v[180:183]
  v_mfma_f32_16x16x32_bf16 v[184:187], v[96:99], a[240:243], v[184:187]
  s_add_u32 s63, s63, 1
  v_mfma_f32_16x16x32_bf16 v[184:187], v[104:107], a[244:247], v[184:187]
  v_mfma_f32_16x16x32_bf16 v[184:187], v[112:115], a[248:251], v[184:187]
  v_mfma_f32_16x16x32_bf16 v[184:187], v[120:123], a[252:255], v[184:187]
  v_mfma_f32_16x16x32_bf16 v[188:191], v[100:103], a[240:243], v[188:191]
  v_mfma_f32_16x16x32_bf16 v[188:191], v[108:111], a[244:247], v[188:191]
  v_mfma_f32_16x16x32_bf16 v[188:191], v[116:119], a[248:251], v[188:191]
  s_cmp_lt_u32 s63, s67
  v_mfma_f32_16x16x32_bf16 v[188:191], v[124:127], a[252:255], v[188:191]
  s_waitcnt lgkmcnt(0)
  s_cbranch_scc1 L_f_10
  s_branch L_f_done
L_f_done:
  s_nop 7
  v_mul_f32 v160, s69, v160
  v_mul_f32 v161, s69, v161
  v_mul_f32 v162, s69, v162
  v_mul_f32 v163, s69, v163
  v_mul_f32 v164, s69, v164
  v_mul_f32 v165, s69, v165
  v_mul_f32 v166, s69, v166
  v_mul_f32 v167, s69, v167
  v_cvt_pk_bf16_f32 v192, v160, v161
  v_cvt_pk_bf16_f32 v193, v162, v163
  v_cvt_pk_bf16_f32 v194, v164, v165
  v_cvt_pk_bf16_f32 v195, v166, v167
  buffer_store_dwordx4 v[192:195], v2, s[40:43], s62 offen offset:0 sc1
  v_mul_f32 v168, s69, v168
  v_mul_f32 v169, s69, v169
  v_mul_f32 v170, s69, v170
  v_mul_f32 v171, s69, v171
  v_mul_f32 v172, s69, v172
  v_mul_f32 v173, s69, v173
  v_mul_f32 v174, s69, v174
  v_mul_f32 v175, s69, v175
  v_cvt_pk_bf16_f32 v196, v168, v169
  v_cvt_pk_bf16_f32 v197, v170, v171
  v_cvt_pk_bf16_f32 v198, v172, v173
  v_cvt_pk_bf16_f32 v199, v174, v175
  buffer_store_dwordx4 v[196:199], v2, s[40:43], s62 offen offset:1024 sc1
  v_mul_f32 v176, s69, v176
  v_mul_f32 v177, s69, v177
  v_mul_f32 v178, s69, v178
  v_mul_f32 v179, s69, v179
  v_mul_f32 v180, s69, v180
  v_mul_f32 v181, s69, v181
  v_mul_f32 v182, s69, v182
  v_mul_f32 v183, s69, v183
  v_cvt_pk_bf16_f32 v200, v176, v177
  v_cvt_pk_bf16_f32 v201, v178, v179
  v_cvt_pk_bf16_f32 v202, v180, v181
  v_cvt_pk_bf16_f32 v203, v182, v183
  buffer_store_dwordx4 v[200:203], v2, s[40:43], s62 offen offset:2048 sc1
  v_mul_f32 v184, s69, v184
  v_mul_f32 v185, s69, v185
  v_mul_f32 v186, s69, v186
  v_mul_f32 v187, s69, v187
  v_mul_f32 v188, s69, v188
  v_mul_f32 v189, s69, v189
  v_mul_f32 v190, s69, v190
  v_mul_f32 v191, s69, v191
  v_cvt_pk_bf16_f32 v204, v184, v185
  v_cvt_pk_bf16_f32 v205, v186, v187
  v_cvt_pk_bf16_f32 v206, v188, v189
  v_cvt_pk_bf16_f32 v207, v190, v191
  buffer_store_dwordx4 v[204:207], v2, s[40:43], s62 offen offset:3072 sc1
  v_mov_b32 v7, s67
  s_waitcnt vmcnt(0) lgkmcnt(0)
  s_barrier
  buffer_store_dword v7, v6, s[40:43], s64 offen sc1
  s_branch L_next
L_after_p:
  s_waitcnt vmcnt(0)
  s_endpgm
L_team:
  s_mov_b32 s67, 0
  v_lshrrev_b32 v20, 4, v0
  v_and_b32 v21, 15, v0
  s_lshl_b32 s68, s44, 11
  s_add_u32 s68, s68, 131072
  v_lshl_add_u32 v2, v0, 4, s68
  v_add_u32 v11, 24576, v2
  s_mov_b32 s73, s68
  s_lshl_b32 s68, s44, 12
  v_lshl_add_u32 v3, v0, 4, s68
  s_lshl_b32 s68, s44, 9
  s_add_u32 s68, s68, 131072
  v_bfe_u32 v22, v0, 3, 1
  v_lshl_add_u32 v5, v22, 8, s68
  v_lshl_add_u32 v5, v20, 6, v5
  v_and_b32 v22, 7, v0
  v_lshl_add_u32 v5, v22, 3, v5
  v_lshrrev_b32 v22, 5, v0
  v_lshlrev_b32 v6, 8, v22
  v_and_b32 v22, 3, v0
  v_lshl_add_u32 v6, v22, 6, v6
  v_bfe_u32 v22, v0, 2, 3
  v_lshl_add_u32 v6, v22, 3, v6
  v_add_u32 v6, 131072, v6
  s_lshl_b32 s68, s44, 9
  s_add_u32 s68, s68, 131072
  v_lshrrev_b32 v22, 1, v0
  v_lshl_add_u32 v7, v22, 4, s68
  s_lshl_b32 s68, s44, 14
  s_lshl_b32 s69, s45, 6
  s_add_u32 s68, s68, s69
  v_lshrrev_b32 v22, 3, v0
  v_lshl_add_u32 v8, v22, 11, s68
  v_and_b32 v22, 7, v0
  v_lshl_add_u32 v8, v22, 3, v8
  v_lshlrev_b32 v9, 8, v20
  v_bfe_u32 v22, v0, 2, 1
  v_lshl_add_u32 v9, v22, 7, v9
  v_and_b32 v22, 1, v0
  v_lshl_add_u32 v9, v22, 6, v9
  v_bfe_u32 v22, v0, 3, 1
  v_lshl_add_u32 v9, v22, 5, v9
  v_bfe_u32 v22, v0, 1, 1
  v_lshl_add_u32 v9, v22, 4, v9
  s_lshl_b32 s68, s44, 16
  s_lshl_b32 s69, s45, 11
  s_add_u32 s68, s68, s69
  s_add_u32 s62, s68, 0xd000000
  v_bfe_u32 v22, v0, 3, 1
  v_lshlrev_b32 v10, 13, v22
  v_lshl_add_u32 v10, v20, 3, v10
  v_bfe_u32 v22, v0, 1, 1
  v_lshl_add_u32 v10, v22, 5, v10
  v_bfe_u32 v22, v0, 2, 1
  v_lshl_add_u32 v10, v22, 2, v10
  v_and_b32 v22, 1, v0
  v_lshl_add_u32 v10, v22, 1, v10
  s_lshl_b32 s64, s44, 11
  s_lshr_b32 s68, s45, 3
  s_lshl_b32 s68, s68, 9
  s_add_u32 s64, s64, s68
  s_and_b32 s68, s45, 1
  s_lshl_b32 s68, s68, 8
  s_add_u32 s64, s64, s68
  s_bfe_u32 s68, s45, 0x20001
  s_lshl_b32 s68, s68, 6
  s_add_u32 s64, s64, s68
  s_add_u32 s64, s64, 0xd040000
  s_mov_b32 s63, 0xd01c000
  s_lshl_b32 s60, s45, 7
  s_add_u32 s60, s60, 0xd081000
  s_lshl_b32 s72, s45, 19
  s_add_u32 s72, s72, 0x3fe0000
  s_mov_b32 s94, 0xaaaaaaaa
  s_mov_b32 s95, 0xaaaaaaaa
  v_mov_b32 v17, 0
  v_mov_b32 v18, 0
  v_mov_b32 v16, 0
  v_mov_b32 v12, 0x3f803f80
  v_mov_b32 v13, 0x3f803f80
  v_mov_b32 v14, 0x3f803f80
  v_mov_b32 v15, 0x3f803f80
  s_mov_b32 s78, 0xff00ff00
  s_mov_b32 s79, 0xff00ff00
  s_mov_b32 s88, 0x3e0293ee
  s_mov_b32 s89, 0x21800000
  s_mov_b32 s91, 0x3c000000
  s_mov_b32 s90, 0xfffe
  s_lshl_b32 s68, s44, 11
  s_add_u32 s70, s68, 147456
  s_add_u32 s71, s68, 139264
  s_lshl_b32 s68, s45, 7
  s_add_u32 s68, s68, 0xd084000
  s_cmp_eq_u32 s44, 0
  s_cselect_b32 s66, s68, 0x40000000
  s_mov_b32 s80, 0x3030303
  s_mov_b32 s81, 0x3030303
  s_mov_b32 s74, 0xd000000
  s_mov_b32 s82, 0xc0c0c0c
  s_mov_b32 s83, 0xc0c0c0c
  s_mov_b32 s75, 0xd010000
  s_mov_b32 s84, 0x30303030
  s_mov_b32 s85, 0x30303030
  s_mov_b32 s76, 0xd020000
  s_mov_b32 s86, 0xc0c0c0c0
  s_mov_b32 s87, 0xc0c0c0c0
  s_mov_b32 s77, 0xd030000
  buffer_store_dwordx2 v[16:17], v8, s[40:43], s74 offen sc1
  buffer_store_dwordx2 v[16:17], v8, s[40:43], s75 offen sc1
  buffer_store_dwordx2 v[16:17], v8, s[40:43], s76 offen sc1
  buffer_store_dwordx2 v[16:17], v8, s[40:43], s77 offen sc1
  v_mov_b32 v22, 0xffff
  buffer_store_short v22, v10, s[40:43], s64 offen sc1
  s_mul_i32 s68, s44, 4
  s_lshr_b32 s68, 0x7640, s68
  s_and_b32 s68, s68, 15
  s_lshl_b32 s68, s68, 12
  s_lshl_b32 s69, s45, 7
  s_add_u32 s68, s68, s69
  s_add_u32 s68, s68, 0xd080000
  v_and_b32 v23, 31, v0
  v_lshlrev_b32 v23, 2, v23
  v_lshrrev_b32 v24, 5, v0
  v_lshl_add_u32 v23, v24, 12, v23
  buffer_store_dword v17, v23, s[40:43], s68 offen sc1
  s_mov_b32 s52, s38
  s_and_b32 s53, s39, 0xffff
  s_mov_b32 s54, 0x100
  s_mov_b32 s55, 0x20000
  s_lshl_b32 s68, 1, s46
  v_mov_b32 v22, s68
  s_cmp_eq_u32 s44, 0
  s_cselect_b32 s69, 0, 0x40000000
  s_mov_b64 exec, 1
  buffer_atomic_or v22, v17, s[52:55], s69 offen offset:128
  s_mov_b64 exec, -1
  v_bfe_u32 v22, v0, 4, 1
  v_lshrrev_b32 v23, 5, v0
  s_lshl_b32 s68, s44, 1
  v_or_b32 v24, s68, v22
  v_lshlrev_b32 v24, 1, v24
  v_xor_b32 v24, v24, v21
  v_lshlrev_b32 v24, 4, v24
  v_lshl_add_u32 v25, v22, 4, v23
  v_add_u32 v25, s68, v25
  v_lshl_add_u32 v26, v25, 13, v24
  s_lshl_b32 s69, s45, 8
  v_add_u32 v26, s69, v26
  s_lshl_b32 s68, s44, 4
  v_add_u32 v25, s68, v20
  v_lshl_add_u32 v27, v25, 10, v24
  s_lshl_b32 s69, s45, 17
  v_add_u32 v27, s69, v27
  v_lshrrev_b32 v22, 5, v0
  v_lshlrev_b32 v28, 12, v22
  v_bfe_u32 v22, v0, 3, 1
  v_lshl_add_u32 v28, v22, 11, v28
  v_lshlrev_b32 v24, 2, v22
  v_bfe_u32 v22, v0, 4, 1
  v_lshl_add_u32 v28, v22, 10, v28
  v_lshl_add_u32 v24, v22, 1, v24
  v_bfe_u32 v22, v0, 2, 1
  v_lshl_add_u32 v28, v22, 8, v28
  v_add_u32 v24, v24, v22
  s_lshl_b32 s68, s44, 1
  v_xor_b32 v24, s68, v24
  v_lshl_add_u32 v28, v24, 5, v28
  v_and_b32 v22, 3, v0
  v_lshl_add_u32 v28, v22, 3, v28
  v_xor_b32 v29, 32, v28
  v_bfe_u32 v22, v0, 3, 1
  v_mul_u32_u24 v22, 2208, v22
  v_xor_b32 v32, v22, v28
  v_xor_b32 v33, 2176, v32
  s_mov_b32 s50, 0x400000
  s_mov_b32 s51, 0x20000
  s_lshl_b32 s56, s44, 10
  s_mov_b32 s48, s30
  s_and_b32 s49, s31, 0xffff
  s_add_u32 m0, s56, 0
  s_mov_b32 s68, 0
  buffer_load_dwordx4 v27, s[48:51], s68 offen  lds
  s_add_u32 m0, s56, 4096
  s_mov_b32 s68, 4096
  buffer_load_dwordx4 v27, s[48:51], s68 offen  lds
  s_add_u32 m0, s56, 8192
  s_mov_b32 s68, 8192
  buffer_load_dwordx4 v27, s[48:51], s68 offen  lds
  s_add_u32 m0, s56, 12288
  s_mov_b32 s68, 12288
  buffer_load_dwordx4 v27, s[48:51], s68 offen  lds
  s_add_u32 m0, s56, 16384
  s_mov_b32 s68, 65536
  buffer_load_dwordx4 v27, s[48:51], s68 offen  lds
  s_add_u32 m0, s56, 20480
  s_mov_b32 s68, 69632
  buffer_load_dwordx4 v27, s[48:51], s68 offen  lds
  s_add_u32 m0, s56, 24576
  s_mov_b32 s68, 73728
  buffer_load_dwordx4 v27, s[48:51], s68 offen  lds
  s_add_u32 m0, s56, 28672
  s_mov_b32 s68, 77824
  buffer_load_dwordx4 v27, s[48:51], s68 offen  lds
  s_add_u32 m0, s56, 32768
  s_mov_b32 s68, 256
  buffer_load_dwordx4 v27, s[48:51], s68 offen  lds
  s_add_u32 m0, s56, 36864
  s_mov_b32 s68, 4352
  buffer_load_dwordx4 v27, s[48:51], s68 offen  lds
  s_add_u32 m0, s56, 40960
  s_mov_b32 s68, 8448
  buffer_load_dwordx4 v27, s[48:51], s68 offen  lds
  s_add_u32 m0, s56, 45056
  s_mov_b32 s68, 12544
  buffer_load_dwordx4 v27, s[48:51], s68 offen  lds
  s_add_u32 m0, s56, 49152
  s_mov_b32 s68, 65792
  buffer_load_dwordx4 v27, s[48:51], s68 offen  lds
  s_add_u32 m0, s56, 53248
  s_mov_b32 s68, 69888
  buffer_load_dwordx4 v27, s[48:51], s68 offen  lds
  s_add_u32 m0, s56, 57344
  s_mov_b32 s68, 73984
  buffer_load_dwordx4 v27, s[48:51], s68 offen  lds
  s_add_u32 m0, s56, 61440
  s_mov_b32 s68, 78080
  buffer_load_dwordx4 v27, s[48:51], s68 offen  lds
  s_add_u32 m0, s56, 65536
  s_mov_b32 s68, 512
  buffer_load_dwordx4 v27, s[48:51], s68 offen  lds
  s_add_u32 m0, s56, 69632
  s_mov_b32 s68, 4608
  buffer_load_dwordx4 v27, s[48:51], s68 offen  lds
  s_add_u32 m0, s56, 73728
  s_mov_b32 s68, 8704
  buffer_load_dwordx4 v27, s[48:51], s68 offen  lds
  s_add_u32 m0, s56, 77824
  s_mov_b32 s68, 12800
  buffer_load_dwordx4 v27, s[48:51], s68 offen  lds
  s_add_u32 m0, s56, 81920
  s_mov_b32 s68, 66048
  buffer_load_dwordx4 v27, s[48:51], s68 offen  lds
  s_add_u32 m0, s56, 86016
  s_mov_b32 s68, 70144
  buffer_load_dwordx4 v27, s[48:51], s68 offen  lds
  s_add_u32 m0, s56, 90112
  s_mov_b32 s68, 74240
  buffer_load_dwordx4 v27, s[48:51], s68 offen  lds
  s_add_u32 m0, s56, 94208
  s_mov_b32 s68, 78336
  buffer_load_dwordx4 v27, s[48:51], s68 offen  lds
  s_add_u32 m0, s56, 98304
  s_mov_b32 s68, 768
  buffer_load_dwordx4 v27, s[48:51], s68 offen  lds
  s_add_u32 m0, s56, 102400
  s_mov_b32 s68, 4864
  buffer_load_dwordx4 v27, s[48:51], s68 offen  lds
  s_add_u32 m0, s56, 106496
  s_mov_b32 s68, 8960
  buffer_load_dwordx4 v27, s[48:51], s68 offen  lds
  s_add_u32 m0, s56, 110592
  s_mov_b32 s68, 13056
  buffer_load_dwordx4 v27, s[48:51], s68 offen  lds
  s_waitcnt vmcnt(24)
  s_barrier
  v_mov_b32 v22, 1
  s_cmp_eq_u32 s44, 0
  s_cselect_b32 s69, 0, 0x40000000
  s_mov_b64 exec, 1
  buffer_atomic_add v22, v17, s[52:55], s69 offen
  s_mov_b64 exec, -1
  s_add_u32 m0, s56, 114688
  s_mov_b32 s68, 66304
  buffer_load_dwordx4 v27, s[48:51], s68 offen  lds
  s_add_u32 m0, s56, 118784
  s_mov_b32 s68, 70400
  buffer_load_dwordx4 v27, s[48:51], s68 offen  lds
  s_add_u32 m0, s56, 122880
  s_mov_b32 s68, 74496
  buffer_load_dwordx4 v27, s[48:51], s68 offen  lds
  s_add_u32 m0, s56, 126976
  s_mov_b32 s68, 78592
  buffer_load_dwordx4 v27, s[48:51], s68 offen  lds
  v_add_u32 v30, 0, v32
  v_add_u32 v31, 0, v33
  s_cmp_lg_u32 s44, 0
  s_cbranch_scc1 L_wr_0_1
  ds_read_b64_tr_b16 v[128:129], v30 offset:0
  ds_read_b64_tr_b16 v[130:131], v30 offset:512
  ds_read_b64_tr_b16 v[132:133], v30 offset:8192
  ds_read_b64_tr_b16 v[134:135], v30 offset:8704
  ds_read_b64_tr_b16 v[136:137], v31 offset:0
  ds_read_b64_tr_b16 v[138:139], v31 offset:512
  ds_read_b64_tr_b16 v[140:141], v31 offset:8192
  ds_read_b64_tr_b16 v[142:143], v31 offset:8704
  s_branch L_wr_0_e
L_wr_0_1:
  s_cmp_lg_u32 s44, 1
  s_cbranch_scc1 L_wr_0_2
  ds_read_b64_tr_b16 v[136:137], v30 offset:0
  ds_read_b64_tr_b16 v[138:139], v30 offset:512
  ds_read_b64_tr_b16 v[140:141], v30 offset:8192
  ds_read_b64_tr_b16 v[142:143], v30 offset:8704
  ds_read_b64_tr_b16 v[128:129], v31 offset:0
  ds_read_b64_tr_b16 v[130:131], v31 offset:512
  ds_read_b64_tr_b16 v[132:133], v31 offset:8192
  ds_read_b64_tr_b16 v[134:135], v31 offset:8704
  s_branch L_wr_0_e
L_wr_0_2:
  s_cmp_lg_u32 s44, 2
  s_cbranch_scc1 L_wr_0_3
  ds_read_b64_tr_b16 v[144:145], v30 offset:0
  ds_read_b64_tr_b16 v[146:147], v30 offset:512
  ds_read_b64_tr_b16 v[148:149], v30 offset:8192
  ds_read_b64_tr_b16 v[150:151], v30 offset:8704
  ds_read_b64_tr_b16 v[152:153], v31 offset:0
  ds_read_b64_tr_b16 v[154:155], v31 offset:512
  ds_read_b64_tr_b16 v[156:157], v31 offset:8192
  ds_read_b64_tr_b16 v[158:159], v31 offset:8704
  s_branch L_wr_0_e
L_wr_0_3:
  ds_read_b64_tr_b16 v[152:153], v30 offset:0
  ds_read_b64_tr_b16 v[154:155], v30 offset:512
  ds_read_b64_tr_b16 v[156:157], v30 offset:8192
  ds_read_b64_tr_b16 v[158:159], v30 offset:8704
  ds_read_b64_tr_b16 v[144:145], v31 offset:0
  ds_read_b64_tr_b16 v[146:147], v31 offset:512
  ds_read_b64_tr_b16 v[148:149], v31 offset:8192
  ds_read_b64_tr_b16 v[150:151], v31 offset:8704
L_wr_0_e:
  s_waitcnt lgkmcnt(0)
  s_waitcnt vmcnt(24)
  s_barrier
  s_mov_b32 s48, s24
  s_and_b32 s49, s25, 0xffff
  s_add_u32 m0, s56, 0
  s_mov_b32 s68, 0
  buffer_load_dwordx4 v26, s[48:51], s68 offen  lds
  s_add_u32 m0, s56, 4096
  s_mov_b32 s68, 65536
  buffer_load_dwordx4 v26, s[48:51], s68 offen  lds
  s_add_u32 m0, s56, 8192
  s_mov_b32 s68, 262144
  buffer_load_dwordx4 v26, s[48:51], s68 offen  lds
  s_add_u32 m0, s56, 12288
  s_mov_b32 s68, 327680
  buffer_load_dwordx4 v26, s[48:51], s68 offen  lds
  v_add_u32 v30, 16384, v32
  v_add_u32 v31, 16384, v33
  s_cmp_lg_u32 s44, 0
  s_cbranch_scc1 L_wr_1_1
  ds_read_b64_tr_b16 v[144:145], v30 offset:0
  ds_read_b64_tr_b16 v[146:147], v30 offset:512
  ds_read_b64_tr_b16 v[148:149], v30 offset:8192
  ds_read_b64_tr_b16 v[150:151], v30 offset:8704
  ds_read_b64_tr_b16 v[152:153], v31 offset:0
  ds_read_b64_tr_b16 v[154:155], v31 offset:512
  ds_read_b64_tr_b16 v[156:157], v31 offset:8192
  ds_read_b64_tr_b16 v[158:159], v31 offset:8704
  s_branch L_wr_1_e
L_wr_1_1:
  s_cmp_lg_u32 s44, 1
  s_cbranch_scc1 L_wr_1_2
  ds_read_b64_tr_b16 v[152:153], v30 offset:0
  ds_read_b64_tr_b16 v[154:155], v30 offset:512
  ds_read_b64_tr_b16 v[156:157], v30 offset:8192
  ds_read_b64_tr_b16 v[158:159], v30 offset:8704
  ds_read_b64_tr_b16 v[144:145], v31 offset:0
  ds_read_b64_tr_b16 v[146:147], v31 offset:512
  ds_read_b64_tr_b16 v[148:149], v31 offset:8192
  ds_read_b64_tr_b16 v[150:151], v31 offset:8704
  s_branch L_wr_1_e
L_wr_1_2:
  s_cmp_lg_u32 s44, 2
  s_cbranch_scc1 L_wr_1_3
  ds_read_b64_tr_b16 v[128:129], v30 offset:0
  ds_read_b64_tr_b16 v[130:131], v30 offset:512
  ds_read_b64_tr_b16 v[132:133], v30 offset:8192
  ds_read_b64_tr_b16 v[134:135], v30 offset:8704
  ds_read_b64_tr_b16 v[136:137], v31 offset:0
  ds_read_b64_tr_b16 v[138:139], v31 offset:512
  ds_read_b64_tr_b16 v[140:141], v31 offset:8192
  ds_read_b64_tr_b16 v[142:143], v31 offset:8704
  s_branch L_wr_1_e
L_wr_1_3:
  ds_read_b64_tr_b16 v[136:137], v30 offset:0
  ds_read_b64_tr_b16 v[138:139], v30 offset:512
  ds_read_b64_tr_b16 v[140:141], v30 offset:8192
  ds_read_b64_tr_b16 v[142:143], v30 offset:8704
  ds_read_b64_tr_b16 v[128:129], v31 offset:0
  ds_read_b64_tr_b16 v[130:131], v31 offset:512
  ds_read_b64_tr_b16 v[132:133], v31 offset:8192
  ds_read_b64_tr_b16 v[134:135], v31 offset:8704
L_wr_1_e:
  s_waitcnt lgkmcnt(0)
  s_waitcnt vmcnt(24)
  s_barrier
  s_add_u32 m0, s56, 16384
  s_mov_b32 s68, 524288
  buffer_load_dwordx4 v26, s[48:51], s68 offen  lds
  s_add_u32 m0, s56, 20480
  s_mov_b32 s68, 589824
  buffer_load_dwordx4 v26, s[48:51], s68 offen  lds
  s_add_u32 m0, s56, 24576
  s_mov_b32 s68, 786432
  buffer_load_dwordx4 v26, s[48:51], s68 offen  lds
  s_add_u32 m0, s56, 28672
  s_mov_b32 s68, 851968
  buffer_load_dwordx4 v26, s[48:51], s68 offen  lds
  v_add_u32 v30, 32768, v32
  v_add_u32 v31, 32768, v33
  s_cmp_lg_u32 s44, 0
  s_cbranch_scc1 L_wr_2_1
  ds_read_b64_tr_b16 v[160:161], v30 offset:0
  ds_read_b64_tr_b16 v[162:163], v30 offset:512
  ds_read_b64_tr_b16 v[164:165], v30 offset:8192
  ds_read_b64_tr_b16 v[166:167], v30 offset:8704
  ds_read_b64_tr_b16 v[168:169], v31 offset:0
  ds_read_b64_tr_b16 v[170:171], v31 offset:512
  ds_read_b64_tr_b16 v[172:173], v31 offset:8192
  ds_read_b64_tr_b16 v[174:175], v31 offset:8704
  s_branch L_wr_2_e
L_wr_2_1:
  s_cmp_lg_u32 s44, 1
  s_cbranch_scc1 L_wr_2_2
  ds_read_b64_tr_b16 v[168:169], v30 offset:0
  ds_read_b64_tr_b16 v[170:171], v30 offset:512
  ds_read_b64_tr_b16 v[172:173], v30 offset:8192
  ds_read_b64_tr_b16 v[174:175], v30 offset:8704
  ds_read_b64_tr_b16 v[160:161], v31 offset:0
  ds_read_b64_tr_b16 v[162:163], v31 offset:512
  ds_read_b64_tr_b16 v[164:165], v31 offset:8192
  ds_read_b64_tr_b16 v[166:167], v31 offset:8704
  s_branch L_wr_2_e
L_wr_2_2:
  s_cmp_lg_u32 s44, 2
  s_cbranch_scc1 L_wr_2_3
  ds_read_b64_tr_b16 v[176:177], v30 offset:0
  ds_read_b64_tr_b16 v[178:179], v30 offset:512
  ds_read_b64_tr_b16 v[180:181], v30 offset:8192
  ds_read_b64_tr_b16 v[182:183], v30 offset:8704
  ds_read_b64_tr_b16 v[184:185], v31 offset:0
  ds_read_b64_tr_b16 v[186:187], v31 offset:512
  ds_read_b64_tr_b16 v[188:189], v31 offset:8192
  ds_read_b64_tr_b16 v[190:191], v31 offset:8704
  s_branch L_wr_2_e
L_wr_2_3:
  ds_read_b64_tr_b16 v[184:185], v30 offset:0
  ds_read_b64_tr_b16 v[186:187], v30 offset:512
  ds_read_b64_tr_b16 v[188:189], v30 offset:8192
  ds_read_b64_tr_b16 v[190:191], v30 offset:8704
  ds_read_b64_tr_b16 v[176:177], v31 offset:0
  ds_read_b64_tr_b16 v[178:179], v31 offset:512
  ds_read_b64_tr_b16 v[180:181], v31 offset:8192
  ds_read_b64_tr_b16 v[182:183], v31 offset:8704
L_wr_2_e:
  s_waitcnt lgkmcnt(0)
  s_waitcnt vmcnt(24)
  s_barrier
  s_add_u32 m0, s56, 32768
  s_mov_b32 s68, 1048576
  buffer_load_dwordx4 v26, s[48:51], s68 offen  lds
  s_add_u32 m0, s56, 36864
  s_mov_b32 s68, 1114112
  buffer_load_dwordx4 v26, s[48:51], s68 offen  lds
  s_add_u32 m0, s56, 40960
  s_mov_b32 s68, 1310720
  buffer_load_dwordx4 v26, s[48:51], s68 offen  lds
  s_add_u32 m0, s56, 45056
  s_mov_b32 s68, 1376256
  buffer_load_dwordx4 v26, s[48:51], s68 offen  lds
  v_add_u32 v30, 49152, v32
  v_add_u32 v31, 49152, v33
  s_cmp_lg_u32 s44, 0
  s_cbranch_scc1 L_wr_3_1
  ds_read_b64_tr_b16 v[176:177], v30 offset:0
  ds_read_b64_tr_b16 v[178:179], v30 offset:512
  ds_read_b64_tr_b16 v[180:181], v30 offset:8192
  ds_read_b64_tr_b16 v[182:183], v30 offset:8704
  ds_read_b64_tr_b16 v[184:185], v31 offset:0
  ds_read_b64_tr_b16 v[186:187], v31 offset:512
  ds_read_b64_tr_b16 v[188:189], v31 offset:8192
  ds_read_b64_tr_b16 v[190:191], v31 offset:8704
  s_branch L_wr_3_e
L_wr_3_1:
  s_cmp_lg_u32 s44, 1
  s_cbranch_scc1 L_wr_3_2
  ds_read_b64_tr_b16 v[184:185], v30 offset:0
  ds_read_b64_tr_b16 v[186:187], v30 offset:512
  ds_read_b64_tr_b16 v[188:189], v30 offset:8192
  ds_read_b64_tr_b16 v[190:191], v30 offset:8704
  ds_read_b64_tr_b16 v[176:177], v31 offset:0
  ds_read_b64_tr_b16 v[178:179], v31 offset:512
  ds_read_b64_tr_b16 v[180:181], v31 offset:8192
  ds_read_b64_tr_b16 v[182:183], v31 offset:8704
  s_branch L_wr_3_e
L_wr_3_2:
  s_cmp_lg_u32 s44, 2
  s_cbranch_scc1 L_wr_3_3
  ds_read_b64_tr_b16 v[160:161], v30 offset:0
  ds_read_b64_tr_b16 v[162:163], v30 offset:512
  ds_read_b64_tr_b16 v[164:165], v30 offset:8192
  ds_read_b64_tr_b16 v[166:167], v30 offset:8704
  ds_read_b64_tr_b16 v[168:169], v31 offset:0
  ds_read_b64_tr_b16 v[170:171], v31 offset:512
  ds_read_b64_tr_b16 v[172:173], v31 offset:8192
  ds_read_b64_tr_b16 v[174:175], v31 offset:8704
  s_branch L_wr_3_e
L_wr_3_3:
  ds_read_b64_tr_b16 v[168:169], v30 offset:0
  ds_read_b64_tr_b16 v[170:171], v30 offset:512
  ds_read_b64_tr_b16 v[172:173], v30 offset:8192
  ds_read_b64_tr_b16 v[174:175], v30 offset:8704
  ds_read_b64_tr_b16 v[160:161], v31 offset:0
  ds_read_b64_tr_b16 v[162:163], v31 offset:512
  ds_read_b64_tr_b16 v[164:165], v31 offset:8192
  ds_read_b64_tr_b16 v[166:167], v31 offset:8704
L_wr_3_e:
  s_waitcnt lgkmcnt(0)
  s_waitcnt vmcnt(24)
  s_barrier
  s_add_u32 m0, s56, 49152
  s_mov_b32 s68, 1572864
  buffer_load_dwordx4 v26, s[48:51], s68 offen  lds
  s_add_u32 m0, s56, 53248
  s_mov_b32 s68, 1638400
  buffer_load_dwordx4 v26, s[48:51], s68 offen  lds
  s_add_u32 m0, s56, 57344
  s_mov_b32 s68, 1835008
  buffer_load_dwordx4 v26, s[48:51], s68 offen  lds
  s_add_u32 m0, s56, 61440
  s_mov_b32 s68, 1900544
  buffer_load_dwordx4 v26, s[48:51], s68 offen  lds
  v_add_u32 v30, 65536, v32
  v_add_u32 v31, 65536, v33
  s_cmp_lg_u32 s44, 0
  s_cbranch_scc1 L_wr_4_1
  ds_read_b64_tr_b16 v[192:193], v30 offset:0
  ds_read_b64_tr_b16 v[194:195], v30 offset:512
  ds_read_b64_tr_b16 v[196:197], v30 offset:8192
  ds_read_b64_tr_b16 v[198:199], v30 offset:8704
  ds_read_b64_tr_b16 v[200:201], v31 offset:0
  ds_read_b64_tr_b16 v[202:203], v31 offset:512
  ds_read_b64_tr_b16 v[204:205], v31 offset:8192
  ds_read_b64_tr_b16 v[206:207], v31 offset:8704
  s_branch L_wr_4_e
L_wr_4_1:
  s_cmp_lg_u32 s44, 1
  s_cbranch_scc1 L_wr_4_2
  ds_read_b64_tr_b16 v[200:201], v30 offset:0
  ds_read_b64_tr_b16 v[202:203], v30 offset:512
  ds_read_b64_tr_b16 v[204:205], v30 offset:8192
  ds_read_b64_tr_b16 v[206:207], v30 offset:8704
  ds_read_b64_tr_b16 v[192:193], v31 offset:0
  ds_read_b64_tr_b16 v[194:195], v31 offset:512
  ds_read_b64_tr_b16 v[196:197], v31 offset:8192
  ds_read_b64_tr_b16 v[198:199], v31 offset:8704
  s_branch L_wr_4_e
L_wr_4_2:
  s_cmp_lg_u32 s44, 2
  s_cbranch_scc1 L_wr_4_3
  ds_read_b64_tr_b16 v[208:209], v30 offset:0
  ds_read_b64_tr_b16 v[210:211], v30 offset:512
  ds_read_b64_tr_b16 v[212:213], v30 offset:8192
  ds_read_b64_tr_b16 v[214:215], v30 offset:8704
  ds_read_b64_tr_b16 v[216:217], v31 offset:0
  ds_read_b64_tr_b16 v[218:219], v31 offset:512
  ds_read_b64_tr_b16 v[220:221], v31 offset:8192
  ds_read_b64_tr_b16 v[222:223], v31 offset:8704
  s_branch L_wr_4_e
L_wr_4_3:
  ds_read_b64_tr_b16 v[216:217], v30 offset:0
  ds_read_b64_tr_b16 v[218:219], v30 offset:512
  ds_read_b64_tr_b16 v[220:221], v30 offset:8192
  ds_read_b64_tr_b16 v[222:223], v30 offset:8704
  ds_read_b64_tr_b16 v[208:209], v31 offset:0
  ds_read_b64_tr_b16 v[210:211], v31 offset:512
  ds_read_b64_tr_b16 v[212:213], v31 offset:8192
  ds_read_b64_tr_b16 v[214:215], v31 offset:8704
L_wr_4_e:
  s_waitcnt lgkmcnt(0)
  s_waitcnt vmcnt(24)
  s_barrier
  s_add_u32 m0, s56, 65536
  s_mov_b32 s68, 2097152
  buffer_load_dwordx4 v26, s[48:51], s68 offen  lds
  s_add_u32 m0, s56, 69632
  s_mov_b32 s68, 2162688
  buffer_load_dwordx4 v26, s[48:51], s68 offen  lds
  s_add_u32 m0, s56, 73728
  s_mov_b32 s68, 2359296
  buffer_load_dwordx4 v26, s[48:51], s68 offen  lds
  s_add_u32 m0, s56, 77824
  s_mov_b32 s68, 2424832
  buffer_load_dwordx4 v26, s[48:51], s68 offen  lds
  v_add_u32 v30, 81920, v32
  v_add_u32 v31, 81920, v33
  s_cmp_lg_u32 s44, 0
  s_cbranch_scc1 L_wr_5_1
  ds_read_b64_tr_b16 v[208:209], v30 offset:0
  ds_read_b64_tr_b16 v[210:211], v30 offset:512
  ds_read_b64_tr_b16 v[212:213], v30 offset:8192
  ds_read_b64_tr_b16 v[214:215], v30 offset:8704
  ds_read_b64_tr_b16 v[216:217], v31 offset:0
  ds_read_b64_tr_b16 v[218:219], v31 offset:512
  ds_read_b64_tr_b16 v[220:221], v31 offset:8192
  ds_read_b64_tr_b16 v[222:223], v31 offset:8704
  s_branch L_wr_5_e
L_wr_5_1:
  s_cmp_lg_u32 s44, 1
  s_cbranch_scc1 L_wr_5_2
  ds_read_b64_tr_b16 v[216:217], v30 offset:0
  ds_read_b64_tr_b16 v[218:219], v30 offset:512
  ds_read_b64_tr_b16 v[220:221], v30 offset:8192
  ds_read_b64_tr_b16 v[222:223], v30 offset:8704
  ds_read_b64_tr_b16 v[208:209], v31 offset:0
  ds_read_b64_tr_b16 v[210:211], v31 offset:512
  ds_read_b64_tr_b16 v[212:213], v31 offset:8192
  ds_read_b64_tr_b16 v[214:215], v31 offset:8704
  s_branch L_wr_5_e
L_wr_5_2:
  s_cmp_lg_u32 s44, 2
  s_cbranch_scc1 L_wr_5_3
  ds_read_b64_tr_b16 v[192:193], v30 offset:0
  ds_read_b64_tr_b16 v[194:195], v30 offset:512
  ds_read_b64_tr_b16 v[196:197], v30 offset:8192
  ds_read_b64_tr_b16 v[198:199], v30 offset:8704
  ds_read_b64_tr_b16 v[200:201], v31 offset:0
  ds_read_b64_tr_b16 v[202:203], v31 offset:512
  ds_read_b64_tr_b16 v[204:205], v31 offset:8192
  ds_read_b64_tr_b16 v[206:207], v31 offset:8704
  s_branch L_wr_5_e
L_wr_5_3:
  ds_read_b64_tr_b16 v[200:201], v30 offset:0
  ds_read_b64_tr_b16 v[202:203], v30 offset:512
  ds_read_b64_tr_b16 v[204:205], v30 offset:8192
  ds_read_b64_tr_b16 v[206:207], v30 offset:8704
  ds_read_b64_tr_b16 v[192:193], v31 offset:0
  ds_read_b64_tr_b16 v[194:195], v31 offset:512
  ds_read_b64_tr_b16 v[196:197], v31 offset:8192
  ds_read_b64_tr_b16 v[198:199], v31 offset:8704
L_wr_5_e:
  s_waitcnt lgkmcnt(0)
  s_waitcnt vmcnt(24)
  s_barrier
  s_add_u32 m0, s56, 81920
  s_mov_b32 s68, 2621440
  buffer_load_dwordx4 v26, s[48:51], s68 offen  lds
  s_add_u32 m0, s56, 86016
  s_mov_b32 s68, 2686976
  buffer_load_dwordx4 v26, s[48:51], s68 offen  lds
  s_add_u32 m0, s56, 90112
  s_mov_b32 s68, 2883584
  buffer_load_dwordx4 v26, s[48:51], s68 offen  lds
  s_add_u32 m0, s56, 94208
  s_mov_b32 s68, 2949120
  buffer_load_dwordx4 v26, s[48:51], s68 offen  lds
  v_add_u32 v30, 98304, v32
  v_add_u32 v31, 98304, v33
  s_cmp_lg_u32 s44, 0
  s_cbranch_scc1 L_wr_6_1
  ds_read_b64_tr_b16 v[224:225], v30 offset:0
  ds_read_b64_tr_b16 v[226:227], v30 offset:512
  ds_read_b64_tr_b16 v[228:229], v30 offset:8192
  ds_read_b64_tr_b16 v[230:231], v30 offset:8704
  ds_read_b64_tr_b16 v[232:233], v31 offset:0
  ds_read_b64_tr_b16 v[234:235], v31 offset:512
  ds_read_b64_tr_b16 v[236:237], v31 offset:8192
  ds_read_b64_tr_b16 v[238:239], v31 offset:8704
  s_branch L_wr_6_e
L_wr_6_1:
  s_cmp_lg_u32 s44, 1
  s_cbranch_scc1 L_wr_6_2
  ds_read_b64_tr_b16 v[232:233], v30 offset:0
  ds_read_b64_tr_b16 v[234:235], v30 offset:512
  ds_read_b64_tr_b16 v[236:237], v30 offset:8192
  ds_read_b64_tr_b16 v[238:239], v30 offset:8704
  ds_read_b64_tr_b16 v[224:225], v31 offset:0
  ds_read_b64_tr_b16 v[226:227], v31 offset:512
  ds_read_b64_tr_b16 v[228:229], v31 offset:8192
  ds_read_b64_tr_b16 v[230:231], v31 offset:8704
  s_branch L_wr_6_e
L_wr_6_2:
  s_cmp_lg_u32 s44, 2
  s_cbranch_scc1 L_wr_6_3
  ds_read_b64_tr_b16 v[240:241], v30 offset:0
  ds_read_b64_tr_b16 v[242:243], v30 offset:512
  ds_read_b64_tr_b16 v[244:245], v30 offset:8192
  ds_read_b64_tr_b16 v[246:247], v30 offset:8704
  ds_read_b64_tr_b16 v[248:249], v31 offset:0
  ds_read_b64_tr_b16 v[250:251], v31 offset:512
  ds_read_b64_tr_b16 v[252:253], v31 offset:8192
  ds_read_b64_tr_b16 v[254:255], v31 offset:8704
  s_branch L_wr_6_e
L_wr_6_3:
  ds_read_b64_tr_b16 v[248:249], v30 offset:0
  ds_read_b64_tr_b16 v[250:251], v30 offset:512
  ds_read_b64_tr_b16 v[252:253], v30 offset:8192
  ds_read_b64_tr_b16 v[254:255], v30 offset:8704
  ds_read_b64_tr_b16 v[240:241], v31 offset:0
  ds_read_b64_tr_b16 v[242:243], v31 offset:512
  ds_read_b64_tr_b16 v[244:245], v31 offset:8192
  ds_read_b64_tr_b16 v[246:247], v31 offset:8704
L_wr_6_e:
  s_waitcnt lgkmcnt(0)
  s_waitcnt vmcnt(24)
  s_barrier
  s_add_u32 m0, s56, 98304
  s_mov_b32 s68, 3145728
  buffer_load_dwordx4 v26, s[48:51], s68 offen  lds
  s_add_u32 m0, s56, 102400
  s_mov_b32 s68, 3211264
  buffer_load_dwordx4 v26, s[48:51], s68 offen  lds
  s_add_u32 m0, s56, 106496
  s_mov_b32 s68, 3407872
  buffer_load_dwordx4 v26, s[48:51], s68 offen  lds
  s_add_u32 m0, s56, 110592
  s_mov_b32 s68, 3473408
  buffer_load_dwordx4 v26, s[48:51], s68 offen  lds
  v_add_u32 v30, 114688, v32
  v_add_u32 v31, 114688, v33
  s_cmp_lg_u32 s44, 0
  s_cbranch_scc1 L_wr_7_1
  ds_read_b64_tr_b16 v[240:241], v30 offset:0
  ds_read_b64_tr_b16 v[242:243], v30 offset:512
  ds_read_b64_tr_b16 v[244:245], v30 offset:8192
  ds_read_b64_tr_b16 v[246:247], v30 offset:8704
  ds_read_b64_tr_b16 v[248:249], v31 offset:0
  ds_read_b64_tr_b16 v[250:251], v31 offset:512
  ds_read_b64_tr_b16 v[252:253], v31 offset:8192
  ds_read_b64_tr_b16 v[254:255], v31 offset:8704
  s_branch L_wr_7_e
L_wr_7_1:
  s_cmp_lg_u32 s44, 1
  s_cbranch_scc1 L_wr_7_2
  ds_read_b64_tr_b16 v[248:249], v30 offset:0
  ds_read_b64_tr_b16 v[250:251], v30 offset:512
  ds_read_b64_tr_b16 v[252:253], v30 offset:8192
  ds_read_b64_tr_b16 v[254:255], v30 offset:8704
  ds_read_b64_tr_b16 v[240:241], v31 offset:0
  ds_read_b64_tr_b16 v[242:243], v31 offset:512
  ds_read_b64_tr_b16 v[244:245], v31 offset:8192
  ds_read_b64_tr_b16 v[246:247], v31 offset:8704
  s_branch L_wr_7_e
L_wr_7_2:
  s_cmp_lg_u32 s44, 2
  s_cbranch_scc1 L_wr_7_3
  ds_read_b64_tr_b16 v[224:225], v30 offset:0
  ds_read_b64_tr_b16 v[226:227], v30 offset:512
  ds_read_b64_tr_b16 v[228:229], v30 offset:8192
  ds_read_b64_tr_b16 v[230:231], v30 offset:8704
  ds_read_b64_tr_b16 v[232:233], v31 offset:0
  ds_read_b64_tr_b16 v[234:235], v31 offset:512
  ds_read_b64_tr_b16 v[236:237], v31 offset:8192
  ds_read_b64_tr_b16 v[238:239], v31 offset:8704
  s_branch L_wr_7_e
L_wr_7_3:
  ds_read_b64_tr_b16 v[232:233], v30 offset:0
  ds_read_b64_tr_b16 v[234:235], v30 offset:512
  ds_read_b64_tr_b16 v[236:237], v30 offset:8192
  ds_read_b64_tr_b16 v[238:239], v30 offset:8704
  ds_read_b64_tr_b16 v[224:225], v31 offset:0
  ds_read_b64_tr_b16 v[226:227], v31 offset:512
  ds_read_b64_tr_b16 v[228:229], v31 offset:8192
  ds_read_b64_tr_b16 v[230:231], v31 offset:8704
L_wr_7_e:
  s_waitcnt lgkmcnt(0)
  s_waitcnt vmcnt(24)
  s_barrier
  s_add_u32 m0, s56, 114688
  s_mov_b32 s68, 3670016
  buffer_load_dwordx4 v26, s[48:51], s68 offen  lds
  s_add_u32 m0, s56, 118784
  s_mov_b32 s68, 3735552
  buffer_load_dwordx4 v26, s[48:51], s68 offen  lds
  s_add_u32 m0, s56, 122880
  s_mov_b32 s68, 3932160
  buffer_load_dwordx4 v26, s[48:51], s68 offen  lds
  s_add_u32 m0, s56, 126976
  s_mov_b32 s68, 3997696
  buffer_load_dwordx4 v26, s[48:51], s68 offen  lds
  v_add_u32 v30, 0, v28
  v_add_u32 v31, 0, v29
  s_cmp_lg_u32 s44, 0
  s_cbranch_scc1 L_wr_8_1
  ds_read_b64_tr_b16 a[0:1], v30 offset:0
  ds_read_b64_tr_b16 a[2:3], v30 offset:512
  ds_read_b64_tr_b16 a[4:5], v30 offset:8192
  ds_read_b64_tr_b16 a[6:7], v30 offset:8704
  ds_read_b64_tr_b16 a[64:65], v31 offset:0
  ds_read_b64_tr_b16 a[66:67], v31 offset:512
  ds_read_b64_tr_b16 a[68:69], v31 offset:8192
  ds_read_b64_tr_b16 a[70:71], v31 offset:8704
  s_branch L_wr_8_e
L_wr_8_1:
  s_cmp_lg_u32 s44, 1
  s_cbranch_scc1 L_wr_8_2
  ds_read_b64_tr_b16 a[16:17], v30 offset:0
  ds_read_b64_tr_b16 a[18:19], v30 offset:512
  ds_read_b64_tr_b16 a[20:21], v30 offset:8192
  ds_read_b64_tr_b16 a[22:23], v30 offset:8704
  ds_read_b64_tr_b16 a[80:81], v31 offset:0
  ds_read_b64_tr_b16 a[82:83], v31 offset:512
  ds_read_b64_tr_b16 a[84:85], v31 offset:8192
  ds_read_b64_tr_b16 a[86:87], v31 offset:8704
  s_branch L_wr_8_e
L_wr_8_2:
  s_cmp_lg_u32 s44, 2
  s_cbranch_scc1 L_wr_8_3
  ds_read_b64_tr_b16 a[32:33], v30 offset:0
  ds_read_b64_tr_b16 a[34:35], v30 offset:512
  ds_read_b64_tr_b16 a[36:37], v30 offset:8192
  ds_read_b64_tr_b16 a[38:39], v30 offset:8704
  ds_read_b64_tr_b16 a[96:97], v31 offset:0
  ds_read_b64_tr_b16 a[98:99], v31 offset:512
  ds_read_b64_tr_b16 a[100:101], v31 offset:8192
  ds_read_b64_tr_b16 a[102:103], v31 offset:8704
  s_branch L_wr_8_e
L_wr_8_3:
  ds_read_b64_tr_b16 a[48:49], v30 offset:0
  ds_read_b64_tr_b16 a[50:51], v30 offset:512
  ds_read_b64_tr_b16 a[52:53], v30 offset:8192
  ds_read_b64_tr_b16 a[54:55], v30 offset:8704
  ds_read_b64_tr_b16 a[112:113], v31 offset:0
  ds_read_b64_tr_b16 a[114:115], v31 offset:512
  ds_read_b64_tr_b16 a[116:117], v31 offset:8192
  ds_read_b64_tr_b16 a[118:119], v31 offset:8704
L_wr_8_e:
  s_waitcnt lgkmcnt(0)
  s_waitcnt vmcnt(24)
  s_barrier
  s_mov_b32 s48, s26
  s_and_b32 s49, s27, 0xffff
  s_add_u32 m0, s56, 0
  s_mov_b32 s68, 0
  buffer_load_dwordx4 v26, s[48:51], s68 offen  lds
  s_add_u32 m0, s56, 4096
  s_mov_b32 s68, 65536
  buffer_load_dwordx4 v26, s[48:51], s68 offen  lds
  s_add_u32 m0, s56, 8192
  s_mov_b32 s68, 262144
  buffer_load_dwordx4 v26, s[48:51], s68 offen  lds
  s_add_u32 m0, s56, 12288
  s_mov_b32 s68, 327680
  buffer_load_dwordx4 v26, s[48:51], s68 offen  lds
  v_add_u32 v30, 16384, v28
  v_add_u32 v31, 16384, v29
  s_cmp_lg_u32 s44, 0
  s_cbranch_scc1 L_wr_9_1
  ds_read_b64_tr_b16 a[8:9], v30 offset:0
  ds_read_b64_tr_b16 a[10:11], v30 offset:512
  ds_read_b64_tr_b16 a[12:13], v30 offset:8192
  ds_read_b64_tr_b16 a[14:15], v30 offset:8704
  ds_read_b64_tr_b16 a[72:73], v31 offset:0
  ds_read_b64_tr_b16 a[74:75], v31 offset:512
  ds_read_b64_tr_b16 a[76:77], v31 offset:8192
  ds_read_b64_tr_b16 a[78:79], v31 offset:8704
  s_branch L_wr_9_e
L_wr_9_1:
  s_cmp_lg_u32 s44, 1
  s_cbranch_scc1 L_wr_9_2
  ds_read_b64_tr_b16 a[24:25], v30 offset:0
  ds_read_b64_tr_b16 a[26:27], v30 offset:512
  ds_read_b64_tr_b16 a[28:29], v30 offset:8192
  ds_read_b64_tr_b16 a[30:31], v30 offset:8704
  ds_read_b64_tr_b16 a[88:89], v31 offset:0
  ds_read_b64_tr_b16 a[90:91], v31 offset:512
  ds_read_b64_tr_b16 a[92:93], v31 offset:8192
  ds_read_b64_tr_b16 a[94:95], v31 offset:8704
  s_branch L_wr_9_e
L_wr_9_2:
  s_cmp_lg_u32 s44, 2
  s_cbranch_scc1 L_wr_9_3
  ds_read_b64_tr_b16 a[40:41], v30 offset:0
  ds_read_b64_tr_b16 a[42:43], v30 offset:512
  ds_read_b64_tr_b16 a[44:45], v30 offset:8192
  ds_read_b64_tr_b16 a[46:47], v30 offset:8704
  ds_read_b64_tr_b16 a[104:105], v31 offset:0
  ds_read_b64_tr_b16 a[106:107], v31 offset:512
  ds_read_b64_tr_b16 a[108:109], v31 offset:8192
  ds_read_b64_tr_b16 a[110:111], v31 offset:8704
  s_branch L_wr_9_e
L_wr_9_3:
  ds_read_b64_tr_b16 a[56:57], v30 offset:0
  ds_read_b64_tr_b16 a[58:59], v30 offset:512
  ds_read_b64_tr_b16 a[60:61], v30 offset:8192
  ds_read_b64_tr_b16 a[62:63], v30 offset:8704
  ds_read_b64_tr_b16 a[120:121], v31 offset:0
  ds_read_b64_tr_b16 a[122:123], v31 offset:512
  ds_read_b64_tr_b16 a[124:125], v31 offset:8192
  ds_read_b64_tr_b16 a[126:127], v31 offset:8704
L_wr_9_e:
  s_waitcnt lgkmcnt(0)
  s_waitcnt vmcnt(24)
  s_barrier
  s_add_u32 m0, s56, 16384
  s_mov_b32 s68, 524288
  buffer_load_dwordx4 v26, s[48:51], s68 offen  lds
  s_add_u32 m0, s56, 20480
  s_mov_b32 s68, 589824
  buffer_load_dwordx4 v26, s[48:51], s68 offen  lds
  s_add_u32 m0, s56, 24576
  s_mov_b32 s68, 786432
  buffer_load_dwordx4 v26, s[48:51], s68 offen  lds
  s_add_u32 m0, s56, 28672
  s_mov_b32 s68, 851968
  buffer_load_dwordx4 v26, s[48:51], s68 offen  lds
  v_add_u32 v30, 32768, v28
  v_add_u32 v31, 32768, v29
  s_cmp_lg_u32 s44, 0
  s_cbranch_scc1 L_wr_10_1
  ds_read_b64_tr_b16 a[16:17], v30 offset:0
  ds_read_b64_tr_b16 a[18:19], v30 offset:512
  ds_read_b64_tr_b16 a[20:21], v30 offset:8192
  ds_read_b64_tr_b16 a[22:23], v30 offset:8704
  ds_read_b64_tr_b16 a[80:81], v31 offset:0
  ds_read_b64_tr_b16 a[82:83], v31 offset:512
  ds_read_b64_tr_b16 a[84:85], v31 offset:8192
  ds_read_b64_tr_b16 a[86:87], v31 offset:8704
  s_branch L_wr_10_e
L_wr_10_1:
  s_cmp_lg_u32 s44, 1
  s_cbranch_scc1 L_wr_10_2
  ds_read_b64_tr_b16 a[0:1], v30 offset:0
  ds_read_b64_tr_b16 a[2:3], v30 offset:512
  ds_read_b64_tr_b16 a[4:5], v30 offset:8192
  ds_read_b64_tr_b16 a[6:7], v30 offset:8704
  ds_read_b64_tr_b16 a[64:65], v31 offset:0
  ds_read_b64_tr_b16 a[66:67], v31 offset:512
  ds_read_b64_tr_b16 a[68:69], v31 offset:8192
  ds_read_b64_tr_b16 a[70:71], v31 offset:8704
  s_branch L_wr_10_e
L_wr_10_2:
  s_cmp_lg_u32 s44, 2
  s_cbranch_scc1 L_wr_10_3
  ds_read_b64_tr_b16 a[48:49], v30 offset:0
  ds_read_b64_tr_b16 a[50:51], v30 offset:512
  ds_read_b64_tr_b16 a[52:53], v30 offset:8192
  ds_read_b64_tr_b16 a[54:55], v30 offset:8704
  ds_read_b64_tr_b16 a[112:113], v31 offset:0
  ds_read_b64_tr_b16 a[114:115], v31 offset:512
  ds_read_b64_tr_b16 a[116:117], v31 offset:8192
  ds_read_b64_tr_b16 a[118:119], v31 offset:8704
  s_branch L_wr_10_e
L_wr_10_3:
  ds_read_b64_tr_b16 a[32:33], v30 offset:0
  ds_read_b64_tr_b16 a[34:35], v30 offset:512
  ds_read_b64_tr_b16 a[36:37], v30 offset:8192
  ds_read_b64_tr_b16 a[38:39], v30 offset:8704
  ds_read_b64_tr_b16 a[96:97], v31 offset:0
  ds_read_b64_tr_b16 a[98:99], v31 offset:512
  ds_read_b64_tr_b16 a[100:101], v31 offset:8192
  ds_read_b64_tr_b16 a[102:103], v31 offset:8704
L_wr_10_e:
  s_waitcnt lgkmcnt(0)
  s_waitcnt vmcnt(24)
  s_barrier
  s_add_u32 m0, s56, 32768
  s_mov_b32 s68, 1048576
  buffer_load_dwordx4 v26, s[48:51], s68 offen  lds
  s_add_u32 m0, s56, 36864
  s_mov_b32 s68, 1114112
  buffer_load_dwordx4 v26, s[48:51], s68 offen  lds
  s_add_u32 m0, s56, 40960
  s_mov_b32 s68, 1310720
  buffer_load_dwordx4 v26, s[48:51], s68 offen  lds
  s_add_u32 m0, s56, 45056
  s_mov_b32 s68, 1376256
  buffer_load_dwordx4 v26, s[48:51], s68 offen  lds
  v_add_u32 v30, 49152, v28
  v_add_u32 v31, 49152, v29
  s_cmp_lg_u32 s44, 0
  s_cbranch_scc1 L_wr_11_1
  ds_read_b64_tr_b16 a[24:25], v30 offset:0
  ds_read_b64_tr_b16 a[26:27], v30 offset:512
  ds_read_b64_tr_b16 a[28:29], v30 offset:8192
  ds_read_b64_tr_b16 a[30:31], v30 offset:8704
  ds_read_b64_tr_b16 a[88:89], v31 offset:0
  ds_read_b64_tr_b16 a[90:91], v31 offset:512
  ds_read_b64_tr_b16 a[92:93], v31 offset:8192
  ds_read_b64_tr_b16 a[94:95], v31 offset:8704
  s_branch L_wr_11_e
L_wr_11_1:
  s_cmp_lg_u32 s44, 1
  s_cbranch_scc1 L_wr_11_2
  ds_read_b64_tr_b16 a[8:9], v30 offset:0
  ds_read_b64_tr_b16 a[10:11], v30 offset:512
  ds_read_b64_tr_b16 a[12:13], v30 offset:8192
  ds_read_b64_tr_b16 a[14:15], v30 offset:8704
  ds_read_b64_tr_b16 a[72:73], v31 offset:0
  ds_read_b64_tr_b16 a[74:75], v31 offset:512
  ds_read_b64_tr_b16 a[76:77], v31 offset:8192
  ds_read_b64_tr_b16 a[78:79], v31 offset:8704
  s_branch L_wr_11_e
L_wr_11_2:
  s_cmp_lg_u32 s44, 2
  s_cbranch_scc1 L_wr_11_3
  ds_read_b64_tr_b16 a[56:57], v30 offset:0
  ds_read_b64_tr_b16 a[58:59], v30 offset:512
  ds_read_b64_tr_b16 a[60:61], v30 offset:8192
  ds_read_b64_tr_b16 a[62:63], v30 offset:8704
  ds_read_b64_tr_b16 a[120:121], v31 offset:0
  ds_read_b64_tr_b16 a[122:123], v31 offset:512
  ds_read_b64_tr_b16 a[124:125], v31 offset:8192
  ds_read_b64_tr_b16 a[126:127], v31 offset:8704
  s_branch L_wr_11_e
L_wr_11_3:
  ds_read_b64_tr_b16 a[40:41], v30 offset:0
  ds_read_b64_tr_b16 a[42:43], v30 offset:512
  ds_read_b64_tr_b16 a[44:45], v30 offset:8192
  ds_read_b64_tr_b16 a[46:47], v30 offset:8704
  ds_read_b64_tr_b16 a[104:105], v31 offset:0
  ds_read_b64_tr_b16 a[106:107], v31 offset:512
  ds_read_b64_tr_b16 a[108:109], v31 offset:8192
  ds_read_b64_tr_b16 a[110:111], v31 offset:8704
L_wr_11_e:
  s_waitcnt lgkmcnt(0)
  s_waitcnt vmcnt(24)
  s_barrier
  s_add_u32 m0, s56, 49152
  s_mov_b32 s68, 1572864
  buffer_load_dwordx4 v26, s[48:51], s68 offen  lds
  s_add_u32 m0, s56, 53248
  s_mov_b32 s68, 1638400
  buffer_load_dwordx4 v26, s[48:51], s68 offen  lds
  s_add_u32 m0, s56, 57344
  s_mov_b32 s68, 1835008
  buffer_load_dwordx4 v26, s[48:51], s68 offen  lds
  s_add_u32 m0, s56, 61440
  s_mov_b32 s68, 1900544
  buffer_load_dwordx4 v26, s[48:51], s68 offen  lds
  v_add_u32 v30, 65536, v28
  v_add_u32 v31, 65536, v29
  s_cmp_lg_u32 s44, 0
  s_cbranch_scc1 L_wr_12_1
  ds_read_b64_tr_b16 a[32:33], v30 offset:0
  ds_read_b64_tr_b16 a[34:35], v30 offset:512
  ds_read_b64_tr_b16 a[36:37], v30 offset:8192
  ds_read_b64_tr_b16 a[38:39], v30 offset:8704
  ds_read_b64_tr_b16 a[96:97], v31 offset:0
  ds_read_b64_tr_b16 a[98:99], v31 offset:512
  ds_read_b64_tr_b16 a[100:101], v31 offset:8192
  ds_read_b64_tr_b16 a[102:103], v31 offset:8704
  s_branch L_wr_12_e
L_wr_12_1:
  s_cmp_lg_u32 s44, 1
  s_cbranch_scc1 L_wr_12_2
  ds_read_b64_tr_b16 a[48:49], v30 offset:0
  ds_read_b64_tr_b16 a[50:51], v30 offset:512
  ds_read_b64_tr_b16 a[52:53], v30 offset:8192
  ds_read_b64_tr_b16 a[54:55], v30 offset:8704
  ds_read_b64_tr_b16 a[112:113], v31 offset:0
  ds_read_b64_tr_b16 a[114:115], v31 offset:512
  ds_read_b64_tr_b16 a[116:117], v31 offset:8192
  ds_read_b64_tr_b16 a[118:119], v31 offset:8704
  s_branch L_wr_12_e
L_wr_12_2:
  s_cmp_lg_u32 s44, 2
  s_cbranch_scc1 L_wr_12_3
  ds_read_b64_tr_b16 a[0:1], v30 offset:0
  ds_read_b64_tr_b16 a[2:3], v30 offset:512
  ds_read_b64_tr_b16 a[4:5], v30 offset:8192
  ds_read_b64_tr_b16 a[6:7], v30 offset:8704
  ds_read_b64_tr_b16 a[64:65], v31 offset:0
  ds_read_b64_tr_b16 a[66:67], v31 offset:512
  ds_read_b64_tr_b16 a[68:69], v31 offset:8192
  ds_read_b64_tr_b16 a[70:71], v31 offset:8704
  s_branch L_wr_12_e
L_wr_12_3:
  ds_read_b64_tr_b16 a[16:17], v30 offset:0
  ds_read_b64_tr_b16 a[18:19], v30 offset:512
  ds_read_b64_tr_b16 a[20:21], v30 offset:8192
  ds_read_b64_tr_b16 a[22:23], v30 offset:8704
  ds_read_b64_tr_b16 a[80:81], v31 offset:0
  ds_read_b64_tr_b16 a[82:83], v31 offset:512
  ds_read_b64_tr_b16 a[84:85], v31 offset:8192
  ds_read_b64_tr_b16 a[86:87], v31 offset:8704
L_wr_12_e:
  s_waitcnt lgkmcnt(0)
  s_waitcnt vmcnt(24)
  s_barrier
  s_add_u32 m0, s56, 65536
  s_mov_b32 s68, 2097152
  buffer_load_dwordx4 v26, s[48:51], s68 offen  lds
  s_add_u32 m0, s56, 69632
  s_mov_b32 s68, 2162688
  buffer_load_dwordx4 v26, s[48:51], s68 offen  lds
  s_add_u32 m0, s56, 73728
  s_mov_b32 s68, 2359296
  buffer_load_dwordx4 v26, s[48:51], s68 offen  lds
  s_add_u32 m0, s56, 77824
  s_mov_b32 s68, 2424832
  buffer_load_dwordx4 v26, s[48:51], s68 offen  lds
  v_add_u32 v30, 81920, v28
  v_add_u32 v31, 81920, v29
  s_cmp_lg_u32 s44, 0
  s_cbranch_scc1 L_wr_13_1
  ds_read_b64_tr_b16 a[40:41], v30 offset:0
  ds_read_b64_tr_b16 a[42:43], v30 offset:512
  ds_read_b64_tr_b16 a[44:45], v30 offset:8192
  ds_read_b64_tr_b16 a[46:47], v30 offset:8704
  ds_read_b64_tr_b16 a[104:105], v31 offset:0
  ds_read_b64_tr_b16 a[106:107], v31 offset:512
  ds_read_b64_tr_b16 a[108:109], v31 offset:8192
  ds_read_b64_tr_b16 a[110:111], v31 offset:8704
  s_branch L_wr_13_e
L_wr_13_1:
  s_cmp_lg_u32 s44, 1
  s_cbranch_scc1 L_wr_13_2
  ds_read_b64_tr_b16 a[56:57], v30 offset:0
  ds_read_b64_tr_b16 a[58:59], v30 offset:512
  ds_read_b64_tr_b16 a[60:61], v30 offset:8192
  ds_read_b64_tr_b16 a[62:63], v30 offset:8704
  ds_read_b64_tr_b16 a[120:121], v31 offset:0
  ds_read_b64_tr_b16 a[122:123], v31 offset:512
  ds_read_b64_tr_b16 a[124:125], v31 offset:8192
  ds_read_b64_tr_b16 a[126:127], v31 offset:8704
  s_branch L_wr_13_e
L_wr_13_2:
  s_cmp_lg_u32 s44, 2
  s_cbranch_scc1 L_wr_13_3
  ds_read_b64_tr_b16 a[8:9], v30 offset:0
  ds_read_b64_tr_b16 a[10:11], v30 offset:512
  ds_read_b64_tr_b16 a[12:13], v30 offset:8192
  ds_read_b64_tr_b16 a[14:15], v30 offset:8704
  ds_read_b64_tr_b16 a[72:73], v31 offset:0
  ds_read_b64_tr_b16 a[74:75], v31 offset:512
  ds_read_b64_tr_b16 a[76:77], v31 offset:8192
  ds_read_b64_tr_b16 a[78:79], v31 offset:8704
  s_branch L_wr_13_e
L_wr_13_3:
  ds_read_b64_tr_b16 a[24:25], v30 offset:0
  ds_read_b64_tr_b16 a[26:27], v30 offset:512
  ds_read_b64_tr_b16 a[28:29], v30 offset:8192
  ds_read_b64_tr_b16 a[30:31], v30 offset:8704
  ds_read_b64_tr_b16 a[88:89], v31 offset:0
  ds_read_b64_tr_b16 a[90:91], v31 offset:512
  ds_read_b64_tr_b16 a[92:93], v31 offset:8192
  ds_read_b64_tr_b16 a[94:95], v31 offset:8704
L_wr_13_e:
  s_waitcnt lgkmcnt(0)
  s_waitcnt vmcnt(24)
  s_barrier
  s_add_u32 m0, s56, 81920
  s_mov_b32 s68, 2621440
  buffer_load_dwordx4 v26, s[48:51], s68 offen  lds
  s_add_u32 m0, s56, 86016
  s_mov_b32 s68, 2686976
  buffer_load_dwordx4 v26, s[48:51], s68 offen  lds
  s_add_u32 m0, s56, 90112
  s_mov_b32 s68, 2883584
  buffer_load_dwordx4 v26, s[48:51], s68 offen  lds
  s_add_u32 m0, s56, 94208
  s_mov_b32 s68, 2949120
  buffer_load_dwordx4 v26, s[48:51], s68 offen  lds
  v_add_u32 v30, 98304, v28
  v_add_u32 v31, 98304, v29
  s_cmp_lg_u32 s44, 0
  s_cbranch_scc1 L_wr_14_1
  ds_read_b64_tr_b16 a[48:49], v30 offset:0
  ds_read_b64_tr_b16 a[50:51], v30 offset:512
  ds_read_b64_tr_b16 a[52:53], v30 offset:8192
  ds_read_b64_tr_b16 a[54:55], v30 offset:8704
  ds_read_b64_tr_b16 a[112:113], v31 offset:0
  ds_read_b64_tr_b16 a[114:115], v31 offset:512
  ds_read_b64_tr_b16 a[116:117], v31 offset:8192
  ds_read_b64_tr_b16 a[118:119], v31 offset:8704
  s_branch L_wr_14_e
L_wr_14_1:
  s_cmp_lg_u32 s44, 1
  s_cbranch_scc1 L_wr_14_2
  ds_read_b64_tr_b16 a[32:33], v30 offset:0
  ds_read_b64_tr_b16 a[34:35], v30 offset:512
  ds_read_b64_tr_b16 a[36:37], v30 offset:8192
  ds_read_b64_tr_b16 a[38:39], v30 offset:8704
  ds_read_b64_tr_b16 a[96:97], v31 offset:0
  ds_read_b64_tr_b16 a[98:99], v31 offset:512
  ds_read_b64_tr_b16 a[100:101], v31 offset:8192
  ds_read_b64_tr_b16 a[102:103], v31 offset:8704
  s_branch L_wr_14_e
L_wr_14_2:
  s_cmp_lg_u32 s44, 2
  s_cbranch_scc1 L_wr_14_3
  ds_read_b64_tr_b16 a[16:17], v30 offset:0
  ds_read_b64_tr_b16 a[18:19], v30 offset:512
  ds_read_b64_tr_b16 a[20:21], v30 offset:8192
  ds_read_b64_tr_b16 a[22:23], v30 offset:8704
  ds_read_b64_tr_b16 a[80:81], v31 offset:0
  ds_read_b64_tr_b16 a[82:83], v31 offset:512
  ds_read_b64_tr_b16 a[84:85], v31 offset:8192
  ds_read_b64_tr_b16 a[86:87], v31 offset:8704
  s_branch L_wr_14_e
L_wr_14_3:
  ds_read_b64_tr_b16 a[0:1], v30 offset:0
  ds_read_b64_tr_b16 a[2:3], v30 offset:512
  ds_read_b64_tr_b16 a[4:5], v30 offset:8192
  ds_read_b64_tr_b16 a[6:7], v30 offset:8704
  ds_read_b64_tr_b16 a[64:65], v31 offset:0
  ds_read_b64_tr_b16 a[66:67], v31 offset:512
  ds_read_b64_tr_b16 a[68:69], v31 offset:8192
  ds_read_b64_tr_b16 a[70:71], v31 offset:8704
L_wr_14_e:
  s_waitcnt lgkmcnt(0)
  s_waitcnt vmcnt(24)
  s_barrier
  s_add_u32 m0, s56, 98304
  s_mov_b32 s68, 3145728
  buffer_load_dwordx4 v26, s[48:51], s68 offen  lds
  s_add_u32 m0, s56, 102400
  s_mov_b32 s68, 3211264
  buffer_load_dwordx4 v26, s[48:51], s68 offen  lds
  s_add_u32 m0, s56, 106496
  s_mov_b32 s68, 3407872
  buffer_load_dwordx4 v26, s[48:51], s68 offen  lds
  s_add_u32 m0, s56, 110592
  s_mov_b32 s68, 3473408
  buffer_load_dwordx4 v26, s[48:51], s68 offen  lds
  v_add_u32 v30, 114688, v28
  v_add_u32 v31, 114688, v29
  s_cmp_lg_u32 s44, 0
  s_cbranch_scc1 L_wr_15_1
  ds_read_b64_tr_b16 a[56:57], v30 offset:0
  ds_read_b64_tr_b16 a[58:59], v30 offset:512
  ds_read_b64_tr_b16 a[60:61], v30 offset:8192
  ds_read_b64_tr_b16 a[62:63], v30 offset:8704
  ds_read_b64_tr_b16 a[120:121], v31 offset:0
  ds_read_b64_tr_b16 a[122:123], v31 offset:512
  ds_read_b64_tr_b16 a[124:125], v31 offset:8192
  ds_read_b64_tr_b16 a[126:127], v31 offset:8704
  s_branch L_wr_15_e
L_wr_15_1:
  s_cmp_lg_u32 s44, 1
  s_cbranch_scc1 L_wr_15_2
  ds_read_b64_tr_b16 a[40:41], v30 offset:0
  ds_read_b64_tr_b16 a[42:43], v30 offset:512
  ds_read_b64_tr_b16 a[44:45], v30 offset:8192
  ds_read_b64_tr_b16 a[46:47], v30 offset:8704
  ds_read_b64_tr_b16 a[104:105], v31 offset:0
  ds_read_b64_tr_b16 a[106:107], v31 offset:512
  ds_read_b64_tr_b16 a[108:109], v31 offset:8192
  ds_read_b64_tr_b16 a[110:111], v31 offset:8704
  s_branch L_wr_15_e
L_wr_15_2:
  s_cmp_lg_u32 s44, 2
  s_cbranch_scc1 L_wr_15_3
  ds_read_b64_tr_b16 a[24:25], v30 offset:0
  ds_read_b64_tr_b16 a[26:27], v30 offset:512
  ds_read_b64_tr_b16 a[28:29], v30 offset:8192
  ds_read_b64_tr_b16 a[30:31], v30 offset:8704
  ds_read_b64_tr_b16 a[88:89], v31 offset:0
  ds_read_b64_tr_b16 a[90:91], v31 offset:512
  ds_read_b64_tr_b16 a[92:93], v31 offset:8192
  ds_read_b64_tr_b16 a[94:95], v31 offset:8704
  s_branch L_wr_15_e
L_wr_15_3:
  ds_read_b64_tr_b16 a[8:9], v30 offset:0
  ds_read_b64_tr_b16 a[10:11], v30 offset:512
  ds_read_b64_tr_b16 a[12:13], v30 offset:8192
  ds_read_b64_tr_b16 a[14:15], v30 offset:8704
  ds_read_b64_tr_b16 a[72:73], v31 offset:0
  ds_read_b64_tr_b16 a[74:75], v31 offset:512
  ds_read_b64_tr_b16 a[76:77], v31 offset:8192
  ds_read_b64_tr_b16 a[78:79], v31 offset:8704
L_wr_15_e:
  s_waitcnt lgkmcnt(0)
  s_waitcnt vmcnt(24)
  s_barrier
  s_add_u32 m0, s56, 114688
  s_mov_b32 s68, 3670016
  buffer_load_dwordx4 v26, s[48:51], s68 offen  lds
  s_add_u32 m0, s56, 118784
  s_mov_b32 s68, 3735552
  buffer_load_dwordx4 v26, s[48:51], s68 offen  lds
  s_add_u32 m0, s56, 122880
  s_mov_b32 s68, 3932160
  buffer_load_dwordx4 v26, s[48:51], s68 offen  lds
  s_add_u32 m0, s56, 126976
  s_mov_b32 s68, 3997696
  buffer_load_dwordx4 v26, s[48:51], s68 offen  lds
  v_add_u32 v30, 0, v28
  v_add_u32 v31, 0, v29
  s_cmp_lg_u32 s44, 0
  s_cbranch_scc1 L_wr_16_1
  ds_read_b64_tr_b16 a[128:129], v30 offset:0
  ds_read_b64_tr_b16 a[130:131], v30 offset:512
  ds_read_b64_tr_b16 a[132:133], v30 offset:8192
  ds_read_b64_tr_b16 a[134:135], v30 offset:8704
  ds_read_b64_tr_b16 a[192:193], v31 offset:0
  ds_read_b64_tr_b16 a[194:195], v31 offset:512
  ds_read_b64_tr_b16 a[196:197], v31 offset:8192
  ds_read_b64_tr_b16 a[198:199], v31 offset:8704
  s_branch L_wr_16_e
L_wr_16_1:
  s_cmp_lg_u32 s44, 1
  s_cbranch_scc1 L_wr_16_2
  ds_read_b64_tr_b16 a[144:145], v30 offset:0
  ds_read_b64_tr_b16 a[146:147], v30 offset:512
  ds_read_b64_tr_b16 a[148:149], v30 offset:8192
  ds_read_b64_tr_b16 a[150:151], v30 offset:8704
  ds_read_b64_tr_b16 a[208:209], v31 offset:0
  ds_read_b64_tr_b16 a[210:211], v31 offset:512
  ds_read_b64_tr_b16 a[212:213], v31 offset:8192
  ds_read_b64_tr_b16 a[214:215], v31 offset:8704
  s_branch L_wr_16_e
L_wr_16_2:
  s_cmp_lg_u32 s44, 2
  s_cbranch_scc1 L_wr_16_3
  ds_read_b64_tr_b16 a[160:161], v30 offset:0
  ds_read_b64_tr_b16 a[162:163], v30 offset:512
  ds_read_b64_tr_b16 a[164:165], v30 offset:8192
  ds_read_b64_tr_b16 a[166:167], v30 offset:8704
  ds_read_b64_tr_b16 a[224:225], v31 offset:0
  ds_read_b64_tr_b16 a[226:227], v31 offset:512
  ds_read_b64_tr_b16 a[228:229], v31 offset:8192
  ds_read_b64_tr_b16 a[230:231], v31 offset:8704
  s_branch L_wr_16_e
L_wr_16_3:
  ds_read_b64_tr_b16 a[176:177], v30 offset:0
  ds_read_b64_tr_b16 a[178:179], v30 offset:512
  ds_read_b64_tr_b16 a[180:181], v30 offset:8192
  ds_read_b64_tr_b16 a[182:183], v30 offset:8704
  ds_read_b64_tr_b16 a[240:241], v31 offset:0
  ds_read_b64_tr_b16 a[242:243], v31 offset:512
  ds_read_b64_tr_b16 a[244:245], v31 offset:8192
  ds_read_b64_tr_b16 a[246:247], v31 offset:8704
L_wr_16_e:
  s_waitcnt lgkmcnt(0)
  s_waitcnt vmcnt(24)
  s_barrier
  s_mov_b32 s48, s28
  s_and_b32 s49, s29, 0xffff
  s_add_u32 m0, s56, 0
  s_mov_b32 s68, 0
  buffer_load_dwordx4 v26, s[48:51], s68 offen  lds
  s_add_u32 m0, s56, 4096
  s_mov_b32 s68, 65536
  buffer_load_dwordx4 v26, s[48:51], s68 offen  lds
  s_add_u32 m0, s56, 8192
  s_mov_b32 s68, 262144
  buffer_load_dwordx4 v26, s[48:51], s68 offen  lds
  s_add_u32 m0, s56, 12288
  s_mov_b32 s68, 327680
  buffer_load_dwordx4 v26, s[48:51], s68 offen  lds
  v_add_u32 v30, 16384, v28
  v_add_u32 v31, 16384, v29
  s_cmp_lg_u32 s44, 0
  s_cbranch_scc1 L_wr_17_1
  ds_read_b64_tr_b16 a[136:137], v30 offset:0
  ds_read_b64_tr_b16 a[138:139], v30 offset:512
  ds_read_b64_tr_b16 a[140:141], v30 offset:8192
  ds_read_b64_tr_b16 a[142:143], v30 offset:8704
  ds_read_b64_tr_b16 a[200:201], v31 offset:0
  ds_read_b64_tr_b16 a[202:203], v31 offset:512
  ds_read_b64_tr_b16 a[204:205], v31 offset:8192
  ds_read_b64_tr_b16 a[206:207], v31 offset:8704
  s_branch L_wr_17_e
L_wr_17_1:
  s_cmp_lg_u32 s44, 1
  s_cbranch_scc1 L_wr_17_2
  ds_read_b64_tr_b16 a[152:153], v30 offset:0
  ds_read_b64_tr_b16 a[154:155], v30 offset:512
  ds_read_b64_tr_b16 a[156:157], v30 offset:8192
  ds_read_b64_tr_b16 a[158:159], v30 offset:8704
  ds_read_b64_tr_b16 a[216:217], v31 offset:0
  ds_read_b64_tr_b16 a[218:219], v31 offset:512
  ds_read_b64_tr_b16 a[220:221], v31 offset:8192
  ds_read_b64_tr_b16 a[222:223], v31 offset:8704
  s_branch L_wr_17_e
L_wr_17_2:
  s_cmp_lg_u32 s44, 2
  s_cbranch_scc1 L_wr_17_3
  ds_read_b64_tr_b16 a[168:169], v30 offset:0
  ds_read_b64_tr_b16 a[170:171], v30 offset:512
  ds_read_b64_tr_b16 a[172:173], v30 offset:8192
  ds_read_b64_tr_b16 a[174:175], v30 offset:8704
  ds_read_b64_tr_b16 a[232:233], v31 offset:0
  ds_read_b64_tr_b16 a[234:235], v31 offset:512
  ds_read_b64_tr_b16 a[236:237], v31 offset:8192
  ds_read_b64_tr_b16 a[238:239], v31 offset:8704
  s_branch L_wr_17_e
L_wr_17_3:
  ds_read_b64_tr_b16 a[184:185], v30 offset:0
  ds_read_b64_tr_b16 a[186:187], v30 offset:512
  ds_read_b64_tr_b16 a[188:189], v30 offset:8192
  ds_read_b64_tr_b16 a[190:191], v30 offset:8704
  ds_read_b64_tr_b16 a[248:249], v31 offset:0
  ds_read_b64_tr_b16 a[250:251], v31 offset:512
  ds_read_b64_tr_b16 a[252:253], v31 offset:8192
  ds_read_b64_tr_b16 a[254:255], v31 offset:8704
L_wr_17_e:
  s_waitcnt lgkmcnt(0)
  s_waitcnt vmcnt(24)
  s_barrier
  s_add_u32 m0, s56, 16384
  s_mov_b32 s68, 524288
  buffer_load_dwordx4 v26, s[48:51], s68 offen  lds
  s_add_u32 m0, s56, 20480
  s_mov_b32 s68, 589824
  buffer_load_dwordx4 v26, s[48:51], s68 offen  lds
  s_add_u32 m0, s56, 24576
  s_mov_b32 s68, 786432
  buffer_load_dwordx4 v26, s[48:51], s68 offen  lds
  s_add_u32 m0, s56, 28672
  s_mov_b32 s68, 851968
  buffer_load_dwordx4 v26, s[48:51], s68 offen  lds
  v_add_u32 v30, 32768, v28
  v_add_u32 v31, 32768, v29
  s_cmp_lg_u32 s44, 0
  s_cbranch_scc1 L_wr_18_1
  ds_read_b64_tr_b16 a[144:145], v30 offset:0
  ds_read_b64_tr_b16 a[146:147], v30 offset:512
  ds_read_b64_tr_b16 a[148:149], v30 offset:8192
  ds_read_b64_tr_b16 a[150:151], v30 offset:8704
  ds_read_b64_tr_b16 a[208:209], v31 offset:0
  ds_read_b64_tr_b16 a[210:211], v31 offset:512
  ds_read_b64_tr_b16 a[212:213], v31 offset:8192
  ds_read_b64_tr_b16 a[214:215], v31 offset:8704
  s_branch L_wr_18_e
L_wr_18_1:
  s_cmp_lg_u32 s44, 1
  s_cbranch_scc1 L_wr_18_2
  ds_read_b64_tr_b16 a[128:129], v30 offset:0
  ds_read_b64_tr_b16 a[130:131], v30 offset:512
  ds_read_b64_tr_b16 a[132:133], v30 offset:8192
  ds_read_b64_tr_b16 a[134:135], v30 offset:8704
  ds_read_b64_tr_b16 a[192:193], v31 offset:0
  ds_read_b64_tr_b16 a[194:195], v31 offset:512
  ds_read_b64_tr_b16 a[196:197], v31 offset:8192
  ds_read_b64_tr_b16 a[198:199], v31 offset:8704
  s_branch L_wr_18_e
L_wr_18_2:
  s_cmp_lg_u32 s44, 2
  s_cbranch_scc1 L_wr_18_3
  ds_read_b64_tr_b16 a[176:177], v30 offset:0
  ds_read_b64_tr_b16 a[178:179], v30 offset:512
  ds_read_b64_tr_b16 a[180:181], v30 offset:8192
  ds_read_b64_tr_b16 a[182:183], v30 offset:8704
  ds_read_b64_tr_b16 a[240:241], v31 offset:0
  ds_read_b64_tr_b16 a[242:243], v31 offset:512
  ds_read_b64_tr_b16 a[244:245], v31 offset:8192
  ds_read_b64_tr_b16 a[246:247], v31 offset:8704
  s_branch L_wr_18_e
L_wr_18_3:
  ds_read_b64_tr_b16 a[160:161], v30 offset:0
  ds_read_b64_tr_b16 a[162:163], v30 offset:512
  ds_read_b64_tr_b16 a[164:165], v30 offset:8192
  ds_read_b64_tr_b16 a[166:167], v30 offset:8704
  ds_read_b64_tr_b16 a[224:225], v31 offset:0
  ds_read_b64_tr_b16 a[226:227], v31 offset:512
  ds_read_b64_tr_b16 a[228:229], v31 offset:8192
  ds_read_b64_tr_b16 a[230:231], v31 offset:8704
L_wr_18_e:
  s_waitcnt lgkmcnt(0)
  s_waitcnt vmcnt(24)
  s_barrier
  s_add_u32 m0, s56, 32768
  s_mov_b32 s68, 1048576
  buffer_load_dwordx4 v26, s[48:51], s68 offen  lds
  s_add_u32 m0, s56, 36864
  s_mov_b32 s68, 1114112
  buffer_load_dwordx4 v26, s[48:51], s68 offen  lds
  s_add_u32 m0, s56, 40960
  s_mov_b32 s68, 1310720
  buffer_load_dwordx4 v26, s[48:51], s68 offen  lds
  s_add_u32 m0, s56, 45056
  s_mov_b32 s68, 1376256
  buffer_load_dwordx4 v26, s[48:51], s68 offen  lds
  v_add_u32 v30, 49152, v28
  v_add_u32 v31, 49152, v29
  s_cmp_lg_u32 s44, 0
  s_cbranch_scc1 L_wr_19_1
  ds_read_b64_tr_b16 a[152:153], v30 offset:0
  ds_read_b64_tr_b16 a[154:155], v30 offset:512
  ds_read_b64_tr_b16 a[156:157], v30 offset:8192
  ds_read_b64_tr_b16 a[158:159], v30 offset:8704
  ds_read_b64_tr_b16 a[216:217], v31 offset:0
  ds_read_b64_tr_b16 a[218:219], v31 offset:512
  ds_read_b64_tr_b16 a[220:221], v31 offset:8192
  ds_read_b64_tr_b16 a[222:223], v31 offset:8704
  s_branch L_wr_19_e
L_wr_19_1:
  s_cmp_lg_u32 s44, 1
  s_cbranch_scc1 L_wr_19_2
  ds_read_b64_tr_b16 a[136:137], v30 offset:0
  ds_read_b64_tr_b16 a[138:139], v30 offset:512
  ds_read_b64_tr_b16 a[140:141], v30 offset:8192
  ds_read_b64_tr_b16 a[142:143], v30 offset:8704
  ds_read_b64_tr_b16 a[200:201], v31 offset:0
  ds_read_b64_tr_b16 a[202:203], v31 offset:512
  ds_read_b64_tr_b16 a[204:205], v31 offset:8192
  ds_read_b64_tr_b16 a[206:207], v31 offset:8704
  s_branch L_wr_19_e
L_wr_19_2:
  s_cmp_lg_u32 s44, 2
  s_cbranch_scc1 L_wr_19_3
  ds_read_b64_tr_b16 a[184:185], v30 offset:0
  ds_read_b64_tr_b16 a[186:187], v30 offset:512
  ds_read_b64_tr_b16 a[188:189], v30 offset:8192
  ds_read_b64_tr_b16 a[190:191], v30 offset:8704
  ds_read_b64_tr_b16 a[248:249], v31 offset:0
  ds_read_b64_tr_b16 a[250:251], v31 offset:512
  ds_read_b64_tr_b16 a[252:253], v31 offset:8192
  ds_read_b64_tr_b16 a[254:255], v31 offset:8704
  s_branch L_wr_19_e
L_wr_19_3:
  ds_read_b64_tr_b16 a[168:169], v30 offset:0
  ds_read_b64_tr_b16 a[170:171], v30 offset:512
  ds_read_b64_tr_b16 a[172:173], v30 offset:8192
  ds_read_b64_tr_b16 a[174:175], v30 offset:8704
  ds_read_b64_tr_b16 a[232:233], v31 offset:0
  ds_read_b64_tr_b16 a[234:235], v31 offset:512
  ds_read_b64_tr_b16 a[236:237], v31 offset:8192
  ds_read_b64_tr_b16 a[238:239], v31 offset:8704
L_wr_19_e:
  s_waitcnt lgkmcnt(0)
  s_waitcnt vmcnt(24)
  s_barrier
  s_add_u32 m0, s56, 49152
  s_mov_b32 s68, 1572864
  buffer_load_dwordx4 v26, s[48:51], s68 offen  lds
  s_add_u32 m0, s56, 53248
  s_mov_b32 s68, 1638400
  buffer_load_dwordx4 v26, s[48:51], s68 offen  lds
  s_add_u32 m0, s56, 57344
  s_mov_b32 s68, 1835008
  buffer_load_dwordx4 v26, s[48:51], s68 offen  lds
  s_add_u32 m0, s56, 61440
  s_mov_b32 s68, 1900544
  buffer_load_dwordx4 v26, s[48:51], s68 offen  lds
  v_add_u32 v30, 65536, v28
  v_add_u32 v31, 65536, v29
  s_cmp_lg_u32 s44, 0
  s_cbranch_scc1 L_wr_20_1
  ds_read_b64_tr_b16 a[160:161], v30 offset:0
  ds_read_b64_tr_b16 a[162:163], v30 offset:512
  ds_read_b64_tr_b16 a[164:165], v30 offset:8192
  ds_read_b64_tr_b16 a[166:167], v30 offset:8704
  ds_read_b64_tr_b16 a[224:225], v31 offset:0
  ds_read_b64_tr_b16 a[226:227], v31 offset:512
  ds_read_b64_tr_b16 a[228:229], v31 offset:8192
  ds_read_b64_tr_b16 a[230:231], v31 offset:8704
  s_branch L_wr_20_e
L_wr_20_1:
  s_cmp_lg_u32 s44, 1
  s_cbranch_scc1 L_wr_20_2
  ds_read_b64_tr_b16 a[176:177], v30 offset:0
  ds_read_b64_tr_b16 a[178:179], v30 offset:512
  ds_read_b64_tr_b16 a[180:181], v30 offset:8192
  ds_read_b64_tr_b16 a[182:183], v30 offset:8704
  ds_read_b64_tr_b16 a[240:241], v31 offset:0
  ds_read_b64_tr_b16 a[242:243], v31 offset:512
  ds_read_b64_tr_b16 a[244:245], v31 offset:8192
  ds_read_b64_tr_b16 a[246:247], v31 offset:8704
  s_branch L_wr_20_e
L_wr_20_2:
  s_cmp_lg_u32 s44, 2
  s_cbranch_scc1 L_wr_20_3
  ds_read_b64_tr_b16 a[128:129], v30 offset:0
  ds_read_b64_tr_b16 a[130:131], v30 offset:512
  ds_read_b64_tr_b16 a[132:133], v30 offset:8192
  ds_read_b64_tr_b16 a[134:135], v30 offset:8704
  ds_read_b64_tr_b16 a[192:193], v31 offset:0
  ds_read_b64_tr_b16 a[194:195], v31 offset:512
  ds_read_b64_tr_b16 a[196:197], v31 offset:8192
  ds_read_b64_tr_b16 a[198:199], v31 offset:8704
  s_branch L_wr_20_e
L_wr_20_3:
  ds_read_b64_tr_b16 a[144:145], v30 offset:0
  ds_read_b64_tr_b16 a[146:147], v30 offset:512
  ds_read_b64_tr_b16 a[148:149], v30 offset:8192
  ds_read_b64_tr_b16 a[150:151], v30 offset:8704
  ds_read_b64_tr_b16 a[208:209], v31 offset:0
  ds_read_b64_tr_b16 a[210:211], v31 offset:512
  ds_read_b64_tr_b16 a[212:213], v31 offset:8192
  ds_read_b64_tr_b16 a[214:215], v31 offset:8704
L_wr_20_e:
  s_waitcnt lgkmcnt(0)
  s_waitcnt vmcnt(24)
  s_barrier
  s_add_u32 m0, s56, 65536
  s_mov_b32 s68, 2097152
  buffer_load_dwordx4 v26, s[48:51], s68 offen  lds
  s_add_u32 m0, s56, 69632
  s_mov_b32 s68, 2162688
  buffer_load_dwordx4 v26, s[48:51], s68 offen  lds
  s_add_u32 m0, s56, 73728
  s_mov_b32 s68, 2359296
  buffer_load_dwordx4 v26, s[48:51], s68 offen  lds
  s_add_u32 m0, s56, 77824
  s_mov_b32 s68, 2424832
  buffer_load_dwordx4 v26, s[48:51], s68 offen  lds
  v_add_u32 v30, 81920, v28
  v_add_u32 v31, 81920, v29
  s_cmp_lg_u32 s44, 0
  s_cbranch_scc1 L_wr_21_1
  ds_read_b64_tr_b16 a[168:169], v30 offset:0
  ds_read_b64_tr_b16 a[170:171], v30 offset:512
  ds_read_b64_tr_b16 a[172:173], v30 offset:8192
  ds_read_b64_tr_b16 a[174:175], v30 offset:8704
  ds_read_b64_tr_b16 a[232:233], v31 offset:0
  ds_read_b64_tr_b16 a[234:235], v31 offset:512
  ds_read_b64_tr_b16 a[236:237], v31 offset:8192
  ds_read_b64_tr_b16 a[238:239], v31 offset:8704
  s_branch L_wr_21_e
L_wr_21_1:
  s_cmp_lg_u32 s44, 1
  s_cbranch_scc1 L_wr_21_2
  ds_read_b64_tr_b16 a[184:185], v30 offset:0
  ds_read_b64_tr_b16 a[186:187], v30 offset:512
  ds_read_b64_tr_b16 a[188:189], v30 offset:8192
  ds_read_b64_tr_b16 a[190:191], v30 offset:8704
  ds_read_b64_tr_b16 a[248:249], v31 offset:0
  ds_read_b64_tr_b16 a[250:251], v31 offset:512
  ds_read_b64_tr_b16 a[252:253], v31 offset:8192
  ds_read_b64_tr_b16 a[254:255], v31 offset:8704
  s_branch L_wr_21_e
L_wr_21_2:
  s_cmp_lg_u32 s44, 2
  s_cbranch_scc1 L_wr_21_3
  ds_read_b64_tr_b16 a[136:137], v30 offset:0
  ds_read_b64_tr_b16 a[138:139], v30 offset:512
  ds_read_b64_tr_b16 a[140:141], v30 offset:8192
  ds_read_b64_tr_b16 a[142:143], v30 offset:8704
  ds_read_b64_tr_b16 a[200:201], v31 offset:0
  ds_read_b64_tr_b16 a[202:203], v31 offset:512
  ds_read_b64_tr_b16 a[204:205], v31 offset:8192
  ds_read_b64_tr_b16 a[206:207], v31 offset:8704
  s_branch L_wr_21_e
L_wr_21_3:
  ds_read_b64_tr_b16 a[152:153], v30 offset:0
  ds_read_b64_tr_b16 a[154:155], v30 offset:512
  ds_read_b64_tr_b16 a[156:157], v30 offset:8192
  ds_read_b64_tr_b16 a[158:159], v30 offset:8704
  ds_read_b64_tr_b16 a[216:217], v31 offset:0
  ds_read_b64_tr_b16 a[218:219], v31 offset:512
  ds_read_b64_tr_b16 a[220:221], v31 offset:8192
  ds_read_b64_tr_b16 a[222:223], v31 offset:8704
L_wr_21_e:
  s_waitcnt lgkmcnt(0)
  s_waitcnt vmcnt(24)
  s_barrier
  s_add_u32 m0, s56, 81920
  s_mov_b32 s68, 2621440
  buffer_load_dwordx4 v26, s[48:51], s68 offen  lds
  s_add_u32 m0, s56, 86016
  s_mov_b32 s68, 2686976
  buffer_load_dwordx4 v26, s[48:51], s68 offen  lds
  s_add_u32 m0, s56, 90112
  s_mov_b32 s68, 2883584
  buffer_load_dwordx4 v26, s[48:51], s68 offen  lds
  s_add_u32 m0, s56, 94208
  s_mov_b32 s68, 2949120
  buffer_load_dwordx4 v26, s[48:51], s68 offen  lds
  v_add_u32 v30, 98304, v28
  v_add_u32 v31, 98304, v29
  s_cmp_lg_u32 s44, 0
  s_cbranch_scc1 L_wr_22_1
  ds_read_b64_tr_b16 a[176:177], v30 offset:0
  ds_read_b64_tr_b16 a[178:179], v30 offset:512
  ds_read_b64_tr_b16 a[180:181], v30 offset:8192
  ds_read_b64_tr_b16 a[182:183], v30 offset:8704
  ds_read_b64_tr_b16 a[240:241], v31 offset:0
  ds_read_b64_tr_b16 a[242:243], v31 offset:512
  ds_read_b64_tr_b16 a[244:245], v31 offset:8192
  ds_read_b64_tr_b16 a[246:247], v31 offset:8704
  s_branch L_wr_22_e
L_wr_22_1:
  s_cmp_lg_u32 s44, 1
  s_cbranch_scc1 L_wr_22_2
  ds_read_b64_tr_b16 a[160:161], v30 offset:0
  ds_read_b64_tr_b16 a[162:163], v30 offset:512
  ds_read_b64_tr_b16 a[164:165], v30 offset:8192
  ds_read_b64_tr_b16 a[166:167], v30 offset:8704
  ds_read_b64_tr_b16 a[224:225], v31 offset:0
  ds_read_b64_tr_b16 a[226:227], v31 offset:512
  ds_read_b64_tr_b16 a[228:229], v31 offset:8192
  ds_read_b64_tr_b16 a[230:231], v31 offset:8704
  s_branch L_wr_22_e
L_wr_22_2:
  s_cmp_lg_u32 s44, 2
  s_cbranch_scc1 L_wr_22_3
  ds_read_b64_tr_b16 a[144:145], v30 offset:0
  ds_read_b64_tr_b16 a[146:147], v30 offset:512
  ds_read_b64_tr_b16 a[148:149], v30 offset:8192
  ds_read_b64_tr_b16 a[150:151], v30 offset:8704
  ds_read_b64_tr_b16 a[208:209], v31 offset:0
  ds_read_b64_tr_b16 a[210:211], v31 offset:512
  ds_read_b64_tr_b16 a[212:213], v31 offset:8192
  ds_read_b64_tr_b16 a[214:215], v31 offset:8704
  s_branch L_wr_22_e
L_wr_22_3:
  ds_read_b64_tr_b16 a[128:129], v30 offset:0
  ds_read_b64_tr_b16 a[130:131], v30 offset:512
  ds_read_b64_tr_b16 a[132:133], v30 offset:8192
  ds_read_b64_tr_b16 a[134:135], v30 offset:8704
  ds_read_b64_tr_b16 a[192:193], v31 offset:0
  ds_read_b64_tr_b16 a[194:195], v31 offset:512
  ds_read_b64_tr_b16 a[196:197], v31 offset:8192
  ds_read_b64_tr_b16 a[198:199], v31 offset:8704
L_wr_22_e:
  s_waitcnt lgkmcnt(0)
  s_waitcnt vmcnt(24)
  s_barrier
  s_add_u32 m0, s56, 98304
  s_mov_b32 s68, 3145728
  buffer_load_dwordx4 v26, s[48:51], s68 offen  lds
  s_add_u32 m0, s56, 102400
  s_mov_b32 s68, 3211264
  buffer_load_dwordx4 v26, s[48:51], s68 offen  lds
  s_add_u32 m0, s56, 106496
  s_mov_b32 s68, 3407872
  buffer_load_dwordx4 v26, s[48:51], s68 offen  lds
  s_add_u32 m0, s56, 110592
  s_mov_b32 s68, 3473408
  buffer_load_dwordx4 v26, s[48:51], s68 offen  lds
  v_add_u32 v30, 114688, v28
  v_add_u32 v31, 114688, v29
  s_cmp_lg_u32 s44, 0
  s_cbranch_scc1 L_wr_23_1
  ds_read_b64_tr_b16 a[184:185], v30 offset:0
  ds_read_b64_tr_b16 a[186:187], v30 offset:512
  ds_read_b64_tr_b16 a[188:189], v30 offset:8192
  ds_read_b64_tr_b16 a[190:191], v30 offset:8704
  ds_read_b64_tr_b16 a[248:249], v31 offset:0
  ds_read_b64_tr_b16 a[250:251], v31 offset:512
  ds_read_b64_tr_b16 a[252:253], v31 offset:8192
  ds_read_b64_tr_b16 a[254:255], v31 offset:8704
  s_branch L_wr_23_e
L_wr_23_1:
  s_cmp_lg_u32 s44, 1
  s_cbranch_scc1 L_wr_23_2
  ds_read_b64_tr_b16 a[168:169], v30 offset:0
  ds_read_b64_tr_b16 a[170:171], v30 offset:512
  ds_read_b64_tr_b16 a[172:173], v30 offset:8192
  ds_read_b64_tr_b16 a[174:175], v30 offset:8704
  ds_read_b64_tr_b16 a[232:233], v31 offset:0
  ds_read_b64_tr_b16 a[234:235], v31 offset:512
  ds_read_b64_tr_b16 a[236:237], v31 offset:8192
  ds_read_b64_tr_b16 a[238:239], v31 offset:8704
  s_branch L_wr_23_e
L_wr_23_2:
  s_cmp_lg_u32 s44, 2
  s_cbranch_scc1 L_wr_23_3
  ds_read_b64_tr_b16 a[152:153], v30 offset:0
  ds_read_b64_tr_b16 a[154:155], v30 offset:512
  ds_read_b64_tr_b16 a[156:157], v30 offset:8192
  ds_read_b64_tr_b16 a[158:159], v30 offset:8704
  ds_read_b64_tr_b16 a[216:217], v31 offset:0
  ds_read_b64_tr_b16 a[218:219], v31 offset:512
  ds_read_b64_tr_b16 a[220:221], v31 offset:8192
  ds_read_b64_tr_b16 a[222:223], v31 offset:8704
  s_branch L_wr_23_e
L_wr_23_3:
  ds_read_b64_tr_b16 a[136:137], v30 offset:0
  ds_read_b64_tr_b16 a[138:139], v30 offset:512
  ds_read_b64_tr_b16 a[140:141], v30 offset:8192
  ds_read_b64_tr_b16 a[142:143], v30 offset:8704
  ds_read_b64_tr_b16 a[200:201], v31 offset:0
  ds_read_b64_tr_b16 a[202:203], v31 offset:512
  ds_read_b64_tr_b16 a[204:205], v31 offset:8192
  ds_read_b64_tr_b16 a[206:207], v31 offset:8704
L_wr_23_e:
  s_waitcnt lgkmcnt(0)
  s_waitcnt vmcnt(24)
  s_barrier
  s_add_u32 m0, s56, 114688
  s_mov_b32 s68, 3670016
  buffer_load_dwordx4 v26, s[48:51], s68 offen  lds
  s_add_u32 m0, s56, 118784
  s_mov_b32 s68, 3735552
  buffer_load_dwordx4 v26, s[48:51], s68 offen  lds
  s_add_u32 m0, s56, 122880
  s_mov_b32 s68, 3932160
  buffer_load_dwordx4 v26, s[48:51], s68 offen  lds
  s_add_u32 m0, s56, 126976
  s_mov_b32 s68, 3997696
  buffer_load_dwordx4 v26, s[48:51], s68 offen  lds
  v_add_u32 v30, 0, v28
  v_add_u32 v31, 0, v29
  ds_read_b64_tr_b16 v[108:109], v30 offset:0
  ds_read_b64_tr_b16 v[110:111], v30 offset:512
  ds_read_b64_tr_b16 v[112:113], v30 offset:8192
  ds_read_b64_tr_b16 v[114:115], v30 offset:8704
  ds_read_b64_tr_b16 v[116:117], v31 offset:0
  ds_read_b64_tr_b16 v[118:119], v31 offset:512
  ds_read_b64_tr_b16 v[120:121], v31 offset:8192
  ds_read_b64_tr_b16 v[122:123], v31 offset:8704
  s_waitcnt lgkmcnt(0)
  s_barrier
  v_add_u32 v30, 0, v3
  ds_write_b128 v30, v[108:111] offset:0
  ds_write_b128 v30, v[112:115] offset:1024
  ds_write_b128 v30, v[116:119] offset:2048
  ds_write_b128 v30, v[120:123] offset:3072
  s_waitcnt lgkmcnt(0)
  s_waitcnt vmcnt(24)
  s_barrier
  v_add_u32 v30, 16384, v28
  v_add_u32 v31, 16384, v29
  ds_read_b64_tr_b16 v[108:109], v30 offset:0
  ds_read_b64_tr_b16 v[110:111], v30 offset:512
  ds_read_b64_tr_b16 v[112:113], v30 offset:8192
  ds_read_b64_tr_b16 v[114:115], v30 offset:8704
  ds_read_b64_tr_b16 v[116:117], v31 offset:0
  ds_read_b64_tr_b16 v[118:119], v31 offset:512
  ds_read_b64_tr_b16 v[120:121], v31 offset:8192
  ds_read_b64_tr_b16 v[122:123], v31 offset:8704
  s_waitcnt lgkmcnt(0)
  s_barrier
  v_add_u32 v30, 16384, v3
  ds_write_b128 v30, v[108:111] offset:0
  ds_write_b128 v30, v[112:115] offset:1024
  ds_write_b128 v30, v[116:119] offset:2048
  ds_write_b128 v30, v[120:123] offset:3072
  s_waitcnt lgkmcnt(0)
  s_waitcnt vmcnt(20)
  s_barrier
  v_add_u32 v30, 32768, v28
  v_add_u32 v31, 32768, v29
  ds_read_b64_tr_b16 v[108:109], v30 offset:0
  ds_read_b64_tr_b16 v[110:111], v30 offset:512
  ds_read_b64_tr_b16 v[112:113], v30 offset:8192
  ds_read_b64_tr_b16 v[114:115], v30 offset:8704
  ds_read_b64_tr_b16 v[116:117], v31 offset:0
  ds_read_b64_tr_b16 v[118:119], v31 offset:512
  ds_read_b64_tr_b16 v[120:121], v31 offset:8192
  ds_read_b64_tr_b16 v[122:123], v31 offset:8704
  s_waitcnt lgkmcnt(0)
  s_barrier
  v_add_u32 v30, 32768, v3
  ds_write_b128 v30, v[108:111] offset:0
  ds_write_b128 v30, v[112:115] offset:1024
  ds_write_b128 v30, v[116:119] offset:2048
  ds_write_b128 v30, v[120:123] offset:3072
  s_waitcnt lgkmcnt(0)
  s_waitcnt vmcnt(16)
  s_barrier
  v_add_u32 v30, 49152, v28
  v_add_u32 v31, 49152, v29
  ds_read_b64_tr_b16 v[108:109], v30 offset:0
  ds_read_b64_tr_b16 v[110:111], v30 offset:512
  ds_read_b64_tr_b16 v[112:113], v30 offset:8192
  ds_read_b64_tr_b16 v[114:115], v30 offset:8704
  ds_read_b64_tr_b16 v[116:117], v31 offset:0
  ds_read_b64_tr_b16 v[118:119], v31 offset:512
  ds_read_b64_tr_b16 v[120:121], v31 offset:8192
  ds_read_b64_tr_b16 v[122:123], v31 offset:8704
  s_waitcnt lgkmcnt(0)
  s_barrier
  v_add_u32 v30, 49152, v3
  ds_write_b128 v30, v[108:111] offset:0
  ds_write_b128 v30, v[112:115] offset:1024
  ds_write_b128 v30, v[116:119] offset:2048
  ds_write_b128 v30, v[120:123] offset:3072
  s_waitcnt lgkmcnt(0)
  s_waitcnt vmcnt(12)
  s_barrier
  v_add_u32 v30, 65536, v28
  v_add_u32 v31, 65536, v29
  ds_read_b64_tr_b16 v[108:109], v30 offset:0
  ds_read_b64_tr_b16 v[110:111], v30 offset:512
  ds_read_b64_tr_b16 v[112:113], v30 offset:8192
  ds_read_b64_tr_b16 v[114:115], v30 offset:8704
  ds_read_b64_tr_b16 v[116:117], v31 offset:0
  ds_read_b64_tr_b16 v[118:119], v31 offset:512
  ds_read_b64_tr_b16 v[120:121], v31 offset:8192
  ds_read_b64_tr_b16 v[122:123], v31 offset:8704
  s_waitcnt lgkmcnt(0)
  s_barrier
  v_add_u32 v30, 65536, v3
  ds_write_b128 v30, v[108:111] offset:0
  ds_write_b128 v30, v[112:115] offset:1024
  ds_write_b128 v30, v[116:119] offset:2048
  ds_write_b128 v30, v[120:123] offset:3072
  s_waitcnt lgkmcnt(0)
  s_waitcnt vmcnt(8)
  s_barrier
  v_add_u32 v30, 81920, v28
  v_add_u32 v31, 81920, v29
  ds_read_b64_tr_b16 v[108:109], v30 offset:0
  ds_read_b64_tr_b16 v[110:111], v30 offset:512
  ds_read_b64_tr_b16 v[112:113], v30 offset:8192
  ds_read_b64_tr_b16 v[114:115], v30 offset:8704
  ds_read_b64_tr_b16 v[116:117], v31 offset:0
  ds_read_b64_tr_b16 v[118:119], v31 offset:512
  ds_read_b64_tr_b16 v[120:121], v31 offset:8192
  ds_read_b64_tr_b16 v[122:123], v31 offset:8704
  s_waitcnt lgkmcnt(0)
  s_barrier
  v_add_u32 v30, 81920, v3
  ds_write_b128 v30, v[108:111] offset:0
  ds_write_b128 v30, v[112:115] offset:1024
  ds_write_b128 v30, v[116:119] offset:2048
  ds_write_b128 v30, v[120:123] offset:3072
  s_waitcnt lgkmcnt(0)
  s_waitcnt vmcnt(4)
  s_barrier
  v_add_u32 v30, 98304, v28
  v_add_u32 v31, 98304, v29
  ds_read_b64_tr_b16 v[108:109], v30 offset:0
  ds_read_b64_tr_b16 v[110:111], v30 offset:512
  ds_read_b64_tr_b16 v[112:113], v30 offset:8192
  ds_read_b64_tr_b16 v[114:115], v30 offset:8704
  ds_read_b64_tr_b16 v[116:117], v31 offset:0
  ds_read_b64_tr_b16 v[118:119], v31 offset:512
  ds_read_b64_tr_b16 v[120:121], v31 offset:8192
  ds_read_b64_tr_b16 v[122:123], v31 offset:8704
  s_waitcnt lgkmcnt(0)
  s_barrier
  v_add_u32 v30, 98304, v3
  ds_write_b128 v30, v[108:111] offset:0
  ds_write_b128 v30, v[112:115] offset:1024
  ds_write_b128 v30, v[116:119] offset:2048
  ds_write_b128 v30, v[120:123] offset:3072
  s_waitcnt lgkmcnt(0)
  s_waitcnt vmcnt(0)
  s_barrier
  v_add_u32 v30, 114688, v28
  v_add_u32 v31, 114688, v29
  ds_read_b64_tr_b16 v[108:109], v30 offset:0
  ds_read_b64_tr_b16 v[110:111], v30 offset:512
  ds_read_b64_tr_b16 v[112:113], v30 offset:8192
  ds_read_b64_tr_b16 v[114:115], v30 offset:8704
  ds_read_b64_tr_b16 v[116:117], v31 offset:0
  ds_read_b64_tr_b16 v[118:119], v31 offset:512
  ds_read_b64_tr_b16 v[120:121], v31 offset:8192
  ds_read_b64_tr_b16 v[122:123], v31 offset:8704
  s_waitcnt lgkmcnt(0)
  s_barrier
  v_add_u32 v30, 114688, v3
  ds_write_b128 v30, v[108:111] offset:0
  ds_write_b128 v30, v[112:115] offset:1024
  ds_write_b128 v30, v[116:119] offset:2048
  ds_write_b128 v30, v[120:123] offset:3072
  s_waitcnt lgkmcnt(0)
  s_lshl_b32 s68, s44, 15
  v_add_u32 v3, s68, v3
  v_and_b32 v22, 1, v0
  v_cmp_eq_u32 vcc, 1, v22
  v_mov_b32 v23, 0x44444444
  v_mov_b32 v24, 0xeeeeeeee
  v_cndmask_b32 v1, v23, v24, vcc
  s_mov_b32 s48, s22
  s_and_b32 s49, s23, 0xffff
  s_mov_b32 s50, 0x2000
  s_mov_b32 s51, 0x20000
  v_bfe_u32 v22, v0, 1, 3
  v_lshlrev_b32 v23, 10, v22
  v_lshrrev_b32 v22, 5, v0
  v_lshl_add_u32 v23, v22, 6, v23
  v_bfe_u32 v22, v0, 4, 1
  v_lshl_add_u32 v23, v22, 4, v23
  v_and_b32 v22, 1, v0
  v_lshl_add_u32 v23, v22, 3, v23
  s_lshl_b32 s68, s44, 8
  buffer_load_dwordx2 v[92:93], v23, s[48:51], s68 offen
  buffer_load_dwordx2 v[94:95], v23, s[48:51], s68 offen offset:32
  buffer_load_dwordx2 v[96:97], v23, s[48:51], s68 offen offset:128
  buffer_load_dwordx2 v[98:99], v23, s[48:51], s68 offen offset:160
  v_lshlrev_b32 v0, 4, v0
  v_add_u32 v0, 147456, v0
  s_mov_b32 s68, 0x05040100
  s_mov_b32 s69, 0x07060302
  s_waitcnt vmcnt(0)
  v_perm_b32 v20, v94, v92, s68
  v_perm_b32 v21, v94, v92, s69
  v_perm_b32 v22, v95, v93, s68
  v_perm_b32 v23, v95, v93, s69
  v_min_u32 v20, -2, v20
  v_min_u32 v21, -2, v21
  v_min_u32 v22, -2, v22
  v_min_u32 v23, -2, v23
  v_perm_b32 v24, v98, v96, s68
  v_perm_b32 v25, v98, v96, s69
  v_perm_b32 v26, v99, v97, s68
  v_perm_b32 v27, v99, v97, s69
  v_min_u32 v24, -2, v24
  v_min_u32 v25, -2, v25
  v_min_u32 v26, -2, v26
  v_min_u32 v27, -2, v27
L_team_init:
  buffer_load_dword v52, v17, s[52:55], 0 offen sc1
  s_add_u32 s67, s67, 1
  s_cmp_gt_u32 s67, 1048576
  s_cbranch_scc1 L_exit
  s_waitcnt vmcnt(0)
  v_cmp_gt_u32 vcc, 32, v52
  s_cbranch_vccnz L_team_init
  buffer_load_dword v52, v17, s[52:55], 0 offen offset:128 sc1
  s_mov_b32 s92, 2
L_fs_pre:
  buffer_load_dword v4, v17, s[40:43], s60 offen sc1
  s_add_u32 s67, s67, 1
  s_cmp_gt_u32 s67, 1048576
  s_cbranch_scc1 L_exit
  s_waitcnt vmcnt(0)
  v_cmp_gt_u32 vcc, s92, v4
  s_cbranch_vccnz L_fs_pre
  v_readfirstlane_b32 s69, v52
  s_mov_b32 m0, s70
  s_mov_b32 s57, s72
  buffer_load_dwordx4 v2, s[40:43], s57 offen sc1 lds
  buffer_load_dwordx4 v2, s[40:43], s57 offen offset:1024 sc1 lds
  s_mov_b32 s56, -1
  s_mov_b32 s65, 0
  s_mov_b32 s7, 0
  s_lshl_b32 s61, s45, 12
  s_lshl_b32 s68, s44, 10
  s_sub_u32 s61, s61, s68
  s_add_u32 s61, s61, 0xbfc0000
  s_max_i32 s93, s56, 0
  s_add_u32 s56, s56, 1
  s_xor_b32 s65, s65, 1
  s_add_u32 s58, s57, 0x1000000
  s_add_u32 s68, s56, 1
  s_min_u32 s68, s68, 63
  s_lshl_b32 s68, s68, 13
  s_add_u32 s57, s72, s68
  s_add_u32 s59, s57, s73
  s_add_u32 s68, s56, 3
  s_min_u32 s92, s68, 64
  s_add_u32 s61, s61, 0x20000
  s_xor_b32 s70, s70, 0x2000
  ds_read_b128 v[76:79], v3 offset:0
  ds_read_b128 v[80:83], v3 offset:1024
  ds_read_b128 v[84:87], v3 offset:2048
  ds_read_b128 v[88:91], v3 offset:3072
  ds_read_b128 v[92:95], v3 offset:16384
  ds_read_b128 v[96:99], v3 offset:17408
  ds_read_b128 v[100:103], v3 offset:18432
  ds_read_b128 v[104:107], v3 offset:19456
  v_xor_b32 v3, 0x8000, v3
  ds_read_b128 v[108:111], v3 offset:0
  ds_read_b128 v[112:115], v3 offset:1024
  ds_read_b128 v[116:119], v3 offset:2048
  ds_read_b128 v[120:123], v3 offset:3072
  v_mov_b64 v[52:53], 0
  v_mov_b64 v[54:55], 0
  v_mov_b64 v[56:57], 0
  v_mov_b64 v[58:59], 0
  v_mov_b64 v[60:61], 0
  v_mov_b64 v[62:63], 0
  v_mov_b64 v[64:65], 0
  v_mov_b64 v[66:67], 0
  v_mov_b64 v[68:69], 0
  v_mov_b64 v[70:71], 0
  v_mov_b64 v[72:73], 0
  v_mov_b64 v[74:75], 0
  s_waitcnt vmcnt(0) lgkmcnt(0)
  v_xor_b32 v32, 2048, v11
  v_xor_b32 v40, 4096, v11
  v_xor_b32 v48, 6144, v11
  v_bfe_u32 v45, v2, 9, 1
  v_and_b32 v4, 0x1ff, v2
  v_lshlrev_b32 v4, 2, v4
  v_lshl_add_u32 v4, v45, 24, v4
  s_sub_u32 s68, s60, s59
  v_mov_b32 v16, s93
  v_writelane_b32 v4, s68, 1
  s_bcnt1_i32_b32 s69, s69
  s_cmp_eq_u32 s69, 1
  s_cbranch_scc0 L_entry_x
  s_branch L_entry_f
L_poll2_f:
  buffer_load_dwordx4 v[20:23], v11, s[40:43], s63 offen sc1
  buffer_load_dwordx4 v[24:27], v11, s[40:43], s63 offen offset:1024 sc1
  s_nop 15
  s_nop 6
  buffer_load_dwordx4 v[28:31], v11, s[40:43], s63 offen sc1
  buffer_load_dwordx4 v[36:39], v11, s[40:43], s63 offen offset:1024 sc1
  v_readlane_b32 s69, v4, 1
  v_xor_b32 v10, 0x2000, v10
  s_waitcnt vmcnt(5)
  v_xor_b32 v32, 2048, v11
  v_xor_b32 v40, 4096, v11
  v_xor_b32 v48, 6144, v11
  s_cmp_lt_u32 s69, s92
  s_cbranch_scc1 L_fs_f
L_fsback_f:
  s_max_i32 s93, s56, 0
  s_add_u32 s56, s56, 1
  s_xor_b32 s65, s65, 1
  s_add_u32 s58, s57, 0x1000000
  s_add_u32 s68, s56, 1
  s_min_u32 s68, s68, 63
  s_lshl_b32 s68, s68, 13
  s_add_u32 s57, s72, s68
  s_add_u32 s59, s57, s73
  s_add_u32 s68, s56, 3
  s_min_u32 s92, s68, 64
  s_add_u32 s61, s61, 0x20000
  s_xor_b32 s70, s70, 0x2000
  v_bfe_u32 v45, v2, 9, 1
  v_and_b32 v4, 0x1ff, v2
  v_lshlrev_b32 v4, 2, v4
  v_lshl_add_u32 v4, v45, 24, v4
  s_sub_u32 s68, s60, s59
  v_mov_b32 v16, s93
  v_writelane_b32 v4, s68, 1
L_entry_f:
  s_waitcnt vmcnt(3)
  ds_write_b128 v11, v[20:23]
  v_smfmac_f32_16x16x64_bf16 v[52:55], v[20:23], a[0:7], v1
  s_waitcnt vmcnt(2)
  ds_write_b128 v11, v[24:27] offset:1024
  v_max3_u32 v44, v20, v21, v22
  v_max3_u32 v44, v44, v23, v24
  v_max3_u32 v44, v44, v25, v26
  v_max_u32 v44, v44, v27
  v_cmp_eq_u32 vcc, -1, v44
  v_smfmac_f32_16x16x64_bf16 v[56:59], v[20:23], a[64:71], v1
  s_mov_b32 m0, s71
  v_smfmac_f32_16x16x64_bf16 v[52:55], v[24:27], a[8:15], v1
  s_cbranch_vccnz L_retry2_f
  v_smfmac_f32_16x16x64_bf16 v[56:59], v[24:27], a[72:79], v1
  v_smfmac_f32_16x16x64_bf16 v[60:63], v[20:23], a[128:135], v1
  v_smfmac_f32_16x16x64_bf16 v[64:67], v[20:23], a[192:199], v1
  v_smfmac_f32_16x16x64_bf16 v[60:63], v[24:27], a[136:143], v1
  s_waitcnt vmcnt(0) lgkmcnt(0)
  s_barrier
  ds_read_b128 v[28:31], v32 offset:0
  v_smfmac_f32_16x16x64_bf16 v[64:67], v[24:27], a[200:207], v1
  ds_read_b128 v[32:35], v32 offset:1024
  ds_read_b128 v[36:39], v40 offset:0
  v_smfmac_f32_16x16x64_bf16 v[68:71], v[20:23], v[76:83], v1
  ds_read_b128 v[40:43], v40 offset:1024
  ds_read_b128 v[44:47], v48 offset:0
  v_smfmac_f32_16x16x64_bf16 v[72:75], v[20:23], v[84:91], v1
  ds_read_b128 v[48:51], v48 offset:1024
  buffer_load_dwordx4 v2, s[40:43], s58 offen offset:0 sc1 lds
  v_smfmac_f32_16x16x64_bf16 v[68:71], v[24:27], v[92:99], v1
  buffer_load_dwordx4 v2, s[40:43], s58 offen offset:1024 sc1 lds
  v_smfmac_f32_16x16x64_bf16 v[72:75], v[24:27], v[100:107], v1
  s_waitcnt lgkmcnt(5)
  ds_read_b128 v[76:79], v3 offset:16384
  v_smfmac_f32_16x16x64_bf16 v[52:55], v[28:31], a[16:23], v1
  s_waitcnt lgkmcnt(5)
  ds_read_b128 v[80:83], v3 offset:17408
  buffer_load_dword v4, v4, s[40:43], s59 offen sc1
  v_smfmac_f32_16x16x64_bf16 v[52:55], v[32:35], a[24:31], v1
  s_waitcnt lgkmcnt(5)
  ds_read_b128 v[84:87], v3 offset:18432
  buffer_store_dwordx4 v[124:127], v2, s[40:43], s61 offen sc1
  v_smfmac_f32_16x16x64_bf16 v[52:55], v[36:39], a[32:39], v1
  s_waitcnt lgkmcnt(5)
  ds_read_b128 v[88:91], v3 offset:19456
  v_xor_b32 v3, 0x18000, v3
  v_smfmac_f32_16x16x64_bf16 v[52:55], v[40:43], a[40:47], v1
  s_waitcnt lgkmcnt(4)
  ds_read_b128 v[92:95], v0 offset:0
  v_smfmac_f32_16x16x64_bf16 v[52:55], v[44:47], a[48:55], v1
  ds_read_b128 v[96:99], v0 offset:2048
  buffer_store_dword v16, v17, s[40:43], s66 offen sc1
  v_smfmac_f32_16x16x64_bf16 v[52:55], v[48:51], a[56:63], v1
  s_nop 0
  ds_read_b128 v[100:103], v0 offset:4096
  v_smfmac_f32_16x16x64_bf16 v[68:71], v[28:31], v[108:115], v1
  s_mov_b32 m0, s70
  ds_read_b128 v[104:107], v0 offset:6144
  v_smfmac_f32_16x16x64_bf16 v[56:59], v[28:31], a[80:87], v1
  s_nop 0
  ds_read_b128 v[108:111], v3 offset:0
  v_add_f32 v52, v52, v53
  v_smfmac_f32_16x16x64_bf16 v[56:59], v[32:35], a[88:95], v1
  ds_read_b128 v[112:115], v3 offset:1024
  v_add_f32 v54, v54, v55
  v_smfmac_f32_16x16x64_bf16 v[72:75], v[28:31], v[116:123], v1
  ds_read_b128 v[20:23], v0 offset:1024
  v_mul_f32 v52, s88, v52
  v_smfmac_f32_16x16x64_bf16 v[56:59], v[36:39], a[96:103], v1
  ds_read_b128 v[116:119], v3 offset:2048
  v_mul_f32 v54, s88, v54
  v_smfmac_f32_16x16x64_bf16 v[56:59], v[40:43], a[104:111], v1
  ds_read_b128 v[120:123], v3 offset:3072
  v_cvt_pk_bf16_f32 v52, v52, v52
  v_smfmac_f32_16x16x64_bf16 v[56:59], v[44:47], a[112:119], v1
  ds_read_b128 v[24:27], v0 offset:3072
  v_cvt_pk_bf16_f32 v53, v54, v54
  v_smfmac_f32_16x16x64_bf16 v[56:59], v[48:51], a[120:127], v1
  s_waitcnt lgkmcnt(10)
  ds_write_b64 v5, v[52:53] offset:0
  v_smfmac_f32_16x16x64_bf16 v[68:71], v[32:35], v[76:83], v1
  s_nop 0
  s_nop 0
  v_smfmac_f32_16x16x64_bf16 v[72:75], v[32:35], v[84:91], v1
  s_nop 0
  ds_read_b128 v[76:79], v3 offset:16384
  v_add_f32 v56, v56, v57
  v_smfmac_f32_16x16x64_bf16 v[60:63], v[28:31], a[144:151], v1
  ds_read_b128 v[80:83], v3 offset:17408
  v_add_f32 v58, v58, v59
  v_smfmac_f32_16x16x64_bf16 v[60:63], v[32:35], a[152:159], v1
  s_waitcnt lgkmcnt(4)
  ds_read_b128 v[84:87], v3 offset:18432
  v_mul_f32 v56, s88, v56
  v_smfmac_f32_16x16x64_bf16 v[68:71], v[36:39], v[108:115], v1
  ds_read_b128 v[88:91], v3 offset:19456
  v_mul_f32 v58, s88, v58
  v_smfmac_f32_16x16x64_bf16 v[60:63], v[36:39], a[160:167], v1
  v_cvt_pk_bf16_f32 v56, v56, v56
  v_smfmac_f32_16x16x64_bf16 v[72:75], v[36:39], v[116:123], v1
  v_cvt_pk_bf16_f32 v57, v58, v58
  v_smfmac_f32_16x16x64_bf16 v[60:63], v[40:43], a[168:175], v1
  ds_write_b64 v5, v[56:57] offset:2048
  v_xor_b32 v3, 0x8000, v3
  v_smfmac_f32_16x16x64_bf16 v[60:63], v[44:47], a[176:183], v1
  ds_read_b128 v[108:111], v3 offset:0
  v_smfmac_f32_16x16x64_bf16 v[60:63], v[48:51], a[184:191], v1
  s_waitcnt lgkmcnt(2)
  ds_read_b128 v[112:115], v3 offset:1024
  v_smfmac_f32_16x16x64_bf16 v[68:71], v[40:43], v[76:83], v1
  s_nop 0
  ds_read_b128 v[116:119], v3 offset:16384
  v_smfmac_f32_16x16x64_bf16 v[72:75], v[40:43], v[84:91], v1
  s_nop 0
  ds_read_b128 v[120:123], v3 offset:17408
  v_add_f32 v60, v60, v61
  v_smfmac_f32_16x16x64_bf16 v[64:67], v[28:31], a[208:215], v1
  s_waitcnt lgkmcnt(4)
  s_barrier
  v_add_f32 v62, v62, v63
  v_smfmac_f32_16x16x64_bf16 v[64:67], v[32:35], a[216:223], v1
  ds_read_b64_tr_b16 v[76:77], v6 offset:0
  ds_read_b64_tr_b16 v[78:79], v6 offset:2048
  v_smfmac_f32_16x16x64_bf16 v[64:67], v[36:39], a[224:231], v1
  ds_read_b64_tr_b16 v[80:81], v6 offset:512
  ds_read_b64_tr_b16 v[82:83], v6 offset:2560
  v_smfmac_f32_16x16x64_bf16 v[64:67], v[40:43], a[232:239], v1
  ds_read_b64_tr_b16 v[84:85], v6 offset:1024
  ds_read_b64_tr_b16 v[86:87], v6 offset:3072
  v_smfmac_f32_16x16x64_bf16 v[64:67], v[44:47], a[240:247], v1
  ds_read_b64_tr_b16 v[88:89], v6 offset:1536
  ds_read_b64_tr_b16 v[90:91], v6 offset:3584
  v_smfmac_f32_16x16x64_bf16 v[64:67], v[48:51], a[248:255], v1
  s_waitcnt lgkmcnt(8)
  ds_read_b128 v[28:31], v0 offset:5120
  v_cvt_pk_bf16_f32 v124, v60, v62
  v_smfmac_f32_16x16x64_bf16 v[68:71], v[44:47], v[108:115], v1
  s_nop 0
  ds_read_b128 v[32:35], v0 offset:7168
  v_smfmac_f32_16x16x64_bf16 v[68:71], v[48:51], v[116:123], v1
  s_waitcnt lgkmcnt(2)
  ds_read_b128 v[108:111], v3 offset:2048
  v_add_f32 v64, v64, v65
  v_mfma_f32_16x16x32_bf16 v[52:55], v[92:95], v[76:79], 0
  v_add_f32 v66, v66, v67
  v_cvt_pk_bf16_f32 v125, v64, v66
  v_mfma_f32_16x16x32_bf16 v[52:55], v[96:99], v[80:83], v[52:55]
  s_waitcnt vmcnt(3)
  ds_write2st64_b32 v5, v124, v125 offset0:16 offset1:24
  v_add_f32 v68, v68, v69
  v_mfma_f32_16x16x32_bf16 v[52:55], v[100:103], v[84:87], v[52:55]
  ds_read_b128 v[112:115], v3 offset:3072
  v_add_f32 v70, v70, v71
  v_mfma_f32_16x16x32_bf16 v[52:55], v[104:107], v[88:91], v[52:55]
  s_waitcnt lgkmcnt(3)
  ds_read_b128 v[116:119], v3 offset:18432
  v_cvt_pk_bf16_f32 v126, v68, v70
  v_mfma_f32_16x16x32_bf16 v[56:59], v[20:23], v[76:79], 0
  ds_read_b128 v[120:123], v3 offset:19456
  v_mfma_f32_16x16x32_bf16 v[56:59], v[24:27], v[80:83], v[56:59]
  ds_read_b128 v[36:39], v2 offset:8192
  ds_read_b128 v[40:43], v2 offset:9216
  v_mfma_f32_16x16x32_bf16 v[56:59], v[28:31], v[84:87], v[56:59]
  s_waitcnt lgkmcnt(5)
  s_barrier
  ds_read_b64_tr_b16 v[92:93], v6 offset:4096
  ds_read_b64_tr_b16 v[94:95], v6 offset:6144
  v_mfma_f32_16x16x32_bf16 v[56:59], v[32:35], v[88:91], v[56:59]
  s_waitcnt lgkmcnt(4)
  ds_read_b64_tr_b16 v[96:97], v6 offset:4608
  ds_read_b64_tr_b16 v[98:99], v6 offset:6656
  v_smfmac_f32_16x16x64_bf16 v[72:75], v[44:47], v[108:115], v1
  ds_read_b64_tr_b16 v[100:101], v6 offset:5120
  ds_read_b64_tr_b16 v[102:103], v6 offset:7168
  v_smfmac_f32_16x16x64_bf16 v[72:75], v[48:51], v[116:123], v1
  ds_read_b64_tr_b16 v[104:105], v6 offset:5632
  ds_read_b64_tr_b16 v[106:107], v6 offset:7680
  v_exp_f32 v20, v52
  v_exp_f32 v21, v53
  v_exp_f32 v22, v54
  s_waitcnt lgkmcnt(4)
  v_mfma_f32_16x16x32_bf16 v[60:63], v[92:95], v[76:79], 0
  v_exp_f32 v23, v55
  v_mfma_f32_16x16x32_bf16 v[60:63], v[96:99], v[80:83], v[60:63]
  s_waitcnt lgkmcnt(0)
  v_exp_f32 v28, v56
  v_mfma_f32_16x16x32_bf16 v[60:63], v[100:103], v[84:87], v[60:63]
  v_exp_f32 v29, v57
  v_mfma_f32_16x16x32_bf16 v[60:63], v[104:107], v[88:91], v[60:63]
  s_cmp_eq_u32 s56, 63
  v_exp_f32 v30, v58
  v_exp_f32 v31, v59
  v_cvt_pk_bf16_f32 v24, v20, v21
  v_cvt_pk_bf16_f32 v25, v22, v23
  v_cvt_pk_bf16_f32 v26, v28, v29
  v_cvt_pk_bf16_f32 v27, v30, v31
  v_add_f32 v72, v72, v73
  v_exp_f32 v20, v60
  v_mfma_f32_16x16x32_bf16 v[64:67], v[12:15], v[24:27], 0
  v_exp_f32 v21, v61
  v_mfma_f32_16x16x32_bf16 v[80:83], v[36:39], v[24:27], 0
  v_add_f32 v74, v74, v75
  v_cvt_pk_bf16_f32 v16, v20, v21
  v_mfma_f32_16x16x32_bf16 v[84:87], v[40:43], v[24:27], 0
  v_cvt_pk_bf16_f32 v127, v72, v74
  v_cvt_pk_bf16_f32 v19, v20, v21
  v_mfma_f32_16x16x16_bf16 v[64:67], v[12:13], v[16:17], v[64:67]
  s_cbranch_scc1 L_team_last
  v_xor_b32 v3, 0x18000, v3
  v_mov_b64 v[44:45], 0
  v_mfma_f32_16x16x16_bf16 v[80:83], v[126:127], v[16:17], v[80:83]
  s_nop 0
  v_mov_b64 v[46:47], 0
  v_mov_b64 v[48:49], 0
  v_mfma_f32_16x16x16_bf16 v[84:87], v[126:127], v[18:19], v[84:87]
  v_rcp_f32 v65, v64
  v_subrev_u32 v66, s89, v64
  v_cmp_le_u32 vcc, s91, v66
  v_mov_b64 v[50:51], 0
L_smback_f:
  v_mul_f32 v80, v80, v65
  v_mul_f32 v81, v81, v65
  v_mul_f32 v82, v82, v65
  v_mul_f32 v83, v83, v65
  v_cvt_pk_bf16_f32 v88, v80, v81
  v_cvt_pk_bf16_f32 v89, v82, v83
  ds_write_b64 v7, v[88:89]
  v_mul_f32 v84, v84, v65
  v_mul_f32 v85, v85, v65
  v_mul_f32 v86, v86, v65
  v_mul_f32 v87, v87, v65
  v_cvt_pk_bf16_f32 v90, v84, v85
  v_cvt_pk_bf16_f32 v91, v86, v87
  s_cbranch_vccnz L_smslow_f
  ds_write_b64 v7, v[90:91] offset:8
  v_xor_b32 v96, 512, v7
  v_xor_b32 v100, 1024, v7
  v_xor_b32 v104, 1536, v7
  v_mov_b64 v[36:37], 0
  v_mov_b64 v[38:39], 0
  v_mov_b64 v[40:41], 0
  v_mov_b64 v[42:43], 0
  v_lshrrev_b32 v24, 16, v12
  v_cndmask_b32 v24, v24, 1.0, s[94:95]
  v_cndmask_b32 v20, 0, v24, s[80:81]
  v_cndmask_b32 v21, 0, v24, s[82:83]
  v_cndmask_b32 v22, 0, v24, s[84:85]
  v_cndmask_b32 v23, 0, v24, s[86:87]
  v_smfmac_f32_16x16x64_bf16 v[48:51], v[88:91], v[224:231], v1
  s_waitcnt lgkmcnt(0)
  s_barrier
  ds_read_b128 v[96:99], v96
  v_smfmac_f32_16x16x64_bf16 v[44:47], v[88:91], v[192:199], v1
  ds_read_b128 v[100:103], v100
  ds_read_b128 v[104:107], v104
  v_smfmac_f32_16x16x64_bf16 v[40:43], v[88:91], v[160:167], v1
  buffer_load_dwordx4 v2, s[40:43], s57 offen offset:0 sc1 lds
  v_mov_b64 v[60:61], 0
  v_smfmac_f32_16x16x64_bf16 v[36:39], v[88:91], v[128:135], v1
  buffer_load_dwordx4 v2, s[40:43], s57 offen offset:1024 sc1 lds
  v_mov_b64 v[62:63], 0
  v_mov_b64 v[64:65], 0
  v_mov_b64 v[66:67], 0
  s_waitcnt lgkmcnt(2)
  v_smfmac_f32_16x16x64_bf16 v[36:39], v[96:99], v[136:143], v1
  s_waitcnt lgkmcnt(1)
  v_mov_b64 v[52:53], 0
  v_smfmac_f32_16x16x64_bf16 v[36:39], v[100:103], v[144:151], v1
  s_waitcnt lgkmcnt(0)
  v_mov_b64 v[54:55], 0
  v_smfmac_f32_16x16x64_bf16 v[36:39], v[104:107], v[152:159], v1
  s_nop 1
  v_mov_b64 v[56:57], 0
  v_smfmac_f32_16x16x64_bf16 v[40:43], v[96:99], v[168:175], v1
  s_nop 1
  v_mov_b64 v[58:59], 0
  v_smfmac_f32_16x16x64_bf16 v[40:43], v[100:103], v[176:183], v1
  v_cvt_pk_bf16_f32 v36, v36, v37
  v_cvt_pk_bf16_f32 v37, v38, v39
  v_and_or_b32 v36, v36, -2, s65
  v_smfmac_f32_16x16x64_bf16 v[40:43], v[104:107], v[184:191], v1
  s_nop 1
  buffer_store_dwordx2 v[36:37], v8, s[40:43], s74 offen
  v_smfmac_f32_16x16x64_bf16 v[44:47], v[96:99], v[200:207], v1
  s_nop 2
  v_smfmac_f32_16x16x64_bf16 v[44:47], v[100:103], v[208:215], v1
  v_cvt_pk_bf16_f32 v40, v40, v41
  v_cvt_pk_bf16_f32 v41, v42, v43
  v_and_or_b32 v40, v40, -2, s65
  v_smfmac_f32_16x16x64_bf16 v[44:47], v[104:107], v[216:223], v1
  s_nop 1
  buffer_store_dwordx2 v[40:41], v8, s[40:43], s75 offen
  v_smfmac_f32_16x16x64_bf16 v[48:51], v[96:99], v[232:239], v1
  s_nop 2
  v_smfmac_f32_16x16x64_bf16 v[48:51], v[100:103], v[240:247], v1
  v_cvt_pk_bf16_f32 v44, v44, v45
  v_cvt_pk_bf16_f32 v45, v46, v47
  v_and_or_b32 v44, v44, -2, s65
  v_smfmac_f32_16x16x64_bf16 v[48:51], v[104:107], v[248:255], v1
  s_nop 1
  buffer_store_dwordx2 v[44:45], v8, s[40:43], s76 offen
  s_nop 4
  v_cvt_pk_bf16_f32 v48, v48, v49
  v_cvt_pk_bf16_f32 v49, v50, v51
  v_and_or_b32 v48, v48, -2, s65
  buffer_store_dwordx2 v[48:49], v8, s[40:43], s77 offen
  s_nop 15
  s_nop 9
  s_cmp_lt_u32 s44, 1
  s_cbranch_scc1 L_poll1_f
  s_nop 9
  s_cmp_lt_u32 s44, 2
  s_cbranch_scc1 L_poll1_f
  s_nop 9
  s_cmp_lt_u32 s44, 3
  s_cbranch_scc1 L_poll1_f
  s_nop 9
L_poll1_f:
  buffer_load_dwordx4 v[28:31], v9, s[40:43], s62 offen sc1
  buffer_load_dwordx4 v[32:35], v9, s[40:43], s62 offen offset:1024 sc1
  v_mov_b64 v[64:65], 0
  v_mov_b64 v[66:67], 0
  v_mov_b64 v[68:69], 0
  v_mov_b64 v[70:71], 0
  v_mov_b64 v[72:73], 0
  v_mov_b64 v[74:75], 0
  v_xor_b32 v11, 0x2000, v11
  v_xor_b32 v0, 0x2000, v0
  s_nop 15
  s_nop 3
  buffer_load_dwordx4 v[36:39], v9, s[40:43], s62 offen sc1
  buffer_load_dwordx4 v[40:43], v9, s[40:43], s62 offen offset:1024 sc1
  ds_read_b128 v[76:79], v3 offset:0
  ds_read_b128 v[80:83], v3 offset:1024
  ds_read_b128 v[84:87], v3 offset:2048
  ds_read_b128 v[88:91], v3 offset:3072
  ds_read_b128 v[92:95], v3 offset:16384
  ds_read_b128 v[96:99], v3 offset:17408
  ds_read_b128 v[100:103], v3 offset:18432
  ds_read_b128 v[104:107], v3 offset:19456
  v_xor_b32 v3, 0x8000, v3
  ds_read_b128 v[108:111], v3 offset:0
  ds_read_b128 v[112:115], v3 offset:1024
  ds_read_b128 v[116:119], v3 offset:2048
  ds_read_b128 v[120:123], v3 offset:3072
L_poll1b_f:
  s_waitcnt vmcnt(3)
  v_mfma_f32_16x16x32_bf16 v[24:27], v[28:31], v[20:23], 0
  v_bitop3_b32 v44, v28, v30, s65 bitop3:0x7e
  s_waitcnt vmcnt(2)
  v_mfma_f32_16x16x32_bf16 v[24:27], v[32:35], v[20:23], v[24:27]
  v_bitop3_b32 v45, v32, v34, s65 bitop3:0x7e
  v_or_b32 v44, v44, v45
  v_and_b32 v44, 1, v44
  v_cmp_ne_u32 vcc, 0, v44
  s_nop 2
  s_cbranch_vccnz L_retry1_f
L_got1_f:
  v_add_f32 v24, v24, v25
  v_add_f32 v26, v26, v27
  s_nop 1
  v_permlane16_swap_b32 v24, v26
  v_add_f32 v24, v24, v26
  v_cvt_pk_bf16_f32 v24, v24, v17
  v_min_u32 v24, s90, v24
  v_cndmask_b32 v24, v24, -1, s[78:79]
  buffer_store_short v24, v10, s[40:43], s64 offen
  s_nop 15
  s_nop 15
  s_nop 15
  s_nop 1
  s_branch L_poll2_f
L_retry2_f:
  s_waitcnt vmcnt(0)
  v_max3_u32 v44, v28, v29, v30
  v_max3_u32 v45, v31, v36, v37
  v_max3_u32 v44, v44, v38, v39
  v_max_u32 v44, v44, v45
  v_cmp_eq_u32 vcc, -1, v44
  v_mov_b64 v[20:21], v[28:29]
  v_mov_b64 v[22:23], v[30:31]
  v_mov_b64 v[24:25], v[36:37]
  v_mov_b64 v[26:27], v[38:39]
  v_mov_b64 v[52:53], 0
  v_mov_b64 v[54:55], 0
  v_mov_b64 v[56:57], 0
  v_mov_b64 v[58:59], 0
  s_cbranch_vccz L_entry_f
  buffer_load_dwordx4 v[20:23], v11, s[40:43], s63 offen sc1
  buffer_load_dwordx4 v[24:27], v11, s[40:43], s63 offen offset:1024 sc1
  s_add_u32 s67, s67, 1
  s_cmp_gt_u32 s67, 1048576
  s_cbranch_scc1 L_exit
  s_nop 15
  s_nop 3
  buffer_load_dwordx4 v[28:31], v11, s[40:43], s63 offen sc1
  buffer_load_dwordx4 v[36:39], v11, s[40:43], s63 offen offset:1024 sc1
  s_branch L_entry_f
L_retry1_f:
  buffer_load_dwordx4 v[28:31], v9, s[40:43], s62 offen sc1
  buffer_load_dwordx4 v[32:35], v9, s[40:43], s62 offen offset:1024 sc1
  s_waitcnt vmcnt(3)
  v_mfma_f32_16x16x32_bf16 v[24:27], v[36:39], v[20:23], 0
  v_bitop3_b32 v44, v36, v38, s65 bitop3:0x7e
  s_waitcnt vmcnt(2)
  v_mfma_f32_16x16x32_bf16 v[24:27], v[40:43], v[20:23], v[24:27]
  v_bitop3_b32 v45, v40, v42, s65 bitop3:0x7e
  v_or_b32 v44, v44, v45
  v_and_b32 v44, 1, v44
  v_cmp_ne_u32 vcc, 0, v44
  s_nop 2
  s_cbranch_vccnz L_retry1b_f
  v_add_f32 v24, v24, v25
  v_add_f32 v26, v26, v27
  s_nop 1
  v_permlane16_swap_b32 v24, v26
  v_add_f32 v24, v24, v26
  v_cvt_pk_bf16_f32 v24, v24, v17
  v_min_u32 v24, s90, v24
  v_cndmask_b32 v24, v24, -1, s[78:79]
  buffer_store_short v24, v10, s[40:43], s64 offen
  s_nop 15
  s_nop 15
  s_nop 15
  s_nop 1
  s_branch L_poll2_f
L_retry1b_f:
  buffer_load_dwordx4 v[36:39], v9, s[40:43], s62 offen sc1
  buffer_load_dwordx4 v[40:43], v9, s[40:43], s62 offen offset:1024 sc1
  s_add_u32 s67, s67, 1
  s_cmp_gt_u32 s67, 1048576
  s_cbranch_scc1 L_exit
  s_branch L_poll1b_f
L_smslow_f:
  v_max3_f32 v22, v52, v53, v54
  v_max3_f32 v22, v22, v55, v56
  v_max3_f32 v22, v22, v57, v58
  v_max3_f32 v22, v22, v59, v60
  v_max_f32 v22, v22, v61
  v_mov_b32 v20, v22
  s_nop 1
  v_permlane32_swap_b32 v20, v22
  v_max_f32 v22, v22, v20
  v_mov_b32 v20, v22
  s_nop 1
  v_permlane16_swap_b32 v20, v22
  v_max_f32 v22, v22, v20
  v_sub_f32 v20, v52, v22
  v_sub_f32 v21, v53, v22
  v_exp_f32 v20, v20
  v_exp_f32 v21, v21
  s_nop 0
  v_cvt_pk_bf16_f32 v24, v20, v21
  v_sub_f32 v20, v54, v22
  v_sub_f32 v21, v55, v22
  v_exp_f32 v20, v20
  v_exp_f32 v21, v21
  s_nop 0
  v_cvt_pk_bf16_f32 v25, v20, v21
  v_sub_f32 v20, v56, v22
  v_sub_f32 v21, v57, v22
  v_exp_f32 v20, v20
  v_exp_f32 v21, v21
  s_nop 0
  v_cvt_pk_bf16_f32 v26, v20, v21
  v_sub_f32 v20, v58, v22
  v_sub_f32 v21, v59, v22
  v_exp_f32 v20, v20
  v_exp_f32 v21, v21
  s_nop 0
  v_cvt_pk_bf16_f32 v27, v20, v21
  v_sub_f32 v20, v60, v22
  v_sub_f32 v21, v61, v22
  v_exp_f32 v20, v20
  v_exp_f32 v21, v21
  s_nop 0
  v_cvt_pk_bf16_f32 v16, v20, v21
  v_cvt_pk_bf16_f32 v19, v20, v21
  s_nop 1
  v_mfma_f32_16x16x32_bf16 v[64:67], v[12:15], v[24:27], 0
  v_mfma_f32_16x16x32_bf16 v[80:83], v[36:39], v[24:27], 0
  v_mfma_f32_16x16x32_bf16 v[84:87], v[40:43], v[24:27], 0
  s_nop 3
  v_mfma_f32_16x16x16_bf16 v[64:67], v[12:13], v[16:17], v[64:67]
  v_mfma_f32_16x16x16_bf16 v[80:83], v[126:127], v[16:17], v[80:83]
  v_mfma_f32_16x16x16_bf16 v[84:87], v[126:127], v[18:19], v[84:87]
  s_nop 7
  v_rcp_f32 v65, v64
  s_mov_b64 vcc, 0
  s_branch L_smback_f
L_fs_f:
  buffer_load_dword v4, v17, s[40:43], s60 offen sc1
  s_add_u32 s67, s67, 1
  s_cmp_gt_u32 s67, 1048576
  s_cbranch_scc1 L_exit
  s_waitcnt vmcnt(0)
  v_cmp_gt_u32 vcc, s92, v4
  s_cbranch_vccnz L_fs_f
  s_branch L_fsback_f
L_poll2_x:
  buffer_load_dwordx4 v[20:23], v11, s[40:43], s63 offen sc1
  buffer_load_dwordx4 v[24:27], v11, s[40:43], s63 offen offset:1024 sc1
  s_nop 15
  s_nop 6
  buffer_load_dwordx4 v[28:31], v11, s[40:43], s63 offen sc1
  buffer_load_dwordx4 v[36:39], v11, s[40:43], s63 offen offset:1024 sc1
  v_readlane_b32 s69, v4, 1
  v_xor_b32 v10, 0x2000, v10
  s_waitcnt vmcnt(5)
  v_xor_b32 v32, 2048, v11
  v_xor_b32 v40, 4096, v11
  v_xor_b32 v48, 6144, v11
  s_cmp_lt_u32 s69, s92
  s_cbranch_scc1 L_fs_x
L_fsback_x:
  s_max_i32 s93, s56, 0
  s_add_u32 s56, s56, 1
  s_xor_b32 s65, s65, 1
  s_add_u32 s58, s57, 0x1000000
  s_add_u32 s68, s56, 1
  s_min_u32 s68, s68, 63
  s_lshl_b32 s68, s68, 13
  s_add_u32 s57, s72, s68
  s_add_u32 s59, s57, s73
  s_add_u32 s68, s56, 3
  s_min_u32 s92, s68, 64
  s_add_u32 s61, s61, 0x20000
  s_xor_b32 s70, s70, 0x2000
  v_bfe_u32 v45, v2, 9, 1
  v_and_b32 v4, 0x1ff, v2
  v_lshlrev_b32 v4, 2, v4
  v_lshl_add_u32 v4, v45, 24, v4
  s_sub_u32 s68, s60, s59
  v_mov_b32 v16, s93
  v_writelane_b32 v4, s68, 1
L_entry_x:
  s_waitcnt vmcnt(3)
  ds_write_b128 v11, v[20:23]
  v_smfmac_f32_16x16x64_bf16 v[52:55], v[20:23], a[0:7], v1
  s_waitcnt vmcnt(2)
  ds_write_b128 v11, v[24:27] offset:1024
  v_max3_u32 v44, v20, v21, v22
  v_max3_u32 v44, v44, v23, v24
  v_max3_u32 v44, v44, v25, v26
  v_max_u32 v44, v44, v27
  v_cmp_eq_u32 vcc, -1, v44
  v_smfmac_f32_16x16x64_bf16 v[56:59], v[20:23], a[64:71], v1
  s_mov_b32 m0, s71
  v_smfmac_f32_16x16x64_bf16 v[52:55], v[24:27], a[8:15], v1
  s_cbranch_vccnz L_retry2_x
  v_smfmac_f32_16x16x64_bf16 v[56:59], v[24:27], a[72:79], v1
  v_smfmac_f32_16x16x64_bf16 v[60:63], v[20:23], a[128:135], v1
  v_smfmac_f32_16x16x64_bf16 v[64:67], v[20:23], a[192:199], v1
  v_smfmac_f32_16x16x64_bf16 v[60:63], v[24:27], a[136:143], v1
  s_waitcnt vmcnt(0) lgkmcnt(0)
  s_barrier
  ds_read_b128 v[28:31], v32 offset:0
  v_smfmac_f32_16x16x64_bf16 v[64:67], v[24:27], a[200:207], v1
  ds_read_b128 v[32:35], v32 offset:1024
  ds_read_b128 v[36:39], v40 offset:0
  v_smfmac_f32_16x16x64_bf16 v[68:71], v[20:23], v[76:83], v1
  ds_read_b128 v[40:43], v40 offset:1024
  ds_read_b128 v[44:47], v48 offset:0
  v_smfmac_f32_16x16x64_bf16 v[72:75], v[20:23], v[84:91], v1
  ds_read_b128 v[48:51], v48 offset:1024
  buffer_load_dwordx4 v2, s[40:43], s58 offen offset:0 sc1 lds
  v_smfmac_f32_16x16x64_bf16 v[68:71], v[24:27], v[92:99], v1
  buffer_load_dwordx4 v2, s[40:43], s58 offen offset:1024 sc1 lds
  v_smfmac_f32_16x16x64_bf16 v[72:75], v[24:27], v[100:107], v1
  s_waitcnt lgkmcnt(5)
  ds_read_b128 v[76:79], v3 offset:16384
  v_smfmac_f32_16x16x64_bf16 v[52:55], v[28:31], a[16:23], v1
  s_waitcnt lgkmcnt(5)
  ds_read_b128 v[80:83], v3 offset:17408
  buffer_load_dword v4, v4, s[40:43], s59 offen sc1
  v_smfmac_f32_16x16x64_bf16 v[52:55], v[32:35], a[24:31], v1
  s_waitcnt lgkmcnt(5)
  ds_read_b128 v[84:87], v3 offset:18432
  buffer_store_dwordx4 v[124:127], v2, s[40:43], s61 offen sc1
  v_smfmac_f32_16x16x64_bf16 v[52:55], v[36:39], a[32:39], v1
  s_waitcnt lgkmcnt(5)
  ds_read_b128 v[88:91], v3 offset:19456
  v_xor_b32 v3, 0x18000, v3
  v_smfmac_f32_16x16x64_bf16 v[52:55], v[40:43], a[40:47], v1
  s_waitcnt lgkmcnt(4)
  ds_read_b128 v[92:95], v0 offset:0
  v_smfmac_f32_16x16x64_bf16 v[52:55], v[44:47], a[48:55], v1
  ds_read_b128 v[96:99], v0 offset:2048
  buffer_store_dword v16, v17, s[40:43], s66 offen sc1
  v_smfmac_f32_16x16x64_bf16 v[52:55], v[48:51], a[56:63], v1
  s_nop 0
  ds_read_b128 v[100:103], v0 offset:4096
  v_smfmac_f32_16x16x64_bf16 v[68:71], v[28:31], v[108:115], v1
  s_mov_b32 m0, s70
  ds_read_b128 v[104:107], v0 offset:6144
  v_smfmac_f32_16x16x64_bf16 v[56:59], v[28:31], a[80:87], v1
  s_nop 0
  ds_read_b128 v[108:111], v3 offset:0
  v_add_f32 v52, v52, v53
  v_smfmac_f32_16x16x64_bf16 v[56:59], v[32:35], a[88:95], v1
  ds_read_b128 v[112:115], v3 offset:1024
  v_add_f32 v54, v54, v55
  v_smfmac_f32_16x16x64_bf16 v[72:75], v[28:31], v[116:123], v1
  ds_read_b128 v[20:23], v0 offset:1024
  v_mul_f32 v52, s88, v52
  v_smfmac_f32_16x16x64_bf16 v[56:59], v[36:39], a[96:103], v1
  ds_read_b128 v[116:119], v3 offset:2048
  v_mul_f32 v54, s88, v54
  v_smfmac_f32_16x16x64_bf16 v[56:59], v[40:43], a[104:111], v1
  ds_read_b128 v[120:123], v3 offset:3072
  v_cvt_pk_bf16_f32 v52, v52, v52
  v_smfmac_f32_16x16x64_bf16 v[56:59], v[44:47], a[112:119], v1
  ds_read_b128 v[24:27], v0 offset:3072
  v_cvt_pk_bf16_f32 v53, v54, v54
  v_smfmac_f32_16x16x64_bf16 v[56:59], v[48:51], a[120:127], v1
  s_waitcnt lgkmcnt(10)
  ds_write_b64 v5, v[52:53] offset:0
  v_smfmac_f32_16x16x64_bf16 v[68:71], v[32:35], v[76:83], v1
  s_nop 0
  s_nop 0
  v_smfmac_f32_16x16x64_bf16 v[72:75], v[32:35], v[84:91], v1
  s_nop 0
  ds_read_b128 v[76:79], v3 offset:16384
  v_add_f32 v56, v56, v57
  v_smfmac_f32_16x16x64_bf16 v[60:63], v[28:31], a[144:151], v1
  ds_read_b128 v[80:83], v3 offset:17408
  v_add_f32 v58, v58, v59
  v_smfmac_f32_16x16x64_bf16 v[60:63], v[32:35], a[152:159], v1
  s_waitcnt lgkmcnt(4)
  ds_read_b128 v[84:87], v3 offset:18432
  v_mul_f32 v56, s88, v56
  v_smfmac_f32_16x16x64_bf16 v[68:71], v[36:39], v[108:115], v1
  ds_read_b128 v[88:91], v3 offset:19456
  v_mul_f32 v58, s88, v58
  v_smfmac_f32_16x16x64_bf16 v[60:63], v[36:39], a[160:167], v1
  v_cvt_pk_bf16_f32 v56, v56, v56
  v_smfmac_f32_16x16x64_bf16 v[72:75], v[36:39], v[116:123], v1
  v_cvt_pk_bf16_f32 v57, v58, v58
  v_smfmac_f32_16x16x64_bf16 v[60:63], v[40:43], a[168:175], v1
  ds_write_b64 v5, v[56:57] offset:2048
  v_xor_b32 v3, 0x8000, v3
  v_smfmac_f32_16x16x64_bf16 v[60:63], v[44:47], a[176:183], v1
  ds_read_b128 v[108:111], v3 offset:0
  v_smfmac_f32_16x16x64_bf16 v[60:63], v[48:51], a[184:191], v1
  s_waitcnt lgkmcnt(2)
  ds_read_b128 v[112:115], v3 offset:1024
  v_smfmac_f32_16x16x64_bf16 v[68:71], v[40:43], v[76:83], v1
  s_nop 0
  ds_read_b128 v[116:119], v3 offset:16384
  v_smfmac_f32_16x16x64_bf16 v[72:75], v[40:43], v[84:91], v1
  s_nop 0
  ds_read_b128 v[120:123], v3 offset:17408
  v_add_f32 v60, v60, v61
  v_smfmac_f32_16x16x64_bf16 v[64:67], v[28:31], a[208:215], v1
  s_waitcnt lgkmcnt(4)
  s_barrier
  v_add_f32 v62, v62, v63
  v_smfmac_f32_16x16x64_bf16 v[64:67], v[32:35], a[216:223], v1
  ds_read_b64_tr_b16 v[76:77], v6 offset:0
  ds_read_b64_tr_b16 v[78:79], v6 offset:2048
  v_smfmac_f32_16x16x64_bf16 v[64:67], v[36:39], a[224:231], v1
  ds_read_b64_tr_b16 v[80:81], v6 offset:512
  ds_read_b64_tr_b16 v[82:83], v6 offset:2560
  v_smfmac_f32_16x16x64_bf16 v[64:67], v[40:43], a[232:239], v1
  ds_read_b64_tr_b16 v[84:85], v6 offset:1024
  ds_read_b64_tr_b16 v[86:87], v6 offset:3072
  v_smfmac_f32_16x16x64_bf16 v[64:67], v[44:47], a[240:247], v1
  ds_read_b64_tr_b16 v[88:89], v6 offset:1536
  ds_read_b64_tr_b16 v[90:91], v6 offset:3584
  v_smfmac_f32_16x16x64_bf16 v[64:67], v[48:51], a[248:255], v1
  s_waitcnt lgkmcnt(8)
  ds_read_b128 v[28:31], v0 offset:5120
  v_cvt_pk_bf16_f32 v124, v60, v62
  v_smfmac_f32_16x16x64_bf16 v[68:71], v[44:47], v[108:115], v1
  s_nop 0
  ds_read_b128 v[32:35], v0 offset:7168
  v_smfmac_f32_16x16x64_bf16 v[68:71], v[48:51], v[116:123], v1
  s_waitcnt lgkmcnt(2)
  ds_read_b128 v[108:111], v3 offset:2048
  v_add_f32 v64, v64, v65
  v_mfma_f32_16x16x32_bf16 v[52:55], v[92:95], v[76:79], 0
  v_add_f32 v66, v66, v67
  v_cvt_pk_bf16_f32 v125, v64, v66
  v_mfma_f32_16x16x32_bf16 v[52:55], v[96:99], v[80:83], v[52:55]
  s_waitcnt vmcnt(3)
  ds_write2st64_b32 v5, v124, v125 offset0:16 offset1:24
  v_add_f32 v68, v68, v69
  v_mfma_f32_16x16x32_bf16 v[52:55], v[100:103], v[84:87], v[52:55]
  ds_read_b128 v[112:115], v3 offset:3072
  v_add_f32 v70, v70, v71
  v_mfma_f32_16x16x32_bf16 v[52:55], v[104:107], v[88:91], v[52:55]
  s_waitcnt lgkmcnt(3)
  ds_read_b128 v[116:119], v3 offset:18432
  v_cvt_pk_bf16_f32 v126, v68, v70
  v_mfma_f32_16x16x32_bf16 v[56:59], v[20:23], v[76:79], 0
  ds_read_b128 v[120:123], v3 offset:19456
  v_mfma_f32_16x16x32_bf16 v[56:59], v[24:27], v[80:83], v[56:59]
  ds_read_b128 v[36:39], v2 offset:8192
  ds_read_b128 v[40:43], v2 offset:9216
  v_mfma_f32_16x16x32_bf16 v[56:59], v[28:31], v[84:87], v[56:59]
  s_waitcnt lgkmcnt(5)
  s_barrier
  ds_read_b64_tr_b16 v[92:93], v6 offset:4096
  ds_read_b64_tr_b16 v[94:95], v6 offset:6144
  v_mfma_f32_16x16x32_bf16 v[56:59], v[32:35], v[88:91], v[56:59]
  s_waitcnt lgkmcnt(4)
  ds_read_b64_tr_b16 v[96:97], v6 offset:4608
  ds_read_b64_tr_b16 v[98:99], v6 offset:6656
  v_smfmac_f32_16x16x64_bf16 v[72:75], v[44:47], v[108:115], v1
  ds_read_b64_tr_b16 v[100:101], v6 offset:5120
  ds_read_b64_tr_b16 v[102:103], v6 offset:7168
  v_smfmac_f32_16x16x64_bf16 v[72:75], v[48:51], v[116:123], v1
  ds_read_b64_tr_b16 v[104:105], v6 offset:5632
  ds_read_b64_tr_b16 v[106:107], v6 offset:7680
  v_exp_f32 v20, v52
  v_exp_f32 v21, v53
  v_exp_f32 v22, v54
  s_waitcnt lgkmcnt(4)
  v_mfma_f32_16x16x32_bf16 v[60:63], v[92:95], v[76:79], 0
  v_exp_f32 v23, v55
  v_mfma_f32_16x16x32_bf16 v[60:63], v[96:99], v[80:83], v[60:63]
  s_waitcnt lgkmcnt(0)
  v_exp_f32 v28, v56
  v_mfma_f32_16x16x32_bf16 v[60:63], v[100:103], v[84:87], v[60:63]
  v_exp_f32 v29, v57
  v_mfma_f32_16x16x32_bf16 v[60:63], v[104:107], v[88:91], v[60:63]
  s_cmp_eq_u32 s56, 63
  v_exp_f32 v30, v58
  v_exp_f32 v31, v59
  v_cvt_pk_bf16_f32 v24, v20, v21
  v_cvt_pk_bf16_f32 v25, v22, v23
  v_cvt_pk_bf16_f32 v26, v28, v29
  v_cvt_pk_bf16_f32 v27, v30, v31
  v_add_f32 v72, v72, v73
  v_exp_f32 v20, v60
  v_mfma_f32_16x16x32_bf16 v[64:67], v[12:15], v[24:27], 0
  v_exp_f32 v21, v61
  v_mfma_f32_16x16x32_bf16 v[80:83], v[36:39], v[24:27], 0
  v_add_f32 v74, v74, v75
  v_cvt_pk_bf16_f32 v16, v20, v21
  v_mfma_f32_16x16x32_bf16 v[84:87], v[40:43], v[24:27], 0
  v_cvt_pk_bf16_f32 v127, v72, v74
  v_cvt_pk_bf16_f32 v19, v20, v21
  v_mfma_f32_16x16x16_bf16 v[64:67], v[12:13], v[16:17], v[64:67]
  s_cbranch_scc1 L_team_last
  v_xor_b32 v3, 0x18000, v3
  v_mov_b64 v[44:45], 0
  v_mfma_f32_16x16x16_bf16 v[80:83], v[126:127], v[16:17], v[80:83]
  s_nop 0
  v_mov_b64 v[46:47], 0
  v_mov_b64 v[48:49], 0
  v_mfma_f32_16x16x16_bf16 v[84:87], v[126:127], v[18:19], v[84:87]
  v_rcp_f32 v65, v64
  v_subrev_u32 v66, s89, v64
  v_cmp_le_u32 vcc, s91, v66
  v_mov_b64 v[50:51], 0
L_smback_x:
  v_mul_f32 v80, v80, v65
  v_mul_f32 v81, v81, v65
  v_mul_f32 v82, v82, v65
  v_mul_f32 v83, v83, v65
  v_cvt_pk_bf16_f32 v88, v80, v81
  v_cvt_pk_bf16_f32 v89, v82, v83
  ds_write_b64 v7, v[88:89]
  v_mul_f32 v84, v84, v65
  v_mul_f32 v85, v85, v65
  v_mul_f32 v86, v86, v65
  v_mul_f32 v87, v87, v65
  v_cvt_pk_bf16_f32 v90, v84, v85
  v_cvt_pk_bf16_f32 v91, v86, v87
  s_cbranch_vccnz L_smslow_x
  ds_write_b64 v7, v[90:91] offset:8
  v_xor_b32 v96, 512, v7
  v_xor_b32 v100, 1024, v7
  v_xor_b32 v104, 1536, v7
  v_mov_b64 v[36:37], 0
  v_mov_b64 v[38:39], 0
  v_mov_b64 v[40:41], 0
  v_mov_b64 v[42:43], 0
  v_lshrrev_b32 v24, 16, v12
  v_cndmask_b32 v24, v24, 1.0, s[94:95]
  v_cndmask_b32 v20, 0, v24, s[80:81]
  v_cndmask_b32 v21, 0, v24, s[82:83]
  v_cndmask_b32 v22, 0, v24, s[84:85]
  v_cndmask_b32 v23, 0, v24, s[86:87]
  v_smfmac_f32_16x16x64_bf16 v[48:51], v[88:91], v[224:231], v1
  s_waitcnt lgkmcnt(0)
  s_barrier
  ds_read_b128 v[96:99], v96
  v_smfmac_f32_16x16x64_bf16 v[44:47], v[88:91], v[192:199], v1
  ds_read_b128 v[100:103], v100
  ds_read_b128 v[104:107], v104
  v_smfmac_f32_16x16x64_bf16 v[40:43], v[88:91], v[160:167], v1
  buffer_load_dwordx4 v2, s[40:43], s57 offen offset:0 sc1 lds
  v_mov_b64 v[60:61], 0
  v_smfmac_f32_16x16x64_bf16 v[36:39], v[88:91], v[128:135], v1
  buffer_load_dwordx4 v2, s[40:43], s57 offen offset:1024 sc1 lds
  v_mov_b64 v[62:63], 0
  v_mov_b64 v[64:65], 0
  v_mov_b64 v[66:67], 0
  s_waitcnt lgkmcnt(2)
  v_smfmac_f32_16x16x64_bf16 v[36:39], v[96:99], v[136:143], v1
  s_waitcnt lgkmcnt(1)
  v_mov_b64 v[52:53], 0
  v_smfmac_f32_16x16x64_bf16 v[36:39], v[100:103], v[144:151], v1
  s_waitcnt lgkmcnt(0)
  v_mov_b64 v[54:55], 0
  v_smfmac_f32_16x16x64_bf16 v[36:39], v[104:107], v[152:159], v1
  s_nop 1
  v_mov_b64 v[56:57], 0
  v_smfmac_f32_16x16x64_bf16 v[40:43], v[96:99], v[168:175], v1
  s_nop 1
  v_mov_b64 v[58:59], 0
  v_smfmac_f32_16x16x64_bf16 v[40:43], v[100:103], v[176:183], v1
  v_cvt_pk_bf16_f32 v36, v36, v37
  v_cvt_pk_bf16_f32 v37, v38, v39
  v_and_or_b32 v36, v36, -2, s65
  v_smfmac_f32_16x16x64_bf16 v[40:43], v[104:107], v[184:191], v1
  s_nop 1
  buffer_store_dwordx2 v[36:37], v8, s[40:43], s74 offen sc1
  v_smfmac_f32_16x16x64_bf16 v[44:47], v[96:99], v[200:207], v1
  s_nop 2
  v_smfmac_f32_16x16x64_bf16 v[44:47], v[100:103], v[208:215], v1
  v_cvt_pk_bf16_f32 v40, v40, v41
  v_cvt_pk_bf16_f32 v41, v42, v43
  v_and_or_b32 v40, v40, -2, s65
  v_smfmac_f32_16x16x64_bf16 v[44:47], v[104:107], v[216:223], v1
  s_nop 1
  buffer_store_dwordx2 v[40:41], v8, s[40:43], s75 offen sc1
  v_smfmac_f32_16x16x64_bf16 v[48:51], v[96:99], v[232:239], v1
  s_nop 2
  v_smfmac_f32_16x16x64_bf16 v[48:51], v[100:103], v[240:247], v1
  v_cvt_pk_bf16_f32 v44, v44, v45
  v_cvt_pk_bf16_f32 v45, v46, v47
  v_and_or_b32 v44, v44, -2, s65
  v_smfmac_f32_16x16x64_bf16 v[48:51], v[104:107], v[248:255], v1
  s_nop 1
  buffer_store_dwordx2 v[44:45], v8, s[40:43], s76 offen sc1
  s_nop 4
  v_cvt_pk_bf16_f32 v48, v48, v49
  v_cvt_pk_bf16_f32 v49, v50, v51
  v_and_or_b32 v48, v48, -2, s65
  buffer_store_dwordx2 v[48:49], v8, s[40:43], s77 offen sc1
  s_nop 15
  s_nop 9
  s_cmp_lt_u32 s44, 1
  s_cbranch_scc1 L_poll1_x
  s_nop 9
  s_cmp_lt_u32 s44, 2
  s_cbranch_scc1 L_poll1_x
  s_nop 9
  s_cmp_lt_u32 s44, 3
  s_cbranch_scc1 L_poll1_x
  s_nop 9
L_poll1_x:
  buffer_load_dwordx4 v[28:31], v9, s[40:43], s62 offen sc1
  buffer_load_dwordx4 v[32:35], v9, s[40:43], s62 offen offset:1024 sc1
  v_mov_b64 v[64:65], 0
  v_mov_b64 v[66:67], 0
  v_mov_b64 v[68:69], 0
  v_mov_b64 v[70:71], 0
  v_mov_b64 v[72:73], 0
  v_mov_b64 v[74:75], 0
  v_xor_b32 v11, 0x2000, v11
  v_xor_b32 v0, 0x2000, v0
  s_nop 15
  s_nop 3
  buffer_load_dwordx4 v[36:39], v9, s[40:43], s62 offen sc1
  buffer_load_dwordx4 v[40:43], v9, s[40:43], s62 offen offset:1024 sc1
  ds_read_b128 v[76:79], v3 offset:0
  ds_read_b128 v[80:83], v3 offset:1024
  ds_read_b128 v[84:87], v3 offset:2048
  ds_read_b128 v[88:91], v3 offset:3072
  ds_read_b128 v[92:95], v3 offset:16384
  ds_read_b128 v[96:99], v3 offset:17408
  ds_read_b128 v[100:103], v3 offset:18432
  ds_read_b128 v[104:107], v3 offset:19456
  v_xor_b32 v3, 0x8000, v3
  ds_read_b128 v[108:111], v3 offset:0
  ds_read_b128 v[112:115], v3 offset:1024
  ds_read_b128 v[116:119], v3 offset:2048
  ds_read_b128 v[120:123], v3 offset:3072
L_poll1b_x:
  s_waitcnt vmcnt(3)
  v_mfma_f32_16x16x32_bf16 v[24:27], v[28:31], v[20:23], 0
  v_bitop3_b32 v44, v28, v30, s65 bitop3:0x7e
  s_waitcnt vmcnt(2)
  v_mfma_f32_16x16x32_bf16 v[24:27], v[32:35], v[20:23], v[24:27]
  v_bitop3_b32 v45, v32, v34, s65 bitop3:0x7e
  v_or_b32 v44, v44, v45
  v_and_b32 v44, 1, v44
  v_cmp_ne_u32 vcc, 0, v44
  s_nop 2
  s_cbranch_vccnz L_retry1_x
L_got1_x:
  v_add_f32 v24, v24, v25
  v_add_f32 v26, v26, v27
  s_nop 1
  v_permlane16_swap_b32 v24, v26
  v_add_f32 v24, v24, v26
  v_cvt_pk_bf16_f32 v24, v24, v17
  v_min_u32 v24, s90, v24
  v_cndmask_b32 v24, v24, -1, s[78:79]
  buffer_store_short v24, v10, s[40:43], s64 offen sc1
  s_nop 15
  s_nop 15
  s_nop 15
  s_nop 1
  s_branch L_poll2_x
L_retry2_x:
  s_waitcnt vmcnt(0)
  v_max3_u32 v44, v28, v29, v30
  v_max3_u32 v45, v31, v36, v37
  v_max3_u32 v44, v44, v38, v39
  v_max_u32 v44, v44, v45
  v_cmp_eq_u32 vcc, -1, v44
  v_mov_b64 v[20:21], v[28:29]
  v_mov_b64 v[22:23], v[30:31]
  v_mov_b64 v[24:25], v[36:37]
  v_mov_b64 v[26:27], v[38:39]
  v_mov_b64 v[52:53], 0
  v_mov_b64 v[54:55], 0
  v_mov_b64 v[56:57], 0
  v_mov_b64 v[58:59], 0
  s_cbranch_vccz L_entry_x
  buffer_load_dwordx4 v[20:23], v11, s[40:43], s63 offen sc1
  buffer_load_dwordx4 v[24:27], v11, s[40:43], s63 offen offset:1024 sc1
  s_add_u32 s67, s67, 1
  s_cmp_gt_u32 s67, 1048576
  s_cbranch_scc1 L_exit
  s_nop 15
  s_nop 3
  buffer_load_dwordx4 v[28:31], v11, s[40:43], s63 offen sc1
  buffer_load_dwordx4 v[36:39], v11, s[40:43], s63 offen offset:1024 sc1
  s_branch L_entry_x
L_retry1_x:
  buffer_load_dwordx4 v[28:31], v9, s[40:43], s62 offen sc1
  buffer_load_dwordx4 v[32:35], v9, s[40:43], s62 offen offset:1024 sc1
  s_waitcnt vmcnt(3)
  v_mfma_f32_16x16x32_bf16 v[24:27], v[36:39], v[20:23], 0
  v_bitop3_b32 v44, v36, v38, s65 bitop3:0x7e
  s_waitcnt vmcnt(2)
  v_mfma_f32_16x16x32_bf16 v[24:27], v[40:43], v[20:23], v[24:27]
  v_bitop3_b32 v45, v40, v42, s65 bitop3:0x7e
  v_or_b32 v44, v44, v45
  v_and_b32 v44, 1, v44
  v_cmp_ne_u32 vcc, 0, v44
  s_nop 2
  s_cbranch_vccnz L_retry1b_x
  v_add_f32 v24, v24, v25
  v_add_f32 v26, v26, v27
  s_nop 1
  v_permlane16_swap_b32 v24, v26
  v_add_f32 v24, v24, v26
  v_cvt_pk_bf16_f32 v24, v24, v17
  v_min_u32 v24, s90, v24
  v_cndmask_b32 v24, v24, -1, s[78:79]
  buffer_store_short v24, v10, s[40:43], s64 offen sc1
  s_nop 15
  s_nop 15
  s_nop 15
  s_nop 1
  s_branch L_poll2_x
L_retry1b_x:
  buffer_load_dwordx4 v[36:39], v9, s[40:43], s62 offen sc1
  buffer_load_dwordx4 v[40:43], v9, s[40:43], s62 offen offset:1024 sc1
  s_add_u32 s67, s67, 1
  s_cmp_gt_u32 s67, 1048576
  s_cbranch_scc1 L_exit
  s_branch L_poll1b_x
L_smslow_x:
  v_max3_f32 v22, v52, v53, v54
  v_max3_f32 v22, v22, v55, v56
  v_max3_f32 v22, v22, v57, v58
  v_max3_f32 v22, v22, v59, v60
  v_max_f32 v22, v22, v61
  v_mov_b32 v20, v22
  s_nop 1
  v_permlane32_swap_b32 v20, v22
  v_max_f32 v22, v22, v20
  v_mov_b32 v20, v22
  s_nop 1
  v_permlane16_swap_b32 v20, v22
  v_max_f32 v22, v22, v20
  v_sub_f32 v20, v52, v22
  v_sub_f32 v21, v53, v22
  v_exp_f32 v20, v20
  v_exp_f32 v21, v21
  s_nop 0
  v_cvt_pk_bf16_f32 v24, v20, v21
  v_sub_f32 v20, v54, v22
  v_sub_f32 v21, v55, v22
  v_exp_f32 v20, v20
  v_exp_f32 v21, v21
  s_nop 0
  v_cvt_pk_bf16_f32 v25, v20, v21
  v_sub_f32 v20, v56, v22
  v_sub_f32 v21, v57, v22
  v_exp_f32 v20, v20
  v_exp_f32 v21, v21
  s_nop 0
  v_cvt_pk_bf16_f32 v26, v20, v21
  v_sub_f32 v20, v58, v22
  v_sub_f32 v21, v59, v22
  v_exp_f32 v20, v20
  v_exp_f32 v21, v21
  s_nop 0
  v_cvt_pk_bf16_f32 v27, v20, v21
  v_sub_f32 v20, v60, v22
  v_sub_f32 v21, v61, v22
  v_exp_f32 v20, v20
  v_exp_f32 v21, v21
  s_nop 0
  v_cvt_pk_bf16_f32 v16, v20, v21
  v_cvt_pk_bf16_f32 v19, v20, v21
  s_nop 1
  v_mfma_f32_16x16x32_bf16 v[64:67], v[12:15], v[24:27], 0
  v_mfma_f32_16x16x32_bf16 v[80:83], v[36:39], v[24:27], 0
  v_mfma_f32_16x16x32_bf16 v[84:87], v[40:43], v[24:27], 0
  s_nop 3
  v_mfma_f32_16x16x16_bf16 v[64:67], v[12:13], v[16:17], v[64:67]
  v_mfma_f32_16x16x16_bf16 v[80:83], v[126:127], v[16:17], v[80:83]
  v_mfma_f32_16x16x16_bf16 v[84:87], v[126:127], v[18:19], v[84:87]
  s_nop 7
  v_rcp_f32 v65, v64
  s_mov_b64 vcc, 0
  s_branch L_smback_x
L_fs_x:
  buffer_load_dword v4, v17, s[40:43], s60 offen sc1
  s_add_u32 s67, s67, 1
  s_cmp_gt_u32 s67, 1048576
  s_cbranch_scc1 L_exit
  s_waitcnt vmcnt(0)
  v_cmp_gt_u32 vcc, s92, v4
  s_cbranch_vccnz L_fs_x
  s_branch L_fsback_x
L_team_last:
  s_waitcnt vmcnt(0)
  s_add_u32 s61, s61, 0x20000
  v_mov_b32 v4, 64
  buffer_store_dwordx4 v[124:127], v2, s[40:43], s61 offen sc1
  s_waitcnt vmcnt(0)
  s_barrier
  buffer_store_dword v4, v17, s[40:43], s66 offen sc1
  s_waitcnt vmcnt(0)
  s_endpgm
L_exit:
  s_endpgm
.p2align 8
.type L_ptab,@object
L_ptab:
.long 0xd,0x7005,0xe,0,0xc0,0x1e,0x180,0x240,4,4,4,4,4,4,4,4,4,4,4,4,4,4,4,4,4,4,4,4,4,4,4,4
.long 0x100d,0x6005,6,0x20,0x80,0xe0,0x140,0x1a0,0x200,0x260,0x2c0,0x320,0x380,0x3e0,4,4,4,4,4,4,4,4,4,4,4,4,4,4,4,4,4,4
.long 0x200d,0x5005,5,0xe,0x10,0xd0,0x1e,0x190,0x250,4,4,4,4,4,4,4,4,4,4,4,4,4,4,4,4,4,4,4,4,4,4,4
.long 0x300d,0x4005,0x1005,0xe,0x20,0xe0,0x1e,0x1a0,0x260,4,4,4,4,4,4,4,4,4,4,4,4,4,4,4,4,4,4,4,4,4,4,4
.long 0x400d,0x3005,6,0x40,0xa0,0x100,0x160,0x1c0,0x220,0x280,0x2e0,0x340,0x3a0,4,4,4,4,4,4,4,4,4,4,4,4,4,4,4,4,4,4,4
.long 0x500d,0x2005,6,0,0x60,0xc0,0x120,0x180,0x1e0,0x240,0x2a0,0x300,0x360,0x3c0,4,4,4,4,4,4,4,4,4,4,4,4,4,4,4,4,4,4
.long 0x600d,0x1e,0x300,0x340,0x380,0x3c0,4,4,4,4,4,4,4,4,4,4,4,4,4,4,4,4,4,4,4,4,4,4,4,4,4,4
.long 0x1d,0x7015,0xe,0x1000,0x10c0,0x1e,0x1180,0x1240,4,4,4,4,4,4,4,4,4,4,4,4,4,4,4,4,4,4,4,4,4,4,4,4
.long 0x101d,0x6015,0x16,0x20,0x80,0xe0,0x140,0x1a0,0x200,0x260,0x2c0,0x320,0x380,0x3e0,4,4,4,4,4,4,4,4,4,4,4,4,4,4,4,4,4,4
.long 0x201d,0x5015,0x15,0xe,0x1010,0x10d0,0x1e,0x1190,0x1250,4,4,4,4,4,4,4,4,4,4,4,4,4,4,4,4,4,4,4,4,4,4,4
.long 0x301d,0x4015,0x1015,0xe,0x1020,0x10e0,0x1e,0x11a0,0x1260,4,4,4,4,4,4,4,4,4,4,4,4,4,4,4,4,4,4,4,4,4,4,4
.long 0x401d,0x3015,0x16,0x40,0xa0,0x100,0x160,0x1c0,0x220,0x280,0x2e0,0x340,0x3a0,4,4,4,4,4,4,4,4,4,4,4,4,4,4,4,4,4,4,4
.long 0x501d,0x2015,0x16,0,0x60,0xc0,0x120,0x180,0x1e0,0x240,0x2a0,0x300,0x360,0x3c0,4,4,4,4,4,4,4,4,4,4,4,4,4,4,4,4,4,4
.long 0x601d,0x1e,0x1300,0x1340,0x1380,0x13c0,4,4,4,4,4,4,4,4,4,4,4,4,4,4,4,4,4,4,4,4,4,4,4,4,4,4
.long 0x2d,0x7025,0xe,0x2000,0x20c0,0x1e,0x2180,0x2240,4,4,4,4,4,4,4,4,4,4,4,4,4,4,4,4,4,4,4,4,4,4,4,4
.long 0x102d,0x6025,0x26,0x20,0x80,0xe0,0x140,0x1a0,0x200,0x260,0x2c0,0x320,0x380,0x3e0,4,4,4,4,4,4,4,4,4,4,4,4,4,4,4,4,4,4
.long 0x202d,0x5025,0x25,0xe,0x2010,0x20d0,0x1e,0x2190,0x2250,4,4,4,4,4,4,4,4,4,4,4,4,4,4,4,4,4,4,4,4,4,4,4
.long 0x302d,0x4025,0x1025,0xe,0x2020,0x20e0,0x1e,0x21a0,0x2260,4,4,4,4,4,4,4,4,4,4,4,4,4,4,4,4,4,4,4,4,4,4,4
.long 0x402d,0x3025,0x26,0x40,0xa0,0x100,0x160,0x1c0,0x220,0x280,0x2e0,0x340,0x3a0,4,4,4,4,4,4,4,4,4,4,4,4,4,4,4,4,4,4,4
.long 0x502d,0x2025,0x26,0,0x60,0xc0,0x120,0x180,0x1e0,0x240,0x2a0,0x300,0x360,0x3c0,4,4,4,4,4,4,4,4,4,4,4,4,4,4,4,4,4,4
.long 0x602d,0x1e,0x2300,0x2340,0x2380,0x23c0,4,4,4,4,4,4,4,4,4,4,4,4,4,4,4,4,4,4,4,4,4,4,4,4,4,4
.long 0x3d,0x7035,0xe,0x3000,0x30c0,0x1e,0x3180,0x3240,4,4,4,4,4,4,4,4,4,4,4,4,4,4,4,4,4,4,4,4,4,4,4,4
.long 0x103d,0x6035,0x36,0x20,0x80,0xe0,0x140,0x1a0,0x200,0x260,0x2c0,0x320,0x380,0x3e0,4,4,4,4,4,4,4,4,4,4,4,4,4,4,4,4,4,4
.long 0x203d,0x5035,0x35,0xe,0x3010,0x30d0,0x1e,0x3190,0x3250,4,4,4,4,4,4,4,4,4,4,4,4,4,4,4,4,4,4,4,4,4,4,4
.long 0x303d,0x4035,0x1035,0xe,0x3020,0x30e0,0x1e,0x31a0,0x3260,4,4,4,4,4,4,4,4,4,4,4,4,4,4,4,4,4,4,4,4,4,4,4
.long 0x403d,0x3035,0x36,0x40,0xa0,0x100,0x160,0x1c0,0x220,0x280,0x2e0,0x340,0x3a0,4,4,4,4,4,4,4,4,4,4,4,4,4,4,4,4,4,4,4
.long 0x503d,0x2035,0x36,0,0x60,0xc0,0x120,0x180,0x1e0,0x240,0x2a0,0x300,0x360,0x3c0,4,4,4,4,4,4,4,4,4,4,4,4,4,4,4,4,4,4
.long 0x603d,0x1e,0x3300,0x3340,0x3380,0x33c0,4,4,4,4,4,4,4,4,4,4,4,4,4,4,4,4,4,4,4,4,4,4,4,4,4,4
.long 0x4d,0x7045,0xe,0x4000,0x40c0,0x1e,0x4180,0x4240,4,4,4,4,4,4,4,4,4,4,4,4,4,4,4,4,4,4,4,4,4,4,4,4
.long 0x104d,0x6045,0x46,0x20,0x80,0xe0,0x140,0x1a0,0x200,0x260,0x2c0,0x320,0x380,0x3e0,4,4,4,4,4,4,4,4,4,4,4,4,4,4,4,4,4,4
.long 0x204d,0x5045,0x45,0xe,0x4010,0x40d0,0x1e,0x4190,0x4250,4,4,4,4,4,4,4,4,4,4,4,4,4,4,4,4,4,4,4,4,4,4,4
.long 0x304d,0x4045,0x1045,0xe,0x4020,0x40e0,0x1e,0x41a0,0x4260,4,4,4,4,4,4,4,4,4,4,4,4,4,4,4,4,4,4,4,4,4,4,4
.long 0x404d,0x3045,0x46,0x40,0xa0,0x100,0x160,0x1c0,0x220,0x280,0x2e0,0x340,0x3a0,4,4,4,4,4,4,4,4,4,4,4,4,4,4,4,4,4,4,4
.long 0x504d,0x2045,0x46,0,0x60,0xc0,0x120,0x180,0x1e0,0x240,0x2a0,0x300,0x360,0x3c0,4,4,4,4,4,4,4,4,4,4,4,4,4,4,4,4,4,4
.long 0x604d,0x1e,0x4300,0x4340,0x4380,0x43c0,4,4,4,4,4,4,4,4,4,4,4,4,4,4,4,4,4,4,4,4,4,4,4,4,4,4
.long 0x5d,0x7055,0xe,0x5000,0x50c0,0x1e,0x5180,0x5240,4,4,4,4,4,4,4,4,4,4,4,4,4,4,4,4,4,4,4,4,4,4,4,4
.long 0x105d,0x6055,0x56,0x20,0x80,0xe0,0x140,0x1a0,0x200,0x260,0x2c0,0x320,0x380,0x3e0,4,4,4,4,4,4,4,4,4,4,4,4,4,4,4,4,4,4
.long 0x205d,0x5055,0x55,0xe,0x5010,0x50d0,0x1e,0x5190,0x5250,4,4,4,4,4,4,4,4,4,4,4,4,4,4,4,4,4,4,4,4,4,4,4
.long 0x305d,0x4055,0x1055,0xe,0x5020,0x50e0,0x1e,0x51a0,0x5260,4,4,4,4,4,4,4,4,4,4,4,4,4,4,4,4,4,4,4,4,4,4,4
.long 0x405d,0x3055,0x56,0x40,0xa0,0x100,0x160,0x1c0,0x220,0x280,0x2e0,0x340,0x3a0,4,4,4,4,4,4,4,4,4,4,4,4,4,4,4,4,4,4,4
.long 0x505d,0x2055,0x56,0,0x60,0xc0,0x120,0x180,0x1e0,0x240,0x2a0,0x300,0x360,0x3c0,4,4,4,4,4,4,4,4,4,4,4,4,4,4,4,4,4,4
.long 0x605d,0x1e,0x5300,0x5340,0x5380,0x53c0,4,4,4,4,4,4,4,4,4,4,4,4,4,4,4,4,4,4,4,4,4,4,4,4,4,4
.long 0x6d,0x7065,0xe,0x6000,0x60c0,0x1e,0x6180,0x6240,4,4,4,4,4,4,4,4,4,4,4,4,4,4,4,4,4,4,4,4,4,4,4,4
.long 0x106d,0x6065,0x66,0x20,0x80,0xe0,0x140,0x1a0,0x200,0x260,0x2c0,0x320,0x380,0x3e0,4,4,4,4,4,4,4,4,4,4,4,4,4,4,4,4,4,4
.long 0x206d,0x5065,0x65,0xe,0x6010,0x60d0,0x1e,0x6190,0x6250,4,4,4,4,4,4,4,4,4,4,4,4,4,4,4,4,4,4,4,4,4,4,4
.long 0x306d,0x4065,0x1065,0xe,0x6020,0x60e0,0x1e,0x61a0,0x6260,4,4,4,4,4,4,4,4,4,4,4,4,4,4,4,4,4,4,4,4,4,4,4
.long 0x406d,0x3065,0x66,0x40,0xa0,0x100,0x160,0x1c0,0x220,0x280,0x2e0,0x340,0x3a0,4,4,4,4,4,4,4,4,4,4,4,4,4,4,4,4,4,4,4
.long 0x506d,0x2065,0x66,0,0x60,0xc0,0x120,0x180,0x1e0,0x240,0x2a0,0x300,0x360,0x3c0,4,4,4,4,4,4,4,4,4,4,4,4,4,4,4,4,4,4
.long 0x606d,0x1e,0x6300,0x6340,0x6380,0x63c0,4,4,4,4,4,4,4,4,4,4,4,4,4,4,4,4,4,4,4,4,4,4,4,4,4,4
.long 0x7d,0x7075,0xe,0x7000,0x70c0,0x1e,0x7180,0x7240,4,4,4,4,4,4,4,4,4,4,4,4,4,4,4,4,4,4,4,4,4,4,4,4
.long 0x107d,0x6075,0x76,0x20,0x80,0xe0,0x140,0x1a0,0x200,0x260,0x2c0,0x320,0x380,0x3e0,4,4,4,4,4,4,4,4,4,4,4,4,4,4,4,4,4,4
.long 0x207d,0x5075,0x75,0xe,0x7010,0x70d0,0x1e,0x7190,0x7250,4,4,4,4,4,4,4,4,4,4,4,4,4,4,4,4,4,4,4,4,4,4,4
.long 0x307d,0x4075,0x1075,0xe,0x7020,0x70e0,0x1e,0x71a0,0x7260,4,4,4,4,4,4,4,4,4,4,4,4,4,4,4,4,4,4,4,4,4,4,4
.long 0x407d,0x3075,0x76,0x40,0xa0,0x100,0x160,0x1c0,0x220,0x280,0x2e0,0x340,0x3a0,4,4,4,4,4,4,4,4,4,4,4,4,4,4,4,4,4,4,4
.long 0x507d,0x2075,0x76,0,0x60,0xc0,0x120,0x180,0x1e0,0x240,0x2a0,0x300,0x360,0x3c0,4,4,4,4,4,4,4,4,4,4,4,4,4,4,4,4,4,4
.long 0x607d,0x1e,0x7300,0x7340,0x7380,0x73c0,4,4,4,4,4,4,4,4,4,4,4,4,4,4,4,4,4,4,4,4,4,4,4,4,4,4
.long 0x8d,0x7085,0xe,0x30,0xf0,0x1e,0x1b0,0x270,4,4,4,4,4,4,4,4,4,4,4,4,4,4,4,4,4,4,4,4,4,4,4,4
.long 0x108d,0x6085,0x86,0x20,0x80,0xe0,0x140,0x1a0,0x200,0x260,0x2c0,0x320,0x380,0x3e0,4,4,4,4,4,4,4,4,4,4,4,4,4,4,4,4,4,4
.long 0x208d,0x5085,0x85,0xe,0x40,0x100,0x1e,0x1c0,0x280,4,4,4,4,4,4,4,4,4,4,4,4,4,4,4,4,4,4,4,4,4,4,4
.long 0x308d,0x4085,0x1085,0xe,0x50,0x110,0x1e,0x1d0,0x290,4,4,4,4,4,4,4,4,4,4,4,4,4,4,4,4,4,4,4,4,4,4,4
.long 0x408d,0x3085,0x86,0x40,0xa0,0x100,0x160,0x1c0,0x220,0x280,0x2e0,0x340,0x3a0,4,4,4,4,4,4,4,4,4,4,4,4,4,4,4,4,4,4,4
.long 0x508d,0x2085,0x86,0,0x60,0xc0,0x120,0x180,0x1e0,0x240,0x2a0,0x300,0x360,0x3c0,4,4,4,4,4,4,4,4,4,4,4,4,4,4,4,4,4,4
.long 0x608d,0x1e,0x310,0x350,0x390,0x3d0,4,4,4,4,4,4,4,4,4,4,4,4,4,4,4,4,4,4,4,4,4,4,4,4,4,4
.long 0x9d,0x7095,0xe,0x1030,0x10f0,0x1e,0x11b0,0x1270,4,4,4,4,4,4,4,4,4,4,4,4,4,4,4,4,4,4,4,4,4,4,4,4
.long 0x109d,0x6095,0x96,0x20,0x80,0xe0,0x140,0x1a0,0x200,0x260,0x2c0,0x320,0x380,0x3e0,4,4,4,4,4,4,4,4,4,4,4,4,4,4,4,4,4,4
.long 0x209d,0x5095,0x95,0xe,0x1040,0x1100,0x1e,0x11c0,0x1280,4,4,4,4,4,4,4,4,4,4,4,4,4,4,4,4,4,4,4,4,4,4,4
.long 0x309d,0x4095,0x1095,0xe,0x1050,0x1110,0x1e,0x11d0,0x1290,4,4,4,4,4,4,4,4,4,4,4,4,4,4,4,4,4,4,4,4,4,4,4
.long 0x409d,0x3095,0x96,0x40,0xa0,0x100,0x160,0x1c0,0x220,0x280,0x2e0,0x340,0x3a0,4,4,4,4,4,4,4,4,4,4,4,4,4,4,4,4,4,4,4
.long 0x509d,0x2095,0x96,0,0x60,0xc0,0x120,0x180,0x1e0,0x240,0x2a0,0x300,0x360,0x3c0,4,4,4,4,4,4,4,4,4,4,4,4,4,4,4,4,4,4
.long 0x609d,0x1e,0x1310,0x1350,0x1390,0x13d0,4,4,4,4,4,4,4,4,4,4,4,4,4,4,4,4,4,4,4,4,4,4,4,4,4,4
.long 0xad,0x70a5,0xe,0x2030,0x20f0,0x1e,0x21b0,0x2270,4,4,4,4,4,4,4,4,4,4,4,4,4,4,4,4,4,4,4,4,4,4,4,4
.long 0x10ad,0x60a5,0xa6,0x20,0x80,0xe0,0x140,0x1a0,0x200,0x260,0x2c0,0x320,0x380,0x3e0,4,4,4,4,4,4,4,4,4,4,4,4,4,4,4,4,4,4
.long 0x20ad,0x50a5,0xa5,0xe,0x2040,0x2100,0x1e,0x21c0,0x2280,4,4,4,4,4,4,4,4,4,4,4,4,4,4,4,4,4,4,4,4,4,4,4
.long 0x30ad,0x40a5,0x10a5,0xe,0x2050,0x2110,0x1e,0x21d0,0x2290,4,4,4,4,4,4,4,4,4,4,4,4,4,4,4,4,4,4,4,4,4,4,4
.long 0x40ad,0x30a5,0xa6,0x40,0xa0,0x100,0x160,0x1c0,0x220,0x280,0x2e0,0x340,0x3a0,4,4,4,4,4,4,4,4,4,4,4,4,4,4,4,4,4,4,4
.long 0x50ad,0x20a5,0xa6,0,0x60,0xc0,0x120,0x180,0x1e0,0x240,0x2a0,0x300,0x360,0x3c0,4,4,4,4,4,4,4,4,4,4,4,4,4,4,4,4,4,4
.long 0x60ad,0x1e,0x2310,0x2350,0x2390,0x23d0,4,4,4,4,4,4,4,4,4,4,4,4,4,4,4,4,4,4,4,4,4,4,4,4,4,4
.long 0xbd,0x70b5,0xe,0x3030,0x30f0,0x1e,0x31b0,0x3270,4,4,4,4,4,4,4,4,4,4,4,4,4,4,4,4,4,4,4,4,4,4,4,4
.long 0x10bd,0x60b5,0xb6,0x20,0x80,0xe0,0x140,0x1a0,0x200,0x260,0x2c0,0x320,0x380,0x3e0,4,4,4,4,4,4,4,4,4,4,4,4,4,4,4,4,4,4
.long 0x20bd,0x50b5,0xb5,0xe,0x3040,0x3100,0x1e,0x31c0,0x3280,4,4,4,4,4,4,4,4,4,4,4,4,4,4,4,4,4,4,4,4,4,4,4
.long 0x30bd,0x40b5,0x10b5,0xe,0x3050,0x3110,0x1e,0x31d0,0x3290,4,4,4,4,4,4,4,4,4,4,4,4,4,4,4,4,4,4,4,4,4,4,4
.long 0x40bd,0x30b5,0xb6,0x40,0xa0,0x100,0x160,0x1c0,0x220,0x280,0x2e0,0x340,0x3a0,4,4,4,4,4,4,4,4,4,4,4,4,4,4,4,4,4,4,4
.long 0x50bd,0x20b5,0xb6,0,0x60,0xc0,0x120,0x180,0x1e0,0x240,0x2a0,0x300,0x360,0x3c0,4,4,4,4,4,4,4,4,4,4,4,4,4,4,4,4,4,4
.long 0x60bd,0x1e,0x3310,0x3350,0x3390,0x33d0,4,4,4,4,4,4,4,4,4,4,4,4,4,4,4,4,4,4,4,4,4,4,4,4,4,4
.long 0xcd,0x70c5,0xe,0x4030,0x40f0,0x1e,0x41b0,0x4270,4,4,4,4,4,4,4,4,4,4,4,4,4,4,4,4,4,4,4,4,4,4,4,4
.long 0x10cd,0x60c5,0xc6,0x20,0x80,0xe0,0x140,0x1a0,0x200,0x260,0x2c0,0x320,0x380,0x3e0,4,4,4,4,4,4,4,4,4,4,4,4,4,4,4,4,4,4
.long 0x20cd,0x50c5,0xc5,0xe,0x4040,0x4100,0x1e,0x41c0,0x4280,4,4,4,4,4,4,4,4,4,4,4,4,4,4,4,4,4,4,4,4,4,4,4
.long 0x30cd,0x40c5,0x10c5,0xe,0x4050,0x4110,0x1e,0x41d0,0x4290,4,4,4,4,4,4,4,4,4,4,4,4,4,4,4,4,4,4,4,4,4,4,4
.long 0x40cd,0x30c5,0xc6,0x40,0xa0,0x100,0x160,0x1c0,0x220,0x280,0x2e0,0x340,0x3a0,4,4,4,4,4,4,4,4,4,4,4,4,4,4,4,4,4,4,4
.long 0x50cd,0x20c5,0xc6,0,0x60,0xc0,0x120,0x180,0x1e0,0x240,0x2a0,0x300,0x360,0x3c0,4,4,4,4,4,4,4,4,4,4,4,4,4,4,4,4,4,4
.long 0x60cd,0x1e,0x4310,0x4350,0x4390,0x43d0,4,4,4,4,4,4,4,4,4,4,4,4,4,4,4,4,4,4,4,4,4,4,4,4,4,4
.long 0xdd,0x70d5,0xe,0x5030,0x50f0,0x1e,0x51b0,0x5270,4,4,4,4,4,4,4,4,4,4,4,4,4,4,4,4,4,4,4,4,4,4,4,4
.long 0x10dd,0x60d5,0xd6,0x20,0x80,0xe0,0x140,0x1a0,0x200,0x260,0x2c0,0x320,0x380,0x3e0,4,4,4,4,4,4,4,4,4,4,4,4,4,4,4,4,4,4
.long 0x20dd,0x50d5,0xd5,0xe,0x5040,0x5100,0x1e,0x51c0,0x5280,4,4,4,4,4,4,4,4,4,4,4,4,4,4,4,4,4,4,4,4,4,4,4
.long 0x30dd,0x40d5,0x10d5,0xe,0x5050,0x5110,0x1e,0x51d0,0x5290,4,4,4,4,4,4,4,4,4,4,4,4,4,4,4,4,4,4,4,4,4,4,4
.long 0x40dd,0x30d5,0xd6,0x40,0xa0,0x100,0x160,0x1c0,0x220,0x280,0x2e0,0x340,0x3a0,4,4,4,4,4,4,4,4,4,4,4,4,4,4,4,4,4,4,4
.long 0x50dd,0x20d5,0xd6,0,0x60,0xc0,0x120,0x180,0x1e0,0x240,0x2a0,0x300,0x360,0x3c0,4,4,4,4,4,4,4,4,4,4,4,4,4,4,4,4,4,4
.long 0x60dd,0x1e,0x5310,0x5350,0x5390,0x53d0,4,4,4,4,4,4,4,4,4,4,4,4,4,4,4,4,4,4,4,4,4,4,4,4,4,4
.long 0xed,0x70e5,0xe,0x6030,0x60f0,0x1e,0x61b0,0x6270,4,4,4,4,4,4,4,4,4,4,4,4,4,4,4,4,4,4,4,4,4,4,4,4
.long 0x10ed,0x60e5,0xe6,0x20,0x80,0xe0,0x140,0x1a0,0x200,0x260,0x2c0,0x320,0x380,0x3e0,4,4,4,4,4,4,4,4,4,4,4,4,4,4,4,4,4,4
.long 0x20ed,0x50e5,0xe5,0xe,0x6040,0x6100,0x1e,0x61c0,0x6280,4,4,4,4,4,4,4,4,4,4,4,4,4,4,4,4,4,4,4,4,4,4,4
.long 0x30ed,0x40e5,0x10e5,0xe,0x6050,0x6110,0x1e,0x61d0,0x6290,4,4,4,4,4,4,4,4,4,4,4,4,4,4,4,4,4,4,4,4,4,4,4
.long 0x40ed,0x30e5,0xe6,0x40,0xa0,0x100,0x160,0x1c0,0x220,0x280,0x2e0,0x340,0x3a0,4,4,4,4,4,4,4,4,4,4,4,4,4,4,4,4,4,4,4
.long 0x50ed,0x20e5,0xe6,0,0x60,0xc0,0x120,0x180,0x1e0,0x240,0x2a0,0x300,0x360,0x3c0,4,4,4,4,4,4,4,4,4,4,4,4,4,4,4,4,4,4
.long 0x60ed,0x1e,0x6310,0x6350,0x6390,0x63d0,4,4,4,4,4,4,4,4,4,4,4,4,4,4,4,4,4,4,4,4,4,4,4,4,4,4
.long 0xfd,0x70f5,0xe,0x7030,0x70f0,0x1e,0x71b0,0x7270,4,4,4,4,4,4,4,4,4,4,4,4,4,4,4,4,4,4,4,4,4,4,4,4
.long 0x10fd,0x60f5,0xf6,0x20,0x80,0xe0,0x140,0x1a0,0x200,0x260,0x2c0,0x320,0x380,0x3e0,4,4,4,4,4,4,4,4,4,4,4,4,4,4,4,4,4,4
.long 0x20fd,0x50f5,0xf5,0xe,0x7040,0x7100,0x1e,0x71c0,0x7280,4,4,4,4,4,4,4,4,4,4,4,4,4,4,4,4,4,4,4,4,4,4,4
.long 0x30fd,0x40f5,0x10f5,0xe,0x7050,0x7110,0x1e,0x71d0,0x7290,4,4,4,4,4,4,4,4,4,4,4,4,4,4,4,4,4,4,4,4,4,4,4
.long 0x40fd,0x30f5,0xf6,0x40,0xa0,0x100,0x160,0x1c0,0x220,0x280,0x2e0,0x340,0x3a0,4,4,4,4,4,4,4,4,4,4,4,4,4,4,4,4,4,4,4
.long 0x50fd,0x20f5,0xf6,0,0x60,0xc0,0x120,0x180,0x1e0,0x240,0x2a0,0x300,0x360,0x3c0,4,4,4,4,4,4,4,4,4,4,4,4,4,4,4,4,4,4
.long 0x60fd,0x1e,0x7310,0x7350,0x7390,0x73d0,4,4,4,4,4,4,4,4,4,4,4,4,4,4,4,4,4,4,4,4,4,4,4,4,4,4
.long 0x10d,0x7105,0xe,0x60,0x120,0x1e,0x1e0,0x2a0,4,4,4,4,4,4,4,4,4,4,4,4,4,4,4,4,4,4,4,4,4,4,4,4
.long 0x110d,0x6105,6,0x30,0x90,0xf0,0x150,0x1b0,0x210,0x270,0x2d0,0x330,0x390,0x3f0,4,4,4,4,4,4,4,4,4,4,4,4,4,4,4,4,4,4
.long 0x210d,0x5105,0x105,0xe,0x70,0x130,0x1e,0x1f0,0x2b0,4,4,4,4,4,4,4,4,4,4,4,4,4,4,4,4,4,4,4,4,4,4,4
.long 0x310d,0x4105,0x1105,0xe,0x80,0x140,0x1e,0x200,0x2c0,4,4,4,4,4,4,4,4,4,4,4,4,4,4,4,4,4,4,4,4,4,4,4
.long 0x410d,0x3105,6,0x50,0xb0,0x110,0x170,0x1d0,0x230,0x290,0x2f0,0x350,0x3b0,4,4,4,4,4,4,4,4,4,4,4,4,4,4,4,4,4,4,4
.long 0x510d,0x2105,6,0x10,0x70,0xd0,0x130,0x190,0x1f0,0x250,0x2b0,0x310,0x370,0x3d0,4,4,4,4,4,4,4,4,4,4,4,4,4,4,4,4,4,4
.long 0x610d,0x1e,0x320,0x360,0x3a0,0x3e0,4,4,4,4,4,4,4,4,4,4,4,4,4,4,4,4,4,4,4,4,4,4,4,4,4,4
.long 0x11d,0x7115,0xe,0x1060,0x1120,0x1e,0x11e0,0x12a0,4,4,4,4,4,4,4,4,4,4,4,4,4,4,4,4,4,4,4,4,4,4,4,4
.long 0x111d,0x6115,0x16,0x30,0x90,0xf0,0x150,0x1b0,0x210,0x270,0x2d0,0x330,0x390,0x3f0,4,4,4,4,4,4,4,4,4,4,4,4,4,4,4,4,4,4
.long 0x211d,0x5115,0x115,0xe,0x1070,0x1130,0x1e,0x11f0,0x12b0,4,4,4,4,4,4,4,4,4,4,4,4,4,4,4,4,4,4,4,4,4,4,4
.long 0x311d,0x4115,0x1115,0xe,0x1080,0x1140,0x1e,0x1200,0x12c0,4,4,4,4,4,4,4,4,4,4,4,4,4,4,4,4,4,4,4,4,4,4,4
.long 0x411d,0x3115,0x16,0x50,0xb0,0x110,0x170,0x1d0,0x230,0x290,0x2f0,0x350,0x3b0,4,4,4,4,4,4,4,4,4,4,4,4,4,4,4,4,4,4,4
.long 0x511d,0x2115,0x16,0x10,0x70,0xd0,0x130,0x190,0x1f0,0x250,0x2b0,0x310,0x370,0x3d0,4,4,4,4,4,4,4,4,4,4,4,4,4,4,4,4,4,4
.long 0x611d,0x1e,0x1320,0x1360,0x13a0,0x13e0,4,4,4,4,4,4,4,4,4,4,4,4,4,4,4,4,4,4,4,4,4,4,4,4,4,4
.long 0x12d,0x7125,0xe,0x2060,0x2120,0x1e,0x21e0,0x22a0,4,4,4,4,4,4,4,4,4,4,4,4,4,4,4,4,4,4,4,4,4,4,4,4
.long 0x112d,0x6125,0x26,0x30,0x90,0xf0,0x150,0x1b0,0x210,0x270,0x2d0,0x330,0x390,0x3f0,4,4,4,4,4,4,4,4,4,4,4,4,4,4,4,4,4,4
.long 0x212d,0x5125,0x125,0xe,0x2070,0x2130,0x1e,0x21f0,0x22b0,4,4,4,4,4,4,4,4,4,4,4,4,4,4,4,4,4,4,4,4,4,4,4
.long 0x312d,0x4125,0x1125,0xe,0x2080,0x2140,0x1e,0x2200,0x22c0,4,4,4,4,4,4,4,4,4,4,4,4,4,4,4,4,4,4,4,4,4,4,4
.long 0x412d,0x3125,0x26,0x50,0xb0,0x110,0x170,0x1d0,0x230,0x290,0x2f0,0x350,0x3b0,4,4,4,4,4,4,4,4,4,4,4,4,4,4,4,4,4,4,4
.long 0x512d,0x2125,0x26,0x10,0x70,0xd0,0x130,0x190,0x1f0,0x250,0x2b0,0x310,0x370,0x3d0,4,4,4,4,4,4,4,4,4,4,4,4,4,4,4,4,4,4
.long 0x612d,0x1e,0x2320,0x2360,0x23a0,0x23e0,4,4,4,4,4,4,4,4,4,4,4,4,4,4,4,4,4,4,4,4,4,4,4,4,4,4
.long 0x13d,0x7135,0xe,0x3060,0x3120,0x1e,0x31e0,0x32a0,4,4,4,4,4,4,4,4,4,4,4,4,4,4,4,4,4,4,4,4,4,4,4,4
.long 0x113d,0x6135,0x36,0x30,0x90,0xf0,0x150,0x1b0,0x210,0x270,0x2d0,0x330,0x390,0x3f0,4,4,4,4,4,4,4,4,4,4,4,4,4,4,4,4,4,4
.long 0x213d,0x5135,0x135,0xe,0x3070,0x3130,0x1e,0x31f0,0x32b0,4,4,4,4,4,4,4,4,4,4,4,4,4,4,4,4,4,4,4,4,4,4,4
.long 0x313d,0x4135,0x1135,0xe,0x3080,0x3140,0x1e,0x3200,0x32c0,4,4,4,4,4,4,4,4,4,4,4,4,4,4,4,4,4,4,4,4,4,4,4
.long 0x413d,0x3135,0x36,0x50,0xb0,0x110,0x170,0x1d0,0x230,0x290,0x2f0,0x350,0x3b0,4,4,4,4,4,4,4,4,4,4,4,4,4,4,4,4,4,4,4
.long 0x513d,0x2135,0x36,0x10,0x70,0xd0,0x130,0x190,0x1f0,0x250,0x2b0,0x310,0x370,0x3d0,4,4,4,4,4,4,4,4,4,4,4,4,4,4,4,4,4,4
.long 0x613d,0x1e,0x3320,0x3360,0x33a0,0x33e0,4,4,4,4,4,4,4,4,4,4,4,4,4,4,4,4,4,4,4,4,4,4,4,4,4,4
.long 0x14d,0x7145,0xe,0x4060,0x4120,0x1e,0x41e0,0x42a0,4,4,4,4,4,4,4,4,4,4,4,4,4,4,4,4,4,4,4,4,4,4,4,4
.long 0x114d,0x6145,0x46,0x30,0x90,0xf0,0x150,0x1b0,0x210,0x270,0x2d0,0x330,0x390,0x3f0,4,4,4,4,4,4,4,4,4,4,4,4,4,4,4,4,4,4
.long 0x214d,0x5145,0x145,0xe,0x4070,0x4130,0x1e,0x41f0,0x42b0,4,4,4,4,4,4,4,4,4,4,4,4,4,4,4,4,4,4,4,4,4,4,4
.long 0x314d,0x4145,0x1145,0xe,0x4080,0x4140,0x1e,0x4200,0x42c0,4,4,4,4,4,4,4,4,4,4,4,4,4,4,4,4,4,4,4,4,4,4,4
.long 0x414d,0x3145,0x46,0x50,0xb0,0x110,0x170,0x1d0,0x230,0x290,0x2f0,0x350,0x3b0,4,4,4,4,4,4,4,4,4,4,4,4,4,4,4,4,4,4,4
.long 0x514d,0x2145,0x46,0x10,0x70,0xd0,0x130,0x190,0x1f0,0x250,0x2b0,0x310,0x370,0x3d0,4,4,4,4,4,4,4,4,4,4,4,4,4,4,4,4,4,4
.long 0x614d,0x1e,0x4320,0x4360,0x43a0,0x43e0,4,4,4,4,4,4,4,4,4,4,4,4,4,4,4,4,4,4,4,4,4,4,4,4,4,4
.long 0x15d,0x7155,0xe,0x5060,0x5120,0x1e,0x51e0,0x52a0,4,4,4,4,4,4,4,4,4,4,4,4,4,4,4,4,4,4,4,4,4,4,4,4
.long 0x115d,0x6155,0x56,0x30,0x90,0xf0,0x150,0x1b0,0x210,0x270,0x2d0,0x330,0x390,0x3f0,4,4,4,4,4,4,4,4,4,4,4,4,4,4,4,4,4,4
.long 0x215d,0x5155,0x155,0xe,0x5070,0x5130,0x1e,0x51f0,0x52b0,4,4,4,4,4,4,4,4,4,4,4,4,4,4,4,4,4,4,4,4,4,4,4
.long 0x315d,0x4155,0x1155,0xe,0x5080,0x5140,0x1e,0x5200,0x52c0,4,4,4,4,4,4,4,4,4,4,4,4,4,4,4,4,4,4,4,4,4,4,4
.long 0x415d,0x3155,0x56,0x50,0xb0,0x110,0x170,0x1d0,0x230,0x290,0x2f0,0x350,0x3b0,4,4,4,4,4,4,4,4,4,4,4,4,4,4,4,4,4,4,4
.long 0x515d,0x2155,0x56,0x10,0x70,0xd0,0x130,0x190,0x1f0,0x250,0x2b0,0x310,0x370,0x3d0,4,4,4,4,4,4,4,4,4,4,4,4,4,4,4,4,4,4
.long 0x615d,0x1e,0x5320,0x5360,0x53a0,0x53e0,4,4,4,4,4,4,4,4,4,4,4,4,4,4,4,4,4,4,4,4,4,4,4,4,4,4
.long 0x16d,0x7165,0xe,0x6060,0x6120,0x1e,0x61e0,0x62a0,4,4,4,4,4,4,4,4,4,4,4,4,4,4,4,4,4,4,4,4,4,4,4,4
.long 0x116d,0x6165,0x66,0x30,0x90,0xf0,0x150,0x1b0,0x210,0x270,0x2d0,0x330,0x390,0x3f0,4,4,4,4,4,4,4,4,4,4,4,4,4,4,4,4,4,4
.long 0x216d,0x5165,0x165,0xe,0x6070,0x6130,0x1e,0x61f0,0x62b0,4,4,4,4,4,4,4,4,4,4,4,4,4,4,4,4,4,4,4,4,4,4,4
.long 0x316d,0x4165,0x1165,0xe,0x6080,0x6140,0x1e,0x6200,0x62c0,4,4,4,4,4,4,4,4,4,4,4,4,4,4,4,4,4,4,4,4,4,4,4
.long 0x416d,0x3165,0x66,0x50,0xb0,0x110,0x170,0x1d0,0x230,0x290,0x2f0,0x350,0x3b0,4,4,4,4,4,4,4,4,4,4,4,4,4,4,4,4,4,4,4
.long 0x516d,0x2165,0x66,0x10,0x70,0xd0,0x130,0x190,0x1f0,0x250,0x2b0,0x310,0x370,0x3d0,4,4,4,4,4,4,4,4,4,4,4,4,4,4,4,4,4,4
.long 0x616d,0x1e,0x6320,0x6360,0x63a0,0x63e0,4,4,4,4,4,4,4,4,4,4,4,4,4,4,4,4,4,4,4,4,4,4,4,4,4,4
.long 0x17d,0x7175,0xe,0x7060,0x7120,0x1e,0x71e0,0x72a0,4,4,4,4,4,4,4,4,4,4,4,4,4,4,4,4,4,4,4,4,4,4,4,4
.long 0x117d,0x6175,0x76,0x30,0x90,0xf0,0x150,0x1b0,0x210,0x270,0x2d0,0x330,0x390,0x3f0,4,4,4,4,4,4,4,4,4,4,4,4,4,4,4,4,4,4
.long 0x217d,0x5175,0x175,0xe,0x7070,0x7130,0x1e,0x71f0,0x72b0,4,4,4,4,4,4,4,4,4,4,4,4,4,4,4,4,4,4,4,4,4,4,4
.long 0x317d,0x4175,0x1175,0xe,0x7080,0x7140,0x1e,0x7200,0x72c0,4,4,4,4,4,4,4,4,4,4,4,4,4,4,4,4,4,4,4,4,4,4,4
.long 0x417d,0x3175,0x76,0x50,0xb0,0x110,0x170,0x1d0,0x230,0x290,0x2f0,0x350,0x3b0,4,4,4,4,4,4,4,4,4,4,4,4,4,4,4,4,4,4,4
.long 0x517d,0x2175,0x76,0x10,0x70,0xd0,0x130,0x190,0x1f0,0x250,0x2b0,0x310,0x370,0x3d0,4,4,4,4,4,4,4,4,4,4,4,4,4,4,4,4,4,4
.long 0x617d,0x1e,0x7320,0x7360,0x73a0,0x73e0,4,4,4,4,4,4,4,4,4,4,4,4,4,4,4,4,4,4,4,4,4,4,4,4,4,4
.long 0x18d,0x7185,0xe,0x90,0x150,0x1e,0x210,0x2d0,4,4,4,4,4,4,4,4,4,4,4,4,4,4,4,4,4,4,4,4,4,4,4,4
.long 0x118d,0x6185,0x86,0x30,0x90,0xf0,0x150,0x1b0,0x210,0x270,0x2d0,0x330,0x390,0x3f0,4,4,4,4,4,4,4,4,4,4,4,4,4,4,4,4,4,4
.long 0x218d,0x5185,0x185,0xe,0xa0,0x160,0x1e,0x220,0x2e0,4,4,4,4,4,4,4,4,4,4,4,4,4,4,4,4,4,4,4,4,4,4,4
.long 0x318d,0x4185,0x1185,0xe,0xb0,0x170,0x1e,0x230,0x2f0,4,4,4,4,4,4,4,4,4,4,4,4,4,4,4,4,4,4,4,4,4,4,4
.long 0x418d,0x3185,0x86,0x50,0xb0,0x110,0x170,0x1d0,0x230,0x290,0x2f0,0x350,0x3b0,4,4,4,4,4,4,4,4,4,4,4,4,4,4,4,4,4,4,4
.long 0x518d,0x2185,0x86,0x10,0x70,0xd0,0x130,0x190,0x1f0,0x250,0x2b0,0x310,0x370,0x3d0,4,4,4,4,4,4,4,4,4,4,4,4,4,4,4,4,4,4
.long 0x618d,0x1e,0x330,0x370,0x3b0,0x3f0,4,4,4,4,4,4,4,4,4,4,4,4,4,4,4,4,4,4,4,4,4,4,4,4,4,4
.long 0x19d,0x7195,0xe,0x1090,0x1150,0x1e,0x1210,0x12d0,4,4,4,4,4,4,4,4,4,4,4,4,4,4,4,4,4,4,4,4,4,4,4,4
.long 0x119d,0x6195,0x96,0x30,0x90,0xf0,0x150,0x1b0,0x210,0x270,0x2d0,0x330,0x390,0x3f0,4,4,4,4,4,4,4,4,4,4,4,4,4,4,4,4,4,4
.long 0x219d,0x5195,0x195,0xe,0x10a0,0x1160,0x1e,0x1220,0x12e0,4,4,4,4,4,4,4,4,4,4,4,4,4,4,4,4,4,4,4,4,4,4,4
.long 0x319d,0x4195,0x1195,0xe,0x10b0,0x1170,0x1e,0x1230,0x12f0,4,4,4,4,4,4,4,4,4,4,4,4,4,4,4,4,4,4,4,4,4,4,4
.long 0x419d,0x3195,0x96,0x50,0xb0,0x110,0x170,0x1d0,0x230,0x290,0x2f0,0x350,0x3b0,4,4,4,4,4,4,4,4,4,4,4,4,4,4,4,4,4,4,4
.long 0x519d,0x2195,0x96,0x10,0x70,0xd0,0x130,0x190,0x1f0,0x250,0x2b0,0x310,0x370,0x3d0,4,4,4,4,4,4,4,4,4,4,4,4,4,4,4,4,4,4
.long 0x619d,0x1e,0x1330,0x1370,0x13b0,0x13f0,4,4,4,4,4,4,4,4,4,4,4,4,4,4,4,4,4,4,4,4,4,4,4,4,4,4
.long 0x1ad,0x71a5,0xe,0x2090,0x2150,0x1e,0x2210,0x22d0,4,4,4,4,4,4,4,4,4,4,4,4,4,4,4,4,4,4,4,4,4,4,4,4
.long 0x11ad,0x61a5,0xa6,0x30,0x90,0xf0,0x150,0x1b0,0x210,0x270,0x2d0,0x330,0x390,0x3f0,4,4,4,4,4,4,4,4,4,4,4,4,4,4,4,4,4,4
.long 0x21ad,0x51a5,0x1a5,0xe,0x20a0,0x2160,0x1e,0x2220,0x22e0,4,4,4,4,4,4,4,4,4,4,4,4,4,4,4,4,4,4,4,4,4,4,4
.long 0x31ad,0x41a5,0x11a5,0xe,0x20b0,0x2170,0x1e,0x2230,0x22f0,4,4,4,4,4,4,4,4,4,4,4,4,4,4,4,4,4,4,4,4,4,4,4
.long 0x41ad,0x31a5,0xa6,0x50,0xb0,0x110,0x170,0x1d0,0x230,0x290,0x2f0,0x350,0x3b0,4,4,4,4,4,4,4,4,4,4,4,4,4,4,4,4,4,4,4
.long 0x51ad,0x21a5,0xa6,0x10,0x70,0xd0,0x130,0x190,0x1f0,0x250,0x2b0,0x310,0x370,0x3d0,4,4,4,4,4,4,4,4,4,4,4,4,4,4,4,4,4,4
.long 0x61ad,0x1e,0x2330,0x2370,0x23b0,0x23f0,4,4,4,4,4,4,4,4,4,4,4,4,4,4,4,4,4,4,4,4,4,4,4,4,4,4
.long 0x1bd,0x71b5,0xe,0x3090,0x3150,0x1e,0x3210,0x32d0,4,4,4,4,4,4,4,4,4,4,4,4,4,4,4,4,4,4,4,4,4,4,4,4
.long 0x11bd,0x61b5,0xb6,0x30,0x90,0xf0,0x150,0x1b0,0x210,0x270,0x2d0,0x330,0x390,0x3f0,4,4,4,4,4,4,4,4,4,4,4,4,4,4,4,4,4,4
.long 0x21bd,0x51b5,0x1b5,0xe,0x30a0,0x3160,0x1e,0x3220,0x32e0,4,4,4,4,4,4,4,4,4,4,4,4,4,4,4,4,4,4,4,4,4,4,4
.long 0x31bd,0x41b5,0x11b5,0xe,0x30b0,0x3170,0x1e,0x3230,0x32f0,4,4,4,4,4,4,4,4,4,4,4,4,4,4,4,4,4,4,4,4,4,4,4
.long 0x41bd,0x31b5,0xb6,0x50,0xb0,0x110,0x170,0x1d0,0x230,0x290,0x2f0,0x350,0x3b0,4,4,4,4,4,4,4,4,4,4,4,4,4,4,4,4,4,4,4
.long 0x51bd,0x21b5,0xb6,0x10,0x70,0xd0,0x130,0x190,0x1f0,0x250,0x2b0,0x310,0x370,0x3d0,4,4,4,4,4,4,4,4,4,4,4,4,4,4,4,4,4,4
.long 0x61bd,0x1e,0x3330,0x3370,0x33b0,0x33f0,4,4,4,4,4,4,4,4,4,4,4,4,4,4,4,4,4,4,4,4,4,4,4,4,4,4
.long 0x1cd,0x71c5,0xe,0x4090,0x4150,0x1e,0x4210,0x42d0,4,4,4,4,4,4,4,4,4,4,4,4,4,4,4,4,4,4,4,4,4,4,4,4
.long 0x11cd,0x61c5,0xc6,0x30,0x90,0xf0,0x150,0x1b0,0x210,0x270,0x2d0,0x330,0x390,0x3f0,4,4,4,4,4,4,4,4,4,4,4,4,4,4,4,4,4,4
.long 0x21cd,0x51c5,0x1c5,0xe,0x40a0,0x4160,0x1e,0x4220,0x42e0,4,4,4,4,4,4,4,4,4,4,4,4,4,4,4,4,4,4,4,4,4,4,4
.long 0x31cd,0x41c5,0x11c5,0xe,0x40b0,0x4170,0x1e,0x4230,0x42f0,4,4,4,4,4,4,4,4,4,4,4,4,4,4,4,4,4,4,4,4,4,4,4
.long 0x41cd,0x31c5,0xc6,0x50,0xb0,0x110,0x170,0x1d0,0x230,0x290,0x2f0,0x350,0x3b0,4,4,4,4,4,4,4,4,4,4,4,4,4,4,4,4,4,4,4
.long 0x51cd,0x21c5,0xc6,0x10,0x70,0xd0,0x130,0x190,0x1f0,0x250,0x2b0,0x310,0x370,0x3d0,4,4,4,4,4,4,4,4,4,4,4,4,4,4,4,4,4,4
.long 0x61cd,0x1e,0x4330,0x4370,0x43b0,0x43f0,4,4,4,4,4,4,4,4,4,4,4,4,4,4,4,4,4,4,4,4,4,4,4,4,4,4
.long 0x1dd,0x71d5,0xe,0x5090,0x5150,0x1e,0x5210,0x52d0,4,4,4,4,4,4,4,4,4,4,4,4,4,4,4,4,4,4,4,4,4,4,4,4
.long 0x11dd,0x61d5,0xd6,0x30,0x90,0xf0,0x150,0x1b0,0x210,0x270,0x2d0,0x330,0x390,0x3f0,4,4,4,4,4,4,4,4,4,4,4,4,4,4,4,4,4,4
.long 0x21dd,0x51d5,0x1d5,0xe,0x50a0,0x5160,0x1e,0x5220,0x52e0,4,4,4,4,4,4,4,4,4,4,4,4,4,4,4,4,4,4,4,4,4,4,4
.long 0x31dd,0x41d5,0x11d5,0xe,0x50b0,0x5170,0x1e,0x5230,0x52f0,4,4,4,4,4,4,4,4,4,4,4,4,4,4,4,4,4,4,4,4,4,4,4
.long 0x41dd,0x31d5,0xd6,0x50,0xb0,0x110,0x170,0x1d0,0x230,0x290,0x2f0,0x350,0x3b0,4,4,4,4,4,4,4,4,4,4,4,4,4,4,4,4,4,4,4
.long 0x51dd,0x21d5,0xd6,0x10,0x70,0xd0,0x130,0x190,0x1f0,0x250,0x2b0,0x310,0x370,0x3d0,4,4,4,4,4,4,4,4,4,4,4,4,4,4,4,4,4,4
.long 0x61dd,0x1e,0x5330,0x5370,0x53b0,0x53f0,4,4,4,4,4,4,4,4,4,4,4,4,4,4,4,4,4,4,4,4,4,4,4,4,4,4
.long 0x1ed,0x71e5,0xe,0x6090,0x6150,0x1e,0x6210,0x62d0,4,4,4,4,4,4,4,4,4,4,4,4,4,4,4,4,4,4,4,4,4,4,4,4
.long 0x11ed,0x61e5,0xe6,0x30,0x90,0xf0,0x150,0x1b0,0x210,0x270,0x2d0,0x330,0x390,0x3f0,4,4,4,4,4,4,4,4,4,4,4,4,4,4,4,4,4,4
.long 0x21ed,0x51e5,0x1e5,0xe,0x60a0,0x6160,0x1e,0x6220,0x62e0,4,4,4,4,4,4,4,4,4,4,4,4,4,4,4,4,4,4,4,4,4,4,4
.long 0x31ed,0x41e5,0x11e5,0xe,0x60b0,0x6170,0x1e,0x6230,0x62f0,4,4,4,4,4,4,4,4,4,4,4,4,4,4,4,4,4,4,4,4,4,4,4
.long 0x41ed,0x31e5,0xe6,0x50,0xb0,0x110,0x170,0x1d0,0x230,0x290,0x2f0,0x350,0x3b0,4,4,4,4,4,4,4,4,4,4,4,4,4,4,4,4,4,4,4
.long 0x51ed,0x21e5,0xe6,0x10,0x70,0xd0,0x130,0x190,0x1f0,0x250,0x2b0,0x310,0x370,0x3d0,4,4,4,4,4,4,4,4,4,4,4,4,4,4,4,4,4,4
.long 0x61ed,0x1e,0x6330,0x6370,0x63b0,0x63f0,4,4,4,4,4,4,4,4,4,4,4,4,4,4,4,4,4,4,4,4,4,4,4,4,4,4
.long 0x1fd,0x71f5,0xe,0x7090,0x7150,0x1e,0x7210,0x72d0,4,4,4,4,4,4,4,4,4,4,4,4,4,4,4,4,4,4,4,4,4,4,4,4
.long 0x11fd,0x61f5,0xf6,0x30,0x90,0xf0,0x150,0x1b0,0x210,0x270,0x2d0,0x330,0x390,0x3f0,4,4,4,4,4,4,4,4,4,4,4,4,4,4,4,4,4,4
.long 0x21fd,0x51f5,0x1f5,0xe,0x70a0,0x7160,0x1e,0x7220,0x72e0,4,4,4,4,4,4,4,4,4,4,4,4,4,4,4,4,4,4,4,4,4,4,4
.long 0x31fd,0x41f5,0x11f5,0xe,0x70b0,0x7170,0x1e,0x7230,0x72f0,4,4,4,4,4,4,4,4,4,4,4,4,4,4,4,4,4,4,4,4,4,4,4
.long 0x41fd,0x31f5,0xf6,0x50,0xb0,0x110,0x170,0x1d0,0x230,0x290,0x2f0,0x350,0x3b0,4,4,4,4,4,4,4,4,4,4,4,4,4,4,4,4,4,4,4
.long 0x51fd,0x21f5,0xf6,0x10,0x70,0xd0,0x130,0x190,0x1f0,0x250,0x2b0,0x310,0x370,0x3d0,4,4,4,4,4,4,4,4,4,4,4,4,4,4,4,4,4,4
.long 0x61fd,0x1e,0x7330,0x7370,0x73b0,0x73f0,4,4,4,4,4,4,4,4,4,4,4,4,4,4,4,4,4,4,4,4,4,4,4,4,4,4
.section .rodata,"a"
.p2align 6
.amdhsa_kernel gated_mix__compressed_kv_cla__memory_aug_recurrent_mem_tr__prompt_kernel
  .amdhsa_next_free_vgpr 512
  .amdhsa_next_free_sgpr 102
  .amdhsa_accum_offset 256
  .amdhsa_group_segment_fixed_size 0
  .amdhsa_kernarg_size 136
  .amdhsa_user_sgpr_count 2
  .amdhsa_user_sgpr_kernarg_segment_ptr 1
  .amdhsa_system_sgpr_workgroup_id_x 1
  .amdhsa_float_denorm_mode_32 3
.end_amdhsa_kernel
```

```asm
; @launch grid=(256,1,1) block=(256,1,1) lds=163840
.amdgcn_target "amdgcn-amd-amdhsa--gfx950"
.text
.globl gated_mix__compressed_kv_cla__memory_aug_recurrent_mem_tr__prompt_kernel
.p2align 8
.type gated_mix__compressed_kv_cla__memory_aug_recurrent_mem_tr__prompt_kernel,@function
gated_mix__compressed_kv_cla__memory_aug_recurrent_mem_tr__prompt_kernel:
  s_cmp_ge_u32 s2, 256
  s_cbranch_scc1 L_exit
  s_load_dwordx16 s[8:23], s[0:1], 0
  s_load_dwordx16 s[24:39], s[0:1], 64
  s_load_dwordx2 s[40:41], s[0:1], 128
  s_and_b32 s47, s2, 7
  s_lshr_b32 s45, s2, 3
  s_max_u32 s3, s47, 1
  s_sub_u32 s3, s3, 1
  s_lshl_b32 s3, s3, 5
  s_add_u32 s94, s3, s45
  s_getpc_b64 s[4:5]
L_pc0:
  s_add_u32 s4, s4, L_ptab-L_pc0
  s_addc_u32 s5, s5, 0
  s_lshl_b32 s3, s94, 7
  v_and_b32 v2, 31, v0
  v_lshl_add_u32 v2, v2, 2, s3
  global_load_dword v1, v2, s[4:5]
  s_getreg_b32 s46, hwreg(HW_REG_XCC_ID, 0, 4)
  v_lshrrev_b32 v3, 6, v0
  v_and_b32 v0, 63, v0
  v_readfirstlane_b32 s44, v3
  s_sub_u32 s4, s4, L_ptab-L_pc0
  s_subb_u32 s5, s5, 0
  s_and_b32 s3, s45, 15
  s_lshl_b32 s3, s3, 13
  v_lshl_add_u32 v2, v0, 7, s3
  v_min_u32 v2, L_ptab-L_pc0, v2
  s_cmp_lg_u32 s44, 3
  s_cbranch_scc1 L_nocodepf
  global_load_dword v31, v2, s[4:5]
L_nocodepf:
  s_and_b32 s46, s46, 7
  s_waitcnt lgkmcnt(0)
  s_add_u32 s40, s40, 0x0
  s_addc_u32 s41, s41, 0
  s_and_b32 s41, s41, 0xffff
  s_mov_b32 s42, 0x10000000
  s_mov_b32 s43, 0x20000
  s_cmp_eq_u32 s47, 0
  s_cbranch_scc1 L_team
  s_lshl2_add_u32 s3, s94, s44
  v_lshlrev_b32 v2, 7, v0
  s_mov_b32 s95, 0
  s_mov_b32 s50, 0x200000
  s_mov_b32 s51, 0x20000
  s_waitcnt vmcnt(0)
L_next:
  v_readlane_b32 s3, v1, s95
  s_add_u32 s95, s95, 1
  s_nop 0
  s_and_b32 s4, s3, 3
  s_cmp_eq_u32 s4, 0
  s_cbranch_scc1 L_after_p
  s_cmp_eq_u32 s4, 2
  s_cbranch_scc1 L_go_outx
L_go_att:
  s_bfe_u32 s56, s3, 0x50004
  s_bfe_u32 s57, s3, 0x3000c
  s_bitcmp1_b32 s3, 3
  s_cbranch_scc1 L_feed
L_att:
  v_lshlrev_b32 v2, 4, v0
  s_lshl_b32 s65, s44, 11
  v_add_u32 v3, s65, v2
  s_mov_b32 s74, 0
  v_and_b32 v6, 7, v0
  s_lshl3_add_u32 s67, s57, 8
  v_lshlrev_b32 v7, 4, v6
  v_sub_u32 v7, s67, v7
  v_med3_i32 v7, v7, 0, 16
  s_lshl_b32 s66, s56, 7
  s_add_u32 s66, s66, 0xd080000
  v_lshl_add_u32 v6, v6, 2, s66
  s_bfe_u32 m0, s3, 0x30010
  s_bfe_u32 s67, s3, 0x60014
  s_nop 0
  v_writelane_b32 v7, s67, m0
  s_lshl_b32 s66, s57, 7
  s_add_u32 s66, s66, 0xd086400
  v_writelane_b32 v6, s66, 63
  v_writelane_b32 v7, 16, 63
  buffer_load_dword v24, v6, s[40:43], 0 offen sc1
  v_mov_b64 v[128:129], 0
  v_mov_b64 v[130:131], 0
  v_mov_b64 v[132:133], 0
  v_mov_b64 v[134:135], 0
  v_mov_b64 v[136:137], 0
  v_mov_b64 v[138:139], 0
  v_mov_b64 v[140:141], 0
  v_mov_b64 v[142:143], 0
  v_mov_b64 v[144:145], 0
  v_mov_b64 v[146:147], 0
  v_mov_b64 v[148:149], 0
  v_mov_b64 v[150:151], 0
  v_mov_b64 v[152:153], 0
  v_mov_b64 v[154:155], 0
  v_mov_b64 v[156:157], 0
  v_mov_b64 v[158:159], 0
  v_mov_b64 v[160:161], 0
  v_mov_b64 v[162:163], 0
  v_mov_b64 v[164:165], 0
  v_mov_b64 v[166:167], 0
  v_mov_b64 v[168:169], 0
  v_mov_b64 v[170:171], 0
  v_mov_b64 v[172:173], 0
  v_mov_b64 v[174:175], 0
  v_mov_b64 v[176:177], 0
  v_mov_b64 v[178:179], 0
  v_mov_b64 v[180:181], 0
  v_mov_b64 v[182:183], 0
  v_mov_b64 v[184:185], 0
  v_mov_b64 v[186:187], 0
  v_mov_b64 v[188:189], 0
  v_mov_b64 v[190:191], 0
  v_mov_b64 v[192:193], 0
  v_mov_b64 v[194:195], 0
  v_mov_b64 v[196:197], 0
  v_mov_b64 v[198:199], 0
  v_mov_b64 v[200:201], 0
  v_mov_b64 v[202:203], 0
  v_mov_b64 v[204:205], 0
  v_mov_b64 v[206:207], 0
  v_mov_b64 v[208:209], 0
  v_mov_b64 v[210:211], 0
  v_mov_b64 v[212:213], 0
  v_mov_b64 v[214:215], 0
  v_mov_b64 v[216:217], 0
  v_mov_b64 v[218:219], 0
  v_mov_b64 v[220:221], 0
  v_mov_b64 v[222:223], 0
  v_mov_b64 v[224:225], 0
  v_mov_b64 v[226:227], 0
  v_mov_b64 v[228:229], 0
  v_mov_b64 v[230:231], 0
  v_mov_b64 v[232:233], 0
  v_mov_b64 v[234:235], 0
  v_mov_b64 v[236:237], 0
  v_mov_b64 v[238:239], 0
  v_mov_b64 v[240:241], 0
  v_mov_b64 v[242:243], 0
  v_mov_b64 v[244:245], 0
  v_mov_b64 v[246:247], 0
  v_mov_b64 v[248:249], 0
  v_mov_b64 v[250:251], 0
  v_mov_b64 v[252:253], 0
  v_mov_b64 v[254:255], 0
  v_mov_b64 v[96:97], 0
  v_accvgpr_write_b32 a128, 0
  v_mov_b64 v[98:99], 0
  v_accvgpr_write_b32 a129, 0
  v_mov_b64 v[100:101], 0
  v_accvgpr_write_b32 a130, 0
  v_mov_b64 v[102:103], 0
  v_accvgpr_write_b32 a131, 0
  v_mov_b64 v[104:105], 0
  v_accvgpr_write_b32 a132, 0
  v_mov_b64 v[106:107], 0
  v_accvgpr_write_b32 a133, 0
  v_mov_b64 v[108:109], 0
  v_accvgpr_write_b32 a134, 0
  v_mov_b64 v[110:111], 0
  v_accvgpr_write_b32 a135, 0
  v_mov_b64 v[112:113], 0
  v_accvgpr_write_b32 a136, 0
  v_mov_b64 v[114:115], 0
  v_accvgpr_write_b32 a137, 0
  v_mov_b64 v[116:117], 0
  v_accvgpr_write_b32 a138, 0
  v_mov_b64 v[118:119], 0
  v_accvgpr_write_b32 a139, 0
  v_mov_b64 v[120:121], 0
  v_accvgpr_write_b32 a140, 0
  v_mov_b64 v[122:123], 0
  v_accvgpr_write_b32 a141, 0
  v_mov_b64 v[124:125], 0
  v_accvgpr_write_b32 a142, 0
  v_mov_b64 v[126:127], 0
  v_accvgpr_write_b32 a143, 0
  v_mov_b32 v16, 0x3f803f80
  v_mov_b32 v17, 0x3f803f80
  v_mov_b32 v18, 0x3f803f80
  v_mov_b32 v19, 0x3f803f80
  s_mov_b32 s48, s18
  s_and_b32 s49, s19, 0xffff
  s_mov_b32 s50, 0x400000
  s_mov_b32 s51, 0x20000
  s_lshl_b32 s66, s56, 19
  s_add_u32 s60, s66, 0x1000000
  s_add_u32 s61, s66, 0x2000000
  s_lshl_b32 s59, s57, 3
  s_lshr_b32 s67, s44, 1
  s_add_u32 s67, s67, s59
  s_lshl_b32 s68, s67, 13
  s_add_u32 s68, s68, s66
  s_and_b32 s67, s44, 1
  s_lshl_b32 s67, s67, 10
  s_add_u32 s68, s68, s67
  s_lshl4_add_u32 s69, s57, s44
  s_add_u32 s63, s59, 7
  s_lshl_b32 s63, s63, 13
  s_add_u32 s63, s63, s60
  s_sub_u32 s59, s59, 1
  s_add_u32 s62, s60, 0x4000
  s_mov_b32 s64, 0
  s_mov_b32 s70, 0x40004000
  s_lshl_b32 s73, s44, 12
  s_lshl_b32 s72, s56, 17
  s_lshl_b32 s67, s44, 15
  s_add_u32 s72, s72, s67
  v_lshrrev_b32 v8, 4, v0
  v_and_b32 v9, 15, v0
  s_lshl_b32 s67, s44, 4
  v_add_u32 v25, s67, v9
  v_lshlrev_b32 v10, 2, v8
  v_sub_u32 v25, v25, v10
  v_lshlrev_b32 v8, 1, v8
  v_and_b32 v10, 7, v0
  v_xor_b32 v8, v8, v10
  v_lshlrev_b32 v8, 4, v8
  v_lshrrev_b32 v10, 3, v0
  v_lshl_add_u32 v26, v10, 10, v8
  v_lshlrev_b32 v9, 2, v9
  v_add_u32 v4, 122880, v2
L_a_wait:
  s_waitcnt vmcnt(0)
  v_cmp_gt_u32 vcc, v7, v24
  s_cbranch_vccz L_a_go
  buffer_load_dword v24, v6, s[40:43], 0 offen sc1
  s_add_u32 s74, s74, 1
  s_cmp_gt_u32 s74, 1048576
  s_cbranch_scc1 L_exit
  s_branch L_a_wait
L_a_go:
  s_add_u32 m0, s65, 131072
  s_add_u32 s66, s60, 0x2000
  buffer_load_dwordx4 v3, s[40:43], s60 offen sc1 lds
  buffer_load_dwordx4 v3, s[40:43], s60 offen offset:1024 sc1 lds
  s_add_u32 m0, s65, 139264
  s_lshl_b32 s67, s69, 6
  buffer_load_dwordx4 v3, s[40:43], s66 offen sc1 lds
  buffer_load_dwordx4 v3, s[40:43], s66 offen offset:1024 sc1 lds
  s_add_u32 s67, s67, 0xd0c0000
  s_add_u32 s58, s68, 0x1000
  buffer_load_dwordx4 a[0:3], v2, s[40:43], s68 offen offset:0 sc1
  buffer_load_dwordx4 a[4:7], v2, s[40:43], s68 offen offset:2048 sc1
  buffer_load_dwordx4 a[8:11], v2, s[40:43], s58 offen offset:0 sc1
  buffer_load_dwordx4 a[12:15], v2, s[40:43], s58 offen offset:2048 sc1
  s_add_u32 s68, s68, 0x4000
  s_add_u32 s58, s68, 0x1000
  buffer_load_dwordx4 a[16:19], v2, s[40:43], s68 offen offset:0 sc1
  buffer_load_dwordx4 a[20:23], v2, s[40:43], s68 offen offset:2048 sc1
  buffer_load_dwordx4 a[24:27], v2, s[40:43], s58 offen offset:0 sc1
  buffer_load_dwordx4 a[28:31], v2, s[40:43], s58 offen offset:2048 sc1
  s_add_u32 s68, s68, 0x4000
  s_add_u32 s58, s68, 0x1000
  buffer_load_dwordx4 a[32:35], v2, s[40:43], s68 offen offset:0 sc1
  buffer_load_dwordx4 a[36:39], v2, s[40:43], s68 offen offset:2048 sc1
  buffer_load_dwordx4 a[40:43], v2, s[40:43], s58 offen offset:0 sc1
  buffer_load_dwordx4 a[44:47], v2, s[40:43], s58 offen offset:2048 sc1
  s_add_u32 s68, s68, 0x4000
  s_add_u32 s58, s68, 0x1000
  buffer_load_dwordx4 a[48:51], v2, s[40:43], s68 offen offset:0 sc1
  buffer_load_dwordx4 a[52:55], v2, s[40:43], s68 offen offset:2048 sc1
  buffer_load_dwordx4 a[56:59], v2, s[40:43], s58 offen offset:0 sc1
  buffer_load_dwordx4 a[60:63], v2, s[40:43], s58 offen offset:2048 sc1
  s_add_u32 s68, s68, 0x4000
  buffer_load_dword v20, v9, s[40:43], s67 offen offset:0 sc1
  buffer_load_dword v21, v9, s[40:43], s67 offen offset:256 sc1
  buffer_load_dword v22, v9, s[40:43], s67 offen offset:512 sc1
  buffer_load_dword v23, v9, s[40:43], s67 offen offset:768 sc1
  s_add_u32 m0, s64, s65
  s_nop 0
  buffer_load_dwordx4 v3, s[40:43], s61 offen sc1 lds
  s_min_u32 s66, s62, s63
  s_nop 0
  buffer_load_dwordx4 v3, s[40:43], s61 offen offset:1024 sc1 lds
  s_add_u32 m0, m0, 0x2000
  s_nop 0
  buffer_load_dwordx4 v3, s[40:43], s66 offen sc1 lds
  s_add_u32 s61, s61, 0x2000
  s_nop 0
  buffer_load_dwordx4 v3, s[40:43], s66 offen offset:1024 sc1 lds
  s_add_u32 s62, s62, 0x2000
  s_add_u32 s64, s64, 0x4000
  s_and_b32 s64, s64, 0x1ffff
  s_add_u32 m0, s64, s65
  s_nop 0
  buffer_load_dwordx4 v3, s[40:43], s61 offen sc1 lds
  s_min_u32 s66, s62, s63
  s_nop 0
  buffer_load_dwordx4 v3, s[40:43], s61 offen offset:1024 sc1 lds
  s_add_u32 m0, m0, 0x2000
  s_nop 0
  buffer_load_dwordx4 v3, s[40:43], s66 offen sc1 lds
  s_add_u32 s61, s61, 0x2000
  s_nop 0
  buffer_load_dwordx4 v3, s[40:43], s66 offen offset:1024 sc1 lds
  s_add_u32 s62, s62, 0x2000
  s_add_u32 s64, s64, 0x4000
  s_and_b32 s64, s64, 0x1ffff
  s_mul_i32 s69, s69, 786432
  s_lshl_b32 s67, s56, 14
  s_add_u32 s69, s69, s67
  s_add_u32 s76, s69, 0x6000000
  s_add_u32 s77, s69, 0x6300000
  s_add_u32 s78, s69, 0x6600000
  s_add_u32 s79, s69, 0x6900000
  v_mov_b32 v24, 0xff800000
  s_cmp_lg_u32 s57, 0
  s_cbranch_scc1 L_a_nomask0
  v_cmp_gt_i32 s[80:81], 0, v25
  v_cmp_gt_i32 s[82:83], 1, v25
  v_cmp_gt_i32 s[84:85], 2, v25
  v_cmp_gt_i32 s[86:87], 3, v25
  v_cndmask_b32 v96, v96, v24, s[80:81]
  v_cndmask_b32 v97, v97, v24, s[82:83]
  v_cndmask_b32 v98, v98, v24, s[84:85]
  v_cndmask_b32 v99, v99, v24, s[86:87]
  v_cmp_gt_i32 s[80:81], 16, v25
  v_cmp_gt_i32 s[82:83], 17, v25
  v_cmp_gt_i32 s[84:85], 18, v25
  v_cmp_gt_i32 s[86:87], 19, v25
  v_cndmask_b32 v100, v100, v24, s[80:81]
  v_cndmask_b32 v101, v101, v24, s[82:83]
  v_cndmask_b32 v102, v102, v24, s[84:85]
  v_cndmask_b32 v103, v103, v24, s[86:87]
L_a_nomask0:
  s_waitcnt vmcnt(28)
  s_barrier
  ds_read_b128 a[64:67], v4 offset:8192
  ds_read_b128 a[68:71], v4 offset:9216
  ds_read_b128 a[72:75], v4 offset:10240
  ds_read_b128 a[76:79], v4 offset:11264
  ds_read_b128 a[80:83], v4 offset:12288
  ds_read_b128 a[84:87], v4 offset:13312
  ds_read_b128 a[88:91], v4 offset:14336
  ds_read_b128 a[92:95], v4 offset:15360
  v_add_u32 v4, 0x2000, v4
  s_waitcnt vmcnt(24) lgkmcnt(0)
  v_mfma_f32_16x16x32_bf16 v[32:35], a[64:67], a[0:3], v[96:99]
  v_mfma_f32_16x16x32_bf16 v[32:35], a[72:75], a[4:7], v[32:35]
  v_mfma_f32_16x16x32_bf16 v[32:35], a[80:83], a[8:11], v[32:35]
  v_mfma_f32_16x16x32_bf16 v[32:35], a[88:91], a[12:15], v[32:35]
  v_mfma_f32_16x16x32_bf16 v[36:39], a[68:71], a[0:3], v[100:103]
  v_mfma_f32_16x16x32_bf16 v[36:39], a[76:79], a[4:7], v[36:39]
  v_mfma_f32_16x16x32_bf16 v[36:39], a[84:87], a[8:11], v[36:39]
  v_mfma_f32_16x16x32_bf16 v[36:39], a[92:95], a[12:15], v[36:39]
  s_waitcnt vmcnt(20) lgkmcnt(0)
  v_mfma_f32_16x16x32_bf16 v[40:43], a[64:67], a[16:19], v[104:107]
  v_mfma_f32_16x16x32_bf16 v[40:43], a[72:75], a[20:23], v[40:43]
  v_mfma_f32_16x16x32_bf16 v[40:43], a[80:83], a[24:27], v[40:43]
  v_mfma_f32_16x16x32_bf16 v[40:43], a[88:91], a[28:31], v[40:43]
  v_mfma_f32_16x16x32_bf16 v[44:47], a[68:71], a[16:19], v[108:111]
  v_mfma_f32_16x16x32_bf16 v[44:47], a[76:79], a[20:23], v[44:47]
  v_mfma_f32_16x16x32_bf16 v[44:47], a[84:87], a[24:27], v[44:47]
  v_mfma_f32_16x16x32_bf16 v[44:47], a[92:95], a[28:31], v[44:47]
  s_waitcnt vmcnt(16) lgkmcnt(0)
  v_mfma_f32_16x16x32_bf16 v[48:51], a[64:67], a[32:35], v[112:115]
  v_mfma_f32_16x16x32_bf16 v[48:51], a[72:75], a[36:39], v[48:51]
  v_mfma_f32_16x16x32_bf16 v[48:51], a[80:83], a[40:43], v[48:51]
  v_mfma_f32_16x16x32_bf16 v[48:51], a[88:91], a[44:47], v[48:51]
  v_mfma_f32_16x16x32_bf16 v[52:55], a[68:71], a[32:35], v[116:119]
  v_mfma_f32_16x16x32_bf16 v[52:55], a[76:79], a[36:39], v[52:55]
  v_mfma_f32_16x16x32_bf16 v[52:55], a[84:87], a[40:43], v[52:55]
  v_mfma_f32_16x16x32_bf16 v[52:55], a[92:95], a[44:47], v[52:55]
  s_waitcnt vmcnt(12) lgkmcnt(0)
  v_mfma_f32_16x16x32_bf16 v[56:59], a[64:67], a[48:51], v[120:123]
  v_mfma_f32_16x16x32_bf16 v[56:59], a[72:75], a[52:55], v[56:59]
  v_mfma_f32_16x16x32_bf16 v[56:59], a[80:83], a[56:59], v[56:59]
  v_mfma_f32_16x16x32_bf16 v[56:59], a[88:91], a[60:63], v[56:59]
  v_mfma_f32_16x16x32_bf16 v[60:63], a[68:71], a[48:51], v[124:127]
  v_mfma_f32_16x16x32_bf16 v[60:63], a[76:79], a[52:55], v[60:63]
  v_mfma_f32_16x16x32_bf16 v[60:63], a[84:87], a[56:59], v[60:63]
  v_mfma_f32_16x16x32_bf16 v[60:63], a[92:95], a[60:63], v[60:63]
  ds_read_b128 a[64:67], v4 offset:8192
  ds_read_b128 a[68:71], v4 offset:9216
  ds_read_b128 a[72:75], v4 offset:10240
  ds_read_b128 a[76:79], v4 offset:11264
  ds_read_b128 a[80:83], v4 offset:12288
  ds_read_b128 a[84:87], v4 offset:13312
  ds_read_b128 a[88:91], v4 offset:14336
  ds_read_b128 a[92:95], v4 offset:15360
  v_mov_b32 v4, v2
  s_add_u32 m0, s64, s65
  s_nop 0
  buffer_load_dwordx4 v3, s[40:43], s61 offen sc1 lds
  s_min_u32 s66, s62, s63
  s_nop 0
  buffer_load_dwordx4 v3, s[40:43], s61 offen offset:1024 sc1 lds
  s_add_u32 m0, m0, 0x2000
  s_nop 0
  buffer_load_dwordx4 v3, s[40:43], s66 offen sc1 lds
  s_add_u32 s61, s61, 0x2000
  s_nop 0
  buffer_load_dwordx4 v3, s[40:43], s66 offen offset:1024 sc1 lds
  s_add_u32 s62, s62, 0x2000
  s_add_u32 s64, s64, 0x4000
  s_and_b32 s64, s64, 0x1ffff
  v_max3_f32 v6, v32, v33, v34
  v_max3_f32 v7, v35, v36, v37
  v_max3_f32 v6, v6, v38, v39
  v_max_f32 v6, v6, v7
  v_mov_b32 v7, v6
  s_nop 1
  v_permlane32_swap_b32 v7, v6
  v_max_f32 v6, v6, v7
  v_mov_b32 v7, v6
  s_nop 1
  v_permlane16_swap_b32 v7, v6
  v_max_f32 v6, v6, v7
  v_add_f32 v6, 0x41800000, v6
  v_sub_f32 v96, v96, v6
  v_sub_f32 v97, v97, v6
  v_sub_f32 v98, v98, v6
  v_sub_f32 v99, v99, v6
  v_sub_f32 v100, v100, v6
  v_sub_f32 v101, v101, v6
  v_sub_f32 v102, v102, v6
  v_sub_f32 v103, v103, v6
  v_sub_f32 v8, v32, v6
  v_sub_f32 v9, v33, v6
  v_sub_f32 v10, v34, v6
  v_sub_f32 v11, v35, v6
  v_sub_f32 v12, v36, v6
  v_sub_f32 v13, v37, v6
  v_sub_f32 v14, v38, v6
  v_sub_f32 v15, v39, v6
  v_exp_f32 v8, v8
  v_exp_f32 v9, v9
  v_exp_f32 v10, v10
  v_exp_f32 v11, v11
  v_exp_f32 v12, v12
  v_exp_f32 v13, v13
  v_exp_f32 v14, v14
  v_exp_f32 v15, v15
  v_cvt_pk_bf16_f32 v64, v8, v9
  v_cvt_pk_bf16_f32 v65, v10, v11
  v_cvt_pk_bf16_f32 v66, v12, v13
  v_cvt_pk_bf16_f32 v67, v14, v15
  s_add_u32 m0, s64, s65
  s_nop 0
  buffer_load_dwordx4 v3, s[40:43], s61 offen sc1 lds
  s_min_u32 s66, s62, s63
  s_nop 0
  buffer_load_dwordx4 v3, s[40:43], s61 offen offset:1024 sc1 lds
  s_add_u32 m0, m0, 0x2000
  s_nop 0
  buffer_load_dwordx4 v3, s[40:43], s66 offen sc1 lds
  s_add_u32 s61, s61, 0x2000
  s_nop 0
  buffer_load_dwordx4 v3, s[40:43], s66 offen offset:1024 sc1 lds
  s_add_u32 s62, s62, 0x2000
  s_add_u32 s64, s64, 0x4000
  s_and_b32 s64, s64, 0x1ffff
  v_max3_f32 v6, v40, v41, v42
  v_max3_f32 v7, v43, v44, v45
  v_max3_f32 v6, v6, v46, v47
  v_max_f32 v6, v6, v7
  v_mov_b32 v7, v6
  s_nop 1
  v_permlane32_swap_b32 v7, v6
  v_max_f32 v6, v6, v7
  v_mov_b32 v7, v6
  s_nop 1
  v_permlane16_swap_b32 v7, v6
  v_max_f32 v6, v6, v7
  v_add_f32 v6, 0x41800000, v6
  v_sub_f32 v104, v104, v6
  v_sub_f32 v105, v105, v6
  v_sub_f32 v106, v106, v6
  v_sub_f32 v107, v107, v6
  v_sub_f32 v108, v108, v6
  v_sub_f32 v109, v109, v6
  v_sub_f32 v110, v110, v6
  v_sub_f32 v111, v111, v6
  v_sub_f32 v8, v40, v6
  v_sub_f32 v9, v41, v6
  v_sub_f32 v10, v42, v6
  v_sub_f32 v11, v43, v6
  v_sub_f32 v12, v44, v6
  v_sub_f32 v13, v45, v6
  v_sub_f32 v14, v46, v6
  v_sub_f32 v15, v47, v6
  v_exp_f32 v8, v8
  v_exp_f32 v9, v9
  v_exp_f32 v10, v10
  v_exp_f32 v11, v11
  v_exp_f32 v12, v12
  v_exp_f32 v13, v13
  v_exp_f32 v14, v14
  v_exp_f32 v15, v15
  v_cvt_pk_bf16_f32 v68, v8, v9
  v_cvt_pk_bf16_f32 v69, v10, v11
  v_cvt_pk_bf16_f32 v70, v12, v13
  v_cvt_pk_bf16_f32 v71, v14, v15
  s_add_u32 m0, s64, s65
  s_nop 0
  buffer_load_dwordx4 v3, s[40:43], s61 offen sc1 lds
  s_min_u32 s66, s62, s63
  s_nop 0
  buffer_load_dwordx4 v3, s[40:43], s61 offen offset:1024 sc1 lds
  s_add_u32 m0, m0, 0x2000
  s_nop 0
  buffer_load_dwordx4 v3, s[40:43], s66 offen sc1 lds
  s_add_u32 s61, s61, 0x2000
  s_nop 0
  buffer_load_dwordx4 v3, s[40:43], s66 offen offset:1024 sc1 lds
  s_add_u32 s62, s62, 0x2000
  s_add_u32 s64, s64, 0x4000
  s_and_b32 s64, s64, 0x1ffff
  v_max3_f32 v6, v48, v49, v50
  v_max3_f32 v7, v51, v52, v53
  v_max3_f32 v6, v6, v54, v55
  v_max_f32 v6, v6, v7
  v_mov_b32 v7, v6
  s_nop 1
  v_permlane32_swap_b32 v7, v6
  v_max_f32 v6, v6, v7
  v_mov_b32 v7, v6
  s_nop 1
  v_permlane16_swap_b32 v7, v6
  v_max_f32 v6, v6, v7
  v_add_f32 v6, 0x41800000, v6
  v_sub_f32 v112, v112, v6
  v_sub_f32 v113, v113, v6
  v_sub_f32 v114, v114, v6
  v_sub_f32 v115, v115, v6
  v_sub_f32 v116, v116, v6
  v_sub_f32 v117, v117, v6
  v_sub_f32 v118, v118, v6
  v_sub_f32 v119, v119, v6
  v_sub_f32 v8, v48, v6
  v_sub_f32 v9, v49, v6
  v_sub_f32 v10, v50, v6
  v_sub_f32 v11, v51, v6
  v_sub_f32 v12, v52, v6
  v_sub_f32 v13, v53, v6
  v_sub_f32 v14, v54, v6
  v_sub_f32 v15, v55, v6
  v_exp_f32 v8, v8
  v_exp_f32 v9, v9
  v_exp_f32 v10, v10
  v_exp_f32 v11, v11
  v_exp_f32 v12, v12
  v_exp_f32 v13, v13
  v_exp_f32 v14, v14
  v_exp_f32 v15, v15
  v_cvt_pk_bf16_f32 v72, v8, v9
  v_cvt_pk_bf16_f32 v73, v10, v11
  v_cvt_pk_bf16_f32 v74, v12, v13
  v_cvt_pk_bf16_f32 v75, v14, v15
  s_add_u32 m0, s64, s65
  s_nop 0
  buffer_load_dwordx4 v3, s[40:43], s61 offen sc1 lds
  s_min_u32 s66, s62, s63
  s_nop 0
  buffer_load_dwordx4 v3, s[40:43], s61 offen offset:1024 sc1 lds
  s_add_u32 m0, m0, 0x2000
  s_nop 0
  buffer_load_dwordx4 v3, s[40:43], s66 offen sc1 lds
  s_add_u32 s61, s61, 0x2000
  s_nop 0
  buffer_load_dwordx4 v3, s[40:43], s66 offen offset:1024 sc1 lds
  s_add_u32 s62, s62, 0x2000
  s_add_u32 s64, s64, 0x4000
  s_and_b32 s64, s64, 0x1ffff
  v_max3_f32 v6, v56, v57, v58
  v_max3_f32 v7, v59, v60, v61
  v_max3_f32 v6, v6, v62, v63
  v_max_f32 v6, v6, v7
  v_mov_b32 v7, v6
  s_nop 1
  v_permlane32_swap_b32 v7, v6
  v_max_f32 v6, v6, v7
  v_mov_b32 v7, v6
  s_nop 1
  v_permlane16_swap_b32 v7, v6
  v_max_f32 v6, v6, v7
  v_add_f32 v6, 0x41800000, v6
  v_sub_f32 v120, v120, v6
  v_sub_f32 v121, v121, v6
  v_sub_f32 v122, v122, v6
  v_sub_f32 v123, v123, v6
  v_sub_f32 v124, v124, v6
  v_sub_f32 v125, v125, v6
  v_sub_f32 v126, v126, v6
  v_sub_f32 v127, v127, v6
  v_sub_f32 v8, v56, v6
  v_sub_f32 v9, v57, v6
  v_sub_f32 v10, v58, v6
  v_sub_f32 v11, v59, v6
  v_sub_f32 v12, v60, v6
  v_sub_f32 v13, v61, v6
  v_sub_f32 v14, v62, v6
  v_sub_f32 v15, v63, v6
  v_exp_f32 v8, v8
  v_exp_f32 v9, v9
  v_exp_f32 v10, v10
  v_exp_f32 v11, v11
  v_exp_f32 v12, v12
  v_exp_f32 v13, v13
  v_exp_f32 v14, v14
  v_exp_f32 v15, v15
  v_cvt_pk_bf16_f32 v76, v8, v9
  v_cvt_pk_bf16_f32 v77, v10, v11
  v_cvt_pk_bf16_f32 v78, v12, v13
  v_cvt_pk_bf16_f32 v79, v14, v15
  s_add_u32 m0, s64, s65
  s_nop 0
  buffer_load_dwordx4 v3, s[40:43], s61 offen sc1 lds
  s_min_u32 s66, s62, s63
  s_nop 0
  buffer_load_dwordx4 v3, s[40:43], s61 offen offset:1024 sc1 lds
  s_add_u32 m0, m0, 0x2000
  s_nop 0
  buffer_load_dwordx4 v3, s[40:43], s66 offen sc1 lds
  s_add_u32 s61, s61, 0x2000
  s_nop 0
  buffer_load_dwordx4 v3, s[40:43], s66 offen offset:1024 sc1 lds
  s_add_u32 s62, s62, 0x2000
  s_add_u32 s64, s64, 0x4000
  s_and_b32 s64, s64, 0x1ffff
  s_mov_b32 s58, 0
  s_cmp_lg_u32 s57, 0
  s_cbranch_scc1 L_a_s0
  v_cmp_gt_i32 s[80:81], 32, v25
  v_cmp_gt_i32 s[82:83], 33, v25
  v_cmp_gt_i32 s[84:85], 34, v25
  v_cmp_gt_i32 s[86:87], 35, v25
  v_cndmask_b32 v96, v96, v24, s[80:81]
  v_cndmask_b32 v97, v97, v24, s[82:83]
  v_cndmask_b32 v98, v98, v24, s[84:85]
  v_cndmask_b32 v99, v99, v24, s[86:87]
  v_cmp_gt_i32 s[80:81], 48, v25
  v_cmp_gt_i32 s[82:83], 49, v25
  v_cmp_gt_i32 s[84:85], 50, v25
  v_cmp_gt_i32 s[86:87], 51, v25
  v_cndmask_b32 v100, v100, v24, s[80:81]
  v_cndmask_b32 v101, v101, v24, s[82:83]
  v_cndmask_b32 v102, v102, v24, s[84:85]
  v_cndmask_b32 v103, v103, v24, s[86:87]
  s_branch L_a_d1
L_a_s1:
  s_waitcnt vmcnt(24) lgkmcnt(0)
  v_mfma_f32_16x16x32_bf16 v[32:35], a[64:67], a[0:3], v[96:99]
  s_barrier
  ds_read_b128 a[96:99], v4 offset:0
  v_mfma_f32_16x16x32_bf16 v[32:35], a[72:75], a[4:7], v[32:35]
  s_nop 0
  ds_read_b128 a[100:103], v4 offset:1024
  v_mfma_f32_16x16x32_bf16 v[32:35], a[80:83], a[8:11], v[32:35]
  s_nop 0
  ds_read_b128 a[104:107], v4 offset:2048
  v_mfma_f32_16x16x32_bf16 v[32:35], a[88:91], a[12:15], v[32:35]
  s_nop 0
  ds_read_b128 a[108:111], v4 offset:3072
  v_mfma_f32_16x16x32_bf16 v[36:39], a[68:71], a[0:3], v[100:103]
  s_nop 0
  ds_read_b128 a[112:115], v4 offset:4096
  v_mfma_f32_16x16x32_bf16 v[36:39], a[76:79], a[4:7], v[36:39]
  s_nop 0
  ds_read_b128 a[116:119], v4 offset:5120
  v_mfma_f32_16x16x32_bf16 v[36:39], a[84:87], a[8:11], v[36:39]
  s_nop 0
  ds_read_b128 a[120:123], v4 offset:6144
  v_mfma_f32_16x16x32_bf16 v[36:39], a[92:95], a[12:15], v[36:39]
  s_nop 0
  ds_read_b128 a[124:127], v4 offset:7168
  v_mfma_f32_16x16x32_bf16 v[40:43], a[64:67], a[16:19], v[104:107]
  s_nop 0
  v_exp_f32 v8, v32
  v_mfma_f32_16x16x32_bf16 v[40:43], a[72:75], a[20:23], v[40:43]
  s_nop 0
  v_exp_f32 v9, v33
  v_mfma_f32_16x16x32_bf16 v[40:43], a[80:83], a[24:27], v[40:43]
  s_nop 0
  v_exp_f32 v10, v34
  v_mfma_f32_16x16x32_bf16 v[40:43], a[88:91], a[28:31], v[40:43]
  s_nop 0
  v_exp_f32 v11, v35
  v_mfma_f32_16x16x32_bf16 v[44:47], a[68:71], a[16:19], v[108:111]
  s_nop 0
  v_cvt_pk_bf16_f32 v64, v8, v9
  v_cvt_pk_bf16_f32 v65, v10, v11
  v_mfma_f32_16x16x32_bf16 v[44:47], a[76:79], a[20:23], v[44:47]
  s_nop 0
  v_or_b32 v5, v64, v65
  v_mfma_f32_16x16x32_bf16 v[44:47], a[84:87], a[24:27], v[44:47]
  s_nop 0
  v_exp_f32 v12, v36
  v_mfma_f32_16x16x32_bf16 v[44:47], a[92:95], a[28:31], v[44:47]
  s_nop 0
  v_exp_f32 v13, v37
  v_mfma_f32_16x16x32_bf16 v[48:51], a[64:67], a[32:35], v[112:115]
  s_nop 0
  v_exp_f32 v14, v38
  v_mfma_f32_16x16x32_bf16 v[48:51], a[72:75], a[36:39], v[48:51]
  s_nop 0
  v_exp_f32 v15, v39
  v_mfma_f32_16x16x32_bf16 v[48:51], a[80:83], a[40:43], v[48:51]
  s_nop 0
  v_cvt_pk_bf16_f32 v66, v12, v13
  v_cvt_pk_bf16_f32 v67, v14, v15
  v_mfma_f32_16x16x32_bf16 v[48:51], a[88:91], a[44:47], v[48:51]
  s_add_u32 m0, s64, s65
  s_nop 0
  buffer_load_dwordx4 v3, s[40:43], s61 offen sc1 lds
  v_or3_b32 v5, v5, v66, v67
  v_mfma_f32_16x16x32_bf16 v[52:55], a[68:71], a[32:35], v[116:119]
  s_nop 0
  v_exp_f32 v8, v40
  v_mfma_f32_16x16x32_bf16 v[52:55], a[76:79], a[36:39], v[52:55]
  s_nop 0
  v_exp_f32 v9, v41
  v_mfma_f32_16x16x32_bf16 v[52:55], a[84:87], a[40:43], v[52:55]
  s_min_u32 s66, s62, s63
  buffer_load_dwordx4 v3, s[40:43], s61 offen offset:1024 sc1 lds
  v_mfma_f32_16x16x32_bf16 v[52:55], a[92:95], a[44:47], v[52:55]
  s_nop 0
  v_exp_f32 v10, v42
  v_mfma_f32_16x16x32_bf16 v[56:59], a[64:67], a[48:51], v[120:123]
  s_nop 0
  v_exp_f32 v11, v43
  v_mfma_f32_16x16x32_bf16 v[56:59], a[72:75], a[52:55], v[56:59]
  s_add_u32 m0, m0, 0x2000
  s_nop 0
  buffer_load_dwordx4 v3, s[40:43], s66 offen sc1 lds
  v_cvt_pk_bf16_f32 v68, v8, v9
  v_mfma_f32_16x16x32_bf16 v[56:59], a[80:83], a[56:59], v[56:59]
  s_nop 0
  v_cvt_pk_bf16_f32 v69, v10, v11
  v_or3_b32 v5, v5, v68, v69
  v_mfma_f32_16x16x32_bf16 v[56:59], a[88:91], a[60:63], v[56:59]
  s_nop 0
  v_exp_f32 v12, v44
  v_mfma_f32_16x16x32_bf16 v[60:63], a[68:71], a[48:51], v[124:127]
  s_add_u32 s61, s61, 0x2000
  buffer_load_dwordx4 v3, s[40:43], s66 offen offset:1024 sc1 lds
  v_mfma_f32_16x16x32_bf16 v[60:63], a[76:79], a[52:55], v[60:63]
  s_add_u32 s62, s62, 0x2000
  v_exp_f32 v13, v45
  v_mfma_f32_16x16x32_bf16 v[60:63], a[84:87], a[56:59], v[60:63]
  s_add_u32 s64, s64, 0x4000
  v_exp_f32 v14, v46
  v_mfma_f32_16x16x32_bf16 v[60:63], a[92:95], a[60:63], v[60:63]
  s_and_b32 s64, s64, 0x1ffff
  v_exp_f32 v15, v47
  v_mfma_f32_16x16x32_bf16 a[128:131], v[16:19], v[80:83], a[128:131]
  s_add_u32 s58, s58, 1
  v_cvt_pk_bf16_f32 v70, v12, v13
  v_cvt_pk_bf16_f32 v71, v14, v15
  v_mfma_f32_16x16x32_bf16 a[132:135], v[16:19], v[84:87], a[132:135]
  s_nop 0
  ds_read_b128 a[64:67], v4 offset:8192
  v_or3_b32 v5, v5, v70, v71
  v_mfma_f32_16x16x32_bf16 a[136:139], v[16:19], v[88:91], a[136:139]
  s_nop 0
  v_exp_f32 v8, v48
  v_mfma_f32_16x16x32_bf16 a[140:143], v[16:19], v[92:95], a[140:143]
  s_nop 0
  v_exp_f32 v9, v49
  s_waitcnt lgkmcnt(1)
  v_mfma_f32_16x16x32_bf16 v[128:131], a[96:99], v[80:83], v[128:131]
  ds_read_b128 a[68:71], v4 offset:9216
  v_mfma_f32_16x16x32_bf16 v[160:163], a[96:99], v[84:87], v[160:163]
  v_exp_f32 v10, v50
  v_mfma_f32_16x16x32_bf16 v[192:195], a[96:99], v[88:91], v[192:195]
  v_exp_f32 v11, v51
  v_mfma_f32_16x16x32_bf16 v[224:227], a[96:99], v[92:95], v[224:227]
  ds_read_b128 a[72:75], v4 offset:10240
  v_cvt_pk_bf16_f32 v72, v8, v9
  v_mfma_f32_16x16x32_bf16 v[132:135], a[100:103], v[80:83], v[132:135]
  v_cvt_pk_bf16_f32 v73, v10, v11
  v_or3_b32 v5, v5, v72, v73
  v_mfma_f32_16x16x32_bf16 v[164:167], a[100:103], v[84:87], v[164:167]
  v_exp_f32 v12, v52
  v_mfma_f32_16x16x32_bf16 v[196:199], a[100:103], v[88:91], v[196:199]
  ds_read_b128 a[76:79], v4 offset:11264
  v_mfma_f32_16x16x32_bf16 v[228:231], a[100:103], v[92:95], v[228:231]
  v_exp_f32 v13, v53
  v_mfma_f32_16x16x32_bf16 v[136:139], a[104:107], v[80:83], v[136:139]
  v_exp_f32 v14, v54
  v_mfma_f32_16x16x32_bf16 v[168:171], a[104:107], v[84:87], v[168:171]
  ds_read_b128 a[80:83], v4 offset:12288
  v_mfma_f32_16x16x32_bf16 v[200:203], a[104:107], v[88:91], v[200:203]
  v_exp_f32 v15, v55
  v_mfma_f32_16x16x32_bf16 v[232:235], a[104:107], v[92:95], v[232:235]
  v_cvt_pk_bf16_f32 v74, v12, v13
  v_cvt_pk_bf16_f32 v75, v14, v15
  v_mfma_f32_16x16x32_bf16 v[140:143], a[108:111], v[80:83], v[140:143]
  ds_read_b128 a[84:87], v4 offset:13312
  v_or3_b32 v5, v5, v74, v75
  v_mfma_f32_16x16x32_bf16 v[172:175], a[108:111], v[84:87], v[172:175]
  v_exp_f32 v8, v56
  v_mfma_f32_16x16x32_bf16 v[204:207], a[108:111], v[88:91], v[204:207]
  v_exp_f32 v9, v57
  v_mfma_f32_16x16x32_bf16 v[236:239], a[108:111], v[92:95], v[236:239]
  ds_read_b128 a[88:91], v4 offset:14336
  v_mfma_f32_16x16x32_bf16 v[144:147], a[112:115], v[80:83], v[144:147]
  v_exp_f32 v10, v58
  v_mfma_f32_16x16x32_bf16 v[176:179], a[112:115], v[84:87], v[176:179]
  v_exp_f32 v11, v59
  v_mfma_f32_16x16x32_bf16 v[208:211], a[112:115], v[88:91], v[208:211]
  ds_read_b128 a[92:95], v4 offset:15360
  v_cvt_pk_bf16_f32 v76, v8, v9
  v_mfma_f32_16x16x32_bf16 v[240:243], a[112:115], v[92:95], v[240:243]
  v_cvt_pk_bf16_f32 v77, v10, v11
  v_or3_b32 v5, v5, v76, v77
  v_mfma_f32_16x16x32_bf16 v[148:151], a[116:119], v[80:83], v[148:151]
  v_exp_f32 v12, v60
  v_mfma_f32_16x16x32_bf16 v[180:183], a[116:119], v[84:87], v[180:183]
  v_exp_f32 v13, v61
  v_mfma_f32_16x16x32_bf16 v[212:215], a[116:119], v[88:91], v[212:215]
  v_exp_f32 v14, v62
  v_mfma_f32_16x16x32_bf16 v[244:247], a[116:119], v[92:95], v[244:247]
  v_exp_f32 v15, v63
  v_mfma_f32_16x16x32_bf16 v[152:155], a[120:123], v[80:83], v[152:155]
  v_cvt_pk_bf16_f32 v78, v12, v13
  v_cvt_pk_bf16_f32 v79, v14, v15
  v_mfma_f32_16x16x32_bf16 v[184:187], a[120:123], v[84:87], v[184:187]
  v_or3_b32 v5, v5, v78, v79
  v_and_b32 v5, s70, v5
  v_mfma_f32_16x16x32_bf16 v[216:219], a[120:123], v[88:91], v[216:219]
  v_cmp_ne_u32 vcc, 0, v5
  v_add_u32 v4, 0x4000, v4
  v_mfma_f32_16x16x32_bf16 v[248:251], a[120:123], v[92:95], v[248:251]
  v_and_b32 v4, 0x1ffff, v4
  v_mfma_f32_16x16x32_bf16 v[156:159], a[124:127], v[80:83], v[156:159]
  v_mfma_f32_16x16x32_bf16 v[188:191], a[124:127], v[84:87], v[188:191]
  v_mfma_f32_16x16x32_bf16 v[220:223], a[124:127], v[88:91], v[220:223]
  v_mfma_f32_16x16x32_bf16 v[252:255], a[124:127], v[92:95], v[252:255]
  s_cbranch_vccnz L_a_s1_t
L_a_s1_r:
L_a_s0:
  s_waitcnt vmcnt(24) lgkmcnt(0)
  v_mfma_f32_16x16x32_bf16 v[32:35], a[64:67], a[0:3], v[96:99]
  s_barrier
  ds_read_b128 a[96:99], v4 offset:0
  v_mfma_f32_16x16x32_bf16 v[32:35], a[72:75], a[4:7], v[32:35]
  s_nop 0
  ds_read_b128 a[100:103], v4 offset:1024
  v_mfma_f32_16x16x32_bf16 v[32:35], a[80:83], a[8:11], v[32:35]
  s_nop 0
  ds_read_b128 a[104:107], v4 offset:2048
  v_mfma_f32_16x16x32_bf16 v[32:35], a[88:91], a[12:15], v[32:35]
  s_nop 0
  ds_read_b128 a[108:111], v4 offset:3072
  v_mfma_f32_16x16x32_bf16 v[36:39], a[68:71], a[0:3], v[100:103]
  s_nop 0
  ds_read_b128 a[112:115], v4 offset:4096
  v_mfma_f32_16x16x32_bf16 v[36:39], a[76:79], a[4:7], v[36:39]
  s_nop 0
  ds_read_b128 a[116:119], v4 offset:5120
  v_mfma_f32_16x16x32_bf16 v[36:39], a[84:87], a[8:11], v[36:39]
  s_nop 0
  ds_read_b128 a[120:123], v4 offset:6144
  v_mfma_f32_16x16x32_bf16 v[36:39], a[92:95], a[12:15], v[36:39]
  s_nop 0
  ds_read_b128 a[124:127], v4 offset:7168
  v_mfma_f32_16x16x32_bf16 v[40:43], a[64:67], a[16:19], v[104:107]
  s_nop 0
  v_exp_f32 v8, v32
  v_mfma_f32_16x16x32_bf16 v[40:43], a[72:75], a[20:23], v[40:43]
  s_nop 0
  v_exp_f32 v9, v33
  v_mfma_f32_16x16x32_bf16 v[40:43], a[80:83], a[24:27], v[40:43]
  s_nop 0
  v_exp_f32 v10, v34
  v_mfma_f32_16x16x32_bf16 v[40:43], a[88:91], a[28:31], v[40:43]
  s_nop 0
  v_exp_f32 v11, v35
  v_mfma_f32_16x16x32_bf16 v[44:47], a[68:71], a[16:19], v[108:111]
  s_nop 0
  v_cvt_pk_bf16_f32 v80, v8, v9
  v_cvt_pk_bf16_f32 v81, v10, v11
  v_mfma_f32_16x16x32_bf16 v[44:47], a[76:79], a[20:23], v[44:47]
  s_nop 0
  v_or_b32 v5, v80, v81
  v_mfma_f32_16x16x32_bf16 v[44:47], a[84:87], a[24:27], v[44:47]
  s_nop 0
  v_exp_f32 v12, v36
  v_mfma_f32_16x16x32_bf16 v[44:47], a[92:95], a[28:31], v[44:47]
  s_nop 0
  v_exp_f32 v13, v37
  v_mfma_f32_16x16x32_bf16 v[48:51], a[64:67], a[32:35], v[112:115]
  s_nop 0
  v_exp_f32 v14, v38
  v_mfma_f32_16x16x32_bf16 v[48:51], a[72:75], a[36:39], v[48:51]
  s_nop 0
  v_exp_f32 v15, v39
  v_mfma_f32_16x16x32_bf16 v[48:51], a[80:83], a[40:43], v[48:51]
  s_nop 0
  v_cvt_pk_bf16_f32 v82, v12, v13
  v_cvt_pk_bf16_f32 v83, v14, v15
  v_mfma_f32_16x16x32_bf16 v[48:51], a[88:91], a[44:47], v[48:51]
  s_add_u32 m0, s64, s65
  s_nop 0
  buffer_load_dwordx4 v3, s[40:43], s61 offen sc1 lds
  v_or3_b32 v5, v5, v82, v83
  v_mfma_f32_16x16x32_bf16 v[52:55], a[68:71], a[32:35], v[116:119]
  s_nop 0
  v_exp_f32 v8, v40
  v_mfma_f32_16x16x32_bf16 v[52:55], a[76:79], a[36:39], v[52:55]
  s_nop 0
  v_exp_f32 v9, v41
  v_mfma_f32_16x16x32_bf16 v[52:55], a[84:87], a[40:43], v[52:55]
  s_min_u32 s66, s62, s63
  buffer_load_dwordx4 v3, s[40:43], s61 offen offset:1024 sc1 lds
  v_mfma_f32_16x16x32_bf16 v[52:55], a[92:95], a[44:47], v[52:55]
  s_nop 0
  v_exp_f32 v10, v42
  v_mfma_f32_16x16x32_bf16 v[56:59], a[64:67], a[48:51], v[120:123]
  s_nop 0
  v_exp_f32 v11, v43
  v_mfma_f32_16x16x32_bf16 v[56:59], a[72:75], a[52:55], v[56:59]
  s_add_u32 m0, m0, 0x2000
  s_nop 0
  buffer_load_dwordx4 v3, s[40:43], s66 offen sc1 lds
  v_cvt_pk_bf16_f32 v84, v8, v9
  v_mfma_f32_16x16x32_bf16 v[56:59], a[80:83], a[56:59], v[56:59]
  s_nop 0
  v_cvt_pk_bf16_f32 v85, v10, v11
  v_or3_b32 v5, v5, v84, v85
  v_mfma_f32_16x16x32_bf16 v[56:59], a[88:91], a[60:63], v[56:59]
  s_nop 0
  v_exp_f32 v12, v44
  v_mfma_f32_16x16x32_bf16 v[60:63], a[68:71], a[48:51], v[124:127]
  s_add_u32 s61, s61, 0x2000
  buffer_load_dwordx4 v3, s[40:43], s66 offen offset:1024 sc1 lds
  v_mfma_f32_16x16x32_bf16 v[60:63], a[76:79], a[52:55], v[60:63]
  s_add_u32 s62, s62, 0x2000
  v_exp_f32 v13, v45
  v_mfma_f32_16x16x32_bf16 v[60:63], a[84:87], a[56:59], v[60:63]
  s_add_u32 s64, s64, 0x4000
  v_exp_f32 v14, v46
  v_mfma_f32_16x16x32_bf16 v[60:63], a[92:95], a[60:63], v[60:63]
  s_and_b32 s64, s64, 0x1ffff
  v_exp_f32 v15, v47
  v_mfma_f32_16x16x32_bf16 a[128:131], v[16:19], v[64:67], a[128:131]
  s_add_u32 s58, s58, 1
  v_cvt_pk_bf16_f32 v86, v12, v13
  v_cvt_pk_bf16_f32 v87, v14, v15
  v_mfma_f32_16x16x32_bf16 a[132:135], v[16:19], v[68:71], a[132:135]
  s_nop 0
  ds_read_b128 a[64:67], v4 offset:8192
  v_or3_b32 v5, v5, v86, v87
  v_mfma_f32_16x16x32_bf16 a[136:139], v[16:19], v[72:75], a[136:139]
  s_nop 0
  v_exp_f32 v8, v48
  v_mfma_f32_16x16x32_bf16 a[140:143], v[16:19], v[76:79], a[140:143]
  s_nop 0
  v_exp_f32 v9, v49
  s_waitcnt lgkmcnt(1)
  v_mfma_f32_16x16x32_bf16 v[128:131], a[96:99], v[64:67], v[128:131]
  ds_read_b128 a[68:71], v4 offset:9216
  v_mfma_f32_16x16x32_bf16 v[160:163], a[96:99], v[68:71], v[160:163]
  v_exp_f32 v10, v50
  v_mfma_f32_16x16x32_bf16 v[192:195], a[96:99], v[72:75], v[192:195]
  v_exp_f32 v11, v51
  v_mfma_f32_16x16x32_bf16 v[224:227], a[96:99], v[76:79], v[224:227]
  ds_read_b128 a[72:75], v4 offset:10240
  v_cvt_pk_bf16_f32 v88, v8, v9
  v_mfma_f32_16x16x32_bf16 v[132:135], a[100:103], v[64:67], v[132:135]
  v_cvt_pk_bf16_f32 v89, v10, v11
  v_or3_b32 v5, v5, v88, v89
  v_mfma_f32_16x16x32_bf16 v[164:167], a[100:103], v[68:71], v[164:167]
  v_exp_f32 v12, v52
  v_mfma_f32_16x16x32_bf16 v[196:199], a[100:103], v[72:75], v[196:199]
  ds_read_b128 a[76:79], v4 offset:11264
  v_mfma_f32_16x16x32_bf16 v[228:231], a[100:103], v[76:79], v[228:231]
  v_exp_f32 v13, v53
  v_mfma_f32_16x16x32_bf16 v[136:139], a[104:107], v[64:67], v[136:139]
  v_exp_f32 v14, v54
  v_mfma_f32_16x16x32_bf16 v[168:171], a[104:107], v[68:71], v[168:171]
  ds_read_b128 a[80:83], v4 offset:12288
  v_mfma_f32_16x16x32_bf16 v[200:203], a[104:107], v[72:75], v[200:203]
  v_exp_f32 v15, v55
  v_mfma_f32_16x16x32_bf16 v[232:235], a[104:107], v[76:79], v[232:235]
  v_cvt_pk_bf16_f32 v90, v12, v13
  v_cvt_pk_bf16_f32 v91, v14, v15
  v_mfma_f32_16x16x32_bf16 v[140:143], a[108:111], v[64:67], v[140:143]
  ds_read_b128 a[84:87], v4 offset:13312
  v_or3_b32 v5, v5, v90, v91
  v_mfma_f32_16x16x32_bf16 v[172:175], a[108:111], v[68:71], v[172:175]
  v_exp_f32 v8, v56
  v_mfma_f32_16x16x32_bf16 v[204:207], a[108:111], v[72:75], v[204:207]
  v_exp_f32 v9, v57
  v_mfma_f32_16x16x32_bf16 v[236:239], a[108:111], v[76:79], v[236:239]
  ds_read_b128 a[88:91], v4 offset:14336
  v_mfma_f32_16x16x32_bf16 v[144:147], a[112:115], v[64:67], v[144:147]
  v_exp_f32 v10, v58
  v_mfma_f32_16x16x32_bf16 v[176:179], a[112:115], v[68:71], v[176:179]
  v_exp_f32 v11, v59
  v_mfma_f32_16x16x32_bf16 v[208:211], a[112:115], v[72:75], v[208:211]
  ds_read_b128 a[92:95], v4 offset:15360
  v_cvt_pk_bf16_f32 v92, v8, v9
  v_mfma_f32_16x16x32_bf16 v[240:243], a[112:115], v[76:79], v[240:243]
  v_cvt_pk_bf16_f32 v93, v10, v11
  v_or3_b32 v5, v5, v92, v93
  v_mfma_f32_16x16x32_bf16 v[148:151], a[116:119], v[64:67], v[148:151]
  v_exp_f32 v12, v60
  v_mfma_f32_16x16x32_bf16 v[180:183], a[116:119], v[68:71], v[180:183]
  v_exp_f32 v13, v61
  v_mfma_f32_16x16x32_bf16 v[212:215], a[116:119], v[72:75], v[212:215]
  v_exp_f32 v14, v62
  v_mfma_f32_16x16x32_bf16 v[244:247], a[116:119], v[76:79], v[244:247]
  v_exp_f32 v15, v63
  v_mfma_f32_16x16x32_bf16 v[152:155], a[120:123], v[64:67], v[152:155]
  v_cvt_pk_bf16_f32 v94, v12, v13
  v_cvt_pk_bf16_f32 v95, v14, v15
  v_mfma_f32_16x16x32_bf16 v[184:187], a[120:123], v[68:71], v[184:187]
  v_or3_b32 v5, v5, v94, v95
  v_and_b32 v5, s70, v5
  v_mfma_f32_16x16x32_bf16 v[216:219], a[120:123], v[72:75], v[216:219]
  v_cmp_ne_u32 vcc, 0, v5
  v_add_u32 v4, 0x4000, v4
  v_mfma_f32_16x16x32_bf16 v[248:251], a[120:123], v[76:79], v[248:251]
  v_and_b32 v4, 0x1ffff, v4
  v_mfma_f32_16x16x32_bf16 v[156:159], a[124:127], v[64:67], v[156:159]
  v_mfma_f32_16x16x32_bf16 v[188:191], a[124:127], v[68:71], v[188:191]
  v_mfma_f32_16x16x32_bf16 v[220:223], a[124:127], v[72:75], v[220:223]
  v_mfma_f32_16x16x32_bf16 v[252:255], a[124:127], v[76:79], v[252:255]
  s_cbranch_vccnz L_a_s0_t
L_a_s0_r:
  s_cmp_eq_u32 s58, s59
  s_cbranch_scc0 L_a_s1
  v_cmp_gt_i32 s[80:81], 0, v25
  v_cmp_gt_i32 s[82:83], 1, v25
  v_cmp_gt_i32 s[84:85], 2, v25
  v_cmp_gt_i32 s[86:87], 3, v25
  v_cndmask_b32 v96, v96, v24, s[80:81]
  v_cndmask_b32 v97, v97, v24, s[82:83]
  v_cndmask_b32 v98, v98, v24, s[84:85]
  v_cndmask_b32 v99, v99, v24, s[86:87]
  v_cmp_gt_i32 s[80:81], 16, v25
  v_cmp_gt_i32 s[82:83], 17, v25
  v_cmp_gt_i32 s[84:85], 18, v25
  v_cmp_gt_i32 s[86:87], 19, v25
  v_cndmask_b32 v100, v100, v24, s[80:81]
  v_cndmask_b32 v101, v101, v24, s[82:83]
  v_cndmask_b32 v102, v102, v24, s[84:85]
  v_cndmask_b32 v103, v103, v24, s[86:87]
  s_nop 0
L_a_d0:
  s_waitcnt vmcnt(24) lgkmcnt(0)
  v_mfma_f32_16x16x32_bf16 v[32:35], a[64:67], a[0:3], v[96:99]
  s_barrier
  ds_read_b128 a[96:99], v4 offset:0
  v_mfma_f32_16x16x32_bf16 v[32:35], a[72:75], a[4:7], v[32:35]
  s_nop 0
  ds_read_b128 a[100:103], v4 offset:1024
  v_mfma_f32_16x16x32_bf16 v[32:35], a[80:83], a[8:11], v[32:35]
  s_nop 0
  ds_read_b128 a[104:107], v4 offset:2048
  v_mfma_f32_16x16x32_bf16 v[32:35], a[88:91], a[12:15], v[32:35]
  s_nop 0
  ds_read_b128 a[108:111], v4 offset:3072
  v_mfma_f32_16x16x32_bf16 v[36:39], a[68:71], a[0:3], v[100:103]
  s_nop 0
  ds_read_b128 a[112:115], v4 offset:4096
  v_mfma_f32_16x16x32_bf16 v[36:39], a[76:79], a[4:7], v[36:39]
  s_nop 0
  ds_read_b128 a[116:119], v4 offset:5120
  v_mfma_f32_16x16x32_bf16 v[36:39], a[84:87], a[8:11], v[36:39]
  s_nop 0
  ds_read_b128 a[120:123], v4 offset:6144
  v_mfma_f32_16x16x32_bf16 v[36:39], a[92:95], a[12:15], v[36:39]
  s_nop 0
  ds_read_b128 a[124:127], v4 offset:7168
  v_mfma_f32_16x16x32_bf16 v[40:43], a[64:67], a[16:19], v[104:107]
  s_nop 0
  v_exp_f32 v8, v32
  v_mfma_f32_16x16x32_bf16 v[40:43], a[72:75], a[20:23], v[40:43]
  s_nop 0
  v_exp_f32 v9, v33
  v_mfma_f32_16x16x32_bf16 v[40:43], a[80:83], a[24:27], v[40:43]
  s_nop 0
  v_exp_f32 v10, v34
  v_mfma_f32_16x16x32_bf16 v[40:43], a[88:91], a[28:31], v[40:43]
  s_nop 0
  v_exp_f32 v11, v35
  v_mfma_f32_16x16x32_bf16 v[44:47], a[68:71], a[16:19], v[108:111]
  s_nop 0
  v_cvt_pk_bf16_f32 v64, v8, v9
  v_cvt_pk_bf16_f32 v65, v10, v11
  v_mfma_f32_16x16x32_bf16 v[44:47], a[76:79], a[20:23], v[44:47]
  s_nop 0
  v_or_b32 v5, v64, v65
  v_mfma_f32_16x16x32_bf16 v[44:47], a[84:87], a[24:27], v[44:47]
  s_nop 0
  v_exp_f32 v12, v36
  v_mfma_f32_16x16x32_bf16 v[44:47], a[92:95], a[28:31], v[44:47]
  s_nop 0
  v_exp_f32 v13, v37
  v_mfma_f32_16x16x32_bf16 v[48:51], a[64:67], a[32:35], v[112:115]
  s_nop 0
  v_exp_f32 v14, v38
  v_mfma_f32_16x16x32_bf16 v[48:51], a[72:75], a[36:39], v[48:51]
  s_nop 0
  v_exp_f32 v15, v39
  v_mfma_f32_16x16x32_bf16 v[48:51], a[80:83], a[40:43], v[48:51]
  s_nop 0
  v_cvt_pk_bf16_f32 v66, v12, v13
  v_cvt_pk_bf16_f32 v67, v14, v15
  v_mfma_f32_16x16x32_bf16 v[48:51], a[88:91], a[44:47], v[48:51]
  s_add_u32 m0, s64, s65
  s_nop 0
  buffer_load_dwordx4 v3, s[40:43], s61 offen sc1 lds
  v_or3_b32 v5, v5, v66, v67
  v_mfma_f32_16x16x32_bf16 v[52:55], a[68:71], a[32:35], v[116:119]
  s_nop 0
  v_exp_f32 v8, v40
  v_mfma_f32_16x16x32_bf16 v[52:55], a[76:79], a[36:39], v[52:55]
  s_nop 0
  v_exp_f32 v9, v41
  v_mfma_f32_16x16x32_bf16 v[52:55], a[84:87], a[40:43], v[52:55]
  s_min_u32 s66, s62, s63
  buffer_load_dwordx4 v3, s[40:43], s61 offen offset:1024 sc1 lds
  v_mfma_f32_16x16x32_bf16 v[52:55], a[92:95], a[44:47], v[52:55]
  s_nop 0
  v_exp_f32 v10, v42
  v_mfma_f32_16x16x32_bf16 v[56:59], a[64:67], a[48:51], v[120:123]
  s_nop 0
  v_exp_f32 v11, v43
  v_mfma_f32_16x16x32_bf16 v[56:59], a[72:75], a[52:55], v[56:59]
  s_add_u32 m0, m0, 0x2000
  s_nop 0
  buffer_load_dwordx4 v3, s[40:43], s66 offen sc1 lds
  v_cvt_pk_bf16_f32 v68, v8, v9
  v_mfma_f32_16x16x32_bf16 v[56:59], a[80:83], a[56:59], v[56:59]
  s_nop 0
  v_cvt_pk_bf16_f32 v69, v10, v11
  v_or3_b32 v5, v5, v68, v69
  v_mfma_f32_16x16x32_bf16 v[56:59], a[88:91], a[60:63], v[56:59]
  s_nop 0
  v_exp_f32 v12, v44
  v_mfma_f32_16x16x32_bf16 v[60:63], a[68:71], a[48:51], v[124:127]
  s_add_u32 s61, s61, 0x2000
  buffer_load_dwordx4 v3, s[40:43], s66 offen offset:1024 sc1 lds
  v_mfma_f32_16x16x32_bf16 v[60:63], a[76:79], a[52:55], v[60:63]
  s_add_u32 s62, s62, 0x2000
  v_exp_f32 v13, v45
  v_mfma_f32_16x16x32_bf16 v[60:63], a[84:87], a[56:59], v[60:63]
  s_add_u32 s64, s64, 0x4000
  v_exp_f32 v14, v46
  v_mfma_f32_16x16x32_bf16 v[60:63], a[92:95], a[60:63], v[60:63]
  s_and_b32 s64, s64, 0x1ffff
  v_exp_f32 v15, v47
  v_mfma_f32_16x16x32_bf16 a[128:131], v[16:19], v[80:83], a[128:131]
  s_add_u32 s58, s58, 1
  v_cvt_pk_bf16_f32 v70, v12, v13
  v_cvt_pk_bf16_f32 v71, v14, v15
  v_mfma_f32_16x16x32_bf16 a[132:135], v[16:19], v[84:87], a[132:135]
  s_nop 0
  ds_read_b128 a[64:67], v4 offset:8192
  v_or3_b32 v5, v5, v70, v71
  v_mfma_f32_16x16x32_bf16 a[136:139], v[16:19], v[88:91], a[136:139]
  s_nop 0
  v_exp_f32 v8, v48
  v_mfma_f32_16x16x32_bf16 a[140:143], v[16:19], v[92:95], a[140:143]
  s_nop 0
  v_exp_f32 v9, v49
  s_waitcnt lgkmcnt(1)
  v_mfma_f32_16x16x32_bf16 v[128:131], a[96:99], v[80:83], v[128:131]
  ds_read_b128 a[68:71], v4 offset:9216
  v_mfma_f32_16x16x32_bf16 v[160:163], a[96:99], v[84:87], v[160:163]
  v_exp_f32 v10, v50
  v_mfma_f32_16x16x32_bf16 v[192:195], a[96:99], v[88:91], v[192:195]
  v_exp_f32 v11, v51
  v_mfma_f32_16x16x32_bf16 v[224:227], a[96:99], v[92:95], v[224:227]
  ds_read_b128 a[72:75], v4 offset:10240
  v_cvt_pk_bf16_f32 v72, v8, v9
  v_mfma_f32_16x16x32_bf16 v[132:135], a[100:103], v[80:83], v[132:135]
  v_cvt_pk_bf16_f32 v73, v10, v11
  v_or3_b32 v5, v5, v72, v73
  v_mfma_f32_16x16x32_bf16 v[164:167], a[100:103], v[84:87], v[164:167]
  v_exp_f32 v12, v52
  v_mfma_f32_16x16x32_bf16 v[196:199], a[100:103], v[88:91], v[196:199]
  ds_read_b128 a[76:79], v4 offset:11264
  v_mfma_f32_16x16x32_bf16 v[228:231], a[100:103], v[92:95], v[228:231]
  v_exp_f32 v13, v53
  v_mfma_f32_16x16x32_bf16 v[136:139], a[104:107], v[80:83], v[136:139]
  v_exp_f32 v14, v54
  v_mfma_f32_16x16x32_bf16 v[168:171], a[104:107], v[84:87], v[168:171]
  ds_read_b128 a[80:83], v4 offset:12288
  v_mfma_f32_16x16x32_bf16 v[200:203], a[104:107], v[88:91], v[200:203]
  v_exp_f32 v15, v55
  v_mfma_f32_16x16x32_bf16 v[232:235], a[104:107], v[92:95], v[232:235]
  v_cvt_pk_bf16_f32 v74, v12, v13
  v_cvt_pk_bf16_f32 v75, v14, v15
  v_mfma_f32_16x16x32_bf16 v[140:143], a[108:111], v[80:83], v[140:143]
  ds_read_b128 a[84:87], v4 offset:13312
  v_or3_b32 v5, v5, v74, v75
  v_mfma_f32_16x16x32_bf16 v[172:175], a[108:111], v[84:87], v[172:175]
  v_exp_f32 v8, v56
  v_mfma_f32_16x16x32_bf16 v[204:207], a[108:111], v[88:91], v[204:207]
  v_exp_f32 v9, v57
  v_mfma_f32_16x16x32_bf16 v[236:239], a[108:111], v[92:95], v[236:239]
  ds_read_b128 a[88:91], v4 offset:14336
  v_mfma_f32_16x16x32_bf16 v[144:147], a[112:115], v[80:83], v[144:147]
  v_exp_f32 v10, v58
  v_mfma_f32_16x16x32_bf16 v[176:179], a[112:115], v[84:87], v[176:179]
  v_exp_f32 v11, v59
  v_mfma_f32_16x16x32_bf16 v[208:211], a[112:115], v[88:91], v[208:211]
  ds_read_b128 a[92:95], v4 offset:15360
  v_cvt_pk_bf16_f32 v76, v8, v9
  v_mfma_f32_16x16x32_bf16 v[240:243], a[112:115], v[92:95], v[240:243]
  v_cvt_pk_bf16_f32 v77, v10, v11
  v_or3_b32 v5, v5, v76, v77
  v_mfma_f32_16x16x32_bf16 v[148:151], a[116:119], v[80:83], v[148:151]
  v_exp_f32 v12, v60
  v_mfma_f32_16x16x32_bf16 v[180:183], a[116:119], v[84:87], v[180:183]
  v_exp_f32 v13, v61
  v_mfma_f32_16x16x32_bf16 v[212:215], a[116:119], v[88:91], v[212:215]
  v_exp_f32 v14, v62
  v_mfma_f32_16x16x32_bf16 v[244:247], a[116:119], v[92:95], v[244:247]
  v_exp_f32 v15, v63
  v_mfma_f32_16x16x32_bf16 v[152:155], a[120:123], v[80:83], v[152:155]
  v_cvt_pk_bf16_f32 v78, v12, v13
  v_cvt_pk_bf16_f32 v79, v14, v15
  v_mfma_f32_16x16x32_bf16 v[184:187], a[120:123], v[84:87], v[184:187]
  v_or3_b32 v5, v5, v78, v79
  v_and_b32 v5, s70, v5
  v_mfma_f32_16x16x32_bf16 v[216:219], a[120:123], v[88:91], v[216:219]
  v_cmp_ne_u32 vcc, 0, v5
  v_cmp_gt_i32 s[80:81], 32, v25
  v_mfma_f32_16x16x32_bf16 v[248:251], a[120:123], v[92:95], v[248:251]
  v_cmp_gt_i32 s[82:83], 33, v25
  v_cmp_gt_i32 s[84:85], 34, v25
  v_mfma_f32_16x16x32_bf16 v[156:159], a[124:127], v[80:83], v[156:159]
  v_cmp_gt_i32 s[86:87], 35, v25
  v_cndmask_b32 v96, v96, v24, s[80:81]
  v_mfma_f32_16x16x32_bf16 v[188:191], a[124:127], v[84:87], v[188:191]
  v_cndmask_b32 v97, v97, v24, s[82:83]
  v_cndmask_b32 v98, v98, v24, s[84:85]
  v_mfma_f32_16x16x32_bf16 v[220:223], a[124:127], v[88:91], v[220:223]
  v_cndmask_b32 v99, v99, v24, s[86:87]
  v_cmp_gt_i32 s[80:81], 48, v25
  v_mfma_f32_16x16x32_bf16 v[252:255], a[124:127], v[92:95], v[252:255]
  v_cmp_gt_i32 s[82:83], 49, v25
  v_cmp_gt_i32 s[84:85], 50, v25
  v_cmp_gt_i32 s[86:87], 51, v25
  v_cndmask_b32 v100, v100, v24, s[80:81]
  v_cndmask_b32 v101, v101, v24, s[82:83]
  v_cndmask_b32 v102, v102, v24, s[84:85]
  v_cndmask_b32 v103, v103, v24, s[86:87]
  v_add_u32 v4, 0x4000, v4
  v_and_b32 v4, 0x1ffff, v4
  s_cbranch_vccnz L_a_d0_t
L_a_d0_r:
L_a_d1:
  s_waitcnt vmcnt(24) lgkmcnt(0)
  v_mfma_f32_16x16x32_bf16 v[32:35], a[64:67], a[0:3], v[96:99]
  s_barrier
  ds_read_b128 a[96:99], v4 offset:0
  v_mfma_f32_16x16x32_bf16 v[32:35], a[72:75], a[4:7], v[32:35]
  s_nop 0
  ds_read_b128 a[100:103], v4 offset:1024
  v_mfma_f32_16x16x32_bf16 v[32:35], a[80:83], a[8:11], v[32:35]
  s_nop 0
  ds_read_b128 a[104:107], v4 offset:2048
  v_mfma_f32_16x16x32_bf16 v[32:35], a[88:91], a[12:15], v[32:35]
  s_nop 0
  ds_read_b128 a[108:111], v4 offset:3072
  v_mfma_f32_16x16x32_bf16 v[36:39], a[68:71], a[0:3], v[100:103]
  s_nop 0
  ds_read_b128 a[112:115], v4 offset:4096
  v_mfma_f32_16x16x32_bf16 v[36:39], a[76:79], a[4:7], v[36:39]
  s_nop 0
  ds_read_b128 a[116:119], v4 offset:5120
  v_mfma_f32_16x16x32_bf16 v[36:39], a[84:87], a[8:11], v[36:39]
  s_nop 0
  ds_read_b128 a[120:123], v4 offset:6144
  v_mfma_f32_16x16x32_bf16 v[36:39], a[92:95], a[12:15], v[36:39]
  s_nop 0
  ds_read_b128 a[124:127], v4 offset:7168
  v_mfma_f32_16x16x32_bf16 v[40:43], a[64:67], a[16:19], v[104:107]
  s_nop 0
  v_exp_f32 v8, v32
  v_mfma_f32_16x16x32_bf16 v[40:43], a[72:75], a[20:23], v[40:43]
  s_nop 0
  v_exp_f32 v9, v33
  v_mfma_f32_16x16x32_bf16 v[40:43], a[80:83], a[24:27], v[40:43]
  s_nop 0
  v_exp_f32 v10, v34
  v_mfma_f32_16x16x32_bf16 v[40:43], a[88:91], a[28:31], v[40:43]
  s_nop 0
  v_exp_f32 v11, v35
  v_mfma_f32_16x16x32_bf16 v[44:47], a[68:71], a[16:19], v[108:111]
  s_nop 0
  v_cvt_pk_bf16_f32 v80, v8, v9
  v_cvt_pk_bf16_f32 v81, v10, v11
  v_mfma_f32_16x16x32_bf16 v[44:47], a[76:79], a[20:23], v[44:47]
  s_nop 0
  v_or_b32 v5, v80, v81
  v_mfma_f32_16x16x32_bf16 v[44:47], a[84:87], a[24:27], v[44:47]
  s_nop 0
  v_exp_f32 v12, v36
  v_mfma_f32_16x16x32_bf16 v[44:47], a[92:95], a[28:31], v[44:47]
  s_nop 0
  v_exp_f32 v13, v37
  v_mfma_f32_16x16x32_bf16 v[48:51], a[64:67], a[32:35], v[112:115]
  s_nop 0
  v_exp_f32 v14, v38
  v_mfma_f32_16x16x32_bf16 v[48:51], a[72:75], a[36:39], v[48:51]
  s_nop 0
  v_exp_f32 v15, v39
  v_mfma_f32_16x16x32_bf16 v[48:51], a[80:83], a[40:43], v[48:51]
  s_nop 0
  v_cvt_pk_bf16_f32 v82, v12, v13
  v_cvt_pk_bf16_f32 v83, v14, v15
  v_mfma_f32_16x16x32_bf16 v[48:51], a[88:91], a[44:47], v[48:51]
  s_add_u32 m0, s64, s65
  s_nop 0
  buffer_load_dwordx4 v3, s[40:43], s61 offen sc1 lds
  v_or3_b32 v5, v5, v82, v83
  v_mfma_f32_16x16x32_bf16 v[52:55], a[68:71], a[32:35], v[116:119]
  s_nop 0
  v_exp_f32 v8, v40
  v_mfma_f32_16x16x32_bf16 v[52:55], a[76:79], a[36:39], v[52:55]
  s_nop 0
  v_exp_f32 v9, v41
  v_mfma_f32_16x16x32_bf16 v[52:55], a[84:87], a[40:43], v[52:55]
  s_min_u32 s66, s62, s63
  buffer_load_dwordx4 v3, s[40:43], s61 offen offset:1024 sc1 lds
  v_mfma_f32_16x16x32_bf16 v[52:55], a[92:95], a[44:47], v[52:55]
  s_nop 0
  v_exp_f32 v10, v42
  v_mfma_f32_16x16x32_bf16 v[56:59], a[64:67], a[48:51], v[120:123]
  s_nop 0
  v_exp_f32 v11, v43
  v_mfma_f32_16x16x32_bf16 v[56:59], a[72:75], a[52:55], v[56:59]
  s_add_u32 m0, m0, 0x2000
  s_nop 0
  buffer_load_dwordx4 v3, s[40:43], s66 offen sc1 lds
  v_cvt_pk_bf16_f32 v84, v8, v9
  v_mfma_f32_16x16x32_bf16 v[56:59], a[80:83], a[56:59], v[56:59]
  s_nop 0
  v_cvt_pk_bf16_f32 v85, v10, v11
  v_or3_b32 v5, v5, v84, v85
  v_mfma_f32_16x16x32_bf16 v[56:59], a[88:91], a[60:63], v[56:59]
  s_nop 0
  v_exp_f32 v12, v44
  v_mfma_f32_16x16x32_bf16 v[60:63], a[68:71], a[48:51], v[124:127]
  s_add_u32 s61, s61, 0x2000
  buffer_load_dwordx4 v3, s[40:43], s66 offen offset:1024 sc1 lds
  v_mfma_f32_16x16x32_bf16 v[60:63], a[76:79], a[52:55], v[60:63]
  s_add_u32 s62, s62, 0x2000
  v_exp_f32 v13, v45
  v_mfma_f32_16x16x32_bf16 v[60:63], a[84:87], a[56:59], v[60:63]
  s_add_u32 s64, s64, 0x4000
  v_exp_f32 v14, v46
  v_mfma_f32_16x16x32_bf16 v[60:63], a[92:95], a[60:63], v[60:63]
  s_and_b32 s64, s64, 0x1ffff
  v_exp_f32 v15, v47
  v_mfma_f32_16x16x32_bf16 a[128:131], v[16:19], v[64:67], a[128:131]
  s_add_u32 s58, s58, 1
  v_cvt_pk_bf16_f32 v86, v12, v13
  v_cvt_pk_bf16_f32 v87, v14, v15
  v_mfma_f32_16x16x32_bf16 a[132:135], v[16:19], v[68:71], a[132:135]
  s_nop 0
  ds_read_b128 a[64:67], v4 offset:8192
  v_or3_b32 v5, v5, v86, v87
  v_mfma_f32_16x16x32_bf16 a[136:139], v[16:19], v[72:75], a[136:139]
  s_nop 0
  v_exp_f32 v8, v48
  v_mfma_f32_16x16x32_bf16 a[140:143], v[16:19], v[76:79], a[140:143]
  s_nop 0
  v_exp_f32 v9, v49
  s_waitcnt lgkmcnt(1)
  v_mfma_f32_16x16x32_bf16 v[128:131], a[96:99], v[64:67], v[128:131]
  ds_read_b128 a[68:71], v4 offset:9216
  v_mfma_f32_16x16x32_bf16 v[160:163], a[96:99], v[68:71], v[160:163]
  v_exp_f32 v10, v50
  v_mfma_f32_16x16x32_bf16 v[192:195], a[96:99], v[72:75], v[192:195]
  v_exp_f32 v11, v51
  v_mfma_f32_16x16x32_bf16 v[224:227], a[96:99], v[76:79], v[224:227]
  ds_read_b128 a[72:75], v4 offset:10240
  v_cvt_pk_bf16_f32 v88, v8, v9
  v_mfma_f32_16x16x32_bf16 v[132:135], a[100:103], v[64:67], v[132:135]
  v_cvt_pk_bf16_f32 v89, v10, v11
  v_or3_b32 v5, v5, v88, v89
  v_mfma_f32_16x16x32_bf16 v[164:167], a[100:103], v[68:71], v[164:167]
  v_exp_f32 v12, v52
  v_mfma_f32_16x16x32_bf16 v[196:199], a[100:103], v[72:75], v[196:199]
  ds_read_b128 a[76:79], v4 offset:11264
  v_mfma_f32_16x16x32_bf16 v[228:231], a[100:103], v[76:79], v[228:231]
  v_exp_f32 v13, v53
  v_mfma_f32_16x16x32_bf16 v[136:139], a[104:107], v[64:67], v[136:139]
  v_exp_f32 v14, v54
  v_mfma_f32_16x16x32_bf16 v[168:171], a[104:107], v[68:71], v[168:171]
  ds_read_b128 a[80:83], v4 offset:12288
  v_mfma_f32_16x16x32_bf16 v[200:203], a[104:107], v[72:75], v[200:203]
  v_exp_f32 v15, v55
  v_mfma_f32_16x16x32_bf16 v[232:235], a[104:107], v[76:79], v[232:235]
  v_cvt_pk_bf16_f32 v90, v12, v13
  v_cvt_pk_bf16_f32 v91, v14, v15
  v_mfma_f32_16x16x32_bf16 v[140:143], a[108:111], v[64:67], v[140:143]
  ds_read_b128 a[84:87], v4 offset:13312
  v_or3_b32 v5, v5, v90, v91
  v_mfma_f32_16x16x32_bf16 v[172:175], a[108:111], v[68:71], v[172:175]
  v_exp_f32 v8, v56
  v_mfma_f32_16x16x32_bf16 v[204:207], a[108:111], v[72:75], v[204:207]
  v_exp_f32 v9, v57
  v_mfma_f32_16x16x32_bf16 v[236:239], a[108:111], v[76:79], v[236:239]
  ds_read_b128 a[88:91], v4 offset:14336
  v_mfma_f32_16x16x32_bf16 v[144:147], a[112:115], v[64:67], v[144:147]
  v_exp_f32 v10, v58
  v_mfma_f32_16x16x32_bf16 v[176:179], a[112:115], v[68:71], v[176:179]
  v_exp_f32 v11, v59
  v_mfma_f32_16x16x32_bf16 v[208:211], a[112:115], v[72:75], v[208:211]
  ds_read_b128 a[92:95], v4 offset:15360
  v_cvt_pk_bf16_f32 v92, v8, v9
  v_mfma_f32_16x16x32_bf16 v[240:243], a[112:115], v[76:79], v[240:243]
  v_cvt_pk_bf16_f32 v93, v10, v11
  v_or3_b32 v5, v5, v92, v93
  v_mfma_f32_16x16x32_bf16 v[148:151], a[116:119], v[64:67], v[148:151]
  v_exp_f32 v12, v60
  v_mfma_f32_16x16x32_bf16 v[180:183], a[116:119], v[68:71], v[180:183]
  v_exp_f32 v13, v61
  v_mfma_f32_16x16x32_bf16 v[212:215], a[116:119], v[72:75], v[212:215]
  v_exp_f32 v14, v62
  v_mfma_f32_16x16x32_bf16 v[244:247], a[116:119], v[76:79], v[244:247]
  v_exp_f32 v15, v63
  v_mfma_f32_16x16x32_bf16 v[152:155], a[120:123], v[64:67], v[152:155]
  v_cvt_pk_bf16_f32 v94, v12, v13
  v_cvt_pk_bf16_f32 v95, v14, v15
  v_mfma_f32_16x16x32_bf16 v[184:187], a[120:123], v[68:71], v[184:187]
  v_or3_b32 v5, v5, v94, v95
  v_and_b32 v5, s70, v5
  v_mfma_f32_16x16x32_bf16 v[216:219], a[120:123], v[72:75], v[216:219]
  v_cmp_ne_u32 vcc, 0, v5
  v_cmp_gt_i32 s[80:81], 0, v25
  v_mfma_f32_16x16x32_bf16 v[248:251], a[120:123], v[76:79], v[248:251]
  v_cmp_gt_i32 s[82:83], 1, v25
  v_cmp_gt_i32 s[84:85], 2, v25
  v_mfma_f32_16x16x32_bf16 v[156:159], a[124:127], v[64:67], v[156:159]
  v_cmp_gt_i32 s[86:87], 3, v25
  v_cndmask_b32 v104, v104, v24, s[80:81]
  v_mfma_f32_16x16x32_bf16 v[188:191], a[124:127], v[68:71], v[188:191]
  v_cndmask_b32 v105, v105, v24, s[82:83]
  v_cndmask_b32 v106, v106, v24, s[84:85]
  v_mfma_f32_16x16x32_bf16 v[220:223], a[124:127], v[72:75], v[220:223]
  v_cndmask_b32 v107, v107, v24, s[86:87]
  v_cmp_gt_i32 s[80:81], 16, v25
  v_mfma_f32_16x16x32_bf16 v[252:255], a[124:127], v[76:79], v[252:255]
  v_cmp_gt_i32 s[82:83], 17, v25
  v_cmp_gt_i32 s[84:85], 18, v25
  v_cmp_gt_i32 s[86:87], 19, v25
  v_cndmask_b32 v108, v108, v24, s[80:81]
  v_cndmask_b32 v109, v109, v24, s[82:83]
  v_cndmask_b32 v110, v110, v24, s[84:85]
  v_cndmask_b32 v111, v111, v24, s[86:87]
  v_add_u32 v4, 0x4000, v4
  v_and_b32 v4, 0x1ffff, v4
  s_cbranch_vccnz L_a_d1_t
L_a_d1_r:
L_a_d2:
  s_waitcnt vmcnt(24) lgkmcnt(0)
  v_mfma_f32_16x16x32_bf16 v[40:43], a[64:67], a[16:19], v[104:107]
  s_barrier
  ds_read_b128 a[96:99], v4 offset:0
  v_mfma_f32_16x16x32_bf16 v[40:43], a[72:75], a[20:23], v[40:43]
  s_nop 0
  ds_read_b128 a[100:103], v4 offset:1024
  v_mfma_f32_16x16x32_bf16 v[40:43], a[80:83], a[24:27], v[40:43]
  s_nop 0
  ds_read_b128 a[104:107], v4 offset:2048
  v_mfma_f32_16x16x32_bf16 v[40:43], a[88:91], a[28:31], v[40:43]
  s_nop 0
  ds_read_b128 a[108:111], v4 offset:3072
  v_mfma_f32_16x16x32_bf16 v[44:47], a[68:71], a[16:19], v[108:111]
  s_nop 0
  ds_read_b128 a[112:115], v4 offset:4096
  v_mfma_f32_16x16x32_bf16 v[44:47], a[76:79], a[20:23], v[44:47]
  s_nop 0
  ds_read_b128 a[116:119], v4 offset:5120
  v_mfma_f32_16x16x32_bf16 v[44:47], a[84:87], a[24:27], v[44:47]
  s_nop 0
  ds_read_b128 a[120:123], v4 offset:6144
  v_mfma_f32_16x16x32_bf16 v[44:47], a[92:95], a[28:31], v[44:47]
  s_nop 0
  ds_read_b128 a[124:127], v4 offset:7168
  v_mfma_f32_16x16x32_bf16 v[48:51], a[64:67], a[32:35], v[112:115]
  s_add_u32 m0, s73, 0
  s_add_u32 s66, s72, 0
  buffer_load_dwordx4 v26, s[48:51], s66 offen lds
  v_mfma_f32_16x16x32_bf16 v[48:51], a[72:75], a[36:39], v[48:51]
  s_add_u32 m0, s73, 1024
  s_add_u32 s66, s72, 8192
  buffer_load_dwordx4 v26, s[48:51], s66 offen lds
  v_mfma_f32_16x16x32_bf16 v[48:51], a[80:83], a[40:43], v[48:51]
  s_add_u32 m0, s73, 2048
  s_add_u32 s66, s72, 16384
  buffer_load_dwordx4 v26, s[48:51], s66 offen lds
  v_mfma_f32_16x16x32_bf16 v[48:51], a[88:91], a[44:47], v[48:51]
  s_add_u32 m0, s73, 3072
  s_add_u32 s66, s72, 24576
  buffer_load_dwordx4 v26, s[48:51], s66 offen lds
  v_mfma_f32_16x16x32_bf16 v[52:55], a[68:71], a[32:35], v[116:119]
  s_add_u32 s58, s58, 1
  v_exp_f32 v8, v40
  v_mfma_f32_16x16x32_bf16 v[52:55], a[76:79], a[36:39], v[52:55]
  s_nop 0
  v_exp_f32 v9, v41
  v_mfma_f32_16x16x32_bf16 v[52:55], a[84:87], a[40:43], v[52:55]
  s_nop 0
  v_exp_f32 v10, v42
  v_mfma_f32_16x16x32_bf16 v[52:55], a[92:95], a[44:47], v[52:55]
  s_nop 0
  v_exp_f32 v11, v43
  v_mfma_f32_16x16x32_bf16 v[56:59], a[64:67], a[48:51], v[120:123]
  s_nop 0
  v_cvt_pk_bf16_f32 v68, v8, v9
  v_cvt_pk_bf16_f32 v69, v10, v11
  v_mfma_f32_16x16x32_bf16 v[56:59], a[72:75], a[52:55], v[56:59]
  s_nop 0
  v_or_b32 v5, v68, v69
  v_mfma_f32_16x16x32_bf16 v[56:59], a[80:83], a[56:59], v[56:59]
  s_nop 0
  v_exp_f32 v12, v44
  v_mfma_f32_16x16x32_bf16 v[56:59], a[88:91], a[60:63], v[56:59]
  s_nop 0
  v_exp_f32 v13, v45
  v_mfma_f32_16x16x32_bf16 v[60:63], a[68:71], a[48:51], v[124:127]
  s_nop 0
  v_exp_f32 v14, v46
  v_mfma_f32_16x16x32_bf16 v[60:63], a[76:79], a[52:55], v[60:63]
  s_nop 0
  v_exp_f32 v15, v47
  v_mfma_f32_16x16x32_bf16 v[60:63], a[84:87], a[56:59], v[60:63]
  s_nop 0
  v_cvt_pk_bf16_f32 v70, v12, v13
  v_cvt_pk_bf16_f32 v71, v14, v15
  v_mfma_f32_16x16x32_bf16 v[60:63], a[92:95], a[60:63], v[60:63]
  s_nop 0
  v_or3_b32 v5, v5, v70, v71
  v_mfma_f32_16x16x32_bf16 a[128:131], v[16:19], v[80:83], a[128:131]
  s_nop 0
  v_exp_f32 v8, v48
  v_mfma_f32_16x16x32_bf16 a[132:135], v[16:19], v[84:87], a[132:135]
  s_nop 0
  ds_read_b128 a[64:67], v4 offset:8192
  v_mfma_f32_16x16x32_bf16 a[136:139], v[16:19], v[88:91], a[136:139]
  s_nop 0
  v_exp_f32 v9, v49
  v_mfma_f32_16x16x32_bf16 a[140:143], v[16:19], v[92:95], a[140:143]
  s_nop 0
  v_exp_f32 v10, v50
  s_waitcnt lgkmcnt(1)
  v_mfma_f32_16x16x32_bf16 v[128:131], a[96:99], v[80:83], v[128:131]
  ds_read_b128 a[68:71], v4 offset:9216
  v_mfma_f32_16x16x32_bf16 v[160:163], a[96:99], v[84:87], v[160:163]
  v_exp_f32 v11, v51
  v_mfma_f32_16x16x32_bf16 v[192:195], a[96:99], v[88:91], v[192:195]
  v_cvt_pk_bf16_f32 v72, v8, v9
  v_cvt_pk_bf16_f32 v73, v10, v11
  v_mfma_f32_16x16x32_bf16 v[224:227], a[96:99], v[92:95], v[224:227]
  ds_read_b128 a[72:75], v4 offset:10240
  v_or3_b32 v5, v5, v72, v73
  v_mfma_f32_16x16x32_bf16 v[132:135], a[100:103], v[80:83], v[132:135]
  v_exp_f32 v12, v52
  v_mfma_f32_16x16x32_bf16 v[164:167], a[100:103], v[84:87], v[164:167]
  v_exp_f32 v13, v53
  v_mfma_f32_16x16x32_bf16 v[196:199], a[100:103], v[88:91], v[196:199]
  ds_read_b128 a[76:79], v4 offset:11264
  v_mfma_f32_16x16x32_bf16 v[228:231], a[100:103], v[92:95], v[228:231]
  v_exp_f32 v14, v54
  v_mfma_f32_16x16x32_bf16 v[136:139], a[104:107], v[80:83], v[136:139]
  v_exp_f32 v15, v55
  v_mfma_f32_16x16x32_bf16 v[168:171], a[104:107], v[84:87], v[168:171]
  ds_read_b128 a[80:83], v4 offset:12288
  v_cvt_pk_bf16_f32 v74, v12, v13
  v_mfma_f32_16x16x32_bf16 v[200:203], a[104:107], v[88:91], v[200:203]
  v_cvt_pk_bf16_f32 v75, v14, v15
  v_or3_b32 v5, v5, v74, v75
  v_mfma_f32_16x16x32_bf16 v[232:235], a[104:107], v[92:95], v[232:235]
  v_exp_f32 v8, v56
  v_mfma_f32_16x16x32_bf16 v[140:143], a[108:111], v[80:83], v[140:143]
  ds_read_b128 a[84:87], v4 offset:13312
  v_mfma_f32_16x16x32_bf16 v[172:175], a[108:111], v[84:87], v[172:175]
  v_exp_f32 v9, v57
  v_mfma_f32_16x16x32_bf16 v[204:207], a[108:111], v[88:91], v[204:207]
  v_exp_f32 v10, v58
  v_mfma_f32_16x16x32_bf16 v[236:239], a[108:111], v[92:95], v[236:239]
  ds_read_b128 a[88:91], v4 offset:14336
  v_mfma_f32_16x16x32_bf16 v[144:147], a[112:115], v[80:83], v[144:147]
  v_exp_f32 v11, v59
  v_mfma_f32_16x16x32_bf16 v[176:179], a[112:115], v[84:87], v[176:179]
  v_cvt_pk_bf16_f32 v76, v8, v9
  v_cvt_pk_bf16_f32 v77, v10, v11
  v_mfma_f32_16x16x32_bf16 v[208:211], a[112:115], v[88:91], v[208:211]
  ds_read_b128 a[92:95], v4 offset:15360
  v_or3_b32 v5, v5, v76, v77
  v_mfma_f32_16x16x32_bf16 v[240:243], a[112:115], v[92:95], v[240:243]
  v_exp_f32 v12, v60
  v_mfma_f32_16x16x32_bf16 v[148:151], a[116:119], v[80:83], v[148:151]
  v_exp_f32 v13, v61
  v_mfma_f32_16x16x32_bf16 v[180:183], a[116:119], v[84:87], v[180:183]
  v_exp_f32 v14, v62
  v_mfma_f32_16x16x32_bf16 v[212:215], a[116:119], v[88:91], v[212:215]
  v_exp_f32 v15, v63
  v_mfma_f32_16x16x32_bf16 v[244:247], a[116:119], v[92:95], v[244:247]
  v_cvt_pk_bf16_f32 v78, v12, v13
  v_cvt_pk_bf16_f32 v79, v14, v15
  v_mfma_f32_16x16x32_bf16 v[152:155], a[120:123], v[80:83], v[152:155]
  v_or3_b32 v5, v5, v78, v79
  v_and_b32 v5, s70, v5
  v_mfma_f32_16x16x32_bf16 v[184:187], a[120:123], v[84:87], v[184:187]
  v_cmp_ne_u32 vcc, 0, v5
  v_cmp_gt_i32 s[80:81], 32, v25
  v_mfma_f32_16x16x32_bf16 v[216:219], a[120:123], v[88:91], v[216:219]
  v_cmp_gt_i32 s[82:83], 33, v25
  v_cmp_gt_i32 s[84:85], 34, v25
  v_mfma_f32_16x16x32_bf16 v[248:251], a[120:123], v[92:95], v[248:251]
  v_cmp_gt_i32 s[86:87], 35, v25
  v_cndmask_b32 v104, v104, v24, s[80:81]
  v_mfma_f32_16x16x32_bf16 v[156:159], a[124:127], v[80:83], v[156:159]
  v_cndmask_b32 v105, v105, v24, s[82:83]
  v_cndmask_b32 v106, v106, v24, s[84:85]
  v_mfma_f32_16x16x32_bf16 v[188:191], a[124:127], v[84:87], v[188:191]
  v_cndmask_b32 v107, v107, v24, s[86:87]
  v_cmp_gt_i32 s[80:81], 48, v25
  v_mfma_f32_16x16x32_bf16 v[220:223], a[124:127], v[88:91], v[220:223]
  v_cmp_gt_i32 s[82:83], 49, v25
  v_cmp_gt_i32 s[84:85], 50, v25
  v_mfma_f32_16x16x32_bf16 v[252:255], a[124:127], v[92:95], v[252:255]
  v_cmp_gt_i32 s[86:87], 51, v25
  v_cndmask_b32 v108, v108, v24, s[80:81]
  v_cndmask_b32 v109, v109, v24, s[82:83]
  v_cndmask_b32 v110, v110, v24, s[84:85]
  v_cndmask_b32 v111, v111, v24, s[86:87]
  v_add_u32 v4, 0x4000, v4
  v_and_b32 v4, 0x1ffff, v4
  s_cbranch_vccnz L_a_d2_t
L_a_d2_r:
L_a_d3:
  s_waitcnt vmcnt(24) lgkmcnt(0)
  v_mfma_f32_16x16x32_bf16 v[40:43], a[64:67], a[16:19], v[104:107]
  s_barrier
  ds_read_b128 a[96:99], v4 offset:0
  v_mfma_f32_16x16x32_bf16 v[40:43], a[72:75], a[20:23], v[40:43]
  s_nop 0
  ds_read_b128 a[100:103], v4 offset:1024
  v_mfma_f32_16x16x32_bf16 v[40:43], a[80:83], a[24:27], v[40:43]
  s_nop 0
  ds_read_b128 a[104:107], v4 offset:2048
  v_mfma_f32_16x16x32_bf16 v[40:43], a[88:91], a[28:31], v[40:43]
  s_nop 0
  ds_read_b128 a[108:111], v4 offset:3072
  v_mfma_f32_16x16x32_bf16 v[44:47], a[68:71], a[16:19], v[108:111]
  s_nop 0
  ds_read_b128 a[112:115], v4 offset:4096
  v_mfma_f32_16x16x32_bf16 v[44:47], a[76:79], a[20:23], v[44:47]
  s_nop 0
  ds_read_b128 a[116:119], v4 offset:5120
  v_mfma_f32_16x16x32_bf16 v[44:47], a[84:87], a[24:27], v[44:47]
  s_nop 0
  ds_read_b128 a[120:123], v4 offset:6144
  v_mfma_f32_16x16x32_bf16 v[44:47], a[92:95], a[28:31], v[44:47]
  s_nop 0
  ds_read_b128 a[124:127], v4 offset:7168
  v_mfma_f32_16x16x32_bf16 v[48:51], a[64:67], a[32:35], v[112:115]
  s_add_u32 m0, s73, 16384
  s_add_u32 s66, s72, 128
  buffer_load_dwordx4 v26, s[48:51], s66 offen lds
  v_mfma_f32_16x16x32_bf16 v[48:51], a[72:75], a[36:39], v[48:51]
  s_add_u32 m0, s73, 17408
  s_add_u32 s66, s72, 8320
  buffer_load_dwordx4 v26, s[48:51], s66 offen lds
  v_mfma_f32_16x16x32_bf16 v[48:51], a[80:83], a[40:43], v[48:51]
  s_add_u32 m0, s73, 18432
  s_add_u32 s66, s72, 16512
  buffer_load_dwordx4 v26, s[48:51], s66 offen lds
  v_mfma_f32_16x16x32_bf16 v[48:51], a[88:91], a[44:47], v[48:51]
  s_add_u32 m0, s73, 19456
  s_add_u32 s66, s72, 24704
  buffer_load_dwordx4 v26, s[48:51], s66 offen lds
  v_mfma_f32_16x16x32_bf16 v[52:55], a[68:71], a[32:35], v[116:119]
  s_add_u32 s58, s58, 1
  v_exp_f32 v8, v40
  v_mfma_f32_16x16x32_bf16 v[52:55], a[76:79], a[36:39], v[52:55]
  s_nop 0
  v_exp_f32 v9, v41
  v_mfma_f32_16x16x32_bf16 v[52:55], a[84:87], a[40:43], v[52:55]
  s_nop 0
  v_exp_f32 v10, v42
  v_mfma_f32_16x16x32_bf16 v[52:55], a[92:95], a[44:47], v[52:55]
  s_nop 0
  v_exp_f32 v11, v43
  v_mfma_f32_16x16x32_bf16 v[56:59], a[64:67], a[48:51], v[120:123]
  s_nop 0
  v_cvt_pk_bf16_f32 v84, v8, v9
  v_cvt_pk_bf16_f32 v85, v10, v11
  v_mfma_f32_16x16x32_bf16 v[56:59], a[72:75], a[52:55], v[56:59]
  s_nop 0
  v_or_b32 v5, v84, v85
  v_mfma_f32_16x16x32_bf16 v[56:59], a[80:83], a[56:59], v[56:59]
  s_nop 0
  v_exp_f32 v12, v44
  v_mfma_f32_16x16x32_bf16 v[56:59], a[88:91], a[60:63], v[56:59]
  s_nop 0
  v_exp_f32 v13, v45
  v_mfma_f32_16x16x32_bf16 v[60:63], a[68:71], a[48:51], v[124:127]
  s_nop 0
  v_exp_f32 v14, v46
  v_mfma_f32_16x16x32_bf16 v[60:63], a[76:79], a[52:55], v[60:63]
  s_nop 0
  v_exp_f32 v15, v47
  v_mfma_f32_16x16x32_bf16 v[60:63], a[84:87], a[56:59], v[60:63]
  s_nop 0
  v_cvt_pk_bf16_f32 v86, v12, v13
  v_cvt_pk_bf16_f32 v87, v14, v15
  v_mfma_f32_16x16x32_bf16 v[60:63], a[92:95], a[60:63], v[60:63]
  s_nop 0
  v_or3_b32 v5, v5, v86, v87
  v_mfma_f32_16x16x32_bf16 a[132:135], v[16:19], v[68:71], a[132:135]
  s_nop 0
  ds_read_b128 a[64:67], v4 offset:8192
  v_mfma_f32_16x16x32_bf16 a[136:139], v[16:19], v[72:75], a[136:139]
  s_nop 0
  ds_read_b128 a[68:71], v4 offset:9216
  v_mfma_f32_16x16x32_bf16 a[140:143], v[16:19], v[76:79], a[140:143]
  s_nop 0
  ds_read_b128 a[72:75], v4 offset:10240
  s_waitcnt lgkmcnt(3)
  v_mfma_f32_16x16x32_bf16 v[160:163], a[96:99], v[68:71], v[160:163]
  s_nop 0
  ds_read_b128 a[76:79], v4 offset:11264
  v_mfma_f32_16x16x32_bf16 v[192:195], a[96:99], v[72:75], v[192:195]
  ds_read_b128 a[80:83], v4 offset:12288
  v_mfma_f32_16x16x32_bf16 v[224:227], a[96:99], v[76:79], v[224:227]
  ds_read_b128 a[84:87], v4 offset:13312
  v_mfma_f32_16x16x32_bf16 v[164:167], a[100:103], v[68:71], v[164:167]
  ds_read_b128 a[88:91], v4 offset:14336
  v_mfma_f32_16x16x32_bf16 v[196:199], a[100:103], v[72:75], v[196:199]
  ds_read_b128 a[92:95], v4 offset:15360
  v_mfma_f32_16x16x32_bf16 v[228:231], a[100:103], v[76:79], v[228:231]
  v_exp_f32 v8, v48
  v_mfma_f32_16x16x32_bf16 v[168:171], a[104:107], v[68:71], v[168:171]
  v_exp_f32 v9, v49
  v_mfma_f32_16x16x32_bf16 v[200:203], a[104:107], v[72:75], v[200:203]
  v_exp_f32 v10, v50
  v_mfma_f32_16x16x32_bf16 v[232:235], a[104:107], v[76:79], v[232:235]
  v_exp_f32 v11, v51
  v_mfma_f32_16x16x32_bf16 v[172:175], a[108:111], v[68:71], v[172:175]
  v_cvt_pk_bf16_f32 v88, v8, v9
  v_cvt_pk_bf16_f32 v89, v10, v11
  v_mfma_f32_16x16x32_bf16 v[204:207], a[108:111], v[72:75], v[204:207]
  v_or3_b32 v5, v5, v88, v89
  v_mfma_f32_16x16x32_bf16 v[236:239], a[108:111], v[76:79], v[236:239]
  v_exp_f32 v12, v52
  v_mfma_f32_16x16x32_bf16 v[176:179], a[112:115], v[68:71], v[176:179]
  v_exp_f32 v13, v53
  v_mfma_f32_16x16x32_bf16 v[208:211], a[112:115], v[72:75], v[208:211]
  v_exp_f32 v14, v54
  v_mfma_f32_16x16x32_bf16 v[240:243], a[112:115], v[76:79], v[240:243]
  v_exp_f32 v15, v55
  v_mfma_f32_16x16x32_bf16 v[180:183], a[116:119], v[68:71], v[180:183]
  v_cvt_pk_bf16_f32 v90, v12, v13
  v_cvt_pk_bf16_f32 v91, v14, v15
  v_mfma_f32_16x16x32_bf16 v[212:215], a[116:119], v[72:75], v[212:215]
  v_or3_b32 v5, v5, v90, v91
  v_mfma_f32_16x16x32_bf16 v[244:247], a[116:119], v[76:79], v[244:247]
  v_exp_f32 v8, v56
  v_mfma_f32_16x16x32_bf16 v[184:187], a[120:123], v[68:71], v[184:187]
  v_exp_f32 v9, v57
  v_mfma_f32_16x16x32_bf16 v[216:219], a[120:123], v[72:75], v[216:219]
  v_exp_f32 v10, v58
  v_mfma_f32_16x16x32_bf16 v[248:251], a[120:123], v[76:79], v[248:251]
  v_exp_f32 v11, v59
  v_mfma_f32_16x16x32_bf16 v[188:191], a[124:127], v[68:71], v[188:191]
  v_cvt_pk_bf16_f32 v92, v8, v9
  v_cvt_pk_bf16_f32 v93, v10, v11
  v_mfma_f32_16x16x32_bf16 v[220:223], a[124:127], v[72:75], v[220:223]
  v_or3_b32 v5, v5, v92, v93
  v_mfma_f32_16x16x32_bf16 v[252:255], a[124:127], v[76:79], v[252:255]
  v_exp_f32 v12, v60
  v_exp_f32 v13, v61
  v_exp_f32 v14, v62
  v_exp_f32 v15, v63
  s_nop 0
  v_cvt_pk_bf16_f32 v94, v12, v13
  v_cvt_pk_bf16_f32 v95, v14, v15
  v_or3_b32 v5, v5, v94, v95
  v_and_b32 v5, s70, v5
  v_cmp_ne_u32 vcc, 0, v5
  v_cmp_gt_i32 s[80:81], 0, v25
  v_cmp_gt_i32 s[82:83], 1, v25
  v_cmp_gt_i32 s[84:85], 2, v25
  v_cmp_gt_i32 s[86:87], 3, v25
  v_cndmask_b32 v112, v112, v24, s[80:81]
  v_cndmask_b32 v113, v113, v24, s[82:83]
  v_cndmask_b32 v114, v114, v24, s[84:85]
  v_cndmask_b32 v115, v115, v24, s[86:87]
  v_cmp_gt_i32 s[80:81], 16, v25
  v_cmp_gt_i32 s[82:83], 17, v25
  v_cmp_gt_i32 s[84:85], 18, v25
  v_cmp_gt_i32 s[86:87], 19, v25
  v_cndmask_b32 v116, v116, v24, s[80:81]
  v_cndmask_b32 v117, v117, v24, s[82:83]
  v_cndmask_b32 v118, v118, v24, s[84:85]
  v_cndmask_b32 v119, v119, v24, s[86:87]
  v_add_u32 v4, 0x4000, v4
  v_and_b32 v4, 0x1ffff, v4
  s_cbranch_vccnz L_a_d3_t
L_a_d3_r:
L_a_d4:
  s_waitcnt vmcnt(24) lgkmcnt(0)
  v_mfma_f32_16x16x32_bf16 v[48:51], a[64:67], a[32:35], v[112:115]
  s_barrier
  ds_read_b128 a[96:99], v4 offset:0
  v_mfma_f32_16x16x32_bf16 v[48:51], a[72:75], a[36:39], v[48:51]
  s_nop 0
  ds_read_b128 a[100:103], v4 offset:1024
  v_mfma_f32_16x16x32_bf16 v[48:51], a[80:83], a[40:43], v[48:51]
  s_nop 0
  ds_read_b128 a[104:107], v4 offset:2048
  v_mfma_f32_16x16x32_bf16 v[48:51], a[88:91], a[44:47], v[48:51]
  s_nop 0
  ds_read_b128 a[108:111], v4 offset:3072
  v_mfma_f32_16x16x32_bf16 v[52:55], a[68:71], a[32:35], v[116:119]
  s_nop 0
  ds_read_b128 a[112:115], v4 offset:4096
  v_mfma_f32_16x16x32_bf16 v[52:55], a[76:79], a[36:39], v[52:55]
  s_nop 0
  ds_read_b128 a[116:119], v4 offset:5120
  v_mfma_f32_16x16x32_bf16 v[52:55], a[84:87], a[40:43], v[52:55]
  s_nop 0
  ds_read_b128 a[120:123], v4 offset:6144
  v_mfma_f32_16x16x32_bf16 v[52:55], a[92:95], a[44:47], v[52:55]
  s_nop 0
  ds_read_b128 a[124:127], v4 offset:7168
  v_mfma_f32_16x16x32_bf16 v[56:59], a[64:67], a[48:51], v[120:123]
  s_add_u32 m0, s73, 32768
  s_add_u32 s66, s72, 256
  buffer_load_dwordx4 v26, s[48:51], s66 offen lds
  v_mfma_f32_16x16x32_bf16 v[56:59], a[72:75], a[52:55], v[56:59]
  s_add_u32 m0, s73, 33792
  s_add_u32 s66, s72, 8448
  buffer_load_dwordx4 v26, s[48:51], s66 offen lds
  v_mfma_f32_16x16x32_bf16 v[56:59], a[80:83], a[56:59], v[56:59]
  s_add_u32 m0, s73, 34816
  s_add_u32 s66, s72, 16640
  buffer_load_dwordx4 v26, s[48:51], s66 offen lds
  v_mfma_f32_16x16x32_bf16 v[56:59], a[88:91], a[60:63], v[56:59]
  s_add_u32 m0, s73, 35840
  s_add_u32 s66, s72, 24832
  buffer_load_dwordx4 v26, s[48:51], s66 offen lds
  v_mfma_f32_16x16x32_bf16 v[60:63], a[68:71], a[48:51], v[124:127]
  s_add_u32 s58, s58, 1
  v_exp_f32 v8, v48
  v_mfma_f32_16x16x32_bf16 v[60:63], a[76:79], a[52:55], v[60:63]
  s_nop 0
  v_exp_f32 v9, v49
  v_mfma_f32_16x16x32_bf16 v[60:63], a[84:87], a[56:59], v[60:63]
  s_nop 0
  v_exp_f32 v10, v50
  v_mfma_f32_16x16x32_bf16 v[60:63], a[92:95], a[60:63], v[60:63]
  s_nop 0
  v_exp_f32 v11, v51
  v_mfma_f32_16x16x32_bf16 a[132:135], v[16:19], v[84:87], a[132:135]
  s_nop 0
  ds_read_b128 a[64:67], v4 offset:8192
  v_cvt_pk_bf16_f32 v72, v8, v9
  v_mfma_f32_16x16x32_bf16 a[136:139], v[16:19], v[88:91], a[136:139]
  s_nop 0
  ds_read_b128 a[68:71], v4 offset:9216
  v_cvt_pk_bf16_f32 v73, v10, v11
  v_mfma_f32_16x16x32_bf16 a[140:143], v[16:19], v[92:95], a[140:143]
  s_nop 0
  ds_read_b128 a[72:75], v4 offset:10240
  v_or_b32 v5, v72, v73
  s_waitcnt lgkmcnt(3)
  v_mfma_f32_16x16x32_bf16 v[160:163], a[96:99], v[84:87], v[160:163]
  s_nop 0
  ds_read_b128 a[76:79], v4 offset:11264
  v_mfma_f32_16x16x32_bf16 v[192:195], a[96:99], v[88:91], v[192:195]
  ds_read_b128 a[80:83], v4 offset:12288
  v_mfma_f32_16x16x32_bf16 v[224:227], a[96:99], v[92:95], v[224:227]
  ds_read_b128 a[84:87], v4 offset:13312
  v_mfma_f32_16x16x32_bf16 v[164:167], a[100:103], v[84:87], v[164:167]
  ds_read_b128 a[88:91], v4 offset:14336
  v_mfma_f32_16x16x32_bf16 v[196:199], a[100:103], v[88:91], v[196:199]
  ds_read_b128 a[92:95], v4 offset:15360
  v_mfma_f32_16x16x32_bf16 v[228:231], a[100:103], v[92:95], v[228:231]
  v_exp_f32 v12, v52
  v_mfma_f32_16x16x32_bf16 v[168:171], a[104:107], v[84:87], v[168:171]
  v_exp_f32 v13, v53
  v_mfma_f32_16x16x32_bf16 v[200:203], a[104:107], v[88:91], v[200:203]
  v_exp_f32 v14, v54
  v_mfma_f32_16x16x32_bf16 v[232:235], a[104:107], v[92:95], v[232:235]
  v_exp_f32 v15, v55
  v_mfma_f32_16x16x32_bf16 v[172:175], a[108:111], v[84:87], v[172:175]
  v_cvt_pk_bf16_f32 v74, v12, v13
  v_cvt_pk_bf16_f32 v75, v14, v15
  v_mfma_f32_16x16x32_bf16 v[204:207], a[108:111], v[88:91], v[204:207]
  v_or3_b32 v5, v5, v74, v75
  v_mfma_f32_16x16x32_bf16 v[236:239], a[108:111], v[92:95], v[236:239]
  v_exp_f32 v8, v56
  v_mfma_f32_16x16x32_bf16 v[176:179], a[112:115], v[84:87], v[176:179]
  v_exp_f32 v9, v57
  v_mfma_f32_16x16x32_bf16 v[208:211], a[112:115], v[88:91], v[208:211]
  v_exp_f32 v10, v58
  v_mfma_f32_16x16x32_bf16 v[240:243], a[112:115], v[92:95], v[240:243]
  v_exp_f32 v11, v59
  v_mfma_f32_16x16x32_bf16 v[180:183], a[116:119], v[84:87], v[180:183]
  v_cvt_pk_bf16_f32 v76, v8, v9
  v_cvt_pk_bf16_f32 v77, v10, v11
  v_mfma_f32_16x16x32_bf16 v[212:215], a[116:119], v[88:91], v[212:215]
  v_or3_b32 v5, v5, v76, v77
  v_mfma_f32_16x16x32_bf16 v[244:247], a[116:119], v[92:95], v[244:247]
  v_exp_f32 v12, v60
  v_mfma_f32_16x16x32_bf16 v[184:187], a[120:123], v[84:87], v[184:187]
  v_exp_f32 v13, v61
  v_mfma_f32_16x16x32_bf16 v[216:219], a[120:123], v[88:91], v[216:219]
  v_exp_f32 v14, v62
  v_mfma_f32_16x16x32_bf16 v[248:251], a[120:123], v[92:95], v[248:251]
  v_exp_f32 v15, v63
  v_mfma_f32_16x16x32_bf16 v[188:191], a[124:127], v[84:87], v[188:191]
  v_cvt_pk_bf16_f32 v78, v12, v13
  v_cvt_pk_bf16_f32 v79, v14, v15
  v_mfma_f32_16x16x32_bf16 v[220:223], a[124:127], v[88:91], v[220:223]
  v_or3_b32 v5, v5, v78, v79
  v_and_b32 v5, s70, v5
  v_mfma_f32_16x16x32_bf16 v[252:255], a[124:127], v[92:95], v[252:255]
  v_cmp_ne_u32 vcc, 0, v5
  v_cmp_gt_i32 s[80:81], 32, v25
  v_cmp_gt_i32 s[82:83], 33, v25
  v_cmp_gt_i32 s[84:85], 34, v25
  v_cmp_gt_i32 s[86:87], 35, v25
  v_cndmask_b32 v112, v112, v24, s[80:81]
  v_cndmask_b32 v113, v113, v24, s[82:83]
  v_cndmask_b32 v114, v114, v24, s[84:85]
  v_cndmask_b32 v115, v115, v24, s[86:87]
  v_cmp_gt_i32 s[80:81], 48, v25
  v_cmp_gt_i32 s[82:83], 49, v25
  v_cmp_gt_i32 s[84:85], 50, v25
  v_cmp_gt_i32 s[86:87], 51, v25
  v_cndmask_b32 v116, v116, v24, s[80:81]
  v_cndmask_b32 v117, v117, v24, s[82:83]
  v_cndmask_b32 v118, v118, v24, s[84:85]
  v_cndmask_b32 v119, v119, v24, s[86:87]
  v_add_u32 v4, 0x4000, v4
  v_and_b32 v4, 0x1ffff, v4
  s_cbranch_vccnz L_a_d4_t
L_a_d4_r:
L_a_d5:
  s_waitcnt vmcnt(24) lgkmcnt(0)
  v_mfma_f32_16x16x32_bf16 v[48:51], a[64:67], a[32:35], v[112:115]
  s_barrier
  ds_read_b128 a[96:99], v4 offset:0
  v_mfma_f32_16x16x32_bf16 v[48:51], a[72:75], a[36:39], v[48:51]
  s_nop 0
  ds_read_b128 a[100:103], v4 offset:1024
  v_mfma_f32_16x16x32_bf16 v[48:51], a[80:83], a[40:43], v[48:51]
  s_nop 0
  ds_read_b128 a[104:107], v4 offset:2048
  v_mfma_f32_16x16x32_bf16 v[48:51], a[88:91], a[44:47], v[48:51]
  s_nop 0
  ds_read_b128 a[108:111], v4 offset:3072
  v_mfma_f32_16x16x32_bf16 v[52:55], a[68:71], a[32:35], v[116:119]
  s_nop 0
  ds_read_b128 a[112:115], v4 offset:4096
  v_mfma_f32_16x16x32_bf16 v[52:55], a[76:79], a[36:39], v[52:55]
  s_nop 0
  ds_read_b128 a[116:119], v4 offset:5120
  v_mfma_f32_16x16x32_bf16 v[52:55], a[84:87], a[40:43], v[52:55]
  s_nop 0
  ds_read_b128 a[120:123], v4 offset:6144
  v_mfma_f32_16x16x32_bf16 v[52:55], a[92:95], a[44:47], v[52:55]
  s_nop 0
  ds_read_b128 a[124:127], v4 offset:7168
  v_mfma_f32_16x16x32_bf16 v[56:59], a[64:67], a[48:51], v[120:123]
  s_add_u32 m0, s73, 49152
  s_add_u32 s66, s72, 384
  buffer_load_dwordx4 v26, s[48:51], s66 offen lds
  v_mfma_f32_16x16x32_bf16 v[56:59], a[72:75], a[52:55], v[56:59]
  s_add_u32 m0, s73, 50176
  s_add_u32 s66, s72, 8576
  buffer_load_dwordx4 v26, s[48:51], s66 offen lds
  v_mfma_f32_16x16x32_bf16 v[56:59], a[80:83], a[56:59], v[56:59]
  s_add_u32 m0, s73, 51200
  s_add_u32 s66, s72, 16768
  buffer_load_dwordx4 v26, s[48:51], s66 offen lds
  v_mfma_f32_16x16x32_bf16 v[56:59], a[88:91], a[60:63], v[56:59]
  s_add_u32 m0, s73, 52224
  s_add_u32 s66, s72, 24960
  buffer_load_dwordx4 v26, s[48:51], s66 offen lds
  v_mfma_f32_16x16x32_bf16 v[60:63], a[68:71], a[48:51], v[124:127]
  s_add_u32 s58, s58, 1
  v_exp_f32 v8, v48
  v_mfma_f32_16x16x32_bf16 v[60:63], a[76:79], a[52:55], v[60:63]
  s_nop 0
  v_exp_f32 v9, v49
  v_mfma_f32_16x16x32_bf16 v[60:63], a[84:87], a[56:59], v[60:63]
  s_nop 0
  v_exp_f32 v10, v50
  v_mfma_f32_16x16x32_bf16 v[60:63], a[92:95], a[60:63], v[60:63]
  s_nop 0
  v_exp_f32 v11, v51
  v_mfma_f32_16x16x32_bf16 a[136:139], v[16:19], v[72:75], a[136:139]
  s_nop 0
  ds_read_b128 a[64:67], v4 offset:8192
  v_cvt_pk_bf16_f32 v88, v8, v9
  v_mfma_f32_16x16x32_bf16 a[140:143], v[16:19], v[76:79], a[140:143]
  s_nop 0
  ds_read_b128 a[68:71], v4 offset:9216
  v_cvt_pk_bf16_f32 v89, v10, v11
  s_waitcnt lgkmcnt(2)
  v_mfma_f32_16x16x32_bf16 v[192:195], a[96:99], v[72:75], v[192:195]
  s_nop 0
  ds_read_b128 a[72:75], v4 offset:10240
  v_or_b32 v5, v88, v89
  v_mfma_f32_16x16x32_bf16 v[224:227], a[96:99], v[76:79], v[224:227]
  s_nop 0
  ds_read_b128 a[76:79], v4 offset:11264
  v_mfma_f32_16x16x32_bf16 v[196:199], a[100:103], v[72:75], v[196:199]
  ds_read_b128 a[80:83], v4 offset:12288
  v_mfma_f32_16x16x32_bf16 v[228:231], a[100:103], v[76:79], v[228:231]
  ds_read_b128 a[84:87], v4 offset:13312
  v_mfma_f32_16x16x32_bf16 v[200:203], a[104:107], v[72:75], v[200:203]
  ds_read_b128 a[88:91], v4 offset:14336
  v_mfma_f32_16x16x32_bf16 v[232:235], a[104:107], v[76:79], v[232:235]
  ds_read_b128 a[92:95], v4 offset:15360
  v_mfma_f32_16x16x32_bf16 v[204:207], a[108:111], v[72:75], v[204:207]
  v_exp_f32 v12, v52
  v_mfma_f32_16x16x32_bf16 v[236:239], a[108:111], v[76:79], v[236:239]
  v_exp_f32 v13, v53
  v_mfma_f32_16x16x32_bf16 v[208:211], a[112:115], v[72:75], v[208:211]
  v_exp_f32 v14, v54
  v_mfma_f32_16x16x32_bf16 v[240:243], a[112:115], v[76:79], v[240:243]
  v_exp_f32 v15, v55
  v_mfma_f32_16x16x32_bf16 v[212:215], a[116:119], v[72:75], v[212:215]
  v_cvt_pk_bf16_f32 v90, v12, v13
  v_cvt_pk_bf16_f32 v91, v14, v15
  v_mfma_f32_16x16x32_bf16 v[244:247], a[116:119], v[76:79], v[244:247]
  v_or3_b32 v5, v5, v90, v91
  v_mfma_f32_16x16x32_bf16 v[216:219], a[120:123], v[72:75], v[216:219]
  v_exp_f32 v8, v56
  v_mfma_f32_16x16x32_bf16 v[248:251], a[120:123], v[76:79], v[248:251]
  v_exp_f32 v9, v57
  v_mfma_f32_16x16x32_bf16 v[220:223], a[124:127], v[72:75], v[220:223]
  v_exp_f32 v10, v58
  v_mfma_f32_16x16x32_bf16 v[252:255], a[124:127], v[76:79], v[252:255]
  v_exp_f32 v11, v59
  s_nop 0
  v_cvt_pk_bf16_f32 v92, v8, v9
  v_cvt_pk_bf16_f32 v93, v10, v11
  v_or3_b32 v5, v5, v92, v93
  v_exp_f32 v12, v60
  v_exp_f32 v13, v61
  v_exp_f32 v14, v62
  v_exp_f32 v15, v63
  s_nop 0
  v_cvt_pk_bf16_f32 v94, v12, v13
  v_cvt_pk_bf16_f32 v95, v14, v15
  v_or3_b32 v5, v5, v94, v95
  v_and_b32 v5, s70, v5
  v_cmp_ne_u32 vcc, 0, v5
  v_cmp_gt_i32 s[80:81], 0, v25
  v_cmp_gt_i32 s[82:83], 1, v25
  v_cmp_gt_i32 s[84:85], 2, v25
  v_cmp_gt_i32 s[86:87], 3, v25
  v_cndmask_b32 v120, v120, v24, s[80:81]
  v_cndmask_b32 v121, v121, v24, s[82:83]
  v_cndmask_b32 v122, v122, v24, s[84:85]
  v_cndmask_b32 v123, v123, v24, s[86:87]
  v_cmp_gt_i32 s[80:81], 16, v25
  v_cmp_gt_i32 s[82:83], 17, v25
  v_cmp_gt_i32 s[84:85], 18, v25
  v_cmp_gt_i32 s[86:87], 19, v25
  v_cndmask_b32 v124, v124, v24, s[80:81]
  v_cndmask_b32 v125, v125, v24, s[82:83]
  v_cndmask_b32 v126, v126, v24, s[84:85]
  v_cndmask_b32 v127, v127, v24, s[86:87]
  v_add_u32 v4, 0x4000, v4
  v_and_b32 v4, 0x1ffff, v4
  s_cbranch_vccnz L_a_d5_t
L_a_d5_r:
L_a_d6:
  s_waitcnt vmcnt(24) lgkmcnt(0)
  v_mfma_f32_16x16x32_bf16 v[56:59], a[64:67], a[48:51], v[120:123]
  s_barrier
  ds_read_b128 a[96:99], v4 offset:0
  v_mfma_f32_16x16x32_bf16 v[56:59], a[72:75], a[52:55], v[56:59]
  s_nop 0
  ds_read_b128 a[100:103], v4 offset:1024
  v_mfma_f32_16x16x32_bf16 v[56:59], a[80:83], a[56:59], v[56:59]
  s_nop 0
  ds_read_b128 a[104:107], v4 offset:2048
  v_mfma_f32_16x16x32_bf16 v[56:59], a[88:91], a[60:63], v[56:59]
  s_nop 0
  ds_read_b128 a[108:111], v4 offset:3072
  v_mfma_f32_16x16x32_bf16 v[60:63], a[68:71], a[48:51], v[124:127]
  s_nop 0
  ds_read_b128 a[112:115], v4 offset:4096
  v_mfma_f32_16x16x32_bf16 v[60:63], a[76:79], a[52:55], v[60:63]
  s_nop 0
  ds_read_b128 a[116:119], v4 offset:5120
  v_mfma_f32_16x16x32_bf16 v[60:63], a[84:87], a[56:59], v[60:63]
  s_nop 0
  ds_read_b128 a[120:123], v4 offset:6144
  v_mfma_f32_16x16x32_bf16 v[60:63], a[92:95], a[60:63], v[60:63]
  s_nop 0
  ds_read_b128 a[124:127], v4 offset:7168
  v_mfma_f32_16x16x32_bf16 a[136:139], v[16:19], v[88:91], a[136:139]
  s_add_u32 m0, s73, 65536
  s_add_u32 s66, s72, 512
  buffer_load_dwordx4 v26, s[48:51], s66 offen lds
  v_mfma_f32_16x16x32_bf16 a[140:143], v[16:19], v[92:95], a[140:143]
  s_add_u32 m0, s73, 66560
  s_add_u32 s66, s72, 8704
  buffer_load_dwordx4 v26, s[48:51], s66 offen lds
  s_waitcnt lgkmcnt(0)
  v_mfma_f32_16x16x32_bf16 v[192:195], a[96:99], v[88:91], v[192:195]
  s_add_u32 m0, s73, 67584
  s_add_u32 s66, s72, 16896
  buffer_load_dwordx4 v26, s[48:51], s66 offen lds
  v_mfma_f32_16x16x32_bf16 v[224:227], a[96:99], v[92:95], v[224:227]
  s_add_u32 m0, s73, 68608
  s_add_u32 s66, s72, 25088
  buffer_load_dwordx4 v26, s[48:51], s66 offen lds
  v_mfma_f32_16x16x32_bf16 v[196:199], a[100:103], v[88:91], v[196:199]
  s_add_u32 s58, s58, 1
  ds_read_b128 a[64:67], v4 offset:8192
  v_mfma_f32_16x16x32_bf16 v[228:231], a[100:103], v[92:95], v[228:231]
  ds_read_b128 a[68:71], v4 offset:9216
  v_mfma_f32_16x16x32_bf16 v[200:203], a[104:107], v[88:91], v[200:203]
  ds_read_b128 a[72:75], v4 offset:10240
  v_mfma_f32_16x16x32_bf16 v[232:235], a[104:107], v[92:95], v[232:235]
  ds_read_b128 a[76:79], v4 offset:11264
  v_mfma_f32_16x16x32_bf16 v[204:207], a[108:111], v[88:91], v[204:207]
  ds_read_b128 a[80:83], v4 offset:12288
  v_mfma_f32_16x16x32_bf16 v[236:239], a[108:111], v[92:95], v[236:239]
  ds_read_b128 a[84:87], v4 offset:13312
  v_mfma_f32_16x16x32_bf16 v[208:211], a[112:115], v[88:91], v[208:211]
  ds_read_b128 a[88:91], v4 offset:14336
  v_mfma_f32_16x16x32_bf16 v[240:243], a[112:115], v[92:95], v[240:243]
  ds_read_b128 a[92:95], v4 offset:15360
  v_mfma_f32_16x16x32_bf16 v[212:215], a[116:119], v[88:91], v[212:215]
  v_exp_f32 v8, v56
  v_mfma_f32_16x16x32_bf16 v[244:247], a[116:119], v[92:95], v[244:247]
  v_exp_f32 v9, v57
  v_mfma_f32_16x16x32_bf16 v[216:219], a[120:123], v[88:91], v[216:219]
  v_exp_f32 v10, v58
  v_mfma_f32_16x16x32_bf16 v[248:251], a[120:123], v[92:95], v[248:251]
  v_exp_f32 v11, v59
  v_mfma_f32_16x16x32_bf16 v[220:223], a[124:127], v[88:91], v[220:223]
  v_cvt_pk_bf16_f32 v76, v8, v9
  v_cvt_pk_bf16_f32 v77, v10, v11
  v_mfma_f32_16x16x32_bf16 v[252:255], a[124:127], v[92:95], v[252:255]
  v_or_b32 v5, v76, v77
  v_exp_f32 v12, v60
  v_exp_f32 v13, v61
  v_exp_f32 v14, v62
  v_exp_f32 v15, v63
  s_nop 0
  v_cvt_pk_bf16_f32 v78, v12, v13
  v_cvt_pk_bf16_f32 v79, v14, v15
  v_or3_b32 v5, v5, v78, v79
  v_and_b32 v5, s70, v5
  v_cmp_ne_u32 vcc, 0, v5
  v_cmp_gt_i32 s[80:81], 32, v25
  v_cmp_gt_i32 s[82:83], 33, v25
  v_cmp_gt_i32 s[84:85], 34, v25
  v_cmp_gt_i32 s[86:87], 35, v25
  v_cndmask_b32 v120, v120, v24, s[80:81]
  v_cndmask_b32 v121, v121, v24, s[82:83]
  v_cndmask_b32 v122, v122, v24, s[84:85]
  v_cndmask_b32 v123, v123, v24, s[86:87]
  v_cmp_gt_i32 s[80:81], 48, v25
  v_cmp_gt_i32 s[82:83], 49, v25
  v_cmp_gt_i32 s[84:85], 50, v25
  v_cmp_gt_i32 s[86:87], 51, v25
  v_cndmask_b32 v124, v124, v24, s[80:81]
  v_cndmask_b32 v125, v125, v24, s[82:83]
  v_cndmask_b32 v126, v126, v24, s[84:85]
  v_cndmask_b32 v127, v127, v24, s[86:87]
  v_add_u32 v4, 0x4000, v4
  v_and_b32 v4, 0x1ffff, v4
  s_cbranch_vccnz L_a_d6_t
L_a_d6_r:
L_a_d7:
  s_waitcnt vmcnt(24) lgkmcnt(0)
  v_mfma_f32_16x16x32_bf16 v[56:59], a[64:67], a[48:51], v[120:123]
  s_barrier
  ds_read_b128 a[96:99], v4 offset:0
  v_mfma_f32_16x16x32_bf16 v[56:59], a[72:75], a[52:55], v[56:59]
  s_nop 0
  ds_read_b128 a[100:103], v4 offset:1024
  v_mfma_f32_16x16x32_bf16 v[56:59], a[80:83], a[56:59], v[56:59]
  s_nop 0
  ds_read_b128 a[104:107], v4 offset:2048
  v_mfma_f32_16x16x32_bf16 v[56:59], a[88:91], a[60:63], v[56:59]
  s_nop 0
  ds_read_b128 a[108:111], v4 offset:3072
  v_mfma_f32_16x16x32_bf16 v[60:63], a[68:71], a[48:51], v[124:127]
  s_nop 0
  ds_read_b128 a[112:115], v4 offset:4096
  v_mfma_f32_16x16x32_bf16 v[60:63], a[76:79], a[52:55], v[60:63]
  s_nop 0
  ds_read_b128 a[116:119], v4 offset:5120
  v_mfma_f32_16x16x32_bf16 v[60:63], a[84:87], a[56:59], v[60:63]
  s_nop 0
  ds_read_b128 a[120:123], v4 offset:6144
  v_mfma_f32_16x16x32_bf16 v[60:63], a[92:95], a[60:63], v[60:63]
  s_nop 0
  ds_read_b128 a[124:127], v4 offset:7168
  v_mfma_f32_16x16x32_bf16 a[140:143], v[16:19], v[76:79], a[140:143]
  s_add_u32 m0, s73, 81920
  s_add_u32 s66, s72, 640
  buffer_load_dwordx4 v26, s[48:51], s66 offen lds
  s_waitcnt lgkmcnt(0)
  v_mfma_f32_16x16x32_bf16 v[224:227], a[96:99], v[76:79], v[224:227]
  s_add_u32 m0, s73, 82944
  s_add_u32 s66, s72, 8832
  buffer_load_dwordx4 v26, s[48:51], s66 offen lds
  v_mfma_f32_16x16x32_bf16 v[228:231], a[100:103], v[76:79], v[228:231]
  s_add_u32 m0, s73, 83968
  s_add_u32 s66, s72, 17024
  buffer_load_dwordx4 v26, s[48:51], s66 offen lds
  v_mfma_f32_16x16x32_bf16 v[232:235], a[104:107], v[76:79], v[232:235]
  s_add_u32 m0, s73, 84992
  s_add_u32 s66, s72, 25216
  buffer_load_dwordx4 v26, s[48:51], s66 offen lds
  v_mfma_f32_16x16x32_bf16 v[236:239], a[108:111], v[76:79], v[236:239]
  s_add_u32 s58, s58, 1
  v_exp_f32 v8, v56
  v_mfma_f32_16x16x32_bf16 v[240:243], a[112:115], v[76:79], v[240:243]
  v_exp_f32 v9, v57
  v_mfma_f32_16x16x32_bf16 v[244:247], a[116:119], v[76:79], v[244:247]
  v_exp_f32 v10, v58
  v_mfma_f32_16x16x32_bf16 v[248:251], a[120:123], v[76:79], v[248:251]
  v_exp_f32 v11, v59
  v_mfma_f32_16x16x32_bf16 v[252:255], a[124:127], v[76:79], v[252:255]
  v_cvt_pk_bf16_f32 v92, v8, v9
  v_cvt_pk_bf16_f32 v93, v10, v11
  v_or_b32 v5, v92, v93
  v_exp_f32 v12, v60
  v_exp_f32 v13, v61
  v_exp_f32 v14, v62
  v_exp_f32 v15, v63
  s_nop 0
  v_cvt_pk_bf16_f32 v94, v12, v13
  v_cvt_pk_bf16_f32 v95, v14, v15
  v_or3_b32 v5, v5, v94, v95
  v_and_b32 v5, s70, v5
  v_cmp_ne_u32 vcc, 0, v5
  v_add_u32 v4, 0x4000, v4
  v_and_b32 v4, 0x1ffff, v4
  s_cbranch_vccnz L_a_d7_t
L_a_d7_r:
  s_waitcnt vmcnt(24)
  s_barrier
  ds_read_b128 a[96:99], v4 offset:0
  ds_read_b128 a[100:103], v4 offset:1024
  ds_read_b128 a[104:107], v4 offset:2048
  ds_read_b128 a[108:111], v4 offset:3072
  ds_read_b128 a[112:115], v4 offset:4096
  ds_read_b128 a[116:119], v4 offset:5120
  ds_read_b128 a[120:123], v4 offset:6144
  ds_read_b128 a[124:127], v4 offset:7168
  s_add_u32 m0, s73, 98304
  s_add_u32 s66, s72, 768
  buffer_load_dwordx4 v26, s[48:51], s66 offen lds
  s_add_u32 m0, s73, 99328
  s_add_u32 s66, s72, 8960
  buffer_load_dwordx4 v26, s[48:51], s66 offen lds
  s_add_u32 m0, s73, 100352
  s_add_u32 s66, s72, 17152
  buffer_load_dwordx4 v26, s[48:51], s66 offen lds
  s_add_u32 m0, s73, 101376
  s_add_u32 s66, s72, 25344
  buffer_load_dwordx4 v26, s[48:51], s66 offen lds
  v_mfma_f32_16x16x32_bf16 a[140:143], v[16:19], v[92:95], a[140:143]
  s_waitcnt lgkmcnt(7)
  v_mfma_f32_16x16x32_bf16 v[224:227], a[96:99], v[92:95], v[224:227]
  s_waitcnt lgkmcnt(6)
  v_mfma_f32_16x16x32_bf16 v[228:231], a[100:103], v[92:95], v[228:231]
  s_waitcnt lgkmcnt(5)
  v_mfma_f32_16x16x32_bf16 v[232:235], a[104:107], v[92:95], v[232:235]
  s_waitcnt lgkmcnt(4)
  v_mfma_f32_16x16x32_bf16 v[236:239], a[108:111], v[92:95], v[236:239]
  s_waitcnt lgkmcnt(3)
  v_mfma_f32_16x16x32_bf16 v[240:243], a[112:115], v[92:95], v[240:243]
  s_waitcnt lgkmcnt(2)
  v_mfma_f32_16x16x32_bf16 v[244:247], a[116:119], v[92:95], v[244:247]
  s_waitcnt lgkmcnt(1)
  v_mfma_f32_16x16x32_bf16 v[248:251], a[120:123], v[92:95], v[248:251]
  s_waitcnt lgkmcnt(0)
  v_mfma_f32_16x16x32_bf16 v[252:255], a[124:127], v[92:95], v[252:255]
  s_barrier
  s_add_u32 m0, s73, 114688
  s_add_u32 s66, s72, 896
  buffer_load_dwordx4 v26, s[48:51], s66 offen lds
  s_add_u32 m0, s73, 115712
  s_add_u32 s66, s72, 9088
  buffer_load_dwordx4 v26, s[48:51], s66 offen lds
  s_add_u32 m0, s73, 116736
  s_add_u32 s66, s72, 17280
  buffer_load_dwordx4 v26, s[48:51], s66 offen lds
  s_add_u32 m0, s73, 117760
  s_add_u32 s66, s72, 25472
  buffer_load_dwordx4 v26, s[48:51], s66 offen lds
  v_accvgpr_read_b32 v6, a128
  v_rcp_f32 v6, v6
  s_nop 0
  v_mul_f32 v20, v20, v6
  v_accvgpr_read_b32 v6, a132
  v_rcp_f32 v6, v6
  s_nop 0
  v_mul_f32 v21, v21, v6
  v_accvgpr_read_b32 v6, a136
  v_rcp_f32 v6, v6
  s_nop 0
  v_mul_f32 v22, v22, v6
  v_accvgpr_read_b32 v6, a140
  v_rcp_f32 v6, v6
  s_nop 0
  v_mul_f32 v23, v23, v6
  v_mul_f32 v128, v128, v20
  v_mul_f32 v129, v129, v20
  v_mul_f32 v130, v130, v20
  v_mul_f32 v131, v131, v20
  v_mul_f32 v132, v132, v20
  v_mul_f32 v133, v133, v20
  v_mul_f32 v134, v134, v20
  v_mul_f32 v135, v135, v20
  v_cvt_pk_bf16_f32 v32, v128, v129
  v_cvt_pk_bf16_f32 v33, v130, v131
  v_cvt_pk_bf16_f32 v34, v132, v133
  v_cvt_pk_bf16_f32 v35, v134, v135
  v_mul_f32 v136, v136, v20
  v_mul_f32 v137, v137, v20
  v_mul_f32 v138, v138, v20
  v_mul_f32 v139, v139, v20
  v_mul_f32 v140, v140, v20
  v_mul_f32 v141, v141, v20
  v_mul_f32 v142, v142, v20
  v_mul_f32 v143, v143, v20
  v_cvt_pk_bf16_f32 v36, v136, v137
  v_cvt_pk_bf16_f32 v37, v138, v139
  v_cvt_pk_bf16_f32 v38, v140, v141
  v_cvt_pk_bf16_f32 v39, v142, v143
  v_mul_f32 v144, v144, v20
  v_mul_f32 v145, v145, v20
  v_mul_f32 v146, v146, v20
  v_mul_f32 v147, v147, v20
  v_mul_f32 v148, v148, v20
  v_mul_f32 v149, v149, v20
  v_mul_f32 v150, v150, v20
  v_mul_f32 v151, v151, v20
  v_cvt_pk_bf16_f32 v40, v144, v145
  v_cvt_pk_bf16_f32 v41, v146, v147
  v_cvt_pk_bf16_f32 v42, v148, v149
  v_cvt_pk_bf16_f32 v43, v150, v151
  v_mul_f32 v152, v152, v20
  v_mul_f32 v153, v153, v20
  v_mul_f32 v154, v154, v20
  v_mul_f32 v155, v155, v20
  v_mul_f32 v156, v156, v20
  v_mul_f32 v157, v157, v20
  v_mul_f32 v158, v158, v20
  v_mul_f32 v159, v159, v20
  v_cvt_pk_bf16_f32 v44, v152, v153
  v_cvt_pk_bf16_f32 v45, v154, v155
  v_cvt_pk_bf16_f32 v46, v156, v157
  v_cvt_pk_bf16_f32 v47, v158, v159
  v_mul_f32 v160, v160, v21
  v_mul_f32 v161, v161, v21
  v_mul_f32 v162, v162, v21
  v_mul_f32 v163, v163, v21
  v_mul_f32 v164, v164, v21
  v_mul_f32 v165, v165, v21
  v_mul_f32 v166, v166, v21
  v_mul_f32 v167, v167, v21
  v_cvt_pk_bf16_f32 v48, v160, v161
  v_cvt_pk_bf16_f32 v49, v162, v163
  v_cvt_pk_bf16_f32 v50, v164, v165
  v_cvt_pk_bf16_f32 v51, v166, v167
  v_mul_f32 v168, v168, v21
  v_mul_f32 v169, v169, v21
  v_mul_f32 v170, v170, v21
  v_mul_f32 v171, v171, v21
  v_mul_f32 v172, v172, v21
  v_mul_f32 v173, v173, v21
  v_mul_f32 v174, v174, v21
  v_mul_f32 v175, v175, v21
  v_cvt_pk_bf16_f32 v52, v168, v169
  v_cvt_pk_bf16_f32 v53, v170, v171
  v_cvt_pk_bf16_f32 v54, v172, v173
  v_cvt_pk_bf16_f32 v55, v174, v175
  v_mul_f32 v176, v176, v21
  v_mul_f32 v177, v177, v21
  v_mul_f32 v178, v178, v21
  v_mul_f32 v179, v179, v21
  v_mul_f32 v180, v180, v21
  v_mul_f32 v181, v181, v21
  v_mul_f32 v182, v182, v21
  v_mul_f32 v183, v183, v21
  v_cvt_pk_bf16_f32 v56, v176, v177
  v_cvt_pk_bf16_f32 v57, v178, v179
  v_cvt_pk_bf16_f32 v58, v180, v181
  v_cvt_pk_bf16_f32 v59, v182, v183
  v_mul_f32 v184, v184, v21
  v_mul_f32 v185, v185, v21
  v_mul_f32 v186, v186, v21
  v_mul_f32 v187, v187, v21
  v_mul_f32 v188, v188, v21
  v_mul_f32 v189, v189, v21
  v_mul_f32 v190, v190, v21
  v_mul_f32 v191, v191, v21
  v_cvt_pk_bf16_f32 v60, v184, v185
  v_cvt_pk_bf16_f32 v61, v186, v187
  v_cvt_pk_bf16_f32 v62, v188, v189
  v_cvt_pk_bf16_f32 v63, v190, v191
  v_mul_f32 v192, v192, v22
  v_mul_f32 v193, v193, v22
  v_mul_f32 v194, v194, v22
  v_mul_f32 v195, v195, v22
  v_mul_f32 v196, v196, v22
  v_mul_f32 v197, v197, v22
  v_mul_f32 v198, v198, v22
  v_mul_f32 v199, v199, v22
  v_cvt_pk_bf16_f32 v64, v192, v193
  v_cvt_pk_bf16_f32 v65, v194, v195
  v_cvt_pk_bf16_f32 v66, v196, v197
  v_cvt_pk_bf16_f32 v67, v198, v199
  v_mul_f32 v200, v200, v22
  v_mul_f32 v201, v201, v22
  v_mul_f32 v202, v202, v22
  v_mul_f32 v203, v203, v22
  v_mul_f32 v204, v204, v22
  v_mul_f32 v205, v205, v22
  v_mul_f32 v206, v206, v22
  v_mul_f32 v207, v207, v22
  v_cvt_pk_bf16_f32 v68, v200, v201
  v_cvt_pk_bf16_f32 v69, v202, v203
  v_cvt_pk_bf16_f32 v70, v204, v205
  v_cvt_pk_bf16_f32 v71, v206, v207
  v_mul_f32 v208, v208, v22
  v_mul_f32 v209, v209, v22
  v_mul_f32 v210, v210, v22
  v_mul_f32 v211, v211, v22
  v_mul_f32 v212, v212, v22
  v_mul_f32 v213, v213, v22
  v_mul_f32 v214, v214, v22
  v_mul_f32 v215, v215, v22
  v_cvt_pk_bf16_f32 v72, v208, v209
  v_cvt_pk_bf16_f32 v73, v210, v211
  v_cvt_pk_bf16_f32 v74, v212, v213
  v_cvt_pk_bf16_f32 v75, v214, v215
  v_mul_f32 v216, v216, v22
  v_mul_f32 v217, v217, v22
  v_mul_f32 v218, v218, v22
  v_mul_f32 v219, v219, v22
  v_mul_f32 v220, v220, v22
  v_mul_f32 v221, v221, v22
  v_mul_f32 v222, v222, v22
  v_mul_f32 v223, v223, v22
  v_cvt_pk_bf16_f32 v76, v216, v217
  v_cvt_pk_bf16_f32 v77, v218, v219
  v_cvt_pk_bf16_f32 v78, v220, v221
  v_cvt_pk_bf16_f32 v79, v222, v223
  v_mul_f32 v224, v224, v23
  v_mul_f32 v225, v225, v23
  v_mul_f32 v226, v226, v23
  v_mul_f32 v227, v227, v23
  v_mul_f32 v228, v228, v23
  v_mul_f32 v229, v229, v23
  v_mul_f32 v230, v230, v23
  v_mul_f32 v231, v231, v23
  v_cvt_pk_bf16_f32 v80, v224, v225
  v_cvt_pk_bf16_f32 v81, v226, v227
  v_cvt_pk_bf16_f32 v82, v228, v229
  v_cvt_pk_bf16_f32 v83, v230, v231
  v_mul_f32 v232, v232, v23
  v_mul_f32 v233, v233, v23
  v_mul_f32 v234, v234, v23
  v_mul_f32 v235, v235, v23
  v_mul_f32 v236, v236, v23
  v_mul_f32 v237, v237, v23
  v_mul_f32 v238, v238, v23
  v_mul_f32 v239, v239, v23
  v_cvt_pk_bf16_f32 v84, v232, v233
  v_cvt_pk_bf16_f32 v85, v234, v235
  v_cvt_pk_bf16_f32 v86, v236, v237
  v_cvt_pk_bf16_f32 v87, v238, v239
  v_mul_f32 v240, v240, v23
  v_mul_f32 v241, v241, v23
  v_mul_f32 v242, v242, v23
  v_mul_f32 v243, v243, v23
  v_mul_f32 v244, v244, v23
  v_mul_f32 v245, v245, v23
  v_mul_f32 v246, v246, v23
  v_mul_f32 v247, v247, v23
  v_cvt_pk_bf16_f32 v88, v240, v241
  v_cvt_pk_bf16_f32 v89, v242, v243
  v_cvt_pk_bf16_f32 v90, v244, v245
  v_cvt_pk_bf16_f32 v91, v246, v247
  v_mul_f32 v248, v248, v23
  v_mul_f32 v249, v249, v23
  v_mul_f32 v250, v250, v23
  v_mul_f32 v251, v251, v23
  v_mul_f32 v252, v252, v23
  v_mul_f32 v253, v253, v23
  v_mul_f32 v254, v254, v23
  v_mul_f32 v255, v255, v23
  v_cvt_pk_bf16_f32 v92, v248, v249
  v_cvt_pk_bf16_f32 v93, v250, v251
  v_cvt_pk_bf16_f32 v94, v252, v253
  v_cvt_pk_bf16_f32 v95, v254, v255
  v_lshrrev_b32 v6, 2, v0
  v_lshlrev_b32 v8, 7, v6
  v_bfe_u32 v6, v0, 3, 2
  v_lshl_add_u32 v8, v6, 5, v8
  v_and_b32 v6, 3, v0
  v_lshl_add_u32 v8, v6, 3, v8
  v_xor_b32 v9, 32, v8
  v_xor_b32 v10, 64, v8
  v_xor_b32 v11, 96, v8
  v_add_u32 v12, 0x10000, v8
  v_add_u32 v13, 0x10000, v9
  v_add_u32 v14, 0x10000, v10
  v_add_u32 v15, 0x10000, v11
  s_waitcnt vmcnt(4)
  s_barrier
  ds_read_b64_tr_b16 a[64:65], v8 offset:0
  ds_read_b64_tr_b16 a[66:67], v8 offset:2048
  ds_read_b64_tr_b16 a[68:69], v8 offset:4096
  ds_read_b64_tr_b16 a[70:71], v8 offset:6144
  ds_read_b64_tr_b16 a[72:73], v8 offset:8192
  ds_read_b64_tr_b16 a[74:75], v8 offset:10240
  ds_read_b64_tr_b16 a[76:77], v8 offset:12288
  ds_read_b64_tr_b16 a[78:79], v8 offset:14336
  ds_read_b64_tr_b16 a[80:81], v9 offset:0
  ds_read_b64_tr_b16 a[82:83], v9 offset:2048
  ds_read_b64_tr_b16 a[84:85], v9 offset:4096
  ds_read_b64_tr_b16 a[86:87], v9 offset:6144
  ds_read_b64_tr_b16 a[88:89], v9 offset:8192
  ds_read_b64_tr_b16 a[90:91], v9 offset:10240
  ds_read_b64_tr_b16 a[92:93], v9 offset:12288
  ds_read_b64_tr_b16 a[94:95], v9 offset:14336
  s_waitcnt lgkmcnt(8)
  v_mfma_f32_16x16x32_bf16 v[128:131], a[64:67], v[32:35], 0
  ds_read_b64_tr_b16 a[96:97], v10 offset:0
  v_mfma_f32_16x16x32_bf16 v[128:131], a[68:71], v[36:39], v[128:131]
  v_mfma_f32_16x16x32_bf16 v[128:131], a[72:75], v[40:43], v[128:131]
  ds_read_b64_tr_b16 a[98:99], v10 offset:2048
  v_mfma_f32_16x16x32_bf16 v[128:131], a[76:79], v[44:47], v[128:131]
  v_mfma_f32_16x16x32_bf16 v[136:139], a[64:67], v[48:51], 0
  ds_read_b64_tr_b16 a[100:101], v10 offset:4096
  v_mfma_f32_16x16x32_bf16 v[136:139], a[68:71], v[52:55], v[136:139]
  v_mfma_f32_16x16x32_bf16 v[136:139], a[72:75], v[56:59], v[136:139]
  ds_read_b64_tr_b16 a[102:103], v10 offset:6144
  v_mfma_f32_16x16x32_bf16 v[136:139], a[76:79], v[60:63], v[136:139]
  v_mfma_f32_16x16x32_bf16 v[144:147], a[64:67], v[64:67], 0
  ds_read_b64_tr_b16 a[104:105], v10 offset:8192
  v_mfma_f32_16x16x32_bf16 v[144:147], a[68:71], v[68:71], v[144:147]
  v_mfma_f32_16x16x32_bf16 v[144:147], a[72:75], v[72:75], v[144:147]
  ds_read_b64_tr_b16 a[106:107], v10 offset:10240
  v_mfma_f32_16x16x32_bf16 v[144:147], a[76:79], v[76:79], v[144:147]
  v_mfma_f32_16x16x32_bf16 v[152:155], a[64:67], v[80:83], 0
  ds_read_b64_tr_b16 a[108:109], v10 offset:12288
  v_mfma_f32_16x16x32_bf16 v[152:155], a[68:71], v[84:87], v[152:155]
  v_mfma_f32_16x16x32_bf16 v[152:155], a[72:75], v[88:91], v[152:155]
  ds_read_b64_tr_b16 a[110:111], v10 offset:14336
  v_mfma_f32_16x16x32_bf16 v[152:155], a[76:79], v[92:95], v[152:155]
  s_waitcnt lgkmcnt(8)
  v_mfma_f32_16x16x32_bf16 v[132:135], a[80:83], v[32:35], 0
  ds_read_b64_tr_b16 a[112:113], v11 offset:0
  v_mfma_f32_16x16x32_bf16 v[132:135], a[84:87], v[36:39], v[132:135]
  v_mfma_f32_16x16x32_bf16 v[132:135], a[88:91], v[40:43], v[132:135]
  ds_read_b64_tr_b16 a[114:115], v11 offset:2048
  v_mfma_f32_16x16x32_bf16 v[132:135], a[92:95], v[44:47], v[132:135]
  v_mfma_f32_16x16x32_bf16 v[140:143], a[80:83], v[48:51], 0
  ds_read_b64_tr_b16 a[116:117], v11 offset:4096
  v_mfma_f32_16x16x32_bf16 v[140:143], a[84:87], v[52:55], v[140:143]
  v_mfma_f32_16x16x32_bf16 v[140:143], a[88:91], v[56:59], v[140:143]
  ds_read_b64_tr_b16 a[118:119], v11 offset:6144
  v_mfma_f32_16x16x32_bf16 v[140:143], a[92:95], v[60:63], v[140:143]
  v_mfma_f32_16x16x32_bf16 v[148:151], a[80:83], v[64:67], 0
  ds_read_b64_tr_b16 a[120:121], v11 offset:8192
  v_mfma_f32_16x16x32_bf16 v[148:151], a[84:87], v[68:71], v[148:151]
  v_mfma_f32_16x16x32_bf16 v[148:151], a[88:91], v[72:75], v[148:151]
  ds_read_b64_tr_b16 a[122:123], v11 offset:10240
  v_mfma_f32_16x16x32_bf16 v[148:151], a[92:95], v[76:79], v[148:151]
  v_mfma_f32_16x16x32_bf16 v[156:159], a[80:83], v[80:83], 0
  ds_read_b64_tr_b16 a[124:125], v11 offset:12288
  v_mfma_f32_16x16x32_bf16 v[156:159], a[84:87], v[84:87], v[156:159]
  v_mfma_f32_16x16x32_bf16 v[156:159], a[88:91], v[88:91], v[156:159]
  ds_read_b64_tr_b16 a[126:127], v11 offset:14336
  v_mfma_f32_16x16x32_bf16 v[156:159], a[92:95], v[92:95], v[156:159]
  s_waitcnt lgkmcnt(8)
  v_mfma_f32_16x16x32_bf16 v[160:163], a[96:99], v[32:35], 0
  ds_read_b64_tr_b16 a[64:65], v8 offset:16384
  v_mfma_f32_16x16x32_bf16 v[160:163], a[100:103], v[36:39], v[160:163]
  s_nop 1
  v_mfma_f32_16x16x32_bf16 v[160:163], a[104:107], v[40:43], v[160:163]
  ds_read_b64_tr_b16 a[66:67], v8 offset:18432
  v_mfma_f32_16x16x32_bf16 v[160:163], a[108:111], v[44:47], v[160:163]
  v_cvt_pk_bf16_f32 v96, v128, v129
  v_cvt_pk_bf16_f32 v97, v130, v131
  v_mfma_f32_16x16x32_bf16 v[168:171], a[96:99], v[48:51], 0
  ds_read_b64_tr_b16 a[68:69], v8 offset:20480
  v_mfma_f32_16x16x32_bf16 v[168:171], a[100:103], v[52:55], v[168:171]
  v_cvt_pk_bf16_f32 v98, v132, v133
  v_cvt_pk_bf16_f32 v99, v134, v135
  v_mfma_f32_16x16x32_bf16 v[168:171], a[104:107], v[56:59], v[168:171]
  ds_read_b64_tr_b16 a[70:71], v8 offset:22528
  v_mfma_f32_16x16x32_bf16 v[168:171], a[108:111], v[60:63], v[168:171]
  buffer_store_dwordx4 v[96:99], v2, s[40:43], s76 offen offset:0 sc1
  v_mfma_f32_16x16x32_bf16 v[176:179], a[96:99], v[64:67], 0
  ds_read_b64_tr_b16 a[72:73], v8 offset:24576
  v_mfma_f32_16x16x32_bf16 v[176:179], a[100:103], v[68:71], v[176:179]
  v_cvt_pk_bf16_f32 v100, v136, v137
  v_cvt_pk_bf16_f32 v101, v138, v139
  v_mfma_f32_16x16x32_bf16 v[176:179], a[104:107], v[72:75], v[176:179]
  ds_read_b64_tr_b16 a[74:75], v8 offset:26624
  v_mfma_f32_16x16x32_bf16 v[176:179], a[108:111], v[76:79], v[176:179]
  v_cvt_pk_bf16_f32 v102, v140, v141
  v_cvt_pk_bf16_f32 v103, v142, v143
  v_mfma_f32_16x16x32_bf16 v[184:187], a[96:99], v[80:83], 0
  ds_read_b64_tr_b16 a[76:77], v8 offset:28672
  v_mfma_f32_16x16x32_bf16 v[184:187], a[100:103], v[84:87], v[184:187]
  buffer_store_dwordx4 v[100:103], v2, s[40:43], s77 offen offset:0 sc1
  v_mfma_f32_16x16x32_bf16 v[184:187], a[104:107], v[88:91], v[184:187]
  ds_read_b64_tr_b16 a[78:79], v8 offset:30720
  v_mfma_f32_16x16x32_bf16 v[184:187], a[108:111], v[92:95], v[184:187]
  s_waitcnt lgkmcnt(8)
  v_cvt_pk_bf16_f32 v104, v144, v145
  v_cvt_pk_bf16_f32 v105, v146, v147
  v_mfma_f32_16x16x32_bf16 v[164:167], a[112:115], v[32:35], 0
  ds_read_b64_tr_b16 a[80:81], v9 offset:16384
  v_mfma_f32_16x16x32_bf16 v[164:167], a[116:119], v[36:39], v[164:167]
  v_cvt_pk_bf16_f32 v106, v148, v149
  v_cvt_pk_bf16_f32 v107, v150, v151
  v_mfma_f32_16x16x32_bf16 v[164:167], a[120:123], v[40:43], v[164:167]
  ds_read_b64_tr_b16 a[82:83], v9 offset:18432
  v_mfma_f32_16x16x32_bf16 v[164:167], a[124:127], v[44:47], v[164:167]
  buffer_store_dwordx4 v[104:107], v2, s[40:43], s78 offen offset:0 sc1
  v_mfma_f32_16x16x32_bf16 v[172:175], a[112:115], v[48:51], 0
  ds_read_b64_tr_b16 a[84:85], v9 offset:20480
  v_mfma_f32_16x16x32_bf16 v[172:175], a[116:119], v[52:55], v[172:175]
  v_cvt_pk_bf16_f32 v108, v152, v153
  v_cvt_pk_bf16_f32 v109, v154, v155
  v_mfma_f32_16x16x32_bf16 v[172:175], a[120:123], v[56:59], v[172:175]
  ds_read_b64_tr_b16 a[86:87], v9 offset:22528
  v_mfma_f32_16x16x32_bf16 v[172:175], a[124:127], v[60:63], v[172:175]
  v_cvt_pk_bf16_f32 v110, v156, v157
  v_cvt_pk_bf16_f32 v111, v158, v159
  v_mfma_f32_16x16x32_bf16 v[180:183], a[112:115], v[64:67], 0
  ds_read_b64_tr_b16 a[88:89], v9 offset:24576
  v_mfma_f32_16x16x32_bf16 v[180:183], a[116:119], v[68:71], v[180:183]
  buffer_store_dwordx4 v[108:111], v2, s[40:43], s79 offen offset:0 sc1
  v_mfma_f32_16x16x32_bf16 v[180:183], a[120:123], v[72:75], v[180:183]
  ds_read_b64_tr_b16 a[90:91], v9 offset:26624
  v_mfma_f32_16x16x32_bf16 v[180:183], a[124:127], v[76:79], v[180:183]
  v_mfma_f32_16x16x32_bf16 v[188:191], a[112:115], v[80:83], 0
  ds_read_b64_tr_b16 a[92:93], v9 offset:28672
  v_mfma_f32_16x16x32_bf16 v[188:191], a[116:119], v[84:87], v[188:191]
  v_mfma_f32_16x16x32_bf16 v[188:191], a[120:123], v[88:91], v[188:191]
  ds_read_b64_tr_b16 a[94:95], v9 offset:30720
  v_mfma_f32_16x16x32_bf16 v[188:191], a[124:127], v[92:95], v[188:191]
  s_waitcnt lgkmcnt(8)
  v_mfma_f32_16x16x32_bf16 v[128:131], a[64:67], v[32:35], 0
  ds_read_b64_tr_b16 a[96:97], v10 offset:16384
  v_mfma_f32_16x16x32_bf16 v[128:131], a[68:71], v[36:39], v[128:131]
  s_nop 1
  v_mfma_f32_16x16x32_bf16 v[128:131], a[72:75], v[40:43], v[128:131]
  ds_read_b64_tr_b16 a[98:99], v10 offset:18432
  v_mfma_f32_16x16x32_bf16 v[128:131], a[76:79], v[44:47], v[128:131]
  v_cvt_pk_bf16_f32 v112, v160, v161
  v_cvt_pk_bf16_f32 v113, v162, v163
  v_mfma_f32_16x16x32_bf16 v[136:139], a[64:67], v[48:51], 0
  ds_read_b64_tr_b16 a[100:101], v10 offset:20480
  v_mfma_f32_16x16x32_bf16 v[136:139], a[68:71], v[52:55], v[136:139]
  v_cvt_pk_bf16_f32 v114, v164, v165
  v_cvt_pk_bf16_f32 v115, v166, v167
  v_mfma_f32_16x16x32_bf16 v[136:139], a[72:75], v[56:59], v[136:139]
  ds_read_b64_tr_b16 a[102:103], v10 offset:22528
  v_mfma_f32_16x16x32_bf16 v[136:139], a[76:79], v[60:63], v[136:139]
  buffer_store_dwordx4 v[112:115], v2, s[40:43], s76 offen offset:1024 sc1
  v_mfma_f32_16x16x32_bf16 v[144:147], a[64:67], v[64:67], 0
  ds_read_b64_tr_b16 a[104:105], v10 offset:24576
  v_mfma_f32_16x16x32_bf16 v[144:147], a[68:71], v[68:71], v[144:147]
  v_cvt_pk_bf16_f32 v116, v168, v169
  v_cvt_pk_bf16_f32 v117, v170, v171
  v_mfma_f32_16x16x32_bf16 v[144:147], a[72:75], v[72:75], v[144:147]
  ds_read_b64_tr_b16 a[106:107], v10 offset:26624
  v_mfma_f32_16x16x32_bf16 v[144:147], a[76:79], v[76:79], v[144:147]
  v_cvt_pk_bf16_f32 v118, v172, v173
  v_cvt_pk_bf16_f32 v119, v174, v175
  v_mfma_f32_16x16x32_bf16 v[152:155], a[64:67], v[80:83], 0
  ds_read_b64_tr_b16 a[108:109], v10 offset:28672
  v_mfma_f32_16x16x32_bf16 v[152:155], a[68:71], v[84:87], v[152:155]
  buffer_store_dwordx4 v[116:119], v2, s[40:43], s77 offen offset:1024 sc1
  v_mfma_f32_16x16x32_bf16 v[152:155], a[72:75], v[88:91], v[152:155]
  ds_read_b64_tr_b16 a[110:111], v10 offset:30720
  v_mfma_f32_16x16x32_bf16 v[152:155], a[76:79], v[92:95], v[152:155]
  s_waitcnt lgkmcnt(8)
  v_cvt_pk_bf16_f32 v120, v176, v177
  v_cvt_pk_bf16_f32 v121, v178, v179
  v_mfma_f32_16x16x32_bf16 v[132:135], a[80:83], v[32:35], 0
  ds_read_b64_tr_b16 a[112:113], v11 offset:16384
  v_mfma_f32_16x16x32_bf16 v[132:135], a[84:87], v[36:39], v[132:135]
  v_cvt_pk_bf16_f32 v122, v180, v181
  v_cvt_pk_bf16_f32 v123, v182, v183
  v_mfma_f32_16x16x32_bf16 v[132:135], a[88:91], v[40:43], v[132:135]
  ds_read_b64_tr_b16 a[114:115], v11 offset:18432
  v_mfma_f32_16x16x32_bf16 v[132:135], a[92:95], v[44:47], v[132:135]
  buffer_store_dwordx4 v[120:123], v2, s[40:43], s78 offen offset:1024 sc1
  v_mfma_f32_16x16x32_bf16 v[140:143], a[80:83], v[48:51], 0
  ds_read_b64_tr_b16 a[116:117], v11 offset:20480
  v_mfma_f32_16x16x32_bf16 v[140:143], a[84:87], v[52:55], v[140:143]
  v_cvt_pk_bf16_f32 v124, v184, v185
  v_cvt_pk_bf16_f32 v125, v186, v187
  v_mfma_f32_16x16x32_bf16 v[140:143], a[88:91], v[56:59], v[140:143]
  ds_read_b64_tr_b16 a[118:119], v11 offset:22528
  v_mfma_f32_16x16x32_bf16 v[140:143], a[92:95], v[60:63], v[140:143]
  v_cvt_pk_bf16_f32 v126, v188, v189
  v_cvt_pk_bf16_f32 v127, v190, v191
  v_mfma_f32_16x16x32_bf16 v[148:151], a[80:83], v[64:67], 0
  ds_read_b64_tr_b16 a[120:121], v11 offset:24576
  v_mfma_f32_16x16x32_bf16 v[148:151], a[84:87], v[68:71], v[148:151]
  buffer_store_dwordx4 v[124:127], v2, s[40:43], s79 offen offset:1024 sc1
  v_mfma_f32_16x16x32_bf16 v[148:151], a[88:91], v[72:75], v[148:151]
  ds_read_b64_tr_b16 a[122:123], v11 offset:26624
  v_mfma_f32_16x16x32_bf16 v[148:151], a[92:95], v[76:79], v[148:151]
  v_mfma_f32_16x16x32_bf16 v[156:159], a[80:83], v[80:83], 0
  ds_read_b64_tr_b16 a[124:125], v11 offset:28672
  v_mfma_f32_16x16x32_bf16 v[156:159], a[84:87], v[84:87], v[156:159]
  v_mfma_f32_16x16x32_bf16 v[156:159], a[88:91], v[88:91], v[156:159]
  ds_read_b64_tr_b16 a[126:127], v11 offset:30720
  v_mfma_f32_16x16x32_bf16 v[156:159], a[92:95], v[92:95], v[156:159]
  s_waitcnt lgkmcnt(8)
  v_mfma_f32_16x16x32_bf16 v[160:163], a[96:99], v[32:35], 0
  ds_read_b64_tr_b16 a[64:65], v8 offset:32768
  v_mfma_f32_16x16x32_bf16 v[160:163], a[100:103], v[36:39], v[160:163]
  s_nop 1
  v_mfma_f32_16x16x32_bf16 v[160:163], a[104:107], v[40:43], v[160:163]
  ds_read_b64_tr_b16 a[66:67], v8 offset:34816
  v_mfma_f32_16x16x32_bf16 v[160:163], a[108:111], v[44:47], v[160:163]
  v_cvt_pk_bf16_f32 v96, v128, v129
  v_cvt_pk_bf16_f32 v97, v130, v131
  v_mfma_f32_16x16x32_bf16 v[168:171], a[96:99], v[48:51], 0
  ds_read_b64_tr_b16 a[68:69], v8 offset:36864
  v_mfma_f32_16x16x32_bf16 v[168:171], a[100:103], v[52:55], v[168:171]
  v_cvt_pk_bf16_f32 v98, v132, v133
  v_cvt_pk_bf16_f32 v99, v134, v135
  v_mfma_f32_16x16x32_bf16 v[168:171], a[104:107], v[56:59], v[168:171]
  ds_read_b64_tr_b16 a[70:71], v8 offset:38912
  v_mfma_f32_16x16x32_bf16 v[168:171], a[108:111], v[60:63], v[168:171]
  buffer_store_dwordx4 v[96:99], v2, s[40:43], s76 offen offset:2048 sc1
  v_mfma_f32_16x16x32_bf16 v[176:179], a[96:99], v[64:67], 0
  ds_read_b64_tr_b16 a[72:73], v8 offset:40960
  v_mfma_f32_16x16x32_bf16 v[176:179], a[100:103], v[68:71], v[176:179]
  v_cvt_pk_bf16_f32 v100, v136, v137
  v_cvt_pk_bf16_f32 v101, v138, v139
  v_mfma_f32_16x16x32_bf16 v[176:179], a[104:107], v[72:75], v[176:179]
  ds_read_b64_tr_b16 a[74:75], v8 offset:43008
  v_mfma_f32_16x16x32_bf16 v[176:179], a[108:111], v[76:79], v[176:179]
  v_cvt_pk_bf16_f32 v102, v140, v141
  v_cvt_pk_bf16_f32 v103, v142, v143
  v_mfma_f32_16x16x32_bf16 v[184:187], a[96:99], v[80:83], 0
  ds_read_b64_tr_b16 a[76:77], v8 offset:45056
  v_mfma_f32_16x16x32_bf16 v[184:187], a[100:103], v[84:87], v[184:187]
  buffer_store_dwordx4 v[100:103], v2, s[40:43], s77 offen offset:2048 sc1
  v_mfma_f32_16x16x32_bf16 v[184:187], a[104:107], v[88:91], v[184:187]
  ds_read_b64_tr_b16 a[78:79], v8 offset:47104
  v_mfma_f32_16x16x32_bf16 v[184:187], a[108:111], v[92:95], v[184:187]
  s_waitcnt lgkmcnt(8)
  v_cvt_pk_bf16_f32 v104, v144, v145
  v_cvt_pk_bf16_f32 v105, v146, v147
  v_mfma_f32_16x16x32_bf16 v[164:167], a[112:115], v[32:35], 0
  ds_read_b64_tr_b16 a[80:81], v9 offset:32768
  v_mfma_f32_16x16x32_bf16 v[164:167], a[116:119], v[36:39], v[164:167]
  v_cvt_pk_bf16_f32 v106, v148, v149
  v_cvt_pk_bf16_f32 v107, v150, v151
  v_mfma_f32_16x16x32_bf16 v[164:167], a[120:123], v[40:43], v[164:167]
  ds_read_b64_tr_b16 a[82:83], v9 offset:34816
  v_mfma_f32_16x16x32_bf16 v[164:167], a[124:127], v[44:47], v[164:167]
  buffer_store_dwordx4 v[104:107], v2, s[40:43], s78 offen offset:2048 sc1
  v_mfma_f32_16x16x32_bf16 v[172:175], a[112:115], v[48:51], 0
  ds_read_b64_tr_b16 a[84:85], v9 offset:36864
  v_mfma_f32_16x16x32_bf16 v[172:175], a[116:119], v[52:55], v[172:175]
  v_cvt_pk_bf16_f32 v108, v152, v153
  v_cvt_pk_bf16_f32 v109, v154, v155
  v_mfma_f32_16x16x32_bf16 v[172:175], a[120:123], v[56:59], v[172:175]
  ds_read_b64_tr_b16 a[86:87], v9 offset:38912
  v_mfma_f32_16x16x32_bf16 v[172:175], a[124:127], v[60:63], v[172:175]
  v_cvt_pk_bf16_f32 v110, v156, v157
  v_cvt_pk_bf16_f32 v111, v158, v159
  v_mfma_f32_16x16x32_bf16 v[180:183], a[112:115], v[64:67], 0
  ds_read_b64_tr_b16 a[88:89], v9 offset:40960
  v_mfma_f32_16x16x32_bf16 v[180:183], a[116:119], v[68:71], v[180:183]
  buffer_store_dwordx4 v[108:111], v2, s[40:43], s79 offen offset:2048 sc1
  v_mfma_f32_16x16x32_bf16 v[180:183], a[120:123], v[72:75], v[180:183]
  ds_read_b64_tr_b16 a[90:91], v9 offset:43008
  v_mfma_f32_16x16x32_bf16 v[180:183], a[124:127], v[76:79], v[180:183]
  v_mfma_f32_16x16x32_bf16 v[188:191], a[112:115], v[80:83], 0
  ds_read_b64_tr_b16 a[92:93], v9 offset:45056
  v_mfma_f32_16x16x32_bf16 v[188:191], a[116:119], v[84:87], v[188:191]
  v_mfma_f32_16x16x32_bf16 v[188:191], a[120:123], v[88:91], v[188:191]
  ds_read_b64_tr_b16 a[94:95], v9 offset:47104
  v_mfma_f32_16x16x32_bf16 v[188:191], a[124:127], v[92:95], v[188:191]
  s_waitcnt lgkmcnt(8)
  v_mfma_f32_16x16x32_bf16 v[128:131], a[64:67], v[32:35], 0
  ds_read_b64_tr_b16 a[96:97], v10 offset:32768
  v_mfma_f32_16x16x32_bf16 v[128:131], a[68:71], v[36:39], v[128:131]
  s_nop 1
  v_mfma_f32_16x16x32_bf16 v[128:131], a[72:75], v[40:43], v[128:131]
  ds_read_b64_tr_b16 a[98:99], v10 offset:34816
  v_mfma_f32_16x16x32_bf16 v[128:131], a[76:79], v[44:47], v[128:131]
  v_cvt_pk_bf16_f32 v112, v160, v161
  v_cvt_pk_bf16_f32 v113, v162, v163
  v_mfma_f32_16x16x32_bf16 v[136:139], a[64:67], v[48:51], 0
  ds_read_b64_tr_b16 a[100:101], v10 offset:36864
  v_mfma_f32_16x16x32_bf16 v[136:139], a[68:71], v[52:55], v[136:139]
  v_cvt_pk_bf16_f32 v114, v164, v165
  v_cvt_pk_bf16_f32 v115, v166, v167
  v_mfma_f32_16x16x32_bf16 v[136:139], a[72:75], v[56:59], v[136:139]
  ds_read_b64_tr_b16 a[102:103], v10 offset:38912
  v_mfma_f32_16x16x32_bf16 v[136:139], a[76:79], v[60:63], v[136:139]
  buffer_store_dwordx4 v[112:115], v2, s[40:43], s76 offen offset:3072 sc1
  v_mfma_f32_16x16x32_bf16 v[144:147], a[64:67], v[64:67], 0
  ds_read_b64_tr_b16 a[104:105], v10 offset:40960
  v_mfma_f32_16x16x32_bf16 v[144:147], a[68:71], v[68:71], v[144:147]
  v_cvt_pk_bf16_f32 v116, v168, v169
  v_cvt_pk_bf16_f32 v117, v170, v171
  v_mfma_f32_16x16x32_bf16 v[144:147], a[72:75], v[72:75], v[144:147]
  ds_read_b64_tr_b16 a[106:107], v10 offset:43008
  v_mfma_f32_16x16x32_bf16 v[144:147], a[76:79], v[76:79], v[144:147]
  v_cvt_pk_bf16_f32 v118, v172, v173
  v_cvt_pk_bf16_f32 v119, v174, v175
  v_mfma_f32_16x16x32_bf16 v[152:155], a[64:67], v[80:83], 0
  ds_read_b64_tr_b16 a[108:109], v10 offset:45056
  v_mfma_f32_16x16x32_bf16 v[152:155], a[68:71], v[84:87], v[152:155]
  buffer_store_dwordx4 v[116:119], v2, s[40:43], s77 offen offset:3072 sc1
  v_mfma_f32_16x16x32_bf16 v[152:155], a[72:75], v[88:91], v[152:155]
  ds_read_b64_tr_b16 a[110:111], v10 offset:47104
  v_mfma_f32_16x16x32_bf16 v[152:155], a[76:79], v[92:95], v[152:155]
  s_waitcnt lgkmcnt(8)
  v_cvt_pk_bf16_f32 v120, v176, v177
  v_cvt_pk_bf16_f32 v121, v178, v179
  v_mfma_f32_16x16x32_bf16 v[132:135], a[80:83], v[32:35], 0
  ds_read_b64_tr_b16 a[112:113], v11 offset:32768
  v_mfma_f32_16x16x32_bf16 v[132:135], a[84:87], v[36:39], v[132:135]
  v_cvt_pk_bf16_f32 v122, v180, v181
  v_cvt_pk_bf16_f32 v123, v182, v183
  v_mfma_f32_16x16x32_bf16 v[132:135], a[88:91], v[40:43], v[132:135]
  ds_read_b64_tr_b16 a[114:115], v11 offset:34816
  v_mfma_f32_16x16x32_bf16 v[132:135], a[92:95], v[44:47], v[132:135]
  buffer_store_dwordx4 v[120:123], v2, s[40:43], s78 offen offset:3072 sc1
  v_mfma_f32_16x16x32_bf16 v[140:143], a[80:83], v[48:51], 0
  ds_read_b64_tr_b16 a[116:117], v11 offset:36864
  v_mfma_f32_16x16x32_bf16 v[140:143], a[84:87], v[52:55], v[140:143]
  v_cvt_pk_bf16_f32 v124, v184, v185
  v_cvt_pk_bf16_f32 v125, v186, v187
  v_mfma_f32_16x16x32_bf16 v[140:143], a[88:91], v[56:59], v[140:143]
  ds_read_b64_tr_b16 a[118:119], v11 offset:38912
  v_mfma_f32_16x16x32_bf16 v[140:143], a[92:95], v[60:63], v[140:143]
  v_cvt_pk_bf16_f32 v126, v188, v189
  v_cvt_pk_bf16_f32 v127, v190, v191
  v_mfma_f32_16x16x32_bf16 v[148:151], a[80:83], v[64:67], 0
  ds_read_b64_tr_b16 a[120:121], v11 offset:40960
  v_mfma_f32_16x16x32_bf16 v[148:151], a[84:87], v[68:71], v[148:151]
  buffer_store_dwordx4 v[124:127], v2, s[40:43], s79 offen offset:3072 sc1
  v_mfma_f32_16x16x32_bf16 v[148:151], a[88:91], v[72:75], v[148:151]
  ds_read_b64_tr_b16 a[122:123], v11 offset:43008
  v_mfma_f32_16x16x32_bf16 v[148:151], a[92:95], v[76:79], v[148:151]
  v_mfma_f32_16x16x32_bf16 v[156:159], a[80:83], v[80:83], 0
  ds_read_b64_tr_b16 a[124:125], v11 offset:45056
  v_mfma_f32_16x16x32_bf16 v[156:159], a[84:87], v[84:87], v[156:159]
  v_mfma_f32_16x16x32_bf16 v[156:159], a[88:91], v[88:91], v[156:159]
  ds_read_b64_tr_b16 a[126:127], v11 offset:47104
  v_mfma_f32_16x16x32_bf16 v[156:159], a[92:95], v[92:95], v[156:159]
  s_waitcnt lgkmcnt(8)
  v_mfma_f32_16x16x32_bf16 v[160:163], a[96:99], v[32:35], 0
  ds_read_b64_tr_b16 a[64:65], v8 offset:49152
  v_mfma_f32_16x16x32_bf16 v[160:163], a[100:103], v[36:39], v[160:163]
  s_add_u32 s76, s76, 0x1000
  s_add_u32 s77, s77, 0x1000
  s_add_u32 s78, s78, 0x1000
  s_add_u32 s79, s79, 0x1000
  v_mfma_f32_16x16x32_bf16 v[160:163], a[104:107], v[40:43], v[160:163]
  ds_read_b64_tr_b16 a[66:67], v8 offset:51200
  v_mfma_f32_16x16x32_bf16 v[160:163], a[108:111], v[44:47], v[160:163]
  v_cvt_pk_bf16_f32 v96, v128, v129
  v_cvt_pk_bf16_f32 v97, v130, v131
  v_mfma_f32_16x16x32_bf16 v[168:171], a[96:99], v[48:51], 0
  ds_read_b64_tr_b16 a[68:69], v8 offset:53248
  v_mfma_f32_16x16x32_bf16 v[168:171], a[100:103], v[52:55], v[168:171]
  v_cvt_pk_bf16_f32 v98, v132, v133
  v_cvt_pk_bf16_f32 v99, v134, v135
  v_mfma_f32_16x16x32_bf16 v[168:171], a[104:107], v[56:59], v[168:171]
  ds_read_b64_tr_b16 a[70:71], v8 offset:55296
  v_mfma_f32_16x16x32_bf16 v[168:171], a[108:111], v[60:63], v[168:171]
  buffer_store_dwordx4 v[96:99], v2, s[40:43], s76 offen offset:0 sc1
  v_mfma_f32_16x16x32_bf16 v[176:179], a[96:99], v[64:67], 0
  ds_read_b64_tr_b16 a[72:73], v8 offset:57344
  v_mfma_f32_16x16x32_bf16 v[176:179], a[100:103], v[68:71], v[176:179]
  v_cvt_pk_bf16_f32 v100, v136, v137
  v_cvt_pk_bf16_f32 v101, v138, v139
  v_mfma_f32_16x16x32_bf16 v[176:179], a[104:107], v[72:75], v[176:179]
  ds_read_b64_tr_b16 a[74:75], v8 offset:59392
  v_mfma_f32_16x16x32_bf16 v[176:179], a[108:111], v[76:79], v[176:179]
  v_cvt_pk_bf16_f32 v102, v140, v141
  v_cvt_pk_bf16_f32 v103, v142, v143
  v_mfma_f32_16x16x32_bf16 v[184:187], a[96:99], v[80:83], 0
  ds_read_b64_tr_b16 a[76:77], v8 offset:61440
  v_mfma_f32_16x16x32_bf16 v[184:187], a[100:103], v[84:87], v[184:187]
  buffer_store_dwordx4 v[100:103], v2, s[40:43], s77 offen offset:0 sc1
  v_mfma_f32_16x16x32_bf16 v[184:187], a[104:107], v[88:91], v[184:187]
  ds_read_b64_tr_b16 a[78:79], v8 offset:63488
  v_mfma_f32_16x16x32_bf16 v[184:187], a[108:111], v[92:95], v[184:187]
  s_waitcnt lgkmcnt(8)
  v_cvt_pk_bf16_f32 v104, v144, v145
  v_cvt_pk_bf16_f32 v105, v146, v147
  v_mfma_f32_16x16x32_bf16 v[164:167], a[112:115], v[32:35], 0
  ds_read_b64_tr_b16 a[80:81], v9 offset:49152
  v_mfma_f32_16x16x32_bf16 v[164:167], a[116:119], v[36:39], v[164:167]
  v_cvt_pk_bf16_f32 v106, v148, v149
  v_cvt_pk_bf16_f32 v107, v150, v151
  v_mfma_f32_16x16x32_bf16 v[164:167], a[120:123], v[40:43], v[164:167]
  ds_read_b64_tr_b16 a[82:83], v9 offset:51200
  v_mfma_f32_16x16x32_bf16 v[164:167], a[124:127], v[44:47], v[164:167]
  buffer_store_dwordx4 v[104:107], v2, s[40:43], s78 offen offset:0 sc1
  v_mfma_f32_16x16x32_bf16 v[172:175], a[112:115], v[48:51], 0
  ds_read_b64_tr_b16 a[84:85], v9 offset:53248
  v_mfma_f32_16x16x32_bf16 v[172:175], a[116:119], v[52:55], v[172:175]
  v_cvt_pk_bf16_f32 v108, v152, v153
  v_cvt_pk_bf16_f32 v109, v154, v155
  v_mfma_f32_16x16x32_bf16 v[172:175], a[120:123], v[56:59], v[172:175]
  ds_read_b64_tr_b16 a[86:87], v9 offset:55296
  v_mfma_f32_16x16x32_bf16 v[172:175], a[124:127], v[60:63], v[172:175]
  v_cvt_pk_bf16_f32 v110, v156, v157
  v_cvt_pk_bf16_f32 v111, v158, v159
  v_mfma_f32_16x16x32_bf16 v[180:183], a[112:115], v[64:67], 0
  ds_read_b64_tr_b16 a[88:89], v9 offset:57344
  v_mfma_f32_16x16x32_bf16 v[180:183], a[116:119], v[68:71], v[180:183]
  buffer_store_dwordx4 v[108:111], v2, s[40:43], s79 offen offset:0 sc1
  v_mfma_f32_16x16x32_bf16 v[180:183], a[120:123], v[72:75], v[180:183]
  ds_read_b64_tr_b16 a[90:91], v9 offset:59392
  v_mfma_f32_16x16x32_bf16 v[180:183], a[124:127], v[76:79], v[180:183]
  v_mfma_f32_16x16x32_bf16 v[188:191], a[112:115], v[80:83], 0
  ds_read_b64_tr_b16 a[92:93], v9 offset:61440
  v_mfma_f32_16x16x32_bf16 v[188:191], a[116:119], v[84:87], v[188:191]
  v_mfma_f32_16x16x32_bf16 v[188:191], a[120:123], v[88:91], v[188:191]
  ds_read_b64_tr_b16 a[94:95], v9 offset:63488
  v_mfma_f32_16x16x32_bf16 v[188:191], a[124:127], v[92:95], v[188:191]
  s_waitcnt lgkmcnt(8)
  v_mfma_f32_16x16x32_bf16 v[128:131], a[64:67], v[32:35], 0
  ds_read_b64_tr_b16 a[96:97], v10 offset:49152
  v_mfma_f32_16x16x32_bf16 v[128:131], a[68:71], v[36:39], v[128:131]
  s_nop 1
  v_mfma_f32_16x16x32_bf16 v[128:131], a[72:75], v[40:43], v[128:131]
  ds_read_b64_tr_b16 a[98:99], v10 offset:51200
  v_mfma_f32_16x16x32_bf16 v[128:131], a[76:79], v[44:47], v[128:131]
  v_cvt_pk_bf16_f32 v112, v160, v161
  v_cvt_pk_bf16_f32 v113, v162, v163
  v_mfma_f32_16x16x32_bf16 v[136:139], a[64:67], v[48:51], 0
  ds_read_b64_tr_b16 a[100:101], v10 offset:53248
  v_mfma_f32_16x16x32_bf16 v[136:139], a[68:71], v[52:55], v[136:139]
  v_cvt_pk_bf16_f32 v114, v164, v165
  v_cvt_pk_bf16_f32 v115, v166, v167
  v_mfma_f32_16x16x32_bf16 v[136:139], a[72:75], v[56:59], v[136:139]
  ds_read_b64_tr_b16 a[102:103], v10 offset:55296
  v_mfma_f32_16x16x32_bf16 v[136:139], a[76:79], v[60:63], v[136:139]
  buffer_store_dwordx4 v[112:115], v2, s[40:43], s76 offen offset:1024 sc1
  v_mfma_f32_16x16x32_bf16 v[144:147], a[64:67], v[64:67], 0
  ds_read_b64_tr_b16 a[104:105], v10 offset:57344
  v_mfma_f32_16x16x32_bf16 v[144:147], a[68:71], v[68:71], v[144:147]
  v_cvt_pk_bf16_f32 v116, v168, v169
  v_cvt_pk_bf16_f32 v117, v170, v171
  v_mfma_f32_16x16x32_bf16 v[144:147], a[72:75], v[72:75], v[144:147]
  ds_read_b64_tr_b16 a[106:107], v10 offset:59392
  v_mfma_f32_16x16x32_bf16 v[144:147], a[76:79], v[76:79], v[144:147]
  v_cvt_pk_bf16_f32 v118, v172, v173
  v_cvt_pk_bf16_f32 v119, v174, v175
  v_mfma_f32_16x16x32_bf16 v[152:155], a[64:67], v[80:83], 0
  ds_read_b64_tr_b16 a[108:109], v10 offset:61440
  v_mfma_f32_16x16x32_bf16 v[152:155], a[68:71], v[84:87], v[152:155]
  buffer_store_dwordx4 v[116:119], v2, s[40:43], s77 offen offset:1024 sc1
  v_mfma_f32_16x16x32_bf16 v[152:155], a[72:75], v[88:91], v[152:155]
  ds_read_b64_tr_b16 a[110:111], v10 offset:63488
  v_mfma_f32_16x16x32_bf16 v[152:155], a[76:79], v[92:95], v[152:155]
  s_waitcnt lgkmcnt(8)
  v_cvt_pk_bf16_f32 v120, v176, v177
  v_cvt_pk_bf16_f32 v121, v178, v179
  v_mfma_f32_16x16x32_bf16 v[132:135], a[80:83], v[32:35], 0
  ds_read_b64_tr_b16 a[112:113], v11 offset:49152
  v_mfma_f32_16x16x32_bf16 v[132:135], a[84:87], v[36:39], v[132:135]
  v_cvt_pk_bf16_f32 v122, v180, v181
  v_cvt_pk_bf16_f32 v123, v182, v183
  v_mfma_f32_16x16x32_bf16 v[132:135], a[88:91], v[40:43], v[132:135]
  ds_read_b64_tr_b16 a[114:115], v11 offset:51200
  v_mfma_f32_16x16x32_bf16 v[132:135], a[92:95], v[44:47], v[132:135]
  buffer_store_dwordx4 v[120:123], v2, s[40:43], s78 offen offset:1024 sc1
  v_mfma_f32_16x16x32_bf16 v[140:143], a[80:83], v[48:51], 0
  ds_read_b64_tr_b16 a[116:117], v11 offset:53248
  v_mfma_f32_16x16x32_bf16 v[140:143], a[84:87], v[52:55], v[140:143]
  v_cvt_pk_bf16_f32 v124, v184, v185
  v_cvt_pk_bf16_f32 v125, v186, v187
  v_mfma_f32_16x16x32_bf16 v[140:143], a[88:91], v[56:59], v[140:143]
  ds_read_b64_tr_b16 a[118:119], v11 offset:55296
  v_mfma_f32_16x16x32_bf16 v[140:143], a[92:95], v[60:63], v[140:143]
  v_cvt_pk_bf16_f32 v126, v188, v189
  v_cvt_pk_bf16_f32 v127, v190, v191
  v_mfma_f32_16x16x32_bf16 v[148:151], a[80:83], v[64:67], 0
  ds_read_b64_tr_b16 a[120:121], v11 offset:57344
  v_mfma_f32_16x16x32_bf16 v[148:151], a[84:87], v[68:71], v[148:151]
  buffer_store_dwordx4 v[124:127], v2, s[40:43], s79 offen offset:1024 sc1
  v_mfma_f32_16x16x32_bf16 v[148:151], a[88:91], v[72:75], v[148:151]
  ds_read_b64_tr_b16 a[122:123], v11 offset:59392
  v_mfma_f32_16x16x32_bf16 v[148:151], a[92:95], v[76:79], v[148:151]
  v_mfma_f32_16x16x32_bf16 v[156:159], a[80:83], v[80:83], 0
  ds_read_b64_tr_b16 a[124:125], v11 offset:61440
  v_mfma_f32_16x16x32_bf16 v[156:159], a[84:87], v[84:87], v[156:159]
  v_mfma_f32_16x16x32_bf16 v[156:159], a[88:91], v[88:91], v[156:159]
  ds_read_b64_tr_b16 a[126:127], v11 offset:63488
  v_mfma_f32_16x16x32_bf16 v[156:159], a[92:95], v[92:95], v[156:159]
  s_waitcnt lgkmcnt(8)
  v_mfma_f32_16x16x32_bf16 v[160:163], a[96:99], v[32:35], 0
  ds_read_b64_tr_b16 a[64:65], v12 offset:0
  v_mfma_f32_16x16x32_bf16 v[160:163], a[100:103], v[36:39], v[160:163]
  s_nop 1
  v_mfma_f32_16x16x32_bf16 v[160:163], a[104:107], v[40:43], v[160:163]
  ds_read_b64_tr_b16 a[66:67], v12 offset:2048
  v_mfma_f32_16x16x32_bf16 v[160:163], a[108:111], v[44:47], v[160:163]
  v_cvt_pk_bf16_f32 v96, v128, v129
  v_cvt_pk_bf16_f32 v97, v130, v131
  v_mfma_f32_16x16x32_bf16 v[168:171], a[96:99], v[48:51], 0
  ds_read_b64_tr_b16 a[68:69], v12 offset:4096
  v_mfma_f32_16x16x32_bf16 v[168:171], a[100:103], v[52:55], v[168:171]
  v_cvt_pk_bf16_f32 v98, v132, v133
  v_cvt_pk_bf16_f32 v99, v134, v135
  v_mfma_f32_16x16x32_bf16 v[168:171], a[104:107], v[56:59], v[168:171]
  ds_read_b64_tr_b16 a[70:71], v12 offset:6144
  v_mfma_f32_16x16x32_bf16 v[168:171], a[108:111], v[60:63], v[168:171]
  buffer_store_dwordx4 v[96:99], v2, s[40:43], s76 offen offset:2048 sc1
  v_mfma_f32_16x16x32_bf16 v[176:179], a[96:99], v[64:67], 0
  ds_read_b64_tr_b16 a[72:73], v12 offset:8192
  v_mfma_f32_16x16x32_bf16 v[176:179], a[100:103], v[68:71], v[176:179]
  v_cvt_pk_bf16_f32 v100, v136, v137
  v_cvt_pk_bf16_f32 v101, v138, v139
  v_mfma_f32_16x16x32_bf16 v[176:179], a[104:107], v[72:75], v[176:179]
  ds_read_b64_tr_b16 a[74:75], v12 offset:10240
  v_mfma_f32_16x16x32_bf16 v[176:179], a[108:111], v[76:79], v[176:179]
  v_cvt_pk_bf16_f32 v102, v140, v141
  v_cvt_pk_bf16_f32 v103, v142, v143
  v_mfma_f32_16x16x32_bf16 v[184:187], a[96:99], v[80:83], 0
  ds_read_b64_tr_b16 a[76:77], v12 offset:12288
  v_mfma_f32_16x16x32_bf16 v[184:187], a[100:103], v[84:87], v[184:187]
  buffer_store_dwordx4 v[100:103], v2, s[40:43], s77 offen offset:2048 sc1
  v_mfma_f32_16x16x32_bf16 v[184:187], a[104:107], v[88:91], v[184:187]
  ds_read_b64_tr_b16 a[78:79], v12 offset:14336
  v_mfma_f32_16x16x32_bf16 v[184:187], a[108:111], v[92:95], v[184:187]
  s_waitcnt lgkmcnt(8)
  v_cvt_pk_bf16_f32 v104, v144, v145
  v_cvt_pk_bf16_f32 v105, v146, v147
  v_mfma_f32_16x16x32_bf16 v[164:167], a[112:115], v[32:35], 0
  ds_read_b64_tr_b16 a[80:81], v13 offset:0
  v_mfma_f32_16x16x32_bf16 v[164:167], a[116:119], v[36:39], v[164:167]
  v_cvt_pk_bf16_f32 v106, v148, v149
  v_cvt_pk_bf16_f32 v107, v150, v151
  v_mfma_f32_16x16x32_bf16 v[164:167], a[120:123], v[40:43], v[164:167]
  ds_read_b64_tr_b16 a[82:83], v13 offset:2048
  v_mfma_f32_16x16x32_bf16 v[164:167], a[124:127], v[44:47], v[164:167]
  buffer_store_dwordx4 v[104:107], v2, s[40:43], s78 offen offset:2048 sc1
  v_mfma_f32_16x16x32_bf16 v[172:175], a[112:115], v[48:51], 0
  ds_read_b64_tr_b16 a[84:85], v13 offset:4096
  v_mfma_f32_16x16x32_bf16 v[172:175], a[116:119], v[52:55], v[172:175]
  v_cvt_pk_bf16_f32 v108, v152, v153
  v_cvt_pk_bf16_f32 v109, v154, v155
  v_mfma_f32_16x16x32_bf16 v[172:175], a[120:123], v[56:59], v[172:175]
  ds_read_b64_tr_b16 a[86:87], v13 offset:6144
  v_mfma_f32_16x16x32_bf16 v[172:175], a[124:127], v[60:63], v[172:175]
  v_cvt_pk_bf16_f32 v110, v156, v157
  v_cvt_pk_bf16_f32 v111, v158, v159
  v_mfma_f32_16x16x32_bf16 v[180:183], a[112:115], v[64:67], 0
  ds_read_b64_tr_b16 a[88:89], v13 offset:8192
  v_mfma_f32_16x16x32_bf16 v[180:183], a[116:119], v[68:71], v[180:183]
  buffer_store_dwordx4 v[108:111], v2, s[40:43], s79 offen offset:2048 sc1
  v_mfma_f32_16x16x32_bf16 v[180:183], a[120:123], v[72:75], v[180:183]
  ds_read_b64_tr_b16 a[90:91], v13 offset:10240
  v_mfma_f32_16x16x32_bf16 v[180:183], a[124:127], v[76:79], v[180:183]
  v_mfma_f32_16x16x32_bf16 v[188:191], a[112:115], v[80:83], 0
  ds_read_b64_tr_b16 a[92:93], v13 offset:12288
  v_mfma_f32_16x16x32_bf16 v[188:191], a[116:119], v[84:87], v[188:191]
  v_mfma_f32_16x16x32_bf16 v[188:191], a[120:123], v[88:91], v[188:191]
  ds_read_b64_tr_b16 a[94:95], v13 offset:14336
  v_mfma_f32_16x16x32_bf16 v[188:191], a[124:127], v[92:95], v[188:191]
  s_waitcnt lgkmcnt(8)
  v_mfma_f32_16x16x32_bf16 v[128:131], a[64:67], v[32:35], 0
  ds_read_b64_tr_b16 a[96:97], v14 offset:0
  v_mfma_f32_16x16x32_bf16 v[128:131], a[68:71], v[36:39], v[128:131]
  s_nop 1
  v_mfma_f32_16x16x32_bf16 v[128:131], a[72:75], v[40:43], v[128:131]
  ds_read_b64_tr_b16 a[98:99], v14 offset:2048
  v_mfma_f32_16x16x32_bf16 v[128:131], a[76:79], v[44:47], v[128:131]
  v_cvt_pk_bf16_f32 v112, v160, v161
  v_cvt_pk_bf16_f32 v113, v162, v163
  v_mfma_f32_16x16x32_bf16 v[136:139], a[64:67], v[48:51], 0
  ds_read_b64_tr_b16 a[100:101], v14 offset:4096
  v_mfma_f32_16x16x32_bf16 v[136:139], a[68:71], v[52:55], v[136:139]
  v_cvt_pk_bf16_f32 v114, v164, v165
  v_cvt_pk_bf16_f32 v115, v166, v167
  v_mfma_f32_16x16x32_bf16 v[136:139], a[72:75], v[56:59], v[136:139]
  ds_read_b64_tr_b16 a[102:103], v14 offset:6144
  v_mfma_f32_16x16x32_bf16 v[136:139], a[76:79], v[60:63], v[136:139]
  buffer_store_dwordx4 v[112:115], v2, s[40:43], s76 offen offset:3072 sc1
  v_mfma_f32_16x16x32_bf16 v[144:147], a[64:67], v[64:67], 0
  ds_read_b64_tr_b16 a[104:105], v14 offset:8192
  v_mfma_f32_16x16x32_bf16 v[144:147], a[68:71], v[68:71], v[144:147]
  v_cvt_pk_bf16_f32 v116, v168, v169
  v_cvt_pk_bf16_f32 v117, v170, v171
  v_mfma_f32_16x16x32_bf16 v[144:147], a[72:75], v[72:75], v[144:147]
  ds_read_b64_tr_b16 a[106:107], v14 offset:10240
  v_mfma_f32_16x16x32_bf16 v[144:147], a[76:79], v[76:79], v[144:147]
  v_cvt_pk_bf16_f32 v118, v172, v173
  v_cvt_pk_bf16_f32 v119, v174, v175
  v_mfma_f32_16x16x32_bf16 v[152:155], a[64:67], v[80:83], 0
  ds_read_b64_tr_b16 a[108:109], v14 offset:12288
  v_mfma_f32_16x16x32_bf16 v[152:155], a[68:71], v[84:87], v[152:155]
  buffer_store_dwordx4 v[116:119], v2, s[40:43], s77 offen offset:3072 sc1
  v_mfma_f32_16x16x32_bf16 v[152:155], a[72:75], v[88:91], v[152:155]
  ds_read_b64_tr_b16 a[110:111], v14 offset:14336
  v_mfma_f32_16x16x32_bf16 v[152:155], a[76:79], v[92:95], v[152:155]
  s_waitcnt lgkmcnt(8)
  v_cvt_pk_bf16_f32 v120, v176, v177
  v_cvt_pk_bf16_f32 v121, v178, v179
  v_mfma_f32_16x16x32_bf16 v[132:135], a[80:83], v[32:35], 0
  ds_read_b64_tr_b16 a[112:113], v15 offset:0
  v_mfma_f32_16x16x32_bf16 v[132:135], a[84:87], v[36:39], v[132:135]
  v_cvt_pk_bf16_f32 v122, v180, v181
  v_cvt_pk_bf16_f32 v123, v182, v183
  v_mfma_f32_16x16x32_bf16 v[132:135], a[88:91], v[40:43], v[132:135]
  ds_read_b64_tr_b16 a[114:115], v15 offset:2048
  v_mfma_f32_16x16x32_bf16 v[132:135], a[92:95], v[44:47], v[132:135]
  buffer_store_dwordx4 v[120:123], v2, s[40:43], s78 offen offset:3072 sc1
  v_mfma_f32_16x16x32_bf16 v[140:143], a[80:83], v[48:51], 0
  ds_read_b64_tr_b16 a[116:117], v15 offset:4096
  v_mfma_f32_16x16x32_bf16 v[140:143], a[84:87], v[52:55], v[140:143]
  v_cvt_pk_bf16_f32 v124, v184, v185
  v_cvt_pk_bf16_f32 v125, v186, v187
  v_mfma_f32_16x16x32_bf16 v[140:143], a[88:91], v[56:59], v[140:143]
  ds_read_b64_tr_b16 a[118:119], v15 offset:6144
  v_mfma_f32_16x16x32_bf16 v[140:143], a[92:95], v[60:63], v[140:143]
  v_cvt_pk_bf16_f32 v126, v188, v189
  v_cvt_pk_bf16_f32 v127, v190, v191
  v_mfma_f32_16x16x32_bf16 v[148:151], a[80:83], v[64:67], 0
  ds_read_b64_tr_b16 a[120:121], v15 offset:8192
  v_mfma_f32_16x16x32_bf16 v[148:151], a[84:87], v[68:71], v[148:151]
  buffer_store_dwordx4 v[124:127], v2, s[40:43], s79 offen offset:3072 sc1
  v_mfma_f32_16x16x32_bf16 v[148:151], a[88:91], v[72:75], v[148:151]
  ds_read_b64_tr_b16 a[122:123], v15 offset:10240
  v_mfma_f32_16x16x32_bf16 v[148:151], a[92:95], v[76:79], v[148:151]
  v_mfma_f32_16x16x32_bf16 v[156:159], a[80:83], v[80:83], 0
  ds_read_b64_tr_b16 a[124:125], v15 offset:12288
  v_mfma_f32_16x16x32_bf16 v[156:159], a[84:87], v[84:87], v[156:159]
  v_mfma_f32_16x16x32_bf16 v[156:159], a[88:91], v[88:91], v[156:159]
  ds_read_b64_tr_b16 a[126:127], v15 offset:14336
  v_mfma_f32_16x16x32_bf16 v[156:159], a[92:95], v[92:95], v[156:159]
  s_waitcnt lgkmcnt(8)
  v_mfma_f32_16x16x32_bf16 v[160:163], a[96:99], v[32:35], 0
  ds_read_b64_tr_b16 a[64:65], v12 offset:16384
  v_mfma_f32_16x16x32_bf16 v[160:163], a[100:103], v[36:39], v[160:163]
  s_add_u32 s76, s76, 0x1000
  s_add_u32 s77, s77, 0x1000
  s_add_u32 s78, s78, 0x1000
  s_add_u32 s79, s79, 0x1000
  v_mfma_f32_16x16x32_bf16 v[160:163], a[104:107], v[40:43], v[160:163]
  ds_read_b64_tr_b16 a[66:67], v12 offset:18432
  v_mfma_f32_16x16x32_bf16 v[160:163], a[108:111], v[44:47], v[160:163]
  v_cvt_pk_bf16_f32 v96, v128, v129
  v_cvt_pk_bf16_f32 v97, v130, v131
  v_mfma_f32_16x16x32_bf16 v[168:171], a[96:99], v[48:51], 0
  ds_read_b64_tr_b16 a[68:69], v12 offset:20480
  v_mfma_f32_16x16x32_bf16 v[168:171], a[100:103], v[52:55], v[168:171]
  v_cvt_pk_bf16_f32 v98, v132, v133
  v_cvt_pk_bf16_f32 v99, v134, v135
  v_mfma_f32_16x16x32_bf16 v[168:171], a[104:107], v[56:59], v[168:171]
  ds_read_b64_tr_b16 a[70:71], v12 offset:22528
  v_mfma_f32_16x16x32_bf16 v[168:171], a[108:111], v[60:63], v[168:171]
  buffer_store_dwordx4 v[96:99], v2, s[40:43], s76 offen offset:0 sc1
  v_mfma_f32_16x16x32_bf16 v[176:179], a[96:99], v[64:67], 0
  ds_read_b64_tr_b16 a[72:73], v12 offset:24576
  v_mfma_f32_16x16x32_bf16 v[176:179], a[100:103], v[68:71], v[176:179]
  v_cvt_pk_bf16_f32 v100, v136, v137
  v_cvt_pk_bf16_f32 v101, v138, v139
  v_mfma_f32_16x16x32_bf16 v[176:179], a[104:107], v[72:75], v[176:179]
  ds_read_b64_tr_b16 a[74:75], v12 offset:26624
  v_mfma_f32_16x16x32_bf16 v[176:179], a[108:111], v[76:79], v[176:179]
  v_cvt_pk_bf16_f32 v102, v140, v141
  v_cvt_pk_bf16_f32 v103, v142, v143
  v_mfma_f32_16x16x32_bf16 v[184:187], a[96:99], v[80:83], 0
  ds_read_b64_tr_b16 a[76:77], v12 offset:28672
  v_mfma_f32_16x16x32_bf16 v[184:187], a[100:103], v[84:87], v[184:187]
  buffer_store_dwordx4 v[100:103], v2, s[40:43], s77 offen offset:0 sc1
  v_mfma_f32_16x16x32_bf16 v[184:187], a[104:107], v[88:91], v[184:187]
  ds_read_b64_tr_b16 a[78:79], v12 offset:30720
  v_mfma_f32_16x16x32_bf16 v[184:187], a[108:111], v[92:95], v[184:187]
  s_waitcnt lgkmcnt(8)
  v_cvt_pk_bf16_f32 v104, v144, v145
  v_cvt_pk_bf16_f32 v105, v146, v147
  v_mfma_f32_16x16x32_bf16 v[164:167], a[112:115], v[32:35], 0
  ds_read_b64_tr_b16 a[80:81], v13 offset:16384
  v_mfma_f32_16x16x32_bf16 v[164:167], a[116:119], v[36:39], v[164:167]
  v_cvt_pk_bf16_f32 v106, v148, v149
  v_cvt_pk_bf16_f32 v107, v150, v151
  v_mfma_f32_16x16x32_bf16 v[164:167], a[120:123], v[40:43], v[164:167]
  ds_read_b64_tr_b16 a[82:83], v13 offset:18432
  v_mfma_f32_16x16x32_bf16 v[164:167], a[124:127], v[44:47], v[164:167]
  buffer_store_dwordx4 v[104:107], v2, s[40:43], s78 offen offset:0 sc1
  v_mfma_f32_16x16x32_bf16 v[172:175], a[112:115], v[48:51], 0
  ds_read_b64_tr_b16 a[84:85], v13 offset:20480
  v_mfma_f32_16x16x32_bf16 v[172:175], a[116:119], v[52:55], v[172:175]
  v_cvt_pk_bf16_f32 v108, v152, v153
  v_cvt_pk_bf16_f32 v109, v154, v155
  v_mfma_f32_16x16x32_bf16 v[172:175], a[120:123], v[56:59], v[172:175]
  ds_read_b64_tr_b16 a[86:87], v13 offset:22528
  v_mfma_f32_16x16x32_bf16 v[172:175], a[124:127], v[60:63], v[172:175]
  v_cvt_pk_bf16_f32 v110, v156, v157
  v_cvt_pk_bf16_f32 v111, v158, v159
  v_mfma_f32_16x16x32_bf16 v[180:183], a[112:115], v[64:67], 0
  ds_read_b64_tr_b16 a[88:89], v13 offset:24576
  v_mfma_f32_16x16x32_bf16 v[180:183], a[116:119], v[68:71], v[180:183]
  buffer_store_dwordx4 v[108:111], v2, s[40:43], s79 offen offset:0 sc1
  v_mfma_f32_16x16x32_bf16 v[180:183], a[120:123], v[72:75], v[180:183]
  ds_read_b64_tr_b16 a[90:91], v13 offset:26624
  v_mfma_f32_16x16x32_bf16 v[180:183], a[124:127], v[76:79], v[180:183]
  v_mfma_f32_16x16x32_bf16 v[188:191], a[112:115], v[80:83], 0
  ds_read_b64_tr_b16 a[92:93], v13 offset:28672
  v_mfma_f32_16x16x32_bf16 v[188:191], a[116:119], v[84:87], v[188:191]
  v_mfma_f32_16x16x32_bf16 v[188:191], a[120:123], v[88:91], v[188:191]
  ds_read_b64_tr_b16 a[94:95], v13 offset:30720
  v_mfma_f32_16x16x32_bf16 v[188:191], a[124:127], v[92:95], v[188:191]
  s_waitcnt lgkmcnt(8)
  v_mfma_f32_16x16x32_bf16 v[128:131], a[64:67], v[32:35], 0
  ds_read_b64_tr_b16 a[96:97], v14 offset:16384
  v_mfma_f32_16x16x32_bf16 v[128:131], a[68:71], v[36:39], v[128:131]
  s_nop 1
  v_mfma_f32_16x16x32_bf16 v[128:131], a[72:75], v[40:43], v[128:131]
  ds_read_b64_tr_b16 a[98:99], v14 offset:18432
  v_mfma_f32_16x16x32_bf16 v[128:131], a[76:79], v[44:47], v[128:131]
  v_cvt_pk_bf16_f32 v112, v160, v161
  v_cvt_pk_bf16_f32 v113, v162, v163
  v_mfma_f32_16x16x32_bf16 v[136:139], a[64:67], v[48:51], 0
  ds_read_b64_tr_b16 a[100:101], v14 offset:20480
  v_mfma_f32_16x16x32_bf16 v[136:139], a[68:71], v[52:55], v[136:139]
  v_cvt_pk_bf16_f32 v114, v164, v165
  v_cvt_pk_bf16_f32 v115, v166, v167
  v_mfma_f32_16x16x32_bf16 v[136:139], a[72:75], v[56:59], v[136:139]
  ds_read_b64_tr_b16 a[102:103], v14 offset:22528
  v_mfma_f32_16x16x32_bf16 v[136:139], a[76:79], v[60:63], v[136:139]
  buffer_store_dwordx4 v[112:115], v2, s[40:43], s76 offen offset:1024 sc1
  v_mfma_f32_16x16x32_bf16 v[144:147], a[64:67], v[64:67], 0
  ds_read_b64_tr_b16 a[104:105], v14 offset:24576
  v_mfma_f32_16x16x32_bf16 v[144:147], a[68:71], v[68:71], v[144:147]
  v_cvt_pk_bf16_f32 v116, v168, v169
  v_cvt_pk_bf16_f32 v117, v170, v171
  v_mfma_f32_16x16x32_bf16 v[144:147], a[72:75], v[72:75], v[144:147]
  ds_read_b64_tr_b16 a[106:107], v14 offset:26624
  v_mfma_f32_16x16x32_bf16 v[144:147], a[76:79], v[76:79], v[144:147]
  v_cvt_pk_bf16_f32 v118, v172, v173
  v_cvt_pk_bf16_f32 v119, v174, v175
  v_mfma_f32_16x16x32_bf16 v[152:155], a[64:67], v[80:83], 0
  ds_read_b64_tr_b16 a[108:109], v14 offset:28672
  v_mfma_f32_16x16x32_bf16 v[152:155], a[68:71], v[84:87], v[152:155]
  buffer_store_dwordx4 v[116:119], v2, s[40:43], s77 offen offset:1024 sc1
  v_mfma_f32_16x16x32_bf16 v[152:155], a[72:75], v[88:91], v[152:155]
  ds_read_b64_tr_b16 a[110:111], v14 offset:30720
  v_mfma_f32_16x16x32_bf16 v[152:155], a[76:79], v[92:95], v[152:155]
  s_waitcnt lgkmcnt(8)
  v_cvt_pk_bf16_f32 v120, v176, v177
  v_cvt_pk_bf16_f32 v121, v178, v179
  v_mfma_f32_16x16x32_bf16 v[132:135], a[80:83], v[32:35], 0
  ds_read_b64_tr_b16 a[112:113], v15 offset:16384
  v_mfma_f32_16x16x32_bf16 v[132:135], a[84:87], v[36:39], v[132:135]
  v_cvt_pk_bf16_f32 v122, v180, v181
  v_cvt_pk_bf16_f32 v123, v182, v183
  v_mfma_f32_16x16x32_bf16 v[132:135], a[88:91], v[40:43], v[132:135]
  ds_read_b64_tr_b16 a[114:115], v15 offset:18432
  v_mfma_f32_16x16x32_bf16 v[132:135], a[92:95], v[44:47], v[132:135]
  buffer_store_dwordx4 v[120:123], v2, s[40:43], s78 offen offset:1024 sc1
  v_mfma_f32_16x16x32_bf16 v[140:143], a[80:83], v[48:51], 0
  ds_read_b64_tr_b16 a[116:117], v15 offset:20480
  v_mfma_f32_16x16x32_bf16 v[140:143], a[84:87], v[52:55], v[140:143]
  v_cvt_pk_bf16_f32 v124, v184, v185
  v_cvt_pk_bf16_f32 v125, v186, v187
  v_mfma_f32_16x16x32_bf16 v[140:143], a[88:91], v[56:59], v[140:143]
  ds_read_b64_tr_b16 a[118:119], v15 offset:22528
  v_mfma_f32_16x16x32_bf16 v[140:143], a[92:95], v[60:63], v[140:143]
  v_cvt_pk_bf16_f32 v126, v188, v189
  v_cvt_pk_bf16_f32 v127, v190, v191
  v_mfma_f32_16x16x32_bf16 v[148:151], a[80:83], v[64:67], 0
  ds_read_b64_tr_b16 a[120:121], v15 offset:24576
  v_mfma_f32_16x16x32_bf16 v[148:151], a[84:87], v[68:71], v[148:151]
  buffer_store_dwordx4 v[124:127], v2, s[40:43], s79 offen offset:1024 sc1
  v_mfma_f32_16x16x32_bf16 v[148:151], a[88:91], v[72:75], v[148:151]
  ds_read_b64_tr_b16 a[122:123], v15 offset:26624
  v_mfma_f32_16x16x32_bf16 v[148:151], a[92:95], v[76:79], v[148:151]
  v_mfma_f32_16x16x32_bf16 v[156:159], a[80:83], v[80:83], 0
  ds_read_b64_tr_b16 a[124:125], v15 offset:28672
  v_mfma_f32_16x16x32_bf16 v[156:159], a[84:87], v[84:87], v[156:159]
  v_mfma_f32_16x16x32_bf16 v[156:159], a[88:91], v[88:91], v[156:159]
  ds_read_b64_tr_b16 a[126:127], v15 offset:30720
  v_mfma_f32_16x16x32_bf16 v[156:159], a[92:95], v[92:95], v[156:159]
  s_waitcnt lgkmcnt(8)
  v_mfma_f32_16x16x32_bf16 v[160:163], a[96:99], v[32:35], 0
  ds_read_b64_tr_b16 a[64:65], v12 offset:32768
  v_mfma_f32_16x16x32_bf16 v[160:163], a[100:103], v[36:39], v[160:163]
  s_nop 1
  v_mfma_f32_16x16x32_bf16 v[160:163], a[104:107], v[40:43], v[160:163]
  ds_read_b64_tr_b16 a[66:67], v12 offset:34816
  v_mfma_f32_16x16x32_bf16 v[160:163], a[108:111], v[44:47], v[160:163]
  v_cvt_pk_bf16_f32 v96, v128, v129
  v_cvt_pk_bf16_f32 v97, v130, v131
  v_mfma_f32_16x16x32_bf16 v[168:171], a[96:99], v[48:51], 0
  ds_read_b64_tr_b16 a[68:69], v12 offset:36864
  v_mfma_f32_16x16x32_bf16 v[168:171], a[100:103], v[52:55], v[168:171]
  v_cvt_pk_bf16_f32 v98, v132, v133
  v_cvt_pk_bf16_f32 v99, v134, v135
  v_mfma_f32_16x16x32_bf16 v[168:171], a[104:107], v[56:59], v[168:171]
  ds_read_b64_tr_b16 a[70:71], v12 offset:38912
  v_mfma_f32_16x16x32_bf16 v[168:171], a[108:111], v[60:63], v[168:171]
  buffer_store_dwordx4 v[96:99], v2, s[40:43], s76 offen offset:2048 sc1
  v_mfma_f32_16x16x32_bf16 v[176:179], a[96:99], v[64:67], 0
  ds_read_b64_tr_b16 a[72:73], v12 offset:40960
  v_mfma_f32_16x16x32_bf16 v[176:179], a[100:103], v[68:71], v[176:179]
  v_cvt_pk_bf16_f32 v100, v136, v137
  v_cvt_pk_bf16_f32 v101, v138, v139
  v_mfma_f32_16x16x32_bf16 v[176:179], a[104:107], v[72:75], v[176:179]
  ds_read_b64_tr_b16 a[74:75], v12 offset:43008
  v_mfma_f32_16x16x32_bf16 v[176:179], a[108:111], v[76:79], v[176:179]
  v_cvt_pk_bf16_f32 v102, v140, v141
  v_cvt_pk_bf16_f32 v103, v142, v143
  v_mfma_f32_16x16x32_bf16 v[184:187], a[96:99], v[80:83], 0
  ds_read_b64_tr_b16 a[76:77], v12 offset:45056
  v_mfma_f32_16x16x32_bf16 v[184:187], a[100:103], v[84:87], v[184:187]
  buffer_store_dwordx4 v[100:103], v2, s[40:43], s77 offen offset:2048 sc1
  v_mfma_f32_16x16x32_bf16 v[184:187], a[104:107], v[88:91], v[184:187]
  ds_read_b64_tr_b16 a[78:79], v12 offset:47104
  v_mfma_f32_16x16x32_bf16 v[184:187], a[108:111], v[92:95], v[184:187]
  s_waitcnt lgkmcnt(8)
  v_cvt_pk_bf16_f32 v104, v144, v145
  v_cvt_pk_bf16_f32 v105, v146, v147
  v_mfma_f32_16x16x32_bf16 v[164:167], a[112:115], v[32:35], 0
  ds_read_b64_tr_b16 a[80:81], v13 offset:32768
  v_mfma_f32_16x16x32_bf16 v[164:167], a[116:119], v[36:39], v[164:167]
  v_cvt_pk_bf16_f32 v106, v148, v149
  v_cvt_pk_bf16_f32 v107, v150, v151
  v_mfma_f32_16x16x32_bf16 v[164:167], a[120:123], v[40:43], v[164:167]
  ds_read_b64_tr_b16 a[82:83], v13 offset:34816
  v_mfma_f32_16x16x32_bf16 v[164:167], a[124:127], v[44:47], v[164:167]
  buffer_store_dwordx4 v[104:107], v2, s[40:43], s78 offen offset:2048 sc1
  v_mfma_f32_16x16x32_bf16 v[172:175], a[112:115], v[48:51], 0
  ds_read_b64_tr_b16 a[84:85], v13 offset:36864
  v_mfma_f32_16x16x32_bf16 v[172:175], a[116:119], v[52:55], v[172:175]
  v_cvt_pk_bf16_f32 v108, v152, v153
  v_cvt_pk_bf16_f32 v109, v154, v155
  v_mfma_f32_16x16x32_bf16 v[172:175], a[120:123], v[56:59], v[172:175]
  ds_read_b64_tr_b16 a[86:87], v13 offset:38912
  v_mfma_f32_16x16x32_bf16 v[172:175], a[124:127], v[60:63], v[172:175]
  v_cvt_pk_bf16_f32 v110, v156, v157
  v_cvt_pk_bf16_f32 v111, v158, v159
  v_mfma_f32_16x16x32_bf16 v[180:183], a[112:115], v[64:67], 0
  ds_read_b64_tr_b16 a[88:89], v13 offset:40960
  v_mfma_f32_16x16x32_bf16 v[180:183], a[116:119], v[68:71], v[180:183]
  buffer_store_dwordx4 v[108:111], v2, s[40:43], s79 offen offset:2048 sc1
  v_mfma_f32_16x16x32_bf16 v[180:183], a[120:123], v[72:75], v[180:183]
  ds_read_b64_tr_b16 a[90:91], v13 offset:43008
  v_mfma_f32_16x16x32_bf16 v[180:183], a[124:127], v[76:79], v[180:183]
  v_mfma_f32_16x16x32_bf16 v[188:191], a[112:115], v[80:83], 0
  ds_read_b64_tr_b16 a[92:93], v13 offset:45056
  v_mfma_f32_16x16x32_bf16 v[188:191], a[116:119], v[84:87], v[188:191]
  v_mfma_f32_16x16x32_bf16 v[188:191], a[120:123], v[88:91], v[188:191]
  ds_read_b64_tr_b16 a[94:95], v13 offset:47104
  v_mfma_f32_16x16x32_bf16 v[188:191], a[124:127], v[92:95], v[188:191]
  s_waitcnt lgkmcnt(8)
  v_mfma_f32_16x16x32_bf16 v[128:131], a[64:67], v[32:35], 0
  ds_read_b64_tr_b16 a[96:97], v14 offset:32768
  v_mfma_f32_16x16x32_bf16 v[128:131], a[68:71], v[36:39], v[128:131]
  s_nop 1
  v_mfma_f32_16x16x32_bf16 v[128:131], a[72:75], v[40:43], v[128:131]
  ds_read_b64_tr_b16 a[98:99], v14 offset:34816
  v_mfma_f32_16x16x32_bf16 v[128:131], a[76:79], v[44:47], v[128:131]
  v_cvt_pk_bf16_f32 v112, v160, v161
  v_cvt_pk_bf16_f32 v113, v162, v163
  v_mfma_f32_16x16x32_bf16 v[136:139], a[64:67], v[48:51], 0
  ds_read_b64_tr_b16 a[100:101], v14 offset:36864
  v_mfma_f32_16x16x32_bf16 v[136:139], a[68:71], v[52:55], v[136:139]
  v_cvt_pk_bf16_f32 v114, v164, v165
  v_cvt_pk_bf16_f32 v115, v166, v167
  v_mfma_f32_16x16x32_bf16 v[136:139], a[72:75], v[56:59], v[136:139]
  ds_read_b64_tr_b16 a[102:103], v14 offset:38912
  v_mfma_f32_16x16x32_bf16 v[136:139], a[76:79], v[60:63], v[136:139]
  buffer_store_dwordx4 v[112:115], v2, s[40:43], s76 offen offset:3072 sc1
  v_mfma_f32_16x16x32_bf16 v[144:147], a[64:67], v[64:67], 0
  ds_read_b64_tr_b16 a[104:105], v14 offset:40960
  v_mfma_f32_16x16x32_bf16 v[144:147], a[68:71], v[68:71], v[144:147]
  v_cvt_pk_bf16_f32 v116, v168, v169
  v_cvt_pk_bf16_f32 v117, v170, v171
  v_mfma_f32_16x16x32_bf16 v[144:147], a[72:75], v[72:75], v[144:147]
  ds_read_b64_tr_b16 a[106:107], v14 offset:43008
  v_mfma_f32_16x16x32_bf16 v[144:147], a[76:79], v[76:79], v[144:147]
  v_cvt_pk_bf16_f32 v118, v172, v173
  v_cvt_pk_bf16_f32 v119, v174, v175
  v_mfma_f32_16x16x32_bf16 v[152:155], a[64:67], v[80:83], 0
  ds_read_b64_tr_b16 a[108:109], v14 offset:45056
  v_mfma_f32_16x16x32_bf16 v[152:155], a[68:71], v[84:87], v[152:155]
  buffer_store_dwordx4 v[116:119], v2, s[40:43], s77 offen offset:3072 sc1
  v_mfma_f32_16x16x32_bf16 v[152:155], a[72:75], v[88:91], v[152:155]
  ds_read_b64_tr_b16 a[110:111], v14 offset:47104
  v_mfma_f32_16x16x32_bf16 v[152:155], a[76:79], v[92:95], v[152:155]
  s_waitcnt lgkmcnt(8)
  v_cvt_pk_bf16_f32 v120, v176, v177
  v_cvt_pk_bf16_f32 v121, v178, v179
  v_mfma_f32_16x16x32_bf16 v[132:135], a[80:83], v[32:35], 0
  ds_read_b64_tr_b16 a[112:113], v15 offset:32768
  v_mfma_f32_16x16x32_bf16 v[132:135], a[84:87], v[36:39], v[132:135]
  v_cvt_pk_bf16_f32 v122, v180, v181
  v_cvt_pk_bf16_f32 v123, v182, v183
  v_mfma_f32_16x16x32_bf16 v[132:135], a[88:91], v[40:43], v[132:135]
  ds_read_b64_tr_b16 a[114:115], v15 offset:34816
  v_mfma_f32_16x16x32_bf16 v[132:135], a[92:95], v[44:47], v[132:135]
  buffer_store_dwordx4 v[120:123], v2, s[40:43], s78 offen offset:3072 sc1
  v_mfma_f32_16x16x32_bf16 v[140:143], a[80:83], v[48:51], 0
  ds_read_b64_tr_b16 a[116:117], v15 offset:36864
  v_mfma_f32_16x16x32_bf16 v[140:143], a[84:87], v[52:55], v[140:143]
  v_cvt_pk_bf16_f32 v124, v184, v185
  v_cvt_pk_bf16_f32 v125, v186, v187
  v_mfma_f32_16x16x32_bf16 v[140:143], a[88:91], v[56:59], v[140:143]
  ds_read_b64_tr_b16 a[118:119], v15 offset:38912
  v_mfma_f32_16x16x32_bf16 v[140:143], a[92:95], v[60:63], v[140:143]
  v_cvt_pk_bf16_f32 v126, v188, v189
  v_cvt_pk_bf16_f32 v127, v190, v191
  v_mfma_f32_16x16x32_bf16 v[148:151], a[80:83], v[64:67], 0
  ds_read_b64_tr_b16 a[120:121], v15 offset:40960
  v_mfma_f32_16x16x32_bf16 v[148:151], a[84:87], v[68:71], v[148:151]
  buffer_store_dwordx4 v[124:127], v2, s[40:43], s79 offen offset:3072 sc1
  v_mfma_f32_16x16x32_bf16 v[148:151], a[88:91], v[72:75], v[148:151]
  ds_read_b64_tr_b16 a[122:123], v15 offset:43008
  v_mfma_f32_16x16x32_bf16 v[148:151], a[92:95], v[76:79], v[148:151]
  v_mfma_f32_16x16x32_bf16 v[156:159], a[80:83], v[80:83], 0
  ds_read_b64_tr_b16 a[124:125], v15 offset:45056
  v_mfma_f32_16x16x32_bf16 v[156:159], a[84:87], v[84:87], v[156:159]
  v_mfma_f32_16x16x32_bf16 v[156:159], a[88:91], v[88:91], v[156:159]
  s_waitcnt vmcnt(32)
  s_barrier
  ds_read_b64_tr_b16 a[126:127], v15 offset:47104
  v_mfma_f32_16x16x32_bf16 v[156:159], a[92:95], v[92:95], v[156:159]
  s_waitcnt lgkmcnt(8)
  v_mfma_f32_16x16x32_bf16 v[160:163], a[96:99], v[32:35], 0
  ds_read_b64_tr_b16 a[64:65], v12 offset:49152
  v_mfma_f32_16x16x32_bf16 v[160:163], a[100:103], v[36:39], v[160:163]
  s_add_u32 s76, s76, 0x1000
  s_add_u32 s77, s77, 0x1000
  s_add_u32 s78, s78, 0x1000
  s_add_u32 s79, s79, 0x1000
  v_mfma_f32_16x16x32_bf16 v[160:163], a[104:107], v[40:43], v[160:163]
  ds_read_b64_tr_b16 a[66:67], v12 offset:51200
  v_mfma_f32_16x16x32_bf16 v[160:163], a[108:111], v[44:47], v[160:163]
  v_cvt_pk_bf16_f32 v96, v128, v129
  v_cvt_pk_bf16_f32 v97, v130, v131
  v_mfma_f32_16x16x32_bf16 v[168:171], a[96:99], v[48:51], 0
  ds_read_b64_tr_b16 a[68:69], v12 offset:53248
  v_mfma_f32_16x16x32_bf16 v[168:171], a[100:103], v[52:55], v[168:171]
  v_cvt_pk_bf16_f32 v98, v132, v133
  v_cvt_pk_bf16_f32 v99, v134, v135
  v_mfma_f32_16x16x32_bf16 v[168:171], a[104:107], v[56:59], v[168:171]
  ds_read_b64_tr_b16 a[70:71], v12 offset:55296
  v_mfma_f32_16x16x32_bf16 v[168:171], a[108:111], v[60:63], v[168:171]
  buffer_store_dwordx4 v[96:99], v2, s[40:43], s76 offen offset:0 sc1
  v_mfma_f32_16x16x32_bf16 v[176:179], a[96:99], v[64:67], 0
  ds_read_b64_tr_b16 a[72:73], v12 offset:57344
  v_mfma_f32_16x16x32_bf16 v[176:179], a[100:103], v[68:71], v[176:179]
  v_cvt_pk_bf16_f32 v100, v136, v137
  v_cvt_pk_bf16_f32 v101, v138, v139
  v_mfma_f32_16x16x32_bf16 v[176:179], a[104:107], v[72:75], v[176:179]
  ds_read_b64_tr_b16 a[74:75], v12 offset:59392
  v_mfma_f32_16x16x32_bf16 v[176:179], a[108:111], v[76:79], v[176:179]
  v_cvt_pk_bf16_f32 v102, v140, v141
  v_cvt_pk_bf16_f32 v103, v142, v143
  v_mfma_f32_16x16x32_bf16 v[184:187], a[96:99], v[80:83], 0
  ds_read_b64_tr_b16 a[76:77], v12 offset:61440
  v_mfma_f32_16x16x32_bf16 v[184:187], a[100:103], v[84:87], v[184:187]
  buffer_store_dwordx4 v[100:103], v2, s[40:43], s77 offen offset:0 sc1
  v_mfma_f32_16x16x32_bf16 v[184:187], a[104:107], v[88:91], v[184:187]
  ds_read_b64_tr_b16 a[78:79], v12 offset:63488
  v_mfma_f32_16x16x32_bf16 v[184:187], a[108:111], v[92:95], v[184:187]
  s_waitcnt lgkmcnt(8)
  v_cvt_pk_bf16_f32 v104, v144, v145
  v_cvt_pk_bf16_f32 v105, v146, v147
  v_mfma_f32_16x16x32_bf16 v[164:167], a[112:115], v[32:35], 0
  ds_read_b64_tr_b16 a[80:81], v13 offset:49152
  v_mfma_f32_16x16x32_bf16 v[164:167], a[116:119], v[36:39], v[164:167]
  v_cvt_pk_bf16_f32 v106, v148, v149
  v_cvt_pk_bf16_f32 v107, v150, v151
  v_mfma_f32_16x16x32_bf16 v[164:167], a[120:123], v[40:43], v[164:167]
  ds_read_b64_tr_b16 a[82:83], v13 offset:51200
  v_mfma_f32_16x16x32_bf16 v[164:167], a[124:127], v[44:47], v[164:167]
  buffer_store_dwordx4 v[104:107], v2, s[40:43], s78 offen offset:0 sc1
  v_mfma_f32_16x16x32_bf16 v[172:175], a[112:115], v[48:51], 0
  ds_read_b64_tr_b16 a[84:85], v13 offset:53248
  v_mfma_f32_16x16x32_bf16 v[172:175], a[116:119], v[52:55], v[172:175]
  v_cvt_pk_bf16_f32 v108, v152, v153
  v_cvt_pk_bf16_f32 v109, v154, v155
  v_mfma_f32_16x16x32_bf16 v[172:175], a[120:123], v[56:59], v[172:175]
  ds_read_b64_tr_b16 a[86:87], v13 offset:55296
  v_mfma_f32_16x16x32_bf16 v[172:175], a[124:127], v[60:63], v[172:175]
  v_cvt_pk_bf16_f32 v110, v156, v157
  v_cvt_pk_bf16_f32 v111, v158, v159
  v_mfma_f32_16x16x32_bf16 v[180:183], a[112:115], v[64:67], 0
  ds_read_b64_tr_b16 a[88:89], v13 offset:57344
  v_mfma_f32_16x16x32_bf16 v[180:183], a[116:119], v[68:71], v[180:183]
  buffer_store_dwordx4 v[108:111], v2, s[40:43], s79 offen offset:0 sc1
  v_mfma_f32_16x16x32_bf16 v[180:183], a[120:123], v[72:75], v[180:183]
  ds_read_b64_tr_b16 a[90:91], v13 offset:59392
  v_mfma_f32_16x16x32_bf16 v[180:183], a[124:127], v[76:79], v[180:183]
  v_mfma_f32_16x16x32_bf16 v[188:191], a[112:115], v[80:83], 0
  ds_read_b64_tr_b16 a[92:93], v13 offset:61440
  v_mfma_f32_16x16x32_bf16 v[188:191], a[116:119], v[84:87], v[188:191]
  v_mfma_f32_16x16x32_bf16 v[188:191], a[120:123], v[88:91], v[188:191]
  ds_read_b64_tr_b16 a[94:95], v13 offset:63488
  v_mfma_f32_16x16x32_bf16 v[188:191], a[124:127], v[92:95], v[188:191]
  s_waitcnt lgkmcnt(8)
  v_mfma_f32_16x16x32_bf16 v[128:131], a[64:67], v[32:35], 0
  ds_read_b64_tr_b16 a[96:97], v14 offset:49152
  v_mfma_f32_16x16x32_bf16 v[128:131], a[68:71], v[36:39], v[128:131]
  s_nop 1
  v_mfma_f32_16x16x32_bf16 v[128:131], a[72:75], v[40:43], v[128:131]
  ds_read_b64_tr_b16 a[98:99], v14 offset:51200
  v_mfma_f32_16x16x32_bf16 v[128:131], a[76:79], v[44:47], v[128:131]
  v_cvt_pk_bf16_f32 v112, v160, v161
  v_cvt_pk_bf16_f32 v113, v162, v163
  v_mfma_f32_16x16x32_bf16 v[136:139], a[64:67], v[48:51], 0
  ds_read_b64_tr_b16 a[100:101], v14 offset:53248
  v_mfma_f32_16x16x32_bf16 v[136:139], a[68:71], v[52:55], v[136:139]
  v_cvt_pk_bf16_f32 v114, v164, v165
  v_cvt_pk_bf16_f32 v115, v166, v167
  v_mfma_f32_16x16x32_bf16 v[136:139], a[72:75], v[56:59], v[136:139]
  ds_read_b64_tr_b16 a[102:103], v14 offset:55296
  v_mfma_f32_16x16x32_bf16 v[136:139], a[76:79], v[60:63], v[136:139]
  buffer_store_dwordx4 v[112:115], v2, s[40:43], s76 offen offset:1024 sc1
  v_mfma_f32_16x16x32_bf16 v[144:147], a[64:67], v[64:67], 0
  ds_read_b64_tr_b16 a[104:105], v14 offset:57344
  v_mfma_f32_16x16x32_bf16 v[144:147], a[68:71], v[68:71], v[144:147]
  v_cvt_pk_bf16_f32 v116, v168, v169
  v_cvt_pk_bf16_f32 v117, v170, v171
  v_mfma_f32_16x16x32_bf16 v[144:147], a[72:75], v[72:75], v[144:147]
  ds_read_b64_tr_b16 a[106:107], v14 offset:59392
  v_mfma_f32_16x16x32_bf16 v[144:147], a[76:79], v[76:79], v[144:147]
  v_cvt_pk_bf16_f32 v118, v172, v173
  v_cvt_pk_bf16_f32 v119, v174, v175
  v_mfma_f32_16x16x32_bf16 v[152:155], a[64:67], v[80:83], 0
  ds_read_b64_tr_b16 a[108:109], v14 offset:61440
  v_mfma_f32_16x16x32_bf16 v[152:155], a[68:71], v[84:87], v[152:155]
  buffer_store_dwordx4 v[116:119], v2, s[40:43], s77 offen offset:1024 sc1
  v_mfma_f32_16x16x32_bf16 v[152:155], a[72:75], v[88:91], v[152:155]
  ds_read_b64_tr_b16 a[110:111], v14 offset:63488
  v_mfma_f32_16x16x32_bf16 v[152:155], a[76:79], v[92:95], v[152:155]
  s_waitcnt lgkmcnt(8)
  v_cvt_pk_bf16_f32 v120, v176, v177
  v_cvt_pk_bf16_f32 v121, v178, v179
  v_mfma_f32_16x16x32_bf16 v[132:135], a[80:83], v[32:35], 0
  ds_read_b64_tr_b16 a[112:113], v15 offset:49152
  v_mfma_f32_16x16x32_bf16 v[132:135], a[84:87], v[36:39], v[132:135]
  v_cvt_pk_bf16_f32 v122, v180, v181
  v_cvt_pk_bf16_f32 v123, v182, v183
  v_mfma_f32_16x16x32_bf16 v[132:135], a[88:91], v[40:43], v[132:135]
  ds_read_b64_tr_b16 a[114:115], v15 offset:51200
  v_mfma_f32_16x16x32_bf16 v[132:135], a[92:95], v[44:47], v[132:135]
  buffer_store_dwordx4 v[120:123], v2, s[40:43], s78 offen offset:1024 sc1
  v_mfma_f32_16x16x32_bf16 v[140:143], a[80:83], v[48:51], 0
  ds_read_b64_tr_b16 a[116:117], v15 offset:53248
  v_mfma_f32_16x16x32_bf16 v[140:143], a[84:87], v[52:55], v[140:143]
  v_cvt_pk_bf16_f32 v124, v184, v185
  v_cvt_pk_bf16_f32 v125, v186, v187
  v_mfma_f32_16x16x32_bf16 v[140:143], a[88:91], v[56:59], v[140:143]
  ds_read_b64_tr_b16 a[118:119], v15 offset:55296
  v_mfma_f32_16x16x32_bf16 v[140:143], a[92:95], v[60:63], v[140:143]
  v_cvt_pk_bf16_f32 v126, v188, v189
  v_cvt_pk_bf16_f32 v127, v190, v191
  v_mfma_f32_16x16x32_bf16 v[148:151], a[80:83], v[64:67], 0
  ds_read_b64_tr_b16 a[120:121], v15 offset:57344
  v_mfma_f32_16x16x32_bf16 v[148:151], a[84:87], v[68:71], v[148:151]
  buffer_store_dwordx4 v[124:127], v2, s[40:43], s79 offen offset:1024 sc1
  v_mfma_f32_16x16x32_bf16 v[148:151], a[88:91], v[72:75], v[148:151]
  ds_read_b64_tr_b16 a[122:123], v15 offset:59392
  v_mfma_f32_16x16x32_bf16 v[148:151], a[92:95], v[76:79], v[148:151]
  v_mfma_f32_16x16x32_bf16 v[156:159], a[80:83], v[80:83], 0
  ds_read_b64_tr_b16 a[124:125], v15 offset:61440
  v_mfma_f32_16x16x32_bf16 v[156:159], a[84:87], v[84:87], v[156:159]
  v_mfma_f32_16x16x32_bf16 v[156:159], a[88:91], v[88:91], v[156:159]
  ds_read_b64_tr_b16 a[126:127], v15 offset:63488
  v_mfma_f32_16x16x32_bf16 v[156:159], a[92:95], v[92:95], v[156:159]
  s_waitcnt lgkmcnt(8)
  v_mfma_f32_16x16x32_bf16 v[160:163], a[96:99], v[32:35], 0
  v_mfma_f32_16x16x32_bf16 v[160:163], a[100:103], v[36:39], v[160:163]
  s_nop 1
  v_mfma_f32_16x16x32_bf16 v[160:163], a[104:107], v[40:43], v[160:163]
  v_mfma_f32_16x16x32_bf16 v[160:163], a[108:111], v[44:47], v[160:163]
  v_cvt_pk_bf16_f32 v96, v128, v129
  v_cvt_pk_bf16_f32 v97, v130, v131
  v_mfma_f32_16x16x32_bf16 v[168:171], a[96:99], v[48:51], 0
  v_mfma_f32_16x16x32_bf16 v[168:171], a[100:103], v[52:55], v[168:171]
  v_cvt_pk_bf16_f32 v98, v132, v133
  v_cvt_pk_bf16_f32 v99, v134, v135
  v_mfma_f32_16x16x32_bf16 v[168:171], a[104:107], v[56:59], v[168:171]
  v_mfma_f32_16x16x32_bf16 v[168:171], a[108:111], v[60:63], v[168:171]
  buffer_store_dwordx4 v[96:99], v2, s[40:43], s76 offen offset:2048 sc1
  v_mfma_f32_16x16x32_bf16 v[176:179], a[96:99], v[64:67], 0
  v_mfma_f32_16x16x32_bf16 v[176:179], a[100:103], v[68:71], v[176:179]
  v_cvt_pk_bf16_f32 v100, v136, v137
  v_cvt_pk_bf16_f32 v101, v138, v139
  v_mfma_f32_16x16x32_bf16 v[176:179], a[104:107], v[72:75], v[176:179]
  v_mfma_f32_16x16x32_bf16 v[176:179], a[108:111], v[76:79], v[176:179]
  v_cvt_pk_bf16_f32 v102, v140, v141
  v_cvt_pk_bf16_f32 v103, v142, v143
  v_mfma_f32_16x16x32_bf16 v[184:187], a[96:99], v[80:83], 0
  v_mfma_f32_16x16x32_bf16 v[184:187], a[100:103], v[84:87], v[184:187]
  buffer_store_dwordx4 v[100:103], v2, s[40:43], s77 offen offset:2048 sc1
  v_mfma_f32_16x16x32_bf16 v[184:187], a[104:107], v[88:91], v[184:187]
  v_mfma_f32_16x16x32_bf16 v[184:187], a[108:111], v[92:95], v[184:187]
  s_waitcnt lgkmcnt(0)
  v_cvt_pk_bf16_f32 v104, v144, v145
  v_cvt_pk_bf16_f32 v105, v146, v147
  v_mfma_f32_16x16x32_bf16 v[164:167], a[112:115], v[32:35], 0
  v_mfma_f32_16x16x32_bf16 v[164:167], a[116:119], v[36:39], v[164:167]
  v_cvt_pk_bf16_f32 v106, v148, v149
  v_cvt_pk_bf16_f32 v107, v150, v151
  v_mfma_f32_16x16x32_bf16 v[164:167], a[120:123], v[40:43], v[164:167]
  v_mfma_f32_16x16x32_bf16 v[164:167], a[124:127], v[44:47], v[164:167]
  buffer_store_dwordx4 v[104:107], v2, s[40:43], s78 offen offset:2048 sc1
  v_mfma_f32_16x16x32_bf16 v[172:175], a[112:115], v[48:51], 0
  v_mfma_f32_16x16x32_bf16 v[172:175], a[116:119], v[52:55], v[172:175]
  v_cvt_pk_bf16_f32 v108, v152, v153
  v_cvt_pk_bf16_f32 v109, v154, v155
  v_mfma_f32_16x16x32_bf16 v[172:175], a[120:123], v[56:59], v[172:175]
  v_mfma_f32_16x16x32_bf16 v[172:175], a[124:127], v[60:63], v[172:175]
  v_cvt_pk_bf16_f32 v110, v156, v157
  v_cvt_pk_bf16_f32 v111, v158, v159
  v_mfma_f32_16x16x32_bf16 v[180:183], a[112:115], v[64:67], 0
  v_mfma_f32_16x16x32_bf16 v[180:183], a[116:119], v[68:71], v[180:183]
  buffer_store_dwordx4 v[108:111], v2, s[40:43], s79 offen offset:2048 sc1
  v_mfma_f32_16x16x32_bf16 v[180:183], a[120:123], v[72:75], v[180:183]
  v_mfma_f32_16x16x32_bf16 v[180:183], a[124:127], v[76:79], v[180:183]
  v_mfma_f32_16x16x32_bf16 v[188:191], a[112:115], v[80:83], 0
  v_mfma_f32_16x16x32_bf16 v[188:191], a[116:119], v[84:87], v[188:191]
  v_mfma_f32_16x16x32_bf16 v[188:191], a[120:123], v[88:91], v[188:191]
  v_mfma_f32_16x16x32_bf16 v[188:191], a[124:127], v[92:95], v[188:191]
  s_nop 7
  v_cvt_pk_bf16_f32 v112, v160, v161
  v_cvt_pk_bf16_f32 v113, v162, v163
  v_cvt_pk_bf16_f32 v114, v164, v165
  v_cvt_pk_bf16_f32 v115, v166, v167
  buffer_store_dwordx4 v[112:115], v2, s[40:43], s76 offen offset:3072 sc1
  v_cvt_pk_bf16_f32 v116, v168, v169
  v_cvt_pk_bf16_f32 v117, v170, v171
  v_cvt_pk_bf16_f32 v118, v172, v173
  v_cvt_pk_bf16_f32 v119, v174, v175
  buffer_store_dwordx4 v[116:119], v2, s[40:43], s77 offen offset:3072 sc1
  v_cvt_pk_bf16_f32 v120, v176, v177
  v_cvt_pk_bf16_f32 v121, v178, v179
  v_cvt_pk_bf16_f32 v122, v180, v181
  v_cvt_pk_bf16_f32 v123, v182, v183
  buffer_store_dwordx4 v[120:123], v2, s[40:43], s78 offen offset:3072 sc1
  v_cvt_pk_bf16_f32 v124, v184, v185
  v_cvt_pk_bf16_f32 v125, v186, v187
  v_cvt_pk_bf16_f32 v126, v188, v189
  v_cvt_pk_bf16_f32 v127, v190, v191
  buffer_store_dwordx4 v[124:127], v2, s[40:43], s79 offen offset:3072 sc1
  s_lshl_b32 s66, s57, 7
  s_add_u32 s66, s66, 0xd086000
  s_cmp_eq_u32 s44, 0
  s_cselect_b32 s66, s66, 0x40000000
  v_mov_b32 v6, 1
  s_waitcnt vmcnt(0)
  s_barrier
  s_mov_b64 exec, 1
  buffer_atomic_add v6, v2, s[40:43], s66 offen
  s_mov_b64 exec, -1
  s_branch L_att_end
L_a_s1_t:
  s_mov_b32 s71, 0
  s_nop 6
  s_branch L_a_slow0_0
L_a_s0_t:
  s_mov_b32 s71, 1
  s_nop 6
  s_branch L_a_slow1_0
L_a_d0_t:
  s_mov_b32 s71, 2
  s_nop 6
  s_branch L_a_slow0_0
L_a_d1_t:
  s_mov_b32 s71, 3
  s_nop 6
  s_branch L_a_slow1_0
L_a_d2_t:
  s_mov_b32 s71, 4
  s_nop 6
  s_branch L_a_slow0_1
L_a_d3_t:
  s_mov_b32 s71, 5
  s_nop 6
  s_branch L_a_slow1_1
L_a_d4_t:
  s_mov_b32 s71, 6
  s_nop 6
  s_branch L_a_slow0_2
L_a_d5_t:
  s_mov_b32 s71, 7
  s_nop 6
  s_branch L_a_slow1_2
L_a_d6_t:
  s_mov_b32 s71, 8
  s_nop 6
  s_branch L_a_slow0_3
L_a_d7_t:
  s_mov_b32 s71, 9
  s_nop 6
  s_branch L_a_slow1_3
L_a_slow0_0:
  v_max3_f32 v6, v32, v33, v34
  v_max3_f32 v7, v35, v36, v37
  v_max3_f32 v6, v6, v38, v39
  v_max_f32 v6, v6, v7
  v_mov_b32 v7, v6
  s_nop 1
  v_permlane32_swap_b32 v7, v6
  v_max_f32 v6, v6, v7
  v_mov_b32 v7, v6
  s_nop 1
  v_permlane16_swap_b32 v7, v6
  v_max_f32 v6, v6, v7
  v_add_f32 v6, 0x41800000, v6
  v_max_f32 v6, 0, v6
  v_exp_f32 v7, -v6
  v_sub_f32 v96, v96, v6
  v_sub_f32 v97, v97, v6
  v_sub_f32 v98, v98, v6
  v_sub_f32 v99, v99, v6
  v_sub_f32 v100, v100, v6
  v_sub_f32 v101, v101, v6
  v_sub_f32 v102, v102, v6
  v_sub_f32 v103, v103, v6
  v_mul_f32 v128, v128, v7
  v_mul_f32 v129, v129, v7
  v_mul_f32 v130, v130, v7
  v_mul_f32 v131, v131, v7
  v_mul_f32 v132, v132, v7
  v_mul_f32 v133, v133, v7
  v_mul_f32 v134, v134, v7
  v_mul_f32 v135, v135, v7
  v_mul_f32 v136, v136, v7
  v_mul_f32 v137, v137, v7
  v_mul_f32 v138, v138, v7
  v_mul_f32 v139, v139, v7
  v_mul_f32 v140, v140, v7
  v_mul_f32 v141, v141, v7
  v_mul_f32 v142, v142, v7
  v_mul_f32 v143, v143, v7
  v_mul_f32 v144, v144, v7
  v_mul_f32 v145, v145, v7
  v_mul_f32 v146, v146, v7
  v_mul_f32 v147, v147, v7
  v_mul_f32 v148, v148, v7
  v_mul_f32 v149, v149, v7
  v_mul_f32 v150, v150, v7
  v_mul_f32 v151, v151, v7
  v_mul_f32 v152, v152, v7
  v_mul_f32 v153, v153, v7
  v_mul_f32 v154, v154, v7
  v_mul_f32 v155, v155, v7
  v_mul_f32 v156, v156, v7
  v_mul_f32 v157, v157, v7
  v_mul_f32 v158, v158, v7
  v_mul_f32 v159, v159, v7
  v_accvgpr_read_b32 v8, a128
  v_mul_f32 v8, v8, v7
  v_accvgpr_write_b32 a128, v8
  v_accvgpr_read_b32 v8, a129
  v_mul_f32 v8, v8, v7
  v_accvgpr_write_b32 a129, v8
  v_accvgpr_read_b32 v8, a130
  v_mul_f32 v8, v8, v7
  v_accvgpr_write_b32 a130, v8
  v_accvgpr_read_b32 v8, a131
  v_mul_f32 v8, v8, v7
  v_accvgpr_write_b32 a131, v8
  v_sub_f32 v8, v32, v6
  v_sub_f32 v9, v33, v6
  v_sub_f32 v10, v34, v6
  v_sub_f32 v11, v35, v6
  v_sub_f32 v12, v36, v6
  v_sub_f32 v13, v37, v6
  v_sub_f32 v14, v38, v6
  v_sub_f32 v15, v39, v6
  v_exp_f32 v8, v8
  v_exp_f32 v9, v9
  v_exp_f32 v10, v10
  v_exp_f32 v11, v11
  v_exp_f32 v12, v12
  v_exp_f32 v13, v13
  v_exp_f32 v14, v14
  v_exp_f32 v15, v15
  v_cvt_pk_bf16_f32 v64, v8, v9
  v_cvt_pk_bf16_f32 v65, v10, v11
  v_cvt_pk_bf16_f32 v66, v12, v13
  v_cvt_pk_bf16_f32 v67, v14, v15
L_a_slow0_1:
  v_max3_f32 v6, v40, v41, v42
  v_max3_f32 v7, v43, v44, v45
  v_max3_f32 v6, v6, v46, v47
  v_max_f32 v6, v6, v7
  v_mov_b32 v7, v6
  s_nop 1
  v_permlane32_swap_b32 v7, v6
  v_max_f32 v6, v6, v7
  v_mov_b32 v7, v6
  s_nop 1
  v_permlane16_swap_b32 v7, v6
  v_max_f32 v6, v6, v7
  v_add_f32 v6, 0x41800000, v6
  v_max_f32 v6, 0, v6
  v_exp_f32 v7, -v6
  v_sub_f32 v104, v104, v6
  v_sub_f32 v105, v105, v6
  v_sub_f32 v106, v106, v6
  v_sub_f32 v107, v107, v6
  v_sub_f32 v108, v108, v6
  v_sub_f32 v109, v109, v6
  v_sub_f32 v110, v110, v6
  v_sub_f32 v111, v111, v6
  v_mul_f32 v160, v160, v7
  v_mul_f32 v161, v161, v7
  v_mul_f32 v162, v162, v7
  v_mul_f32 v163, v163, v7
  v_mul_f32 v164, v164, v7
  v_mul_f32 v165, v165, v7
  v_mul_f32 v166, v166, v7
  v_mul_f32 v167, v167, v7
  v_mul_f32 v168, v168, v7
  v_mul_f32 v169, v169, v7
  v_mul_f32 v170, v170, v7
  v_mul_f32 v171, v171, v7
  v_mul_f32 v172, v172, v7
  v_mul_f32 v173, v173, v7
  v_mul_f32 v174, v174, v7
  v_mul_f32 v175, v175, v7
  v_mul_f32 v176, v176, v7
  v_mul_f32 v177, v177, v7
  v_mul_f32 v178, v178, v7
  v_mul_f32 v179, v179, v7
  v_mul_f32 v180, v180, v7
  v_mul_f32 v181, v181, v7
  v_mul_f32 v182, v182, v7
  v_mul_f32 v183, v183, v7
  v_mul_f32 v184, v184, v7
  v_mul_f32 v185, v185, v7
  v_mul_f32 v186, v186, v7
  v_mul_f32 v187, v187, v7
  v_mul_f32 v188, v188, v7
  v_mul_f32 v189, v189, v7
  v_mul_f32 v190, v190, v7
  v_mul_f32 v191, v191, v7
  v_accvgpr_read_b32 v8, a132
  v_mul_f32 v8, v8, v7
  v_accvgpr_write_b32 a132, v8
  v_accvgpr_read_b32 v8, a133
  v_mul_f32 v8, v8, v7
  v_accvgpr_write_b32 a133, v8
  v_accvgpr_read_b32 v8, a134
  v_mul_f32 v8, v8, v7
  v_accvgpr_write_b32 a134, v8
  v_accvgpr_read_b32 v8, a135
  v_mul_f32 v8, v8, v7
  v_accvgpr_write_b32 a135, v8
  v_sub_f32 v8, v40, v6
  v_sub_f32 v9, v41, v6
  v_sub_f32 v10, v42, v6
  v_sub_f32 v11, v43, v6
  v_sub_f32 v12, v44, v6
  v_sub_f32 v13, v45, v6
  v_sub_f32 v14, v46, v6
  v_sub_f32 v15, v47, v6
  v_exp_f32 v8, v8
  v_exp_f32 v9, v9
  v_exp_f32 v10, v10
  v_exp_f32 v11, v11
  v_exp_f32 v12, v12
  v_exp_f32 v13, v13
  v_exp_f32 v14, v14
  v_exp_f32 v15, v15
  v_cvt_pk_bf16_f32 v68, v8, v9
  v_cvt_pk_bf16_f32 v69, v10, v11
  v_cvt_pk_bf16_f32 v70, v12, v13
  v_cvt_pk_bf16_f32 v71, v14, v15
L_a_slow0_2:
  v_max3_f32 v6, v48, v49, v50
  v_max3_f32 v7, v51, v52, v53
  v_max3_f32 v6, v6, v54, v55
  v_max_f32 v6, v6, v7
  v_mov_b32 v7, v6
  s_nop 1
  v_permlane32_swap_b32 v7, v6
  v_max_f32 v6, v6, v7
  v_mov_b32 v7, v6
  s_nop 1
  v_permlane16_swap_b32 v7, v6
  v_max_f32 v6, v6, v7
  v_add_f32 v6, 0x41800000, v6
  v_max_f32 v6, 0, v6
  v_exp_f32 v7, -v6
  v_sub_f32 v112, v112, v6
  v_sub_f32 v113, v113, v6
  v_sub_f32 v114, v114, v6
  v_sub_f32 v115, v115, v6
  v_sub_f32 v116, v116, v6
  v_sub_f32 v117, v117, v6
  v_sub_f32 v118, v118, v6
  v_sub_f32 v119, v119, v6
  v_mul_f32 v192, v192, v7
  v_mul_f32 v193, v193, v7
  v_mul_f32 v194, v194, v7
  v_mul_f32 v195, v195, v7
  v_mul_f32 v196, v196, v7
  v_mul_f32 v197, v197, v7
  v_mul_f32 v198, v198, v7
  v_mul_f32 v199, v199, v7
  v_mul_f32 v200, v200, v7
  v_mul_f32 v201, v201, v7
  v_mul_f32 v202, v202, v7
  v_mul_f32 v203, v203, v7
  v_mul_f32 v204, v204, v7
  v_mul_f32 v205, v205, v7
  v_mul_f32 v206, v206, v7
  v_mul_f32 v207, v207, v7
  v_mul_f32 v208, v208, v7
  v_mul_f32 v209, v209, v7
  v_mul_f32 v210, v210, v7
  v_mul_f32 v211, v211, v7
  v_mul_f32 v212, v212, v7
  v_mul_f32 v213, v213, v7
  v_mul_f32 v214, v214, v7
  v_mul_f32 v215, v215, v7
  v_mul_f32 v216, v216, v7
  v_mul_f32 v217, v217, v7
  v_mul_f32 v218, v218, v7
  v_mul_f32 v219, v219, v7
  v_mul_f32 v220, v220, v7
  v_mul_f32 v221, v221, v7
  v_mul_f32 v222, v222, v7
  v_mul_f32 v223, v223, v7
  v_accvgpr_read_b32 v8, a136
  v_mul_f32 v8, v8, v7
  v_accvgpr_write_b32 a136, v8
  v_accvgpr_read_b32 v8, a137
  v_mul_f32 v8, v8, v7
  v_accvgpr_write_b32 a137, v8
  v_accvgpr_read_b32 v8, a138
  v_mul_f32 v8, v8, v7
  v_accvgpr_write_b32 a138, v8
  v_accvgpr_read_b32 v8, a139
  v_mul_f32 v8, v8, v7
  v_accvgpr_write_b32 a139, v8
  v_sub_f32 v8, v48, v6
  v_sub_f32 v9, v49, v6
  v_sub_f32 v10, v50, v6
  v_sub_f32 v11, v51, v6
  v_sub_f32 v12, v52, v6
  v_sub_f32 v13, v53, v6
  v_sub_f32 v14, v54, v6
  v_sub_f32 v15, v55, v6
  v_exp_f32 v8, v8
  v_exp_f32 v9, v9
  v_exp_f32 v10, v10
  v_exp_f32 v11, v11
  v_exp_f32 v12, v12
  v_exp_f32 v13, v13
  v_exp_f32 v14, v14
  v_exp_f32 v15, v15
  v_cvt_pk_bf16_f32 v72, v8, v9
  v_cvt_pk_bf16_f32 v73, v10, v11
  v_cvt_pk_bf16_f32 v74, v12, v13
  v_cvt_pk_bf16_f32 v75, v14, v15
L_a_slow0_3:
  v_max3_f32 v6, v56, v57, v58
  v_max3_f32 v7, v59, v60, v61
  v_max3_f32 v6, v6, v62, v63
  v_max_f32 v6, v6, v7
  v_mov_b32 v7, v6
  s_nop 1
  v_permlane32_swap_b32 v7, v6
  v_max_f32 v6, v6, v7
  v_mov_b32 v7, v6
  s_nop 1
  v_permlane16_swap_b32 v7, v6
  v_max_f32 v6, v6, v7
  v_add_f32 v6, 0x41800000, v6
  v_max_f32 v6, 0, v6
  v_exp_f32 v7, -v6
  v_sub_f32 v120, v120, v6
  v_sub_f32 v121, v121, v6
  v_sub_f32 v122, v122, v6
  v_sub_f32 v123, v123, v6
  v_sub_f32 v124, v124, v6
  v_sub_f32 v125, v125, v6
  v_sub_f32 v126, v126, v6
  v_sub_f32 v127, v127, v6
  v_mul_f32 v224, v224, v7
  v_mul_f32 v225, v225, v7
  v_mul_f32 v226, v226, v7
  v_mul_f32 v227, v227, v7
  v_mul_f32 v228, v228, v7
  v_mul_f32 v229, v229, v7
  v_mul_f32 v230, v230, v7
  v_mul_f32 v231, v231, v7
  v_mul_f32 v232, v232, v7
  v_mul_f32 v233, v233, v7
  v_mul_f32 v234, v234, v7
  v_mul_f32 v235, v235, v7
  v_mul_f32 v236, v236, v7
  v_mul_f32 v237, v237, v7
  v_mul_f32 v238, v238, v7
  v_mul_f32 v239, v239, v7
  v_mul_f32 v240, v240, v7
  v_mul_f32 v241, v241, v7
  v_mul_f32 v242, v242, v7
  v_mul_f32 v243, v243, v7
  v_mul_f32 v244, v244, v7
  v_mul_f32 v245, v245, v7
  v_mul_f32 v246, v246, v7
  v_mul_f32 v247, v247, v7
  v_mul_f32 v248, v248, v7
  v_mul_f32 v249, v249, v7
  v_mul_f32 v250, v250, v7
  v_mul_f32 v251, v251, v7
  v_mul_f32 v252, v252, v7
  v_mul_f32 v253, v253, v7
  v_mul_f32 v254, v254, v7
  v_mul_f32 v255, v255, v7
  v_accvgpr_read_b32 v8, a140
  v_mul_f32 v8, v8, v7
  v_accvgpr_write_b32 a140, v8
  v_accvgpr_read_b32 v8, a141
  v_mul_f32 v8, v8, v7
  v_accvgpr_write_b32 a141, v8
  v_accvgpr_read_b32 v8, a142
  v_mul_f32 v8, v8, v7
  v_accvgpr_write_b32 a142, v8
  v_accvgpr_read_b32 v8, a143
  v_mul_f32 v8, v8, v7
  v_accvgpr_write_b32 a143, v8
  v_sub_f32 v8, v56, v6
  v_sub_f32 v9, v57, v6
  v_sub_f32 v10, v58, v6
  v_sub_f32 v11, v59, v6
  v_sub_f32 v12, v60, v6
  v_sub_f32 v13, v61, v6
  v_sub_f32 v14, v62, v6
  v_sub_f32 v15, v63, v6
  v_exp_f32 v8, v8
  v_exp_f32 v9, v9
  v_exp_f32 v10, v10
  v_exp_f32 v11, v11
  v_exp_f32 v12, v12
  v_exp_f32 v13, v13
  v_exp_f32 v14, v14
  v_exp_f32 v15, v15
  v_cvt_pk_bf16_f32 v76, v8, v9
  v_cvt_pk_bf16_f32 v77, v10, v11
  v_cvt_pk_bf16_f32 v78, v12, v13
  v_cvt_pk_bf16_f32 v79, v14, v15
  s_cmp_eq_u32 s71, 0
  s_cbranch_scc1 L_a_s1_r
  s_cmp_eq_u32 s71, 2
  s_cbranch_scc1 L_a_d0_r
  s_cmp_eq_u32 s71, 4
  s_cbranch_scc1 L_a_d2_r
  s_cmp_eq_u32 s71, 6
  s_cbranch_scc1 L_a_d4_r
  s_branch L_a_d6_r
L_a_slow1_0:
  v_max3_f32 v6, v32, v33, v34
  v_max3_f32 v7, v35, v36, v37
  v_max3_f32 v6, v6, v38, v39
  v_max_f32 v6, v6, v7
  v_mov_b32 v7, v6
  s_nop 1
  v_permlane32_swap_b32 v7, v6
  v_max_f32 v6, v6, v7
  v_mov_b32 v7, v6
  s_nop 1
  v_permlane16_swap_b32 v7, v6
  v_max_f32 v6, v6, v7
  v_add_f32 v6, 0x41800000, v6
  v_max_f32 v6, 0, v6
  v_exp_f32 v7, -v6
  v_sub_f32 v96, v96, v6
  v_sub_f32 v97, v97, v6
  v_sub_f32 v98, v98, v6
  v_sub_f32 v99, v99, v6
  v_sub_f32 v100, v100, v6
  v_sub_f32 v101, v101, v6
  v_sub_f32 v102, v102, v6
  v_sub_f32 v103, v103, v6
  v_mul_f32 v128, v128, v7
  v_mul_f32 v129, v129, v7
  v_mul_f32 v130, v130, v7
  v_mul_f32 v131, v131, v7
  v_mul_f32 v132, v132, v7
  v_mul_f32 v133, v133, v7
  v_mul_f32 v134, v134, v7
  v_mul_f32 v135, v135, v7
  v_mul_f32 v136, v136, v7
  v_mul_f32 v137, v137, v7
  v_mul_f32 v138, v138, v7
  v_mul_f32 v139, v139, v7
  v_mul_f32 v140, v140, v7
  v_mul_f32 v141, v141, v7
  v_mul_f32 v142, v142, v7
  v_mul_f32 v143, v143, v7
  v_mul_f32 v144, v144, v7
  v_mul_f32 v145, v145, v7
  v_mul_f32 v146, v146, v7
  v_mul_f32 v147, v147, v7
  v_mul_f32 v148, v148, v7
  v_mul_f32 v149, v149, v7
  v_mul_f32 v150, v150, v7
  v_mul_f32 v151, v151, v7
  v_mul_f32 v152, v152, v7
  v_mul_f32 v153, v153, v7
  v_mul_f32 v154, v154, v7
  v_mul_f32 v155, v155, v7
  v_mul_f32 v156, v156, v7
  v_mul_f32 v157, v157, v7
  v_mul_f32 v158, v158, v7
  v_mul_f32 v159, v159, v7
  v_accvgpr_read_b32 v8, a128
  v_mul_f32 v8, v8, v7
  v_accvgpr_write_b32 a128, v8
  v_accvgpr_read_b32 v8, a129
  v_mul_f32 v8, v8, v7
  v_accvgpr_write_b32 a129, v8
  v_accvgpr_read_b32 v8, a130
  v_mul_f32 v8, v8, v7
  v_accvgpr_write_b32 a130, v8
  v_accvgpr_read_b32 v8, a131
  v_mul_f32 v8, v8, v7
  v_accvgpr_write_b32 a131, v8
  v_sub_f32 v8, v32, v6
  v_sub_f32 v9, v33, v6
  v_sub_f32 v10, v34, v6
  v_sub_f32 v11, v35, v6
  v_sub_f32 v12, v36, v6
  v_sub_f32 v13, v37, v6
  v_sub_f32 v14, v38, v6
  v_sub_f32 v15, v39, v6
  v_exp_f32 v8, v8
  v_exp_f32 v9, v9
  v_exp_f32 v10, v10
  v_exp_f32 v11, v11
  v_exp_f32 v12, v12
  v_exp_f32 v13, v13
  v_exp_f32 v14, v14
  v_exp_f32 v15, v15
  v_cvt_pk_bf16_f32 v80, v8, v9
  v_cvt_pk_bf16_f32 v81, v10, v11
  v_cvt_pk_bf16_f32 v82, v12, v13
  v_cvt_pk_bf16_f32 v83, v14, v15
L_a_slow1_1:
  v_max3_f32 v6, v40, v41, v42
  v_max3_f32 v7, v43, v44, v45
  v_max3_f32 v6, v6, v46, v47
  v_max_f32 v6, v6, v7
  v_mov_b32 v7, v6
  s_nop 1
  v_permlane32_swap_b32 v7, v6
  v_max_f32 v6, v6, v7
  v_mov_b32 v7, v6
  s_nop 1
  v_permlane16_swap_b32 v7, v6
  v_max_f32 v6, v6, v7
  v_add_f32 v6, 0x41800000, v6
  v_max_f32 v6, 0, v6
  v_exp_f32 v7, -v6
  v_sub_f32 v104, v104, v6
  v_sub_f32 v105, v105, v6
  v_sub_f32 v106, v106, v6
  v_sub_f32 v107, v107, v6
  v_sub_f32 v108, v108, v6
  v_sub_f32 v109, v109, v6
  v_sub_f32 v110, v110, v6
  v_sub_f32 v111, v111, v6
  v_mul_f32 v160, v160, v7
  v_mul_f32 v161, v161, v7
  v_mul_f32 v162, v162, v7
  v_mul_f32 v163, v163, v7
  v_mul_f32 v164, v164, v7
  v_mul_f32 v165, v165, v7
  v_mul_f32 v166, v166, v7
  v_mul_f32 v167, v167, v7
  v_mul_f32 v168, v168, v7
  v_mul_f32 v169, v169, v7
  v_mul_f32 v170, v170, v7
  v_mul_f32 v171, v171, v7
  v_mul_f32 v172, v172, v7
  v_mul_f32 v173, v173, v7
  v_mul_f32 v174, v174, v7
  v_mul_f32 v175, v175, v7
  v_mul_f32 v176, v176, v7
  v_mul_f32 v177, v177, v7
  v_mul_f32 v178, v178, v7
  v_mul_f32 v179, v179, v7
  v_mul_f32 v180, v180, v7
  v_mul_f32 v181, v181, v7
  v_mul_f32 v182, v182, v7
  v_mul_f32 v183, v183, v7
  v_mul_f32 v184, v184, v7
  v_mul_f32 v185, v185, v7
  v_mul_f32 v186, v186, v7
  v_mul_f32 v187, v187, v7
  v_mul_f32 v188, v188, v7
  v_mul_f32 v189, v189, v7
  v_mul_f32 v190, v190, v7
  v_mul_f32 v191, v191, v7
  v_accvgpr_read_b32 v8, a132
  v_mul_f32 v8, v8, v7
  v_accvgpr_write_b32 a132, v8
  v_accvgpr_read_b32 v8, a133
  v_mul_f32 v8, v8, v7
  v_accvgpr_write_b32 a133, v8
  v_accvgpr_read_b32 v8, a134
  v_mul_f32 v8, v8, v7
  v_accvgpr_write_b32 a134, v8
  v_accvgpr_read_b32 v8, a135
  v_mul_f32 v8, v8, v7
  v_accvgpr_write_b32 a135, v8
  v_sub_f32 v8, v40, v6
  v_sub_f32 v9, v41, v6
  v_sub_f32 v10, v42, v6
  v_sub_f32 v11, v43, v6
  v_sub_f32 v12, v44, v6
  v_sub_f32 v13, v45, v6
  v_sub_f32 v14, v46, v6
  v_sub_f32 v15, v47, v6
  v_exp_f32 v8, v8
  v_exp_f32 v9, v9
  v_exp_f32 v10, v10
  v_exp_f32 v11, v11
  v_exp_f32 v12, v12
  v_exp_f32 v13, v13
  v_exp_f32 v14, v14
  v_exp_f32 v15, v15
  v_cvt_pk_bf16_f32 v84, v8, v9
  v_cvt_pk_bf16_f32 v85, v10, v11
  v_cvt_pk_bf16_f32 v86, v12, v13
  v_cvt_pk_bf16_f32 v87, v14, v15
L_a_slow1_2:
  v_max3_f32 v6, v48, v49, v50
  v_max3_f32 v7, v51, v52, v53
  v_max3_f32 v6, v6, v54, v55
  v_max_f32 v6, v6, v7
  v_mov_b32 v7, v6
  s_nop 1
  v_permlane32_swap_b32 v7, v6
  v_max_f32 v6, v6, v7
  v_mov_b32 v7, v6
  s_nop 1
  v_permlane16_swap_b32 v7, v6
  v_max_f32 v6, v6, v7
  v_add_f32 v6, 0x41800000, v6
  v_max_f32 v6, 0, v6
  v_exp_f32 v7, -v6
  v_sub_f32 v112, v112, v6
  v_sub_f32 v113, v113, v6
  v_sub_f32 v114, v114, v6
  v_sub_f32 v115, v115, v6
  v_sub_f32 v116, v116, v6
  v_sub_f32 v117, v117, v6
  v_sub_f32 v118, v118, v6
  v_sub_f32 v119, v119, v6
  v_mul_f32 v192, v192, v7
  v_mul_f32 v193, v193, v7
  v_mul_f32 v194, v194, v7
  v_mul_f32 v195, v195, v7
  v_mul_f32 v196, v196, v7
  v_mul_f32 v197, v197, v7
  v_mul_f32 v198, v198, v7
  v_mul_f32 v199, v199, v7
  v_mul_f32 v200, v200, v7
  v_mul_f32 v201, v201, v7
  v_mul_f32 v202, v202, v7
  v_mul_f32 v203, v203, v7
  v_mul_f32 v204, v204, v7
  v_mul_f32 v205, v205, v7
  v_mul_f32 v206, v206, v7
  v_mul_f32 v207, v207, v7
  v_mul_f32 v208, v208, v7
  v_mul_f32 v209, v209, v7
  v_mul_f32 v210, v210, v7
  v_mul_f32 v211, v211, v7
  v_mul_f32 v212, v212, v7
  v_mul_f32 v213, v213, v7
  v_mul_f32 v214, v214, v7
  v_mul_f32 v215, v215, v7
  v_mul_f32 v216, v216, v7
  v_mul_f32 v217, v217, v7
  v_mul_f32 v218, v218, v7
  v_mul_f32 v219, v219, v7
  v_mul_f32 v220, v220, v7
  v_mul_f32 v221, v221, v7
  v_mul_f32 v222, v222, v7
  v_mul_f32 v223, v223, v7
  v_accvgpr_read_b32 v8, a136
  v_mul_f32 v8, v8, v7
  v_accvgpr_write_b32 a136, v8
  v_accvgpr_read_b32 v8, a137
  v_mul_f32 v8, v8, v7
  v_accvgpr_write_b32 a137, v8
  v_accvgpr_read_b32 v8, a138
  v_mul_f32 v8, v8, v7
  v_accvgpr_write_b32 a138, v8
  v_accvgpr_read_b32 v8, a139
  v_mul_f32 v8, v8, v7
  v_accvgpr_write_b32 a139, v8
  v_sub_f32 v8, v48, v6
  v_sub_f32 v9, v49, v6
  v_sub_f32 v10, v50, v6
  v_sub_f32 v11, v51, v6
  v_sub_f32 v12, v52, v6
  v_sub_f32 v13, v53, v6
  v_sub_f32 v14, v54, v6
  v_sub_f32 v15, v55, v6
  v_exp_f32 v8, v8
  v_exp_f32 v9, v9
  v_exp_f32 v10, v10
  v_exp_f32 v11, v11
  v_exp_f32 v12, v12
  v_exp_f32 v13, v13
  v_exp_f32 v14, v14
  v_exp_f32 v15, v15
  v_cvt_pk_bf16_f32 v88, v8, v9
  v_cvt_pk_bf16_f32 v89, v10, v11
  v_cvt_pk_bf16_f32 v90, v12, v13
  v_cvt_pk_bf16_f32 v91, v14, v15
L_a_slow1_3:
  v_max3_f32 v6, v56, v57, v58
  v_max3_f32 v7, v59, v60, v61
  v_max3_f32 v6, v6, v62, v63
  v_max_f32 v6, v6, v7
  v_mov_b32 v7, v6
  s_nop 1
  v_permlane32_swap_b32 v7, v6
  v_max_f32 v6, v6, v7
  v_mov_b32 v7, v6
  s_nop 1
  v_permlane16_swap_b32 v7, v6
  v_max_f32 v6, v6, v7
  v_add_f32 v6, 0x41800000, v6
  v_max_f32 v6, 0, v6
  v_exp_f32 v7, -v6
  v_sub_f32 v120, v120, v6
  v_sub_f32 v121, v121, v6
  v_sub_f32 v122, v122, v6
  v_sub_f32 v123, v123, v6
  v_sub_f32 v124, v124, v6
  v_sub_f32 v125, v125, v6
  v_sub_f32 v126, v126, v6
  v_sub_f32 v127, v127, v6
  v_mul_f32 v224, v224, v7
  v_mul_f32 v225, v225, v7
  v_mul_f32 v226, v226, v7
  v_mul_f32 v227, v227, v7
  v_mul_f32 v228, v228, v7
  v_mul_f32 v229, v229, v7
  v_mul_f32 v230, v230, v7
  v_mul_f32 v231, v231, v7
  v_mul_f32 v232, v232, v7
  v_mul_f32 v233, v233, v7
  v_mul_f32 v234, v234, v7
  v_mul_f32 v235, v235, v7
  v_mul_f32 v236, v236, v7
  v_mul_f32 v237, v237, v7
  v_mul_f32 v238, v238, v7
  v_mul_f32 v239, v239, v7
  v_mul_f32 v240, v240, v7
  v_mul_f32 v241, v241, v7
  v_mul_f32 v242, v242, v7
  v_mul_f32 v243, v243, v7
  v_mul_f32 v244, v244, v7
  v_mul_f32 v245, v245, v7
  v_mul_f32 v246, v246, v7
  v_mul_f32 v247, v247, v7
  v_mul_f32 v248, v248, v7
  v_mul_f32 v249, v249, v7
  v_mul_f32 v250, v250, v7
  v_mul_f32 v251, v251, v7
  v_mul_f32 v252, v252, v7
  v_mul_f32 v253, v253, v7
  v_mul_f32 v254, v254, v7
  v_mul_f32 v255, v255, v7
  v_accvgpr_read_b32 v8, a140
  v_mul_f32 v8, v8, v7
  v_accvgpr_write_b32 a140, v8
  v_accvgpr_read_b32 v8, a141
  v_mul_f32 v8, v8, v7
  v_accvgpr_write_b32 a141, v8
  v_accvgpr_read_b32 v8, a142
  v_mul_f32 v8, v8, v7
  v_accvgpr_write_b32 a142, v8
  v_accvgpr_read_b32 v8, a143
  v_mul_f32 v8, v8, v7
  v_accvgpr_write_b32 a143, v8
  v_sub_f32 v8, v56, v6
  v_sub_f32 v9, v57, v6
  v_sub_f32 v10, v58, v6
  v_sub_f32 v11, v59, v6
  v_sub_f32 v12, v60, v6
  v_sub_f32 v13, v61, v6
  v_sub_f32 v14, v62, v6
  v_sub_f32 v15, v63, v6
  v_exp_f32 v8, v8
  v_exp_f32 v9, v9
  v_exp_f32 v10, v10
  v_exp_f32 v11, v11
  v_exp_f32 v12, v12
  v_exp_f32 v13, v13
  v_exp_f32 v14, v14
  v_exp_f32 v15, v15
  v_cvt_pk_bf16_f32 v92, v8, v9
  v_cvt_pk_bf16_f32 v93, v10, v11
  v_cvt_pk_bf16_f32 v94, v12, v13
  v_cvt_pk_bf16_f32 v95, v14, v15
  s_cmp_eq_u32 s71, 1
  s_cbranch_scc1 L_a_s0_r
  s_cmp_eq_u32 s71, 3
  s_cbranch_scc1 L_a_d1_r
  s_cmp_eq_u32 s71, 5
  s_cbranch_scc1 L_a_d3_r
  s_cmp_eq_u32 s71, 7
  s_cbranch_scc1 L_a_d5_r
  s_branch L_a_d7_r
L_att_end:
  s_branch L_next
L_go_outx:
  s_bfe_u32 s56, s3, 0x40004
  s_bfe_u32 s62, s3, 0x10004
  s_bitcmp1_b32 s3, 3
  s_cbranch_scc1 L_red
L_barr:
  s_mov_b32 s48, s30
  s_and_b32 s49, s31, 0xffff
  s_mov_b32 s50, 0x400000
  s_mov_b32 s51, 0x20000
  v_lshlrev_b32 v2, 4, v0
  v_mov_b32 v7, 0
  s_mov_b32 s57, 0
  v_lshrrev_b32 v3, 4, v0
  v_and_b32 v4, 15, v0
  v_lshlrev_b32 v5, 1, v3
  v_xor_b32 v5, v5, v4
  v_lshlrev_b32 v5, 4, v5
  v_lshl_add_u32 v88, v3, 10, v5
  v_xor_b32 v89, 128, v88
  s_lshl_b32 s66, s44, 15
  s_lshl_b32 s60, s56, 18
  s_lshl_b32 s58, s44, 8
  s_add_u32 s60, s60, s58
  s_add_u32 m0, s66, 0
  s_add_u32 s58, s60, 0
  buffer_load_dwordx4 v88, s[48:51], s58 offen lds
  s_add_u32 m0, s66, 1024
  s_add_u32 s58, s60, 4096
  buffer_load_dwordx4 v89, s[48:51], s58 offen lds
  s_add_u32 m0, s66, 2048
  s_add_u32 s58, s60, 8192
  buffer_load_dwordx4 v88, s[48:51], s58 offen lds
  s_add_u32 m0, s66, 3072
  s_add_u32 s58, s60, 12288
  buffer_load_dwordx4 v89, s[48:51], s58 offen lds
  s_add_u32 m0, s66, 4096
  s_add_u32 s58, s60, 16384
  buffer_load_dwordx4 v88, s[48:51], s58 offen lds
  s_add_u32 m0, s66, 5120
  s_add_u32 s58, s60, 20480
  buffer_load_dwordx4 v89, s[48:51], s58 offen lds
  s_add_u32 m0, s66, 6144
  s_add_u32 s58, s60, 24576
  buffer_load_dwordx4 v88, s[48:51], s58 offen lds
  s_add_u32 m0, s66, 7168
  s_add_u32 s58, s60, 28672
  buffer_load_dwordx4 v89, s[48:51], s58 offen lds
  s_add_u32 m0, s66, 8192
  s_add_u32 s58, s60, 32768
  buffer_load_dwordx4 v88, s[48:51], s58 offen lds
  s_add_u32 m0, s66, 9216
  s_add_u32 s58, s60, 36864
  buffer_load_dwordx4 v89, s[48:51], s58 offen lds
  s_add_u32 m0, s66, 10240
  s_add_u32 s58, s60, 40960
  buffer_load_dwordx4 v88, s[48:51], s58 offen lds
  s_add_u32 m0, s66, 11264
  s_add_u32 s58, s60, 45056
  buffer_load_dwordx4 v89, s[48:51], s58 offen lds
  s_add_u32 m0, s66, 12288
  s_add_u32 s58, s60, 49152
  buffer_load_dwordx4 v88, s[48:51], s58 offen lds
  s_add_u32 m0, s66, 13312
  s_add_u32 s58, s60, 53248
  buffer_load_dwordx4 v89, s[48:51], s58 offen lds
  s_add_u32 m0, s66, 14336
  s_add_u32 s58, s60, 57344
  buffer_load_dwordx4 v88, s[48:51], s58 offen lds
  s_add_u32 m0, s66, 15360
  s_add_u32 s58, s60, 61440
  buffer_load_dwordx4 v89, s[48:51], s58 offen lds
  s_add_u32 m0, s66, 16384
  s_add_u32 s58, s60, 65536
  buffer_load_dwordx4 v88, s[48:51], s58 offen lds
  s_add_u32 m0, s66, 17408
  s_add_u32 s58, s60, 69632
  buffer_load_dwordx4 v89, s[48:51], s58 offen lds
  s_add_u32 m0, s66, 18432
  s_add_u32 s58, s60, 73728
  buffer_load_dwordx4 v88, s[48:51], s58 offen lds
  s_add_u32 m0, s66, 19456
  s_add_u32 s58, s60, 77824
  buffer_load_dwordx4 v89, s[48:51], s58 offen lds
  s_add_u32 m0, s66, 20480
  s_add_u32 s58, s60, 81920
  buffer_load_dwordx4 v88, s[48:51], s58 offen lds
  s_add_u32 m0, s66, 21504
  s_add_u32 s58, s60, 86016
  buffer_load_dwordx4 v89, s[48:51], s58 offen lds
  s_add_u32 m0, s66, 22528
  s_add_u32 s58, s60, 90112
  buffer_load_dwordx4 v88, s[48:51], s58 offen lds
  s_add_u32 m0, s66, 23552
  s_add_u32 s58, s60, 94208
  buffer_load_dwordx4 v89, s[48:51], s58 offen lds
  s_add_u32 m0, s66, 24576
  s_add_u32 s58, s60, 98304
  buffer_load_dwordx4 v88, s[48:51], s58 offen lds
  s_add_u32 m0, s66, 25600
  s_add_u32 s58, s60, 102400
  buffer_load_dwordx4 v89, s[48:51], s58 offen lds
  s_add_u32 m0, s66, 26624
  s_add_u32 s58, s60, 106496
  buffer_load_dwordx4 v88, s[48:51], s58 offen lds
  s_add_u32 m0, s66, 27648
  s_add_u32 s58, s60, 110592
  buffer_load_dwordx4 v89, s[48:51], s58 offen lds
  s_add_u32 m0, s66, 28672
  s_add_u32 s58, s60, 114688
  buffer_load_dwordx4 v88, s[48:51], s58 offen lds
  s_add_u32 m0, s66, 29696
  s_add_u32 s58, s60, 118784
  buffer_load_dwordx4 v89, s[48:51], s58 offen lds
  s_add_u32 m0, s66, 30720
  s_add_u32 s58, s60, 122880
  buffer_load_dwordx4 v88, s[48:51], s58 offen lds
  s_add_u32 m0, s66, 31744
  s_add_u32 s58, s60, 126976
  buffer_load_dwordx4 v89, s[48:51], s58 offen lds
  v_lshrrev_b32 v5, 2, v0
  v_lshl_add_u32 v104, v5, 8, s66
  v_and_b32 v5, 7, v5
  v_lshl_add_u32 v104, v5, 5, v104
  v_and_b32 v5, 3, v0
  v_lshl_add_u32 v104, v5, 3, v104
  v_xor_b32 v105, 32, v104
  v_xor_b32 v106, 64, v104
  v_xor_b32 v107, 96, v104
  v_xor_b32 v108, 128, v104
  v_xor_b32 v109, 160, v104
  v_xor_b32 v110, 192, v104
  v_xor_b32 v111, 224, v104
  s_waitcnt vmcnt(24)
  ds_read_b64_tr_b16 a[0:1], v104 offset:0
  ds_read_b64_tr_b16 a[2:3], v104 offset:4096
  ds_read_b64_tr_b16 a[32:33], v105 offset:0
  ds_read_b64_tr_b16 a[34:35], v105 offset:4096
  ds_read_b64_tr_b16 a[64:65], v106 offset:0
  ds_read_b64_tr_b16 a[66:67], v106 offset:4096
  ds_read_b64_tr_b16 a[96:97], v107 offset:0
  ds_read_b64_tr_b16 a[98:99], v107 offset:4096
  ds_read_b64_tr_b16 a[128:129], v108 offset:0
  ds_read_b64_tr_b16 a[130:131], v108 offset:4096
  ds_read_b64_tr_b16 a[160:161], v109 offset:0
  ds_read_b64_tr_b16 a[162:163], v109 offset:4096
  ds_read_b64_tr_b16 a[192:193], v110 offset:0
  ds_read_b64_tr_b16 a[194:195], v110 offset:4096
  ds_read_b64_tr_b16 a[224:225], v111 offset:0
  ds_read_b64_tr_b16 a[226:227], v111 offset:4096
  s_waitcnt vmcnt(16)
  ds_read_b64_tr_b16 a[4:5], v104 offset:8192
  ds_read_b64_tr_b16 a[6:7], v104 offset:12288
  ds_read_b64_tr_b16 a[36:37], v105 offset:8192
  ds_read_b64_tr_b16 a[38:39], v105 offset:12288
  ds_read_b64_tr_b16 a[68:69], v106 offset:8192
  ds_read_b64_tr_b16 a[70:71], v106 offset:12288
  ds_read_b64_tr_b16 a[100:101], v107 offset:8192
  ds_read_b64_tr_b16 a[102:103], v107 offset:12288
  ds_read_b64_tr_b16 a[132:133], v108 offset:8192
  ds_read_b64_tr_b16 a[134:135], v108 offset:12288
  ds_read_b64_tr_b16 a[164:165], v109 offset:8192
  ds_read_b64_tr_b16 a[166:167], v109 offset:12288
  ds_read_b64_tr_b16 a[196:197], v110 offset:8192
  ds_read_b64_tr_b16 a[198:199], v110 offset:12288
  ds_read_b64_tr_b16 a[228:229], v111 offset:8192
  ds_read_b64_tr_b16 a[230:231], v111 offset:12288
  s_waitcnt vmcnt(8)
  ds_read_b64_tr_b16 a[8:9], v104 offset:16384
  ds_read_b64_tr_b16 a[10:11], v104 offset:20480
  ds_read_b64_tr_b16 a[40:41], v105 offset:16384
  ds_read_b64_tr_b16 a[42:43], v105 offset:20480
  ds_read_b64_tr_b16 a[72:73], v106 offset:16384
  ds_read_b64_tr_b16 a[74:75], v106 offset:20480
  ds_read_b64_tr_b16 a[104:105], v107 offset:16384
  ds_read_b64_tr_b16 a[106:107], v107 offset:20480
  ds_read_b64_tr_b16 a[136:137], v108 offset:16384
  ds_read_b64_tr_b16 a[138:139], v108 offset:20480
  ds_read_b64_tr_b16 a[168:169], v109 offset:16384
  ds_read_b64_tr_b16 a[170:171], v109 offset:20480
  ds_read_b64_tr_b16 a[200:201], v110 offset:16384
  ds_read_b64_tr_b16 a[202:203], v110 offset:20480
  ds_read_b64_tr_b16 a[232:233], v111 offset:16384
  ds_read_b64_tr_b16 a[234:235], v111 offset:20480
  s_waitcnt vmcnt(0)
  ds_read_b64_tr_b16 a[12:13], v104 offset:24576
  ds_read_b64_tr_b16 a[14:15], v104 offset:28672
  ds_read_b64_tr_b16 a[44:45], v105 offset:24576
  ds_read_b64_tr_b16 a[46:47], v105 offset:28672
  ds_read_b64_tr_b16 a[76:77], v106 offset:24576
  ds_read_b64_tr_b16 a[78:79], v106 offset:28672
  ds_read_b64_tr_b16 a[108:109], v107 offset:24576
  ds_read_b64_tr_b16 a[110:111], v107 offset:28672
  ds_read_b64_tr_b16 a[140:141], v108 offset:24576
  ds_read_b64_tr_b16 a[142:143], v108 offset:28672
  ds_read_b64_tr_b16 a[172:173], v109 offset:24576
  ds_read_b64_tr_b16 a[174:175], v109 offset:28672
  ds_read_b64_tr_b16 a[204:205], v110 offset:24576
  ds_read_b64_tr_b16 a[206:207], v110 offset:28672
  ds_read_b64_tr_b16 a[236:237], v111 offset:24576
  ds_read_b64_tr_b16 a[238:239], v111 offset:28672
  s_waitcnt lgkmcnt(0)
  s_add_u32 m0, s66, 0
  s_add_u32 s58, s60, 131072
  buffer_load_dwordx4 v88, s[48:51], s58 offen lds
  s_add_u32 m0, s66, 1024
  s_add_u32 s58, s60, 135168
  buffer_load_dwordx4 v89, s[48:51], s58 offen lds
  s_add_u32 m0, s66, 2048
  s_add_u32 s58, s60, 139264
  buffer_load_dwordx4 v88, s[48:51], s58 offen lds
  s_add_u32 m0, s66, 3072
  s_add_u32 s58, s60, 143360
  buffer_load_dwordx4 v89, s[48:51], s58 offen lds
  s_add_u32 m0, s66, 4096
  s_add_u32 s58, s60, 147456
  buffer_load_dwordx4 v88, s[48:51], s58 offen lds
  s_add_u32 m0, s66, 5120
  s_add_u32 s58, s60, 151552
  buffer_load_dwordx4 v89, s[48:51], s58 offen lds
  s_add_u32 m0, s66, 6144
  s_add_u32 s58, s60, 155648
  buffer_load_dwordx4 v88, s[48:51], s58 offen lds
  s_add_u32 m0, s66, 7168
  s_add_u32 s58, s60, 159744
  buffer_load_dwordx4 v89, s[48:51], s58 offen lds
  s_add_u32 m0, s66, 8192
  s_add_u32 s58, s60, 163840
  buffer_load_dwordx4 v88, s[48:51], s58 offen lds
  s_add_u32 m0, s66, 9216
  s_add_u32 s58, s60, 167936
  buffer_load_dwordx4 v89, s[48:51], s58 offen lds
  s_add_u32 m0, s66, 10240
  s_add_u32 s58, s60, 172032
  buffer_load_dwordx4 v88, s[48:51], s58 offen lds
  s_add_u32 m0, s66, 11264
  s_add_u32 s58, s60, 176128
  buffer_load_dwordx4 v89, s[48:51], s58 offen lds
  s_add_u32 m0, s66, 12288
  s_add_u32 s58, s60, 180224
  buffer_load_dwordx4 v88, s[48:51], s58 offen lds
  s_add_u32 m0, s66, 13312
  s_add_u32 s58, s60, 184320
  buffer_load_dwordx4 v89, s[48:51], s58 offen lds
  s_add_u32 m0, s66, 14336
  s_add_u32 s58, s60, 188416
  buffer_load_dwordx4 v88, s[48:51], s58 offen lds
  s_add_u32 m0, s66, 15360
  s_add_u32 s58, s60, 192512
  buffer_load_dwordx4 v89, s[48:51], s58 offen lds
  s_add_u32 m0, s66, 16384
  s_add_u32 s58, s60, 196608
  buffer_load_dwordx4 v88, s[48:51], s58 offen lds
  s_add_u32 m0, s66, 17408
  s_add_u32 s58, s60, 200704
  buffer_load_dwordx4 v89, s[48:51], s58 offen lds
  s_add_u32 m0, s66, 18432
  s_add_u32 s58, s60, 204800
  buffer_load_dwordx4 v88, s[48:51], s58 offen lds
  s_add_u32 m0, s66, 19456
  s_add_u32 s58, s60, 208896
  buffer_load_dwordx4 v89, s[48:51], s58 offen lds
  s_add_u32 m0, s66, 20480
  s_add_u32 s58, s60, 212992
  buffer_load_dwordx4 v88, s[48:51], s58 offen lds
  s_add_u32 m0, s66, 21504
  s_add_u32 s58, s60, 217088
  buffer_load_dwordx4 v89, s[48:51], s58 offen lds
  s_add_u32 m0, s66, 22528
  s_add_u32 s58, s60, 221184
  buffer_load_dwordx4 v88, s[48:51], s58 offen lds
  s_add_u32 m0, s66, 23552
  s_add_u32 s58, s60, 225280
  buffer_load_dwordx4 v89, s[48:51], s58 offen lds
  s_add_u32 m0, s66, 24576
  s_add_u32 s58, s60, 229376
  buffer_load_dwordx4 v88, s[48:51], s58 offen lds
  s_add_u32 m0, s66, 25600
  s_add_u32 s58, s60, 233472
  buffer_load_dwordx4 v89, s[48:51], s58 offen lds
  s_add_u32 m0, s66, 26624
  s_add_u32 s58, s60, 237568
  buffer_load_dwordx4 v88, s[48:51], s58 offen lds
  s_add_u32 m0, s66, 27648
  s_add_u32 s58, s60, 241664
  buffer_load_dwordx4 v89, s[48:51], s58 offen lds
  s_add_u32 m0, s66, 28672
  s_add_u32 s58, s60, 245760
  buffer_load_dwordx4 v88, s[48:51], s58 offen lds
  s_add_u32 m0, s66, 29696
  s_add_u32 s58, s60, 249856
  buffer_load_dwordx4 v89, s[48:51], s58 offen lds
  s_add_u32 m0, s66, 30720
  s_add_u32 s58, s60, 253952
  buffer_load_dwordx4 v88, s[48:51], s58 offen lds
  s_add_u32 m0, s66, 31744
  s_add_u32 s58, s60, 258048
  buffer_load_dwordx4 v89, s[48:51], s58 offen lds
  s_lshr_b32 s58, s44, 1
  s_lshl1_add_u32 s61, s56, s58
  s_and_b32 s59, s44, 1
  s_lshl_b32 s60, s44, 12
  s_add_u32 s60, s60, 131072
  v_bfe_u32 v6, v0, 3, 1
  v_lshl_add_u32 v8, v6, 8, s60
  v_lshl_add_u32 v8, v3, 6, v8
  v_and_b32 v6, 7, v0
  v_lshl_add_u32 v8, v6, 3, v8
  v_lshrrev_b32 v6, 5, v0
  v_lshl_add_u32 v9, v6, 8, s60
  v_and_b32 v6, 3, v0
  v_lshl_add_u32 v9, v6, 6, v9
  v_bfe_u32 v6, v0, 2, 3
  v_lshl_add_u32 v9, v6, 3, v9
  s_mul_i32 s60, s58, 24576
  v_add_u32 v12, s60, v2
  s_lshl_b32 s66, s59, 12
  s_lshl_b32 s67, s61, 19
  s_add_u32 s67, s67, s66
  s_add_u32 s67, s67, 0x3000000
  s_add_u32 s66, s66, s60
  s_lshl1_add_u32 s60, s59, s58
  s_lshl_b32 s60, s60, 12
  s_add_u32 s60, s60, 98304
  v_add_u32 v13, s60, v2
  v_add_u32 v14, 98304, v2
  s_lshl_b32 s60, s59, 4
  v_add_u32 v4, s60, v4
  v_lshlrev_b32 v31, 2, v4
  v_add_u32 v31, 0xd0c0000, v31
  v_lshlrev_b32 v3, 2, v3
  v_sub_u32 v4, v4, v3
  v_mov_b32 v6, 0xff800000
  s_lshl_b32 s68, s61, 7
  s_add_u32 s73, s68, 0xd081000
  s_add_u32 s68, s68, 0xd084000
  s_lshl_b32 s69, s61, 12
  s_add_u32 s69, s69, 0xc020000
  s_lshl2_add_u32 s70, s56, s44
  s_lshl_b32 s70, s70, 12
  s_add_u32 s70, s70, 0x6080000
  s_cmp_eq_u32 s44, 0
  s_mov_b32 s72, 0x40000000
  s_cmov_b32 s72, 0xd087000
  v_cmp_gt_i32 vcc, 0, v4
  v_mov_b32 v16, 0x3f803f80
  s_nop 0
  v_cndmask_b32 v20, 0, v6, vcc
  v_cmp_gt_i32 vcc, 1, v4
  v_mov_b32 v17, 0x3f803f80
  s_nop 0
  v_cndmask_b32 v21, 0, v6, vcc
  v_cmp_gt_i32 vcc, 2, v4
  v_mov_b32 v18, 0x3f803f80
  s_nop 0
  v_cndmask_b32 v22, 0, v6, vcc
  v_cmp_gt_i32 vcc, 3, v4
  v_mov_b32 v19, 0x3f803f80
  s_nop 0
  v_cndmask_b32 v23, 0, v6, vcc
  v_cmp_gt_i32 vcc, 16, v4
  v_mov_b32 v16, 0x3f803f80
  s_nop 0
  v_cndmask_b32 v24, 0, v6, vcc
  v_cmp_gt_i32 vcc, 17, v4
  v_mov_b32 v17, 0x3f803f80
  s_nop 0
  v_cndmask_b32 v25, 0, v6, vcc
  v_cmp_gt_i32 vcc, 18, v4
  v_mov_b32 v18, 0x3f803f80
  s_nop 0
  v_cndmask_b32 v26, 0, v6, vcc
  v_cmp_gt_i32 vcc, 19, v4
  v_mov_b32 v19, 0x3f803f80
  s_nop 0
  v_cndmask_b32 v27, 0, v6, vcc
  v_mov_b32 v33, 0
  v_mov_b32 v34, 0
  s_waitcnt vmcnt(24)
  ds_read_b64_tr_b16 a[16:17], v104 offset:0
  ds_read_b64_tr_b16 a[18:19], v104 offset:4096
  ds_read_b64_tr_b16 a[48:49], v105 offset:0
  ds_read_b64_tr_b16 a[50:51], v105 offset:4096
  ds_read_b64_tr_b16 a[80:81], v106 offset:0
  ds_read_b64_tr_b16 a[82:83], v106 offset:4096
  ds_read_b64_tr_b16 a[112:113], v107 offset:0
  ds_read_b64_tr_b16 a[114:115], v107 offset:4096
  ds_read_b64_tr_b16 a[144:145], v108 offset:0
  ds_read_b64_tr_b16 a[146:147], v108 offset:4096
  ds_read_b64_tr_b16 a[176:177], v109 offset:0
  ds_read_b64_tr_b16 a[178:179], v109 offset:4096
  ds_read_b64_tr_b16 a[208:209], v110 offset:0
  ds_read_b64_tr_b16 a[210:211], v110 offset:4096
  ds_read_b64_tr_b16 a[240:241], v111 offset:0
  ds_read_b64_tr_b16 a[242:243], v111 offset:4096
  s_waitcnt vmcnt(16)
  ds_read_b64_tr_b16 a[20:21], v104 offset:8192
  ds_read_b64_tr_b16 a[22:23], v104 offset:12288
  ds_read_b64_tr_b16 a[52:53], v105 offset:8192
  ds_read_b64_tr_b16 a[54:55], v105 offset:12288
  ds_read_b64_tr_b16 a[84:85], v106 offset:8192
  ds_read_b64_tr_b16 a[86:87], v106 offset:12288
  ds_read_b64_tr_b16 a[116:117], v107 offset:8192
  ds_read_b64_tr_b16 a[118:119], v107 offset:12288
  ds_read_b64_tr_b16 a[148:149], v108 offset:8192
  ds_read_b64_tr_b16 a[150:151], v108 offset:12288
  ds_read_b64_tr_b16 a[180:181], v109 offset:8192
  ds_read_b64_tr_b16 a[182:183], v109 offset:12288
  ds_read_b64_tr_b16 a[212:213], v110 offset:8192
  ds_read_b64_tr_b16 a[214:215], v110 offset:12288
  ds_read_b64_tr_b16 a[244:245], v111 offset:8192
  ds_read_b64_tr_b16 a[246:247], v111 offset:12288
  s_waitcnt vmcnt(8)
  ds_read_b64_tr_b16 a[24:25], v104 offset:16384
  ds_read_b64_tr_b16 a[26:27], v104 offset:20480
  ds_read_b64_tr_b16 a[56:57], v105 offset:16384
  ds_read_b64_tr_b16 a[58:59], v105 offset:20480
  ds_read_b64_tr_b16 a[88:89], v106 offset:16384
  ds_read_b64_tr_b16 a[90:91], v106 offset:20480
  ds_read_b64_tr_b16 a[120:121], v107 offset:16384
  ds_read_b64_tr_b16 a[122:123], v107 offset:20480
  ds_read_b64_tr_b16 a[152:153], v108 offset:16384
  ds_read_b64_tr_b16 a[154:155], v108 offset:20480
  ds_read_b64_tr_b16 a[184:185], v109 offset:16384
  ds_read_b64_tr_b16 a[186:187], v109 offset:20480
  ds_read_b64_tr_b16 a[216:217], v110 offset:16384
  ds_read_b64_tr_b16 a[218:219], v110 offset:20480
  ds_read_b64_tr_b16 a[248:249], v111 offset:16384
  ds_read_b64_tr_b16 a[250:251], v111 offset:20480
  s_waitcnt vmcnt(0)
  ds_read_b64_tr_b16 a[28:29], v104 offset:24576
  ds_read_b64_tr_b16 a[30:31], v104 offset:28672
  ds_read_b64_tr_b16 a[60:61], v105 offset:24576
  ds_read_b64_tr_b16 a[62:63], v105 offset:28672
  ds_read_b64_tr_b16 a[92:93], v106 offset:24576
  ds_read_b64_tr_b16 a[94:95], v106 offset:28672
  ds_read_b64_tr_b16 a[124:125], v107 offset:24576
  ds_read_b64_tr_b16 a[126:127], v107 offset:28672
  ds_read_b64_tr_b16 a[156:157], v108 offset:24576
  ds_read_b64_tr_b16 a[158:159], v108 offset:28672
  ds_read_b64_tr_b16 a[188:189], v109 offset:24576
  ds_read_b64_tr_b16 a[190:191], v109 offset:28672
  ds_read_b64_tr_b16 a[220:221], v110 offset:24576
  ds_read_b64_tr_b16 a[222:223], v110 offset:28672
  ds_read_b64_tr_b16 a[252:253], v111 offset:24576
  ds_read_b64_tr_b16 a[254:255], v111 offset:28672
  s_waitcnt lgkmcnt(0)
  s_lshl_b32 s58, s61, 7
  s_add_u32 s58, s58, 0xd080010
  v_lshl_add_u32 v3, v0, 2, s58
  v_and_b32 v4, 7, v0
  v_lshlrev_b32 v4, 7, v4
  v_add_u32 v4, 0xd086400, v4
  v_cmp_gt_u32 vcc, 2, v0
  v_mov_b32 v249, 0
  s_nop 0
  v_cndmask_b32 v3, v4, v3, vcc
  v_cndmask_b32 v4, 16, 32, vcc
L_b_w0:
  buffer_load_dword v5, v3, s[40:43], 0 offen sc1
  s_add_u32 s57, s57, 1
  s_cmp_gt_u32 s57, 1048576
  s_cbranch_scc1 L_exit
  s_waitcnt vmcnt(0)
  v_cmp_ne_u32 vcc, v4, v5
  s_cbranch_vccnz L_b_w0
  v_readlane_b32 s63, v1, s95
  s_mov_b32 s62, 4
  s_mov_b32 s65, 0
  s_barrier
  s_bitcmp1_b32 s63, 2
  s_cbranch_scc1 L_b_nodma_1
  s_lshr_b32 s59, s63, 4
L_b_nodma_1_c:
  v_cmp_lt_u32 vcc, s59, v249
  s_cbranch_vccnz L_b_nodma_1_go
  buffer_load_dword v249, v7, s[40:43], s73 offen sc1
  s_add_u32 s57, s57, 1
  s_cmp_gt_u32 s57, 1048576
  s_cbranch_scc1 L_exit
  s_waitcnt vmcnt(0)
  s_branch L_b_nodma_1_c
L_b_nodma_1_go:
  s_lshl_b32 s58, s63, 9
  s_add_u32 s58, s58, s67
  s_add_u32 m0, s66, 0
  s_add_u32 s59, s58, 0x0
  buffer_load_dwordx4 v2, s[40:43], s59 offen offset:0 sc1 lds
  buffer_load_dwordx4 v2, s[40:43], s59 offen offset:1024 sc1 lds
  buffer_load_dwordx4 v2, s[40:43], s59 offen offset:2048 sc1 lds
  buffer_load_dwordx4 v2, s[40:43], s59 offen offset:3072 sc1 lds
  s_add_u32 m0, s66, 8192
  s_add_u32 s59, s58, 0x1000000
  buffer_load_dwordx4 v2, s[40:43], s59 offen offset:0 sc1 lds
  buffer_load_dwordx4 v2, s[40:43], s59 offen offset:1024 sc1 lds
  buffer_load_dwordx4 v2, s[40:43], s59 offen offset:2048 sc1 lds
  buffer_load_dwordx4 v2, s[40:43], s59 offen offset:3072 sc1 lds
  s_add_u32 m0, s66, 16384
  s_add_u32 s59, s58, 0x2000000
  buffer_load_dwordx4 v2, s[40:43], s59 offen offset:0 sc1 lds
  buffer_load_dwordx4 v2, s[40:43], s59 offen offset:1024 sc1 lds
  buffer_load_dwordx4 v2, s[40:43], s59 offen offset:2048 sc1 lds
  buffer_load_dwordx4 v2, s[40:43], s59 offen offset:3072 sc1 lds
  s_lshl_b32 s58, s63, 3
  buffer_load_dword v11, v31, s[40:43], s58 offen sc1
L_b_nodma_1:
  s_lshl_b32 s58, s63, 13
  s_add_u32 s58, s58, s69
  buffer_load_dwordx4 v[56:59], v2, s[40:43], s58 offen offset:0 sc1
  buffer_load_dwordx4 v[60:63], v2, s[40:43], s58 offen offset:1024 sc1
  buffer_load_dwordx4 v[64:67], v2, s[40:43], s58 offen offset:2048 sc1
  buffer_load_dwordx4 v[68:71], v2, s[40:43], s58 offen offset:3072 sc1
L_b_round:
  s_mov_b32 s64, s62
  s_mov_b32 s62, s63
  s_add_u32 s95, s95, 1
  v_readlane_b32 s63, v1, s95
  s_cmp_ge_u32 s66, 49152
  s_mov_b32 s60, 49152
  s_cmov_b32 s60, -49152
  s_add_u32 s66, s66, s60
  s_waitcnt vmcnt(0)
  s_barrier
  v_sub_f32 v10, 1.0, v11
  s_and_b32 s59, s44, 1
  s_lshl_b32 s59, s59, 10
  v_add_u32 v4, s59, v12
  ds_read_b128 v[88:91], v4 offset:0
  ds_read_b128 v[104:107], v12 offset:8192
  ds_read_b128 v[108:111], v12 offset:9216
  ds_read_b128 v[92:95], v4 offset:2048
  ds_read_b128 v[112:115], v12 offset:10240
  ds_read_b128 v[116:119], v12 offset:11264
  ds_read_b128 v[96:99], v4 offset:4096
  ds_read_b128 v[120:123], v12 offset:12288
  ds_read_b128 v[124:127], v12 offset:13312
  ds_read_b128 v[100:103], v4 offset:6144
  ds_read_b128 v[128:131], v12 offset:14336
  ds_read_b128 v[132:135], v12 offset:15360
  s_lshl_b32 s58, s64, 2
  s_add_u32 s58, s58, s72
  s_bitcmp1_b32 s64, 2
  s_cselect_b32 s58, 0x40000000, s58
  v_mov_b32 v3, 1
  s_mov_b64 exec, 1
  buffer_atomic_add v3, v7, s[40:43], s58 offen
  s_mov_b64 exec, -1
L_b_chk:
  v_max3_u32 v3, v56, v60, v64
  v_max_u32 v3, v3, v68
  v_cmp_eq_u32 vcc, -1, v3
  s_cbranch_vccnz L_b_late
  ds_write2st64_b32 v8, v56, v57 offset0:0 offset1:8
  ds_write2st64_b32 v8, v60, v61 offset0:2 offset1:10
  ds_write2st64_b32 v8, v64, v65 offset0:4 offset1:12
  ds_write2st64_b32 v8, v68, v69 offset0:6 offset1:14
  s_waitcnt lgkmcnt(4)
  v_mfma_f32_16x16x32_bf16 v[40:43], v[104:107], v[88:91], v[20:23]
  ds_read_b64_tr_b16 v[72:73], v9 offset:0
  v_mfma_f32_16x16x32_bf16 v[44:47], v[108:111], v[88:91], v[24:27]
  ds_read_b64_tr_b16 v[74:75], v9 offset:2048
  v_mfma_f32_16x16x32_bf16 v[40:43], v[112:115], v[92:95], v[40:43]
  ds_read_b64_tr_b16 v[76:77], v9 offset:512
  v_mfma_f32_16x16x32_bf16 v[44:47], v[116:119], v[92:95], v[44:47]
  ds_read_b64_tr_b16 v[78:79], v9 offset:2560
  v_mfma_f32_16x16x32_bf16 v[40:43], v[120:123], v[96:99], v[40:43]
  ds_read_b64_tr_b16 v[80:81], v9 offset:1024
  v_mfma_f32_16x16x32_bf16 v[44:47], v[124:127], v[96:99], v[44:47]
  ds_read_b64_tr_b16 v[82:83], v9 offset:3072
  v_mfma_f32_16x16x32_bf16 v[40:43], v[128:131], v[100:103], v[40:43]
  ds_read_b64_tr_b16 v[84:85], v9 offset:1536
  v_mfma_f32_16x16x32_bf16 v[44:47], v[132:135], v[100:103], v[44:47]
  ds_read_b64_tr_b16 v[86:87], v9 offset:3584
  ds_read_b128 v[136:139], v12 offset:16384
  ds_read_b128 v[140:143], v12 offset:17408
  ds_read_b128 v[144:147], v12 offset:18432
  ds_read_b128 v[148:151], v12 offset:19456
  ds_read_b128 v[152:155], v12 offset:20480
  ds_read_b128 v[156:159], v12 offset:21504
  s_bitcmp1_b32 s63, 2
  s_cbranch_scc1 L_b_nodma_2
  s_lshr_b32 s59, s63, 4
L_b_nodma_2_c:
  v_cmp_lt_u32 vcc, s59, v249
  s_cbranch_vccnz L_b_nodma_2_go
  buffer_load_dword v249, v7, s[40:43], s73 offen sc1
  s_add_u32 s57, s57, 1
  s_cmp_gt_u32 s57, 1048576
  s_cbranch_scc1 L_exit
  s_waitcnt vmcnt(0)
  s_branch L_b_nodma_2_c
L_b_nodma_2_go:
  s_lshl_b32 s58, s63, 9
  s_add_u32 s58, s58, s67
  s_add_u32 m0, s66, 0
  s_add_u32 s59, s58, 0x0
  buffer_load_dwordx4 v2, s[40:43], s59 offen offset:0 sc1 lds
  buffer_load_dwordx4 v2, s[40:43], s59 offen offset:1024 sc1 lds
  buffer_load_dwordx4 v2, s[40:43], s59 offen offset:2048 sc1 lds
  buffer_load_dwordx4 v2, s[40:43], s59 offen offset:3072 sc1 lds
  s_add_u32 m0, s66, 8192
  s_add_u32 s59, s58, 0x1000000
  buffer_load_dwordx4 v2, s[40:43], s59 offen offset:0 sc1 lds
  buffer_load_dwordx4 v2, s[40:43], s59 offen offset:1024 sc1 lds
  buffer_load_dwordx4 v2, s[40:43], s59 offen offset:2048 sc1 lds
  buffer_load_dwordx4 v2, s[40:43], s59 offen offset:3072 sc1 lds
  s_add_u32 m0, s66, 16384
  s_add_u32 s59, s58, 0x2000000
  buffer_load_dwordx4 v2, s[40:43], s59 offen offset:0 sc1 lds
  buffer_load_dwordx4 v2, s[40:43], s59 offen offset:1024 sc1 lds
  buffer_load_dwordx4 v2, s[40:43], s59 offen offset:2048 sc1 lds
  buffer_load_dwordx4 v2, s[40:43], s59 offen offset:3072 sc1 lds
  s_lshl_b32 s58, s63, 3
  buffer_load_dword v11, v31, s[40:43], s58 offen sc1
L_b_nodma_2:
  s_waitcnt lgkmcnt(6)
  v_mfma_f32_16x16x32_bf16 v[48:51], v[72:75], v[88:91], 0
  ds_read_b128 v[160:163], v12 offset:22528
  v_mfma_f32_16x16x32_bf16 v[48:51], v[76:79], v[92:95], v[48:51]
  ds_read_b128 v[164:167], v12 offset:23552
  v_mfma_f32_16x16x32_bf16 v[48:51], v[80:83], v[96:99], v[48:51]
  v_mfma_f32_16x16x32_bf16 v[48:51], v[84:87], v[100:103], v[48:51]
  v_add_u32 v12, s60, v12
  v_max_f32 v3, v40, v41
  v_max3_f32 v3, v3, v42, v43
  v_max3_f32 v3, v3, v44, v45
  v_max3_f32 v3, v3, v46, v47
  s_nop 2
  v_max3_f32 v3, v3, v48, v49
  v_mov_b32 v4, v3
  s_nop 1
  v_permlane32_swap_b32 v4, v3
  v_max_f32 v3, v3, v4
  v_mov_b32 v4, v3
  s_nop 1
  v_permlane16_swap_b32 v4, v3
  v_max_f32 v3, v3, v4
  v_sub_f32 v40, v40, v3
  v_sub_f32 v41, v41, v3
  v_sub_f32 v42, v42, v3
  v_sub_f32 v43, v43, v3
  v_sub_f32 v44, v44, v3
  v_sub_f32 v45, v45, v3
  v_sub_f32 v46, v46, v3
  v_sub_f32 v47, v47, v3
  v_sub_f32 v48, v48, v3
  v_sub_f32 v49, v49, v3
  v_exp_f32 v40, v40
  v_exp_f32 v41, v41
  v_exp_f32 v42, v42
  v_exp_f32 v43, v43
  v_exp_f32 v44, v44
  v_exp_f32 v45, v45
  v_exp_f32 v46, v46
  v_exp_f32 v47, v47
  v_exp_f32 v48, v48
  v_exp_f32 v49, v49
  v_cvt_pk_bf16_f32 v36, v40, v41
  v_cvt_pk_bf16_f32 v37, v42, v43
  v_cvt_pk_bf16_f32 v38, v44, v45
  v_cvt_pk_bf16_f32 v39, v46, v47
  v_cvt_pk_bf16_f32 v32, v48, v49
  v_cvt_pk_bf16_f32 v35, v48, v49
  s_waitcnt lgkmcnt(0)
  v_mfma_f32_16x16x32_bf16 v[52:55], v[16:19], v[36:39], 0
  v_mfma_f32_16x16x32_bf16 v[168:171], v[136:139], v[36:39], 0
  v_mfma_f32_16x16x32_bf16 v[172:175], v[140:143], v[36:39], 0
  v_mfma_f32_16x16x32_bf16 v[176:179], v[144:147], v[36:39], 0
  v_mfma_f32_16x16x32_bf16 v[180:183], v[148:151], v[36:39], 0
  v_mfma_f32_16x16x32_bf16 v[184:187], v[152:155], v[36:39], 0
  v_mfma_f32_16x16x32_bf16 v[188:191], v[156:159], v[36:39], 0
  v_mfma_f32_16x16x16_bf16 v[52:55], v[16:17], v[32:33], v[52:55]
  v_mfma_f32_16x16x32_bf16 v[192:195], v[160:163], v[36:39], 0
  v_mfma_f32_16x16x32_bf16 v[196:199], v[164:167], v[36:39], 0
  v_mfma_f32_16x16x16_bf16 v[168:171], v[58:59], v[32:33], v[168:171]
  v_mfma_f32_16x16x16_bf16 v[172:175], v[58:59], v[34:35], v[172:175]
  v_mfma_f32_16x16x16_bf16 v[176:179], v[62:63], v[32:33], v[176:179]
  v_mfma_f32_16x16x16_bf16 v[180:183], v[62:63], v[34:35], v[180:183]
  v_mfma_f32_16x16x16_bf16 v[184:187], v[66:67], v[32:33], v[184:187]
  v_mfma_f32_16x16x16_bf16 v[188:191], v[66:67], v[34:35], v[188:191]
  v_rcp_f32 v3, v52
  v_mfma_f32_16x16x16_bf16 v[192:195], v[70:71], v[32:33], v[192:195]
  v_mul_f32 v3, v3, v10
  v_mfma_f32_16x16x16_bf16 v[196:199], v[70:71], v[34:35], v[196:199]
  v_mul_f32 v168, v168, v3
  v_mul_f32 v169, v169, v3
  v_mul_f32 v170, v170, v3
  v_mul_f32 v171, v171, v3
  v_mul_f32 v172, v172, v3
  v_mul_f32 v173, v173, v3
  v_mul_f32 v174, v174, v3
  v_mul_f32 v175, v175, v3
  v_cvt_pk_bf16_f32 v232, v168, v169
  v_cvt_pk_bf16_f32 v233, v170, v171
  v_cvt_pk_bf16_f32 v234, v172, v173
  v_cvt_pk_bf16_f32 v235, v174, v175
  ds_write_b128 v13, v[232:235] offset:0
  v_mul_f32 v176, v176, v3
  v_mul_f32 v177, v177, v3
  v_mul_f32 v178, v178, v3
  v_mul_f32 v179, v179, v3
  v_mul_f32 v180, v180, v3
  v_mul_f32 v181, v181, v3
  v_mul_f32 v182, v182, v3
  v_mul_f32 v183, v183, v3
  v_cvt_pk_bf16_f32 v236, v176, v177
  v_cvt_pk_bf16_f32 v237, v178, v179
  v_cvt_pk_bf16_f32 v238, v180, v181
  v_cvt_pk_bf16_f32 v239, v182, v183
  ds_write_b128 v13, v[236:239] offset:1024
  v_mul_f32 v184, v184, v3
  v_mul_f32 v185, v185, v3
  v_mul_f32 v186, v186, v3
  v_mul_f32 v187, v187, v3
  v_mul_f32 v188, v188, v3
  v_mul_f32 v189, v189, v3
  v_mul_f32 v190, v190, v3
  v_mul_f32 v191, v191, v3
  v_cvt_pk_bf16_f32 v240, v184, v185
  v_cvt_pk_bf16_f32 v241, v186, v187
  v_cvt_pk_bf16_f32 v242, v188, v189
  v_cvt_pk_bf16_f32 v243, v190, v191
  ds_write_b128 v13, v[240:243] offset:2048
  v_mul_f32 v192, v192, v3
  v_mul_f32 v193, v193, v3
  v_mul_f32 v194, v194, v3
  v_mul_f32 v195, v195, v3
  v_mul_f32 v196, v196, v3
  v_mul_f32 v197, v197, v3
  v_mul_f32 v198, v198, v3
  v_mul_f32 v199, v199, v3
  v_cvt_pk_bf16_f32 v244, v192, v193
  v_cvt_pk_bf16_f32 v245, v194, v195
  v_cvt_pk_bf16_f32 v246, v196, v197
  v_cvt_pk_bf16_f32 v247, v198, v199
  ds_write_b128 v13, v[244:247] offset:3072
  buffer_load_dword v249, v7, s[40:43], s73 offen sc1
  v_xor_b32 v13, 0x4000, v13
  s_mul_i32 s71, s62, 98304
  s_add_u32 s71, s71, s70
  s_waitcnt lgkmcnt(0)
  s_barrier
  ds_read_b128 v[104:107], v14 offset:0
  ds_read_b128 v[108:111], v14 offset:1024
  ds_read_b128 v[112:115], v14 offset:2048
  ds_read_b128 v[116:119], v14 offset:3072
  ds_read_b128 v[120:123], v14 offset:4096
  ds_read_b128 v[124:127], v14 offset:5120
  ds_read_b128 v[128:131], v14 offset:6144
  ds_read_b128 v[132:135], v14 offset:7168
  s_waitcnt lgkmcnt(7)
  v_mfma_f32_16x16x32_bf16 v[200:203], a[0:3], v[104:107], 0
  s_waitcnt lgkmcnt(6)
  v_mfma_f32_16x16x32_bf16 v[200:203], a[4:7], v[108:111], v[200:203]
  s_waitcnt lgkmcnt(5)
  v_mfma_f32_16x16x32_bf16 v[200:203], a[8:11], v[112:115], v[200:203]
  s_waitcnt lgkmcnt(4)
  v_mfma_f32_16x16x32_bf16 v[200:203], a[12:15], v[116:119], v[200:203]
  s_waitcnt lgkmcnt(3)
  v_mfma_f32_16x16x32_bf16 v[200:203], a[16:19], v[120:123], v[200:203]
  s_waitcnt lgkmcnt(2)
  v_mfma_f32_16x16x32_bf16 v[200:203], a[20:23], v[124:127], v[200:203]
  s_waitcnt lgkmcnt(1)
  v_mfma_f32_16x16x32_bf16 v[200:203], a[24:27], v[128:131], v[200:203]
  s_waitcnt lgkmcnt(0)
  v_mfma_f32_16x16x32_bf16 v[200:203], a[28:31], v[132:135], v[200:203]
  v_mfma_f32_16x16x32_bf16 v[204:207], a[32:35], v[104:107], 0
  ds_read_b128 v[136:139], v14 offset:8192
  v_mfma_f32_16x16x32_bf16 v[204:207], a[36:39], v[108:111], v[204:207]
  ds_read_b128 v[140:143], v14 offset:9216
  v_mfma_f32_16x16x32_bf16 v[204:207], a[40:43], v[112:115], v[204:207]
  ds_read_b128 v[144:147], v14 offset:10240
  v_mfma_f32_16x16x32_bf16 v[204:207], a[44:47], v[116:119], v[204:207]
  ds_read_b128 v[148:151], v14 offset:11264
  v_mfma_f32_16x16x32_bf16 v[204:207], a[48:51], v[120:123], v[204:207]
  ds_read_b128 v[152:155], v14 offset:12288
  v_mfma_f32_16x16x32_bf16 v[204:207], a[52:55], v[124:127], v[204:207]
  ds_read_b128 v[156:159], v14 offset:13312
  v_mfma_f32_16x16x32_bf16 v[204:207], a[56:59], v[128:131], v[204:207]
  ds_read_b128 v[160:163], v14 offset:14336
  v_mfma_f32_16x16x32_bf16 v[204:207], a[60:63], v[132:135], v[204:207]
  ds_read_b128 v[164:167], v14 offset:15360
  v_mfma_f32_16x16x32_bf16 v[208:211], a[64:67], v[104:107], 0
  v_mfma_f32_16x16x32_bf16 v[208:211], a[68:71], v[108:111], v[208:211]
  v_mfma_f32_16x16x32_bf16 v[208:211], a[72:75], v[112:115], v[208:211]
  v_mfma_f32_16x16x32_bf16 v[208:211], a[76:79], v[116:119], v[208:211]
  v_mfma_f32_16x16x32_bf16 v[208:211], a[80:83], v[120:123], v[208:211]
  v_mfma_f32_16x16x32_bf16 v[208:211], a[84:87], v[124:127], v[208:211]
  v_mfma_f32_16x16x32_bf16 v[208:211], a[88:91], v[128:131], v[208:211]
  v_mfma_f32_16x16x32_bf16 v[208:211], a[92:95], v[132:135], v[208:211]
  v_cvt_pk_bf16_f32 v232, v200, v201
  v_cvt_pk_bf16_f32 v233, v202, v203
  v_mfma_f32_16x16x32_bf16 v[212:215], a[96:99], v[104:107], 0
  v_cvt_pk_bf16_f32 v234, v204, v205
  v_cvt_pk_bf16_f32 v235, v206, v207
  v_mfma_f32_16x16x32_bf16 v[212:215], a[100:103], v[108:111], v[212:215]
  buffer_store_dwordx4 v[232:235], v2, s[40:43], s71 offen offset:0 sc1
  v_mfma_f32_16x16x32_bf16 v[212:215], a[104:107], v[112:115], v[212:215]
  v_mfma_f32_16x16x32_bf16 v[212:215], a[108:111], v[116:119], v[212:215]
  v_mfma_f32_16x16x32_bf16 v[212:215], a[112:115], v[120:123], v[212:215]
  v_mfma_f32_16x16x32_bf16 v[212:215], a[116:119], v[124:127], v[212:215]
  v_mfma_f32_16x16x32_bf16 v[212:215], a[120:123], v[128:131], v[212:215]
  v_mfma_f32_16x16x32_bf16 v[212:215], a[124:127], v[132:135], v[212:215]
  v_mfma_f32_16x16x32_bf16 v[216:219], a[128:131], v[104:107], 0
  v_mfma_f32_16x16x32_bf16 v[216:219], a[132:135], v[108:111], v[216:219]
  v_mfma_f32_16x16x32_bf16 v[216:219], a[136:139], v[112:115], v[216:219]
  v_mfma_f32_16x16x32_bf16 v[216:219], a[140:143], v[116:119], v[216:219]
  v_mfma_f32_16x16x32_bf16 v[216:219], a[144:147], v[120:123], v[216:219]
  v_mfma_f32_16x16x32_bf16 v[216:219], a[148:151], v[124:127], v[216:219]
  v_mfma_f32_16x16x32_bf16 v[216:219], a[152:155], v[128:131], v[216:219]
  v_mfma_f32_16x16x32_bf16 v[216:219], a[156:159], v[132:135], v[216:219]
  v_cvt_pk_bf16_f32 v236, v208, v209
  v_cvt_pk_bf16_f32 v237, v210, v211
  v_mfma_f32_16x16x32_bf16 v[220:223], a[160:163], v[104:107], 0
  s_waitcnt lgkmcnt(0)
  v_xor_b32 v14, 0x4000, v14
  v_cvt_pk_bf16_f32 v238, v212, v213
  v_cvt_pk_bf16_f32 v239, v214, v215
  v_mfma_f32_16x16x32_bf16 v[220:223], a[164:167], v[108:111], v[220:223]
  buffer_store_dwordx4 v[236:239], v2, s[40:43], s71 offen offset:1024 sc1
  v_mfma_f32_16x16x32_bf16 v[220:223], a[168:171], v[112:115], v[220:223]
  v_mfma_f32_16x16x32_bf16 v[220:223], a[172:175], v[116:119], v[220:223]
  v_mfma_f32_16x16x32_bf16 v[220:223], a[176:179], v[120:123], v[220:223]
  v_mfma_f32_16x16x32_bf16 v[220:223], a[180:183], v[124:127], v[220:223]
  v_mfma_f32_16x16x32_bf16 v[220:223], a[184:187], v[128:131], v[220:223]
  v_mfma_f32_16x16x32_bf16 v[220:223], a[188:191], v[132:135], v[220:223]
  v_mfma_f32_16x16x32_bf16 v[224:227], a[192:195], v[104:107], 0
  v_mfma_f32_16x16x32_bf16 v[224:227], a[196:199], v[108:111], v[224:227]
  v_mfma_f32_16x16x32_bf16 v[224:227], a[200:203], v[112:115], v[224:227]
  v_mfma_f32_16x16x32_bf16 v[224:227], a[204:207], v[116:119], v[224:227]
  v_mfma_f32_16x16x32_bf16 v[224:227], a[208:211], v[120:123], v[224:227]
  v_mfma_f32_16x16x32_bf16 v[224:227], a[212:215], v[124:127], v[224:227]
  v_mfma_f32_16x16x32_bf16 v[224:227], a[216:219], v[128:131], v[224:227]
  v_mfma_f32_16x16x32_bf16 v[224:227], a[220:223], v[132:135], v[224:227]
  v_cvt_pk_bf16_f32 v240, v216, v217
  v_cvt_pk_bf16_f32 v241, v218, v219
  v_mfma_f32_16x16x32_bf16 v[228:231], a[224:227], v[104:107], 0
  v_cvt_pk_bf16_f32 v242, v220, v221
  v_cvt_pk_bf16_f32 v243, v222, v223
  v_mfma_f32_16x16x32_bf16 v[228:231], a[228:231], v[108:111], v[228:231]
  buffer_store_dwordx4 v[240:243], v2, s[40:43], s71 offen offset:2048 sc1
  v_mfma_f32_16x16x32_bf16 v[228:231], a[232:235], v[112:115], v[228:231]
  v_mfma_f32_16x16x32_bf16 v[228:231], a[236:239], v[116:119], v[228:231]
  v_mfma_f32_16x16x32_bf16 v[228:231], a[240:243], v[120:123], v[228:231]
  v_mfma_f32_16x16x32_bf16 v[228:231], a[244:247], v[124:127], v[228:231]
  v_mfma_f32_16x16x32_bf16 v[228:231], a[248:251], v[128:131], v[228:231]
  v_mfma_f32_16x16x32_bf16 v[228:231], a[252:255], v[132:135], v[228:231]
  v_mfma_f32_16x16x32_bf16 v[200:203], a[0:3], v[136:139], 0
  v_mfma_f32_16x16x32_bf16 v[200:203], a[4:7], v[140:143], v[200:203]
  v_mfma_f32_16x16x32_bf16 v[200:203], a[8:11], v[144:147], v[200:203]
  v_mfma_f32_16x16x32_bf16 v[200:203], a[12:15], v[148:151], v[200:203]
  v_mfma_f32_16x16x32_bf16 v[200:203], a[16:19], v[152:155], v[200:203]
  v_mfma_f32_16x16x32_bf16 v[200:203], a[20:23], v[156:159], v[200:203]
  v_mfma_f32_16x16x32_bf16 v[200:203], a[24:27], v[160:163], v[200:203]
  v_mfma_f32_16x16x32_bf16 v[200:203], a[28:31], v[164:167], v[200:203]
  v_cvt_pk_bf16_f32 v244, v224, v225
  v_cvt_pk_bf16_f32 v245, v226, v227
  v_mfma_f32_16x16x32_bf16 v[204:207], a[32:35], v[136:139], 0
  v_cvt_pk_bf16_f32 v246, v228, v229
  v_cvt_pk_bf16_f32 v247, v230, v231
  v_mfma_f32_16x16x32_bf16 v[204:207], a[36:39], v[140:143], v[204:207]
  buffer_store_dwordx4 v[244:247], v2, s[40:43], s71 offen offset:3072 sc1
  v_mfma_f32_16x16x32_bf16 v[204:207], a[40:43], v[144:147], v[204:207]
  v_mfma_f32_16x16x32_bf16 v[204:207], a[44:47], v[148:151], v[204:207]
  v_mfma_f32_16x16x32_bf16 v[204:207], a[48:51], v[152:155], v[204:207]
  v_mfma_f32_16x16x32_bf16 v[204:207], a[52:55], v[156:159], v[204:207]
  v_mfma_f32_16x16x32_bf16 v[204:207], a[56:59], v[160:163], v[204:207]
  v_mfma_f32_16x16x32_bf16 v[204:207], a[60:63], v[164:167], v[204:207]
  v_mfma_f32_16x16x32_bf16 v[208:211], a[64:67], v[136:139], 0
  v_mfma_f32_16x16x32_bf16 v[208:211], a[68:71], v[140:143], v[208:211]
  v_mfma_f32_16x16x32_bf16 v[208:211], a[72:75], v[144:147], v[208:211]
  v_mfma_f32_16x16x32_bf16 v[208:211], a[76:79], v[148:151], v[208:211]
  v_mfma_f32_16x16x32_bf16 v[208:211], a[80:83], v[152:155], v[208:211]
  v_mfma_f32_16x16x32_bf16 v[208:211], a[84:87], v[156:159], v[208:211]
  v_mfma_f32_16x16x32_bf16 v[208:211], a[88:91], v[160:163], v[208:211]
  s_add_u32 s71, s71, 786432
  v_mfma_f32_16x16x32_bf16 v[208:211], a[92:95], v[164:167], v[208:211]
  v_cvt_pk_bf16_f32 v232, v200, v201
  v_cvt_pk_bf16_f32 v233, v202, v203
  v_mfma_f32_16x16x32_bf16 v[212:215], a[96:99], v[136:139], 0
  v_cvt_pk_bf16_f32 v234, v204, v205
  v_cvt_pk_bf16_f32 v235, v206, v207
  v_mfma_f32_16x16x32_bf16 v[212:215], a[100:103], v[140:143], v[212:215]
  buffer_store_dwordx4 v[232:235], v2, s[40:43], s71 offen offset:0 sc1
  v_mfma_f32_16x16x32_bf16 v[212:215], a[104:107], v[144:147], v[212:215]
  v_mfma_f32_16x16x32_bf16 v[212:215], a[108:111], v[148:151], v[212:215]
  v_mfma_f32_16x16x32_bf16 v[212:215], a[112:115], v[152:155], v[212:215]
  s_lshl_b32 s58, s63, 13
  s_add_u32 s58, s58, s69
  v_mfma_f32_16x16x32_bf16 v[212:215], a[116:119], v[156:159], v[212:215]
  buffer_load_dwordx4 v[56:59], v2, s[40:43], s58 offen offset:0 sc1
  v_mfma_f32_16x16x32_bf16 v[212:215], a[120:123], v[160:163], v[212:215]
  v_mfma_f32_16x16x32_bf16 v[212:215], a[124:127], v[164:167], v[212:215]
  buffer_load_dwordx4 v[60:63], v2, s[40:43], s58 offen offset:1024 sc1
  v_mfma_f32_16x16x32_bf16 v[216:219], a[128:131], v[136:139], 0
  v_mfma_f32_16x16x32_bf16 v[216:219], a[132:135], v[140:143], v[216:219]
  buffer_load_dwordx4 v[64:67], v2, s[40:43], s58 offen offset:2048 sc1
  v_mfma_f32_16x16x32_bf16 v[216:219], a[136:139], v[144:147], v[216:219]
  v_mfma_f32_16x16x32_bf16 v[216:219], a[140:143], v[148:151], v[216:219]
  buffer_load_dwordx4 v[68:71], v2, s[40:43], s58 offen offset:3072 sc1
  v_mfma_f32_16x16x32_bf16 v[216:219], a[144:147], v[152:155], v[216:219]
  v_mfma_f32_16x16x32_bf16 v[216:219], a[148:151], v[156:159], v[216:219]
  v_mfma_f32_16x16x32_bf16 v[216:219], a[152:155], v[160:163], v[216:219]
  v_mfma_f32_16x16x32_bf16 v[216:219], a[156:159], v[164:167], v[216:219]
  v_cvt_pk_bf16_f32 v236, v208, v209
  v_cvt_pk_bf16_f32 v237, v210, v211
  v_mfma_f32_16x16x32_bf16 v[220:223], a[160:163], v[136:139], 0
  v_cvt_pk_bf16_f32 v238, v212, v213
  v_cvt_pk_bf16_f32 v239, v214, v215
  v_mfma_f32_16x16x32_bf16 v[220:223], a[164:167], v[140:143], v[220:223]
  buffer_store_dwordx4 v[236:239], v2, s[40:43], s71 offen offset:1024 sc1
  v_mfma_f32_16x16x32_bf16 v[220:223], a[168:171], v[144:147], v[220:223]
  v_mfma_f32_16x16x32_bf16 v[220:223], a[172:175], v[148:151], v[220:223]
  v_mfma_f32_16x16x32_bf16 v[220:223], a[176:179], v[152:155], v[220:223]
  v_mfma_f32_16x16x32_bf16 v[220:223], a[180:183], v[156:159], v[220:223]
  v_mfma_f32_16x16x32_bf16 v[220:223], a[184:187], v[160:163], v[220:223]
  v_mfma_f32_16x16x32_bf16 v[220:223], a[188:191], v[164:167], v[220:223]
  v_mfma_f32_16x16x32_bf16 v[224:227], a[192:195], v[136:139], 0
  v_mfma_f32_16x16x32_bf16 v[224:227], a[196:199], v[140:143], v[224:227]
  v_mfma_f32_16x16x32_bf16 v[224:227], a[200:203], v[144:147], v[224:227]
  v_mfma_f32_16x16x32_bf16 v[224:227], a[204:207], v[148:151], v[224:227]
  v_mfma_f32_16x16x32_bf16 v[224:227], a[208:211], v[152:155], v[224:227]
  v_mfma_f32_16x16x32_bf16 v[224:227], a[212:215], v[156:159], v[224:227]
  v_mfma_f32_16x16x32_bf16 v[224:227], a[216:219], v[160:163], v[224:227]
  v_mfma_f32_16x16x32_bf16 v[224:227], a[220:223], v[164:167], v[224:227]
  v_cvt_pk_bf16_f32 v240, v216, v217
  v_cvt_pk_bf16_f32 v241, v218, v219
  v_mfma_f32_16x16x32_bf16 v[228:231], a[224:227], v[136:139], 0
  v_cvt_pk_bf16_f32 v242, v220, v221
  v_cvt_pk_bf16_f32 v243, v222, v223
  v_mfma_f32_16x16x32_bf16 v[228:231], a[228:231], v[140:143], v[228:231]
  buffer_store_dwordx4 v[240:243], v2, s[40:43], s71 offen offset:2048 sc1
  v_mfma_f32_16x16x32_bf16 v[228:231], a[232:235], v[144:147], v[228:231]
  v_mfma_f32_16x16x32_bf16 v[228:231], a[236:239], v[148:151], v[228:231]
  v_mfma_f32_16x16x32_bf16 v[228:231], a[240:243], v[152:155], v[228:231]
  v_mfma_f32_16x16x32_bf16 v[228:231], a[244:247], v[156:159], v[228:231]
  v_mfma_f32_16x16x32_bf16 v[228:231], a[248:251], v[160:163], v[228:231]
  v_mfma_f32_16x16x32_bf16 v[228:231], a[252:255], v[164:167], v[228:231]
  s_nop 7
  v_cvt_pk_bf16_f32 v244, v224, v225
  v_cvt_pk_bf16_f32 v245, v226, v227
  v_cvt_pk_bf16_f32 v246, v228, v229
  v_cvt_pk_bf16_f32 v247, v230, v231
  buffer_store_dwordx4 v[244:247], v2, s[40:43], s71 offen offset:3072 sc1
  s_bitcmp1_b32 s63, 2
  s_cbranch_scc0 L_b_round
  s_mov_b32 s64, s62
  s_waitcnt vmcnt(0)
  s_barrier
  s_lshl_b32 s58, s64, 2
  s_add_u32 s58, s58, s72
  s_bitcmp1_b32 s64, 2
  s_cselect_b32 s58, 0x40000000, s58
  v_mov_b32 v3, 1
  s_mov_b64 exec, 1
  buffer_atomic_add v3, v7, s[40:43], s58 offen
  s_mov_b64 exec, -1
  s_branch L_next
L_b_late:
  s_lshl_b32 s58, s62, 13
  s_add_u32 s58, s58, s69
  buffer_load_dwordx4 v[56:59], v2, s[40:43], s58 offen offset:0 sc1
  buffer_load_dwordx4 v[60:63], v2, s[40:43], s58 offen offset:1024 sc1
  buffer_load_dwordx4 v[64:67], v2, s[40:43], s58 offen offset:2048 sc1
  buffer_load_dwordx4 v[68:71], v2, s[40:43], s58 offen offset:3072 sc1
  s_add_u32 s57, s57, 1
  s_cmp_gt_u32 s57, 1048576
  s_cbranch_scc1 L_exit
  s_waitcnt vmcnt(0)
  s_branch L_b_chk
L_red:
  s_mov_b32 s48, s36
  s_and_b32 s49, s37, 0xffff
  s_mov_b32 s50, 0x200000
  s_mov_b32 s51, 0x20000
  v_lshlrev_b32 v2, 4, v0
  v_mov_b32 v7, 0
  s_mov_b32 s57, 0
  v_and_b32 v3, 4, v1
  v_cmp_ne_u32 vcc, 0, v3
  v_bfe_u32 v3, v1, 4, 6
  v_lshrrev_b32 v4, 3, v3
  s_lshr_b32 s58, vcc_lo, s95
  s_ff1_i32_b32 s58, s58
  s_bfm_b32 s58, s58, s95
  s_cmp_eq_u32 s62, 0
  s_cselect_b32 s59, s58, 0
  v_lshlrev_b32 v4, 7, v4
  v_add_u32 v4, 0xd086000, v4
  v_lshlrev_b32 v3, 6, v3
  v_add_u32 v3, 0xd087000, v3
  v_cmp_gt_u32 vcc, 32, v0
  v_and_b32 v5, 15, v0
  v_lshrrev_b32 v6, 4, v0
  v_cndmask_b32 v3, v3, v4, vcc
  v_cndmask_b32 v4, 16, 32, vcc
  buffer_load_dword v16, v3, s[40:43], 0 offen sc1
  v_lshlrev_b32 v24, 10, v5
  v_lshl_add_u32 v24, v6, 4, v24
  v_bfe_u32 v17, v0, 2, 1
  v_lshlrev_b32 v17, 1, v17
  v_sub_u32 v17, v6, v17
  v_bfe_u32 v18, v0, 3, 1
  v_bfe_u32 v19, v0, 1, 1
  v_lshl_add_u32 v18, v18, 1, v19
  v_lshl_add_u32 v17, v17, 2, v18
  v_and_b32 v18, 1, v0
  v_lshlrev_b32 v18, 4, v18
  v_mov_b32 v19, 0x3f80
  v_lshlrev_b32 v18, v18, v19
  v_cmp_eq_u32 vcc, 0, v17
  s_nop 1
  v_cndmask_b32 v8, 0, v18, vcc
  v_cmp_eq_u32 vcc, 1, v17
  s_nop 1
  v_cndmask_b32 v9, 0, v18, vcc
  v_cmp_eq_u32 vcc, 2, v17
  s_nop 1
  v_cndmask_b32 v10, 0, v18, vcc
  v_cmp_eq_u32 vcc, 3, v17
  s_nop 1
  v_cndmask_b32 v11, 0, v18, vcc
  v_cmp_eq_u32 vcc, 4, v17
  s_nop 1
  v_cndmask_b32 v12, 0, v18, vcc
  v_cmp_eq_u32 vcc, 5, v17
  s_nop 1
  v_cndmask_b32 v13, 0, v18, vcc
  v_cmp_eq_u32 vcc, 6, v17
  s_nop 1
  v_cndmask_b32 v14, 0, v18, vcc
  v_cmp_eq_u32 vcc, 7, v17
  s_nop 1
  v_cndmask_b32 v15, 0, v18, vcc
  v_readlane_b32 s63, v1, s95
L_r_wait:
  s_waitcnt vmcnt(0)
  v_cmp_gt_u32 vcc, v4, v16
  s_nop 0
  s_and_b64 vcc, vcc, s[58:59]
  s_cbranch_scc0 L_r_go
  buffer_load_dword v16, v3, s[40:43], 0 offen sc1
  s_add_u32 s57, s57, 1
  s_cmp_gt_u32 s57, 1048576
  s_cbranch_scc1 L_exit
  s_branch L_r_wait
L_r_go:
  s_bfe_u32 s58, s63, 0x60004
  s_bfe_u32 s59, s63, 0x1000e
  s_lshl1_add_u32 s58, s58, s59
  s_mul_i32 s64, s58, 786432
  s_bfe_u32 s59, s63, 0x2000c
  s_lshl2_add_u32 s59, s59, s44
  s_lshl_b32 s58, s58, 14
  s_lshl_b32 s71, s59, 6
  s_add_u32 s71, s71, s58
  s_lshl_b32 s59, s59, 10
  s_add_u32 s64, s64, s59
  s_add_u32 s64, s64, 0x6000000
  s_bitcmp1_b32 s63, 2
  s_cselect_b32 s64, 0x40000000, s64
  buffer_load_dwordx4 v[64:67], v2, s[40:43], s64 offen sc1
  s_add_u32 s64, s64, 0x4000
  buffer_load_dwordx4 v[68:71], v2, s[40:43], s64 offen sc1
  s_add_u32 s64, s64, 0x4000
  buffer_load_dwordx4 v[72:75], v2, s[40:43], s64 offen sc1
  s_add_u32 s64, s64, 0x4000
  buffer_load_dwordx4 v[76:79], v2, s[40:43], s64 offen sc1
  s_add_u32 s64, s64, 0x4000
  buffer_load_dwordx4 v[80:83], v2, s[40:43], s64 offen sc1
  s_add_u32 s64, s64, 0x4000
  buffer_load_dwordx4 v[84:87], v2, s[40:43], s64 offen sc1
  s_add_u32 s64, s64, 0x4000
  buffer_load_dwordx4 v[88:91], v2, s[40:43], s64 offen sc1
  s_add_u32 s64, s64, 0x4000
  buffer_load_dwordx4 v[92:95], v2, s[40:43], s64 offen sc1
  s_add_u32 s64, s64, 0x4000
  buffer_load_dwordx4 v[96:99], v2, s[40:43], s64 offen sc1
  s_add_u32 s64, s64, 0x4000
  buffer_load_dwordx4 v[100:103], v2, s[40:43], s64 offen sc1
  s_add_u32 s64, s64, 0x4000
  buffer_load_dwordx4 v[104:107], v2, s[40:43], s64 offen sc1
  s_add_u32 s64, s64, 0x4000
  buffer_load_dwordx4 v[108:111], v2, s[40:43], s64 offen sc1
  s_add_u32 s64, s64, 0x4000
  buffer_load_dwordx4 v[112:115], v2, s[40:43], s64 offen sc1
  s_add_u32 s64, s64, 0x4000
  buffer_load_dwordx4 v[116:119], v2, s[40:43], s64 offen sc1
  s_add_u32 s64, s64, 0x4000
  buffer_load_dwordx4 v[120:123], v2, s[40:43], s64 offen sc1
  s_add_u32 s64, s64, 0x4000
L_r_loop:
  s_mov_b32 s61, s63
  s_mov_b32 s65, s71
  s_add_u32 s95, s95, 1
  s_nop 0
  v_readlane_b32 s63, v1, s95
  buffer_load_dwordx4 v[124:127], v2, s[40:43], s64 offen sc1
  s_add_u32 s64, s64, 0x4000
  s_waitcnt vmcnt(15)
  v_mfma_f32_16x16x32_bf16 v[16:19], v[8:11], v[64:67], 0
  v_mfma_f32_16x16x32_bf16 v[20:23], v[12:15], v[64:67], 0
  buffer_load_dwordx4 v[64:67], v2, s[40:43], s64 offen sc1
  s_add_u32 s64, s64, 0x4000
  s_waitcnt vmcnt(15)
  v_mfma_f32_16x16x32_bf16 v[16:19], v[8:11], v[68:71], v[16:19]
  v_mfma_f32_16x16x32_bf16 v[20:23], v[12:15], v[68:71], v[20:23]
  buffer_load_dwordx4 v[68:71], v2, s[40:43], s64 offen sc1
  s_add_u32 s64, s64, 0x4000
  s_waitcnt vmcnt(15)
  v_mfma_f32_16x16x32_bf16 v[16:19], v[8:11], v[72:75], v[16:19]
  v_mfma_f32_16x16x32_bf16 v[20:23], v[12:15], v[72:75], v[20:23]
  buffer_load_dwordx4 v[72:75], v2, s[40:43], s64 offen sc1
  s_add_u32 s64, s64, 0x4000
  s_waitcnt vmcnt(15)
  v_mfma_f32_16x16x32_bf16 v[16:19], v[8:11], v[76:79], v[16:19]
  v_mfma_f32_16x16x32_bf16 v[20:23], v[12:15], v[76:79], v[20:23]
  buffer_load_dwordx4 v[76:79], v2, s[40:43], s64 offen sc1
  s_add_u32 s64, s64, 0x4000
  s_waitcnt vmcnt(15)
  v_mfma_f32_16x16x32_bf16 v[16:19], v[8:11], v[80:83], v[16:19]
  v_mfma_f32_16x16x32_bf16 v[20:23], v[12:15], v[80:83], v[20:23]
  buffer_load_dwordx4 v[80:83], v2, s[40:43], s64 offen sc1
  s_add_u32 s64, s64, 0x4000
  s_waitcnt vmcnt(15)
  v_mfma_f32_16x16x32_bf16 v[16:19], v[8:11], v[84:87], v[16:19]
  v_mfma_f32_16x16x32_bf16 v[20:23], v[12:15], v[84:87], v[20:23]
  buffer_load_dwordx4 v[84:87], v2, s[40:43], s64 offen sc1
  s_add_u32 s64, s64, 0x4000
  s_waitcnt vmcnt(15)
  v_mfma_f32_16x16x32_bf16 v[16:19], v[8:11], v[88:91], v[16:19]
  v_mfma_f32_16x16x32_bf16 v[20:23], v[12:15], v[88:91], v[20:23]
  buffer_load_dwordx4 v[88:91], v2, s[40:43], s64 offen sc1
  s_add_u32 s64, s64, 0x4000
  s_waitcnt vmcnt(15)
  v_mfma_f32_16x16x32_bf16 v[16:19], v[8:11], v[92:95], v[16:19]
  v_mfma_f32_16x16x32_bf16 v[20:23], v[12:15], v[92:95], v[20:23]
  buffer_load_dwordx4 v[92:95], v2, s[40:43], s64 offen sc1
  s_add_u32 s64, s64, 0x4000
  s_waitcnt vmcnt(15)
  v_mfma_f32_16x16x32_bf16 v[16:19], v[8:11], v[96:99], v[16:19]
  v_mfma_f32_16x16x32_bf16 v[20:23], v[12:15], v[96:99], v[20:23]
  buffer_load_dwordx4 v[96:99], v2, s[40:43], s64 offen sc1
  s_add_u32 s64, s64, 0x4000
  s_waitcnt vmcnt(15)
  v_mfma_f32_16x16x32_bf16 v[16:19], v[8:11], v[100:103], v[16:19]
  v_mfma_f32_16x16x32_bf16 v[20:23], v[12:15], v[100:103], v[20:23]
  buffer_load_dwordx4 v[100:103], v2, s[40:43], s64 offen sc1
  s_add_u32 s64, s64, 0x4000
  s_waitcnt vmcnt(15)
  v_mfma_f32_16x16x32_bf16 v[16:19], v[8:11], v[104:107], v[16:19]
  v_mfma_f32_16x16x32_bf16 v[20:23], v[12:15], v[104:107], v[20:23]
  buffer_load_dwordx4 v[104:107], v2, s[40:43], s64 offen sc1
  s_add_u32 s64, s64, 0x4000
  s_waitcnt vmcnt(15)
  v_mfma_f32_16x16x32_bf16 v[16:19], v[8:11], v[108:111], v[16:19]
  v_mfma_f32_16x16x32_bf16 v[20:23], v[12:15], v[108:111], v[20:23]
  buffer_load_dwordx4 v[108:111], v2, s[40:43], s64 offen sc1
  s_add_u32 s64, s64, 0x4000
  s_waitcnt vmcnt(15)
  v_mfma_f32_16x16x32_bf16 v[16:19], v[8:11], v[112:115], v[16:19]
  v_mfma_f32_16x16x32_bf16 v[20:23], v[12:15], v[112:115], v[20:23]
  buffer_load_dwordx4 v[112:115], v2, s[40:43], s64 offen sc1
  s_add_u32 s64, s64, 0x4000
  s_waitcnt vmcnt(15)
  v_mfma_f32_16x16x32_bf16 v[16:19], v[8:11], v[116:119], v[16:19]
  v_mfma_f32_16x16x32_bf16 v[20:23], v[12:15], v[116:119], v[20:23]
  buffer_load_dwordx4 v[116:119], v2, s[40:43], s64 offen sc1
  s_add_u32 s64, s64, 0x4000
  s_waitcnt vmcnt(15)
  v_mfma_f32_16x16x32_bf16 v[16:19], v[8:11], v[120:123], v[16:19]
  v_mfma_f32_16x16x32_bf16 v[20:23], v[12:15], v[120:123], v[20:23]
  buffer_load_dwordx4 v[120:123], v2, s[40:43], s64 offen sc1
  s_add_u32 s64, s64, 0x4000
  s_waitcnt vmcnt(15)
  v_mfma_f32_16x16x32_bf16 v[16:19], v[8:11], v[124:127], v[16:19]
  v_mfma_f32_16x16x32_bf16 v[20:23], v[12:15], v[124:127], v[20:23]
  buffer_load_dwordx4 v[124:127], v2, s[40:43], s64 offen sc1
  s_add_u32 s64, s64, 0x4000
  s_waitcnt vmcnt(15)
  v_mfma_f32_16x16x32_bf16 v[16:19], v[8:11], v[64:67], v[16:19]
  v_mfma_f32_16x16x32_bf16 v[20:23], v[12:15], v[64:67], v[20:23]
  s_cmp_lg_u32 s62, 0
  s_cbranch_scc1 L_r_stage
L_r_stageback:
  buffer_load_dwordx4 v[64:67], v2, s[40:43], s64 offen sc1
  s_add_u32 s64, s64, 0x4000
  s_waitcnt vmcnt(15)
  v_mfma_f32_16x16x32_bf16 v[16:19], v[8:11], v[68:71], v[16:19]
  v_mfma_f32_16x16x32_bf16 v[20:23], v[12:15], v[68:71], v[20:23]
  buffer_load_dwordx4 v[68:71], v2, s[40:43], s64 offen sc1
  s_add_u32 s64, s64, 0x4000
  s_waitcnt vmcnt(15)
  v_mfma_f32_16x16x32_bf16 v[16:19], v[8:11], v[72:75], v[16:19]
  v_mfma_f32_16x16x32_bf16 v[20:23], v[12:15], v[72:75], v[20:23]
  buffer_load_dwordx4 v[72:75], v2, s[40:43], s64 offen sc1
  s_add_u32 s64, s64, 0x4000
  s_waitcnt vmcnt(15)
  v_mfma_f32_16x16x32_bf16 v[16:19], v[8:11], v[76:79], v[16:19]
  v_mfma_f32_16x16x32_bf16 v[20:23], v[12:15], v[76:79], v[20:23]
  buffer_load_dwordx4 v[76:79], v2, s[40:43], s64 offen sc1
  s_add_u32 s64, s64, 0x4000
  s_waitcnt vmcnt(15)
  v_mfma_f32_16x16x32_bf16 v[16:19], v[8:11], v[80:83], v[16:19]
  v_mfma_f32_16x16x32_bf16 v[20:23], v[12:15], v[80:83], v[20:23]
  buffer_load_dwordx4 v[80:83], v2, s[40:43], s64 offen sc1
  s_add_u32 s64, s64, 0x4000
  s_waitcnt vmcnt(15)
  v_mfma_f32_16x16x32_bf16 v[16:19], v[8:11], v[84:87], v[16:19]
  v_mfma_f32_16x16x32_bf16 v[20:23], v[12:15], v[84:87], v[20:23]
  buffer_load_dwordx4 v[84:87], v2, s[40:43], s64 offen sc1
  s_add_u32 s64, s64, 0x4000
  s_waitcnt vmcnt(15)
  v_mfma_f32_16x16x32_bf16 v[16:19], v[8:11], v[88:91], v[16:19]
  v_mfma_f32_16x16x32_bf16 v[20:23], v[12:15], v[88:91], v[20:23]
  buffer_load_dwordx4 v[88:91], v2, s[40:43], s64 offen sc1
  s_add_u32 s64, s64, 0x4000
  s_waitcnt vmcnt(15)
  v_mfma_f32_16x16x32_bf16 v[16:19], v[8:11], v[92:95], v[16:19]
  v_mfma_f32_16x16x32_bf16 v[20:23], v[12:15], v[92:95], v[20:23]
  buffer_load_dwordx4 v[92:95], v2, s[40:43], s64 offen sc1
  s_add_u32 s64, s64, 0x4000
  s_waitcnt vmcnt(15)
  v_mfma_f32_16x16x32_bf16 v[16:19], v[8:11], v[96:99], v[16:19]
  v_mfma_f32_16x16x32_bf16 v[20:23], v[12:15], v[96:99], v[20:23]
  buffer_load_dwordx4 v[96:99], v2, s[40:43], s64 offen sc1
  s_add_u32 s64, s64, 0x4000
  s_waitcnt vmcnt(15)
  v_mfma_f32_16x16x32_bf16 v[16:19], v[8:11], v[100:103], v[16:19]
  v_mfma_f32_16x16x32_bf16 v[20:23], v[12:15], v[100:103], v[20:23]
  buffer_load_dwordx4 v[100:103], v2, s[40:43], s64 offen sc1
  s_add_u32 s64, s64, 0x4000
  s_waitcnt vmcnt(15)
  v_mfma_f32_16x16x32_bf16 v[16:19], v[8:11], v[104:107], v[16:19]
  v_mfma_f32_16x16x32_bf16 v[20:23], v[12:15], v[104:107], v[20:23]
  buffer_load_dwordx4 v[104:107], v2, s[40:43], s64 offen sc1
  s_add_u32 s64, s64, 0x4000
  s_waitcnt vmcnt(15)
  v_mfma_f32_16x16x32_bf16 v[16:19], v[8:11], v[108:111], v[16:19]
  v_mfma_f32_16x16x32_bf16 v[20:23], v[12:15], v[108:111], v[20:23]
  buffer_load_dwordx4 v[108:111], v2, s[40:43], s64 offen sc1
  s_add_u32 s64, s64, 0x4000
  s_waitcnt vmcnt(15)
  v_mfma_f32_16x16x32_bf16 v[16:19], v[8:11], v[112:115], v[16:19]
  v_mfma_f32_16x16x32_bf16 v[20:23], v[12:15], v[112:115], v[20:23]
  buffer_load_dwordx4 v[112:115], v2, s[40:43], s64 offen sc1
  s_add_u32 s64, s64, 0x4000
  s_waitcnt vmcnt(15)
  v_mfma_f32_16x16x32_bf16 v[16:19], v[8:11], v[116:119], v[16:19]
  v_mfma_f32_16x16x32_bf16 v[20:23], v[12:15], v[116:119], v[20:23]
  buffer_load_dwordx4 v[116:119], v2, s[40:43], s64 offen sc1
  s_add_u32 s64, s64, 0x4000
  s_waitcnt vmcnt(15)
  v_mfma_f32_16x16x32_bf16 v[16:19], v[8:11], v[120:123], v[16:19]
  v_mfma_f32_16x16x32_bf16 v[20:23], v[12:15], v[120:123], v[20:23]
  buffer_load_dwordx4 v[120:123], v2, s[40:43], s64 offen sc1
  s_add_u32 s64, s64, 0x4000
  s_waitcnt vmcnt(15)
  v_mfma_f32_16x16x32_bf16 v[16:19], v[8:11], v[124:127], v[16:19]
  v_mfma_f32_16x16x32_bf16 v[20:23], v[12:15], v[124:127], v[20:23]
  buffer_load_dwordx4 v[124:127], v2, s[40:43], s64 offen sc1
  s_add_u32 s64, s64, 0x4000
  s_waitcnt vmcnt(15)
  v_mfma_f32_16x16x32_bf16 v[16:19], v[8:11], v[64:67], v[16:19]
  v_mfma_f32_16x16x32_bf16 v[20:23], v[12:15], v[64:67], v[20:23]
  s_bfe_u32 s58, s63, 0x60004
  s_bfe_u32 s59, s63, 0x1000e
  s_lshl1_add_u32 s58, s58, s59
  s_mul_i32 s64, s58, 786432
  s_bfe_u32 s59, s63, 0x2000c
  s_lshl2_add_u32 s59, s59, s44
  s_lshl_b32 s58, s58, 14
  s_lshl_b32 s71, s59, 6
  s_add_u32 s71, s71, s58
  s_lshl_b32 s59, s59, 10
  s_add_u32 s64, s64, s59
  s_add_u32 s64, s64, 0x6000000
  s_bitcmp1_b32 s63, 2
  s_cselect_b32 s64, 0x40000000, s64
  buffer_load_dwordx4 v[64:67], v2, s[40:43], s64 offen sc1
  s_add_u32 s64, s64, 0x4000
  s_waitcnt vmcnt(15)
  v_mfma_f32_16x16x32_bf16 v[16:19], v[8:11], v[68:71], v[16:19]
  v_mfma_f32_16x16x32_bf16 v[20:23], v[12:15], v[68:71], v[20:23]
  buffer_load_dwordx4 v[68:71], v2, s[40:43], s64 offen sc1
  s_add_u32 s64, s64, 0x4000
  s_waitcnt vmcnt(15)
  v_mfma_f32_16x16x32_bf16 v[16:19], v[8:11], v[72:75], v[16:19]
  v_mfma_f32_16x16x32_bf16 v[20:23], v[12:15], v[72:75], v[20:23]
  buffer_load_dwordx4 v[72:75], v2, s[40:43], s64 offen sc1
  s_add_u32 s64, s64, 0x4000
  s_waitcnt vmcnt(15)
  v_mfma_f32_16x16x32_bf16 v[16:19], v[8:11], v[76:79], v[16:19]
  v_mfma_f32_16x16x32_bf16 v[20:23], v[12:15], v[76:79], v[20:23]
  buffer_load_dwordx4 v[76:79], v2, s[40:43], s64 offen sc1
  s_add_u32 s64, s64, 0x4000
  s_waitcnt vmcnt(15)
  v_mfma_f32_16x16x32_bf16 v[16:19], v[8:11], v[80:83], v[16:19]
  v_mfma_f32_16x16x32_bf16 v[20:23], v[12:15], v[80:83], v[20:23]
  buffer_load_dwordx4 v[80:83], v2, s[40:43], s64 offen sc1
  s_add_u32 s64, s64, 0x4000
  s_waitcnt vmcnt(15)
  v_mfma_f32_16x16x32_bf16 v[16:19], v[8:11], v[84:87], v[16:19]
  v_mfma_f32_16x16x32_bf16 v[20:23], v[12:15], v[84:87], v[20:23]
  buffer_load_dwordx4 v[84:87], v2, s[40:43], s64 offen sc1
  s_add_u32 s64, s64, 0x4000
  s_waitcnt vmcnt(15)
  v_mfma_f32_16x16x32_bf16 v[16:19], v[8:11], v[88:91], v[16:19]
  v_mfma_f32_16x16x32_bf16 v[20:23], v[12:15], v[88:91], v[20:23]
  buffer_load_dwordx4 v[88:91], v2, s[40:43], s64 offen sc1
  s_add_u32 s64, s64, 0x4000
  s_waitcnt vmcnt(15)
  v_mfma_f32_16x16x32_bf16 v[16:19], v[8:11], v[92:95], v[16:19]
  v_mfma_f32_16x16x32_bf16 v[20:23], v[12:15], v[92:95], v[20:23]
  buffer_load_dwordx4 v[92:95], v2, s[40:43], s64 offen sc1
  s_add_u32 s64, s64, 0x4000
  s_waitcnt vmcnt(15)
  v_mfma_f32_16x16x32_bf16 v[16:19], v[8:11], v[96:99], v[16:19]
  v_mfma_f32_16x16x32_bf16 v[20:23], v[12:15], v[96:99], v[20:23]
  buffer_load_dwordx4 v[96:99], v2, s[40:43], s64 offen sc1
  s_add_u32 s64, s64, 0x4000
  s_waitcnt vmcnt(15)
  v_mfma_f32_16x16x32_bf16 v[16:19], v[8:11], v[100:103], v[16:19]
  v_mfma_f32_16x16x32_bf16 v[20:23], v[12:15], v[100:103], v[20:23]
  buffer_load_dwordx4 v[100:103], v2, s[40:43], s64 offen sc1
  s_add_u32 s64, s64, 0x4000
  s_waitcnt vmcnt(15)
  v_mfma_f32_16x16x32_bf16 v[16:19], v[8:11], v[104:107], v[16:19]
  v_mfma_f32_16x16x32_bf16 v[20:23], v[12:15], v[104:107], v[20:23]
  buffer_load_dwordx4 v[104:107], v2, s[40:43], s64 offen sc1
  s_add_u32 s64, s64, 0x4000
  s_waitcnt vmcnt(15)
  v_mfma_f32_16x16x32_bf16 v[16:19], v[8:11], v[108:111], v[16:19]
  v_mfma_f32_16x16x32_bf16 v[20:23], v[12:15], v[108:111], v[20:23]
  buffer_load_dwordx4 v[108:111], v2, s[40:43], s64 offen sc1
  s_add_u32 s64, s64, 0x4000
  s_waitcnt vmcnt(15)
  v_mfma_f32_16x16x32_bf16 v[16:19], v[8:11], v[112:115], v[16:19]
  v_mfma_f32_16x16x32_bf16 v[20:23], v[12:15], v[112:115], v[20:23]
  buffer_load_dwordx4 v[112:115], v2, s[40:43], s64 offen sc1
  s_add_u32 s64, s64, 0x4000
  s_waitcnt vmcnt(15)
  v_mfma_f32_16x16x32_bf16 v[16:19], v[8:11], v[116:119], v[16:19]
  v_mfma_f32_16x16x32_bf16 v[20:23], v[12:15], v[116:119], v[20:23]
  buffer_load_dwordx4 v[116:119], v2, s[40:43], s64 offen sc1
  s_add_u32 s64, s64, 0x4000
  s_waitcnt vmcnt(15)
  v_mfma_f32_16x16x32_bf16 v[16:19], v[8:11], v[120:123], v[16:19]
  v_mfma_f32_16x16x32_bf16 v[20:23], v[12:15], v[120:123], v[20:23]
  buffer_load_dwordx4 v[120:123], v2, s[40:43], s64 offen sc1
  s_add_u32 s64, s64, 0x4000
  s_waitcnt vmcnt(15)
  v_mfma_f32_16x16x32_bf16 v[16:19], v[8:11], v[124:127], v[16:19]
  v_mfma_f32_16x16x32_bf16 v[20:23], v[12:15], v[124:127], v[20:23]
  s_nop 6
  v_cvt_pk_bf16_f32 v32, v16, v17
  v_cvt_pk_bf16_f32 v33, v18, v19
  v_cvt_pk_bf16_f32 v34, v20, v21
  v_cvt_pk_bf16_f32 v35, v22, v23
  buffer_store_dwordx4 v[32:35], v24, s[48:51], s65 offen
  s_bitcmp1_b32 s63, 2
  s_cbranch_scc0 L_r_loop
  s_waitcnt vmcnt(1)
  s_branch L_next
L_r_stage:
  s_bfe_u32 s66, s61, 0x60004
  s_lshl_b32 s66, s66, 6
  s_add_u32 s66, s66, 0xd087000
L_r_st2:
  buffer_load_dword v3, v7, s[40:43], s66 offen sc1
  s_add_u32 s57, s57, 1
  s_cmp_gt_u32 s57, 1048576
  s_cbranch_scc1 L_exit
  s_waitcnt vmcnt(0)
  v_cmp_gt_u32 vcc, 16, v3
  s_cbranch_vccnz L_r_st2
  s_branch L_r_stageback
L_feed:
  s_cmp_lt_u32 s57, 4
  s_cselect_b64 s[52:53], s[10:11], s[8:9]
  s_cselect_b64 s[48:49], s[14:15], s[12:13]
  s_cselect_b64 s[4:5], s[16:17], s[24:25]
  s_cselect_b32 s72, 0x21, 0x30
  s_cselect_b32 s67, 16, 32
  s_cselect_b32 s69, 1.0, 0x3e0293ee
  s_cselect_b32 s74, 2, 4
  s_cmp_eq_u32 s57, 6
  s_cselect_b64 s[48:49], s[26:27], s[48:49]
  s_cselect_b64 s[4:5], s[28:29], s[4:5]
  s_cselect_b32 s72, 0x54, s72
  s_cselect_b32 s67, 64, s67
  s_cselect_b32 s69, 1.0, s69
  s_cselect_b32 s74, 2, s74
  v_readlane_b32 s73, v1, s95
  s_add_u32 s95, s95, 1
  s_and_b32 s53, s53, 0xffff
  s_mov_b32 s54, 0x200000
  s_mov_b32 s55, 0x20000
  s_cmp_lt_u32 s44, 2
  s_cselect_b64 s[48:49], s[48:49], s[4:5]
  s_cselect_b32 s58, 0, 4
  s_lshr_b32 s72, s72, s58
  s_and_b32 s72, s72, 15
  s_and_b32 s49, s49, 0xffff
  s_mov_b32 s50, 0x400000
  s_mov_b32 s51, 0x20000
  v_lshlrev_b32 v2, 4, v0
  v_mov_b32 v6, 0
  v_lshrrev_b32 v3, 3, v0
  v_lshlrev_b32 v20, 13, v3
  v_and_b32 v3, 2, v3
  v_and_b32 v4, 7, v0
  v_xor_b32 v3, v3, v4
  v_lshl_add_u32 v20, v3, 4, v20
  v_xor_b32 v21, 64, v20
  s_lshl_b32 s60, s44, 14
  s_add_u32 s60, s60, 0x18000
  s_and_b32 s59, s44, 1
  s_lshl1_add_u32 s75, s56, s59
  s_lshl_b32 s75, s75, 7
  s_lshl_b32 s58, s57, 2
  s_lshr_b32 s78, 0, s58
  s_and_b32 s78, s78, 15
  s_lshl_b32 s58, s78, 20
  s_or_b32 s75, s75, s58
  s_cmp_lt_u32 s72, 3
  s_cbranch_scc1 L_f_w_3
  s_add_u32 m0, s60, 0
  s_xor_b32 s58, s75, 0
  buffer_load_dwordx4 v20, s[48:51], s58 offen  lds
  s_add_u32 m0, s60, 1024
  s_xor_b32 s58, s75, 65536
  buffer_load_dwordx4 v21, s[48:51], s58 offen  lds
  s_add_u32 m0, s60, 2048
  s_xor_b32 s58, s75, 131072
  buffer_load_dwordx4 v20, s[48:51], s58 offen  lds
  s_add_u32 m0, s60, 3072
  s_xor_b32 s58, s75, 196608
  buffer_load_dwordx4 v21, s[48:51], s58 offen  lds
  s_branch L_f_w_3e
L_f_w_3:
  s_add_u32 m0, s60, 0
  s_xor_b32 s58, s75, 0
  buffer_load_dwordx4 v20, s[48:51], s58 offen nt lds
  s_add_u32 m0, s60, 1024
  s_xor_b32 s58, s75, 65536
  buffer_load_dwordx4 v21, s[48:51], s58 offen nt lds
  s_add_u32 m0, s60, 2048
  s_xor_b32 s58, s75, 131072
  buffer_load_dwordx4 v20, s[48:51], s58 offen nt lds
  s_add_u32 m0, s60, 3072
  s_xor_b32 s58, s75, 196608
  buffer_load_dwordx4 v21, s[48:51], s58 offen nt lds
L_f_w_3e:
  s_cmp_lt_u32 s72, 3
  s_cbranch_scc1 L_f_w_4
  s_add_u32 m0, s60, 4096
  s_xor_b32 s58, s75, 262144
  buffer_load_dwordx4 v20, s[48:51], s58 offen  lds
  s_add_u32 m0, s60, 5120
  s_xor_b32 s58, s75, 327680
  buffer_load_dwordx4 v21, s[48:51], s58 offen  lds
  s_add_u32 m0, s60, 6144
  s_xor_b32 s58, s75, 393216
  buffer_load_dwordx4 v20, s[48:51], s58 offen  lds
  s_add_u32 m0, s60, 7168
  s_xor_b32 s58, s75, 458752
  buffer_load_dwordx4 v21, s[48:51], s58 offen  lds
  s_branch L_f_w_4e
L_f_w_4:
  s_add_u32 m0, s60, 4096
  s_xor_b32 s58, s75, 262144
  buffer_load_dwordx4 v20, s[48:51], s58 offen nt lds
  s_add_u32 m0, s60, 5120
  s_xor_b32 s58, s75, 327680
  buffer_load_dwordx4 v21, s[48:51], s58 offen nt lds
  s_add_u32 m0, s60, 6144
  s_xor_b32 s58, s75, 393216
  buffer_load_dwordx4 v20, s[48:51], s58 offen nt lds
  s_add_u32 m0, s60, 7168
  s_xor_b32 s58, s75, 458752
  buffer_load_dwordx4 v21, s[48:51], s58 offen nt lds
L_f_w_4e:
  s_cmp_lt_u32 s72, 3
  s_cbranch_scc1 L_f_w_5
  s_add_u32 m0, s60, 8192
  s_xor_b32 s58, s75, 524288
  buffer_load_dwordx4 v20, s[48:51], s58 offen  lds
  s_add_u32 m0, s60, 9216
  s_xor_b32 s58, s75, 589824
  buffer_load_dwordx4 v21, s[48:51], s58 offen  lds
  s_add_u32 m0, s60, 10240
  s_xor_b32 s58, s75, 655360
  buffer_load_dwordx4 v20, s[48:51], s58 offen  lds
  s_add_u32 m0, s60, 11264
  s_xor_b32 s58, s75, 720896
  buffer_load_dwordx4 v21, s[48:51], s58 offen  lds
  s_branch L_f_w_5e
L_f_w_5:
  s_add_u32 m0, s60, 8192
  s_xor_b32 s58, s75, 524288
  buffer_load_dwordx4 v20, s[48:51], s58 offen nt lds
  s_add_u32 m0, s60, 9216
  s_xor_b32 s58, s75, 589824
  buffer_load_dwordx4 v21, s[48:51], s58 offen nt lds
  s_add_u32 m0, s60, 10240
  s_xor_b32 s58, s75, 655360
  buffer_load_dwordx4 v20, s[48:51], s58 offen nt lds
  s_add_u32 m0, s60, 11264
  s_xor_b32 s58, s75, 720896
  buffer_load_dwordx4 v21, s[48:51], s58 offen nt lds
L_f_w_5e:
  s_cmp_lt_u32 s72, 3
  s_cbranch_scc1 L_f_w_6
  s_add_u32 m0, s60, 12288
  s_xor_b32 s58, s75, 786432
  buffer_load_dwordx4 v20, s[48:51], s58 offen  lds
  s_add_u32 m0, s60, 13312
  s_xor_b32 s58, s75, 851968
  buffer_load_dwordx4 v21, s[48:51], s58 offen  lds
  s_add_u32 m0, s60, 14336
  s_xor_b32 s58, s75, 917504
  buffer_load_dwordx4 v20, s[48:51], s58 offen  lds
  s_add_u32 m0, s60, 15360
  s_xor_b32 s58, s75, 983040
  buffer_load_dwordx4 v21, s[48:51], s58 offen  lds
  s_branch L_f_w_6e
L_f_w_6:
  s_add_u32 m0, s60, 12288
  s_xor_b32 s58, s75, 786432
  buffer_load_dwordx4 v20, s[48:51], s58 offen nt lds
  s_add_u32 m0, s60, 13312
  s_xor_b32 s58, s75, 851968
  buffer_load_dwordx4 v21, s[48:51], s58 offen nt lds
  s_add_u32 m0, s60, 14336
  s_xor_b32 s58, s75, 917504
  buffer_load_dwordx4 v20, s[48:51], s58 offen nt lds
  s_add_u32 m0, s60, 15360
  s_xor_b32 s58, s75, 983040
  buffer_load_dwordx4 v21, s[48:51], s58 offen nt lds
L_f_w_6e:
  s_mov_b32 s76, 0x40000000
  v_and_b32 v32, 15, v0
  v_mov_b32 v33, 1
  s_lshl2_add_u32 s58, s44, s57
  s_cmp_ge_u32 s58, 4
  s_cbranch_scc1 L_f_nogate
  s_mov_b64 s[4:5], s[8:9]
  s_mov_b64 s[6:7], s[34:35]
  v_lshrrev_b32 v4, 4, v0
  v_lshlrev_b32 v4, 4, v4
  v_lshl_add_u32 v5, v32, 10, v4
  s_lshl2_add_u32 s77, s56, s57
  s_lshl_b32 s58, s77, 14
  v_add_u32 v5, s58, v5
  global_load_dwordx4 v[64:67], v5, s[4:5] offset:0
  global_load_dwordx4 v[128:131], v4, s[6:7] offset:0
  global_load_dwordx4 v[68:71], v5, s[4:5] offset:64
  global_load_dwordx4 v[132:135], v4, s[6:7] offset:64
  global_load_dwordx4 v[72:75], v5, s[4:5] offset:128
  global_load_dwordx4 v[136:139], v4, s[6:7] offset:128
  global_load_dwordx4 v[76:79], v5, s[4:5] offset:192
  global_load_dwordx4 v[140:143], v4, s[6:7] offset:192
  global_load_dwordx4 v[80:83], v5, s[4:5] offset:256
  global_load_dwordx4 v[144:147], v4, s[6:7] offset:256
  global_load_dwordx4 v[84:87], v5, s[4:5] offset:320
  global_load_dwordx4 v[148:151], v4, s[6:7] offset:320
  global_load_dwordx4 v[88:91], v5, s[4:5] offset:384
  global_load_dwordx4 v[152:155], v4, s[6:7] offset:384
  global_load_dwordx4 v[92:95], v5, s[4:5] offset:448
  global_load_dwordx4 v[156:159], v4, s[6:7] offset:448
  global_load_dwordx4 v[96:99], v5, s[4:5] offset:512
  global_load_dwordx4 v[160:163], v4, s[6:7] offset:512
  global_load_dwordx4 v[100:103], v5, s[4:5] offset:576
  global_load_dwordx4 v[164:167], v4, s[6:7] offset:576
  global_load_dwordx4 v[104:107], v5, s[4:5] offset:640
  global_load_dwordx4 v[168:171], v4, s[6:7] offset:640
  global_load_dwordx4 v[108:111], v5, s[4:5] offset:704
  global_load_dwordx4 v[172:175], v4, s[6:7] offset:704
  global_load_dwordx4 v[112:115], v5, s[4:5] offset:768
  global_load_dwordx4 v[176:179], v4, s[6:7] offset:768
  global_load_dwordx4 v[116:119], v5, s[4:5] offset:832
  global_load_dwordx4 v[180:183], v4, s[6:7] offset:832
  global_load_dwordx4 v[120:123], v5, s[4:5] offset:896
  global_load_dwordx4 v[184:187], v4, s[6:7] offset:896
  global_load_dwordx4 v[124:127], v5, s[4:5] offset:960
  global_load_dwordx4 v[188:191], v4, s[6:7] offset:960
  v_lshlrev_b32 v32, 2, v32
  s_lshl_b32 s77, s77, 6
  s_add_u32 s77, s77, 0xd0c0000
  s_lshr_b32 s76, s56, 2
  s_lshl_b32 s76, s76, 7
  s_add_u32 s76, s76, 0xd086400
L_f_nogate:
  v_lshrrev_b32 v3, 4, v0
  v_lshl_add_u32 v24, v3, 10, s60
  v_bfe_u32 v4, v0, 2, 2
  v_lshl_add_u32 v24, v4, 7, v24
  v_bfe_u32 v4, v0, 3, 2
  v_lshl_add_u32 v24, v4, 5, v24
  v_and_b32 v4, 3, v0
  v_lshl_add_u32 v24, v4, 3, v24
  v_and_b32 v4, 15, v0
  v_xor_b32 v3, v3, v4
  v_lshlrev_b32 v3, 4, v3
  v_lshl_add_u32 v16, v4, 10, v3
  s_lshl1_add_u32 s58, s78, s59
  s_lshl_b32 s58, s58, 7
  v_xor_b32 v8, s58, v2
  s_lshl_b32 s62, s72, 24
  s_lshl_b32 s58, s56, 19
  s_add_u32 s62, s62, s58
  s_lshl_b32 s58, s59, 12
  s_add_u32 s62, s62, s58
  s_add_u32 s65, s62, 0x0
  s_mov_b32 s62, 0x40000000
  s_lshl_b32 s58, s57, 2
  s_cmp_eq_u32 s57, 6
  s_cselect_b32 s58, 0x1000, s58
  s_lshl_b32 s64, s56, 7
  s_add_u32 s64, s64, s58
  s_add_u32 s64, s64, 0xd080000
  s_cmp_eq_u32 s44, 0
  s_cselect_b32 s64, s64, 0x40000000
  v_xor_b32 v25, 32, v24
  v_xor_b32 v17, 64, v16
  v_xor_b32 v26, 64, v24
  v_xor_b32 v18, 128, v16
  v_xor_b32 v27, 96, v24
  v_xor_b32 v19, 192, v16
  v_xor_b32 v9, 16, v8
  v_xor_b32 v10, 32, v8
  v_xor_b32 v11, 48, v8
  v_xor_b32 v12, 64, v8
  v_xor_b32 v13, 80, v8
  v_xor_b32 v14, 96, v8
  v_xor_b32 v15, 112, v8
  s_lshl_b32 s66, s44, 13
  s_mov_b32 s71, s66
  s_and_b32 s61, s73, 7
  s_lshl_b32 s61, s61, 18
  s_add_u32 s61, s61, s71
  s_mov_b32 s70, 0
  s_mov_b32 s63, 0
  s_mov_b32 s68, 0
  s_lshl2_add_u32 s79, s56, s44
  s_lshl_b32 s79, s79, 10
  s_add_u32 s79, s79, 0xc020000
  v_mov_b64 v[36:37], -1
  v_mov_b64 v[38:39], -1
  s_waitcnt vmcnt(12)
  ds_read_b64_tr_b16 a[0:1], v24 offset:0
  ds_read_b64_tr_b16 a[2:3], v24 offset:512
  ds_read_b64_tr_b16 a[64:65], v25 offset:0
  ds_read_b64_tr_b16 a[66:67], v25 offset:512
  ds_read_b64_tr_b16 a[128:129], v26 offset:0
  ds_read_b64_tr_b16 a[130:131], v26 offset:512
  ds_read_b64_tr_b16 a[192:193], v27 offset:0
  ds_read_b64_tr_b16 a[194:195], v27 offset:512
  s_waitcnt lgkmcnt(0)
  s_cmp_lt_u32 s72, 3
  s_cbranch_scc1 L_f_w_7
  s_add_u32 m0, s60, 0
  s_xor_b32 s58, s75, 1048576
  buffer_load_dwordx4 v20, s[48:51], s58 offen  lds
  s_add_u32 m0, s60, 1024
  s_xor_b32 s58, s75, 1114112
  buffer_load_dwordx4 v21, s[48:51], s58 offen  lds
  s_add_u32 m0, s60, 2048
  s_xor_b32 s58, s75, 1179648
  buffer_load_dwordx4 v20, s[48:51], s58 offen  lds
  s_add_u32 m0, s60, 3072
  s_xor_b32 s58, s75, 1245184
  buffer_load_dwordx4 v21, s[48:51], s58 offen  lds
  s_branch L_f_w_7e
L_f_w_7:
  s_add_u32 m0, s60, 0
  s_xor_b32 s58, s75, 1048576
  buffer_load_dwordx4 v20, s[48:51], s58 offen nt lds
  s_add_u32 m0, s60, 1024
  s_xor_b32 s58, s75, 1114112
  buffer_load_dwordx4 v21, s[48:51], s58 offen nt lds
  s_add_u32 m0, s60, 2048
  s_xor_b32 s58, s75, 1179648
  buffer_load_dwordx4 v20, s[48:51], s58 offen nt lds
  s_add_u32 m0, s60, 3072
  s_xor_b32 s58, s75, 1245184
  buffer_load_dwordx4 v21, s[48:51], s58 offen nt lds
L_f_w_7e:
  s_waitcnt vmcnt(12)
  ds_read_b64_tr_b16 a[4:5], v24 offset:4096
  ds_read_b64_tr_b16 a[6:7], v24 offset:4608
  ds_read_b64_tr_b16 a[68:69], v25 offset:4096
  ds_read_b64_tr_b16 a[70:71], v25 offset:4608
  ds_read_b64_tr_b16 a[132:133], v26 offset:4096
  ds_read_b64_tr_b16 a[134:135], v26 offset:4608
  ds_read_b64_tr_b16 a[196:197], v27 offset:4096
  ds_read_b64_tr_b16 a[198:199], v27 offset:4608
  s_waitcnt lgkmcnt(0)
  s_cmp_lt_u32 s72, 3
  s_cbranch_scc1 L_f_w_8
  s_add_u32 m0, s60, 4096
  s_xor_b32 s58, s75, 1310720
  buffer_load_dwordx4 v20, s[48:51], s58 offen  lds
  s_add_u32 m0, s60, 5120
  s_xor_b32 s58, s75, 1376256
  buffer_load_dwordx4 v21, s[48:51], s58 offen  lds
  s_add_u32 m0, s60, 6144
  s_xor_b32 s58, s75, 1441792
  buffer_load_dwordx4 v20, s[48:51], s58 offen  lds
  s_add_u32 m0, s60, 7168
  s_xor_b32 s58, s75, 1507328
  buffer_load_dwordx4 v21, s[48:51], s58 offen  lds
  s_branch L_f_w_8e
L_f_w_8:
  s_add_u32 m0, s60, 4096
  s_xor_b32 s58, s75, 1310720
  buffer_load_dwordx4 v20, s[48:51], s58 offen nt lds
  s_add_u32 m0, s60, 5120
  s_xor_b32 s58, s75, 1376256
  buffer_load_dwordx4 v21, s[48:51], s58 offen nt lds
  s_add_u32 m0, s60, 6144
  s_xor_b32 s58, s75, 1441792
  buffer_load_dwordx4 v20, s[48:51], s58 offen nt lds
  s_add_u32 m0, s60, 7168
  s_xor_b32 s58, s75, 1507328
  buffer_load_dwordx4 v21, s[48:51], s58 offen nt lds
L_f_w_8e:
  s_waitcnt vmcnt(12)
  ds_read_b64_tr_b16 a[8:9], v24 offset:8192
  ds_read_b64_tr_b16 a[10:11], v24 offset:8704
  ds_read_b64_tr_b16 a[72:73], v25 offset:8192
  ds_read_b64_tr_b16 a[74:75], v25 offset:8704
  ds_read_b64_tr_b16 a[136:137], v26 offset:8192
  ds_read_b64_tr_b16 a[138:139], v26 offset:8704
  ds_read_b64_tr_b16 a[200:201], v27 offset:8192
  ds_read_b64_tr_b16 a[202:203], v27 offset:8704
  s_waitcnt lgkmcnt(0)
  s_cmp_lt_u32 s72, 3
  s_cbranch_scc1 L_f_w_9
  s_add_u32 m0, s60, 8192
  s_xor_b32 s58, s75, 1572864
  buffer_load_dwordx4 v20, s[48:51], s58 offen  lds
  s_add_u32 m0, s60, 9216
  s_xor_b32 s58, s75, 1638400
  buffer_load_dwordx4 v21, s[48:51], s58 offen  lds
  s_add_u32 m0, s60, 10240
  s_xor_b32 s58, s75, 1703936
  buffer_load_dwordx4 v20, s[48:51], s58 offen  lds
  s_add_u32 m0, s60, 11264
  s_xor_b32 s58, s75, 1769472
  buffer_load_dwordx4 v21, s[48:51], s58 offen  lds
  s_branch L_f_w_9e
L_f_w_9:
  s_add_u32 m0, s60, 8192
  s_xor_b32 s58, s75, 1572864
  buffer_load_dwordx4 v20, s[48:51], s58 offen nt lds
  s_add_u32 m0, s60, 9216
  s_xor_b32 s58, s75, 1638400
  buffer_load_dwordx4 v21, s[48:51], s58 offen nt lds
  s_add_u32 m0, s60, 10240
  s_xor_b32 s58, s75, 1703936
  buffer_load_dwordx4 v20, s[48:51], s58 offen nt lds
  s_add_u32 m0, s60, 11264
  s_xor_b32 s58, s75, 1769472
  buffer_load_dwordx4 v21, s[48:51], s58 offen nt lds
L_f_w_9e:
  s_waitcnt vmcnt(12)
  ds_read_b64_tr_b16 a[12:13], v24 offset:12288
  ds_read_b64_tr_b16 a[14:15], v24 offset:12800
  ds_read_b64_tr_b16 a[76:77], v25 offset:12288
  ds_read_b64_tr_b16 a[78:79], v25 offset:12800
  ds_read_b64_tr_b16 a[140:141], v26 offset:12288
  ds_read_b64_tr_b16 a[142:143], v26 offset:12800
  ds_read_b64_tr_b16 a[204:205], v27 offset:12288
  ds_read_b64_tr_b16 a[206:207], v27 offset:12800
  s_waitcnt lgkmcnt(0)
  s_cmp_lt_u32 s72, 3
  s_cbranch_scc1 L_f_w_10
  s_add_u32 m0, s60, 12288
  s_xor_b32 s58, s75, 1835008
  buffer_load_dwordx4 v20, s[48:51], s58 offen  lds
  s_add_u32 m0, s60, 13312
  s_xor_b32 s58, s75, 1900544
  buffer_load_dwordx4 v21, s[48:51], s58 offen  lds
  s_add_u32 m0, s60, 14336
  s_xor_b32 s58, s75, 1966080
  buffer_load_dwordx4 v20, s[48:51], s58 offen  lds
  s_add_u32 m0, s60, 15360
  s_xor_b32 s58, s75, 2031616
  buffer_load_dwordx4 v21, s[48:51], s58 offen  lds
  s_branch L_f_w_10e
L_f_w_10:
  s_add_u32 m0, s60, 12288
  s_xor_b32 s58, s75, 1835008
  buffer_load_dwordx4 v20, s[48:51], s58 offen nt lds
  s_add_u32 m0, s60, 13312
  s_xor_b32 s58, s75, 1900544
  buffer_load_dwordx4 v21, s[48:51], s58 offen nt lds
  s_add_u32 m0, s60, 14336
  s_xor_b32 s58, s75, 1966080
  buffer_load_dwordx4 v20, s[48:51], s58 offen nt lds
  s_add_u32 m0, s60, 15360
  s_xor_b32 s58, s75, 2031616
  buffer_load_dwordx4 v21, s[48:51], s58 offen nt lds
L_f_w_10e:
  s_waitcnt vmcnt(12)
  ds_read_b64_tr_b16 a[16:17], v24 offset:0
  ds_read_b64_tr_b16 a[18:19], v24 offset:512
  ds_read_b64_tr_b16 a[80:81], v25 offset:0
  ds_read_b64_tr_b16 a[82:83], v25 offset:512
  ds_read_b64_tr_b16 a[144:145], v26 offset:0
  ds_read_b64_tr_b16 a[146:147], v26 offset:512
  ds_read_b64_tr_b16 a[208:209], v27 offset:0
  ds_read_b64_tr_b16 a[210:211], v27 offset:512
  s_waitcnt lgkmcnt(0)
  s_cmp_lt_u32 s72, 3
  s_cbranch_scc1 L_f_w_11
  s_add_u32 m0, s60, 0
  s_xor_b32 s58, s75, 2097152
  buffer_load_dwordx4 v20, s[48:51], s58 offen  lds
  s_add_u32 m0, s60, 1024
  s_xor_b32 s58, s75, 2162688
  buffer_load_dwordx4 v21, s[48:51], s58 offen  lds
  s_add_u32 m0, s60, 2048
  s_xor_b32 s58, s75, 2228224
  buffer_load_dwordx4 v20, s[48:51], s58 offen  lds
  s_add_u32 m0, s60, 3072
  s_xor_b32 s58, s75, 2293760
  buffer_load_dwordx4 v21, s[48:51], s58 offen  lds
  s_branch L_f_w_11e
L_f_w_11:
  s_add_u32 m0, s60, 0
  s_xor_b32 s58, s75, 2097152
  buffer_load_dwordx4 v20, s[48:51], s58 offen nt lds
  s_add_u32 m0, s60, 1024
  s_xor_b32 s58, s75, 2162688
  buffer_load_dwordx4 v21, s[48:51], s58 offen nt lds
  s_add_u32 m0, s60, 2048
  s_xor_b32 s58, s75, 2228224
  buffer_load_dwordx4 v20, s[48:51], s58 offen nt lds
  s_add_u32 m0, s60, 3072
  s_xor_b32 s58, s75, 2293760
  buffer_load_dwordx4 v21, s[48:51], s58 offen nt lds
L_f_w_11e:
  s_waitcnt vmcnt(12)
  ds_read_b64_tr_b16 a[20:21], v24 offset:4096
  ds_read_b64_tr_b16 a[22:23], v24 offset:4608
  ds_read_b64_tr_b16 a[84:85], v25 offset:4096
  ds_read_b64_tr_b16 a[86:87], v25 offset:4608
  ds_read_b64_tr_b16 a[148:149], v26 offset:4096
  ds_read_b64_tr_b16 a[150:151], v26 offset:4608
  ds_read_b64_tr_b16 a[212:213], v27 offset:4096
  ds_read_b64_tr_b16 a[214:215], v27 offset:4608
  s_waitcnt lgkmcnt(0)
  s_cmp_lt_u32 s72, 3
  s_cbranch_scc1 L_f_w_12
  s_add_u32 m0, s60, 4096
  s_xor_b32 s58, s75, 2359296
  buffer_load_dwordx4 v20, s[48:51], s58 offen  lds
  s_add_u32 m0, s60, 5120
  s_xor_b32 s58, s75, 2424832
  buffer_load_dwordx4 v21, s[48:51], s58 offen  lds
  s_add_u32 m0, s60, 6144
  s_xor_b32 s58, s75, 2490368
  buffer_load_dwordx4 v20, s[48:51], s58 offen  lds
  s_add_u32 m0, s60, 7168
  s_xor_b32 s58, s75, 2555904
  buffer_load_dwordx4 v21, s[48:51], s58 offen  lds
  s_branch L_f_w_12e
L_f_w_12:
  s_add_u32 m0, s60, 4096
  s_xor_b32 s58, s75, 2359296
  buffer_load_dwordx4 v20, s[48:51], s58 offen nt lds
  s_add_u32 m0, s60, 5120
  s_xor_b32 s58, s75, 2424832
  buffer_load_dwordx4 v21, s[48:51], s58 offen nt lds
  s_add_u32 m0, s60, 6144
  s_xor_b32 s58, s75, 2490368
  buffer_load_dwordx4 v20, s[48:51], s58 offen nt lds
  s_add_u32 m0, s60, 7168
  s_xor_b32 s58, s75, 2555904
  buffer_load_dwordx4 v21, s[48:51], s58 offen nt lds
L_f_w_12e:
  s_waitcnt vmcnt(12)
  ds_read_b64_tr_b16 a[24:25], v24 offset:8192
  ds_read_b64_tr_b16 a[26:27], v24 offset:8704
  ds_read_b64_tr_b16 a[88:89], v25 offset:8192
  ds_read_b64_tr_b16 a[90:91], v25 offset:8704
  ds_read_b64_tr_b16 a[152:153], v26 offset:8192
  ds_read_b64_tr_b16 a[154:155], v26 offset:8704
  ds_read_b64_tr_b16 a[216:217], v27 offset:8192
  ds_read_b64_tr_b16 a[218:219], v27 offset:8704
  s_waitcnt lgkmcnt(0)
  s_cmp_lt_u32 s72, 3
  s_cbranch_scc1 L_f_w_13
  s_add_u32 m0, s60, 8192
  s_xor_b32 s58, s75, 2621440
  buffer_load_dwordx4 v20, s[48:51], s58 offen  lds
  s_add_u32 m0, s60, 9216
  s_xor_b32 s58, s75, 2686976
  buffer_load_dwordx4 v21, s[48:51], s58 offen  lds
  s_add_u32 m0, s60, 10240
  s_xor_b32 s58, s75, 2752512
  buffer_load_dwordx4 v20, s[48:51], s58 offen  lds
  s_add_u32 m0, s60, 11264
  s_xor_b32 s58, s75, 2818048
  buffer_load_dwordx4 v21, s[48:51], s58 offen  lds
  s_branch L_f_w_13e
L_f_w_13:
  s_add_u32 m0, s60, 8192
  s_xor_b32 s58, s75, 2621440
  buffer_load_dwordx4 v20, s[48:51], s58 offen nt lds
  s_add_u32 m0, s60, 9216
  s_xor_b32 s58, s75, 2686976
  buffer_load_dwordx4 v21, s[48:51], s58 offen nt lds
  s_add_u32 m0, s60, 10240
  s_xor_b32 s58, s75, 2752512
  buffer_load_dwordx4 v20, s[48:51], s58 offen nt lds
  s_add_u32 m0, s60, 11264
  s_xor_b32 s58, s75, 2818048
  buffer_load_dwordx4 v21, s[48:51], s58 offen nt lds
L_f_w_13e:
  s_waitcnt vmcnt(12)
  ds_read_b64_tr_b16 a[28:29], v24 offset:12288
  ds_read_b64_tr_b16 a[30:31], v24 offset:12800
  ds_read_b64_tr_b16 a[92:93], v25 offset:12288
  ds_read_b64_tr_b16 a[94:95], v25 offset:12800
  ds_read_b64_tr_b16 a[156:157], v26 offset:12288
  ds_read_b64_tr_b16 a[158:159], v26 offset:12800
  ds_read_b64_tr_b16 a[220:221], v27 offset:12288
  ds_read_b64_tr_b16 a[222:223], v27 offset:12800
  s_waitcnt lgkmcnt(0)
  s_cmp_lt_u32 s72, 3
  s_cbranch_scc1 L_f_w_14
  s_add_u32 m0, s60, 12288
  s_xor_b32 s58, s75, 2883584
  buffer_load_dwordx4 v20, s[48:51], s58 offen  lds
  s_add_u32 m0, s60, 13312
  s_xor_b32 s58, s75, 2949120
  buffer_load_dwordx4 v21, s[48:51], s58 offen  lds
  s_add_u32 m0, s60, 14336
  s_xor_b32 s58, s75, 3014656
  buffer_load_dwordx4 v20, s[48:51], s58 offen  lds
  s_add_u32 m0, s60, 15360
  s_xor_b32 s58, s75, 3080192
  buffer_load_dwordx4 v21, s[48:51], s58 offen  lds
  s_branch L_f_w_14e
L_f_w_14:
  s_add_u32 m0, s60, 12288
  s_xor_b32 s58, s75, 2883584
  buffer_load_dwordx4 v20, s[48:51], s58 offen nt lds
  s_add_u32 m0, s60, 13312
  s_xor_b32 s58, s75, 2949120
  buffer_load_dwordx4 v21, s[48:51], s58 offen nt lds
  s_add_u32 m0, s60, 14336
  s_xor_b32 s58, s75, 3014656
  buffer_load_dwordx4 v20, s[48:51], s58 offen nt lds
  s_add_u32 m0, s60, 15360
  s_xor_b32 s58, s75, 3080192
  buffer_load_dwordx4 v21, s[48:51], s58 offen nt lds
L_f_w_14e:
  s_waitcnt vmcnt(12)
  ds_read_b64_tr_b16 a[32:33], v24 offset:0
  ds_read_b64_tr_b16 a[34:35], v24 offset:512
  ds_read_b64_tr_b16 a[96:97], v25 offset:0
  ds_read_b64_tr_b16 a[98:99], v25 offset:512
  ds_read_b64_tr_b16 a[160:161], v26 offset:0
  ds_read_b64_tr_b16 a[162:163], v26 offset:512
  ds_read_b64_tr_b16 a[224:225], v27 offset:0
  ds_read_b64_tr_b16 a[226:227], v27 offset:512
  s_waitcnt lgkmcnt(0)
  s_cmp_lt_u32 s72, 3
  s_cbranch_scc1 L_f_w_15
  s_add_u32 m0, s60, 0
  s_xor_b32 s58, s75, 3145728
  buffer_load_dwordx4 v20, s[48:51], s58 offen  lds
  s_add_u32 m0, s60, 1024
  s_xor_b32 s58, s75, 3211264
  buffer_load_dwordx4 v21, s[48:51], s58 offen  lds
  s_add_u32 m0, s60, 2048
  s_xor_b32 s58, s75, 3276800
  buffer_load_dwordx4 v20, s[48:51], s58 offen  lds
  s_add_u32 m0, s60, 3072
  s_xor_b32 s58, s75, 3342336
  buffer_load_dwordx4 v21, s[48:51], s58 offen  lds
  s_branch L_f_w_15e
L_f_w_15:
  s_add_u32 m0, s60, 0
  s_xor_b32 s58, s75, 3145728
  buffer_load_dwordx4 v20, s[48:51], s58 offen nt lds
  s_add_u32 m0, s60, 1024
  s_xor_b32 s58, s75, 3211264
  buffer_load_dwordx4 v21, s[48:51], s58 offen nt lds
  s_add_u32 m0, s60, 2048
  s_xor_b32 s58, s75, 3276800
  buffer_load_dwordx4 v20, s[48:51], s58 offen nt lds
  s_add_u32 m0, s60, 3072
  s_xor_b32 s58, s75, 3342336
  buffer_load_dwordx4 v21, s[48:51], s58 offen nt lds
L_f_w_15e:
  s_waitcnt vmcnt(12)
  ds_read_b64_tr_b16 a[36:37], v24 offset:4096
  ds_read_b64_tr_b16 a[38:39], v24 offset:4608
  ds_read_b64_tr_b16 a[100:101], v25 offset:4096
  ds_read_b64_tr_b16 a[102:103], v25 offset:4608
  ds_read_b64_tr_b16 a[164:165], v26 offset:4096
  ds_read_b64_tr_b16 a[166:167], v26 offset:4608
  ds_read_b64_tr_b16 a[228:229], v27 offset:4096
  ds_read_b64_tr_b16 a[230:231], v27 offset:4608
  s_waitcnt lgkmcnt(0)
  s_cmp_lt_u32 s72, 3
  s_cbranch_scc1 L_f_w_16
  s_add_u32 m0, s60, 4096
  s_xor_b32 s58, s75, 3407872
  buffer_load_dwordx4 v20, s[48:51], s58 offen  lds
  s_add_u32 m0, s60, 5120
  s_xor_b32 s58, s75, 3473408
  buffer_load_dwordx4 v21, s[48:51], s58 offen  lds
  s_add_u32 m0, s60, 6144
  s_xor_b32 s58, s75, 3538944
  buffer_load_dwordx4 v20, s[48:51], s58 offen  lds
  s_add_u32 m0, s60, 7168
  s_xor_b32 s58, s75, 3604480
  buffer_load_dwordx4 v21, s[48:51], s58 offen  lds
  s_branch L_f_w_16e
L_f_w_16:
  s_add_u32 m0, s60, 4096
  s_xor_b32 s58, s75, 3407872
  buffer_load_dwordx4 v20, s[48:51], s58 offen nt lds
  s_add_u32 m0, s60, 5120
  s_xor_b32 s58, s75, 3473408
  buffer_load_dwordx4 v21, s[48:51], s58 offen nt lds
  s_add_u32 m0, s60, 6144
  s_xor_b32 s58, s75, 3538944
  buffer_load_dwordx4 v20, s[48:51], s58 offen nt lds
  s_add_u32 m0, s60, 7168
  s_xor_b32 s58, s75, 3604480
  buffer_load_dwordx4 v21, s[48:51], s58 offen nt lds
L_f_w_16e:
  s_waitcnt vmcnt(12)
  ds_read_b64_tr_b16 a[40:41], v24 offset:8192
  ds_read_b64_tr_b16 a[42:43], v24 offset:8704
  ds_read_b64_tr_b16 a[104:105], v25 offset:8192
  ds_read_b64_tr_b16 a[106:107], v25 offset:8704
  ds_read_b64_tr_b16 a[168:169], v26 offset:8192
  ds_read_b64_tr_b16 a[170:171], v26 offset:8704
  ds_read_b64_tr_b16 a[232:233], v27 offset:8192
  ds_read_b64_tr_b16 a[234:235], v27 offset:8704
  s_waitcnt lgkmcnt(0)
  s_cmp_lt_u32 s72, 3
  s_cbranch_scc1 L_f_w_17
  s_add_u32 m0, s60, 8192
  s_xor_b32 s58, s75, 3670016
  buffer_load_dwordx4 v20, s[48:51], s58 offen  lds
  s_add_u32 m0, s60, 9216
  s_xor_b32 s58, s75, 3735552
  buffer_load_dwordx4 v21, s[48:51], s58 offen  lds
  s_add_u32 m0, s60, 10240
  s_xor_b32 s58, s75, 3801088
  buffer_load_dwordx4 v20, s[48:51], s58 offen  lds
  s_add_u32 m0, s60, 11264
  s_xor_b32 s58, s75, 3866624
  buffer_load_dwordx4 v21, s[48:51], s58 offen  lds
  s_branch L_f_w_17e
L_f_w_17:
  s_add_u32 m0, s60, 8192
  s_xor_b32 s58, s75, 3670016
  buffer_load_dwordx4 v20, s[48:51], s58 offen nt lds
  s_add_u32 m0, s60, 9216
  s_xor_b32 s58, s75, 3735552
  buffer_load_dwordx4 v21, s[48:51], s58 offen nt lds
  s_add_u32 m0, s60, 10240
  s_xor_b32 s58, s75, 3801088
  buffer_load_dwordx4 v20, s[48:51], s58 offen nt lds
  s_add_u32 m0, s60, 11264
  s_xor_b32 s58, s75, 3866624
  buffer_load_dwordx4 v21, s[48:51], s58 offen nt lds
L_f_w_17e:
  s_waitcnt vmcnt(12)
  ds_read_b64_tr_b16 a[44:45], v24 offset:12288
  ds_read_b64_tr_b16 a[46:47], v24 offset:12800
  ds_read_b64_tr_b16 a[108:109], v25 offset:12288
  ds_read_b64_tr_b16 a[110:111], v25 offset:12800
  ds_read_b64_tr_b16 a[172:173], v26 offset:12288
  ds_read_b64_tr_b16 a[174:175], v26 offset:12800
  ds_read_b64_tr_b16 a[236:237], v27 offset:12288
  ds_read_b64_tr_b16 a[238:239], v27 offset:12800
  s_waitcnt lgkmcnt(0)
  s_cmp_lt_u32 s72, 3
  s_cbranch_scc1 L_f_w_18
  s_add_u32 m0, s60, 12288
  s_xor_b32 s58, s75, 3932160
  buffer_load_dwordx4 v20, s[48:51], s58 offen  lds
  s_add_u32 m0, s60, 13312
  s_xor_b32 s58, s75, 3997696
  buffer_load_dwordx4 v21, s[48:51], s58 offen  lds
  s_add_u32 m0, s60, 14336
  s_xor_b32 s58, s75, 4063232
  buffer_load_dwordx4 v20, s[48:51], s58 offen  lds
  s_add_u32 m0, s60, 15360
  s_xor_b32 s58, s75, 4128768
  buffer_load_dwordx4 v21, s[48:51], s58 offen  lds
  s_branch L_f_w_18e
L_f_w_18:
  s_add_u32 m0, s60, 12288
  s_xor_b32 s58, s75, 3932160
  buffer_load_dwordx4 v20, s[48:51], s58 offen nt lds
  s_add_u32 m0, s60, 13312
  s_xor_b32 s58, s75, 3997696
  buffer_load_dwordx4 v21, s[48:51], s58 offen nt lds
  s_add_u32 m0, s60, 14336
  s_xor_b32 s58, s75, 4063232
  buffer_load_dwordx4 v20, s[48:51], s58 offen nt lds
  s_add_u32 m0, s60, 15360
  s_xor_b32 s58, s75, 4128768
  buffer_load_dwordx4 v21, s[48:51], s58 offen nt lds
L_f_w_18e:
  s_waitcnt vmcnt(12)
  ds_read_b64_tr_b16 a[48:49], v24 offset:0
  ds_read_b64_tr_b16 a[50:51], v24 offset:512
  ds_read_b64_tr_b16 a[112:113], v25 offset:0
  ds_read_b64_tr_b16 a[114:115], v25 offset:512
  ds_read_b64_tr_b16 a[176:177], v26 offset:0
  ds_read_b64_tr_b16 a[178:179], v26 offset:512
  ds_read_b64_tr_b16 a[240:241], v27 offset:0
  ds_read_b64_tr_b16 a[242:243], v27 offset:512
  s_mov_b32 s48, s38
  s_and_b32 s49, s39, 0xffff
  s_mov_b32 s50, 0x100
  s_mov_b32 s51, 0x20000
  buffer_load_dword v3, v6, s[48:51], 0 offen sc1
  s_add_u32 m0, s66, 0
  s_add_u32 s58, s61, 0
  buffer_load_dwordx4 v8, s[52:55], s58 offen lds
  s_add_u32 m0, s66, 1024
  s_add_u32 s58, s61, 1024
  buffer_load_dwordx4 v9, s[52:55], s58 offen lds
  s_add_u32 m0, s66, 2048
  s_add_u32 s58, s61, 2048
  buffer_load_dwordx4 v10, s[52:55], s58 offen lds
  s_add_u32 m0, s66, 3072
  s_add_u32 s58, s61, 3072
  buffer_load_dwordx4 v11, s[52:55], s58 offen lds
  s_add_u32 m0, s66, 4096
  s_add_u32 s58, s61, 4096
  buffer_load_dwordx4 v12, s[52:55], s58 offen lds
  s_add_u32 m0, s66, 5120
  s_add_u32 s58, s61, 5120
  buffer_load_dwordx4 v13, s[52:55], s58 offen lds
  s_add_u32 m0, s66, 6144
  s_add_u32 s58, s61, 6144
  buffer_load_dwordx4 v14, s[52:55], s58 offen lds
  s_add_u32 m0, s66, 7168
  s_add_u32 s58, s61, 7168
  buffer_load_dwordx4 v15, s[52:55], s58 offen lds
  s_add_u32 s70, s70, 1
  s_lshr_b32 s61, s70, 3
  s_lshl_b32 s61, s61, 2
  s_lshr_b32 s61, s73, s61
  s_and_b32 s61, s61, 7
  s_and_b32 s59, s70, 7
  s_lshl3_add_u32 s61, s61, s59
  s_lshl_b32 s61, s61, 15
  s_add_u32 s61, s61, s71
  s_add_u32 s66, s66, 0x8000
  s_and_b32 s66, s66, 0x1ffff
  s_waitcnt vmcnt(17)
  ds_read_b64_tr_b16 a[52:53], v24 offset:4096
  ds_read_b64_tr_b16 a[54:55], v24 offset:4608
  ds_read_b64_tr_b16 a[116:117], v25 offset:4096
  ds_read_b64_tr_b16 a[118:119], v25 offset:4608
  ds_read_b64_tr_b16 a[180:181], v26 offset:4096
  ds_read_b64_tr_b16 a[182:183], v26 offset:4608
  ds_read_b64_tr_b16 a[244:245], v27 offset:4096
  ds_read_b64_tr_b16 a[246:247], v27 offset:4608
  s_add_u32 m0, s66, 0
  s_add_u32 s58, s61, 0
  buffer_load_dwordx4 v8, s[52:55], s58 offen lds
  s_add_u32 m0, s66, 1024
  s_add_u32 s58, s61, 1024
  buffer_load_dwordx4 v9, s[52:55], s58 offen lds
  s_add_u32 m0, s66, 2048
  s_add_u32 s58, s61, 2048
  buffer_load_dwordx4 v10, s[52:55], s58 offen lds
  s_add_u32 m0, s66, 3072
  s_add_u32 s58, s61, 3072
  buffer_load_dwordx4 v11, s[52:55], s58 offen lds
  s_add_u32 m0, s66, 4096
  s_add_u32 s58, s61, 4096
  buffer_load_dwordx4 v12, s[52:55], s58 offen lds
  s_add_u32 m0, s66, 5120
  s_add_u32 s58, s61, 5120
  buffer_load_dwordx4 v13, s[52:55], s58 offen lds
  s_add_u32 m0, s66, 6144
  s_add_u32 s58, s61, 6144
  buffer_load_dwordx4 v14, s[52:55], s58 offen lds
  s_add_u32 m0, s66, 7168
  s_add_u32 s58, s61, 7168
  buffer_load_dwordx4 v15, s[52:55], s58 offen lds
  s_add_u32 s70, s70, 1
  s_lshr_b32 s61, s70, 3
  s_lshl_b32 s61, s61, 2
  s_lshr_b32 s61, s73, s61
  s_and_b32 s61, s61, 7
  s_and_b32 s59, s70, 7
  s_lshl3_add_u32 s61, s61, s59
  s_lshl_b32 s61, s61, 15
  s_add_u32 s61, s61, s71
  s_add_u32 s66, s66, 0x8000
  s_and_b32 s66, s66, 0x1ffff
  s_waitcnt vmcnt(21)
  ds_read_b64_tr_b16 a[56:57], v24 offset:8192
  ds_read_b64_tr_b16 a[58:59], v24 offset:8704
  ds_read_b64_tr_b16 a[120:121], v25 offset:8192
  ds_read_b64_tr_b16 a[122:123], v25 offset:8704
  ds_read_b64_tr_b16 a[184:185], v26 offset:8192
  ds_read_b64_tr_b16 a[186:187], v26 offset:8704
  ds_read_b64_tr_b16 a[248:249], v27 offset:8192
  ds_read_b64_tr_b16 a[250:251], v27 offset:8704
  s_add_u32 m0, s66, 0
  s_add_u32 s58, s61, 0
  buffer_load_dwordx4 v8, s[52:55], s58 offen lds
  s_add_u32 m0, s66, 1024
  s_add_u32 s58, s61, 1024
  buffer_load_dwordx4 v9, s[52:55], s58 offen lds
  s_add_u32 m0, s66, 2048
  s_add_u32 s58, s61, 2048
  buffer_load_dwordx4 v10, s[52:55], s58 offen lds
  s_add_u32 m0, s66, 3072
  s_add_u32 s58, s61, 3072
  buffer_load_dwordx4 v11, s[52:55], s58 offen lds
  s_add_u32 m0, s66, 4096
  s_add_u32 s58, s61, 4096
  buffer_load_dwordx4 v12, s[52:55], s58 offen lds
  s_add_u32 m0, s66, 5120
  s_add_u32 s58, s61, 5120
  buffer_load_dwordx4 v13, s[52:55], s58 offen lds
  s_add_u32 m0, s66, 6144
  s_add_u32 s58, s61, 6144
  buffer_load_dwordx4 v14, s[52:55], s58 offen lds
  s_add_u32 m0, s66, 7168
  s_add_u32 s58, s61, 7168
  buffer_load_dwordx4 v15, s[52:55], s58 offen lds
  s_add_u32 s70, s70, 1
  s_lshr_b32 s61, s70, 3
  s_lshl_b32 s61, s61, 2
  s_lshr_b32 s61, s73, s61
  s_and_b32 s61, s61, 7
  s_and_b32 s59, s70, 7
  s_lshl3_add_u32 s61, s61, s59
  s_lshl_b32 s61, s61, 15
  s_add_u32 s61, s61, s71
  s_add_u32 s66, s66, 0x8000
  s_and_b32 s66, s66, 0x1ffff
  s_waitcnt vmcnt(25)
  ds_read_b64_tr_b16 a[60:61], v24 offset:12288
  ds_read_b64_tr_b16 a[62:63], v24 offset:12800
  ds_read_b64_tr_b16 a[124:125], v25 offset:12288
  ds_read_b64_tr_b16 a[126:127], v25 offset:12800
  ds_read_b64_tr_b16 a[188:189], v26 offset:12288
  ds_read_b64_tr_b16 a[190:191], v26 offset:12800
  ds_read_b64_tr_b16 a[252:253], v27 offset:12288
  ds_read_b64_tr_b16 a[254:255], v27 offset:12800
  s_cmp_eq_u32 s76, 0x40000000
  s_cbranch_scc1 L_f_nogate2
  v_mfma_f32_16x16x32_bf16 v[192:195], v[128:131], v[64:67], 0
  v_mfma_f32_16x16x32_bf16 v[192:195], v[132:135], v[68:71], v[192:195]
  v_mfma_f32_16x16x32_bf16 v[192:195], v[136:139], v[72:75], v[192:195]
  v_mfma_f32_16x16x32_bf16 v[192:195], v[140:143], v[76:79], v[192:195]
  v_mfma_f32_16x16x32_bf16 v[192:195], v[144:147], v[80:83], v[192:195]
  v_mfma_f32_16x16x32_bf16 v[192:195], v[148:151], v[84:87], v[192:195]
  v_mfma_f32_16x16x32_bf16 v[192:195], v[152:155], v[88:91], v[192:195]
  v_mfma_f32_16x16x32_bf16 v[192:195], v[156:159], v[92:95], v[192:195]
  v_mfma_f32_16x16x32_bf16 v[192:195], v[160:163], v[96:99], v[192:195]
  v_mfma_f32_16x16x32_bf16 v[192:195], v[164:167], v[100:103], v[192:195]
  v_mfma_f32_16x16x32_bf16 v[192:195], v[168:171], v[104:107], v[192:195]
  v_mfma_f32_16x16x32_bf16 v[192:195], v[172:175], v[108:111], v[192:195]
  v_mfma_f32_16x16x32_bf16 v[192:195], v[176:179], v[112:115], v[192:195]
  v_mfma_f32_16x16x32_bf16 v[192:195], v[180:183], v[116:119], v[192:195]
  v_mfma_f32_16x16x32_bf16 v[192:195], v[184:187], v[120:123], v[192:195]
  v_mfma_f32_16x16x32_bf16 v[192:195], v[188:191], v[124:127], v[192:195]
  s_nop 7
  v_mul_f32 v192, 0xbfb8aa3b, v192
  v_exp_f32 v192, v192
  s_nop 0
  v_add_f32 v192, 1.0, v192
  v_rcp_f32 v192, v192
  s_nop 0
  buffer_store_dword v192, v32, s[40:43], s77 offen sc1
L_f_nogate2:
  s_waitcnt vmcnt(16) lgkmcnt(0)
L_f_init:
  v_cmp_gt_u32 vcc, 32, v3
  s_cbranch_vccz L_f_go
  buffer_load_dword v3, v6, s[48:51], 0 offen sc1
  s_add_u32 s68, s68, 1
  s_cmp_gt_u32 s68, 1048576
  s_cbranch_scc1 L_exit
  s_waitcnt vmcnt(0)
  s_branch L_f_init
L_f_go:
  s_barrier
  ds_read_b128 v[64:67], v16 offset:0
  ds_read_b128 v[68:71], v16 offset:16384
  ds_read_b128 v[72:75], v17 offset:0
  ds_read_b128 v[76:79], v17 offset:16384
  ds_read_b128 v[80:83], v18 offset:0
  ds_read_b128 v[84:87], v18 offset:16384
  ds_read_b128 v[88:91], v19 offset:0
  ds_read_b128 v[92:95], v19 offset:16384
  s_cmp_lt_u32 s44, s74
  s_waitcnt lgkmcnt(0)
  s_cbranch_scc0 L_f_10
L_f_00:
  v_mfma_f32_16x16x32_bf16 v[128:131], a[0:3], v[64:67], 0
  v_mfma_f32_16x16x32_bf16 v[128:131], a[4:7], v[72:75], v[128:131]
  v_mfma_f32_16x16x32_bf16 v[128:131], a[8:11], v[80:83], v[128:131]
  ds_read_b128 v[96:99], v16 offset:256
  v_mfma_f32_16x16x32_bf16 v[128:131], a[12:15], v[88:91], v[128:131]
  s_cmp_lg_u32 s57, 6
  s_cbranch_scc1 L_f_pw_19
  buffer_store_dwordx4 v[36:39], v2, s[40:43], s79 offen sc1
  s_add_u32 s79, s79, 0x20000
L_f_pw_19:
  v_mfma_f32_16x16x32_bf16 v[136:139], a[0:3], v[68:71], 0
  ds_read_b128 v[100:103], v16 offset:16640
  v_mfma_f32_16x16x32_bf16 v[136:139], a[4:7], v[76:79], v[136:139]
  v_mfma_f32_16x16x32_bf16 v[136:139], a[8:11], v[84:87], v[136:139]
  ds_read_b128 v[104:107], v17 offset:256
  v_mfma_f32_16x16x32_bf16 v[136:139], a[12:15], v[92:95], v[136:139]
  v_mfma_f32_16x16x32_bf16 v[132:135], a[64:67], v[64:67], 0
  ds_read_b128 v[108:111], v17 offset:16640
  v_mfma_f32_16x16x32_bf16 v[132:135], a[68:71], v[72:75], v[132:135]
  v_mul_f32 v160, s69, v160
  v_mul_f32 v161, s69, v161
  v_mfma_f32_16x16x32_bf16 v[132:135], a[72:75], v[80:83], v[132:135]
  ds_read_b128 v[112:115], v18 offset:256
  v_mul_f32 v162, s69, v162
  v_mfma_f32_16x16x32_bf16 v[132:135], a[76:79], v[88:91], v[132:135]
  v_mul_f32 v163, s69, v163
  v_mul_f32 v164, s69, v164
  v_mfma_f32_16x16x32_bf16 v[140:143], a[64:67], v[68:71], 0
  ds_read_b128 v[116:119], v18 offset:16640
  v_mul_f32 v165, s69, v165
  v_mfma_f32_16x16x32_bf16 v[140:143], a[68:71], v[76:79], v[140:143]
  v_mul_f32 v166, s69, v166
  v_mul_f32 v167, s69, v167
  v_mfma_f32_16x16x32_bf16 v[140:143], a[72:75], v[84:87], v[140:143]
  ds_read_b128 v[120:123], v19 offset:256
  v_cvt_pk_bf16_f32 v192, v160, v161
  v_mfma_f32_16x16x32_bf16 v[140:143], a[76:79], v[92:95], v[140:143]
  v_cvt_pk_bf16_f32 v193, v162, v163
  v_cvt_pk_bf16_f32 v194, v164, v165
  v_mfma_f32_16x16x32_bf16 v[144:147], a[128:131], v[64:67], 0
  ds_read_b128 v[124:127], v19 offset:16640
  v_cvt_pk_bf16_f32 v195, v166, v167
  v_mfma_f32_16x16x32_bf16 v[144:147], a[132:135], v[72:75], v[144:147]
  buffer_store_dwordx4 v[192:195], v2, s[40:43], s62 offen offset:0 sc1
  v_mfma_f32_16x16x32_bf16 v[144:147], a[136:139], v[80:83], v[144:147]
  v_mul_f32 v168, s69, v168
  v_mul_f32 v169, s69, v169
  v_mfma_f32_16x16x32_bf16 v[144:147], a[140:143], v[88:91], v[144:147]
  v_mul_f32 v170, s69, v170
  v_mul_f32 v171, s69, v171
  v_mfma_f32_16x16x32_bf16 v[152:155], a[128:131], v[68:71], 0
  v_mul_f32 v172, s69, v172
  v_mul_f32 v173, s69, v173
  v_mfma_f32_16x16x32_bf16 v[152:155], a[132:135], v[76:79], v[152:155]
  v_mul_f32 v174, s69, v174
  v_mul_f32 v175, s69, v175
  v_mfma_f32_16x16x32_bf16 v[152:155], a[136:139], v[84:87], v[152:155]
  v_cvt_pk_bf16_f32 v196, v168, v169
  v_cvt_pk_bf16_f32 v197, v170, v171
  v_mfma_f32_16x16x32_bf16 v[152:155], a[140:143], v[92:95], v[152:155]
  v_cvt_pk_bf16_f32 v198, v172, v173
  v_cvt_pk_bf16_f32 v199, v174, v175
  v_mfma_f32_16x16x32_bf16 v[148:151], a[192:195], v[64:67], 0
  buffer_store_dwordx4 v[196:199], v2, s[40:43], s62 offen offset:1024 sc1
  v_mfma_f32_16x16x32_bf16 v[148:151], a[196:199], v[72:75], v[148:151]
  v_mul_f32 v176, s69, v176
  v_mul_f32 v177, s69, v177
  v_mfma_f32_16x16x32_bf16 v[148:151], a[200:203], v[80:83], v[148:151]
  v_mul_f32 v178, s69, v178
  v_mul_f32 v179, s69, v179
  v_mfma_f32_16x16x32_bf16 v[148:151], a[204:207], v[88:91], v[148:151]
  v_mul_f32 v180, s69, v180
  v_mul_f32 v181, s69, v181
  v_mfma_f32_16x16x32_bf16 v[156:159], a[192:195], v[68:71], 0
  v_mul_f32 v182, s69, v182
  v_mul_f32 v183, s69, v183
  v_mfma_f32_16x16x32_bf16 v[156:159], a[196:199], v[76:79], v[156:159]
  v_cvt_pk_bf16_f32 v200, v176, v177
  v_cvt_pk_bf16_f32 v201, v178, v179
  v_mfma_f32_16x16x32_bf16 v[156:159], a[200:203], v[84:87], v[156:159]
  v_cvt_pk_bf16_f32 v202, v180, v181
  v_cvt_pk_bf16_f32 v203, v182, v183
  v_mfma_f32_16x16x32_bf16 v[156:159], a[204:207], v[92:95], v[156:159]
  s_waitcnt lgkmcnt(0)
  buffer_store_dwordx4 v[200:203], v2, s[40:43], s62 offen offset:2048 sc1
  v_mfma_f32_16x16x32_bf16 v[128:131], a[16:19], v[96:99], v[128:131]
  v_mul_f32 v184, s69, v184
  v_mul_f32 v185, s69, v185
  v_mfma_f32_16x16x32_bf16 v[128:131], a[20:23], v[104:107], v[128:131]
  v_mul_f32 v186, s69, v186
  v_mul_f32 v187, s69, v187
  v_mfma_f32_16x16x32_bf16 v[128:131], a[24:27], v[112:115], v[128:131]
  ds_read_b128 v[64:67], v16 offset:512
  v_mul_f32 v188, s69, v188
  v_mfma_f32_16x16x32_bf16 v[128:131], a[28:31], v[120:123], v[128:131]
  v_mul_f32 v189, s69, v189
  v_mul_f32 v190, s69, v190
  v_mfma_f32_16x16x32_bf16 v[136:139], a[16:19], v[100:103], v[136:139]
  ds_read_b128 v[68:71], v16 offset:16896
  v_mul_f32 v191, s69, v191
  v_mfma_f32_16x16x32_bf16 v[136:139], a[20:23], v[108:111], v[136:139]
  v_cvt_pk_bf16_f32 v204, v184, v185
  v_cvt_pk_bf16_f32 v205, v186, v187
  v_mfma_f32_16x16x32_bf16 v[136:139], a[24:27], v[116:119], v[136:139]
  ds_read_b128 v[72:75], v17 offset:512
  v_cvt_pk_bf16_f32 v206, v188, v189
  v_mfma_f32_16x16x32_bf16 v[136:139], a[28:31], v[124:127], v[136:139]
  v_cvt_pk_bf16_f32 v207, v190, v191
  v_mfma_f32_16x16x32_bf16 v[132:135], a[80:83], v[96:99], v[132:135]
  ds_read_b128 v[76:79], v17 offset:16896
  v_mfma_f32_16x16x32_bf16 v[132:135], a[84:87], v[104:107], v[132:135]
  buffer_store_dwordx4 v[204:207], v2, s[40:43], s62 offen offset:3072 sc1
  v_mfma_f32_16x16x32_bf16 v[132:135], a[88:91], v[112:115], v[132:135]
  ds_read_b128 v[80:83], v18 offset:512
  v_mfma_f32_16x16x32_bf16 v[132:135], a[92:95], v[120:123], v[132:135]
  v_mfma_f32_16x16x32_bf16 v[140:143], a[80:83], v[100:103], v[140:143]
  ds_read_b128 v[84:87], v18 offset:16896
  v_mfma_f32_16x16x32_bf16 v[140:143], a[84:87], v[108:111], v[140:143]
  v_mfma_f32_16x16x32_bf16 v[140:143], a[88:91], v[116:119], v[140:143]
  ds_read_b128 v[88:91], v19 offset:512
  v_mfma_f32_16x16x32_bf16 v[140:143], a[92:95], v[124:127], v[140:143]
  v_mfma_f32_16x16x32_bf16 v[144:147], a[144:147], v[96:99], v[144:147]
  ds_read_b128 v[92:95], v19 offset:16896
  v_mfma_f32_16x16x32_bf16 v[144:147], a[148:151], v[104:107], v[144:147]
  v_mfma_f32_16x16x32_bf16 v[144:147], a[152:155], v[112:115], v[144:147]
  v_mfma_f32_16x16x32_bf16 v[144:147], a[156:159], v[120:123], v[144:147]
  s_add_u32 m0, s66, 0
  s_add_u32 s58, s61, 0
  v_mfma_f32_16x16x32_bf16 v[152:155], a[144:147], v[100:103], v[152:155]
  v_mfma_f32_16x16x32_bf16 v[152:155], a[148:151], v[108:111], v[152:155]
  buffer_load_dwordx4 v8, s[52:55], s58 offen lds
  v_mfma_f32_16x16x32_bf16 v[152:155], a[152:155], v[116:119], v[152:155]
  v_mfma_f32_16x16x32_bf16 v[152:155], a[156:159], v[124:127], v[152:155]
  s_add_u32 m0, s66, 1024
  s_add_u32 s58, s61, 1024
  v_mfma_f32_16x16x32_bf16 v[148:151], a[208:211], v[96:99], v[148:151]
  v_mfma_f32_16x16x32_bf16 v[148:151], a[212:215], v[104:107], v[148:151]
  buffer_load_dwordx4 v9, s[52:55], s58 offen lds
  v_mfma_f32_16x16x32_bf16 v[148:151], a[216:219], v[112:115], v[148:151]
  v_mfma_f32_16x16x32_bf16 v[148:151], a[220:223], v[120:123], v[148:151]
  s_add_u32 m0, s66, 2048
  s_add_u32 s58, s61, 2048
  v_mfma_f32_16x16x32_bf16 v[156:159], a[208:211], v[100:103], v[156:159]
  v_mfma_f32_16x16x32_bf16 v[156:159], a[212:215], v[108:111], v[156:159]
  buffer_load_dwordx4 v10, s[52:55], s58 offen lds
  v_mfma_f32_16x16x32_bf16 v[156:159], a[216:219], v[116:119], v[156:159]
  v_mfma_f32_16x16x32_bf16 v[156:159], a[220:223], v[124:127], v[156:159]
  s_waitcnt lgkmcnt(0)
  s_add_u32 m0, s66, 3072
  s_add_u32 s58, s61, 3072
  v_mfma_f32_16x16x32_bf16 v[128:131], a[32:35], v[64:67], v[128:131]
  v_mfma_f32_16x16x32_bf16 v[128:131], a[36:39], v[72:75], v[128:131]
  buffer_load_dwordx4 v11, s[52:55], s58 offen lds
  v_mfma_f32_16x16x32_bf16 v[128:131], a[40:43], v[80:83], v[128:131]
  ds_read_b128 v[96:99], v16 offset:768
  v_mfma_f32_16x16x32_bf16 v[128:131], a[44:47], v[88:91], v[128:131]
  s_add_u32 m0, s66, 4096
  s_add_u32 s58, s61, 4096
  v_mfma_f32_16x16x32_bf16 v[136:139], a[32:35], v[68:71], v[136:139]
  ds_read_b128 v[100:103], v16 offset:17152
  v_mfma_f32_16x16x32_bf16 v[136:139], a[36:39], v[76:79], v[136:139]
  buffer_load_dwordx4 v12, s[52:55], s58 offen lds
  v_mfma_f32_16x16x32_bf16 v[136:139], a[40:43], v[84:87], v[136:139]
  ds_read_b128 v[104:107], v17 offset:768
  v_mfma_f32_16x16x32_bf16 v[136:139], a[44:47], v[92:95], v[136:139]
  s_add_u32 m0, s66, 5120
  s_add_u32 s58, s61, 5120
  v_mfma_f32_16x16x32_bf16 v[132:135], a[96:99], v[64:67], v[132:135]
  ds_read_b128 v[108:111], v17 offset:17152
  v_mfma_f32_16x16x32_bf16 v[132:135], a[100:103], v[72:75], v[132:135]
  buffer_load_dwordx4 v13, s[52:55], s58 offen lds
  v_mfma_f32_16x16x32_bf16 v[132:135], a[104:107], v[80:83], v[132:135]
  ds_read_b128 v[112:115], v18 offset:768
  v_mfma_f32_16x16x32_bf16 v[132:135], a[108:111], v[88:91], v[132:135]
  s_add_u32 m0, s66, 6144
  s_add_u32 s58, s61, 6144
  v_mfma_f32_16x16x32_bf16 v[140:143], a[96:99], v[68:71], v[140:143]
  ds_read_b128 v[116:119], v18 offset:17152
  v_mfma_f32_16x16x32_bf16 v[140:143], a[100:103], v[76:79], v[140:143]
  buffer_load_dwordx4 v14, s[52:55], s58 offen lds
  v_mfma_f32_16x16x32_bf16 v[140:143], a[104:107], v[84:87], v[140:143]
  ds_read_b128 v[120:123], v19 offset:768
  v_mfma_f32_16x16x32_bf16 v[140:143], a[108:111], v[92:95], v[140:143]
  s_add_u32 m0, s66, 7168
  s_add_u32 s58, s61, 7168
  v_mfma_f32_16x16x32_bf16 v[144:147], a[160:163], v[64:67], v[144:147]
  ds_read_b128 v[124:127], v19 offset:17152
  v_mfma_f32_16x16x32_bf16 v[144:147], a[164:167], v[72:75], v[144:147]
  buffer_load_dwordx4 v15, s[52:55], s58 offen lds
  v_mfma_f32_16x16x32_bf16 v[144:147], a[168:171], v[80:83], v[144:147]
  v_mfma_f32_16x16x32_bf16 v[144:147], a[172:175], v[88:91], v[144:147]
  v_mfma_f32_16x16x32_bf16 v[152:155], a[160:163], v[68:71], v[152:155]
  v_add_u32 v16, 0x8000, v16
  v_mfma_f32_16x16x32_bf16 v[152:155], a[164:167], v[76:79], v[152:155]
  v_and_b32 v16, 0x1ffff, v16
  v_mfma_f32_16x16x32_bf16 v[152:155], a[168:171], v[84:87], v[152:155]
  v_add_u32 v17, 0x8000, v17
  v_mfma_f32_16x16x32_bf16 v[152:155], a[172:175], v[92:95], v[152:155]
  v_and_b32 v17, 0x1ffff, v17
  v_mfma_f32_16x16x32_bf16 v[148:151], a[224:227], v[64:67], v[148:151]
  v_add_u32 v18, 0x8000, v18
  v_mfma_f32_16x16x32_bf16 v[148:151], a[228:231], v[72:75], v[148:151]
  v_and_b32 v18, 0x1ffff, v18
  v_mfma_f32_16x16x32_bf16 v[148:151], a[232:235], v[80:83], v[148:151]
  v_add_u32 v19, 0x8000, v19
  v_mfma_f32_16x16x32_bf16 v[148:151], a[236:239], v[88:91], v[148:151]
  v_and_b32 v19, 0x1ffff, v19
  v_mfma_f32_16x16x32_bf16 v[156:159], a[224:227], v[68:71], v[156:159]
  s_sub_u32 s59, s63, 1
  s_max_i32 s59, s59, 0
  v_mfma_f32_16x16x32_bf16 v[156:159], a[228:231], v[76:79], v[156:159]
  v_mov_b32 v7, s59
  v_mfma_f32_16x16x32_bf16 v[156:159], a[232:235], v[84:87], v[156:159]
  v_mfma_f32_16x16x32_bf16 v[156:159], a[236:239], v[92:95], v[156:159]
  s_waitcnt lgkmcnt(0)
  v_mfma_f32_16x16x32_bf16 v[128:131], a[48:51], v[96:99], v[128:131]
  s_waitcnt vmcnt(20)
  v_mfma_f32_16x16x32_bf16 v[128:131], a[52:55], v[104:107], v[128:131]
  s_barrier
  v_mfma_f32_16x16x32_bf16 v[128:131], a[56:59], v[112:115], v[128:131]
  ds_read_b128 v[64:67], v16 offset:0
  v_mfma_f32_16x16x32_bf16 v[128:131], a[60:63], v[120:123], v[128:131]
  buffer_store_dword v7, v6, s[40:43], s64 offen sc1
  v_mfma_f32_16x16x32_bf16 v[136:139], a[48:51], v[100:103], v[136:139]
  s_lshr_b32 s62, s63, 3
  ds_read_b128 v[68:71], v16 offset:16384
  v_mfma_f32_16x16x32_bf16 v[136:139], a[52:55], v[108:111], v[136:139]
  s_lshl_b32 s62, s62, 2
  v_mfma_f32_16x16x32_bf16 v[136:139], a[56:59], v[116:119], v[136:139]
  s_lshr_b32 s62, s73, s62
  ds_read_b128 v[72:75], v17 offset:0
  v_mfma_f32_16x16x32_bf16 v[136:139], a[60:63], v[124:127], v[136:139]
  s_and_b32 s62, s62, 7
  v_mfma_f32_16x16x32_bf16 v[132:135], a[112:115], v[96:99], v[132:135]
  s_and_b32 s59, s63, 7
  ds_read_b128 v[76:79], v17 offset:16384
  v_mfma_f32_16x16x32_bf16 v[132:135], a[116:119], v[104:107], v[132:135]
  s_lshl3_add_u32 s62, s62, s59
  v_mfma_f32_16x16x32_bf16 v[132:135], a[120:123], v[112:115], v[132:135]
  s_lshl_b32 s62, s62, 13
  ds_read_b128 v[80:83], v18 offset:0
  v_mfma_f32_16x16x32_bf16 v[132:135], a[124:127], v[120:123], v[132:135]
  s_add_u32 s62, s62, s65
  v_mfma_f32_16x16x32_bf16 v[140:143], a[112:115], v[100:103], v[140:143]
  s_add_u32 s70, s70, 1
  ds_read_b128 v[84:87], v18 offset:16384
  v_mfma_f32_16x16x32_bf16 v[140:143], a[116:119], v[108:111], v[140:143]
  s_lshr_b32 s61, s70, 3
  v_mfma_f32_16x16x32_bf16 v[140:143], a[120:123], v[116:119], v[140:143]
  s_lshl_b32 s61, s61, 2
  ds_read_b128 v[88:91], v19 offset:0
  v_mfma_f32_16x16x32_bf16 v[140:143], a[124:127], v[124:127], v[140:143]
  s_lshr_b32 s61, s73, s61
  v_mfma_f32_16x16x32_bf16 v[144:147], a[176:179], v[96:99], v[144:147]
  s_and_b32 s61, s61, 7
  ds_read_b128 v[92:95], v19 offset:16384
  v_mfma_f32_16x16x32_bf16 v[144:147], a[180:183], v[104:107], v[144:147]
  s_and_b32 s59, s70, 7
  v_mfma_f32_16x16x32_bf16 v[144:147], a[184:187], v[112:115], v[144:147]
  s_lshl3_add_u32 s61, s61, s59
  v_mfma_f32_16x16x32_bf16 v[144:147], a[188:191], v[120:123], v[144:147]
  s_lshl_b32 s61, s61, 15
  v_mfma_f32_16x16x32_bf16 v[152:155], a[176:179], v[100:103], v[152:155]
  s_add_u32 s61, s61, s71
  v_mfma_f32_16x16x32_bf16 v[152:155], a[180:183], v[108:111], v[152:155]
  s_add_u32 s66, s66, 0x8000
  v_mfma_f32_16x16x32_bf16 v[152:155], a[184:187], v[116:119], v[152:155]
  s_and_b32 s66, s66, 0x1ffff
  v_mfma_f32_16x16x32_bf16 v[152:155], a[188:191], v[124:127], v[152:155]
  v_mfma_f32_16x16x32_bf16 v[148:151], a[240:243], v[96:99], v[148:151]
  s_add_u32 s63, s63, 1
  v_mfma_f32_16x16x32_bf16 v[148:151], a[244:247], v[104:107], v[148:151]
  v_mfma_f32_16x16x32_bf16 v[148:151], a[248:251], v[112:115], v[148:151]
  v_mfma_f32_16x16x32_bf16 v[148:151], a[252:255], v[120:123], v[148:151]
  v_mfma_f32_16x16x32_bf16 v[156:159], a[240:243], v[100:103], v[156:159]
  v_mfma_f32_16x16x32_bf16 v[156:159], a[244:247], v[108:111], v[156:159]
  v_mfma_f32_16x16x32_bf16 v[156:159], a[248:251], v[116:119], v[156:159]
  s_cmp_lt_u32 s63, s67
  v_mfma_f32_16x16x32_bf16 v[156:159], a[252:255], v[124:127], v[156:159]
  s_waitcnt lgkmcnt(0)
L_f_01:
  v_mfma_f32_16x16x32_bf16 v[160:163], a[0:3], v[64:67], 0
  v_mfma_f32_16x16x32_bf16 v[160:163], a[4:7], v[72:75], v[160:163]
  v_mfma_f32_16x16x32_bf16 v[160:163], a[8:11], v[80:83], v[160:163]
  ds_read_b128 v[96:99], v16 offset:256
  v_mfma_f32_16x16x32_bf16 v[160:163], a[12:15], v[88:91], v[160:163]
  s_cmp_lg_u32 s57, 6
  s_cbranch_scc1 L_f_pw_20
  buffer_store_dwordx4 v[36:39], v2, s[40:43], s79 offen sc1
  s_add_u32 s79, s79, 0x20000
L_f_pw_20:
  v_mfma_f32_16x16x32_bf16 v[168:171], a[0:3], v[68:71], 0
  ds_read_b128 v[100:103], v16 offset:16640
  v_mfma_f32_16x16x32_bf16 v[168:171], a[4:7], v[76:79], v[168:171]
  v_mfma_f32_16x16x32_bf16 v[168:171], a[8:11], v[84:87], v[168:171]
  ds_read_b128 v[104:107], v17 offset:256
  v_mfma_f32_16x16x32_bf16 v[168:171], a[12:15], v[92:95], v[168:171]
  v_mfma_f32_16x16x32_bf16 v[164:167], a[64:67], v[64:67], 0
  ds_read_b128 v[108:111], v17 offset:16640
  v_mfma_f32_16x16x32_bf16 v[164:167], a[68:71], v[72:75], v[164:167]
  v_mul_f32 v128, s69, v128
  v_mul_f32 v129, s69, v129
  v_mfma_f32_16x16x32_bf16 v[164:167], a[72:75], v[80:83], v[164:167]
  ds_read_b128 v[112:115], v18 offset:256
  v_mul_f32 v130, s69, v130
  v_mfma_f32_16x16x32_bf16 v[164:167], a[76:79], v[88:91], v[164:167]
  v_mul_f32 v131, s69, v131
  v_mul_f32 v132, s69, v132
  v_mfma_f32_16x16x32_bf16 v[172:175], a[64:67], v[68:71], 0
  ds_read_b128 v[116:119], v18 offset:16640
  v_mul_f32 v133, s69, v133
  v_mfma_f32_16x16x32_bf16 v[172:175], a[68:71], v[76:79], v[172:175]
  v_mul_f32 v134, s69, v134
  v_mul_f32 v135, s69, v135
  v_mfma_f32_16x16x32_bf16 v[172:175], a[72:75], v[84:87], v[172:175]
  ds_read_b128 v[120:123], v19 offset:256
  v_cvt_pk_bf16_f32 v192, v128, v129
  v_mfma_f32_16x16x32_bf16 v[172:175], a[76:79], v[92:95], v[172:175]
  v_cvt_pk_bf16_f32 v193, v130, v131
  v_cvt_pk_bf16_f32 v194, v132, v133
  v_mfma_f32_16x16x32_bf16 v[176:179], a[128:131], v[64:67], 0
  ds_read_b128 v[124:127], v19 offset:16640
  v_cvt_pk_bf16_f32 v195, v134, v135
  v_mfma_f32_16x16x32_bf16 v[176:179], a[132:135], v[72:75], v[176:179]
  buffer_store_dwordx4 v[192:195], v2, s[40:43], s62 offen offset:0 sc1
  v_mfma_f32_16x16x32_bf16 v[176:179], a[136:139], v[80:83], v[176:179]
  v_mul_f32 v136, s69, v136
  v_mul_f32 v137, s69, v137
  v_mfma_f32_16x16x32_bf16 v[176:179], a[140:143], v[88:91], v[176:179]
  v_mul_f32 v138, s69, v138
  v_mul_f32 v139, s69, v139
  v_mfma_f32_16x16x32_bf16 v[184:187], a[128:131], v[68:71], 0
  v_mul_f32 v140, s69, v140
  v_mul_f32 v141, s69, v141
  v_mfma_f32_16x16x32_bf16 v[184:187], a[132:135], v[76:79], v[184:187]
  v_mul_f32 v142, s69, v142
  v_mul_f32 v143, s69, v143
  v_mfma_f32_16x16x32_bf16 v[184:187], a[136:139], v[84:87], v[184:187]
  v_cvt_pk_bf16_f32 v196, v136, v137
  v_cvt_pk_bf16_f32 v197, v138, v139
  v_mfma_f32_16x16x32_bf16 v[184:187], a[140:143], v[92:95], v[184:187]
  v_cvt_pk_bf16_f32 v198, v140, v141
  v_cvt_pk_bf16_f32 v199, v142, v143
  v_mfma_f32_16x16x32_bf16 v[180:183], a[192:195], v[64:67], 0
  buffer_store_dwordx4 v[196:199], v2, s[40:43], s62 offen offset:1024 sc1
  v_mfma_f32_16x16x32_bf16 v[180:183], a[196:199], v[72:75], v[180:183]
  v_mul_f32 v144, s69, v144
  v_mul_f32 v145, s69, v145
  v_mfma_f32_16x16x32_bf16 v[180:183], a[200:203], v[80:83], v[180:183]
  v_mul_f32 v146, s69, v146
  v_mul_f32 v147, s69, v147
  v_mfma_f32_16x16x32_bf16 v[180:183], a[204:207], v[88:91], v[180:183]
  v_mul_f32 v148, s69, v148
  v_mul_f32 v149, s69, v149
  v_mfma_f32_16x16x32_bf16 v[188:191], a[192:195], v[68:71], 0
  v_mul_f32 v150, s69, v150
  v_mul_f32 v151, s69, v151
  v_mfma_f32_16x16x32_bf16 v[188:191], a[196:199], v[76:79], v[188:191]
  v_cvt_pk_bf16_f32 v200, v144, v145
  v_cvt_pk_bf16_f32 v201, v146, v147
  v_mfma_f32_16x16x32_bf16 v[188:191], a[200:203], v[84:87], v[188:191]
  v_cvt_pk_bf16_f32 v202, v148, v149
  v_cvt_pk_bf16_f32 v203, v150, v151
  v_mfma_f32_16x16x32_bf16 v[188:191], a[204:207], v[92:95], v[188:191]
  s_waitcnt lgkmcnt(0)
  buffer_store_dwordx4 v[200:203], v2, s[40:43], s62 offen offset:2048 sc1
  v_mfma_f32_16x16x32_bf16 v[160:163], a[16:19], v[96:99], v[160:163]
  v_mul_f32 v152, s69, v152
  v_mul_f32 v153, s69, v153
  v_mfma_f32_16x16x32_bf16 v[160:163], a[20:23], v[104:107], v[160:163]
  v_mul_f32 v154, s69, v154
  v_mul_f32 v155, s69, v155
  v_mfma_f32_16x16x32_bf16 v[160:163], a[24:27], v[112:115], v[160:163]
  ds_read_b128 v[64:67], v16 offset:512
  v_mul_f32 v156, s69, v156
  v_mfma_f32_16x16x32_bf16 v[160:163], a[28:31], v[120:123], v[160:163]
  v_mul_f32 v157, s69, v157
  v_mul_f32 v158, s69, v158
  v_mfma_f32_16x16x32_bf16 v[168:171], a[16:19], v[100:103], v[168:171]
  ds_read_b128 v[68:71], v16 offset:16896
  v_mul_f32 v159, s69, v159
  v_mfma_f32_16x16x32_bf16 v[168:171], a[20:23], v[108:111], v[168:171]
  v_cvt_pk_bf16_f32 v204, v152, v153
  v_cvt_pk_bf16_f32 v205, v154, v155
  v_mfma_f32_16x16x32_bf16 v[168:171], a[24:27], v[116:119], v[168:171]
  ds_read_b128 v[72:75], v17 offset:512
  v_cvt_pk_bf16_f32 v206, v156, v157
  v_mfma_f32_16x16x32_bf16 v[168:171], a[28:31], v[124:127], v[168:171]
  v_cvt_pk_bf16_f32 v207, v158, v159
  v_mfma_f32_16x16x32_bf16 v[164:167], a[80:83], v[96:99], v[164:167]
  ds_read_b128 v[76:79], v17 offset:16896
  v_mfma_f32_16x16x32_bf16 v[164:167], a[84:87], v[104:107], v[164:167]
  buffer_store_dwordx4 v[204:207], v2, s[40:43], s62 offen offset:3072 sc1
  v_mfma_f32_16x16x32_bf16 v[164:167], a[88:91], v[112:115], v[164:167]
  ds_read_b128 v[80:83], v18 offset:512
  v_mfma_f32_16x16x32_bf16 v[164:167], a[92:95], v[120:123], v[164:167]
  v_mfma_f32_16x16x32_bf16 v[172:175], a[80:83], v[100:103], v[172:175]
  ds_read_b128 v[84:87], v18 offset:16896
  v_mfma_f32_16x16x32_bf16 v[172:175], a[84:87], v[108:111], v[172:175]
  v_mfma_f32_16x16x32_bf16 v[172:175], a[88:91], v[116:119], v[172:175]
  ds_read_b128 v[88:91], v19 offset:512
  v_mfma_f32_16x16x32_bf16 v[172:175], a[92:95], v[124:127], v[172:175]
  v_mfma_f32_16x16x32_bf16 v[176:179], a[144:147], v[96:99], v[176:179]
  ds_read_b128 v[92:95], v19 offset:16896
  v_mfma_f32_16x16x32_bf16 v[176:179], a[148:151], v[104:107], v[176:179]
  v_mfma_f32_16x16x32_bf16 v[176:179], a[152:155], v[112:115], v[176:179]
  v_mfma_f32_16x16x32_bf16 v[176:179], a[156:159], v[120:123], v[176:179]
  s_add_u32 m0, s66, 0
  s_add_u32 s58, s61, 0
  v_mfma_f32_16x16x32_bf16 v[184:187], a[144:147], v[100:103], v[184:187]
  v_mfma_f32_16x16x32_bf16 v[184:187], a[148:151], v[108:111], v[184:187]
  buffer_load_dwordx4 v8, s[52:55], s58 offen lds
  v_mfma_f32_16x16x32_bf16 v[184:187], a[152:155], v[116:119], v[184:187]
  v_mfma_f32_16x16x32_bf16 v[184:187], a[156:159], v[124:127], v[184:187]
  s_add_u32 m0, s66, 1024
  s_add_u32 s58, s61, 1024
  v_mfma_f32_16x16x32_bf16 v[180:183], a[208:211], v[96:99], v[180:183]
  v_mfma_f32_16x16x32_bf16 v[180:183], a[212:215], v[104:107], v[180:183]
  buffer_load_dwordx4 v9, s[52:55], s58 offen lds
  v_mfma_f32_16x16x32_bf16 v[180:183], a[216:219], v[112:115], v[180:183]
  v_mfma_f32_16x16x32_bf16 v[180:183], a[220:223], v[120:123], v[180:183]
  s_add_u32 m0, s66, 2048
  s_add_u32 s58, s61, 2048
  v_mfma_f32_16x16x32_bf16 v[188:191], a[208:211], v[100:103], v[188:191]
  v_mfma_f32_16x16x32_bf16 v[188:191], a[212:215], v[108:111], v[188:191]
  buffer_load_dwordx4 v10, s[52:55], s58 offen lds
  v_mfma_f32_16x16x32_bf16 v[188:191], a[216:219], v[116:119], v[188:191]
  v_mfma_f32_16x16x32_bf16 v[188:191], a[220:223], v[124:127], v[188:191]
  s_waitcnt lgkmcnt(0)
  s_add_u32 m0, s66, 3072
  s_add_u32 s58, s61, 3072
  v_mfma_f32_16x16x32_bf16 v[160:163], a[32:35], v[64:67], v[160:163]
  v_mfma_f32_16x16x32_bf16 v[160:163], a[36:39], v[72:75], v[160:163]
  buffer_load_dwordx4 v11, s[52:55], s58 offen lds
  v_mfma_f32_16x16x32_bf16 v[160:163], a[40:43], v[80:83], v[160:163]
  ds_read_b128 v[96:99], v16 offset:768
  v_mfma_f32_16x16x32_bf16 v[160:163], a[44:47], v[88:91], v[160:163]
  s_add_u32 m0, s66, 4096
  s_add_u32 s58, s61, 4096
  v_mfma_f32_16x16x32_bf16 v[168:171], a[32:35], v[68:71], v[168:171]
  ds_read_b128 v[100:103], v16 offset:17152
  v_mfma_f32_16x16x32_bf16 v[168:171], a[36:39], v[76:79], v[168:171]
  buffer_load_dwordx4 v12, s[52:55], s58 offen lds
  v_mfma_f32_16x16x32_bf16 v[168:171], a[40:43], v[84:87], v[168:171]
  ds_read_b128 v[104:107], v17 offset:768
  v_mfma_f32_16x16x32_bf16 v[168:171], a[44:47], v[92:95], v[168:171]
  s_add_u32 m0, s66, 5120
  s_add_u32 s58, s61, 5120
  v_mfma_f32_16x16x32_bf16 v[164:167], a[96:99], v[64:67], v[164:167]
  ds_read_b128 v[108:111], v17 offset:17152
  v_mfma_f32_16x16x32_bf16 v[164:167], a[100:103], v[72:75], v[164:167]
  buffer_load_dwordx4 v13, s[52:55], s58 offen lds
  v_mfma_f32_16x16x32_bf16 v[164:167], a[104:107], v[80:83], v[164:167]
  ds_read_b128 v[112:115], v18 offset:768
  v_mfma_f32_16x16x32_bf16 v[164:167], a[108:111], v[88:91], v[164:167]
  s_add_u32 m0, s66, 6144
  s_add_u32 s58, s61, 6144
  v_mfma_f32_16x16x32_bf16 v[172:175], a[96:99], v[68:71], v[172:175]
  ds_read_b128 v[116:119], v18 offset:17152
  v_mfma_f32_16x16x32_bf16 v[172:175], a[100:103], v[76:79], v[172:175]
  buffer_load_dwordx4 v14, s[52:55], s58 offen lds
  v_mfma_f32_16x16x32_bf16 v[172:175], a[104:107], v[84:87], v[172:175]
  ds_read_b128 v[120:123], v19 offset:768
  v_mfma_f32_16x16x32_bf16 v[172:175], a[108:111], v[92:95], v[172:175]
  s_add_u32 m0, s66, 7168
  s_add_u32 s58, s61, 7168
  v_mfma_f32_16x16x32_bf16 v[176:179], a[160:163], v[64:67], v[176:179]
  ds_read_b128 v[124:127], v19 offset:17152
  v_mfma_f32_16x16x32_bf16 v[176:179], a[164:167], v[72:75], v[176:179]
  buffer_load_dwordx4 v15, s[52:55], s58 offen lds
  v_mfma_f32_16x16x32_bf16 v[176:179], a[168:171], v[80:83], v[176:179]
  v_mfma_f32_16x16x32_bf16 v[176:179], a[172:175], v[88:91], v[176:179]
  v_mfma_f32_16x16x32_bf16 v[184:187], a[160:163], v[68:71], v[184:187]
  v_add_u32 v16, 0x8000, v16
  v_mfma_f32_16x16x32_bf16 v[184:187], a[164:167], v[76:79], v[184:187]
  v_and_b32 v16, 0x1ffff, v16
  v_mfma_f32_16x16x32_bf16 v[184:187], a[168:171], v[84:87], v[184:187]
  v_add_u32 v17, 0x8000, v17
  v_mfma_f32_16x16x32_bf16 v[184:187], a[172:175], v[92:95], v[184:187]
  v_and_b32 v17, 0x1ffff, v17
  v_mfma_f32_16x16x32_bf16 v[180:183], a[224:227], v[64:67], v[180:183]
  v_add_u32 v18, 0x8000, v18
  v_mfma_f32_16x16x32_bf16 v[180:183], a[228:231], v[72:75], v[180:183]
  v_and_b32 v18, 0x1ffff, v18
  v_mfma_f32_16x16x32_bf16 v[180:183], a[232:235], v[80:83], v[180:183]
  v_add_u32 v19, 0x8000, v19
  v_mfma_f32_16x16x32_bf16 v[180:183], a[236:239], v[88:91], v[180:183]
  v_and_b32 v19, 0x1ffff, v19
  v_mfma_f32_16x16x32_bf16 v[188:191], a[224:227], v[68:71], v[188:191]
  s_sub_u32 s59, s63, 1
  s_max_i32 s59, s59, 0
  v_mfma_f32_16x16x32_bf16 v[188:191], a[228:231], v[76:79], v[188:191]
  v_mov_b32 v7, s59
  v_mfma_f32_16x16x32_bf16 v[188:191], a[232:235], v[84:87], v[188:191]
  v_mfma_f32_16x16x32_bf16 v[188:191], a[236:239], v[92:95], v[188:191]
  s_waitcnt lgkmcnt(0)
  v_mfma_f32_16x16x32_bf16 v[160:163], a[48:51], v[96:99], v[160:163]
  s_waitcnt vmcnt(20)
  v_mfma_f32_16x16x32_bf16 v[160:163], a[52:55], v[104:107], v[160:163]
  s_barrier
  v_mfma_f32_16x16x32_bf16 v[160:163], a[56:59], v[112:115], v[160:163]
  ds_read_b128 v[64:67], v16 offset:0
  v_mfma_f32_16x16x32_bf16 v[160:163], a[60:63], v[120:123], v[160:163]
  buffer_store_dword v7, v6, s[40:43], s64 offen sc1
  v_mfma_f32_16x16x32_bf16 v[168:171], a[48:51], v[100:103], v[168:171]
  s_lshr_b32 s62, s63, 3
  ds_read_b128 v[68:71], v16 offset:16384
  v_mfma_f32_16x16x32_bf16 v[168:171], a[52:55], v[108:111], v[168:171]
  s_lshl_b32 s62, s62, 2
  v_mfma_f32_16x16x32_bf16 v[168:171], a[56:59], v[116:119], v[168:171]
  s_lshr_b32 s62, s73, s62
  ds_read_b128 v[72:75], v17 offset:0
  v_mfma_f32_16x16x32_bf16 v[168:171], a[60:63], v[124:127], v[168:171]
  s_and_b32 s62, s62, 7
  v_mfma_f32_16x16x32_bf16 v[164:167], a[112:115], v[96:99], v[164:167]
  s_and_b32 s59, s63, 7
  ds_read_b128 v[76:79], v17 offset:16384
  v_mfma_f32_16x16x32_bf16 v[164:167], a[116:119], v[104:107], v[164:167]
  s_lshl3_add_u32 s62, s62, s59
  v_mfma_f32_16x16x32_bf16 v[164:167], a[120:123], v[112:115], v[164:167]
  s_lshl_b32 s62, s62, 13
  ds_read_b128 v[80:83], v18 offset:0
  v_mfma_f32_16x16x32_bf16 v[164:167], a[124:127], v[120:123], v[164:167]
  s_add_u32 s62, s62, s65
  v_mfma_f32_16x16x32_bf16 v[172:175], a[112:115], v[100:103], v[172:175]
  s_add_u32 s70, s70, 1
  ds_read_b128 v[84:87], v18 offset:16384
  v_mfma_f32_16x16x32_bf16 v[172:175], a[116:119], v[108:111], v[172:175]
  s_lshr_b32 s61, s70, 3
  v_mfma_f32_16x16x32_bf16 v[172:175], a[120:123], v[116:119], v[172:175]
  s_lshl_b32 s61, s61, 2
  ds_read_b128 v[88:91], v19 offset:0
  v_mfma_f32_16x16x32_bf16 v[172:175], a[124:127], v[124:127], v[172:175]
  s_lshr_b32 s61, s73, s61
  v_mfma_f32_16x16x32_bf16 v[176:179], a[176:179], v[96:99], v[176:179]
  s_and_b32 s61, s61, 7
  ds_read_b128 v[92:95], v19 offset:16384
  v_mfma_f32_16x16x32_bf16 v[176:179], a[180:183], v[104:107], v[176:179]
  s_and_b32 s59, s70, 7
  v_mfma_f32_16x16x32_bf16 v[176:179], a[184:187], v[112:115], v[176:179]
  s_lshl3_add_u32 s61, s61, s59
  v_mfma_f32_16x16x32_bf16 v[176:179], a[188:191], v[120:123], v[176:179]
  s_lshl_b32 s61, s61, 15
  v_mfma_f32_16x16x32_bf16 v[184:187], a[176:179], v[100:103], v[184:187]
  s_add_u32 s61, s61, s71
  v_mfma_f32_16x16x32_bf16 v[184:187], a[180:183], v[108:111], v[184:187]
  s_add_u32 s66, s66, 0x8000
  v_mfma_f32_16x16x32_bf16 v[184:187], a[184:187], v[116:119], v[184:187]
  s_and_b32 s66, s66, 0x1ffff
  v_mfma_f32_16x16x32_bf16 v[184:187], a[188:191], v[124:127], v[184:187]
  v_mfma_f32_16x16x32_bf16 v[180:183], a[240:243], v[96:99], v[180:183]
  s_add_u32 s63, s63, 1
  v_mfma_f32_16x16x32_bf16 v[180:183], a[244:247], v[104:107], v[180:183]
  s_mov_b64 exec, 1
  buffer_atomic_add v33, v6, s[40:43], s76 offen
  s_mov_b64 exec, -1
  v_mfma_f32_16x16x32_bf16 v[180:183], a[248:251], v[112:115], v[180:183]
  s_mov_b32 s76, 0x40000000
  v_mfma_f32_16x16x32_bf16 v[180:183], a[252:255], v[120:123], v[180:183]
  v_mfma_f32_16x16x32_bf16 v[188:191], a[240:243], v[100:103], v[188:191]
  v_mfma_f32_16x16x32_bf16 v[188:191], a[244:247], v[108:111], v[188:191]
  v_mfma_f32_16x16x32_bf16 v[188:191], a[248:251], v[116:119], v[188:191]
  s_cmp_lt_u32 s63, s67
  v_mfma_f32_16x16x32_bf16 v[188:191], a[252:255], v[124:127], v[188:191]
  s_waitcnt lgkmcnt(0)
  s_cbranch_scc1 L_f_00
  s_branch L_f_done
L_f_10:
  v_mfma_f32_16x16x32_bf16 v[128:131], v[64:67], a[0:3], 0
  v_mfma_f32_16x16x32_bf16 v[128:131], v[72:75], a[4:7], v[128:131]
  v_mfma_f32_16x16x32_bf16 v[128:131], v[80:83], a[8:11], v[128:131]
  ds_read_b128 v[96:99], v16 offset:256
  v_mfma_f32_16x16x32_bf16 v[128:131], v[88:91], a[12:15], v[128:131]
  s_cmp_lg_u32 s57, 6
  s_cbranch_scc1 L_f_pw_21
  buffer_store_dwordx4 v[36:39], v2, s[40:43], s79 offen sc1
  s_add_u32 s79, s79, 0x20000
L_f_pw_21:
  v_mfma_f32_16x16x32_bf16 v[132:135], v[68:71], a[0:3], 0
  ds_read_b128 v[100:103], v16 offset:16640
  v_mfma_f32_16x16x32_bf16 v[132:135], v[76:79], a[4:7], v[132:135]
  v_mfma_f32_16x16x32_bf16 v[132:135], v[84:87], a[8:11], v[132:135]
  ds_read_b128 v[104:107], v17 offset:256
  v_mfma_f32_16x16x32_bf16 v[132:135], v[92:95], a[12:15], v[132:135]
  v_mfma_f32_16x16x32_bf16 v[136:139], v[64:67], a[64:67], 0
  ds_read_b128 v[108:111], v17 offset:16640
  v_mfma_f32_16x16x32_bf16 v[136:139], v[72:75], a[68:71], v[136:139]
  v_cvt_pk_bf16_f32 v192, v160, v161
  v_cvt_pk_bf16_f32 v193, v162, v163
  v_mfma_f32_16x16x32_bf16 v[136:139], v[80:83], a[72:75], v[136:139]
  ds_read_b128 v[112:115], v18 offset:256
  v_cvt_pk_bf16_f32 v194, v164, v165
  v_mfma_f32_16x16x32_bf16 v[136:139], v[88:91], a[76:79], v[136:139]
  v_cvt_pk_bf16_f32 v195, v166, v167
  v_mfma_f32_16x16x32_bf16 v[140:143], v[68:71], a[64:67], 0
  ds_read_b128 v[116:119], v18 offset:16640
  v_mfma_f32_16x16x32_bf16 v[140:143], v[76:79], a[68:71], v[140:143]
  buffer_store_dwordx4 v[192:195], v2, s[40:43], s62 offen offset:0 sc1
  v_mfma_f32_16x16x32_bf16 v[140:143], v[84:87], a[72:75], v[140:143]
  ds_read_b128 v[120:123], v19 offset:256
  v_cvt_pk_bf16_f32 v196, v168, v169
  v_mfma_f32_16x16x32_bf16 v[140:143], v[92:95], a[76:79], v[140:143]
  v_cvt_pk_bf16_f32 v197, v170, v171
  v_cvt_pk_bf16_f32 v198, v172, v173
  v_mfma_f32_16x16x32_bf16 v[144:147], v[64:67], a[128:131], 0
  ds_read_b128 v[124:127], v19 offset:16640
  v_cvt_pk_bf16_f32 v199, v174, v175
  v_mfma_f32_16x16x32_bf16 v[144:147], v[72:75], a[132:135], v[144:147]
  buffer_store_dwordx4 v[196:199], v2, s[40:43], s62 offen offset:1024 sc1
  v_mfma_f32_16x16x32_bf16 v[144:147], v[80:83], a[136:139], v[144:147]
  v_cvt_pk_bf16_f32 v200, v176, v177
  v_cvt_pk_bf16_f32 v201, v178, v179
  v_mfma_f32_16x16x32_bf16 v[144:147], v[88:91], a[140:143], v[144:147]
  v_cvt_pk_bf16_f32 v202, v180, v181
  v_cvt_pk_bf16_f32 v203, v182, v183
  v_mfma_f32_16x16x32_bf16 v[148:151], v[68:71], a[128:131], 0
  buffer_store_dwordx4 v[200:203], v2, s[40:43], s62 offen offset:2048 sc1
  v_mfma_f32_16x16x32_bf16 v[148:151], v[76:79], a[132:135], v[148:151]
  v_cvt_pk_bf16_f32 v204, v184, v185
  v_cvt_pk_bf16_f32 v205, v186, v187
  v_mfma_f32_16x16x32_bf16 v[148:151], v[84:87], a[136:139], v[148:151]
  v_cvt_pk_bf16_f32 v206, v188, v189
  v_cvt_pk_bf16_f32 v207, v190, v191
  v_mfma_f32_16x16x32_bf16 v[148:151], v[92:95], a[140:143], v[148:151]
  buffer_store_dwordx4 v[204:207], v2, s[40:43], s62 offen offset:3072 sc1
  v_mfma_f32_16x16x32_bf16 v[152:155], v[64:67], a[192:195], 0
  v_mfma_f32_16x16x32_bf16 v[152:155], v[72:75], a[196:199], v[152:155]
  v_mfma_f32_16x16x32_bf16 v[152:155], v[80:83], a[200:203], v[152:155]
  v_mfma_f32_16x16x32_bf16 v[152:155], v[88:91], a[204:207], v[152:155]
  v_mfma_f32_16x16x32_bf16 v[156:159], v[68:71], a[192:195], 0
  v_mfma_f32_16x16x32_bf16 v[156:159], v[76:79], a[196:199], v[156:159]
  v_mfma_f32_16x16x32_bf16 v[156:159], v[84:87], a[200:203], v[156:159]
  v_mfma_f32_16x16x32_bf16 v[156:159], v[92:95], a[204:207], v[156:159]
  s_waitcnt lgkmcnt(0)
  v_mfma_f32_16x16x32_bf16 v[128:131], v[96:99], a[16:19], v[128:131]
  v_mfma_f32_16x16x32_bf16 v[128:131], v[104:107], a[20:23], v[128:131]
  v_mfma_f32_16x16x32_bf16 v[128:131], v[112:115], a[24:27], v[128:131]
  ds_read_b128 v[64:67], v16 offset:512
  v_mfma_f32_16x16x32_bf16 v[128:131], v[120:123], a[28:31], v[128:131]
  v_mfma_f32_16x16x32_bf16 v[132:135], v[100:103], a[16:19], v[132:135]
  ds_read_b128 v[68:71], v16 offset:16896
  v_mfma_f32_16x16x32_bf16 v[132:135], v[108:111], a[20:23], v[132:135]
  v_mfma_f32_16x16x32_bf16 v[132:135], v[116:119], a[24:27], v[132:135]
  ds_read_b128 v[72:75], v17 offset:512
  v_mfma_f32_16x16x32_bf16 v[132:135], v[124:127], a[28:31], v[132:135]
  v_mfma_f32_16x16x32_bf16 v[136:139], v[96:99], a[80:83], v[136:139]
  ds_read_b128 v[76:79], v17 offset:16896
  v_mfma_f32_16x16x32_bf16 v[136:139], v[104:107], a[84:87], v[136:139]
  v_mfma_f32_16x16x32_bf16 v[136:139], v[112:115], a[88:91], v[136:139]
  ds_read_b128 v[80:83], v18 offset:512
  v_mfma_f32_16x16x32_bf16 v[136:139], v[120:123], a[92:95], v[136:139]
  v_mfma_f32_16x16x32_bf16 v[140:143], v[100:103], a[80:83], v[140:143]
  ds_read_b128 v[84:87], v18 offset:16896
  v_mfma_f32_16x16x32_bf16 v[140:143], v[108:111], a[84:87], v[140:143]
  v_mfma_f32_16x16x32_bf16 v[140:143], v[116:119], a[88:91], v[140:143]
  ds_read_b128 v[88:91], v19 offset:512
  v_mfma_f32_16x16x32_bf16 v[140:143], v[124:127], a[92:95], v[140:143]
  v_mfma_f32_16x16x32_bf16 v[144:147], v[96:99], a[144:147], v[144:147]
  ds_read_b128 v[92:95], v19 offset:16896
  v_mfma_f32_16x16x32_bf16 v[144:147], v[104:107], a[148:151], v[144:147]
  v_mfma_f32_16x16x32_bf16 v[144:147], v[112:115], a[152:155], v[144:147]
  v_mfma_f32_16x16x32_bf16 v[144:147], v[120:123], a[156:159], v[144:147]
  s_add_u32 m0, s66, 0
  s_add_u32 s58, s61, 0
  v_mfma_f32_16x16x32_bf16 v[148:151], v[100:103], a[144:147], v[148:151]
  v_mfma_f32_16x16x32_bf16 v[148:151], v[108:111], a[148:151], v[148:151]
  buffer_load_dwordx4 v8, s[52:55], s58 offen lds
  v_mfma_f32_16x16x32_bf16 v[148:151], v[116:119], a[152:155], v[148:151]
  v_mfma_f32_16x16x32_bf16 v[148:151], v[124:127], a[156:159], v[148:151]
  s_add_u32 m0, s66, 1024
  s_add_u32 s58, s61, 1024
  v_mfma_f32_16x16x32_bf16 v[152:155], v[96:99], a[208:211], v[152:155]
  v_mfma_f32_16x16x32_bf16 v[152:155], v[104:107], a[212:215], v[152:155]
  buffer_load_dwordx4 v9, s[52:55], s58 offen lds
  v_mfma_f32_16x16x32_bf16 v[152:155], v[112:115], a[216:219], v[152:155]
  v_mfma_f32_16x16x32_bf16 v[152:155], v[120:123], a[220:223], v[152:155]
  s_add_u32 m0, s66, 2048
  s_add_u32 s58, s61, 2048
  v_mfma_f32_16x16x32_bf16 v[156:159], v[100:103], a[208:211], v[156:159]
  v_mfma_f32_16x16x32_bf16 v[156:159], v[108:111], a[212:215], v[156:159]
  buffer_load_dwordx4 v10, s[52:55], s58 offen lds
  v_mfma_f32_16x16x32_bf16 v[156:159], v[116:119], a[216:219], v[156:159]
  v_mfma_f32_16x16x32_bf16 v[156:159], v[124:127], a[220:223], v[156:159]
  s_waitcnt lgkmcnt(0)
  s_add_u32 m0, s66, 3072
  s_add_u32 s58, s61, 3072
  v_mfma_f32_16x16x32_bf16 v[128:131], v[64:67], a[32:35], v[128:131]
  v_mfma_f32_16x16x32_bf16 v[128:131], v[72:75], a[36:39], v[128:131]
  buffer_load_dwordx4 v11, s[52:55], s58 offen lds
  v_mfma_f32_16x16x32_bf16 v[128:131], v[80:83], a[40:43], v[128:131]
  ds_read_b128 v[96:99], v16 offset:768
  v_mfma_f32_16x16x32_bf16 v[128:131], v[88:91], a[44:47], v[128:131]
  s_add_u32 m0, s66, 4096
  s_add_u32 s58, s61, 4096
  v_mfma_f32_16x16x32_bf16 v[132:135], v[68:71], a[32:35], v[132:135]
  ds_read_b128 v[100:103], v16 offset:17152
  v_mfma_f32_16x16x32_bf16 v[132:135], v[76:79], a[36:39], v[132:135]
  buffer_load_dwordx4 v12, s[52:55], s58 offen lds
  v_mfma_f32_16x16x32_bf16 v[132:135], v[84:87], a[40:43], v[132:135]
  ds_read_b128 v[104:107], v17 offset:768
  v_mfma_f32_16x16x32_bf16 v[132:135], v[92:95], a[44:47], v[132:135]
  s_add_u32 m0, s66, 5120
  s_add_u32 s58, s61, 5120
  v_mfma_f32_16x16x32_bf16 v[136:139], v[64:67], a[96:99], v[136:139]
  ds_read_b128 v[108:111], v17 offset:17152
  v_mfma_f32_16x16x32_bf16 v[136:139], v[72:75], a[100:103], v[136:139]
  buffer_load_dwordx4 v13, s[52:55], s58 offen lds
  v_mfma_f32_16x16x32_bf16 v[136:139], v[80:83], a[104:107], v[136:139]
  ds_read_b128 v[112:115], v18 offset:768
  v_mfma_f32_16x16x32_bf16 v[136:139], v[88:91], a[108:111], v[136:139]
  s_add_u32 m0, s66, 6144
  s_add_u32 s58, s61, 6144
  v_mfma_f32_16x16x32_bf16 v[140:143], v[68:71], a[96:99], v[140:143]
  ds_read_b128 v[116:119], v18 offset:17152
  v_mfma_f32_16x16x32_bf16 v[140:143], v[76:79], a[100:103], v[140:143]
  buffer_load_dwordx4 v14, s[52:55], s58 offen lds
  v_mfma_f32_16x16x32_bf16 v[140:143], v[84:87], a[104:107], v[140:143]
  ds_read_b128 v[120:123], v19 offset:768
  v_mfma_f32_16x16x32_bf16 v[140:143], v[92:95], a[108:111], v[140:143]
  s_add_u32 m0, s66, 7168
  s_add_u32 s58, s61, 7168
  v_mfma_f32_16x16x32_bf16 v[144:147], v[64:67], a[160:163], v[144:147]
  ds_read_b128 v[124:127], v19 offset:17152
  v_mfma_f32_16x16x32_bf16 v[144:147], v[72:75], a[164:167], v[144:147]
  buffer_load_dwordx4 v15, s[52:55], s58 offen lds
  v_mfma_f32_16x16x32_bf16 v[144:147], v[80:83], a[168:171], v[144:147]
  v_mfma_f32_16x16x32_bf16 v[144:147], v[88:91], a[172:175], v[144:147]
  v_mfma_f32_16x16x32_bf16 v[148:151], v[68:71], a[160:163], v[148:151]
  v_add_u32 v16, 0x8000, v16
  v_mfma_f32_16x16x32_bf16 v[148:151], v[76:79], a[164:167], v[148:151]
  v_and_b32 v16, 0x1ffff, v16
  v_mfma_f32_16x16x32_bf16 v[148:151], v[84:87], a[168:171], v[148:151]
  v_add_u32 v17, 0x8000, v17
  v_mfma_f32_16x16x32_bf16 v[148:151], v[92:95], a[172:175], v[148:151]
  v_and_b32 v17, 0x1ffff, v17
  v_mfma_f32_16x16x32_bf16 v[152:155], v[64:67], a[224:227], v[152:155]
  v_add_u32 v18, 0x8000, v18
  v_mfma_f32_16x16x32_bf16 v[152:155], v[72:75], a[228:231], v[152:155]
  v_and_b32 v18, 0x1ffff, v18
  v_mfma_f32_16x16x32_bf16 v[152:155], v[80:83], a[232:235], v[152:155]
  v_add_u32 v19, 0x8000, v19
  v_mfma_f32_16x16x32_bf16 v[152:155], v[88:91], a[236:239], v[152:155]
  v_and_b32 v19, 0x1ffff, v19
  v_mfma_f32_16x16x32_bf16 v[156:159], v[68:71], a[224:227], v[156:159]
  s_sub_u32 s59, s63, 1
  s_max_i32 s59, s59, 0
  v_mfma_f32_16x16x32_bf16 v[156:159], v[76:79], a[228:231], v[156:159]
  v_mov_b32 v7, s59
  v_mfma_f32_16x16x32_bf16 v[156:159], v[84:87], a[232:235], v[156:159]
  v_mfma_f32_16x16x32_bf16 v[156:159], v[92:95], a[236:239], v[156:159]
  s_waitcnt lgkmcnt(0)
  v_mfma_f32_16x16x32_bf16 v[128:131], v[96:99], a[48:51], v[128:131]
  s_waitcnt vmcnt(20)
  v_mfma_f32_16x16x32_bf16 v[128:131], v[104:107], a[52:55], v[128:131]
  s_barrier
  v_mfma_f32_16x16x32_bf16 v[128:131], v[112:115], a[56:59], v[128:131]
  ds_read_b128 v[64:67], v16 offset:0
  v_mfma_f32_16x16x32_bf16 v[128:131], v[120:123], a[60:63], v[128:131]
  buffer_store_dword v7, v6, s[40:43], s64 offen sc1
  v_mfma_f32_16x16x32_bf16 v[132:135], v[100:103], a[48:51], v[132:135]
  s_lshr_b32 s62, s63, 3
  ds_read_b128 v[68:71], v16 offset:16384
  v_mfma_f32_16x16x32_bf16 v[132:135], v[108:111], a[52:55], v[132:135]
  s_lshl_b32 s62, s62, 2
  v_mfma_f32_16x16x32_bf16 v[132:135], v[116:119], a[56:59], v[132:135]
  s_lshr_b32 s62, s73, s62
  ds_read_b128 v[72:75], v17 offset:0
  v_mfma_f32_16x16x32_bf16 v[132:135], v[124:127], a[60:63], v[132:135]
  s_and_b32 s62, s62, 7
  v_mfma_f32_16x16x32_bf16 v[136:139], v[96:99], a[112:115], v[136:139]
  s_and_b32 s59, s63, 7
  ds_read_b128 v[76:79], v17 offset:16384
  v_mfma_f32_16x16x32_bf16 v[136:139], v[104:107], a[116:119], v[136:139]
  s_lshl3_add_u32 s62, s62, s59
  v_mfma_f32_16x16x32_bf16 v[136:139], v[112:115], a[120:123], v[136:139]
  s_lshl_b32 s62, s62, 13
  ds_read_b128 v[80:83], v18 offset:0
  v_mfma_f32_16x16x32_bf16 v[136:139], v[120:123], a[124:127], v[136:139]
  s_add_u32 s62, s62, s65
  v_mfma_f32_16x16x32_bf16 v[140:143], v[100:103], a[112:115], v[140:143]
  s_add_u32 s70, s70, 1
  ds_read_b128 v[84:87], v18 offset:16384
  v_mfma_f32_16x16x32_bf16 v[140:143], v[108:111], a[116:119], v[140:143]
  s_lshr_b32 s61, s70, 3
  v_mfma_f32_16x16x32_bf16 v[140:143], v[116:119], a[120:123], v[140:143]
  s_lshl_b32 s61, s61, 2
  ds_read_b128 v[88:91], v19 offset:0
  v_mfma_f32_16x16x32_bf16 v[140:143], v[124:127], a[124:127], v[140:143]
  s_lshr_b32 s61, s73, s61
  v_mfma_f32_16x16x32_bf16 v[144:147], v[96:99], a[176:179], v[144:147]
  s_and_b32 s61, s61, 7
  ds_read_b128 v[92:95], v19 offset:16384
  v_mfma_f32_16x16x32_bf16 v[144:147], v[104:107], a[180:183], v[144:147]
  s_and_b32 s59, s70, 7
  v_mfma_f32_16x16x32_bf16 v[144:147], v[112:115], a[184:187], v[144:147]
  s_lshl3_add_u32 s61, s61, s59
  v_mfma_f32_16x16x32_bf16 v[144:147], v[120:123], a[188:191], v[144:147]
  s_lshl_b32 s61, s61, 15
  v_mfma_f32_16x16x32_bf16 v[148:151], v[100:103], a[176:179], v[148:151]
  s_add_u32 s61, s61, s71
  v_mfma_f32_16x16x32_bf16 v[148:151], v[108:111], a[180:183], v[148:151]
  s_add_u32 s66, s66, 0x8000
  v_mfma_f32_16x16x32_bf16 v[148:151], v[116:119], a[184:187], v[148:151]
  s_and_b32 s66, s66, 0x1ffff
  v_mfma_f32_16x16x32_bf16 v[148:151], v[124:127], a[188:191], v[148:151]
  v_mfma_f32_16x16x32_bf16 v[152:155], v[96:99], a[240:243], v[152:155]
  s_add_u32 s63, s63, 1
  v_mfma_f32_16x16x32_bf16 v[152:155], v[104:107], a[244:247], v[152:155]
  v_mfma_f32_16x16x32_bf16 v[152:155], v[112:115], a[248:251], v[152:155]
  v_mfma_f32_16x16x32_bf16 v[152:155], v[120:123], a[252:255], v[152:155]
  v_mfma_f32_16x16x32_bf16 v[156:159], v[100:103], a[240:243], v[156:159]
  v_mfma_f32_16x16x32_bf16 v[156:159], v[108:111], a[244:247], v[156:159]
  v_mfma_f32_16x16x32_bf16 v[156:159], v[116:119], a[248:251], v[156:159]
  s_cmp_lt_u32 s63, s67
  v_mfma_f32_16x16x32_bf16 v[156:159], v[124:127], a[252:255], v[156:159]
  s_waitcnt lgkmcnt(0)
L_f_11:
  v_mfma_f32_16x16x32_bf16 v[160:163], v[64:67], a[0:3], 0
  v_mfma_f32_16x16x32_bf16 v[160:163], v[72:75], a[4:7], v[160:163]
  v_mfma_f32_16x16x32_bf16 v[160:163], v[80:83], a[8:11], v[160:163]
  ds_read_b128 v[96:99], v16 offset:256
  v_mfma_f32_16x16x32_bf16 v[160:163], v[88:91], a[12:15], v[160:163]
  s_cmp_lg_u32 s57, 6
  s_cbranch_scc1 L_f_pw_22
  buffer_store_dwordx4 v[36:39], v2, s[40:43], s79 offen sc1
  s_add_u32 s79, s79, 0x20000
L_f_pw_22:
  v_mfma_f32_16x16x32_bf16 v[164:167], v[68:71], a[0:3], 0
  ds_read_b128 v[100:103], v16 offset:16640
  v_mfma_f32_16x16x32_bf16 v[164:167], v[76:79], a[4:7], v[164:167]
  v_mfma_f32_16x16x32_bf16 v[164:167], v[84:87], a[8:11], v[164:167]
  ds_read_b128 v[104:107], v17 offset:256
  v_mfma_f32_16x16x32_bf16 v[164:167], v[92:95], a[12:15], v[164:167]
  v_mfma_f32_16x16x32_bf16 v[168:171], v[64:67], a[64:67], 0
  ds_read_b128 v[108:111], v17 offset:16640
  v_mfma_f32_16x16x32_bf16 v[168:171], v[72:75], a[68:71], v[168:171]
  v_cvt_pk_bf16_f32 v192, v128, v129
  v_cvt_pk_bf16_f32 v193, v130, v131
  v_mfma_f32_16x16x32_bf16 v[168:171], v[80:83], a[72:75], v[168:171]
  ds_read_b128 v[112:115], v18 offset:256
  v_cvt_pk_bf16_f32 v194, v132, v133
  v_mfma_f32_16x16x32_bf16 v[168:171], v[88:91], a[76:79], v[168:171]
  v_cvt_pk_bf16_f32 v195, v134, v135
  v_mfma_f32_16x16x32_bf16 v[172:175], v[68:71], a[64:67], 0
  ds_read_b128 v[116:119], v18 offset:16640
  v_mfma_f32_16x16x32_bf16 v[172:175], v[76:79], a[68:71], v[172:175]
  buffer_store_dwordx4 v[192:195], v2, s[40:43], s62 offen offset:0 sc1
  v_mfma_f32_16x16x32_bf16 v[172:175], v[84:87], a[72:75], v[172:175]
  ds_read_b128 v[120:123], v19 offset:256
  v_cvt_pk_bf16_f32 v196, v136, v137
  v_mfma_f32_16x16x32_bf16 v[172:175], v[92:95], a[76:79], v[172:175]
  v_cvt_pk_bf16_f32 v197, v138, v139
  v_cvt_pk_bf16_f32 v198, v140, v141
  v_mfma_f32_16x16x32_bf16 v[176:179], v[64:67], a[128:131], 0
  ds_read_b128 v[124:127], v19 offset:16640
  v_cvt_pk_bf16_f32 v199, v142, v143
  v_mfma_f32_16x16x32_bf16 v[176:179], v[72:75], a[132:135], v[176:179]
  buffer_store_dwordx4 v[196:199], v2, s[40:43], s62 offen offset:1024 sc1
  v_mfma_f32_16x16x32_bf16 v[176:179], v[80:83], a[136:139], v[176:179]
  v_cvt_pk_bf16_f32 v200, v144, v145
  v_cvt_pk_bf16_f32 v201, v146, v147
  v_mfma_f32_16x16x32_bf16 v[176:179], v[88:91], a[140:143], v[176:179]
  v_cvt_pk_bf16_f32 v202, v148, v149
  v_cvt_pk_bf16_f32 v203, v150, v151
  v_mfma_f32_16x16x32_bf16 v[180:183], v[68:71], a[128:131], 0
  buffer_store_dwordx4 v[200:203], v2, s[40:43], s62 offen offset:2048 sc1
  v_mfma_f32_16x16x32_bf16 v[180:183], v[76:79], a[132:135], v[180:183]
  v_cvt_pk_bf16_f32 v204, v152, v153
  v_cvt_pk_bf16_f32 v205, v154, v155
  v_mfma_f32_16x16x32_bf16 v[180:183], v[84:87], a[136:139], v[180:183]
  v_cvt_pk_bf16_f32 v206, v156, v157
  v_cvt_pk_bf16_f32 v207, v158, v159
  v_mfma_f32_16x16x32_bf16 v[180:183], v[92:95], a[140:143], v[180:183]
  buffer_store_dwordx4 v[204:207], v2, s[40:43], s62 offen offset:3072 sc1
  v_mfma_f32_16x16x32_bf16 v[184:187], v[64:67], a[192:195], 0
  v_mfma_f32_16x16x32_bf16 v[184:187], v[72:75], a[196:199], v[184:187]
  v_mfma_f32_16x16x32_bf16 v[184:187], v[80:83], a[200:203], v[184:187]
  v_mfma_f32_16x16x32_bf16 v[184:187], v[88:91], a[204:207], v[184:187]
  v_mfma_f32_16x16x32_bf16 v[188:191], v[68:71], a[192:195], 0
  v_mfma_f32_16x16x32_bf16 v[188:191], v[76:79], a[196:199], v[188:191]
  v_mfma_f32_16x16x32_bf16 v[188:191], v[84:87], a[200:203], v[188:191]
  v_mfma_f32_16x16x32_bf16 v[188:191], v[92:95], a[204:207], v[188:191]
  s_waitcnt lgkmcnt(0)
  v_mfma_f32_16x16x32_bf16 v[160:163], v[96:99], a[16:19], v[160:163]
  v_mfma_f32_16x16x32_bf16 v[160:163], v[104:107], a[20:23], v[160:163]
  v_mfma_f32_16x16x32_bf16 v[160:163], v[112:115], a[24:27], v[160:163]
  ds_read_b128 v[64:67], v16 offset:512
  v_mfma_f32_16x16x32_bf16 v[160:163], v[120:123], a[28:31], v[160:163]
  v_mfma_f32_16x16x32_bf16 v[164:167], v[100:103], a[16:19], v[164:167]
  ds_read_b128 v[68:71], v16 offset:16896
  v_mfma_f32_16x16x32_bf16 v[164:167], v[108:111], a[20:23], v[164:167]
  v_mfma_f32_16x16x32_bf16 v[164:167], v[116:119], a[24:27], v[164:167]
  ds_read_b128 v[72:75], v17 offset:512
  v_mfma_f32_16x16x32_bf16 v[164:167], v[124:127], a[28:31], v[164:167]
  v_mfma_f32_16x16x32_bf16 v[168:171], v[96:99], a[80:83], v[168:171]
  ds_read_b128 v[76:79], v17 offset:16896
  v_mfma_f32_16x16x32_bf16 v[168:171], v[104:107], a[84:87], v[168:171]
  v_mfma_f32_16x16x32_bf16 v[168:171], v[112:115], a[88:91], v[168:171]
  ds_read_b128 v[80:83], v18 offset:512
  v_mfma_f32_16x16x32_bf16 v[168:171], v[120:123], a[92:95], v[168:171]
  v_mfma_f32_16x16x32_bf16 v[172:175], v[100:103], a[80:83], v[172:175]
  ds_read_b128 v[84:87], v18 offset:16896
  v_mfma_f32_16x16x32_bf16 v[172:175], v[108:111], a[84:87], v[172:175]
  v_mfma_f32_16x16x32_bf16 v[172:175], v[116:119], a[88:91], v[172:175]
  ds_read_b128 v[88:91], v19 offset:512
  v_mfma_f32_16x16x32_bf16 v[172:175], v[124:127], a[92:95], v[172:175]
  v_mfma_f32_16x16x32_bf16 v[176:179], v[96:99], a[144:147], v[176:179]
  ds_read_b128 v[92:95], v19 offset:16896
  v_mfma_f32_16x16x32_bf16 v[176:179], v[104:107], a[148:151], v[176:179]
  v_mfma_f32_16x16x32_bf16 v[176:179], v[112:115], a[152:155], v[176:179]
  v_mfma_f32_16x16x32_bf16 v[176:179], v[120:123], a[156:159], v[176:179]
  s_add_u32 m0, s66, 0
  s_add_u32 s58, s61, 0
  v_mfma_f32_16x16x32_bf16 v[180:183], v[100:103], a[144:147], v[180:183]
  v_mfma_f32_16x16x32_bf16 v[180:183], v[108:111], a[148:151], v[180:183]
  buffer_load_dwordx4 v8, s[52:55], s58 offen lds
  v_mfma_f32_16x16x32_bf16 v[180:183], v[116:119], a[152:155], v[180:183]
  v_mfma_f32_16x16x32_bf16 v[180:183], v[124:127], a[156:159], v[180:183]
  s_add_u32 m0, s66, 1024
  s_add_u32 s58, s61, 1024
  v_mfma_f32_16x16x32_bf16 v[184:187], v[96:99], a[208:211], v[184:187]
  v_mfma_f32_16x16x32_bf16 v[184:187], v[104:107], a[212:215], v[184:187]
  buffer_load_dwordx4 v9, s[52:55], s58 offen lds
  v_mfma_f32_16x16x32_bf16 v[184:187], v[112:115], a[216:219], v[184:187]
  v_mfma_f32_16x16x32_bf16 v[184:187], v[120:123], a[220:223], v[184:187]
  s_add_u32 m0, s66, 2048
  s_add_u32 s58, s61, 2048
  v_mfma_f32_16x16x32_bf16 v[188:191], v[100:103], a[208:211], v[188:191]
  v_mfma_f32_16x16x32_bf16 v[188:191], v[108:111], a[212:215], v[188:191]
  buffer_load_dwordx4 v10, s[52:55], s58 offen lds
  v_mfma_f32_16x16x32_bf16 v[188:191], v[116:119], a[216:219], v[188:191]
  v_mfma_f32_16x16x32_bf16 v[188:191], v[124:127], a[220:223], v[188:191]
  s_waitcnt lgkmcnt(0)
  s_add_u32 m0, s66, 3072
  s_add_u32 s58, s61, 3072
  v_mfma_f32_16x16x32_bf16 v[160:163], v[64:67], a[32:35], v[160:163]
  v_mfma_f32_16x16x32_bf16 v[160:163], v[72:75], a[36:39], v[160:163]
  buffer_load_dwordx4 v11, s[52:55], s58 offen lds
  v_mfma_f32_16x16x32_bf16 v[160:163], v[80:83], a[40:43], v[160:163]
  ds_read_b128 v[96:99], v16 offset:768
  v_mfma_f32_16x16x32_bf16 v[160:163], v[88:91], a[44:47], v[160:163]
  s_add_u32 m0, s66, 4096
  s_add_u32 s58, s61, 4096
  v_mfma_f32_16x16x32_bf16 v[164:167], v[68:71], a[32:35], v[164:167]
  ds_read_b128 v[100:103], v16 offset:17152
  v_mfma_f32_16x16x32_bf16 v[164:167], v[76:79], a[36:39], v[164:167]
  buffer_load_dwordx4 v12, s[52:55], s58 offen lds
  v_mfma_f32_16x16x32_bf16 v[164:167], v[84:87], a[40:43], v[164:167]
  ds_read_b128 v[104:107], v17 offset:768
  v_mfma_f32_16x16x32_bf16 v[164:167], v[92:95], a[44:47], v[164:167]
  s_add_u32 m0, s66, 5120
  s_add_u32 s58, s61, 5120
  v_mfma_f32_16x16x32_bf16 v[168:171], v[64:67], a[96:99], v[168:171]
  ds_read_b128 v[108:111], v17 offset:17152
  v_mfma_f32_16x16x32_bf16 v[168:171], v[72:75], a[100:103], v[168:171]
  buffer_load_dwordx4 v13, s[52:55], s58 offen lds
  v_mfma_f32_16x16x32_bf16 v[168:171], v[80:83], a[104:107], v[168:171]
  ds_read_b128 v[112:115], v18 offset:768
  v_mfma_f32_16x16x32_bf16 v[168:171], v[88:91], a[108:111], v[168:171]
  s_add_u32 m0, s66, 6144
  s_add_u32 s58, s61, 6144
  v_mfma_f32_16x16x32_bf16 v[172:175], v[68:71], a[96:99], v[172:175]
  ds_read_b128 v[116:119], v18 offset:17152
  v_mfma_f32_16x16x32_bf16 v[172:175], v[76:79], a[100:103], v[172:175]
  buffer_load_dwordx4 v14, s[52:55], s58 offen lds
  v_mfma_f32_16x16x32_bf16 v[172:175], v[84:87], a[104:107], v[172:175]
  ds_read_b128 v[120:123], v19 offset:768
  v_mfma_f32_16x16x32_bf16 v[172:175], v[92:95], a[108:111], v[172:175]
  s_add_u32 m0, s66, 7168
  s_add_u32 s58, s61, 7168
  v_mfma_f32_16x16x32_bf16 v[176:179], v[64:67], a[160:163], v[176:179]
  ds_read_b128 v[124:127], v19 offset:17152
  v_mfma_f32_16x16x32_bf16 v[176:179], v[72:75], a[164:167], v[176:179]
  buffer_load_dwordx4 v15, s[52:55], s58 offen lds
  v_mfma_f32_16x16x32_bf16 v[176:179], v[80:83], a[168:171], v[176:179]
  v_mfma_f32_16x16x32_bf16 v[176:179], v[88:91], a[172:175], v[176:179]
  v_mfma_f32_16x16x32_bf16 v[180:183], v[68:71], a[160:163], v[180:183]
  v_add_u32 v16, 0x8000, v16
  v_mfma_f32_16x16x32_bf16 v[180:183], v[76:79], a[164:167], v[180:183]
  v_and_b32 v16, 0x1ffff, v16
  v_mfma_f32_16x16x32_bf16 v[180:183], v[84:87], a[168:171], v[180:183]
  v_add_u32 v17, 0x8000, v17
  v_mfma_f32_16x16x32_bf16 v[180:183], v[92:95], a[172:175], v[180:183]
  v_and_b32 v17, 0x1ffff, v17
  v_mfma_f32_16x16x32_bf16 v[184:187], v[64:67], a[224:227], v[184:187]
  v_add_u32 v18, 0x8000, v18
  v_mfma_f32_16x16x32_bf16 v[184:187], v[72:75], a[228:231], v[184:187]
  v_and_b32 v18, 0x1ffff, v18
  v_mfma_f32_16x16x32_bf16 v[184:187], v[80:83], a[232:235], v[184:187]
  v_add_u32 v19, 0x8000, v19
  v_mfma_f32_16x16x32_bf16 v[184:187], v[88:91], a[236:239], v[184:187]
  v_and_b32 v19, 0x1ffff, v19
  v_mfma_f32_16x16x32_bf16 v[188:191], v[68:71], a[224:227], v[188:191]
  s_sub_u32 s59, s63, 1
  s_max_i32 s59, s59, 0
  v_mfma_f32_16x16x32_bf16 v[188:191], v[76:79], a[228:231], v[188:191]
  v_mov_b32 v7, s59
  v_mfma_f32_16x16x32_bf16 v[188:191], v[84:87], a[232:235], v[188:191]
  v_mfma_f32_16x16x32_bf16 v[188:191], v[92:95], a[236:239], v[188:191]
  s_waitcnt lgkmcnt(0)
  v_mfma_f32_16x16x32_bf16 v[160:163], v[96:99], a[48:51], v[160:163]
  s_waitcnt vmcnt(20)
  v_mfma_f32_16x16x32_bf16 v[160:163], v[104:107], a[52:55], v[160:163]
  s_barrier
  v_mfma_f32_16x16x32_bf16 v[160:163], v[112:115], a[56:59], v[160:163]
  ds_read_b128 v[64:67], v16 offset:0
  v_mfma_f32_16x16x32_bf16 v[160:163], v[120:123], a[60:63], v[160:163]
  buffer_store_dword v7, v6, s[40:43], s64 offen sc1
  v_mfma_f32_16x16x32_bf16 v[164:167], v[100:103], a[48:51], v[164:167]
  s_lshr_b32 s62, s63, 3
  ds_read_b128 v[68:71], v16 offset:16384
  v_mfma_f32_16x16x32_bf16 v[164:167], v[108:111], a[52:55], v[164:167]
  s_lshl_b32 s62, s62, 2
  v_mfma_f32_16x16x32_bf16 v[164:167], v[116:119], a[56:59], v[164:167]
  s_lshr_b32 s62, s73, s62
  ds_read_b128 v[72:75], v17 offset:0
  v_mfma_f32_16x16x32_bf16 v[164:167], v[124:127], a[60:63], v[164:167]
  s_and_b32 s62, s62, 7
  v_mfma_f32_16x16x32_bf16 v[168:171], v[96:99], a[112:115], v[168:171]
  s_and_b32 s59, s63, 7
  ds_read_b128 v[76:79], v17 offset:16384
  v_mfma_f32_16x16x32_bf16 v[168:171], v[104:107], a[116:119], v[168:171]
  s_lshl3_add_u32 s62, s62, s59
  v_mfma_f32_16x16x32_bf16 v[168:171], v[112:115], a[120:123], v[168:171]
  s_lshl_b32 s62, s62, 13
  ds_read_b128 v[80:83], v18 offset:0
  v_mfma_f32_16x16x32_bf16 v[168:171], v[120:123], a[124:127], v[168:171]
  s_add_u32 s62, s62, s65
  v_mfma_f32_16x16x32_bf16 v[172:175], v[100:103], a[112:115], v[172:175]
  s_add_u32 s70, s70, 1
  ds_read_b128 v[84:87], v18 offset:16384
  v_mfma_f32_16x16x32_bf16 v[172:175], v[108:111], a[116:119], v[172:175]
  s_lshr_b32 s61, s70, 3
  v_mfma_f32_16x16x32_bf16 v[172:175], v[116:119], a[120:123], v[172:175]
  s_lshl_b32 s61, s61, 2
  ds_read_b128 v[88:91], v19 offset:0
  v_mfma_f32_16x16x32_bf16 v[172:175], v[124:127], a[124:127], v[172:175]
  s_lshr_b32 s61, s73, s61
  v_mfma_f32_16x16x32_bf16 v[176:179], v[96:99], a[176:179], v[176:179]
  s_and_b32 s61, s61, 7
  ds_read_b128 v[92:95], v19 offset:16384
  v_mfma_f32_16x16x32_bf16 v[176:179], v[104:107], a[180:183], v[176:179]
  s_and_b32 s59, s70, 7
  v_mfma_f32_16x16x32_bf16 v[176:179], v[112:115], a[184:187], v[176:179]
  s_lshl3_add_u32 s61, s61, s59
  v_mfma_f32_16x16x32_bf16 v[176:179], v[120:123], a[188:191], v[176:179]
  s_lshl_b32 s61, s61, 15
  v_mfma_f32_16x16x32_bf16 v[180:183], v[100:103], a[176:179], v[180:183]
  s_add_u32 s61, s61, s71
  v_mfma_f32_16x16x32_bf16 v[180:183], v[108:111], a[180:183], v[180:183]
  s_add_u32 s66, s66, 0x8000
  v_mfma_f32_16x16x32_bf16 v[180:183], v[116:119], a[184:187], v[180:183]
  s_and_b32 s66, s66, 0x1ffff
  v_mfma_f32_16x16x32_bf16 v[180:183], v[124:127], a[188:191], v[180:183]
  v_mfma_f32_16x16x32_bf16 v[184:187], v[96:99], a[240:243], v[184:187]
  s_add_u32 s63, s63, 1
  v_mfma_f32_16x16x32_bf16 v[184:187], v[104:107], a[244:247], v[184:187]
  v_mfma_f32_16x16x32_bf16 v[184:187], v[112:115], a[248:251], v[184:187]
  v_mfma_f32_16x16x32_bf16 v[184:187], v[120:123], a[252:255], v[184:187]
  v_mfma_f32_16x16x32_bf16 v[188:191], v[100:103], a[240:243], v[188:191]
  v_mfma_f32_16x16x32_bf16 v[188:191], v[108:111], a[244:247], v[188:191]
  v_mfma_f32_16x16x32_bf16 v[188:191], v[116:119], a[248:251], v[188:191]
  s_cmp_lt_u32 s63, s67
  v_mfma_f32_16x16x32_bf16 v[188:191], v[124:127], a[252:255], v[188:191]
  s_waitcnt lgkmcnt(0)
  s_cbranch_scc1 L_f_10
  s_branch L_f_done
L_f_done:
  s_nop 7
  v_mul_f32 v160, s69, v160
  v_mul_f32 v161, s69, v161
  v_mul_f32 v162, s69, v162
  v_mul_f32 v163, s69, v163
  v_mul_f32 v164, s69, v164
  v_mul_f32 v165, s69, v165
  v_mul_f32 v166, s69, v166
  v_mul_f32 v167, s69, v167
  v_cvt_pk_bf16_f32 v192, v160, v161
  v_cvt_pk_bf16_f32 v193, v162, v163
  v_cvt_pk_bf16_f32 v194, v164, v165
  v_cvt_pk_bf16_f32 v195, v166, v167
  buffer_store_dwordx4 v[192:195], v2, s[40:43], s62 offen offset:0 sc1
  v_mul_f32 v168, s69, v168
  v_mul_f32 v169, s69, v169
  v_mul_f32 v170, s69, v170
  v_mul_f32 v171, s69, v171
  v_mul_f32 v172, s69, v172
  v_mul_f32 v173, s69, v173
  v_mul_f32 v174, s69, v174
  v_mul_f32 v175, s69, v175
  v_cvt_pk_bf16_f32 v196, v168, v169
  v_cvt_pk_bf16_f32 v197, v170, v171
  v_cvt_pk_bf16_f32 v198, v172, v173
  v_cvt_pk_bf16_f32 v199, v174, v175
  buffer_store_dwordx4 v[196:199], v2, s[40:43], s62 offen offset:1024 sc1
  v_mul_f32 v176, s69, v176
  v_mul_f32 v177, s69, v177
  v_mul_f32 v178, s69, v178
  v_mul_f32 v179, s69, v179
  v_mul_f32 v180, s69, v180
  v_mul_f32 v181, s69, v181
  v_mul_f32 v182, s69, v182
  v_mul_f32 v183, s69, v183
  v_cvt_pk_bf16_f32 v200, v176, v177
  v_cvt_pk_bf16_f32 v201, v178, v179
  v_cvt_pk_bf16_f32 v202, v180, v181
  v_cvt_pk_bf16_f32 v203, v182, v183
  buffer_store_dwordx4 v[200:203], v2, s[40:43], s62 offen offset:2048 sc1
  v_mul_f32 v184, s69, v184
  v_mul_f32 v185, s69, v185
  v_mul_f32 v186, s69, v186
  v_mul_f32 v187, s69, v187
  v_mul_f32 v188, s69, v188
  v_mul_f32 v189, s69, v189
  v_mul_f32 v190, s69, v190
  v_mul_f32 v191, s69, v191
  v_cvt_pk_bf16_f32 v204, v184, v185
  v_cvt_pk_bf16_f32 v205, v186, v187
  v_cvt_pk_bf16_f32 v206, v188, v189
  v_cvt_pk_bf16_f32 v207, v190, v191
  buffer_store_dwordx4 v[204:207], v2, s[40:43], s62 offen offset:3072 sc1
  v_mov_b32 v7, s67
  s_waitcnt vmcnt(0) lgkmcnt(0)
  s_barrier
  buffer_store_dword v7, v6, s[40:43], s64 offen sc1
  s_branch L_next
L_after_p:
  s_waitcnt vmcnt(0)
  s_endpgm
L_team:
  s_mov_b32 s67, 0
  v_lshrrev_b32 v20, 4, v0
  v_and_b32 v21, 15, v0
  s_lshl_b32 s68, s44, 11
  s_add_u32 s68, s68, 131072
  v_lshl_add_u32 v2, v0, 4, s68
  v_add_u32 v11, 24576, v2
  s_mov_b32 s73, s68
  s_lshl_b32 s68, s44, 12
  v_lshl_add_u32 v3, v0, 4, s68
  s_lshl_b32 s68, s44, 9
  s_add_u32 s68, s68, 131072
  v_bfe_u32 v22, v0, 3, 1
  v_lshl_add_u32 v5, v22, 8, s68
  v_lshl_add_u32 v5, v20, 6, v5
  v_and_b32 v22, 7, v0
  v_lshl_add_u32 v5, v22, 3, v5
  v_lshrrev_b32 v22, 5, v0
  v_lshlrev_b32 v6, 8, v22
  v_and_b32 v22, 3, v0
  v_lshl_add_u32 v6, v22, 6, v6
  v_bfe_u32 v22, v0, 2, 3
  v_lshl_add_u32 v6, v22, 3, v6
  v_add_u32 v6, 131072, v6
  s_lshl_b32 s68, s44, 9
  s_add_u32 s68, s68, 131072
  v_lshrrev_b32 v22, 1, v0
  v_lshl_add_u32 v7, v22, 4, s68
  s_lshl_b32 s68, s44, 14
  s_lshl_b32 s69, s45, 6
  s_add_u32 s68, s68, s69
  v_lshrrev_b32 v22, 3, v0
  v_lshl_add_u32 v8, v22, 11, s68
  v_and_b32 v22, 7, v0
  v_lshl_add_u32 v8, v22, 3, v8
  v_lshlrev_b32 v9, 8, v20
  v_bfe_u32 v22, v0, 2, 1
  v_lshl_add_u32 v9, v22, 7, v9
  v_and_b32 v22, 1, v0
  v_lshl_add_u32 v9, v22, 6, v9
  v_bfe_u32 v22, v0, 3, 1
  v_lshl_add_u32 v9, v22, 5, v9
  v_bfe_u32 v22, v0, 1, 1
  v_lshl_add_u32 v9, v22, 4, v9
  s_lshl_b32 s68, s44, 16
  s_lshl_b32 s69, s45, 11
  s_add_u32 s68, s68, s69
  s_add_u32 s62, s68, 0xd000000
  v_bfe_u32 v22, v0, 3, 1
  v_lshlrev_b32 v10, 13, v22
  v_lshl_add_u32 v10, v20, 3, v10
  v_bfe_u32 v22, v0, 1, 1
  v_lshl_add_u32 v10, v22, 5, v10
  v_bfe_u32 v22, v0, 2, 1
  v_lshl_add_u32 v10, v22, 2, v10
  v_and_b32 v22, 1, v0
  v_lshl_add_u32 v10, v22, 1, v10
  s_lshl_b32 s64, s44, 11
  s_lshr_b32 s68, s45, 3
  s_lshl_b32 s68, s68, 9
  s_add_u32 s64, s64, s68
  s_and_b32 s68, s45, 1
  s_lshl_b32 s68, s68, 8
  s_add_u32 s64, s64, s68
  s_bfe_u32 s68, s45, 0x20001
  s_lshl_b32 s68, s68, 6
  s_add_u32 s64, s64, s68
  s_add_u32 s64, s64, 0xd040000
  s_mov_b32 s63, 0xd01c000
  s_lshl_b32 s60, s45, 7
  s_add_u32 s60, s60, 0xd081000
  s_lshl_b32 s72, s45, 19
  s_add_u32 s72, s72, 0x3fe0000
  s_mov_b32 s94, 0xaaaaaaaa
  s_mov_b32 s95, 0xaaaaaaaa
  v_mov_b32 v17, 0
  v_mov_b32 v18, 0
  v_mov_b32 v16, 0
  v_mov_b32 v12, 0x3f803f80
  v_mov_b32 v13, 0x3f803f80
  v_mov_b32 v14, 0x3f803f80
  v_mov_b32 v15, 0x3f803f80
  s_mov_b32 s78, 0xff00ff00
  s_mov_b32 s79, 0xff00ff00
  s_mov_b32 s88, 0x3e0293ee
  s_mov_b32 s89, 0x21800000
  s_mov_b32 s91, 0x3c000000
  s_mov_b32 s90, 0xfffe
  s_lshl_b32 s68, s44, 11
  s_add_u32 s70, s68, 147456
  s_add_u32 s71, s68, 139264
  s_lshl_b32 s68, s45, 7
  s_add_u32 s68, s68, 0xd084000
  s_cmp_eq_u32 s44, 0
  s_cselect_b32 s66, s68, 0x40000000
  s_mov_b32 s80, 0x3030303
  s_mov_b32 s81, 0x3030303
  s_mov_b32 s74, 0xd000000
  s_mov_b32 s82, 0xc0c0c0c
  s_mov_b32 s83, 0xc0c0c0c
  s_mov_b32 s75, 0xd010000
  s_mov_b32 s84, 0x30303030
  s_mov_b32 s85, 0x30303030
  s_mov_b32 s76, 0xd020000
  s_mov_b32 s86, 0xc0c0c0c0
  s_mov_b32 s87, 0xc0c0c0c0
  s_mov_b32 s77, 0xd030000
  buffer_store_dwordx2 v[16:17], v8, s[40:43], s74 offen sc1
  buffer_store_dwordx2 v[16:17], v8, s[40:43], s75 offen sc1
  buffer_store_dwordx2 v[16:17], v8, s[40:43], s76 offen sc1
  buffer_store_dwordx2 v[16:17], v8, s[40:43], s77 offen sc1
  v_mov_b32 v22, 0xffff
  buffer_store_short v22, v10, s[40:43], s64 offen sc1
  s_mul_i32 s68, s44, 4
  s_lshr_b32 s68, 0x7640, s68
  s_and_b32 s68, s68, 15
  s_lshl_b32 s68, s68, 12
  s_lshl_b32 s69, s45, 7
  s_add_u32 s68, s68, s69
  s_add_u32 s68, s68, 0xd080000
  v_and_b32 v23, 31, v0
  v_lshlrev_b32 v23, 2, v23
  v_lshrrev_b32 v24, 5, v0
  v_lshl_add_u32 v23, v24, 12, v23
  buffer_store_dword v17, v23, s[40:43], s68 offen sc1
  s_mov_b32 s52, s38
  s_and_b32 s53, s39, 0xffff
  s_mov_b32 s54, 0x100
  s_mov_b32 s55, 0x20000
  s_lshl_b32 s68, 1, s46
  v_mov_b32 v22, s68
  s_cmp_eq_u32 s44, 0
  s_cselect_b32 s69, 0, 0x40000000
  s_mov_b64 exec, 1
  buffer_atomic_or v22, v17, s[52:55], s69 offen offset:128
  s_mov_b64 exec, -1
  v_bfe_u32 v22, v0, 4, 1
  v_lshrrev_b32 v23, 5, v0
  s_lshl_b32 s68, s44, 1
  v_or_b32 v24, s68, v22
  v_lshlrev_b32 v24, 1, v24
  v_xor_b32 v24, v24, v21
  v_lshlrev_b32 v24, 4, v24
  v_lshl_add_u32 v25, v22, 4, v23
  v_add_u32 v25, s68, v25
  v_lshl_add_u32 v26, v25, 13, v24
  s_lshl_b32 s69, s45, 8
  v_add_u32 v26, s69, v26
  s_lshl_b32 s68, s44, 4
  v_add_u32 v25, s68, v20
  v_lshl_add_u32 v27, v25, 10, v24
  s_lshl_b32 s69, s45, 17
  v_add_u32 v27, s69, v27
  v_lshrrev_b32 v22, 5, v0
  v_lshlrev_b32 v28, 12, v22
  v_bfe_u32 v22, v0, 3, 1
  v_lshl_add_u32 v28, v22, 11, v28
  v_lshlrev_b32 v24, 2, v22
  v_bfe_u32 v22, v0, 4, 1
  v_lshl_add_u32 v28, v22, 10, v28
  v_lshl_add_u32 v24, v22, 1, v24
  v_bfe_u32 v22, v0, 2, 1
  v_lshl_add_u32 v28, v22, 8, v28
  v_add_u32 v24, v24, v22
  s_lshl_b32 s68, s44, 1
  v_xor_b32 v24, s68, v24
  v_lshl_add_u32 v28, v24, 5, v28
  v_and_b32 v22, 3, v0
  v_lshl_add_u32 v28, v22, 3, v28
  v_xor_b32 v29, 32, v28
  v_bfe_u32 v22, v0, 3, 1
  v_mul_u32_u24 v22, 2208, v22
  v_xor_b32 v32, v22, v28
  v_xor_b32 v33, 2176, v32
  s_mov_b32 s50, 0x400000
  s_mov_b32 s51, 0x20000
  s_lshl_b32 s56, s44, 10
  s_mov_b32 s48, s30
  s_and_b32 s49, s31, 0xffff
  s_add_u32 m0, s56, 0
  s_mov_b32 s68, 0
  buffer_load_dwordx4 v27, s[48:51], s68 offen  lds
  s_add_u32 m0, s56, 4096
  s_mov_b32 s68, 4096
  buffer_load_dwordx4 v27, s[48:51], s68 offen  lds
  s_add_u32 m0, s56, 8192
  s_mov_b32 s68, 8192
  buffer_load_dwordx4 v27, s[48:51], s68 offen  lds
  s_add_u32 m0, s56, 12288
  s_mov_b32 s68, 12288
  buffer_load_dwordx4 v27, s[48:51], s68 offen  lds
  s_add_u32 m0, s56, 16384
  s_mov_b32 s68, 65536
  buffer_load_dwordx4 v27, s[48:51], s68 offen  lds
  s_add_u32 m0, s56, 20480
  s_mov_b32 s68, 69632
  buffer_load_dwordx4 v27, s[48:51], s68 offen  lds
  s_add_u32 m0, s56, 24576
  s_mov_b32 s68, 73728
  buffer_load_dwordx4 v27, s[48:51], s68 offen  lds
  s_add_u32 m0, s56, 28672
  s_mov_b32 s68, 77824
  buffer_load_dwordx4 v27, s[48:51], s68 offen  lds
  s_add_u32 m0, s56, 32768
  s_mov_b32 s68, 256
  buffer_load_dwordx4 v27, s[48:51], s68 offen  lds
  s_add_u32 m0, s56, 36864
  s_mov_b32 s68, 4352
  buffer_load_dwordx4 v27, s[48:51], s68 offen  lds
  s_add_u32 m0, s56, 40960
  s_mov_b32 s68, 8448
  buffer_load_dwordx4 v27, s[48:51], s68 offen  lds
  s_add_u32 m0, s56, 45056
  s_mov_b32 s68, 12544
  buffer_load_dwordx4 v27, s[48:51], s68 offen  lds
  s_add_u32 m0, s56, 49152
  s_mov_b32 s68, 65792
  buffer_load_dwordx4 v27, s[48:51], s68 offen  lds
  s_add_u32 m0, s56, 53248
  s_mov_b32 s68, 69888
  buffer_load_dwordx4 v27, s[48:51], s68 offen  lds
  s_add_u32 m0, s56, 57344
  s_mov_b32 s68, 73984
  buffer_load_dwordx4 v27, s[48:51], s68 offen  lds
  s_add_u32 m0, s56, 61440
  s_mov_b32 s68, 78080
  buffer_load_dwordx4 v27, s[48:51], s68 offen  lds
  s_add_u32 m0, s56, 65536
  s_mov_b32 s68, 512
  buffer_load_dwordx4 v27, s[48:51], s68 offen  lds
  s_add_u32 m0, s56, 69632
  s_mov_b32 s68, 4608
  buffer_load_dwordx4 v27, s[48:51], s68 offen  lds
  s_add_u32 m0, s56, 73728
  s_mov_b32 s68, 8704
  buffer_load_dwordx4 v27, s[48:51], s68 offen  lds
  s_add_u32 m0, s56, 77824
  s_mov_b32 s68, 12800
  buffer_load_dwordx4 v27, s[48:51], s68 offen  lds
  s_add_u32 m0, s56, 81920
  s_mov_b32 s68, 66048
  buffer_load_dwordx4 v27, s[48:51], s68 offen  lds
  s_add_u32 m0, s56, 86016
  s_mov_b32 s68, 70144
  buffer_load_dwordx4 v27, s[48:51], s68 offen  lds
  s_add_u32 m0, s56, 90112
  s_mov_b32 s68, 74240
  buffer_load_dwordx4 v27, s[48:51], s68 offen  lds
  s_add_u32 m0, s56, 94208
  s_mov_b32 s68, 78336
  buffer_load_dwordx4 v27, s[48:51], s68 offen  lds
  s_add_u32 m0, s56, 98304
  s_mov_b32 s68, 768
  buffer_load_dwordx4 v27, s[48:51], s68 offen  lds
  s_add_u32 m0, s56, 102400
  s_mov_b32 s68, 4864
  buffer_load_dwordx4 v27, s[48:51], s68 offen  lds
  s_add_u32 m0, s56, 106496
  s_mov_b32 s68, 8960
  buffer_load_dwordx4 v27, s[48:51], s68 offen  lds
  s_add_u32 m0, s56, 110592
  s_mov_b32 s68, 13056
  buffer_load_dwordx4 v27, s[48:51], s68 offen  lds
  s_waitcnt vmcnt(24)
  s_barrier
  v_mov_b32 v22, 1
  s_cmp_eq_u32 s44, 0
  s_cselect_b32 s69, 0, 0x40000000
  s_mov_b64 exec, 1
  buffer_atomic_add v22, v17, s[52:55], s69 offen
  s_mov_b64 exec, -1
  s_add_u32 m0, s56, 114688
  s_mov_b32 s68, 66304
  buffer_load_dwordx4 v27, s[48:51], s68 offen  lds
  s_add_u32 m0, s56, 118784
  s_mov_b32 s68, 70400
  buffer_load_dwordx4 v27, s[48:51], s68 offen  lds
  s_add_u32 m0, s56, 122880
  s_mov_b32 s68, 74496
  buffer_load_dwordx4 v27, s[48:51], s68 offen  lds
  s_add_u32 m0, s56, 126976
  s_mov_b32 s68, 78592
  buffer_load_dwordx4 v27, s[48:51], s68 offen  lds
  v_add_u32 v30, 0, v32
  v_add_u32 v31, 0, v33
  s_cmp_lg_u32 s44, 0
  s_cbranch_scc1 L_wr_0_1
  ds_read_b64_tr_b16 v[128:129], v30 offset:0
  ds_read_b64_tr_b16 v[130:131], v30 offset:512
  ds_read_b64_tr_b16 v[132:133], v30 offset:8192
  ds_read_b64_tr_b16 v[134:135], v30 offset:8704
  ds_read_b64_tr_b16 v[136:137], v31 offset:0
  ds_read_b64_tr_b16 v[138:139], v31 offset:512
  ds_read_b64_tr_b16 v[140:141], v31 offset:8192
  ds_read_b64_tr_b16 v[142:143], v31 offset:8704
  s_branch L_wr_0_e
L_wr_0_1:
  s_cmp_lg_u32 s44, 1
  s_cbranch_scc1 L_wr_0_2
  ds_read_b64_tr_b16 v[136:137], v30 offset:0
  ds_read_b64_tr_b16 v[138:139], v30 offset:512
  ds_read_b64_tr_b16 v[140:141], v30 offset:8192
  ds_read_b64_tr_b16 v[142:143], v30 offset:8704
  ds_read_b64_tr_b16 v[128:129], v31 offset:0
  ds_read_b64_tr_b16 v[130:131], v31 offset:512
  ds_read_b64_tr_b16 v[132:133], v31 offset:8192
  ds_read_b64_tr_b16 v[134:135], v31 offset:8704
  s_branch L_wr_0_e
L_wr_0_2:
  s_cmp_lg_u32 s44, 2
  s_cbranch_scc1 L_wr_0_3
  ds_read_b64_tr_b16 v[144:145], v30 offset:0
  ds_read_b64_tr_b16 v[146:147], v30 offset:512
  ds_read_b64_tr_b16 v[148:149], v30 offset:8192
  ds_read_b64_tr_b16 v[150:151], v30 offset:8704
  ds_read_b64_tr_b16 v[152:153], v31 offset:0
  ds_read_b64_tr_b16 v[154:155], v31 offset:512
  ds_read_b64_tr_b16 v[156:157], v31 offset:8192
  ds_read_b64_tr_b16 v[158:159], v31 offset:8704
  s_branch L_wr_0_e
L_wr_0_3:
  ds_read_b64_tr_b16 v[152:153], v30 offset:0
  ds_read_b64_tr_b16 v[154:155], v30 offset:512
  ds_read_b64_tr_b16 v[156:157], v30 offset:8192
  ds_read_b64_tr_b16 v[158:159], v30 offset:8704
  ds_read_b64_tr_b16 v[144:145], v31 offset:0
  ds_read_b64_tr_b16 v[146:147], v31 offset:512
  ds_read_b64_tr_b16 v[148:149], v31 offset:8192
  ds_read_b64_tr_b16 v[150:151], v31 offset:8704
L_wr_0_e:
  s_waitcnt lgkmcnt(0)
  s_waitcnt vmcnt(24)
  s_barrier
  s_mov_b32 s48, s24
  s_and_b32 s49, s25, 0xffff
  s_add_u32 m0, s56, 0
  s_mov_b32 s68, 0
  buffer_load_dwordx4 v26, s[48:51], s68 offen  lds
  s_add_u32 m0, s56, 4096
  s_mov_b32 s68, 65536
  buffer_load_dwordx4 v26, s[48:51], s68 offen  lds
  s_add_u32 m0, s56, 8192
  s_mov_b32 s68, 262144
  buffer_load_dwordx4 v26, s[48:51], s68 offen  lds
  s_add_u32 m0, s56, 12288
  s_mov_b32 s68, 327680
  buffer_load_dwordx4 v26, s[48:51], s68 offen  lds
  v_add_u32 v30, 16384, v32
  v_add_u32 v31, 16384, v33
  s_cmp_lg_u32 s44, 0
  s_cbranch_scc1 L_wr_1_1
  ds_read_b64_tr_b16 v[144:145], v30 offset:0
  ds_read_b64_tr_b16 v[146:147], v30 offset:512
  ds_read_b64_tr_b16 v[148:149], v30 offset:8192
  ds_read_b64_tr_b16 v[150:151], v30 offset:8704
  ds_read_b64_tr_b16 v[152:153], v31 offset:0
  ds_read_b64_tr_b16 v[154:155], v31 offset:512
  ds_read_b64_tr_b16 v[156:157], v31 offset:8192
  ds_read_b64_tr_b16 v[158:159], v31 offset:8704
  s_branch L_wr_1_e
L_wr_1_1:
  s_cmp_lg_u32 s44, 1
  s_cbranch_scc1 L_wr_1_2
  ds_read_b64_tr_b16 v[152:153], v30 offset:0
  ds_read_b64_tr_b16 v[154:155], v30 offset:512
  ds_read_b64_tr_b16 v[156:157], v30 offset:8192
  ds_read_b64_tr_b16 v[158:159], v30 offset:8704
  ds_read_b64_tr_b16 v[144:145], v31 offset:0
  ds_read_b64_tr_b16 v[146:147], v31 offset:512
  ds_read_b64_tr_b16 v[148:149], v31 offset:8192
  ds_read_b64_tr_b16 v[150:151], v31 offset:8704
  s_branch L_wr_1_e
L_wr_1_2:
  s_cmp_lg_u32 s44, 2
  s_cbranch_scc1 L_wr_1_3
  ds_read_b64_tr_b16 v[128:129], v30 offset:0
  ds_read_b64_tr_b16 v[130:131], v30 offset:512
  ds_read_b64_tr_b16 v[132:133], v30 offset:8192
  ds_read_b64_tr_b16 v[134:135], v30 offset:8704
  ds_read_b64_tr_b16 v[136:137], v31 offset:0
  ds_read_b64_tr_b16 v[138:139], v31 offset:512
  ds_read_b64_tr_b16 v[140:141], v31 offset:8192
  ds_read_b64_tr_b16 v[142:143], v31 offset:8704
  s_branch L_wr_1_e
L_wr_1_3:
  ds_read_b64_tr_b16 v[136:137], v30 offset:0
  ds_read_b64_tr_b16 v[138:139], v30 offset:512
  ds_read_b64_tr_b16 v[140:141], v30 offset:8192
  ds_read_b64_tr_b16 v[142:143], v30 offset:8704
  ds_read_b64_tr_b16 v[128:129], v31 offset:0
  ds_read_b64_tr_b16 v[130:131], v31 offset:512
  ds_read_b64_tr_b16 v[132:133], v31 offset:8192
  ds_read_b64_tr_b16 v[134:135], v31 offset:8704
L_wr_1_e:
  s_waitcnt lgkmcnt(0)
  s_waitcnt vmcnt(24)
  s_barrier
  s_add_u32 m0, s56, 16384
  s_mov_b32 s68, 524288
  buffer_load_dwordx4 v26, s[48:51], s68 offen  lds
  s_add_u32 m0, s56, 20480
  s_mov_b32 s68, 589824
  buffer_load_dwordx4 v26, s[48:51], s68 offen  lds
  s_add_u32 m0, s56, 24576
  s_mov_b32 s68, 786432
  buffer_load_dwordx4 v26, s[48:51], s68 offen  lds
  s_add_u32 m0, s56, 28672
  s_mov_b32 s68, 851968
  buffer_load_dwordx4 v26, s[48:51], s68 offen  lds
  v_add_u32 v30, 32768, v32
  v_add_u32 v31, 32768, v33
  s_cmp_lg_u32 s44, 0
  s_cbranch_scc1 L_wr_2_1
  ds_read_b64_tr_b16 v[160:161], v30 offset:0
  ds_read_b64_tr_b16 v[162:163], v30 offset:512
  ds_read_b64_tr_b16 v[164:165], v30 offset:8192
  ds_read_b64_tr_b16 v[166:167], v30 offset:8704
  ds_read_b64_tr_b16 v[168:169], v31 offset:0
  ds_read_b64_tr_b16 v[170:171], v31 offset:512
  ds_read_b64_tr_b16 v[172:173], v31 offset:8192
  ds_read_b64_tr_b16 v[174:175], v31 offset:8704
  s_branch L_wr_2_e
L_wr_2_1:
  s_cmp_lg_u32 s44, 1
  s_cbranch_scc1 L_wr_2_2
  ds_read_b64_tr_b16 v[168:169], v30 offset:0
  ds_read_b64_tr_b16 v[170:171], v30 offset:512
  ds_read_b64_tr_b16 v[172:173], v30 offset:8192
  ds_read_b64_tr_b16 v[174:175], v30 offset:8704
  ds_read_b64_tr_b16 v[160:161], v31 offset:0
  ds_read_b64_tr_b16 v[162:163], v31 offset:512
  ds_read_b64_tr_b16 v[164:165], v31 offset:8192
  ds_read_b64_tr_b16 v[166:167], v31 offset:8704
  s_branch L_wr_2_e
L_wr_2_2:
  s_cmp_lg_u32 s44, 2
  s_cbranch_scc1 L_wr_2_3
  ds_read_b64_tr_b16 v[176:177], v30 offset:0
  ds_read_b64_tr_b16 v[178:179], v30 offset:512
  ds_read_b64_tr_b16 v[180:181], v30 offset:8192
  ds_read_b64_tr_b16 v[182:183], v30 offset:8704
  ds_read_b64_tr_b16 v[184:185], v31 offset:0
  ds_read_b64_tr_b16 v[186:187], v31 offset:512
  ds_read_b64_tr_b16 v[188:189], v31 offset:8192
  ds_read_b64_tr_b16 v[190:191], v31 offset:8704
  s_branch L_wr_2_e
L_wr_2_3:
  ds_read_b64_tr_b16 v[184:185], v30 offset:0
  ds_read_b64_tr_b16 v[186:187], v30 offset:512
  ds_read_b64_tr_b16 v[188:189], v30 offset:8192
  ds_read_b64_tr_b16 v[190:191], v30 offset:8704
  ds_read_b64_tr_b16 v[176:177], v31 offset:0
  ds_read_b64_tr_b16 v[178:179], v31 offset:512
  ds_read_b64_tr_b16 v[180:181], v31 offset:8192
  ds_read_b64_tr_b16 v[182:183], v31 offset:8704
L_wr_2_e:
  s_waitcnt lgkmcnt(0)
  s_waitcnt vmcnt(24)
  s_barrier
  s_add_u32 m0, s56, 32768
  s_mov_b32 s68, 1048576
  buffer_load_dwordx4 v26, s[48:51], s68 offen  lds
  s_add_u32 m0, s56, 36864
  s_mov_b32 s68, 1114112
  buffer_load_dwordx4 v26, s[48:51], s68 offen  lds
  s_add_u32 m0, s56, 40960
  s_mov_b32 s68, 1310720
  buffer_load_dwordx4 v26, s[48:51], s68 offen  lds
  s_add_u32 m0, s56, 45056
  s_mov_b32 s68, 1376256
  buffer_load_dwordx4 v26, s[48:51], s68 offen  lds
  v_add_u32 v30, 49152, v32
  v_add_u32 v31, 49152, v33
  s_cmp_lg_u32 s44, 0
  s_cbranch_scc1 L_wr_3_1
  ds_read_b64_tr_b16 v[176:177], v30 offset:0
  ds_read_b64_tr_b16 v[178:179], v30 offset:512
  ds_read_b64_tr_b16 v[180:181], v30 offset:8192
  ds_read_b64_tr_b16 v[182:183], v30 offset:8704
  ds_read_b64_tr_b16 v[184:185], v31 offset:0
  ds_read_b64_tr_b16 v[186:187], v31 offset:512
  ds_read_b64_tr_b16 v[188:189], v31 offset:8192
  ds_read_b64_tr_b16 v[190:191], v31 offset:8704
  s_branch L_wr_3_e
L_wr_3_1:
  s_cmp_lg_u32 s44, 1
  s_cbranch_scc1 L_wr_3_2
  ds_read_b64_tr_b16 v[184:185], v30 offset:0
  ds_read_b64_tr_b16 v[186:187], v30 offset:512
  ds_read_b64_tr_b16 v[188:189], v30 offset:8192
  ds_read_b64_tr_b16 v[190:191], v30 offset:8704
  ds_read_b64_tr_b16 v[176:177], v31 offset:0
  ds_read_b64_tr_b16 v[178:179], v31 offset:512
  ds_read_b64_tr_b16 v[180:181], v31 offset:8192
  ds_read_b64_tr_b16 v[182:183], v31 offset:8704
  s_branch L_wr_3_e
L_wr_3_2:
  s_cmp_lg_u32 s44, 2
  s_cbranch_scc1 L_wr_3_3
  ds_read_b64_tr_b16 v[160:161], v30 offset:0
  ds_read_b64_tr_b16 v[162:163], v30 offset:512
  ds_read_b64_tr_b16 v[164:165], v30 offset:8192
  ds_read_b64_tr_b16 v[166:167], v30 offset:8704
  ds_read_b64_tr_b16 v[168:169], v31 offset:0
  ds_read_b64_tr_b16 v[170:171], v31 offset:512
  ds_read_b64_tr_b16 v[172:173], v31 offset:8192
  ds_read_b64_tr_b16 v[174:175], v31 offset:8704
  s_branch L_wr_3_e
L_wr_3_3:
  ds_read_b64_tr_b16 v[168:169], v30 offset:0
  ds_read_b64_tr_b16 v[170:171], v30 offset:512
  ds_read_b64_tr_b16 v[172:173], v30 offset:8192
  ds_read_b64_tr_b16 v[174:175], v30 offset:8704
  ds_read_b64_tr_b16 v[160:161], v31 offset:0
  ds_read_b64_tr_b16 v[162:163], v31 offset:512
  ds_read_b64_tr_b16 v[164:165], v31 offset:8192
  ds_read_b64_tr_b16 v[166:167], v31 offset:8704
L_wr_3_e:
  s_waitcnt lgkmcnt(0)
  s_waitcnt vmcnt(24)
  s_barrier
  s_add_u32 m0, s56, 49152
  s_mov_b32 s68, 1572864
  buffer_load_dwordx4 v26, s[48:51], s68 offen  lds
  s_add_u32 m0, s56, 53248
  s_mov_b32 s68, 1638400
  buffer_load_dwordx4 v26, s[48:51], s68 offen  lds
  s_add_u32 m0, s56, 57344
  s_mov_b32 s68, 1835008
  buffer_load_dwordx4 v26, s[48:51], s68 offen  lds
  s_add_u32 m0, s56, 61440
  s_mov_b32 s68, 1900544
  buffer_load_dwordx4 v26, s[48:51], s68 offen  lds
  v_add_u32 v30, 65536, v32
  v_add_u32 v31, 65536, v33
  s_cmp_lg_u32 s44, 0
  s_cbranch_scc1 L_wr_4_1
  ds_read_b64_tr_b16 v[192:193], v30 offset:0
  ds_read_b64_tr_b16 v[194:195], v30 offset:512
  ds_read_b64_tr_b16 v[196:197], v30 offset:8192
  ds_read_b64_tr_b16 v[198:199], v30 offset:8704
  ds_read_b64_tr_b16 v[200:201], v31 offset:0
  ds_read_b64_tr_b16 v[202:203], v31 offset:512
  ds_read_b64_tr_b16 v[204:205], v31 offset:8192
  ds_read_b64_tr_b16 v[206:207], v31 offset:8704
  s_branch L_wr_4_e
L_wr_4_1:
  s_cmp_lg_u32 s44, 1
  s_cbranch_scc1 L_wr_4_2
  ds_read_b64_tr_b16 v[200:201], v30 offset:0
  ds_read_b64_tr_b16 v[202:203], v30 offset:512
  ds_read_b64_tr_b16 v[204:205], v30 offset:8192
  ds_read_b64_tr_b16 v[206:207], v30 offset:8704
  ds_read_b64_tr_b16 v[192:193], v31 offset:0
  ds_read_b64_tr_b16 v[194:195], v31 offset:512
  ds_read_b64_tr_b16 v[196:197], v31 offset:8192
  ds_read_b64_tr_b16 v[198:199], v31 offset:8704
  s_branch L_wr_4_e
L_wr_4_2:
  s_cmp_lg_u32 s44, 2
  s_cbranch_scc1 L_wr_4_3
  ds_read_b64_tr_b16 v[208:209], v30 offset:0
  ds_read_b64_tr_b16 v[210:211], v30 offset:512
  ds_read_b64_tr_b16 v[212:213], v30 offset:8192
  ds_read_b64_tr_b16 v[214:215], v30 offset:8704
  ds_read_b64_tr_b16 v[216:217], v31 offset:0
  ds_read_b64_tr_b16 v[218:219], v31 offset:512
  ds_read_b64_tr_b16 v[220:221], v31 offset:8192
  ds_read_b64_tr_b16 v[222:223], v31 offset:8704
  s_branch L_wr_4_e
L_wr_4_3:
  ds_read_b64_tr_b16 v[216:217], v30 offset:0
  ds_read_b64_tr_b16 v[218:219], v30 offset:512
  ds_read_b64_tr_b16 v[220:221], v30 offset:8192
  ds_read_b64_tr_b16 v[222:223], v30 offset:8704
  ds_read_b64_tr_b16 v[208:209], v31 offset:0
  ds_read_b64_tr_b16 v[210:211], v31 offset:512
  ds_read_b64_tr_b16 v[212:213], v31 offset:8192
  ds_read_b64_tr_b16 v[214:215], v31 offset:8704
L_wr_4_e:
  s_waitcnt lgkmcnt(0)
  s_waitcnt vmcnt(24)
  s_barrier
  s_add_u32 m0, s56, 65536
  s_mov_b32 s68, 2097152
  buffer_load_dwordx4 v26, s[48:51], s68 offen  lds
  s_add_u32 m0, s56, 69632
  s_mov_b32 s68, 2162688
  buffer_load_dwordx4 v26, s[48:51], s68 offen  lds
  s_add_u32 m0, s56, 73728
  s_mov_b32 s68, 2359296
  buffer_load_dwordx4 v26, s[48:51], s68 offen  lds
  s_add_u32 m0, s56, 77824
  s_mov_b32 s68, 2424832
  buffer_load_dwordx4 v26, s[48:51], s68 offen  lds
  v_add_u32 v30, 81920, v32
  v_add_u32 v31, 81920, v33
  s_cmp_lg_u32 s44, 0
  s_cbranch_scc1 L_wr_5_1
  ds_read_b64_tr_b16 v[208:209], v30 offset:0
  ds_read_b64_tr_b16 v[210:211], v30 offset:512
  ds_read_b64_tr_b16 v[212:213], v30 offset:8192
  ds_read_b64_tr_b16 v[214:215], v30 offset:8704
  ds_read_b64_tr_b16 v[216:217], v31 offset:0
  ds_read_b64_tr_b16 v[218:219], v31 offset:512
  ds_read_b64_tr_b16 v[220:221], v31 offset:8192
  ds_read_b64_tr_b16 v[222:223], v31 offset:8704
  s_branch L_wr_5_e
L_wr_5_1:
  s_cmp_lg_u32 s44, 1
  s_cbranch_scc1 L_wr_5_2
  ds_read_b64_tr_b16 v[216:217], v30 offset:0
  ds_read_b64_tr_b16 v[218:219], v30 offset:512
  ds_read_b64_tr_b16 v[220:221], v30 offset:8192
  ds_read_b64_tr_b16 v[222:223], v30 offset:8704
  ds_read_b64_tr_b16 v[208:209], v31 offset:0
  ds_read_b64_tr_b16 v[210:211], v31 offset:512
  ds_read_b64_tr_b16 v[212:213], v31 offset:8192
  ds_read_b64_tr_b16 v[214:215], v31 offset:8704
  s_branch L_wr_5_e
L_wr_5_2:
  s_cmp_lg_u32 s44, 2
  s_cbranch_scc1 L_wr_5_3
  ds_read_b64_tr_b16 v[192:193], v30 offset:0
  ds_read_b64_tr_b16 v[194:195], v30 offset:512
  ds_read_b64_tr_b16 v[196:197], v30 offset:8192
  ds_read_b64_tr_b16 v[198:199], v30 offset:8704
  ds_read_b64_tr_b16 v[200:201], v31 offset:0
  ds_read_b64_tr_b16 v[202:203], v31 offset:512
  ds_read_b64_tr_b16 v[204:205], v31 offset:8192
  ds_read_b64_tr_b16 v[206:207], v31 offset:8704
  s_branch L_wr_5_e
L_wr_5_3:
  ds_read_b64_tr_b16 v[200:201], v30 offset:0
  ds_read_b64_tr_b16 v[202:203], v30 offset:512
  ds_read_b64_tr_b16 v[204:205], v30 offset:8192
  ds_read_b64_tr_b16 v[206:207], v30 offset:8704
  ds_read_b64_tr_b16 v[192:193], v31 offset:0
  ds_read_b64_tr_b16 v[194:195], v31 offset:512
  ds_read_b64_tr_b16 v[196:197], v31 offset:8192
  ds_read_b64_tr_b16 v[198:199], v31 offset:8704
L_wr_5_e:
  s_waitcnt lgkmcnt(0)
  s_waitcnt vmcnt(24)
  s_barrier
  s_add_u32 m0, s56, 81920
  s_mov_b32 s68, 2621440
  buffer_load_dwordx4 v26, s[48:51], s68 offen  lds
  s_add_u32 m0, s56, 86016
  s_mov_b32 s68, 2686976
  buffer_load_dwordx4 v26, s[48:51], s68 offen  lds
  s_add_u32 m0, s56, 90112
  s_mov_b32 s68, 2883584
  buffer_load_dwordx4 v26, s[48:51], s68 offen  lds
  s_add_u32 m0, s56, 94208
  s_mov_b32 s68, 2949120
  buffer_load_dwordx4 v26, s[48:51], s68 offen  lds
  v_add_u32 v30, 98304, v32
  v_add_u32 v31, 98304, v33
  s_cmp_lg_u32 s44, 0
  s_cbranch_scc1 L_wr_6_1
  ds_read_b64_tr_b16 v[224:225], v30 offset:0
  ds_read_b64_tr_b16 v[226:227], v30 offset:512
  ds_read_b64_tr_b16 v[228:229], v30 offset:8192
  ds_read_b64_tr_b16 v[230:231], v30 offset:8704
  ds_read_b64_tr_b16 v[232:233], v31 offset:0
  ds_read_b64_tr_b16 v[234:235], v31 offset:512
  ds_read_b64_tr_b16 v[236:237], v31 offset:8192
  ds_read_b64_tr_b16 v[238:239], v31 offset:8704
  s_branch L_wr_6_e
L_wr_6_1:
  s_cmp_lg_u32 s44, 1
  s_cbranch_scc1 L_wr_6_2
  ds_read_b64_tr_b16 v[232:233], v30 offset:0
  ds_read_b64_tr_b16 v[234:235], v30 offset:512
  ds_read_b64_tr_b16 v[236:237], v30 offset:8192
  ds_read_b64_tr_b16 v[238:239], v30 offset:8704
  ds_read_b64_tr_b16 v[224:225], v31 offset:0
  ds_read_b64_tr_b16 v[226:227], v31 offset:512
  ds_read_b64_tr_b16 v[228:229], v31 offset:8192
  ds_read_b64_tr_b16 v[230:231], v31 offset:8704
  s_branch L_wr_6_e
L_wr_6_2:
  s_cmp_lg_u32 s44, 2
  s_cbranch_scc1 L_wr_6_3
  ds_read_b64_tr_b16 v[240:241], v30 offset:0
  ds_read_b64_tr_b16 v[242:243], v30 offset:512
  ds_read_b64_tr_b16 v[244:245], v30 offset:8192
  ds_read_b64_tr_b16 v[246:247], v30 offset:8704
  ds_read_b64_tr_b16 v[248:249], v31 offset:0
  ds_read_b64_tr_b16 v[250:251], v31 offset:512
  ds_read_b64_tr_b16 v[252:253], v31 offset:8192
  ds_read_b64_tr_b16 v[254:255], v31 offset:8704
  s_branch L_wr_6_e
L_wr_6_3:
  ds_read_b64_tr_b16 v[248:249], v30 offset:0
  ds_read_b64_tr_b16 v[250:251], v30 offset:512
  ds_read_b64_tr_b16 v[252:253], v30 offset:8192
  ds_read_b64_tr_b16 v[254:255], v30 offset:8704
  ds_read_b64_tr_b16 v[240:241], v31 offset:0
  ds_read_b64_tr_b16 v[242:243], v31 offset:512
  ds_read_b64_tr_b16 v[244:245], v31 offset:8192
  ds_read_b64_tr_b16 v[246:247], v31 offset:8704
L_wr_6_e:
  s_waitcnt lgkmcnt(0)
  s_waitcnt vmcnt(24)
  s_barrier
  s_add_u32 m0, s56, 98304
  s_mov_b32 s68, 3145728
  buffer_load_dwordx4 v26, s[48:51], s68 offen  lds
  s_add_u32 m0, s56, 102400
  s_mov_b32 s68, 3211264
  buffer_load_dwordx4 v26, s[48:51], s68 offen  lds
  s_add_u32 m0, s56, 106496
  s_mov_b32 s68, 3407872
  buffer_load_dwordx4 v26, s[48:51], s68 offen  lds
  s_add_u32 m0, s56, 110592
  s_mov_b32 s68, 3473408
  buffer_load_dwordx4 v26, s[48:51], s68 offen  lds
  v_add_u32 v30, 114688, v32
  v_add_u32 v31, 114688, v33
  s_cmp_lg_u32 s44, 0
  s_cbranch_scc1 L_wr_7_1
  ds_read_b64_tr_b16 v[240:241], v30 offset:0
  ds_read_b64_tr_b16 v[242:243], v30 offset:512
  ds_read_b64_tr_b16 v[244:245], v30 offset:8192
  ds_read_b64_tr_b16 v[246:247], v30 offset:8704
  ds_read_b64_tr_b16 v[248:249], v31 offset:0
  ds_read_b64_tr_b16 v[250:251], v31 offset:512
  ds_read_b64_tr_b16 v[252:253], v31 offset:8192
  ds_read_b64_tr_b16 v[254:255], v31 offset:8704
  s_branch L_wr_7_e
L_wr_7_1:
  s_cmp_lg_u32 s44, 1
  s_cbranch_scc1 L_wr_7_2
  ds_read_b64_tr_b16 v[248:249], v30 offset:0
  ds_read_b64_tr_b16 v[250:251], v30 offset:512
  ds_read_b64_tr_b16 v[252:253], v30 offset:8192
  ds_read_b64_tr_b16 v[254:255], v30 offset:8704
  ds_read_b64_tr_b16 v[240:241], v31 offset:0
  ds_read_b64_tr_b16 v[242:243], v31 offset:512
  ds_read_b64_tr_b16 v[244:245], v31 offset:8192
  ds_read_b64_tr_b16 v[246:247], v31 offset:8704
  s_branch L_wr_7_e
L_wr_7_2:
  s_cmp_lg_u32 s44, 2
  s_cbranch_scc1 L_wr_7_3
  ds_read_b64_tr_b16 v[224:225], v30 offset:0
  ds_read_b64_tr_b16 v[226:227], v30 offset:512
  ds_read_b64_tr_b16 v[228:229], v30 offset:8192
  ds_read_b64_tr_b16 v[230:231], v30 offset:8704
  ds_read_b64_tr_b16 v[232:233], v31 offset:0
  ds_read_b64_tr_b16 v[234:235], v31 offset:512
  ds_read_b64_tr_b16 v[236:237], v31 offset:8192
  ds_read_b64_tr_b16 v[238:239], v31 offset:8704
  s_branch L_wr_7_e
L_wr_7_3:
  ds_read_b64_tr_b16 v[232:233], v30 offset:0
  ds_read_b64_tr_b16 v[234:235], v30 offset:512
  ds_read_b64_tr_b16 v[236:237], v30 offset:8192
  ds_read_b64_tr_b16 v[238:239], v30 offset:8704
  ds_read_b64_tr_b16 v[224:225], v31 offset:0
  ds_read_b64_tr_b16 v[226:227], v31 offset:512
  ds_read_b64_tr_b16 v[228:229], v31 offset:8192
  ds_read_b64_tr_b16 v[230:231], v31 offset:8704
L_wr_7_e:
  s_waitcnt lgkmcnt(0)
  s_waitcnt vmcnt(24)
  s_barrier
  s_add_u32 m0, s56, 114688
  s_mov_b32 s68, 3670016
  buffer_load_dwordx4 v26, s[48:51], s68 offen  lds
  s_add_u32 m0, s56, 118784
  s_mov_b32 s68, 3735552
  buffer_load_dwordx4 v26, s[48:51], s68 offen  lds
  s_add_u32 m0, s56, 122880
  s_mov_b32 s68, 3932160
  buffer_load_dwordx4 v26, s[48:51], s68 offen  lds
  s_add_u32 m0, s56, 126976
  s_mov_b32 s68, 3997696
  buffer_load_dwordx4 v26, s[48:51], s68 offen  lds
  v_add_u32 v30, 0, v28
  v_add_u32 v31, 0, v29
  s_cmp_lg_u32 s44, 0
  s_cbranch_scc1 L_wr_8_1
  ds_read_b64_tr_b16 a[0:1], v30 offset:0
  ds_read_b64_tr_b16 a[2:3], v30 offset:512
  ds_read_b64_tr_b16 a[4:5], v30 offset:8192
  ds_read_b64_tr_b16 a[6:7], v30 offset:8704
  ds_read_b64_tr_b16 a[64:65], v31 offset:0
  ds_read_b64_tr_b16 a[66:67], v31 offset:512
  ds_read_b64_tr_b16 a[68:69], v31 offset:8192
  ds_read_b64_tr_b16 a[70:71], v31 offset:8704
  s_branch L_wr_8_e
L_wr_8_1:
  s_cmp_lg_u32 s44, 1
  s_cbranch_scc1 L_wr_8_2
  ds_read_b64_tr_b16 a[16:17], v30 offset:0
  ds_read_b64_tr_b16 a[18:19], v30 offset:512
  ds_read_b64_tr_b16 a[20:21], v30 offset:8192
  ds_read_b64_tr_b16 a[22:23], v30 offset:8704
  ds_read_b64_tr_b16 a[80:81], v31 offset:0
  ds_read_b64_tr_b16 a[82:83], v31 offset:512
  ds_read_b64_tr_b16 a[84:85], v31 offset:8192
  ds_read_b64_tr_b16 a[86:87], v31 offset:8704
  s_branch L_wr_8_e
L_wr_8_2:
  s_cmp_lg_u32 s44, 2
  s_cbranch_scc1 L_wr_8_3
  ds_read_b64_tr_b16 a[32:33], v30 offset:0
  ds_read_b64_tr_b16 a[34:35], v30 offset:512
  ds_read_b64_tr_b16 a[36:37], v30 offset:8192
  ds_read_b64_tr_b16 a[38:39], v30 offset:8704
  ds_read_b64_tr_b16 a[96:97], v31 offset:0
  ds_read_b64_tr_b16 a[98:99], v31 offset:512
  ds_read_b64_tr_b16 a[100:101], v31 offset:8192
  ds_read_b64_tr_b16 a[102:103], v31 offset:8704
  s_branch L_wr_8_e
L_wr_8_3:
  ds_read_b64_tr_b16 a[48:49], v30 offset:0
  ds_read_b64_tr_b16 a[50:51], v30 offset:512
  ds_read_b64_tr_b16 a[52:53], v30 offset:8192
  ds_read_b64_tr_b16 a[54:55], v30 offset:8704
  ds_read_b64_tr_b16 a[112:113], v31 offset:0
  ds_read_b64_tr_b16 a[114:115], v31 offset:512
  ds_read_b64_tr_b16 a[116:117], v31 offset:8192
  ds_read_b64_tr_b16 a[118:119], v31 offset:8704
L_wr_8_e:
  s_waitcnt lgkmcnt(0)
  s_waitcnt vmcnt(24)
  s_barrier
  s_mov_b32 s48, s26
  s_and_b32 s49, s27, 0xffff
  s_add_u32 m0, s56, 0
  s_mov_b32 s68, 0
  buffer_load_dwordx4 v26, s[48:51], s68 offen  lds
  s_add_u32 m0, s56, 4096
  s_mov_b32 s68, 65536
  buffer_load_dwordx4 v26, s[48:51], s68 offen  lds
  s_add_u32 m0, s56, 8192
  s_mov_b32 s68, 262144
  buffer_load_dwordx4 v26, s[48:51], s68 offen  lds
  s_add_u32 m0, s56, 12288
  s_mov_b32 s68, 327680
  buffer_load_dwordx4 v26, s[48:51], s68 offen  lds
  v_add_u32 v30, 16384, v28
  v_add_u32 v31, 16384, v29
  s_cmp_lg_u32 s44, 0
  s_cbranch_scc1 L_wr_9_1
  ds_read_b64_tr_b16 a[8:9], v30 offset:0
  ds_read_b64_tr_b16 a[10:11], v30 offset:512
  ds_read_b64_tr_b16 a[12:13], v30 offset:8192
  ds_read_b64_tr_b16 a[14:15], v30 offset:8704
  ds_read_b64_tr_b16 a[72:73], v31 offset:0
  ds_read_b64_tr_b16 a[74:75], v31 offset:512
  ds_read_b64_tr_b16 a[76:77], v31 offset:8192
  ds_read_b64_tr_b16 a[78:79], v31 offset:8704
  s_branch L_wr_9_e
L_wr_9_1:
  s_cmp_lg_u32 s44, 1
  s_cbranch_scc1 L_wr_9_2
  ds_read_b64_tr_b16 a[24:25], v30 offset:0
  ds_read_b64_tr_b16 a[26:27], v30 offset:512
  ds_read_b64_tr_b16 a[28:29], v30 offset:8192
  ds_read_b64_tr_b16 a[30:31], v30 offset:8704
  ds_read_b64_tr_b16 a[88:89], v31 offset:0
  ds_read_b64_tr_b16 a[90:91], v31 offset:512
  ds_read_b64_tr_b16 a[92:93], v31 offset:8192
  ds_read_b64_tr_b16 a[94:95], v31 offset:8704
  s_branch L_wr_9_e
L_wr_9_2:
  s_cmp_lg_u32 s44, 2
  s_cbranch_scc1 L_wr_9_3
  ds_read_b64_tr_b16 a[40:41], v30 offset:0
  ds_read_b64_tr_b16 a[42:43], v30 offset:512
  ds_read_b64_tr_b16 a[44:45], v30 offset:8192
  ds_read_b64_tr_b16 a[46:47], v30 offset:8704
  ds_read_b64_tr_b16 a[104:105], v31 offset:0
  ds_read_b64_tr_b16 a[106:107], v31 offset:512
  ds_read_b64_tr_b16 a[108:109], v31 offset:8192
  ds_read_b64_tr_b16 a[110:111], v31 offset:8704
  s_branch L_wr_9_e
L_wr_9_3:
  ds_read_b64_tr_b16 a[56:57], v30 offset:0
  ds_read_b64_tr_b16 a[58:59], v30 offset:512
  ds_read_b64_tr_b16 a[60:61], v30 offset:8192
  ds_read_b64_tr_b16 a[62:63], v30 offset:8704
  ds_read_b64_tr_b16 a[120:121], v31 offset:0
  ds_read_b64_tr_b16 a[122:123], v31 offset:512
  ds_read_b64_tr_b16 a[124:125], v31 offset:8192
  ds_read_b64_tr_b16 a[126:127], v31 offset:8704
L_wr_9_e:
  s_waitcnt lgkmcnt(0)
  s_waitcnt vmcnt(24)
  s_barrier
  s_add_u32 m0, s56, 16384
  s_mov_b32 s68, 524288
  buffer_load_dwordx4 v26, s[48:51], s68 offen  lds
  s_add_u32 m0, s56, 20480
  s_mov_b32 s68, 589824
  buffer_load_dwordx4 v26, s[48:51], s68 offen  lds
  s_add_u32 m0, s56, 24576
  s_mov_b32 s68, 786432
  buffer_load_dwordx4 v26, s[48:51], s68 offen  lds
  s_add_u32 m0, s56, 28672
  s_mov_b32 s68, 851968
  buffer_load_dwordx4 v26, s[48:51], s68 offen  lds
  v_add_u32 v30, 32768, v28
  v_add_u32 v31, 32768, v29
  s_cmp_lg_u32 s44, 0
  s_cbranch_scc1 L_wr_10_1
  ds_read_b64_tr_b16 a[16:17], v30 offset:0
  ds_read_b64_tr_b16 a[18:19], v30 offset:512
  ds_read_b64_tr_b16 a[20:21], v30 offset:8192
  ds_read_b64_tr_b16 a[22:23], v30 offset:8704
  ds_read_b64_tr_b16 a[80:81], v31 offset:0
  ds_read_b64_tr_b16 a[82:83], v31 offset:512
  ds_read_b64_tr_b16 a[84:85], v31 offset:8192
  ds_read_b64_tr_b16 a[86:87], v31 offset:8704
  s_branch L_wr_10_e
L_wr_10_1:
  s_cmp_lg_u32 s44, 1
  s_cbranch_scc1 L_wr_10_2
  ds_read_b64_tr_b16 a[0:1], v30 offset:0
  ds_read_b64_tr_b16 a[2:3], v30 offset:512
  ds_read_b64_tr_b16 a[4:5], v30 offset:8192
  ds_read_b64_tr_b16 a[6:7], v30 offset:8704
  ds_read_b64_tr_b16 a[64:65], v31 offset:0
  ds_read_b64_tr_b16 a[66:67], v31 offset:512
  ds_read_b64_tr_b16 a[68:69], v31 offset:8192
  ds_read_b64_tr_b16 a[70:71], v31 offset:8704
  s_branch L_wr_10_e
L_wr_10_2:
  s_cmp_lg_u32 s44, 2
  s_cbranch_scc1 L_wr_10_3
  ds_read_b64_tr_b16 a[48:49], v30 offset:0
  ds_read_b64_tr_b16 a[50:51], v30 offset:512
  ds_read_b64_tr_b16 a[52:53], v30 offset:8192
  ds_read_b64_tr_b16 a[54:55], v30 offset:8704
  ds_read_b64_tr_b16 a[112:113], v31 offset:0
  ds_read_b64_tr_b16 a[114:115], v31 offset:512
  ds_read_b64_tr_b16 a[116:117], v31 offset:8192
  ds_read_b64_tr_b16 a[118:119], v31 offset:8704
  s_branch L_wr_10_e
L_wr_10_3:
  ds_read_b64_tr_b16 a[32:33], v30 offset:0
  ds_read_b64_tr_b16 a[34:35], v30 offset:512
  ds_read_b64_tr_b16 a[36:37], v30 offset:8192
  ds_read_b64_tr_b16 a[38:39], v30 offset:8704
  ds_read_b64_tr_b16 a[96:97], v31 offset:0
  ds_read_b64_tr_b16 a[98:99], v31 offset:512
  ds_read_b64_tr_b16 a[100:101], v31 offset:8192
  ds_read_b64_tr_b16 a[102:103], v31 offset:8704
L_wr_10_e:
  s_waitcnt lgkmcnt(0)
  s_waitcnt vmcnt(24)
  s_barrier
  s_add_u32 m0, s56, 32768
  s_mov_b32 s68, 1048576
  buffer_load_dwordx4 v26, s[48:51], s68 offen  lds
  s_add_u32 m0, s56, 36864
  s_mov_b32 s68, 1114112
  buffer_load_dwordx4 v26, s[48:51], s68 offen  lds
  s_add_u32 m0, s56, 40960
  s_mov_b32 s68, 1310720
  buffer_load_dwordx4 v26, s[48:51], s68 offen  lds
  s_add_u32 m0, s56, 45056
  s_mov_b32 s68, 1376256
  buffer_load_dwordx4 v26, s[48:51], s68 offen  lds
  v_add_u32 v30, 49152, v28
  v_add_u32 v31, 49152, v29
  s_cmp_lg_u32 s44, 0
  s_cbranch_scc1 L_wr_11_1
  ds_read_b64_tr_b16 a[24:25], v30 offset:0
  ds_read_b64_tr_b16 a[26:27], v30 offset:512
  ds_read_b64_tr_b16 a[28:29], v30 offset:8192
  ds_read_b64_tr_b16 a[30:31], v30 offset:8704
  ds_read_b64_tr_b16 a[88:89], v31 offset:0
  ds_read_b64_tr_b16 a[90:91], v31 offset:512
  ds_read_b64_tr_b16 a[92:93], v31 offset:8192
  ds_read_b64_tr_b16 a[94:95], v31 offset:8704
  s_branch L_wr_11_e
L_wr_11_1:
  s_cmp_lg_u32 s44, 1
  s_cbranch_scc1 L_wr_11_2
  ds_read_b64_tr_b16 a[8:9], v30 offset:0
  ds_read_b64_tr_b16 a[10:11], v30 offset:512
  ds_read_b64_tr_b16 a[12:13], v30 offset:8192
  ds_read_b64_tr_b16 a[14:15], v30 offset:8704
  ds_read_b64_tr_b16 a[72:73], v31 offset:0
  ds_read_b64_tr_b16 a[74:75], v31 offset:512
  ds_read_b64_tr_b16 a[76:77], v31 offset:8192
  ds_read_b64_tr_b16 a[78:79], v31 offset:8704
  s_branch L_wr_11_e
L_wr_11_2:
  s_cmp_lg_u32 s44, 2
  s_cbranch_scc1 L_wr_11_3
  ds_read_b64_tr_b16 a[56:57], v30 offset:0
  ds_read_b64_tr_b16 a[58:59], v30 offset:512
  ds_read_b64_tr_b16 a[60:61], v30 offset:8192
  ds_read_b64_tr_b16 a[62:63], v30 offset:8704
  ds_read_b64_tr_b16 a[120:121], v31 offset:0
  ds_read_b64_tr_b16 a[122:123], v31 offset:512
  ds_read_b64_tr_b16 a[124:125], v31 offset:8192
  ds_read_b64_tr_b16 a[126:127], v31 offset:8704
  s_branch L_wr_11_e
L_wr_11_3:
  ds_read_b64_tr_b16 a[40:41], v30 offset:0
  ds_read_b64_tr_b16 a[42:43], v30 offset:512
  ds_read_b64_tr_b16 a[44:45], v30 offset:8192
  ds_read_b64_tr_b16 a[46:47], v30 offset:8704
  ds_read_b64_tr_b16 a[104:105], v31 offset:0
  ds_read_b64_tr_b16 a[106:107], v31 offset:512
  ds_read_b64_tr_b16 a[108:109], v31 offset:8192
  ds_read_b64_tr_b16 a[110:111], v31 offset:8704
L_wr_11_e:
  s_waitcnt lgkmcnt(0)
  s_waitcnt vmcnt(24)
  s_barrier
  s_add_u32 m0, s56, 49152
  s_mov_b32 s68, 1572864
  buffer_load_dwordx4 v26, s[48:51], s68 offen  lds
  s_add_u32 m0, s56, 53248
  s_mov_b32 s68, 1638400
  buffer_load_dwordx4 v26, s[48:51], s68 offen  lds
  s_add_u32 m0, s56, 57344
  s_mov_b32 s68, 1835008
  buffer_load_dwordx4 v26, s[48:51], s68 offen  lds
  s_add_u32 m0, s56, 61440
  s_mov_b32 s68, 1900544
  buffer_load_dwordx4 v26, s[48:51], s68 offen  lds
  v_add_u32 v30, 65536, v28
  v_add_u32 v31, 65536, v29
  s_cmp_lg_u32 s44, 0
  s_cbranch_scc1 L_wr_12_1
  ds_read_b64_tr_b16 a[32:33], v30 offset:0
  ds_read_b64_tr_b16 a[34:35], v30 offset:512
  ds_read_b64_tr_b16 a[36:37], v30 offset:8192
  ds_read_b64_tr_b16 a[38:39], v30 offset:8704
  ds_read_b64_tr_b16 a[96:97], v31 offset:0
  ds_read_b64_tr_b16 a[98:99], v31 offset:512
  ds_read_b64_tr_b16 a[100:101], v31 offset:8192
  ds_read_b64_tr_b16 a[102:103], v31 offset:8704
  s_branch L_wr_12_e
L_wr_12_1:
  s_cmp_lg_u32 s44, 1
  s_cbranch_scc1 L_wr_12_2
  ds_read_b64_tr_b16 a[48:49], v30 offset:0
  ds_read_b64_tr_b16 a[50:51], v30 offset:512
  ds_read_b64_tr_b16 a[52:53], v30 offset:8192
  ds_read_b64_tr_b16 a[54:55], v30 offset:8704
  ds_read_b64_tr_b16 a[112:113], v31 offset:0
  ds_read_b64_tr_b16 a[114:115], v31 offset:512
  ds_read_b64_tr_b16 a[116:117], v31 offset:8192
  ds_read_b64_tr_b16 a[118:119], v31 offset:8704
  s_branch L_wr_12_e
L_wr_12_2:
  s_cmp_lg_u32 s44, 2
  s_cbranch_scc1 L_wr_12_3
  ds_read_b64_tr_b16 a[0:1], v30 offset:0
  ds_read_b64_tr_b16 a[2:3], v30 offset:512
  ds_read_b64_tr_b16 a[4:5], v30 offset:8192
  ds_read_b64_tr_b16 a[6:7], v30 offset:8704
  ds_read_b64_tr_b16 a[64:65], v31 offset:0
  ds_read_b64_tr_b16 a[66:67], v31 offset:512
  ds_read_b64_tr_b16 a[68:69], v31 offset:8192
  ds_read_b64_tr_b16 a[70:71], v31 offset:8704
  s_branch L_wr_12_e
L_wr_12_3:
  ds_read_b64_tr_b16 a[16:17], v30 offset:0
  ds_read_b64_tr_b16 a[18:19], v30 offset:512
  ds_read_b64_tr_b16 a[20:21], v30 offset:8192
  ds_read_b64_tr_b16 a[22:23], v30 offset:8704
  ds_read_b64_tr_b16 a[80:81], v31 offset:0
  ds_read_b64_tr_b16 a[82:83], v31 offset:512
  ds_read_b64_tr_b16 a[84:85], v31 offset:8192
  ds_read_b64_tr_b16 a[86:87], v31 offset:8704
L_wr_12_e:
  s_waitcnt lgkmcnt(0)
  s_waitcnt vmcnt(24)
  s_barrier
  s_add_u32 m0, s56, 65536
  s_mov_b32 s68, 2097152
  buffer_load_dwordx4 v26, s[48:51], s68 offen  lds
  s_add_u32 m0, s56, 69632
  s_mov_b32 s68, 2162688
  buffer_load_dwordx4 v26, s[48:51], s68 offen  lds
  s_add_u32 m0, s56, 73728
  s_mov_b32 s68, 2359296
  buffer_load_dwordx4 v26, s[48:51], s68 offen  lds
  s_add_u32 m0, s56, 77824
  s_mov_b32 s68, 2424832
  buffer_load_dwordx4 v26, s[48:51], s68 offen  lds
  v_add_u32 v30, 81920, v28
  v_add_u32 v31, 81920, v29
  s_cmp_lg_u32 s44, 0
  s_cbranch_scc1 L_wr_13_1
  ds_read_b64_tr_b16 a[40:41], v30 offset:0
  ds_read_b64_tr_b16 a[42:43], v30 offset:512
  ds_read_b64_tr_b16 a[44:45], v30 offset:8192
  ds_read_b64_tr_b16 a[46:47], v30 offset:8704
  ds_read_b64_tr_b16 a[104:105], v31 offset:0
  ds_read_b64_tr_b16 a[106:107], v31 offset:512
  ds_read_b64_tr_b16 a[108:109], v31 offset:8192
  ds_read_b64_tr_b16 a[110:111], v31 offset:8704
  s_branch L_wr_13_e
L_wr_13_1:
  s_cmp_lg_u32 s44, 1
  s_cbranch_scc1 L_wr_13_2
  ds_read_b64_tr_b16 a[56:57], v30 offset:0
  ds_read_b64_tr_b16 a[58:59], v30 offset:512
  ds_read_b64_tr_b16 a[60:61], v30 offset:8192
  ds_read_b64_tr_b16 a[62:63], v30 offset:8704
  ds_read_b64_tr_b16 a[120:121], v31 offset:0
  ds_read_b64_tr_b16 a[122:123], v31 offset:512
  ds_read_b64_tr_b16 a[124:125], v31 offset:8192
  ds_read_b64_tr_b16 a[126:127], v31 offset:8704
  s_branch L_wr_13_e
L_wr_13_2:
  s_cmp_lg_u32 s44, 2
  s_cbranch_scc1 L_wr_13_3
  ds_read_b64_tr_b16 a[8:9], v30 offset:0
  ds_read_b64_tr_b16 a[10:11], v30 offset:512
  ds_read_b64_tr_b16 a[12:13], v30 offset:8192
  ds_read_b64_tr_b16 a[14:15], v30 offset:8704
  ds_read_b64_tr_b16 a[72:73], v31 offset:0
  ds_read_b64_tr_b16 a[74:75], v31 offset:512
  ds_read_b64_tr_b16 a[76:77], v31 offset:8192
  ds_read_b64_tr_b16 a[78:79], v31 offset:8704
  s_branch L_wr_13_e
L_wr_13_3:
  ds_read_b64_tr_b16 a[24:25], v30 offset:0
  ds_read_b64_tr_b16 a[26:27], v30 offset:512
  ds_read_b64_tr_b16 a[28:29], v30 offset:8192
  ds_read_b64_tr_b16 a[30:31], v30 offset:8704
  ds_read_b64_tr_b16 a[88:89], v31 offset:0
  ds_read_b64_tr_b16 a[90:91], v31 offset:512
  ds_read_b64_tr_b16 a[92:93], v31 offset:8192
  ds_read_b64_tr_b16 a[94:95], v31 offset:8704
L_wr_13_e:
  s_waitcnt lgkmcnt(0)
  s_waitcnt vmcnt(24)
  s_barrier
  s_add_u32 m0, s56, 81920
  s_mov_b32 s68, 2621440
  buffer_load_dwordx4 v26, s[48:51], s68 offen  lds
  s_add_u32 m0, s56, 86016
  s_mov_b32 s68, 2686976
  buffer_load_dwordx4 v26, s[48:51], s68 offen  lds
  s_add_u32 m0, s56, 90112
  s_mov_b32 s68, 2883584
  buffer_load_dwordx4 v26, s[48:51], s68 offen  lds
  s_add_u32 m0, s56, 94208
  s_mov_b32 s68, 2949120
  buffer_load_dwordx4 v26, s[48:51], s68 offen  lds
  v_add_u32 v30, 98304, v28
  v_add_u32 v31, 98304, v29
  s_cmp_lg_u32 s44, 0
  s_cbranch_scc1 L_wr_14_1
  ds_read_b64_tr_b16 a[48:49], v30 offset:0
  ds_read_b64_tr_b16 a[50:51], v30 offset:512
  ds_read_b64_tr_b16 a[52:53], v30 offset:8192
  ds_read_b64_tr_b16 a[54:55], v30 offset:8704
  ds_read_b64_tr_b16 a[112:113], v31 offset:0
  ds_read_b64_tr_b16 a[114:115], v31 offset:512
  ds_read_b64_tr_b16 a[116:117], v31 offset:8192
  ds_read_b64_tr_b16 a[118:119], v31 offset:8704
  s_branch L_wr_14_e
L_wr_14_1:
  s_cmp_lg_u32 s44, 1
  s_cbranch_scc1 L_wr_14_2
  ds_read_b64_tr_b16 a[32:33], v30 offset:0
  ds_read_b64_tr_b16 a[34:35], v30 offset:512
  ds_read_b64_tr_b16 a[36:37], v30 offset:8192
  ds_read_b64_tr_b16 a[38:39], v30 offset:8704
  ds_read_b64_tr_b16 a[96:97], v31 offset:0
  ds_read_b64_tr_b16 a[98:99], v31 offset:512
  ds_read_b64_tr_b16 a[100:101], v31 offset:8192
  ds_read_b64_tr_b16 a[102:103], v31 offset:8704
  s_branch L_wr_14_e
L_wr_14_2:
  s_cmp_lg_u32 s44, 2
  s_cbranch_scc1 L_wr_14_3
  ds_read_b64_tr_b16 a[16:17], v30 offset:0
  ds_read_b64_tr_b16 a[18:19], v30 offset:512
  ds_read_b64_tr_b16 a[20:21], v30 offset:8192
  ds_read_b64_tr_b16 a[22:23], v30 offset:8704
  ds_read_b64_tr_b16 a[80:81], v31 offset:0
  ds_read_b64_tr_b16 a[82:83], v31 offset:512
  ds_read_b64_tr_b16 a[84:85], v31 offset:8192
  ds_read_b64_tr_b16 a[86:87], v31 offset:8704
  s_branch L_wr_14_e
L_wr_14_3:
  ds_read_b64_tr_b16 a[0:1], v30 offset:0
  ds_read_b64_tr_b16 a[2:3], v30 offset:512
  ds_read_b64_tr_b16 a[4:5], v30 offset:8192
  ds_read_b64_tr_b16 a[6:7], v30 offset:8704
  ds_read_b64_tr_b16 a[64:65], v31 offset:0
  ds_read_b64_tr_b16 a[66:67], v31 offset:512
  ds_read_b64_tr_b16 a[68:69], v31 offset:8192
  ds_read_b64_tr_b16 a[70:71], v31 offset:8704
L_wr_14_e:
  s_waitcnt lgkmcnt(0)
  s_waitcnt vmcnt(24)
  s_barrier
  s_add_u32 m0, s56, 98304
  s_mov_b32 s68, 3145728
  buffer_load_dwordx4 v26, s[48:51], s68 offen  lds
  s_add_u32 m0, s56, 102400
  s_mov_b32 s68, 3211264
  buffer_load_dwordx4 v26, s[48:51], s68 offen  lds
  s_add_u32 m0, s56, 106496
  s_mov_b32 s68, 3407872
  buffer_load_dwordx4 v26, s[48:51], s68 offen  lds
  s_add_u32 m0, s56, 110592
  s_mov_b32 s68, 3473408
  buffer_load_dwordx4 v26, s[48:51], s68 offen  lds
  v_add_u32 v30, 114688, v28
  v_add_u32 v31, 114688, v29
  s_cmp_lg_u32 s44, 0
  s_cbranch_scc1 L_wr_15_1
  ds_read_b64_tr_b16 a[56:57], v30 offset:0
  ds_read_b64_tr_b16 a[58:59], v30 offset:512
  ds_read_b64_tr_b16 a[60:61], v30 offset:8192
  ds_read_b64_tr_b16 a[62:63], v30 offset:8704
  ds_read_b64_tr_b16 a[120:121], v31 offset:0
  ds_read_b64_tr_b16 a[122:123], v31 offset:512
  ds_read_b64_tr_b16 a[124:125], v31 offset:8192
  ds_read_b64_tr_b16 a[126:127], v31 offset:8704
  s_branch L_wr_15_e
L_wr_15_1:
  s_cmp_lg_u32 s44, 1
  s_cbranch_scc1 L_wr_15_2
  ds_read_b64_tr_b16 a[40:41], v30 offset:0
  ds_read_b64_tr_b16 a[42:43], v30 offset:512
  ds_read_b64_tr_b16 a[44:45], v30 offset:8192
  ds_read_b64_tr_b16 a[46:47], v30 offset:8704
  ds_read_b64_tr_b16 a[104:105], v31 offset:0
  ds_read_b64_tr_b16 a[106:107], v31 offset:512
  ds_read_b64_tr_b16 a[108:109], v31 offset:8192
  ds_read_b64_tr_b16 a[110:111], v31 offset:8704
  s_branch L_wr_15_e
L_wr_15_2:
  s_cmp_lg_u32 s44, 2
  s_cbranch_scc1 L_wr_15_3
  ds_read_b64_tr_b16 a[24:25], v30 offset:0
  ds_read_b64_tr_b16 a[26:27], v30 offset:512
  ds_read_b64_tr_b16 a[28:29], v30 offset:8192
  ds_read_b64_tr_b16 a[30:31], v30 offset:8704
  ds_read_b64_tr_b16 a[88:89], v31 offset:0
  ds_read_b64_tr_b16 a[90:91], v31 offset:512
  ds_read_b64_tr_b16 a[92:93], v31 offset:8192
  ds_read_b64_tr_b16 a[94:95], v31 offset:8704
  s_branch L_wr_15_e
L_wr_15_3:
  ds_read_b64_tr_b16 a[8:9], v30 offset:0
  ds_read_b64_tr_b16 a[10:11], v30 offset:512
  ds_read_b64_tr_b16 a[12:13], v30 offset:8192
  ds_read_b64_tr_b16 a[14:15], v30 offset:8704
  ds_read_b64_tr_b16 a[72:73], v31 offset:0
  ds_read_b64_tr_b16 a[74:75], v31 offset:512
  ds_read_b64_tr_b16 a[76:77], v31 offset:8192
  ds_read_b64_tr_b16 a[78:79], v31 offset:8704
L_wr_15_e:
  s_waitcnt lgkmcnt(0)
  s_waitcnt vmcnt(24)
  s_barrier
  s_add_u32 m0, s56, 114688
  s_mov_b32 s68, 3670016
  buffer_load_dwordx4 v26, s[48:51], s68 offen  lds
  s_add_u32 m0, s56, 118784
  s_mov_b32 s68, 3735552
  buffer_load_dwordx4 v26, s[48:51], s68 offen  lds
  s_add_u32 m0, s56, 122880
  s_mov_b32 s68, 3932160
  buffer_load_dwordx4 v26, s[48:51], s68 offen  lds
  s_add_u32 m0, s56, 126976
  s_mov_b32 s68, 3997696
  buffer_load_dwordx4 v26, s[48:51], s68 offen  lds
  v_add_u32 v30, 0, v28
  v_add_u32 v31, 0, v29
  s_cmp_lg_u32 s44, 0
  s_cbranch_scc1 L_wr_16_1
  ds_read_b64_tr_b16 a[128:129], v30 offset:0
  ds_read_b64_tr_b16 a[130:131], v30 offset:512
  ds_read_b64_tr_b16 a[132:133], v30 offset:8192
  ds_read_b64_tr_b16 a[134:135], v30 offset:8704
  ds_read_b64_tr_b16 a[192:193], v31 offset:0
  ds_read_b64_tr_b16 a[194:195], v31 offset:512
  ds_read_b64_tr_b16 a[196:197], v31 offset:8192
  ds_read_b64_tr_b16 a[198:199], v31 offset:8704
  s_branch L_wr_16_e
L_wr_16_1:
  s_cmp_lg_u32 s44, 1
  s_cbranch_scc1 L_wr_16_2
  ds_read_b64_tr_b16 a[144:145], v30 offset:0
  ds_read_b64_tr_b16 a[146:147], v30 offset:512
  ds_read_b64_tr_b16 a[148:149], v30 offset:8192
  ds_read_b64_tr_b16 a[150:151], v30 offset:8704
  ds_read_b64_tr_b16 a[208:209], v31 offset:0
  ds_read_b64_tr_b16 a[210:211], v31 offset:512
  ds_read_b64_tr_b16 a[212:213], v31 offset:8192
  ds_read_b64_tr_b16 a[214:215], v31 offset:8704
  s_branch L_wr_16_e
L_wr_16_2:
  s_cmp_lg_u32 s44, 2
  s_cbranch_scc1 L_wr_16_3
  ds_read_b64_tr_b16 a[160:161], v30 offset:0
  ds_read_b64_tr_b16 a[162:163], v30 offset:512
  ds_read_b64_tr_b16 a[164:165], v30 offset:8192
  ds_read_b64_tr_b16 a[166:167], v30 offset:8704
  ds_read_b64_tr_b16 a[224:225], v31 offset:0
  ds_read_b64_tr_b16 a[226:227], v31 offset:512
  ds_read_b64_tr_b16 a[228:229], v31 offset:8192
  ds_read_b64_tr_b16 a[230:231], v31 offset:8704
  s_branch L_wr_16_e
L_wr_16_3:
  ds_read_b64_tr_b16 a[176:177], v30 offset:0
  ds_read_b64_tr_b16 a[178:179], v30 offset:512
  ds_read_b64_tr_b16 a[180:181], v30 offset:8192
  ds_read_b64_tr_b16 a[182:183], v30 offset:8704
  ds_read_b64_tr_b16 a[240:241], v31 offset:0
  ds_read_b64_tr_b16 a[242:243], v31 offset:512
  ds_read_b64_tr_b16 a[244:245], v31 offset:8192
  ds_read_b64_tr_b16 a[246:247], v31 offset:8704
L_wr_16_e:
  s_waitcnt lgkmcnt(0)
  s_waitcnt vmcnt(24)
  s_barrier
  s_mov_b32 s48, s28
  s_and_b32 s49, s29, 0xffff
  s_add_u32 m0, s56, 0
  s_mov_b32 s68, 0
  buffer_load_dwordx4 v26, s[48:51], s68 offen  lds
  s_add_u32 m0, s56, 4096
  s_mov_b32 s68, 65536
  buffer_load_dwordx4 v26, s[48:51], s68 offen  lds
  s_add_u32 m0, s56, 8192
  s_mov_b32 s68, 262144
  buffer_load_dwordx4 v26, s[48:51], s68 offen  lds
  s_add_u32 m0, s56, 12288
  s_mov_b32 s68, 327680
  buffer_load_dwordx4 v26, s[48:51], s68 offen  lds
  v_add_u32 v30, 16384, v28
  v_add_u32 v31, 16384, v29
  s_cmp_lg_u32 s44, 0
  s_cbranch_scc1 L_wr_17_1
  ds_read_b64_tr_b16 a[136:137], v30 offset:0
  ds_read_b64_tr_b16 a[138:139], v30 offset:512
  ds_read_b64_tr_b16 a[140:141], v30 offset:8192
  ds_read_b64_tr_b16 a[142:143], v30 offset:8704
  ds_read_b64_tr_b16 a[200:201], v31 offset:0
  ds_read_b64_tr_b16 a[202:203], v31 offset:512
  ds_read_b64_tr_b16 a[204:205], v31 offset:8192
  ds_read_b64_tr_b16 a[206:207], v31 offset:8704
  s_branch L_wr_17_e
L_wr_17_1:
  s_cmp_lg_u32 s44, 1
  s_cbranch_scc1 L_wr_17_2
  ds_read_b64_tr_b16 a[152:153], v30 offset:0
  ds_read_b64_tr_b16 a[154:155], v30 offset:512
  ds_read_b64_tr_b16 a[156:157], v30 offset:8192
  ds_read_b64_tr_b16 a[158:159], v30 offset:8704
  ds_read_b64_tr_b16 a[216:217], v31 offset:0
  ds_read_b64_tr_b16 a[218:219], v31 offset:512
  ds_read_b64_tr_b16 a[220:221], v31 offset:8192
  ds_read_b64_tr_b16 a[222:223], v31 offset:8704
  s_branch L_wr_17_e
L_wr_17_2:
  s_cmp_lg_u32 s44, 2
  s_cbranch_scc1 L_wr_17_3
  ds_read_b64_tr_b16 a[168:169], v30 offset:0
  ds_read_b64_tr_b16 a[170:171], v30 offset:512
  ds_read_b64_tr_b16 a[172:173], v30 offset:8192
  ds_read_b64_tr_b16 a[174:175], v30 offset:8704
  ds_read_b64_tr_b16 a[232:233], v31 offset:0
  ds_read_b64_tr_b16 a[234:235], v31 offset:512
  ds_read_b64_tr_b16 a[236:237], v31 offset:8192
  ds_read_b64_tr_b16 a[238:239], v31 offset:8704
  s_branch L_wr_17_e
L_wr_17_3:
  ds_read_b64_tr_b16 a[184:185], v30 offset:0
  ds_read_b64_tr_b16 a[186:187], v30 offset:512
  ds_read_b64_tr_b16 a[188:189], v30 offset:8192
  ds_read_b64_tr_b16 a[190:191], v30 offset:8704
  ds_read_b64_tr_b16 a[248:249], v31 offset:0
  ds_read_b64_tr_b16 a[250:251], v31 offset:512
  ds_read_b64_tr_b16 a[252:253], v31 offset:8192
  ds_read_b64_tr_b16 a[254:255], v31 offset:8704
L_wr_17_e:
  s_waitcnt lgkmcnt(0)
  s_waitcnt vmcnt(24)
  s_barrier
  s_add_u32 m0, s56, 16384
  s_mov_b32 s68, 524288
  buffer_load_dwordx4 v26, s[48:51], s68 offen  lds
  s_add_u32 m0, s56, 20480
  s_mov_b32 s68, 589824
  buffer_load_dwordx4 v26, s[48:51], s68 offen  lds
  s_add_u32 m0, s56, 24576
  s_mov_b32 s68, 786432
  buffer_load_dwordx4 v26, s[48:51], s68 offen  lds
  s_add_u32 m0, s56, 28672
  s_mov_b32 s68, 851968
  buffer_load_dwordx4 v26, s[48:51], s68 offen  lds
  v_add_u32 v30, 32768, v28
  v_add_u32 v31, 32768, v29
  s_cmp_lg_u32 s44, 0
  s_cbranch_scc1 L_wr_18_1
  ds_read_b64_tr_b16 a[144:145], v30 offset:0
  ds_read_b64_tr_b16 a[146:147], v30 offset:512
  ds_read_b64_tr_b16 a[148:149], v30 offset:8192
  ds_read_b64_tr_b16 a[150:151], v30 offset:8704
  ds_read_b64_tr_b16 a[208:209], v31 offset:0
  ds_read_b64_tr_b16 a[210:211], v31 offset:512
  ds_read_b64_tr_b16 a[212:213], v31 offset:8192
  ds_read_b64_tr_b16 a[214:215], v31 offset:8704
  s_branch L_wr_18_e
L_wr_18_1:
  s_cmp_lg_u32 s44, 1
  s_cbranch_scc1 L_wr_18_2
  ds_read_b64_tr_b16 a[128:129], v30 offset:0
  ds_read_b64_tr_b16 a[130:131], v30 offset:512
  ds_read_b64_tr_b16 a[132:133], v30 offset:8192
  ds_read_b64_tr_b16 a[134:135], v30 offset:8704
  ds_read_b64_tr_b16 a[192:193], v31 offset:0
  ds_read_b64_tr_b16 a[194:195], v31 offset:512
  ds_read_b64_tr_b16 a[196:197], v31 offset:8192
  ds_read_b64_tr_b16 a[198:199], v31 offset:8704
  s_branch L_wr_18_e
L_wr_18_2:
  s_cmp_lg_u32 s44, 2
  s_cbranch_scc1 L_wr_18_3
  ds_read_b64_tr_b16 a[176:177], v30 offset:0
  ds_read_b64_tr_b16 a[178:179], v30 offset:512
  ds_read_b64_tr_b16 a[180:181], v30 offset:8192
  ds_read_b64_tr_b16 a[182:183], v30 offset:8704
  ds_read_b64_tr_b16 a[240:241], v31 offset:0
  ds_read_b64_tr_b16 a[242:243], v31 offset:512
  ds_read_b64_tr_b16 a[244:245], v31 offset:8192
  ds_read_b64_tr_b16 a[246:247], v31 offset:8704
  s_branch L_wr_18_e
L_wr_18_3:
  ds_read_b64_tr_b16 a[160:161], v30 offset:0
  ds_read_b64_tr_b16 a[162:163], v30 offset:512
  ds_read_b64_tr_b16 a[164:165], v30 offset:8192
  ds_read_b64_tr_b16 a[166:167], v30 offset:8704
  ds_read_b64_tr_b16 a[224:225], v31 offset:0
  ds_read_b64_tr_b16 a[226:227], v31 offset:512
  ds_read_b64_tr_b16 a[228:229], v31 offset:8192
  ds_read_b64_tr_b16 a[230:231], v31 offset:8704
L_wr_18_e:
  s_waitcnt lgkmcnt(0)
  s_waitcnt vmcnt(24)
  s_barrier
  s_add_u32 m0, s56, 32768
  s_mov_b32 s68, 1048576
  buffer_load_dwordx4 v26, s[48:51], s68 offen  lds
  s_add_u32 m0, s56, 36864
  s_mov_b32 s68, 1114112
  buffer_load_dwordx4 v26, s[48:51], s68 offen  lds
  s_add_u32 m0, s56, 40960
  s_mov_b32 s68, 1310720
  buffer_load_dwordx4 v26, s[48:51], s68 offen  lds
  s_add_u32 m0, s56, 45056
  s_mov_b32 s68, 1376256
  buffer_load_dwordx4 v26, s[48:51], s68 offen  lds
  v_add_u32 v30, 49152, v28
  v_add_u32 v31, 49152, v29
  s_cmp_lg_u32 s44, 0
  s_cbranch_scc1 L_wr_19_1
  ds_read_b64_tr_b16 a[152:153], v30 offset:0
  ds_read_b64_tr_b16 a[154:155], v30 offset:512
  ds_read_b64_tr_b16 a[156:157], v30 offset:8192
  ds_read_b64_tr_b16 a[158:159], v30 offset:8704
  ds_read_b64_tr_b16 a[216:217], v31 offset:0
  ds_read_b64_tr_b16 a[218:219], v31 offset:512
  ds_read_b64_tr_b16 a[220:221], v31 offset:8192
  ds_read_b64_tr_b16 a[222:223], v31 offset:8704
  s_branch L_wr_19_e
L_wr_19_1:
  s_cmp_lg_u32 s44, 1
  s_cbranch_scc1 L_wr_19_2
  ds_read_b64_tr_b16 a[136:137], v30 offset:0
  ds_read_b64_tr_b16 a[138:139], v30 offset:512
  ds_read_b64_tr_b16 a[140:141], v30 offset:8192
  ds_read_b64_tr_b16 a[142:143], v30 offset:8704
  ds_read_b64_tr_b16 a[200:201], v31 offset:0
  ds_read_b64_tr_b16 a[202:203], v31 offset:512
  ds_read_b64_tr_b16 a[204:205], v31 offset:8192
  ds_read_b64_tr_b16 a[206:207], v31 offset:8704
  s_branch L_wr_19_e
L_wr_19_2:
  s_cmp_lg_u32 s44, 2
  s_cbranch_scc1 L_wr_19_3
  ds_read_b64_tr_b16 a[184:185], v30 offset:0
  ds_read_b64_tr_b16 a[186:187], v30 offset:512
  ds_read_b64_tr_b16 a[188:189], v30 offset:8192
  ds_read_b64_tr_b16 a[190:191], v30 offset:8704
  ds_read_b64_tr_b16 a[248:249], v31 offset:0
  ds_read_b64_tr_b16 a[250:251], v31 offset:512
  ds_read_b64_tr_b16 a[252:253], v31 offset:8192
  ds_read_b64_tr_b16 a[254:255], v31 offset:8704
  s_branch L_wr_19_e
L_wr_19_3:
  ds_read_b64_tr_b16 a[168:169], v30 offset:0
  ds_read_b64_tr_b16 a[170:171], v30 offset:512
  ds_read_b64_tr_b16 a[172:173], v30 offset:8192
  ds_read_b64_tr_b16 a[174:175], v30 offset:8704
  ds_read_b64_tr_b16 a[232:233], v31 offset:0
  ds_read_b64_tr_b16 a[234:235], v31 offset:512
  ds_read_b64_tr_b16 a[236:237], v31 offset:8192
  ds_read_b64_tr_b16 a[238:239], v31 offset:8704
L_wr_19_e:
  s_waitcnt lgkmcnt(0)
  s_waitcnt vmcnt(24)
  s_barrier
  s_add_u32 m0, s56, 49152
  s_mov_b32 s68, 1572864
  buffer_load_dwordx4 v26, s[48:51], s68 offen  lds
  s_add_u32 m0, s56, 53248
  s_mov_b32 s68, 1638400
  buffer_load_dwordx4 v26, s[48:51], s68 offen  lds
  s_add_u32 m0, s56, 57344
  s_mov_b32 s68, 1835008
  buffer_load_dwordx4 v26, s[48:51], s68 offen  lds
  s_add_u32 m0, s56, 61440
  s_mov_b32 s68, 1900544
  buffer_load_dwordx4 v26, s[48:51], s68 offen  lds
  v_add_u32 v30, 65536, v28
  v_add_u32 v31, 65536, v29
  s_cmp_lg_u32 s44, 0
  s_cbranch_scc1 L_wr_20_1
  ds_read_b64_tr_b16 a[160:161], v30 offset:0
  ds_read_b64_tr_b16 a[162:163], v30 offset:512
  ds_read_b64_tr_b16 a[164:165], v30 offset:8192
  ds_read_b64_tr_b16 a[166:167], v30 offset:8704
  ds_read_b64_tr_b16 a[224:225], v31 offset:0
  ds_read_b64_tr_b16 a[226:227], v31 offset:512
  ds_read_b64_tr_b16 a[228:229], v31 offset:8192
  ds_read_b64_tr_b16 a[230:231], v31 offset:8704
  s_branch L_wr_20_e
L_wr_20_1:
  s_cmp_lg_u32 s44, 1
  s_cbranch_scc1 L_wr_20_2
  ds_read_b64_tr_b16 a[176:177], v30 offset:0
  ds_read_b64_tr_b16 a[178:179], v30 offset:512
  ds_read_b64_tr_b16 a[180:181], v30 offset:8192
  ds_read_b64_tr_b16 a[182:183], v30 offset:8704
  ds_read_b64_tr_b16 a[240:241], v31 offset:0
  ds_read_b64_tr_b16 a[242:243], v31 offset:512
  ds_read_b64_tr_b16 a[244:245], v31 offset:8192
  ds_read_b64_tr_b16 a[246:247], v31 offset:8704
  s_branch L_wr_20_e
L_wr_20_2:
  s_cmp_lg_u32 s44, 2
  s_cbranch_scc1 L_wr_20_3
  ds_read_b64_tr_b16 a[128:129], v30 offset:0
  ds_read_b64_tr_b16 a[130:131], v30 offset:512
  ds_read_b64_tr_b16 a[132:133], v30 offset:8192
  ds_read_b64_tr_b16 a[134:135], v30 offset:8704
  ds_read_b64_tr_b16 a[192:193], v31 offset:0
  ds_read_b64_tr_b16 a[194:195], v31 offset:512
  ds_read_b64_tr_b16 a[196:197], v31 offset:8192
  ds_read_b64_tr_b16 a[198:199], v31 offset:8704
  s_branch L_wr_20_e
L_wr_20_3:
  ds_read_b64_tr_b16 a[144:145], v30 offset:0
  ds_read_b64_tr_b16 a[146:147], v30 offset:512
  ds_read_b64_tr_b16 a[148:149], v30 offset:8192
  ds_read_b64_tr_b16 a[150:151], v30 offset:8704
  ds_read_b64_tr_b16 a[208:209], v31 offset:0
  ds_read_b64_tr_b16 a[210:211], v31 offset:512
  ds_read_b64_tr_b16 a[212:213], v31 offset:8192
  ds_read_b64_tr_b16 a[214:215], v31 offset:8704
L_wr_20_e:
  s_waitcnt lgkmcnt(0)
  s_waitcnt vmcnt(24)
  s_barrier
  s_add_u32 m0, s56, 65536
  s_mov_b32 s68, 2097152
  buffer_load_dwordx4 v26, s[48:51], s68 offen  lds
  s_add_u32 m0, s56, 69632
  s_mov_b32 s68, 2162688
  buffer_load_dwordx4 v26, s[48:51], s68 offen  lds
  s_add_u32 m0, s56, 73728
  s_mov_b32 s68, 2359296
  buffer_load_dwordx4 v26, s[48:51], s68 offen  lds
  s_add_u32 m0, s56, 77824
  s_mov_b32 s68, 2424832
  buffer_load_dwordx4 v26, s[48:51], s68 offen  lds
  v_add_u32 v30, 81920, v28
  v_add_u32 v31, 81920, v29
  s_cmp_lg_u32 s44, 0
  s_cbranch_scc1 L_wr_21_1
  ds_read_b64_tr_b16 a[168:169], v30 offset:0
  ds_read_b64_tr_b16 a[170:171], v30 offset:512
  ds_read_b64_tr_b16 a[172:173], v30 offset:8192
  ds_read_b64_tr_b16 a[174:175], v30 offset:8704
  ds_read_b64_tr_b16 a[232:233], v31 offset:0
  ds_read_b64_tr_b16 a[234:235], v31 offset:512
  ds_read_b64_tr_b16 a[236:237], v31 offset:8192
  ds_read_b64_tr_b16 a[238:239], v31 offset:8704
  s_branch L_wr_21_e
L_wr_21_1:
  s_cmp_lg_u32 s44, 1
  s_cbranch_scc1 L_wr_21_2
  ds_read_b64_tr_b16 a[184:185], v30 offset:0
  ds_read_b64_tr_b16 a[186:187], v30 offset:512
  ds_read_b64_tr_b16 a[188:189], v30 offset:8192
  ds_read_b64_tr_b16 a[190:191], v30 offset:8704
  ds_read_b64_tr_b16 a[248:249], v31 offset:0
  ds_read_b64_tr_b16 a[250:251], v31 offset:512
  ds_read_b64_tr_b16 a[252:253], v31 offset:8192
  ds_read_b64_tr_b16 a[254:255], v31 offset:8704
  s_branch L_wr_21_e
L_wr_21_2:
  s_cmp_lg_u32 s44, 2
  s_cbranch_scc1 L_wr_21_3
  ds_read_b64_tr_b16 a[136:137], v30 offset:0
  ds_read_b64_tr_b16 a[138:139], v30 offset:512
  ds_read_b64_tr_b16 a[140:141], v30 offset:8192
  ds_read_b64_tr_b16 a[142:143], v30 offset:8704
  ds_read_b64_tr_b16 a[200:201], v31 offset:0
  ds_read_b64_tr_b16 a[202:203], v31 offset:512
  ds_read_b64_tr_b16 a[204:205], v31 offset:8192
  ds_read_b64_tr_b16 a[206:207], v31 offset:8704
  s_branch L_wr_21_e
L_wr_21_3:
  ds_read_b64_tr_b16 a[152:153], v30 offset:0
  ds_read_b64_tr_b16 a[154:155], v30 offset:512
  ds_read_b64_tr_b16 a[156:157], v30 offset:8192
  ds_read_b64_tr_b16 a[158:159], v30 offset:8704
  ds_read_b64_tr_b16 a[216:217], v31 offset:0
  ds_read_b64_tr_b16 a[218:219], v31 offset:512
  ds_read_b64_tr_b16 a[220:221], v31 offset:8192
  ds_read_b64_tr_b16 a[222:223], v31 offset:8704
L_wr_21_e:
  s_waitcnt lgkmcnt(0)
  s_waitcnt vmcnt(24)
  s_barrier
  s_add_u32 m0, s56, 81920
  s_mov_b32 s68, 2621440
  buffer_load_dwordx4 v26, s[48:51], s68 offen  lds
  s_add_u32 m0, s56, 86016
  s_mov_b32 s68, 2686976
  buffer_load_dwordx4 v26, s[48:51], s68 offen  lds
  s_add_u32 m0, s56, 90112
  s_mov_b32 s68, 2883584
  buffer_load_dwordx4 v26, s[48:51], s68 offen  lds
  s_add_u32 m0, s56, 94208
  s_mov_b32 s68, 2949120
  buffer_load_dwordx4 v26, s[48:51], s68 offen  lds
  v_add_u32 v30, 98304, v28
  v_add_u32 v31, 98304, v29
  s_cmp_lg_u32 s44, 0
  s_cbranch_scc1 L_wr_22_1
  ds_read_b64_tr_b16 a[176:177], v30 offset:0
  ds_read_b64_tr_b16 a[178:179], v30 offset:512
  ds_read_b64_tr_b16 a[180:181], v30 offset:8192
  ds_read_b64_tr_b16 a[182:183], v30 offset:8704
  ds_read_b64_tr_b16 a[240:241], v31 offset:0
  ds_read_b64_tr_b16 a[242:243], v31 offset:512
  ds_read_b64_tr_b16 a[244:245], v31 offset:8192
  ds_read_b64_tr_b16 a[246:247], v31 offset:8704
  s_branch L_wr_22_e
L_wr_22_1:
  s_cmp_lg_u32 s44, 1
  s_cbranch_scc1 L_wr_22_2
  ds_read_b64_tr_b16 a[160:161], v30 offset:0
  ds_read_b64_tr_b16 a[162:163], v30 offset:512
  ds_read_b64_tr_b16 a[164:165], v30 offset:8192
  ds_read_b64_tr_b16 a[166:167], v30 offset:8704
  ds_read_b64_tr_b16 a[224:225], v31 offset:0
  ds_read_b64_tr_b16 a[226:227], v31 offset:512
  ds_read_b64_tr_b16 a[228:229], v31 offset:8192
  ds_read_b64_tr_b16 a[230:231], v31 offset:8704
  s_branch L_wr_22_e
L_wr_22_2:
  s_cmp_lg_u32 s44, 2
  s_cbranch_scc1 L_wr_22_3
  ds_read_b64_tr_b16 a[144:145], v30 offset:0
  ds_read_b64_tr_b16 a[146:147], v30 offset:512
  ds_read_b64_tr_b16 a[148:149], v30 offset:8192
  ds_read_b64_tr_b16 a[150:151], v30 offset:8704
  ds_read_b64_tr_b16 a[208:209], v31 offset:0
  ds_read_b64_tr_b16 a[210:211], v31 offset:512
  ds_read_b64_tr_b16 a[212:213], v31 offset:8192
  ds_read_b64_tr_b16 a[214:215], v31 offset:8704
  s_branch L_wr_22_e
L_wr_22_3:
  ds_read_b64_tr_b16 a[128:129], v30 offset:0
  ds_read_b64_tr_b16 a[130:131], v30 offset:512
  ds_read_b64_tr_b16 a[132:133], v30 offset:8192
  ds_read_b64_tr_b16 a[134:135], v30 offset:8704
  ds_read_b64_tr_b16 a[192:193], v31 offset:0
  ds_read_b64_tr_b16 a[194:195], v31 offset:512
  ds_read_b64_tr_b16 a[196:197], v31 offset:8192
  ds_read_b64_tr_b16 a[198:199], v31 offset:8704
L_wr_22_e:
  s_waitcnt lgkmcnt(0)
  s_waitcnt vmcnt(24)
  s_barrier
  s_add_u32 m0, s56, 98304
  s_mov_b32 s68, 3145728
  buffer_load_dwordx4 v26, s[48:51], s68 offen  lds
  s_add_u32 m0, s56, 102400
  s_mov_b32 s68, 3211264
  buffer_load_dwordx4 v26, s[48:51], s68 offen  lds
  s_add_u32 m0, s56, 106496
  s_mov_b32 s68, 3407872
  buffer_load_dwordx4 v26, s[48:51], s68 offen  lds
  s_add_u32 m0, s56, 110592
  s_mov_b32 s68, 3473408
  buffer_load_dwordx4 v26, s[48:51], s68 offen  lds
  v_add_u32 v30, 114688, v28
  v_add_u32 v31, 114688, v29
  s_cmp_lg_u32 s44, 0
  s_cbranch_scc1 L_wr_23_1
  ds_read_b64_tr_b16 a[184:185], v30 offset:0
  ds_read_b64_tr_b16 a[186:187], v30 offset:512
  ds_read_b64_tr_b16 a[188:189], v30 offset:8192
  ds_read_b64_tr_b16 a[190:191], v30 offset:8704
  ds_read_b64_tr_b16 a[248:249], v31 offset:0
  ds_read_b64_tr_b16 a[250:251], v31 offset:512
  ds_read_b64_tr_b16 a[252:253], v31 offset:8192
  ds_read_b64_tr_b16 a[254:255], v31 offset:8704
  s_branch L_wr_23_e
L_wr_23_1:
  s_cmp_lg_u32 s44, 1
  s_cbranch_scc1 L_wr_23_2
  ds_read_b64_tr_b16 a[168:169], v30 offset:0
  ds_read_b64_tr_b16 a[170:171], v30 offset:512
  ds_read_b64_tr_b16 a[172:173], v30 offset:8192
  ds_read_b64_tr_b16 a[174:175], v30 offset:8704
  ds_read_b64_tr_b16 a[232:233], v31 offset:0
  ds_read_b64_tr_b16 a[234:235], v31 offset:512
  ds_read_b64_tr_b16 a[236:237], v31 offset:8192
  ds_read_b64_tr_b16 a[238:239], v31 offset:8704
  s_branch L_wr_23_e
L_wr_23_2:
  s_cmp_lg_u32 s44, 2
  s_cbranch_scc1 L_wr_23_3
  ds_read_b64_tr_b16 a[152:153], v30 offset:0
  ds_read_b64_tr_b16 a[154:155], v30 offset:512
  ds_read_b64_tr_b16 a[156:157], v30 offset:8192
  ds_read_b64_tr_b16 a[158:159], v30 offset:8704
  ds_read_b64_tr_b16 a[216:217], v31 offset:0
  ds_read_b64_tr_b16 a[218:219], v31 offset:512
  ds_read_b64_tr_b16 a[220:221], v31 offset:8192
  ds_read_b64_tr_b16 a[222:223], v31 offset:8704
  s_branch L_wr_23_e
L_wr_23_3:
  ds_read_b64_tr_b16 a[136:137], v30 offset:0
  ds_read_b64_tr_b16 a[138:139], v30 offset:512
  ds_read_b64_tr_b16 a[140:141], v30 offset:8192
  ds_read_b64_tr_b16 a[142:143], v30 offset:8704
  ds_read_b64_tr_b16 a[200:201], v31 offset:0
  ds_read_b64_tr_b16 a[202:203], v31 offset:512
  ds_read_b64_tr_b16 a[204:205], v31 offset:8192
  ds_read_b64_tr_b16 a[206:207], v31 offset:8704
L_wr_23_e:
  s_waitcnt lgkmcnt(0)
  s_waitcnt vmcnt(24)
  s_barrier
  s_add_u32 m0, s56, 114688
  s_mov_b32 s68, 3670016
  buffer_load_dwordx4 v26, s[48:51], s68 offen  lds
  s_add_u32 m0, s56, 118784
  s_mov_b32 s68, 3735552
  buffer_load_dwordx4 v26, s[48:51], s68 offen  lds
  s_add_u32 m0, s56, 122880
  s_mov_b32 s68, 3932160
  buffer_load_dwordx4 v26, s[48:51], s68 offen  lds
  s_add_u32 m0, s56, 126976
  s_mov_b32 s68, 3997696
  buffer_load_dwordx4 v26, s[48:51], s68 offen  lds
  v_add_u32 v30, 0, v28
  v_add_u32 v31, 0, v29
  ds_read_b64_tr_b16 v[108:109], v30 offset:0
  ds_read_b64_tr_b16 v[110:111], v30 offset:512
  ds_read_b64_tr_b16 v[112:113], v30 offset:8192
  ds_read_b64_tr_b16 v[114:115], v30 offset:8704
  ds_read_b64_tr_b16 v[116:117], v31 offset:0
  ds_read_b64_tr_b16 v[118:119], v31 offset:512
  ds_read_b64_tr_b16 v[120:121], v31 offset:8192
  ds_read_b64_tr_b16 v[122:123], v31 offset:8704
  s_waitcnt lgkmcnt(0)
  s_barrier
  v_add_u32 v30, 0, v3
  ds_write_b128 v30, v[108:111] offset:0
  ds_write_b128 v30, v[112:115] offset:1024
  ds_write_b128 v30, v[116:119] offset:2048
  ds_write_b128 v30, v[120:123] offset:3072
  s_waitcnt lgkmcnt(0)
  s_waitcnt vmcnt(24)
  s_barrier
  v_add_u32 v30, 16384, v28
  v_add_u32 v31, 16384, v29
  ds_read_b64_tr_b16 v[108:109], v30 offset:0
  ds_read_b64_tr_b16 v[110:111], v30 offset:512
  ds_read_b64_tr_b16 v[112:113], v30 offset:8192
  ds_read_b64_tr_b16 v[114:115], v30 offset:8704
  ds_read_b64_tr_b16 v[116:117], v31 offset:0
  ds_read_b64_tr_b16 v[118:119], v31 offset:512
  ds_read_b64_tr_b16 v[120:121], v31 offset:8192
  ds_read_b64_tr_b16 v[122:123], v31 offset:8704
  s_waitcnt lgkmcnt(0)
  s_barrier
  v_add_u32 v30, 16384, v3
  ds_write_b128 v30, v[108:111] offset:0
  ds_write_b128 v30, v[112:115] offset:1024
  ds_write_b128 v30, v[116:119] offset:2048
  ds_write_b128 v30, v[120:123] offset:3072
  s_waitcnt lgkmcnt(0)
  s_waitcnt vmcnt(20)
  s_barrier
  v_add_u32 v30, 32768, v28
  v_add_u32 v31, 32768, v29
  ds_read_b64_tr_b16 v[108:109], v30 offset:0
  ds_read_b64_tr_b16 v[110:111], v30 offset:512
  ds_read_b64_tr_b16 v[112:113], v30 offset:8192
  ds_read_b64_tr_b16 v[114:115], v30 offset:8704
  ds_read_b64_tr_b16 v[116:117], v31 offset:0
  ds_read_b64_tr_b16 v[118:119], v31 offset:512
  ds_read_b64_tr_b16 v[120:121], v31 offset:8192
  ds_read_b64_tr_b16 v[122:123], v31 offset:8704
  s_waitcnt lgkmcnt(0)
  s_barrier
  v_add_u32 v30, 32768, v3
  ds_write_b128 v30, v[108:111] offset:0
  ds_write_b128 v30, v[112:115] offset:1024
  ds_write_b128 v30, v[116:119] offset:2048
  ds_write_b128 v30, v[120:123] offset:3072
  s_waitcnt lgkmcnt(0)
  s_waitcnt vmcnt(16)
  s_barrier
  v_add_u32 v30, 49152, v28
  v_add_u32 v31, 49152, v29
  ds_read_b64_tr_b16 v[108:109], v30 offset:0
  ds_read_b64_tr_b16 v[110:111], v30 offset:512
  ds_read_b64_tr_b16 v[112:113], v30 offset:8192
  ds_read_b64_tr_b16 v[114:115], v30 offset:8704
  ds_read_b64_tr_b16 v[116:117], v31 offset:0
  ds_read_b64_tr_b16 v[118:119], v31 offset:512
  ds_read_b64_tr_b16 v[120:121], v31 offset:8192
  ds_read_b64_tr_b16 v[122:123], v31 offset:8704
  s_waitcnt lgkmcnt(0)
  s_barrier
  v_add_u32 v30, 49152, v3
  ds_write_b128 v30, v[108:111] offset:0
  ds_write_b128 v30, v[112:115] offset:1024
  ds_write_b128 v30, v[116:119] offset:2048
  ds_write_b128 v30, v[120:123] offset:3072
  s_waitcnt lgkmcnt(0)
  s_waitcnt vmcnt(12)
  s_barrier
  v_add_u32 v30, 65536, v28
  v_add_u32 v31, 65536, v29
  ds_read_b64_tr_b16 v[108:109], v30 offset:0
  ds_read_b64_tr_b16 v[110:111], v30 offset:512
  ds_read_b64_tr_b16 v[112:113], v30 offset:8192
  ds_read_b64_tr_b16 v[114:115], v30 offset:8704
  ds_read_b64_tr_b16 v[116:117], v31 offset:0
  ds_read_b64_tr_b16 v[118:119], v31 offset:512
  ds_read_b64_tr_b16 v[120:121], v31 offset:8192
  ds_read_b64_tr_b16 v[122:123], v31 offset:8704
  s_waitcnt lgkmcnt(0)
  s_barrier
  v_add_u32 v30, 65536, v3
  ds_write_b128 v30, v[108:111] offset:0
  ds_write_b128 v30, v[112:115] offset:1024
  ds_write_b128 v30, v[116:119] offset:2048
  ds_write_b128 v30, v[120:123] offset:3072
  s_waitcnt lgkmcnt(0)
  s_waitcnt vmcnt(8)
  s_barrier
  v_add_u32 v30, 81920, v28
  v_add_u32 v31, 81920, v29
  ds_read_b64_tr_b16 v[108:109], v30 offset:0
  ds_read_b64_tr_b16 v[110:111], v30 offset:512
  ds_read_b64_tr_b16 v[112:113], v30 offset:8192
  ds_read_b64_tr_b16 v[114:115], v30 offset:8704
  ds_read_b64_tr_b16 v[116:117], v31 offset:0
  ds_read_b64_tr_b16 v[118:119], v31 offset:512
  ds_read_b64_tr_b16 v[120:121], v31 offset:8192
  ds_read_b64_tr_b16 v[122:123], v31 offset:8704
  s_waitcnt lgkmcnt(0)
  s_barrier
  v_add_u32 v30, 81920, v3
  ds_write_b128 v30, v[108:111] offset:0
  ds_write_b128 v30, v[112:115] offset:1024
  ds_write_b128 v30, v[116:119] offset:2048
  ds_write_b128 v30, v[120:123] offset:3072
  s_waitcnt lgkmcnt(0)
  s_waitcnt vmcnt(4)
  s_barrier
  v_add_u32 v30, 98304, v28
  v_add_u32 v31, 98304, v29
  ds_read_b64_tr_b16 v[108:109], v30 offset:0
  ds_read_b64_tr_b16 v[110:111], v30 offset:512
  ds_read_b64_tr_b16 v[112:113], v30 offset:8192
  ds_read_b64_tr_b16 v[114:115], v30 offset:8704
  ds_read_b64_tr_b16 v[116:117], v31 offset:0
  ds_read_b64_tr_b16 v[118:119], v31 offset:512
  ds_read_b64_tr_b16 v[120:121], v31 offset:8192
  ds_read_b64_tr_b16 v[122:123], v31 offset:8704
  s_waitcnt lgkmcnt(0)
  s_barrier
  v_add_u32 v30, 98304, v3
  ds_write_b128 v30, v[108:111] offset:0
  ds_write_b128 v30, v[112:115] offset:1024
  ds_write_b128 v30, v[116:119] offset:2048
  ds_write_b128 v30, v[120:123] offset:3072
  s_waitcnt lgkmcnt(0)
  s_waitcnt vmcnt(0)
  s_barrier
  v_add_u32 v30, 114688, v28
  v_add_u32 v31, 114688, v29
  ds_read_b64_tr_b16 v[108:109], v30 offset:0
  ds_read_b64_tr_b16 v[110:111], v30 offset:512
  ds_read_b64_tr_b16 v[112:113], v30 offset:8192
  ds_read_b64_tr_b16 v[114:115], v30 offset:8704
  ds_read_b64_tr_b16 v[116:117], v31 offset:0
  ds_read_b64_tr_b16 v[118:119], v31 offset:512
  ds_read_b64_tr_b16 v[120:121], v31 offset:8192
  ds_read_b64_tr_b16 v[122:123], v31 offset:8704
  s_waitcnt lgkmcnt(0)
  s_barrier
  v_add_u32 v30, 114688, v3
  ds_write_b128 v30, v[108:111] offset:0
  ds_write_b128 v30, v[112:115] offset:1024
  ds_write_b128 v30, v[116:119] offset:2048
  ds_write_b128 v30, v[120:123] offset:3072
  s_waitcnt lgkmcnt(0)
  s_lshl_b32 s68, s44, 15
  v_add_u32 v3, s68, v3
  v_and_b32 v22, 1, v0
  v_cmp_eq_u32 vcc, 1, v22
  v_mov_b32 v23, 0x44444444
  v_mov_b32 v24, 0xeeeeeeee
  v_cndmask_b32 v1, v23, v24, vcc
  s_mov_b32 s48, s22
  s_and_b32 s49, s23, 0xffff
  s_mov_b32 s50, 0x2000
  s_mov_b32 s51, 0x20000
  v_bfe_u32 v22, v0, 1, 3
  v_lshlrev_b32 v23, 10, v22
  v_lshrrev_b32 v22, 5, v0
  v_lshl_add_u32 v23, v22, 6, v23
  v_bfe_u32 v22, v0, 4, 1
  v_lshl_add_u32 v23, v22, 4, v23
  v_and_b32 v22, 1, v0
  v_lshl_add_u32 v23, v22, 3, v23
  s_lshl_b32 s68, s44, 8
  buffer_load_dwordx2 v[92:93], v23, s[48:51], s68 offen
  buffer_load_dwordx2 v[94:95], v23, s[48:51], s68 offen offset:32
  buffer_load_dwordx2 v[96:97], v23, s[48:51], s68 offen offset:128
  buffer_load_dwordx2 v[98:99], v23, s[48:51], s68 offen offset:160
  v_lshlrev_b32 v0, 4, v0
  v_add_u32 v0, 147456, v0
  s_mov_b32 s68, 0x05040100
  s_mov_b32 s69, 0x07060302
  s_waitcnt vmcnt(0)
  v_perm_b32 v20, v94, v92, s68
  v_perm_b32 v21, v94, v92, s69
  v_perm_b32 v22, v95, v93, s68
  v_perm_b32 v23, v95, v93, s69
  v_min_u32 v20, -2, v20
  v_min_u32 v21, -2, v21
  v_min_u32 v22, -2, v22
  v_min_u32 v23, -2, v23
  v_perm_b32 v24, v98, v96, s68
  v_perm_b32 v25, v98, v96, s69
  v_perm_b32 v26, v99, v97, s68
  v_perm_b32 v27, v99, v97, s69
  v_min_u32 v24, -2, v24
  v_min_u32 v25, -2, v25
  v_min_u32 v26, -2, v26
  v_min_u32 v27, -2, v27
L_team_init:
  buffer_load_dword v52, v17, s[52:55], 0 offen sc1
  s_add_u32 s67, s67, 1
  s_cmp_gt_u32 s67, 1048576
  s_cbranch_scc1 L_exit
  s_waitcnt vmcnt(0)
  v_cmp_gt_u32 vcc, 32, v52
  s_cbranch_vccnz L_team_init
  buffer_load_dword v52, v17, s[52:55], 0 offen offset:128 sc1
  s_mov_b32 s92, 2
L_fs_pre:
  buffer_load_dword v4, v17, s[40:43], s60 offen sc1
  s_add_u32 s67, s67, 1
  s_cmp_gt_u32 s67, 1048576
  s_cbranch_scc1 L_exit
  s_waitcnt vmcnt(0)
  v_cmp_gt_u32 vcc, s92, v4
  s_cbranch_vccnz L_fs_pre
  v_readfirstlane_b32 s69, v52
  s_mov_b32 m0, s70
  s_mov_b32 s57, s72
  buffer_load_dwordx4 v2, s[40:43], s57 offen sc1 lds
  buffer_load_dwordx4 v2, s[40:43], s57 offen offset:1024 sc1 lds
  s_mov_b32 s56, -1
  s_mov_b32 s65, 0
  s_mov_b32 s7, 0
  s_lshl_b32 s61, s45, 12
  s_lshl_b32 s68, s44, 10
  s_sub_u32 s61, s61, s68
  s_add_u32 s61, s61, 0xbfc0000
  s_add_u32 s56, s56, 1
  s_xor_b32 s65, s65, 1
  s_add_u32 s58, s57, 0x1000000
  s_add_u32 s68, s56, 1
  s_min_u32 s68, s68, 63
  s_lshl_b32 s68, s68, 13
  s_add_u32 s57, s72, s68
  s_add_u32 s59, s57, s73
  s_add_u32 s68, s56, 3
  s_min_u32 s92, s68, 64
  s_add_u32 s61, s61, 0x20000
  s_xor_b32 s70, s70, 0x2000
  ds_read_b128 v[76:79], v3 offset:0
  ds_read_b128 v[80:83], v3 offset:1024
  ds_read_b128 v[84:87], v3 offset:2048
  ds_read_b128 v[88:91], v3 offset:3072
  ds_read_b128 v[92:95], v3 offset:16384
  ds_read_b128 v[96:99], v3 offset:17408
  ds_read_b128 v[100:103], v3 offset:18432
  ds_read_b128 v[104:107], v3 offset:19456
  v_xor_b32 v3, 0x8000, v3
  ds_read_b128 v[108:111], v3 offset:0
  ds_read_b128 v[112:115], v3 offset:1024
  ds_read_b128 v[116:119], v3 offset:2048
  ds_read_b128 v[120:123], v3 offset:3072
  v_mov_b64 v[52:53], 0
  v_mov_b64 v[54:55], 0
  v_mov_b64 v[56:57], 0
  v_mov_b64 v[58:59], 0
  v_mov_b64 v[60:61], 0
  v_mov_b64 v[62:63], 0
  v_mov_b64 v[64:65], 0
  v_mov_b64 v[66:67], 0
  v_mov_b64 v[68:69], 0
  v_mov_b64 v[70:71], 0
  v_mov_b64 v[72:73], 0
  v_mov_b64 v[74:75], 0
  s_waitcnt vmcnt(0) lgkmcnt(0)
  v_xor_b32 v32, 2048, v11
  v_xor_b32 v40, 4096, v11
  v_xor_b32 v48, 6144, v11
  v_bfe_u32 v45, v2, 9, 1
  v_and_b32 v4, 0x1ff, v2
  v_lshlrev_b32 v4, 2, v4
  v_lshl_add_u32 v4, v45, 24, v4
  s_sub_u32 s68, s60, s59
  v_min_u32 v124, -2, v124
  v_writelane_b32 v4, s68, 1
  s_bcnt1_i32_b32 s69, s69
  s_cmp_eq_u32 s69, 1
  s_cbranch_scc0 L_entry_x
  s_branch L_entry_f
L_poll2_f:
  buffer_load_dwordx4 v[20:23], v11, s[40:43], s63 offen sc1
  buffer_load_dwordx4 v[24:27], v11, s[40:43], s63 offen offset:1024 sc1
  s_nop 15
  s_nop 6
  buffer_load_dwordx4 v[28:31], v11, s[40:43], s63 offen sc1
  buffer_load_dwordx4 v[36:39], v11, s[40:43], s63 offen offset:1024 sc1
  v_readlane_b32 s69, v4, 1
  v_xor_b32 v10, 0x2000, v10
  s_waitcnt vmcnt(5)
  v_xor_b32 v32, 2048, v11
  v_xor_b32 v40, 4096, v11
  v_xor_b32 v48, 6144, v11
  s_cmp_lt_u32 s69, s92
  s_cbranch_scc1 L_fs_f
L_fsback_f:
  s_add_u32 s56, s56, 1
  s_xor_b32 s65, s65, 1
  s_add_u32 s58, s57, 0x1000000
  s_add_u32 s68, s56, 1
  s_min_u32 s68, s68, 63
  s_lshl_b32 s68, s68, 13
  s_add_u32 s57, s72, s68
  s_add_u32 s59, s57, s73
  s_add_u32 s68, s56, 3
  s_min_u32 s92, s68, 64
  s_add_u32 s61, s61, 0x20000
  s_xor_b32 s70, s70, 0x2000
  v_bfe_u32 v45, v2, 9, 1
  v_and_b32 v4, 0x1ff, v2
  v_lshlrev_b32 v4, 2, v4
  v_lshl_add_u32 v4, v45, 24, v4
  s_sub_u32 s68, s60, s59
  v_min_u32 v124, -2, v124
  v_writelane_b32 v4, s68, 1
L_entry_f:
  s_waitcnt vmcnt(3)
  ds_write_b128 v11, v[20:23]
  v_smfmac_f32_16x16x64_bf16 v[52:55], v[20:23], a[0:7], v1
  s_waitcnt vmcnt(2)
  ds_write_b128 v11, v[24:27] offset:1024
  v_max3_u32 v44, v20, v21, v22
  v_max3_u32 v44, v44, v23, v24
  v_max3_u32 v44, v44, v25, v26
  v_max_u32 v44, v44, v27
  v_cmp_eq_u32 vcc, -1, v44
  v_smfmac_f32_16x16x64_bf16 v[56:59], v[20:23], a[64:71], v1
  s_mov_b32 m0, s71
  v_smfmac_f32_16x16x64_bf16 v[52:55], v[24:27], a[8:15], v1
  s_cbranch_vccnz L_retry2_f
  v_smfmac_f32_16x16x64_bf16 v[56:59], v[24:27], a[72:79], v1
  v_smfmac_f32_16x16x64_bf16 v[60:63], v[20:23], a[128:135], v1
  v_smfmac_f32_16x16x64_bf16 v[64:67], v[20:23], a[192:199], v1
  v_smfmac_f32_16x16x64_bf16 v[60:63], v[24:27], a[136:143], v1
  s_waitcnt vmcnt(0) lgkmcnt(0)
  s_barrier
  ds_read_b128 v[28:31], v32 offset:0
  v_smfmac_f32_16x16x64_bf16 v[64:67], v[24:27], a[200:207], v1
  ds_read_b128 v[32:35], v32 offset:1024
  ds_read_b128 v[36:39], v40 offset:0
  v_smfmac_f32_16x16x64_bf16 v[68:71], v[20:23], v[76:83], v1
  ds_read_b128 v[40:43], v40 offset:1024
  ds_read_b128 v[44:47], v48 offset:0
  v_smfmac_f32_16x16x64_bf16 v[72:75], v[20:23], v[84:91], v1
  ds_read_b128 v[48:51], v48 offset:1024
  buffer_load_dwordx4 v2, s[40:43], s58 offen offset:0 sc1 lds
  v_smfmac_f32_16x16x64_bf16 v[68:71], v[24:27], v[92:99], v1
  buffer_load_dwordx4 v2, s[40:43], s58 offen offset:1024 sc1 lds
  v_smfmac_f32_16x16x64_bf16 v[72:75], v[24:27], v[100:107], v1
  s_waitcnt lgkmcnt(5)
  ds_read_b128 v[76:79], v3 offset:16384
  v_smfmac_f32_16x16x64_bf16 v[52:55], v[28:31], a[16:23], v1
  s_waitcnt lgkmcnt(5)
  ds_read_b128 v[80:83], v3 offset:17408
  buffer_load_dword v4, v4, s[40:43], s59 offen sc1
  v_smfmac_f32_16x16x64_bf16 v[52:55], v[32:35], a[24:31], v1
  s_waitcnt lgkmcnt(5)
  ds_read_b128 v[84:87], v3 offset:18432
  buffer_store_dwordx4 v[124:127], v2, s[40:43], s61 offen sc1
  v_smfmac_f32_16x16x64_bf16 v[52:55], v[36:39], a[32:39], v1
  s_waitcnt lgkmcnt(5)
  ds_read_b128 v[88:91], v3 offset:19456
  v_xor_b32 v3, 0x18000, v3
  v_smfmac_f32_16x16x64_bf16 v[52:55], v[40:43], a[40:47], v1
  s_waitcnt lgkmcnt(4)
  ds_read_b128 v[92:95], v0 offset:0
  v_smfmac_f32_16x16x64_bf16 v[52:55], v[44:47], a[48:55], v1
  ds_read_b128 v[96:99], v0 offset:2048
  v_smfmac_f32_16x16x64_bf16 v[52:55], v[48:51], a[56:63], v1
  s_nop 0
  ds_read_b128 v[100:103], v0 offset:4096
  v_smfmac_f32_16x16x64_bf16 v[68:71], v[28:31], v[108:115], v1
  s_mov_b32 m0, s70
  ds_read_b128 v[104:107], v0 offset:6144
  v_smfmac_f32_16x16x64_bf16 v[56:59], v[28:31], a[80:87], v1
  s_nop 0
  ds_read_b128 v[108:111], v3 offset:0
  v_add_f32 v52, v52, v53
  v_smfmac_f32_16x16x64_bf16 v[56:59], v[32:35], a[88:95], v1
  ds_read_b128 v[112:115], v3 offset:1024
  v_add_f32 v54, v54, v55
  v_smfmac_f32_16x16x64_bf16 v[72:75], v[28:31], v[116:123], v1
  ds_read_b128 v[20:23], v0 offset:1024
  v_mul_f32 v52, s88, v52
  v_smfmac_f32_16x16x64_bf16 v[56:59], v[36:39], a[96:103], v1
  ds_read_b128 v[116:119], v3 offset:2048
  v_mul_f32 v54, s88, v54
  v_smfmac_f32_16x16x64_bf16 v[56:59], v[40:43], a[104:111], v1
  ds_read_b128 v[120:123], v3 offset:3072
  v_cvt_pk_bf16_f32 v52, v52, v52
  v_smfmac_f32_16x16x64_bf16 v[56:59], v[44:47], a[112:119], v1
  ds_read_b128 v[24:27], v0 offset:3072
  v_cvt_pk_bf16_f32 v53, v54, v54
  v_smfmac_f32_16x16x64_bf16 v[56:59], v[48:51], a[120:127], v1
  s_waitcnt lgkmcnt(10)
  ds_write_b64 v5, v[52:53] offset:0
  v_smfmac_f32_16x16x64_bf16 v[68:71], v[32:35], v[76:83], v1
  s_nop 0
  s_nop 0
  v_smfmac_f32_16x16x64_bf16 v[72:75], v[32:35], v[84:91], v1
  s_nop 0
  ds_read_b128 v[76:79], v3 offset:16384
  v_add_f32 v56, v56, v57
  v_smfmac_f32_16x16x64_bf16 v[60:63], v[28:31], a[144:151], v1
  ds_read_b128 v[80:83], v3 offset:17408
  v_add_f32 v58, v58, v59
  v_smfmac_f32_16x16x64_bf16 v[60:63], v[32:35], a[152:159], v1
  s_waitcnt lgkmcnt(4)
  ds_read_b128 v[84:87], v3 offset:18432
  v_mul_f32 v56, s88, v56
  v_smfmac_f32_16x16x64_bf16 v[68:71], v[36:39], v[108:115], v1
  ds_read_b128 v[88:91], v3 offset:19456
  v_mul_f32 v58, s88, v58
  v_smfmac_f32_16x16x64_bf16 v[60:63], v[36:39], a[160:167], v1
  v_cvt_pk_bf16_f32 v56, v56, v56
  v_smfmac_f32_16x16x64_bf16 v[72:75], v[36:39], v[116:123], v1
  v_cvt_pk_bf16_f32 v57, v58, v58
  v_smfmac_f32_16x16x64_bf16 v[60:63], v[40:43], a[168:175], v1
  ds_write_b64 v5, v[56:57] offset:2048
  v_xor_b32 v3, 0x8000, v3
  v_smfmac_f32_16x16x64_bf16 v[60:63], v[44:47], a[176:183], v1
  ds_read_b128 v[108:111], v3 offset:0
  v_smfmac_f32_16x16x64_bf16 v[60:63], v[48:51], a[184:191], v1
  s_waitcnt lgkmcnt(2)
  ds_read_b128 v[112:115], v3 offset:1024
  v_smfmac_f32_16x16x64_bf16 v[68:71], v[40:43], v[76:83], v1
  s_nop 0
  ds_read_b128 v[116:119], v3 offset:16384
  v_smfmac_f32_16x16x64_bf16 v[72:75], v[40:43], v[84:91], v1
  s_nop 0
  ds_read_b128 v[120:123], v3 offset:17408
  v_add_f32 v60, v60, v61
  v_smfmac_f32_16x16x64_bf16 v[64:67], v[28:31], a[208:215], v1
  s_waitcnt lgkmcnt(4)
  s_barrier
  v_add_f32 v62, v62, v63
  v_smfmac_f32_16x16x64_bf16 v[64:67], v[32:35], a[216:223], v1
  ds_read_b64_tr_b16 v[76:77], v6 offset:0
  ds_read_b64_tr_b16 v[78:79], v6 offset:2048
  v_smfmac_f32_16x16x64_bf16 v[64:67], v[36:39], a[224:231], v1
  ds_read_b64_tr_b16 v[80:81], v6 offset:512
  ds_read_b64_tr_b16 v[82:83], v6 offset:2560
  v_smfmac_f32_16x16x64_bf16 v[64:67], v[40:43], a[232:239], v1
  ds_read_b64_tr_b16 v[84:85], v6 offset:1024
  ds_read_b64_tr_b16 v[86:87], v6 offset:3072
  v_smfmac_f32_16x16x64_bf16 v[64:67], v[44:47], a[240:247], v1
  ds_read_b64_tr_b16 v[88:89], v6 offset:1536
  ds_read_b64_tr_b16 v[90:91], v6 offset:3584
  v_smfmac_f32_16x16x64_bf16 v[64:67], v[48:51], a[248:255], v1
  s_waitcnt lgkmcnt(8)
  ds_read_b128 v[28:31], v0 offset:5120
  v_cvt_pk_bf16_f32 v124, v60, v62
  v_smfmac_f32_16x16x64_bf16 v[68:71], v[44:47], v[108:115], v1
  s_nop 0
  ds_read_b128 v[32:35], v0 offset:7168
  v_smfmac_f32_16x16x64_bf16 v[68:71], v[48:51], v[116:123], v1
  s_waitcnt lgkmcnt(2)
  ds_read_b128 v[108:111], v3 offset:2048
  v_add_f32 v64, v64, v65
  v_mfma_f32_16x16x32_bf16 v[52:55], v[92:95], v[76:79], 0
  v_add_f32 v66, v66, v67
  v_cvt_pk_bf16_f32 v125, v64, v66
  v_mfma_f32_16x16x32_bf16 v[52:55], v[96:99], v[80:83], v[52:55]
  s_waitcnt vmcnt(2)
  ds_write2st64_b32 v5, v124, v125 offset0:16 offset1:24
  v_add_f32 v68, v68, v69
  v_mfma_f32_16x16x32_bf16 v[52:55], v[100:103], v[84:87], v[52:55]
  ds_read_b128 v[112:115], v3 offset:3072
  v_add_f32 v70, v70, v71
  v_mfma_f32_16x16x32_bf16 v[52:55], v[104:107], v[88:91], v[52:55]
  s_waitcnt lgkmcnt(3)
  ds_read_b128 v[116:119], v3 offset:18432
  v_cvt_pk_bf16_f32 v126, v68, v70
  v_mfma_f32_16x16x32_bf16 v[56:59], v[20:23], v[76:79], 0
  ds_read_b128 v[120:123], v3 offset:19456
  v_mfma_f32_16x16x32_bf16 v[56:59], v[24:27], v[80:83], v[56:59]
  ds_read_b128 v[36:39], v2 offset:8192
  ds_read_b128 v[40:43], v2 offset:9216
  v_mfma_f32_16x16x32_bf16 v[56:59], v[28:31], v[84:87], v[56:59]
  s_waitcnt lgkmcnt(5)
  s_barrier
  ds_read_b64_tr_b16 v[92:93], v6 offset:4096
  ds_read_b64_tr_b16 v[94:95], v6 offset:6144
  v_mfma_f32_16x16x32_bf16 v[56:59], v[32:35], v[88:91], v[56:59]
  s_waitcnt lgkmcnt(4)
  ds_read_b64_tr_b16 v[96:97], v6 offset:4608
  ds_read_b64_tr_b16 v[98:99], v6 offset:6656
  v_smfmac_f32_16x16x64_bf16 v[72:75], v[44:47], v[108:115], v1
  ds_read_b64_tr_b16 v[100:101], v6 offset:5120
  ds_read_b64_tr_b16 v[102:103], v6 offset:7168
  v_smfmac_f32_16x16x64_bf16 v[72:75], v[48:51], v[116:123], v1
  ds_read_b64_tr_b16 v[104:105], v6 offset:5632
  ds_read_b64_tr_b16 v[106:107], v6 offset:7680
  v_exp_f32 v20, v52
  v_exp_f32 v21, v53
  v_exp_f32 v22, v54
  s_waitcnt lgkmcnt(4)
  v_mfma_f32_16x16x32_bf16 v[60:63], v[92:95], v[76:79], 0
  v_exp_f32 v23, v55
  v_mfma_f32_16x16x32_bf16 v[60:63], v[96:99], v[80:83], v[60:63]
  s_waitcnt lgkmcnt(0)
  v_exp_f32 v28, v56
  v_mfma_f32_16x16x32_bf16 v[60:63], v[100:103], v[84:87], v[60:63]
  v_exp_f32 v29, v57
  v_mfma_f32_16x16x32_bf16 v[60:63], v[104:107], v[88:91], v[60:63]
  s_cmp_eq_u32 s56, 63
  v_exp_f32 v30, v58
  v_exp_f32 v31, v59
  v_cvt_pk_bf16_f32 v24, v20, v21
  v_cvt_pk_bf16_f32 v25, v22, v23
  v_cvt_pk_bf16_f32 v26, v28, v29
  v_cvt_pk_bf16_f32 v27, v30, v31
  v_add_f32 v72, v72, v73
  v_exp_f32 v20, v60
  v_mfma_f32_16x16x32_bf16 v[64:67], v[12:15], v[24:27], 0
  v_exp_f32 v21, v61
  v_mfma_f32_16x16x32_bf16 v[80:83], v[36:39], v[24:27], 0
  v_add_f32 v74, v74, v75
  v_cvt_pk_bf16_f32 v16, v20, v21
  v_mfma_f32_16x16x32_bf16 v[84:87], v[40:43], v[24:27], 0
  v_cvt_pk_bf16_f32 v127, v72, v74
  v_cvt_pk_bf16_f32 v19, v20, v21
  v_mfma_f32_16x16x16_bf16 v[64:67], v[12:13], v[16:17], v[64:67]
  s_cbranch_scc1 L_team_last
  v_xor_b32 v3, 0x18000, v3
  v_mov_b64 v[44:45], 0
  v_mfma_f32_16x16x16_bf16 v[80:83], v[126:127], v[16:17], v[80:83]
  s_nop 0
  v_mov_b64 v[46:47], 0
  v_mov_b64 v[48:49], 0
  v_mfma_f32_16x16x16_bf16 v[84:87], v[126:127], v[18:19], v[84:87]
  v_rcp_f32 v65, v64
  v_subrev_u32 v66, s89, v64
  v_cmp_le_u32 vcc, s91, v66
  v_mov_b64 v[50:51], 0
L_smback_f:
  v_mul_f32 v80, v80, v65
  v_mul_f32 v81, v81, v65
  v_mul_f32 v82, v82, v65
  v_mul_f32 v83, v83, v65
  v_cvt_pk_bf16_f32 v88, v80, v81
  v_cvt_pk_bf16_f32 v89, v82, v83
  ds_write_b64 v7, v[88:89]
  v_mul_f32 v84, v84, v65
  v_mul_f32 v85, v85, v65
  v_mul_f32 v86, v86, v65
  v_mul_f32 v87, v87, v65
  v_cvt_pk_bf16_f32 v90, v84, v85
  v_cvt_pk_bf16_f32 v91, v86, v87
  s_cbranch_vccnz L_smslow_f
  ds_write_b64 v7, v[90:91] offset:8
  v_xor_b32 v96, 512, v7
  v_xor_b32 v100, 1024, v7
  v_xor_b32 v104, 1536, v7
  v_mov_b64 v[36:37], 0
  v_mov_b64 v[38:39], 0
  v_mov_b64 v[40:41], 0
  v_mov_b64 v[42:43], 0
  v_lshrrev_b32 v24, 16, v12
  v_cndmask_b32 v24, v24, 1.0, s[94:95]
  v_cndmask_b32 v20, 0, v24, s[80:81]
  v_cndmask_b32 v21, 0, v24, s[82:83]
  v_cndmask_b32 v22, 0, v24, s[84:85]
  v_cndmask_b32 v23, 0, v24, s[86:87]
  v_smfmac_f32_16x16x64_bf16 v[48:51], v[88:91], v[224:231], v1
  s_waitcnt lgkmcnt(0)
  s_barrier
  ds_read_b128 v[96:99], v96
  v_smfmac_f32_16x16x64_bf16 v[44:47], v[88:91], v[192:199], v1
  ds_read_b128 v[100:103], v100
  ds_read_b128 v[104:107], v104
  v_smfmac_f32_16x16x64_bf16 v[40:43], v[88:91], v[160:167], v1
  buffer_load_dwordx4 v2, s[40:43], s57 offen offset:0 sc1 lds
  v_mov_b64 v[60:61], 0
  v_smfmac_f32_16x16x64_bf16 v[36:39], v[88:91], v[128:135], v1
  buffer_load_dwordx4 v2, s[40:43], s57 offen offset:1024 sc1 lds
  v_mov_b64 v[62:63], 0
  v_mov_b64 v[64:65], 0
  v_mov_b64 v[66:67], 0
  s_waitcnt lgkmcnt(2)
  v_smfmac_f32_16x16x64_bf16 v[36:39], v[96:99], v[136:143], v1
  s_waitcnt lgkmcnt(1)
  v_mov_b64 v[52:53], 0
  v_smfmac_f32_16x16x64_bf16 v[36:39], v[100:103], v[144:151], v1
  s_waitcnt lgkmcnt(0)
  v_mov_b64 v[54:55], 0
  v_smfmac_f32_16x16x64_bf16 v[36:39], v[104:107], v[152:159], v1
  s_nop 1
  v_mov_b64 v[56:57], 0
  v_smfmac_f32_16x16x64_bf16 v[40:43], v[96:99], v[168:175], v1
  s_nop 1
  v_mov_b64 v[58:59], 0
  v_smfmac_f32_16x16x64_bf16 v[40:43], v[100:103], v[176:183], v1
  v_cvt_pk_bf16_f32 v36, v36, v37
  v_cvt_pk_bf16_f32 v37, v38, v39
  v_and_or_b32 v36, v36, -2, s65
  v_smfmac_f32_16x16x64_bf16 v[40:43], v[104:107], v[184:191], v1
  s_nop 1
  buffer_store_dwordx2 v[36:37], v8, s[40:43], s74 offen
  v_smfmac_f32_16x16x64_bf16 v[44:47], v[96:99], v[200:207], v1
  s_nop 2
  v_smfmac_f32_16x16x64_bf16 v[44:47], v[100:103], v[208:215], v1
  v_cvt_pk_bf16_f32 v40, v40, v41
  v_cvt_pk_bf16_f32 v41, v42, v43
  v_and_or_b32 v40, v40, -2, s65
  v_smfmac_f32_16x16x64_bf16 v[44:47], v[104:107], v[216:223], v1
  s_nop 1
  buffer_store_dwordx2 v[40:41], v8, s[40:43], s75 offen
  v_smfmac_f32_16x16x64_bf16 v[48:51], v[96:99], v[232:239], v1
  s_nop 2
  v_smfmac_f32_16x16x64_bf16 v[48:51], v[100:103], v[240:247], v1
  v_cvt_pk_bf16_f32 v44, v44, v45
  v_cvt_pk_bf16_f32 v45, v46, v47
  v_and_or_b32 v44, v44, -2, s65
  v_smfmac_f32_16x16x64_bf16 v[48:51], v[104:107], v[248:255], v1
  s_nop 1
  buffer_store_dwordx2 v[44:45], v8, s[40:43], s76 offen
  s_nop 4
  v_cvt_pk_bf16_f32 v48, v48, v49
  v_cvt_pk_bf16_f32 v49, v50, v51
  v_and_or_b32 v48, v48, -2, s65
  buffer_store_dwordx2 v[48:49], v8, s[40:43], s77 offen
  s_nop 15
  s_nop 9
  s_cmp_lt_u32 s44, 1
  s_cbranch_scc1 L_poll1_f
  s_nop 9
  s_cmp_lt_u32 s44, 2
  s_cbranch_scc1 L_poll1_f
  s_nop 9
  s_cmp_lt_u32 s44, 3
  s_cbranch_scc1 L_poll1_f
  s_nop 9
L_poll1_f:
  buffer_load_dwordx4 v[28:31], v9, s[40:43], s62 offen sc1
  buffer_load_dwordx4 v[32:35], v9, s[40:43], s62 offen offset:1024 sc1
  v_mov_b64 v[64:65], 0
  v_mov_b64 v[66:67], 0
  v_mov_b64 v[68:69], 0
  v_mov_b64 v[70:71], 0
  v_mov_b64 v[72:73], 0
  v_mov_b64 v[74:75], 0
  v_xor_b32 v11, 0x2000, v11
  v_xor_b32 v0, 0x2000, v0
  s_nop 15
  s_nop 3
  buffer_load_dwordx4 v[36:39], v9, s[40:43], s62 offen sc1
  buffer_load_dwordx4 v[40:43], v9, s[40:43], s62 offen offset:1024 sc1
  ds_read_b128 v[76:79], v3 offset:0
  ds_read_b128 v[80:83], v3 offset:1024
  ds_read_b128 v[84:87], v3 offset:2048
  ds_read_b128 v[88:91], v3 offset:3072
  ds_read_b128 v[92:95], v3 offset:16384
  ds_read_b128 v[96:99], v3 offset:17408
  ds_read_b128 v[100:103], v3 offset:18432
  ds_read_b128 v[104:107], v3 offset:19456
  v_xor_b32 v3, 0x8000, v3
  ds_read_b128 v[108:111], v3 offset:0
  ds_read_b128 v[112:115], v3 offset:1024
  ds_read_b128 v[116:119], v3 offset:2048
  ds_read_b128 v[120:123], v3 offset:3072
L_poll1b_f:
  s_waitcnt vmcnt(3)
  v_mfma_f32_16x16x32_bf16 v[24:27], v[28:31], v[20:23], 0
  v_bitop3_b32 v44, v28, v30, s65 bitop3:0x7e
  s_waitcnt vmcnt(2)
  v_mfma_f32_16x16x32_bf16 v[24:27], v[32:35], v[20:23], v[24:27]
  v_bitop3_b32 v45, v32, v34, s65 bitop3:0x7e
  v_or_b32 v44, v44, v45
  v_and_b32 v44, 1, v44
  v_cmp_ne_u32 vcc, 0, v44
  s_nop 2
  s_cbranch_vccnz L_retry1_f
L_got1_f:
  v_add_f32 v24, v24, v25
  v_add_f32 v26, v26, v27
  s_nop 1
  v_permlane16_swap_b32 v24, v26
  v_add_f32 v24, v24, v26
  v_cvt_pk_bf16_f32 v24, v24, v17
  v_min_u32 v24, s90, v24
  v_cndmask_b32 v24, v24, -1, s[78:79]
  buffer_store_short v24, v10, s[40:43], s64 offen
  s_nop 15
  s_nop 15
  s_nop 15
  s_nop 1
  s_branch L_poll2_f
L_retry2_f:
  s_waitcnt vmcnt(0)
  v_max3_u32 v44, v28, v29, v30
  v_max3_u32 v45, v31, v36, v37
  v_max3_u32 v44, v44, v38, v39
  v_max_u32 v44, v44, v45
  v_cmp_eq_u32 vcc, -1, v44
  v_mov_b64 v[20:21], v[28:29]
  v_mov_b64 v[22:23], v[30:31]
  v_mov_b64 v[24:25], v[36:37]
  v_mov_b64 v[26:27], v[38:39]
  v_mov_b64 v[52:53], 0
  v_mov_b64 v[54:55], 0
  v_mov_b64 v[56:57], 0
  v_mov_b64 v[58:59], 0
  s_cbranch_vccz L_entry_f
  buffer_load_dwordx4 v[20:23], v11, s[40:43], s63 offen sc1
  buffer_load_dwordx4 v[24:27], v11, s[40:43], s63 offen offset:1024 sc1
  s_add_u32 s67, s67, 1
  s_cmp_gt_u32 s67, 1048576
  s_cbranch_scc1 L_exit
  s_nop 15
  s_nop 3
  buffer_load_dwordx4 v[28:31], v11, s[40:43], s63 offen sc1
  buffer_load_dwordx4 v[36:39], v11, s[40:43], s63 offen offset:1024 sc1
  s_branch L_entry_f
L_retry1_f:
  buffer_load_dwordx4 v[28:31], v9, s[40:43], s62 offen sc1
  buffer_load_dwordx4 v[32:35], v9, s[40:43], s62 offen offset:1024 sc1
  s_waitcnt vmcnt(3)
  v_mfma_f32_16x16x32_bf16 v[24:27], v[36:39], v[20:23], 0
  v_bitop3_b32 v44, v36, v38, s65 bitop3:0x7e
  s_waitcnt vmcnt(2)
  v_mfma_f32_16x16x32_bf16 v[24:27], v[40:43], v[20:23], v[24:27]
  v_bitop3_b32 v45, v40, v42, s65 bitop3:0x7e
  v_or_b32 v44, v44, v45
  v_and_b32 v44, 1, v44
  v_cmp_ne_u32 vcc, 0, v44
  s_nop 2
  s_cbranch_vccnz L_retry1b_f
  v_add_f32 v24, v24, v25
  v_add_f32 v26, v26, v27
  s_nop 1
  v_permlane16_swap_b32 v24, v26
  v_add_f32 v24, v24, v26
  v_cvt_pk_bf16_f32 v24, v24, v17
  v_min_u32 v24, s90, v24
  v_cndmask_b32 v24, v24, -1, s[78:79]
  buffer_store_short v24, v10, s[40:43], s64 offen
  s_nop 15
  s_nop 15
  s_nop 15
  s_nop 1
  s_branch L_poll2_f
L_retry1b_f:
  buffer_load_dwordx4 v[36:39], v9, s[40:43], s62 offen sc1
  buffer_load_dwordx4 v[40:43], v9, s[40:43], s62 offen offset:1024 sc1
  s_add_u32 s67, s67, 1
  s_cmp_gt_u32 s67, 1048576
  s_cbranch_scc1 L_exit
  s_branch L_poll1b_f
L_smslow_f:
  v_max3_f32 v22, v52, v53, v54
  v_max3_f32 v22, v22, v55, v56
  v_max3_f32 v22, v22, v57, v58
  v_max3_f32 v22, v22, v59, v60
  v_max_f32 v22, v22, v61
  v_mov_b32 v20, v22
  s_nop 1
  v_permlane32_swap_b32 v20, v22
  v_max_f32 v22, v22, v20
  v_mov_b32 v20, v22
  s_nop 1
  v_permlane16_swap_b32 v20, v22
  v_max_f32 v22, v22, v20
  v_sub_f32 v20, v52, v22
  v_sub_f32 v21, v53, v22
  v_exp_f32 v20, v20
  v_exp_f32 v21, v21
  s_nop 0
  v_cvt_pk_bf16_f32 v24, v20, v21
  v_sub_f32 v20, v54, v22
  v_sub_f32 v21, v55, v22
  v_exp_f32 v20, v20
  v_exp_f32 v21, v21
  s_nop 0
  v_cvt_pk_bf16_f32 v25, v20, v21
  v_sub_f32 v20, v56, v22
  v_sub_f32 v21, v57, v22
  v_exp_f32 v20, v20
  v_exp_f32 v21, v21
  s_nop 0
  v_cvt_pk_bf16_f32 v26, v20, v21
  v_sub_f32 v20, v58, v22
  v_sub_f32 v21, v59, v22
  v_exp_f32 v20, v20
  v_exp_f32 v21, v21
  s_nop 0
  v_cvt_pk_bf16_f32 v27, v20, v21
  v_sub_f32 v20, v60, v22
  v_sub_f32 v21, v61, v22
  v_exp_f32 v20, v20
  v_exp_f32 v21, v21
  s_nop 0
  v_cvt_pk_bf16_f32 v16, v20, v21
  v_cvt_pk_bf16_f32 v19, v20, v21
  s_nop 1
  v_mfma_f32_16x16x32_bf16 v[64:67], v[12:15], v[24:27], 0
  v_mfma_f32_16x16x32_bf16 v[80:83], v[36:39], v[24:27], 0
  v_mfma_f32_16x16x32_bf16 v[84:87], v[40:43], v[24:27], 0
  s_nop 3
  v_mfma_f32_16x16x16_bf16 v[64:67], v[12:13], v[16:17], v[64:67]
  v_mfma_f32_16x16x16_bf16 v[80:83], v[126:127], v[16:17], v[80:83]
  v_mfma_f32_16x16x16_bf16 v[84:87], v[126:127], v[18:19], v[84:87]
  s_nop 7
  v_rcp_f32 v65, v64
  s_mov_b64 vcc, 0
  s_branch L_smback_f
L_fs_f:
  buffer_load_dword v4, v17, s[40:43], s60 offen sc1
  s_add_u32 s67, s67, 1
  s_cmp_gt_u32 s67, 1048576
  s_cbranch_scc1 L_exit
  s_waitcnt vmcnt(0)
  v_cmp_gt_u32 vcc, s92, v4
  s_cbranch_vccnz L_fs_f
  s_branch L_fsback_f
L_poll2_x:
  buffer_load_dwordx4 v[20:23], v11, s[40:43], s63 offen sc1
  buffer_load_dwordx4 v[24:27], v11, s[40:43], s63 offen offset:1024 sc1
  s_nop 15
  s_nop 6
  buffer_load_dwordx4 v[28:31], v11, s[40:43], s63 offen sc1
  buffer_load_dwordx4 v[36:39], v11, s[40:43], s63 offen offset:1024 sc1
  v_readlane_b32 s69, v4, 1
  v_xor_b32 v10, 0x2000, v10
  s_waitcnt vmcnt(5)
  v_xor_b32 v32, 2048, v11
  v_xor_b32 v40, 4096, v11
  v_xor_b32 v48, 6144, v11
  s_cmp_lt_u32 s69, s92
  s_cbranch_scc1 L_fs_x
L_fsback_x:
  s_add_u32 s56, s56, 1
  s_xor_b32 s65, s65, 1
  s_add_u32 s58, s57, 0x1000000
  s_add_u32 s68, s56, 1
  s_min_u32 s68, s68, 63
  s_lshl_b32 s68, s68, 13
  s_add_u32 s57, s72, s68
  s_add_u32 s59, s57, s73
  s_add_u32 s68, s56, 3
  s_min_u32 s92, s68, 64
  s_add_u32 s61, s61, 0x20000
  s_xor_b32 s70, s70, 0x2000
  v_bfe_u32 v45, v2, 9, 1
  v_and_b32 v4, 0x1ff, v2
  v_lshlrev_b32 v4, 2, v4
  v_lshl_add_u32 v4, v45, 24, v4
  s_sub_u32 s68, s60, s59
  v_min_u32 v124, -2, v124
  v_writelane_b32 v4, s68, 1
L_entry_x:
  s_waitcnt vmcnt(3)
  ds_write_b128 v11, v[20:23]
  v_smfmac_f32_16x16x64_bf16 v[52:55], v[20:23], a[0:7], v1
  s_waitcnt vmcnt(2)
  ds_write_b128 v11, v[24:27] offset:1024
  v_max3_u32 v44, v20, v21, v22
  v_max3_u32 v44, v44, v23, v24
  v_max3_u32 v44, v44, v25, v26
  v_max_u32 v44, v44, v27
  v_cmp_eq_u32 vcc, -1, v44
  v_smfmac_f32_16x16x64_bf16 v[56:59], v[20:23], a[64:71], v1
  s_mov_b32 m0, s71
  v_smfmac_f32_16x16x64_bf16 v[52:55], v[24:27], a[8:15], v1
  s_cbranch_vccnz L_retry2_x
  v_smfmac_f32_16x16x64_bf16 v[56:59], v[24:27], a[72:79], v1
  v_smfmac_f32_16x16x64_bf16 v[60:63], v[20:23], a[128:135], v1
  v_smfmac_f32_16x16x64_bf16 v[64:67], v[20:23], a[192:199], v1
  v_smfmac_f32_16x16x64_bf16 v[60:63], v[24:27], a[136:143], v1
  s_waitcnt vmcnt(0) lgkmcnt(0)
  s_barrier
  ds_read_b128 v[28:31], v32 offset:0
  v_smfmac_f32_16x16x64_bf16 v[64:67], v[24:27], a[200:207], v1
  ds_read_b128 v[32:35], v32 offset:1024
  ds_read_b128 v[36:39], v40 offset:0
  v_smfmac_f32_16x16x64_bf16 v[68:71], v[20:23], v[76:83], v1
  ds_read_b128 v[40:43], v40 offset:1024
  ds_read_b128 v[44:47], v48 offset:0
  v_smfmac_f32_16x16x64_bf16 v[72:75], v[20:23], v[84:91], v1
  ds_read_b128 v[48:51], v48 offset:1024
  buffer_load_dwordx4 v2, s[40:43], s58 offen offset:0 sc1 lds
  v_smfmac_f32_16x16x64_bf16 v[68:71], v[24:27], v[92:99], v1
  buffer_load_dwordx4 v2, s[40:43], s58 offen offset:1024 sc1 lds
  v_smfmac_f32_16x16x64_bf16 v[72:75], v[24:27], v[100:107], v1
  s_waitcnt lgkmcnt(5)
  ds_read_b128 v[76:79], v3 offset:16384
  v_smfmac_f32_16x16x64_bf16 v[52:55], v[28:31], a[16:23], v1
  s_waitcnt lgkmcnt(5)
  ds_read_b128 v[80:83], v3 offset:17408
  buffer_load_dword v4, v4, s[40:43], s59 offen sc1
  v_smfmac_f32_16x16x64_bf16 v[52:55], v[32:35], a[24:31], v1
  s_waitcnt lgkmcnt(5)
  ds_read_b128 v[84:87], v3 offset:18432
  buffer_store_dwordx4 v[124:127], v2, s[40:43], s61 offen sc1
  v_smfmac_f32_16x16x64_bf16 v[52:55], v[36:39], a[32:39], v1
  s_waitcnt lgkmcnt(5)
  ds_read_b128 v[88:91], v3 offset:19456
  v_xor_b32 v3, 0x18000, v3
  v_smfmac_f32_16x16x64_bf16 v[52:55], v[40:43], a[40:47], v1
  s_waitcnt lgkmcnt(4)
  ds_read_b128 v[92:95], v0 offset:0
  v_smfmac_f32_16x16x64_bf16 v[52:55], v[44:47], a[48:55], v1
  ds_read_b128 v[96:99], v0 offset:2048
  v_smfmac_f32_16x16x64_bf16 v[52:55], v[48:51], a[56:63], v1
  s_nop 0
  ds_read_b128 v[100:103], v0 offset:4096
  v_smfmac_f32_16x16x64_bf16 v[68:71], v[28:31], v[108:115], v1
  s_mov_b32 m0, s70
  ds_read_b128 v[104:107], v0 offset:6144
  v_smfmac_f32_16x16x64_bf16 v[56:59], v[28:31], a[80:87], v1
  s_nop 0
  ds_read_b128 v[108:111], v3 offset:0
  v_add_f32 v52, v52, v53
  v_smfmac_f32_16x16x64_bf16 v[56:59], v[32:35], a[88:95], v1
  ds_read_b128 v[112:115], v3 offset:1024
  v_add_f32 v54, v54, v55
  v_smfmac_f32_16x16x64_bf16 v[72:75], v[28:31], v[116:123], v1
  ds_read_b128 v[20:23], v0 offset:1024
  v_mul_f32 v52, s88, v52
  v_smfmac_f32_16x16x64_bf16 v[56:59], v[36:39], a[96:103], v1
  ds_read_b128 v[116:119], v3 offset:2048
  v_mul_f32 v54, s88, v54
  v_smfmac_f32_16x16x64_bf16 v[56:59], v[40:43], a[104:111], v1
  ds_read_b128 v[120:123], v3 offset:3072
  v_cvt_pk_bf16_f32 v52, v52, v52
  v_smfmac_f32_16x16x64_bf16 v[56:59], v[44:47], a[112:119], v1
  ds_read_b128 v[24:27], v0 offset:3072
  v_cvt_pk_bf16_f32 v53, v54, v54
  v_smfmac_f32_16x16x64_bf16 v[56:59], v[48:51], a[120:127], v1
  s_waitcnt lgkmcnt(10)
  ds_write_b64 v5, v[52:53] offset:0
  v_smfmac_f32_16x16x64_bf16 v[68:71], v[32:35], v[76:83], v1
  s_nop 0
  s_nop 0
  v_smfmac_f32_16x16x64_bf16 v[72:75], v[32:35], v[84:91], v1
  s_nop 0
  ds_read_b128 v[76:79], v3 offset:16384
  v_add_f32 v56, v56, v57
  v_smfmac_f32_16x16x64_bf16 v[60:63], v[28:31], a[144:151], v1
  ds_read_b128 v[80:83], v3 offset:17408
  v_add_f32 v58, v58, v59
  v_smfmac_f32_16x16x64_bf16 v[60:63], v[32:35], a[152:159], v1
  s_waitcnt lgkmcnt(4)
  ds_read_b128 v[84:87], v3 offset:18432
  v_mul_f32 v56, s88, v56
  v_smfmac_f32_16x16x64_bf16 v[68:71], v[36:39], v[108:115], v1
  ds_read_b128 v[88:91], v3 offset:19456
  v_mul_f32 v58, s88, v58
  v_smfmac_f32_16x16x64_bf16 v[60:63], v[36:39], a[160:167], v1
  v_cvt_pk_bf16_f32 v56, v56, v56
  v_smfmac_f32_16x16x64_bf16 v[72:75], v[36:39], v[116:123], v1
  v_cvt_pk_bf16_f32 v57, v58, v58
  v_smfmac_f32_16x16x64_bf16 v[60:63], v[40:43], a[168:175], v1
  ds_write_b64 v5, v[56:57] offset:2048
  v_xor_b32 v3, 0x8000, v3
  v_smfmac_f32_16x16x64_bf16 v[60:63], v[44:47], a[176:183], v1
  ds_read_b128 v[108:111], v3 offset:0
  v_smfmac_f32_16x16x64_bf16 v[60:63], v[48:51], a[184:191], v1
  s_waitcnt lgkmcnt(2)
  ds_read_b128 v[112:115], v3 offset:1024
  v_smfmac_f32_16x16x64_bf16 v[68:71], v[40:43], v[76:83], v1
  s_nop 0
  ds_read_b128 v[116:119], v3 offset:16384
  v_smfmac_f32_16x16x64_bf16 v[72:75], v[40:43], v[84:91], v1
  s_nop 0
  ds_read_b128 v[120:123], v3 offset:17408
  v_add_f32 v60, v60, v61
  v_smfmac_f32_16x16x64_bf16 v[64:67], v[28:31], a[208:215], v1
  s_waitcnt lgkmcnt(4)
  s_barrier
  v_add_f32 v62, v62, v63
  v_smfmac_f32_16x16x64_bf16 v[64:67], v[32:35], a[216:223], v1
  ds_read_b64_tr_b16 v[76:77], v6 offset:0
  ds_read_b64_tr_b16 v[78:79], v6 offset:2048
  v_smfmac_f32_16x16x64_bf16 v[64:67], v[36:39], a[224:231], v1
  ds_read_b64_tr_b16 v[80:81], v6 offset:512
  ds_read_b64_tr_b16 v[82:83], v6 offset:2560
  v_smfmac_f32_16x16x64_bf16 v[64:67], v[40:43], a[232:239], v1
  ds_read_b64_tr_b16 v[84:85], v6 offset:1024
  ds_read_b64_tr_b16 v[86:87], v6 offset:3072
  v_smfmac_f32_16x16x64_bf16 v[64:67], v[44:47], a[240:247], v1
  ds_read_b64_tr_b16 v[88:89], v6 offset:1536
  ds_read_b64_tr_b16 v[90:91], v6 offset:3584
  v_smfmac_f32_16x16x64_bf16 v[64:67], v[48:51], a[248:255], v1
  s_waitcnt lgkmcnt(8)
  ds_read_b128 v[28:31], v0 offset:5120
  v_cvt_pk_bf16_f32 v124, v60, v62
  v_smfmac_f32_16x16x64_bf16 v[68:71], v[44:47], v[108:115], v1
  s_nop 0
  ds_read_b128 v[32:35], v0 offset:7168
  v_smfmac_f32_16x16x64_bf16 v[68:71], v[48:51], v[116:123], v1
  s_waitcnt lgkmcnt(2)
  ds_read_b128 v[108:111], v3 offset:2048
  v_add_f32 v64, v64, v65
  v_mfma_f32_16x16x32_bf16 v[52:55], v[92:95], v[76:79], 0
  v_add_f32 v66, v66, v67
  v_cvt_pk_bf16_f32 v125, v64, v66
  v_mfma_f32_16x16x32_bf16 v[52:55], v[96:99], v[80:83], v[52:55]
  s_waitcnt vmcnt(2)
  ds_write2st64_b32 v5, v124, v125 offset0:16 offset1:24
  v_add_f32 v68, v68, v69
  v_mfma_f32_16x16x32_bf16 v[52:55], v[100:103], v[84:87], v[52:55]
  ds_read_b128 v[112:115], v3 offset:3072
  v_add_f32 v70, v70, v71
  v_mfma_f32_16x16x32_bf16 v[52:55], v[104:107], v[88:91], v[52:55]
  s_waitcnt lgkmcnt(3)
  ds_read_b128 v[116:119], v3 offset:18432
  v_cvt_pk_bf16_f32 v126, v68, v70
  v_mfma_f32_16x16x32_bf16 v[56:59], v[20:23], v[76:79], 0
  ds_read_b128 v[120:123], v3 offset:19456
  v_mfma_f32_16x16x32_bf16 v[56:59], v[24:27], v[80:83], v[56:59]
  ds_read_b128 v[36:39], v2 offset:8192
  ds_read_b128 v[40:43], v2 offset:9216
  v_mfma_f32_16x16x32_bf16 v[56:59], v[28:31], v[84:87], v[56:59]
  s_waitcnt lgkmcnt(5)
  s_barrier
  ds_read_b64_tr_b16 v[92:93], v6 offset:4096
  ds_read_b64_tr_b16 v[94:95], v6 offset:6144
  v_mfma_f32_16x16x32_bf16 v[56:59], v[32:35], v[88:91], v[56:59]
  s_waitcnt lgkmcnt(4)
  ds_read_b64_tr_b16 v[96:97], v6 offset:4608
  ds_read_b64_tr_b16 v[98:99], v6 offset:6656
  v_smfmac_f32_16x16x64_bf16 v[72:75], v[44:47], v[108:115], v1
  ds_read_b64_tr_b16 v[100:101], v6 offset:5120
  ds_read_b64_tr_b16 v[102:103], v6 offset:7168
  v_smfmac_f32_16x16x64_bf16 v[72:75], v[48:51], v[116:123], v1
  ds_read_b64_tr_b16 v[104:105], v6 offset:5632
  ds_read_b64_tr_b16 v[106:107], v6 offset:7680
  v_exp_f32 v20, v52
  v_exp_f32 v21, v53
  v_exp_f32 v22, v54
  s_waitcnt lgkmcnt(4)
  v_mfma_f32_16x16x32_bf16 v[60:63], v[92:95], v[76:79], 0
  v_exp_f32 v23, v55
  v_mfma_f32_16x16x32_bf16 v[60:63], v[96:99], v[80:83], v[60:63]
  s_waitcnt lgkmcnt(0)
  v_exp_f32 v28, v56
  v_mfma_f32_16x16x32_bf16 v[60:63], v[100:103], v[84:87], v[60:63]
  v_exp_f32 v29, v57
  v_mfma_f32_16x16x32_bf16 v[60:63], v[104:107], v[88:91], v[60:63]
  s_cmp_eq_u32 s56, 63
  v_exp_f32 v30, v58
  v_exp_f32 v31, v59
  v_cvt_pk_bf16_f32 v24, v20, v21
  v_cvt_pk_bf16_f32 v25, v22, v23
  v_cvt_pk_bf16_f32 v26, v28, v29
  v_cvt_pk_bf16_f32 v27, v30, v31
  v_add_f32 v72, v72, v73
  v_exp_f32 v20, v60
  v_mfma_f32_16x16x32_bf16 v[64:67], v[12:15], v[24:27], 0
  v_exp_f32 v21, v61
  v_mfma_f32_16x16x32_bf16 v[80:83], v[36:39], v[24:27], 0
  v_add_f32 v74, v74, v75
  v_cvt_pk_bf16_f32 v16, v20, v21
  v_mfma_f32_16x16x32_bf16 v[84:87], v[40:43], v[24:27], 0
  v_cvt_pk_bf16_f32 v127, v72, v74
  v_cvt_pk_bf16_f32 v19, v20, v21
  v_mfma_f32_16x16x16_bf16 v[64:67], v[12:13], v[16:17], v[64:67]
  s_cbranch_scc1 L_team_last
  v_xor_b32 v3, 0x18000, v3
  v_mov_b64 v[44:45], 0
  v_mfma_f32_16x16x16_bf16 v[80:83], v[126:127], v[16:17], v[80:83]
  s_nop 0
  v_mov_b64 v[46:47], 0
  v_mov_b64 v[48:49], 0
  v_mfma_f32_16x16x16_bf16 v[84:87], v[126:127], v[18:19], v[84:87]
  v_rcp_f32 v65, v64
  v_subrev_u32 v66, s89, v64
  v_cmp_le_u32 vcc, s91, v66
  v_mov_b64 v[50:51], 0
L_smback_x:
  v_mul_f32 v80, v80, v65
  v_mul_f32 v81, v81, v65
  v_mul_f32 v82, v82, v65
  v_mul_f32 v83, v83, v65
  v_cvt_pk_bf16_f32 v88, v80, v81
  v_cvt_pk_bf16_f32 v89, v82, v83
  ds_write_b64 v7, v[88:89]
  v_mul_f32 v84, v84, v65
  v_mul_f32 v85, v85, v65
  v_mul_f32 v86, v86, v65
  v_mul_f32 v87, v87, v65
  v_cvt_pk_bf16_f32 v90, v84, v85
  v_cvt_pk_bf16_f32 v91, v86, v87
  s_cbranch_vccnz L_smslow_x
  ds_write_b64 v7, v[90:91] offset:8
  v_xor_b32 v96, 512, v7
  v_xor_b32 v100, 1024, v7
  v_xor_b32 v104, 1536, v7
  v_mov_b64 v[36:37], 0
  v_mov_b64 v[38:39], 0
  v_mov_b64 v[40:41], 0
  v_mov_b64 v[42:43], 0
  v_lshrrev_b32 v24, 16, v12
  v_cndmask_b32 v24, v24, 1.0, s[94:95]
  v_cndmask_b32 v20, 0, v24, s[80:81]
  v_cndmask_b32 v21, 0, v24, s[82:83]
  v_cndmask_b32 v22, 0, v24, s[84:85]
  v_cndmask_b32 v23, 0, v24, s[86:87]
  v_smfmac_f32_16x16x64_bf16 v[48:51], v[88:91], v[224:231], v1
  s_waitcnt lgkmcnt(0)
  s_barrier
  ds_read_b128 v[96:99], v96
  v_smfmac_f32_16x16x64_bf16 v[44:47], v[88:91], v[192:199], v1
  ds_read_b128 v[100:103], v100
  ds_read_b128 v[104:107], v104
  v_smfmac_f32_16x16x64_bf16 v[40:43], v[88:91], v[160:167], v1
  buffer_load_dwordx4 v2, s[40:43], s57 offen offset:0 sc1 lds
  v_mov_b64 v[60:61], 0
  v_smfmac_f32_16x16x64_bf16 v[36:39], v[88:91], v[128:135], v1
  buffer_load_dwordx4 v2, s[40:43], s57 offen offset:1024 sc1 lds
  v_mov_b64 v[62:63], 0
  v_mov_b64 v[64:65], 0
  v_mov_b64 v[66:67], 0
  s_waitcnt lgkmcnt(2)
  v_smfmac_f32_16x16x64_bf16 v[36:39], v[96:99], v[136:143], v1
  s_waitcnt lgkmcnt(1)
  v_mov_b64 v[52:53], 0
  v_smfmac_f32_16x16x64_bf16 v[36:39], v[100:103], v[144:151], v1
  s_waitcnt lgkmcnt(0)
  v_mov_b64 v[54:55], 0
  v_smfmac_f32_16x16x64_bf16 v[36:39], v[104:107], v[152:159], v1
  s_nop 1
  v_mov_b64 v[56:57], 0
  v_smfmac_f32_16x16x64_bf16 v[40:43], v[96:99], v[168:175], v1
  s_nop 1
  v_mov_b64 v[58:59], 0
  v_smfmac_f32_16x16x64_bf16 v[40:43], v[100:103], v[176:183], v1
  v_cvt_pk_bf16_f32 v36, v36, v37
  v_cvt_pk_bf16_f32 v37, v38, v39
  v_and_or_b32 v36, v36, -2, s65
  v_smfmac_f32_16x16x64_bf16 v[40:43], v[104:107], v[184:191], v1
  s_nop 1
  buffer_store_dwordx2 v[36:37], v8, s[40:43], s74 offen sc1
  v_smfmac_f32_16x16x64_bf16 v[44:47], v[96:99], v[200:207], v1
  s_nop 2
  v_smfmac_f32_16x16x64_bf16 v[44:47], v[100:103], v[208:215], v1
  v_cvt_pk_bf16_f32 v40, v40, v41
  v_cvt_pk_bf16_f32 v41, v42, v43
  v_and_or_b32 v40, v40, -2, s65
  v_smfmac_f32_16x16x64_bf16 v[44:47], v[104:107], v[216:223], v1
  s_nop 1
  buffer_store_dwordx2 v[40:41], v8, s[40:43], s75 offen sc1
  v_smfmac_f32_16x16x64_bf16 v[48:51], v[96:99], v[232:239], v1
  s_nop 2
  v_smfmac_f32_16x16x64_bf16 v[48:51], v[100:103], v[240:247], v1
  v_cvt_pk_bf16_f32 v44, v44, v45
  v_cvt_pk_bf16_f32 v45, v46, v47
  v_and_or_b32 v44, v44, -2, s65
  v_smfmac_f32_16x16x64_bf16 v[48:51], v[104:107], v[248:255], v1
  s_nop 1
  buffer_store_dwordx2 v[44:45], v8, s[40:43], s76 offen sc1
  s_nop 4
  v_cvt_pk_bf16_f32 v48, v48, v49
  v_cvt_pk_bf16_f32 v49, v50, v51
  v_and_or_b32 v48, v48, -2, s65
  buffer_store_dwordx2 v[48:49], v8, s[40:43], s77 offen sc1
  s_nop 15
  s_nop 9
  s_cmp_lt_u32 s44, 1
  s_cbranch_scc1 L_poll1_x
  s_nop 9
  s_cmp_lt_u32 s44, 2
  s_cbranch_scc1 L_poll1_x
  s_nop 9
  s_cmp_lt_u32 s44, 3
  s_cbranch_scc1 L_poll1_x
  s_nop 9
L_poll1_x:
  buffer_load_dwordx4 v[28:31], v9, s[40:43], s62 offen sc1
  buffer_load_dwordx4 v[32:35], v9, s[40:43], s62 offen offset:1024 sc1
  v_mov_b64 v[64:65], 0
  v_mov_b64 v[66:67], 0
  v_mov_b64 v[68:69], 0
  v_mov_b64 v[70:71], 0
  v_mov_b64 v[72:73], 0
  v_mov_b64 v[74:75], 0
  v_xor_b32 v11, 0x2000, v11
  v_xor_b32 v0, 0x2000, v0
  s_nop 15
  s_nop 3
  buffer_load_dwordx4 v[36:39], v9, s[40:43], s62 offen sc1
  buffer_load_dwordx4 v[40:43], v9, s[40:43], s62 offen offset:1024 sc1
  ds_read_b128 v[76:79], v3 offset:0
  ds_read_b128 v[80:83], v3 offset:1024
  ds_read_b128 v[84:87], v3 offset:2048
  ds_read_b128 v[88:91], v3 offset:3072
  ds_read_b128 v[92:95], v3 offset:16384
  ds_read_b128 v[96:99], v3 offset:17408
  ds_read_b128 v[100:103], v3 offset:18432
  ds_read_b128 v[104:107], v3 offset:19456
  v_xor_b32 v3, 0x8000, v3
  ds_read_b128 v[108:111], v3 offset:0
  ds_read_b128 v[112:115], v3 offset:1024
  ds_read_b128 v[116:119], v3 offset:2048
  ds_read_b128 v[120:123], v3 offset:3072
L_poll1b_x:
  s_waitcnt vmcnt(3)
  v_mfma_f32_16x16x32_bf16 v[24:27], v[28:31], v[20:23], 0
  v_bitop3_b32 v44, v28, v30, s65 bitop3:0x7e
  s_waitcnt vmcnt(2)
  v_mfma_f32_16x16x32_bf16 v[24:27], v[32:35], v[20:23], v[24:27]
  v_bitop3_b32 v45, v32, v34, s65 bitop3:0x7e
  v_or_b32 v44, v44, v45
  v_and_b32 v44, 1, v44
  v_cmp_ne_u32 vcc, 0, v44
  s_nop 2
  s_cbranch_vccnz L_retry1_x
L_got1_x:
  v_add_f32 v24, v24, v25
  v_add_f32 v26, v26, v27
  s_nop 1
  v_permlane16_swap_b32 v24, v26
  v_add_f32 v24, v24, v26
  v_cvt_pk_bf16_f32 v24, v24, v17
  v_min_u32 v24, s90, v24
  v_cndmask_b32 v24, v24, -1, s[78:79]
  buffer_store_short v24, v10, s[40:43], s64 offen sc1
  s_nop 15
  s_nop 15
  s_nop 15
  s_nop 1
  s_branch L_poll2_x
L_retry2_x:
  s_waitcnt vmcnt(0)
  v_max3_u32 v44, v28, v29, v30
  v_max3_u32 v45, v31, v36, v37
  v_max3_u32 v44, v44, v38, v39
  v_max_u32 v44, v44, v45
  v_cmp_eq_u32 vcc, -1, v44
  v_mov_b64 v[20:21], v[28:29]
  v_mov_b64 v[22:23], v[30:31]
  v_mov_b64 v[24:25], v[36:37]
  v_mov_b64 v[26:27], v[38:39]
  v_mov_b64 v[52:53], 0
  v_mov_b64 v[54:55], 0
  v_mov_b64 v[56:57], 0
  v_mov_b64 v[58:59], 0
  s_cbranch_vccz L_entry_x
  buffer_load_dwordx4 v[20:23], v11, s[40:43], s63 offen sc1
  buffer_load_dwordx4 v[24:27], v11, s[40:43], s63 offen offset:1024 sc1
  s_add_u32 s67, s67, 1
  s_cmp_gt_u32 s67, 1048576
  s_cbranch_scc1 L_exit
  s_nop 15
  s_nop 3
  buffer_load_dwordx4 v[28:31], v11, s[40:43], s63 offen sc1
  buffer_load_dwordx4 v[36:39], v11, s[40:43], s63 offen offset:1024 sc1
  s_branch L_entry_x
L_retry1_x:
  buffer_load_dwordx4 v[28:31], v9, s[40:43], s62 offen sc1
  buffer_load_dwordx4 v[32:35], v9, s[40:43], s62 offen offset:1024 sc1
  s_waitcnt vmcnt(3)
  v_mfma_f32_16x16x32_bf16 v[24:27], v[36:39], v[20:23], 0
  v_bitop3_b32 v44, v36, v38, s65 bitop3:0x7e
  s_waitcnt vmcnt(2)
  v_mfma_f32_16x16x32_bf16 v[24:27], v[40:43], v[20:23], v[24:27]
  v_bitop3_b32 v45, v40, v42, s65 bitop3:0x7e
  v_or_b32 v44, v44, v45
  v_and_b32 v44, 1, v44
  v_cmp_ne_u32 vcc, 0, v44
  s_nop 2
  s_cbranch_vccnz L_retry1b_x
  v_add_f32 v24, v24, v25
  v_add_f32 v26, v26, v27
  s_nop 1
  v_permlane16_swap_b32 v24, v26
  v_add_f32 v24, v24, v26
  v_cvt_pk_bf16_f32 v24, v24, v17
  v_min_u32 v24, s90, v24
  v_cndmask_b32 v24, v24, -1, s[78:79]
  buffer_store_short v24, v10, s[40:43], s64 offen sc1
  s_nop 15
  s_nop 15
  s_nop 15
  s_nop 1
  s_branch L_poll2_x
L_retry1b_x:
  buffer_load_dwordx4 v[36:39], v9, s[40:43], s62 offen sc1
  buffer_load_dwordx4 v[40:43], v9, s[40:43], s62 offen offset:1024 sc1
  s_add_u32 s67, s67, 1
  s_cmp_gt_u32 s67, 1048576
  s_cbranch_scc1 L_exit
  s_branch L_poll1b_x
L_smslow_x:
  v_max3_f32 v22, v52, v53, v54
  v_max3_f32 v22, v22, v55, v56
  v_max3_f32 v22, v22, v57, v58
  v_max3_f32 v22, v22, v59, v60
  v_max_f32 v22, v22, v61
  v_mov_b32 v20, v22
  s_nop 1
  v_permlane32_swap_b32 v20, v22
  v_max_f32 v22, v22, v20
  v_mov_b32 v20, v22
  s_nop 1
  v_permlane16_swap_b32 v20, v22
  v_max_f32 v22, v22, v20
  v_sub_f32 v20, v52, v22
  v_sub_f32 v21, v53, v22
  v_exp_f32 v20, v20
  v_exp_f32 v21, v21
  s_nop 0
  v_cvt_pk_bf16_f32 v24, v20, v21
  v_sub_f32 v20, v54, v22
  v_sub_f32 v21, v55, v22
  v_exp_f32 v20, v20
  v_exp_f32 v21, v21
  s_nop 0
  v_cvt_pk_bf16_f32 v25, v20, v21
  v_sub_f32 v20, v56, v22
  v_sub_f32 v21, v57, v22
  v_exp_f32 v20, v20
  v_exp_f32 v21, v21
  s_nop 0
  v_cvt_pk_bf16_f32 v26, v20, v21
  v_sub_f32 v20, v58, v22
  v_sub_f32 v21, v59, v22
  v_exp_f32 v20, v20
  v_exp_f32 v21, v21
  s_nop 0
  v_cvt_pk_bf16_f32 v27, v20, v21
  v_sub_f32 v20, v60, v22
  v_sub_f32 v21, v61, v22
  v_exp_f32 v20, v20
  v_exp_f32 v21, v21
  s_nop 0
  v_cvt_pk_bf16_f32 v16, v20, v21
  v_cvt_pk_bf16_f32 v19, v20, v21
  s_nop 1
  v_mfma_f32_16x16x32_bf16 v[64:67], v[12:15], v[24:27], 0
  v_mfma_f32_16x16x32_bf16 v[80:83], v[36:39], v[24:27], 0
  v_mfma_f32_16x16x32_bf16 v[84:87], v[40:43], v[24:27], 0
  s_nop 3
  v_mfma_f32_16x16x16_bf16 v[64:67], v[12:13], v[16:17], v[64:67]
  v_mfma_f32_16x16x16_bf16 v[80:83], v[126:127], v[16:17], v[80:83]
  v_mfma_f32_16x16x16_bf16 v[84:87], v[126:127], v[18:19], v[84:87]
  s_nop 7
  v_rcp_f32 v65, v64
  s_mov_b64 vcc, 0
  s_branch L_smback_x
L_fs_x:
  buffer_load_dword v4, v17, s[40:43], s60 offen sc1
  s_add_u32 s67, s67, 1
  s_cmp_gt_u32 s67, 1048576
  s_cbranch_scc1 L_exit
  s_waitcnt vmcnt(0)
  v_cmp_gt_u32 vcc, s92, v4
  s_cbranch_vccnz L_fs_x
  s_branch L_fsback_x
L_team_last:
  s_add_u32 s61, s61, 0x20000
  v_min_u32 v124, -2, v124
  buffer_store_dwordx4 v[124:127], v2, s[40:43], s61 offen sc1
  s_waitcnt vmcnt(0)
  s_endpgm
L_exit:
  s_endpgm
.p2align 8
.type L_ptab,@object
L_ptab:
.long 0xd,0x10,0x1047005,0xe,0,0xc0,0x1e,0x180,0x240,4,4,4,4,4,4,4,4,4,4,4,4,4,4,4,4,4,4,4,4,4,4,4
.long 0x100d,0x32,0x846005,6,0x20,0x80,0xe0,0x140,0x1a0,0x200,0x260,0x2c0,0x320,0x380,0x3e0,4,4,4,4,4,4,4,4,4,4,4,4,4,4,4,4,4
.long 0x200d,0x54,0x1055005,0x1850005,0xe,0x10,0xd0,0x1e,0x190,0x250,4,4,4,4,4,4,4,4,4,4,4,4,4,4,4,4,4,4,4,4,4,4
.long 0x300d,0x76,0x854005,0x2051005,0xe,0x20,0xe0,0x1e,0x1a0,0x260,4,4,4,4,4,4,4,4,4,4,4,4,4,4,4,4,4,4,4,4,4,4
.long 0x400d,0x3276,0x2043005,6,0x40,0xa0,0x100,0x160,0x1c0,0x220,0x280,0x2e0,0x340,0x3a0,4,4,4,4,4,4,4,4,4,4,4,4,4,4,4,4,4,4
.long 0x500d,0x1054,0x1842005,6,0,0x60,0xc0,0x120,0x180,0x1e0,0x240,0x2a0,0x300,0x360,0x3c0,4,4,4,4,4,4,4,4,4,4,4,4,4,4,4,4,4
.long 0x600d,0x76543210,0x1e,0x300,0x340,0x380,0x3c0,4,4,4,4,4,4,4,4,4,4,4,4,4,4,4,4,4,4,4,4,4,4,4,4,4
.long 0x1d,0x10,0x1047015,0xe,0x1000,0x10c0,0x1e,0x1180,0x1240,4,4,4,4,4,4,4,4,4,4,4,4,4,4,4,4,4,4,4,4,4,4,4
.long 0x101d,0x32,0x846015,0x16,0x20,0x80,0xe0,0x140,0x1a0,0x200,0x260,0x2c0,0x320,0x380,0x3e0,4,4,4,4,4,4,4,4,4,4,4,4,4,4,4,4,4
.long 0x201d,0x54,0x1055015,0x1850015,0xe,0x1010,0x10d0,0x1e,0x1190,0x1250,4,4,4,4,4,4,4,4,4,4,4,4,4,4,4,4,4,4,4,4,4,4
.long 0x301d,0x76,0x854015,0x2051015,0xe,0x1020,0x10e0,0x1e,0x11a0,0x1260,4,4,4,4,4,4,4,4,4,4,4,4,4,4,4,4,4,4,4,4,4,4
.long 0x401d,0x3276,0x2043015,0x16,0x40,0xa0,0x100,0x160,0x1c0,0x220,0x280,0x2e0,0x340,0x3a0,4,4,4,4,4,4,4,4,4,4,4,4,4,4,4,4,4,4
.long 0x501d,0x1054,0x1842015,0x16,0,0x60,0xc0,0x120,0x180,0x1e0,0x240,0x2a0,0x300,0x360,0x3c0,4,4,4,4,4,4,4,4,4,4,4,4,4,4,4,4,4
.long 0x601d,0x76543210,0x1e,0x1300,0x1340,0x1380,0x13c0,4,4,4,4,4,4,4,4,4,4,4,4,4,4,4,4,4,4,4,4,4,4,4,4,4
.long 0x2d,0x10,0x1047025,0xe,0x2000,0x20c0,0x1e,0x2180,0x2240,4,4,4,4,4,4,4,4,4,4,4,4,4,4,4,4,4,4,4,4,4,4,4
.long 0x102d,0x32,0x846025,0x26,0x20,0x80,0xe0,0x140,0x1a0,0x200,0x260,0x2c0,0x320,0x380,0x3e0,4,4,4,4,4,4,4,4,4,4,4,4,4,4,4,4,4
.long 0x202d,0x54,0x1055025,0x1850025,0xe,0x2010,0x20d0,0x1e,0x2190,0x2250,4,4,4,4,4,4,4,4,4,4,4,4,4,4,4,4,4,4,4,4,4,4
.long 0x302d,0x76,0x854025,0x2051025,0xe,0x2020,0x20e0,0x1e,0x21a0,0x2260,4,4,4,4,4,4,4,4,4,4,4,4,4,4,4,4,4,4,4,4,4,4
.long 0x402d,0x3276,0x2043025,0x26,0x40,0xa0,0x100,0x160,0x1c0,0x220,0x280,0x2e0,0x340,0x3a0,4,4,4,4,4,4,4,4,4,4,4,4,4,4,4,4,4,4
.long 0x502d,0x1054,0x1842025,0x26,0,0x60,0xc0,0x120,0x180,0x1e0,0x240,0x2a0,0x300,0x360,0x3c0,4,4,4,4,4,4,4,4,4,4,4,4,4,4,4,4,4
.long 0x602d,0x76543210,0x1e,0x2300,0x2340,0x2380,0x23c0,4,4,4,4,4,4,4,4,4,4,4,4,4,4,4,4,4,4,4,4,4,4,4,4,4
.long 0x3d,0x10,0x1047035,0xe,0x3000,0x30c0,0x1e,0x3180,0x3240,4,4,4,4,4,4,4,4,4,4,4,4,4,4,4,4,4,4,4,4,4,4,4
.long 0x103d,0x32,0x846035,0x36,0x20,0x80,0xe0,0x140,0x1a0,0x200,0x260,0x2c0,0x320,0x380,0x3e0,4,4,4,4,4,4,4,4,4,4,4,4,4,4,4,4,4
.long 0x203d,0x54,0x1055035,0x1850035,0xe,0x3010,0x30d0,0x1e,0x3190,0x3250,4,4,4,4,4,4,4,4,4,4,4,4,4,4,4,4,4,4,4,4,4,4
.long 0x303d,0x76,0x854035,0x2051035,0xe,0x3020,0x30e0,0x1e,0x31a0,0x3260,4,4,4,4,4,4,4,4,4,4,4,4,4,4,4,4,4,4,4,4,4,4
.long 0x403d,0x3276,0x2043035,0x36,0x40,0xa0,0x100,0x160,0x1c0,0x220,0x280,0x2e0,0x340,0x3a0,4,4,4,4,4,4,4,4,4,4,4,4,4,4,4,4,4,4
.long 0x503d,0x1054,0x1842035,0x36,0,0x60,0xc0,0x120,0x180,0x1e0,0x240,0x2a0,0x300,0x360,0x3c0,4,4,4,4,4,4,4,4,4,4,4,4,4,4,4,4,4
.long 0x603d,0x76543210,0x1e,0x3300,0x3340,0x3380,0x33c0,4,4,4,4,4,4,4,4,4,4,4,4,4,4,4,4,4,4,4,4,4,4,4,4,4
.long 0x4d,0x10,0x1047045,0xe,0x4000,0x40c0,0x1e,0x4180,0x4240,4,4,4,4,4,4,4,4,4,4,4,4,4,4,4,4,4,4,4,4,4,4,4
.long 0x104d,0x32,0x846045,0x46,0x20,0x80,0xe0,0x140,0x1a0,0x200,0x260,0x2c0,0x320,0x380,0x3e0,4,4,4,4,4,4,4,4,4,4,4,4,4,4,4,4,4
.long 0x204d,0x54,0x1055045,0x1850045,0xe,0x4010,0x40d0,0x1e,0x4190,0x4250,4,4,4,4,4,4,4,4,4,4,4,4,4,4,4,4,4,4,4,4,4,4
.long 0x304d,0x76,0x854045,0x2051045,0xe,0x4020,0x40e0,0x1e,0x41a0,0x4260,4,4,4,4,4,4,4,4,4,4,4,4,4,4,4,4,4,4,4,4,4,4
.long 0x404d,0x3276,0x2043045,0x46,0x40,0xa0,0x100,0x160,0x1c0,0x220,0x280,0x2e0,0x340,0x3a0,4,4,4,4,4,4,4,4,4,4,4,4,4,4,4,4,4,4
.long 0x504d,0x1054,0x1842045,0x46,0,0x60,0xc0,0x120,0x180,0x1e0,0x240,0x2a0,0x300,0x360,0x3c0,4,4,4,4,4,4,4,4,4,4,4,4,4,4,4,4,4
.long 0x604d,0x76543210,0x1e,0x4300,0x4340,0x4380,0x43c0,4,4,4,4,4,4,4,4,4,4,4,4,4,4,4,4,4,4,4,4,4,4,4,4,4
.long 0x5d,0x10,0x1047055,0xe,0x5000,0x50c0,0x1e,0x5180,0x5240,4,4,4,4,4,4,4,4,4,4,4,4,4,4,4,4,4,4,4,4,4,4,4
.long 0x105d,0x32,0x846055,0x56,0x20,0x80,0xe0,0x140,0x1a0,0x200,0x260,0x2c0,0x320,0x380,0x3e0,4,4,4,4,4,4,4,4,4,4,4,4,4,4,4,4,4
.long 0x205d,0x54,0x1055055,0x1850055,0xe,0x5010,0x50d0,0x1e,0x5190,0x5250,4,4,4,4,4,4,4,4,4,4,4,4,4,4,4,4,4,4,4,4,4,4
.long 0x305d,0x76,0x854055,0x2051055,0xe,0x5020,0x50e0,0x1e,0x51a0,0x5260,4,4,4,4,4,4,4,4,4,4,4,4,4,4,4,4,4,4,4,4,4,4
.long 0x405d,0x3276,0x2043055,0x56,0x40,0xa0,0x100,0x160,0x1c0,0x220,0x280,0x2e0,0x340,0x3a0,4,4,4,4,4,4,4,4,4,4,4,4,4,4,4,4,4,4
.long 0x505d,0x1054,0x1842055,0x56,0,0x60,0xc0,0x120,0x180,0x1e0,0x240,0x2a0,0x300,0x360,0x3c0,4,4,4,4,4,4,4,4,4,4,4,4,4,4,4,4,4
.long 0x605d,0x76543210,0x1e,0x5300,0x5340,0x5380,0x53c0,4,4,4,4,4,4,4,4,4,4,4,4,4,4,4,4,4,4,4,4,4,4,4,4,4
.long 0x6d,0x10,0x1047065,0xe,0x6000,0x60c0,0x1e,0x6180,0x6240,4,4,4,4,4,4,4,4,4,4,4,4,4,4,4,4,4,4,4,4,4,4,4
.long 0x106d,0x32,0x846065,0x66,0x20,0x80,0xe0,0x140,0x1a0,0x200,0x260,0x2c0,0x320,0x380,0x3e0,4,4,4,4,4,4,4,4,4,4,4,4,4,4,4,4,4
.long 0x206d,0x54,0x1055065,0x1850065,0xe,0x6010,0x60d0,0x1e,0x6190,0x6250,4,4,4,4,4,4,4,4,4,4,4,4,4,4,4,4,4,4,4,4,4,4
.long 0x306d,0x76,0x854065,0x2051065,0xe,0x6020,0x60e0,0x1e,0x61a0,0x6260,4,4,4,4,4,4,4,4,4,4,4,4,4,4,4,4,4,4,4,4,4,4
.long 0x406d,0x3276,0x2043065,0x66,0x40,0xa0,0x100,0x160,0x1c0,0x220,0x280,0x2e0,0x340,0x3a0,4,4,4,4,4,4,4,4,4,4,4,4,4,4,4,4,4,4
.long 0x506d,0x1054,0x1842065,0x66,0,0x60,0xc0,0x120,0x180,0x1e0,0x240,0x2a0,0x300,0x360,0x3c0,4,4,4,4,4,4,4,4,4,4,4,4,4,4,4,4,4
.long 0x606d,0x76543210,0x1e,0x6300,0x6340,0x6380,0x63c0,4,4,4,4,4,4,4,4,4,4,4,4,4,4,4,4,4,4,4,4,4,4,4,4,4
.long 0x7d,0x10,0x1047075,0xe,0x7000,0x70c0,0x1e,0x7180,0x7240,4,4,4,4,4,4,4,4,4,4,4,4,4,4,4,4,4,4,4,4,4,4,4
.long 0x107d,0x32,0x846075,0x76,0x20,0x80,0xe0,0x140,0x1a0,0x200,0x260,0x2c0,0x320,0x380,0x3e0,4,4,4,4,4,4,4,4,4,4,4,4,4,4,4,4,4
.long 0x207d,0x54,0x1055075,0x1850075,0xe,0x7010,0x70d0,0x1e,0x7190,0x7250,4,4,4,4,4,4,4,4,4,4,4,4,4,4,4,4,4,4,4,4,4,4
.long 0x307d,0x76,0x854075,0x2051075,0xe,0x7020,0x70e0,0x1e,0x71a0,0x7260,4,4,4,4,4,4,4,4,4,4,4,4,4,4,4,4,4,4,4,4,4,4
.long 0x407d,0x3276,0x2043075,0x76,0x40,0xa0,0x100,0x160,0x1c0,0x220,0x280,0x2e0,0x340,0x3a0,4,4,4,4,4,4,4,4,4,4,4,4,4,4,4,4,4,4
.long 0x507d,0x1054,0x1842075,0x76,0,0x60,0xc0,0x120,0x180,0x1e0,0x240,0x2a0,0x300,0x360,0x3c0,4,4,4,4,4,4,4,4,4,4,4,4,4,4,4,4,4
.long 0x607d,0x76543210,0x1e,0x7300,0x7340,0x7380,0x73c0,4,4,4,4,4,4,4,4,4,4,4,4,4,4,4,4,4,4,4,4,4,4,4,4,4
.long 0x8d,0x10,0x1047085,0xe,0x30,0xf0,0x1e,0x1b0,0x270,4,4,4,4,4,4,4,4,4,4,4,4,4,4,4,4,4,4,4,4,4,4,4
.long 0x108d,0x32,0x846085,0x86,0x20,0x80,0xe0,0x140,0x1a0,0x200,0x260,0x2c0,0x320,0x380,0x3e0,4,4,4,4,4,4,4,4,4,4,4,4,4,4,4,4,4
.long 0x208d,0x54,0x1055085,0x1850085,0xe,0x40,0x100,0x1e,0x1c0,0x280,4,4,4,4,4,4,4,4,4,4,4,4,4,4,4,4,4,4,4,4,4,4
.long 0x308d,0x76,0x854085,0x2051085,0xe,0x50,0x110,0x1e,0x1d0,0x290,4,4,4,4,4,4,4,4,4,4,4,4,4,4,4,4,4,4,4,4,4,4
.long 0x408d,0x3276,0x2043085,0x86,0x40,0xa0,0x100,0x160,0x1c0,0x220,0x280,0x2e0,0x340,0x3a0,4,4,4,4,4,4,4,4,4,4,4,4,4,4,4,4,4,4
.long 0x508d,0x1054,0x1842085,0x86,0,0x60,0xc0,0x120,0x180,0x1e0,0x240,0x2a0,0x300,0x360,0x3c0,4,4,4,4,4,4,4,4,4,4,4,4,4,4,4,4,4
.long 0x608d,0x76543210,0x1e,0x310,0x350,0x390,0x3d0,4,4,4,4,4,4,4,4,4,4,4,4,4,4,4,4,4,4,4,4,4,4,4,4,4
.long 0x9d,0x10,0x1047095,0xe,0x1030,0x10f0,0x1e,0x11b0,0x1270,4,4,4,4,4,4,4,4,4,4,4,4,4,4,4,4,4,4,4,4,4,4,4
.long 0x109d,0x32,0x846095,0x96,0x20,0x80,0xe0,0x140,0x1a0,0x200,0x260,0x2c0,0x320,0x380,0x3e0,4,4,4,4,4,4,4,4,4,4,4,4,4,4,4,4,4
.long 0x209d,0x54,0x1055095,0x1850095,0xe,0x1040,0x1100,0x1e,0x11c0,0x1280,4,4,4,4,4,4,4,4,4,4,4,4,4,4,4,4,4,4,4,4,4,4
.long 0x309d,0x76,0x854095,0x2051095,0xe,0x1050,0x1110,0x1e,0x11d0,0x1290,4,4,4,4,4,4,4,4,4,4,4,4,4,4,4,4,4,4,4,4,4,4
.long 0x409d,0x3276,0x2043095,0x96,0x40,0xa0,0x100,0x160,0x1c0,0x220,0x280,0x2e0,0x340,0x3a0,4,4,4,4,4,4,4,4,4,4,4,4,4,4,4,4,4,4
.long 0x509d,0x1054,0x1842095,0x96,0,0x60,0xc0,0x120,0x180,0x1e0,0x240,0x2a0,0x300,0x360,0x3c0,4,4,4,4,4,4,4,4,4,4,4,4,4,4,4,4,4
.long 0x609d,0x76543210,0x1e,0x1310,0x1350,0x1390,0x13d0,4,4,4,4,4,4,4,4,4,4,4,4,4,4,4,4,4,4,4,4,4,4,4,4,4
.long 0xad,0x10,0x10470a5,0xe,0x2030,0x20f0,0x1e,0x21b0,0x2270,4,4,4,4,4,4,4,4,4,4,4,4,4,4,4,4,4,4,4,4,4,4,4
.long 0x10ad,0x32,0x8460a5,0xa6,0x20,0x80,0xe0,0x140,0x1a0,0x200,0x260,0x2c0,0x320,0x380,0x3e0,4,4,4,4,4,4,4,4,4,4,4,4,4,4,4,4,4
.long 0x20ad,0x54,0x10550a5,0x18500a5,0xe,0x2040,0x2100,0x1e,0x21c0,0x2280,4,4,4,4,4,4,4,4,4,4,4,4,4,4,4,4,4,4,4,4,4,4
.long 0x30ad,0x76,0x8540a5,0x20510a5,0xe,0x2050,0x2110,0x1e,0x21d0,0x2290,4,4,4,4,4,4,4,4,4,4,4,4,4,4,4,4,4,4,4,4,4,4
.long 0x40ad,0x3276,0x20430a5,0xa6,0x40,0xa0,0x100,0x160,0x1c0,0x220,0x280,0x2e0,0x340,0x3a0,4,4,4,4,4,4,4,4,4,4,4,4,4,4,4,4,4,4
.long 0x50ad,0x1054,0x18420a5,0xa6,0,0x60,0xc0,0x120,0x180,0x1e0,0x240,0x2a0,0x300,0x360,0x3c0,4,4,4,4,4,4,4,4,4,4,4,4,4,4,4,4,4
.long 0x60ad,0x76543210,0x1e,0x2310,0x2350,0x2390,0x23d0,4,4,4,4,4,4,4,4,4,4,4,4,4,4,4,4,4,4,4,4,4,4,4,4,4
.long 0xbd,0x10,0x10470b5,0xe,0x3030,0x30f0,0x1e,0x31b0,0x3270,4,4,4,4,4,4,4,4,4,4,4,4,4,4,4,4,4,4,4,4,4,4,4
.long 0x10bd,0x32,0x8460b5,0xb6,0x20,0x80,0xe0,0x140,0x1a0,0x200,0x260,0x2c0,0x320,0x380,0x3e0,4,4,4,4,4,4,4,4,4,4,4,4,4,4,4,4,4
.long 0x20bd,0x54,0x10550b5,0x18500b5,0xe,0x3040,0x3100,0x1e,0x31c0,0x3280,4,4,4,4,4,4,4,4,4,4,4,4,4,4,4,4,4,4,4,4,4,4
.long 0x30bd,0x76,0x8540b5,0x20510b5,0xe,0x3050,0x3110,0x1e,0x31d0,0x3290,4,4,4,4,4,4,4,4,4,4,4,4,4,4,4,4,4,4,4,4,4,4
.long 0x40bd,0x3276,0x20430b5,0xb6,0x40,0xa0,0x100,0x160,0x1c0,0x220,0x280,0x2e0,0x340,0x3a0,4,4,4,4,4,4,4,4,4,4,4,4,4,4,4,4,4,4
.long 0x50bd,0x1054,0x18420b5,0xb6,0,0x60,0xc0,0x120,0x180,0x1e0,0x240,0x2a0,0x300,0x360,0x3c0,4,4,4,4,4,4,4,4,4,4,4,4,4,4,4,4,4
.long 0x60bd,0x76543210,0x1e,0x3310,0x3350,0x3390,0x33d0,4,4,4,4,4,4,4,4,4,4,4,4,4,4,4,4,4,4,4,4,4,4,4,4,4
.long 0xcd,0x10,0x10470c5,0xe,0x4030,0x40f0,0x1e,0x41b0,0x4270,4,4,4,4,4,4,4,4,4,4,4,4,4,4,4,4,4,4,4,4,4,4,4
.long 0x10cd,0x32,0x8460c5,0xc6,0x20,0x80,0xe0,0x140,0x1a0,0x200,0x260,0x2c0,0x320,0x380,0x3e0,4,4,4,4,4,4,4,4,4,4,4,4,4,4,4,4,4
.long 0x20cd,0x54,0x10550c5,0x18500c5,0xe,0x4040,0x4100,0x1e,0x41c0,0x4280,4,4,4,4,4,4,4,4,4,4,4,4,4,4,4,4,4,4,4,4,4,4
.long 0x30cd,0x76,0x8540c5,0x20510c5,0xe,0x4050,0x4110,0x1e,0x41d0,0x4290,4,4,4,4,4,4,4,4,4,4,4,4,4,4,4,4,4,4,4,4,4,4
.long 0x40cd,0x3276,0x20430c5,0xc6,0x40,0xa0,0x100,0x160,0x1c0,0x220,0x280,0x2e0,0x340,0x3a0,4,4,4,4,4,4,4,4,4,4,4,4,4,4,4,4,4,4
.long 0x50cd,0x1054,0x18420c5,0xc6,0,0x60,0xc0,0x120,0x180,0x1e0,0x240,0x2a0,0x300,0x360,0x3c0,4,4,4,4,4,4,4,4,4,4,4,4,4,4,4,4,4
.long 0x60cd,0x76543210,0x1e,0x4310,0x4350,0x4390,0x43d0,4,4,4,4,4,4,4,4,4,4,4,4,4,4,4,4,4,4,4,4,4,4,4,4,4
.long 0xdd,0x10,0x10470d5,0xe,0x5030,0x50f0,0x1e,0x51b0,0x5270,4,4,4,4,4,4,4,4,4,4,4,4,4,4,4,4,4,4,4,4,4,4,4
.long 0x10dd,0x32,0x8460d5,0xd6,0x20,0x80,0xe0,0x140,0x1a0,0x200,0x260,0x2c0,0x320,0x380,0x3e0,4,4,4,4,4,4,4,4,4,4,4,4,4,4,4,4,4
.long 0x20dd,0x54,0x10550d5,0x18500d5,0xe,0x5040,0x5100,0x1e,0x51c0,0x5280,4,4,4,4,4,4,4,4,4,4,4,4,4,4,4,4,4,4,4,4,4,4
.long 0x30dd,0x76,0x8540d5,0x20510d5,0xe,0x5050,0x5110,0x1e,0x51d0,0x5290,4,4,4,4,4,4,4,4,4,4,4,4,4,4,4,4,4,4,4,4,4,4
.long 0x40dd,0x3276,0x20430d5,0xd6,0x40,0xa0,0x100,0x160,0x1c0,0x220,0x280,0x2e0,0x340,0x3a0,4,4,4,4,4,4,4,4,4,4,4,4,4,4,4,4,4,4
.long 0x50dd,0x1054,0x18420d5,0xd6,0,0x60,0xc0,0x120,0x180,0x1e0,0x240,0x2a0,0x300,0x360,0x3c0,4,4,4,4,4,4,4,4,4,4,4,4,4,4,4,4,4
.long 0x60dd,0x76543210,0x1e,0x5310,0x5350,0x5390,0x53d0,4,4,4,4,4,4,4,4,4,4,4,4,4,4,4,4,4,4,4,4,4,4,4,4,4
.long 0xed,0x10,0x10470e5,0xe,0x6030,0x60f0,0x1e,0x61b0,0x6270,4,4,4,4,4,4,4,4,4,4,4,4,4,4,4,4,4,4,4,4,4,4,4
.long 0x10ed,0x32,0x8460e5,0xe6,0x20,0x80,0xe0,0x140,0x1a0,0x200,0x260,0x2c0,0x320,0x380,0x3e0,4,4,4,4,4,4,4,4,4,4,4,4,4,4,4,4,4
.long 0x20ed,0x54,0x10550e5,0x18500e5,0xe,0x6040,0x6100,0x1e,0x61c0,0x6280,4,4,4,4,4,4,4,4,4,4,4,4,4,4,4,4,4,4,4,4,4,4
.long 0x30ed,0x76,0x8540e5,0x20510e5,0xe,0x6050,0x6110,0x1e,0x61d0,0x6290,4,4,4,4,4,4,4,4,4,4,4,4,4,4,4,4,4,4,4,4,4,4
.long 0x40ed,0x3276,0x20430e5,0xe6,0x40,0xa0,0x100,0x160,0x1c0,0x220,0x280,0x2e0,0x340,0x3a0,4,4,4,4,4,4,4,4,4,4,4,4,4,4,4,4,4,4
.long 0x50ed,0x1054,0x18420e5,0xe6,0,0x60,0xc0,0x120,0x180,0x1e0,0x240,0x2a0,0x300,0x360,0x3c0,4,4,4,4,4,4,4,4,4,4,4,4,4,4,4,4,4
.long 0x60ed,0x76543210,0x1e,0x6310,0x6350,0x6390,0x63d0,4,4,4,4,4,4,4,4,4,4,4,4,4,4,4,4,4,4,4,4,4,4,4,4,4
.long 0xfd,0x10,0x10470f5,0xe,0x7030,0x70f0,0x1e,0x71b0,0x7270,4,4,4,4,4,4,4,4,4,4,4,4,4,4,4,4,4,4,4,4,4,4,4
.long 0x10fd,0x32,0x8460f5,0xf6,0x20,0x80,0xe0,0x140,0x1a0,0x200,0x260,0x2c0,0x320,0x380,0x3e0,4,4,4,4,4,4,4,4,4,4,4,4,4,4,4,4,4
.long 0x20fd,0x54,0x10550f5,0x18500f5,0xe,0x7040,0x7100,0x1e,0x71c0,0x7280,4,4,4,4,4,4,4,4,4,4,4,4,4,4,4,4,4,4,4,4,4,4
.long 0x30fd,0x76,0x8540f5,0x20510f5,0xe,0x7050,0x7110,0x1e,0x71d0,0x7290,4,4,4,4,4,4,4,4,4,4,4,4,4,4,4,4,4,4,4,4,4,4
.long 0x40fd,0x3276,0x20430f5,0xf6,0x40,0xa0,0x100,0x160,0x1c0,0x220,0x280,0x2e0,0x340,0x3a0,4,4,4,4,4,4,4,4,4,4,4,4,4,4,4,4,4,4
.long 0x50fd,0x1054,0x18420f5,0xf6,0,0x60,0xc0,0x120,0x180,0x1e0,0x240,0x2a0,0x300,0x360,0x3c0,4,4,4,4,4,4,4,4,4,4,4,4,4,4,4,4,4
.long 0x60fd,0x76543210,0x1e,0x7310,0x7350,0x7390,0x73d0,4,4,4,4,4,4,4,4,4,4,4,4,4,4,4,4,4,4,4,4,4,4,4,4,4
.long 0x10d,0x10,0x1047105,0xe,0x60,0x120,0x1e,0x1e0,0x2a0,4,4,4,4,4,4,4,4,4,4,4,4,4,4,4,4,4,4,4,4,4,4,4
.long 0x110d,0x32,0x846105,6,0x30,0x90,0xf0,0x150,0x1b0,0x210,0x270,0x2d0,0x330,0x390,0x3f0,4,4,4,4,4,4,4,4,4,4,4,4,4,4,4,4,4
.long 0x210d,0x54,0x1055105,0x1850105,0xe,0x70,0x130,0x1e,0x1f0,0x2b0,4,4,4,4,4,4,4,4,4,4,4,4,4,4,4,4,4,4,4,4,4,4
.long 0x310d,0x76,0x854105,0x2051105,0xe,0x80,0x140,0x1e,0x200,0x2c0,4,4,4,4,4,4,4,4,4,4,4,4,4,4,4,4,4,4,4,4,4,4
.long 0x410d,0x3276,0x2043105,6,0x50,0xb0,0x110,0x170,0x1d0,0x230,0x290,0x2f0,0x350,0x3b0,4,4,4,4,4,4,4,4,4,4,4,4,4,4,4,4,4,4
.long 0x510d,0x1054,0x1842105,6,0x10,0x70,0xd0,0x130,0x190,0x1f0,0x250,0x2b0,0x310,0x370,0x3d0,4,4,4,4,4,4,4,4,4,4,4,4,4,4,4,4,4
.long 0x610d,0x76543210,0x1e,0x320,0x360,0x3a0,0x3e0,4,4,4,4,4,4,4,4,4,4,4,4,4,4,4,4,4,4,4,4,4,4,4,4,4
.long 0x11d,0x10,0x1047115,0xe,0x1060,0x1120,0x1e,0x11e0,0x12a0,4,4,4,4,4,4,4,4,4,4,4,4,4,4,4,4,4,4,4,4,4,4,4
.long 0x111d,0x32,0x846115,0x16,0x30,0x90,0xf0,0x150,0x1b0,0x210,0x270,0x2d0,0x330,0x390,0x3f0,4,4,4,4,4,4,4,4,4,4,4,4,4,4,4,4,4
.long 0x211d,0x54,0x1055115,0x1850115,0xe,0x1070,0x1130,0x1e,0x11f0,0x12b0,4,4,4,4,4,4,4,4,4,4,4,4,4,4,4,4,4,4,4,4,4,4
.long 0x311d,0x76,0x854115,0x2051115,0xe,0x1080,0x1140,0x1e,0x1200,0x12c0,4,4,4,4,4,4,4,4,4,4,4,4,4,4,4,4,4,4,4,4,4,4
.long 0x411d,0x3276,0x2043115,0x16,0x50,0xb0,0x110,0x170,0x1d0,0x230,0x290,0x2f0,0x350,0x3b0,4,4,4,4,4,4,4,4,4,4,4,4,4,4,4,4,4,4
.long 0x511d,0x1054,0x1842115,0x16,0x10,0x70,0xd0,0x130,0x190,0x1f0,0x250,0x2b0,0x310,0x370,0x3d0,4,4,4,4,4,4,4,4,4,4,4,4,4,4,4,4,4
.long 0x611d,0x76543210,0x1e,0x1320,0x1360,0x13a0,0x13e0,4,4,4,4,4,4,4,4,4,4,4,4,4,4,4,4,4,4,4,4,4,4,4,4,4
.long 0x12d,0x10,0x1047125,0xe,0x2060,0x2120,0x1e,0x21e0,0x22a0,4,4,4,4,4,4,4,4,4,4,4,4,4,4,4,4,4,4,4,4,4,4,4
.long 0x112d,0x32,0x846125,0x26,0x30,0x90,0xf0,0x150,0x1b0,0x210,0x270,0x2d0,0x330,0x390,0x3f0,4,4,4,4,4,4,4,4,4,4,4,4,4,4,4,4,4
.long 0x212d,0x54,0x1055125,0x1850125,0xe,0x2070,0x2130,0x1e,0x21f0,0x22b0,4,4,4,4,4,4,4,4,4,4,4,4,4,4,4,4,4,4,4,4,4,4
.long 0x312d,0x76,0x854125,0x2051125,0xe,0x2080,0x2140,0x1e,0x2200,0x22c0,4,4,4,4,4,4,4,4,4,4,4,4,4,4,4,4,4,4,4,4,4,4
.long 0x412d,0x3276,0x2043125,0x26,0x50,0xb0,0x110,0x170,0x1d0,0x230,0x290,0x2f0,0x350,0x3b0,4,4,4,4,4,4,4,4,4,4,4,4,4,4,4,4,4,4
.long 0x512d,0x1054,0x1842125,0x26,0x10,0x70,0xd0,0x130,0x190,0x1f0,0x250,0x2b0,0x310,0x370,0x3d0,4,4,4,4,4,4,4,4,4,4,4,4,4,4,4,4,4
.long 0x612d,0x76543210,0x1e,0x2320,0x2360,0x23a0,0x23e0,4,4,4,4,4,4,4,4,4,4,4,4,4,4,4,4,4,4,4,4,4,4,4,4,4
.long 0x13d,0x10,0x1047135,0xe,0x3060,0x3120,0x1e,0x31e0,0x32a0,4,4,4,4,4,4,4,4,4,4,4,4,4,4,4,4,4,4,4,4,4,4,4
.long 0x113d,0x32,0x846135,0x36,0x30,0x90,0xf0,0x150,0x1b0,0x210,0x270,0x2d0,0x330,0x390,0x3f0,4,4,4,4,4,4,4,4,4,4,4,4,4,4,4,4,4
.long 0x213d,0x54,0x1055135,0x1850135,0xe,0x3070,0x3130,0x1e,0x31f0,0x32b0,4,4,4,4,4,4,4,4,4,4,4,4,4,4,4,4,4,4,4,4,4,4
.long 0x313d,0x76,0x854135,0x2051135,0xe,0x3080,0x3140,0x1e,0x3200,0x32c0,4,4,4,4,4,4,4,4,4,4,4,4,4,4,4,4,4,4,4,4,4,4
.long 0x413d,0x3276,0x2043135,0x36,0x50,0xb0,0x110,0x170,0x1d0,0x230,0x290,0x2f0,0x350,0x3b0,4,4,4,4,4,4,4,4,4,4,4,4,4,4,4,4,4,4
.long 0x513d,0x1054,0x1842135,0x36,0x10,0x70,0xd0,0x130,0x190,0x1f0,0x250,0x2b0,0x310,0x370,0x3d0,4,4,4,4,4,4,4,4,4,4,4,4,4,4,4,4,4
.long 0x613d,0x76543210,0x1e,0x3320,0x3360,0x33a0,0x33e0,4,4,4,4,4,4,4,4,4,4,4,4,4,4,4,4,4,4,4,4,4,4,4,4,4
.long 0x14d,0x10,0x1047145,0xe,0x4060,0x4120,0x1e,0x41e0,0x42a0,4,4,4,4,4,4,4,4,4,4,4,4,4,4,4,4,4,4,4,4,4,4,4
.long 0x114d,0x32,0x846145,0x46,0x30,0x90,0xf0,0x150,0x1b0,0x210,0x270,0x2d0,0x330,0x390,0x3f0,4,4,4,4,4,4,4,4,4,4,4,4,4,4,4,4,4
.long 0x214d,0x54,0x1055145,0x1850145,0xe,0x4070,0x4130,0x1e,0x41f0,0x42b0,4,4,4,4,4,4,4,4,4,4,4,4,4,4,4,4,4,4,4,4,4,4
.long 0x314d,0x76,0x854145,0x2051145,0xe,0x4080,0x4140,0x1e,0x4200,0x42c0,4,4,4,4,4,4,4,4,4,4,4,4,4,4,4,4,4,4,4,4,4,4
.long 0x414d,0x3276,0x2043145,0x46,0x50,0xb0,0x110,0x170,0x1d0,0x230,0x290,0x2f0,0x350,0x3b0,4,4,4,4,4,4,4,4,4,4,4,4,4,4,4,4,4,4
.long 0x514d,0x1054,0x1842145,0x46,0x10,0x70,0xd0,0x130,0x190,0x1f0,0x250,0x2b0,0x310,0x370,0x3d0,4,4,4,4,4,4,4,4,4,4,4,4,4,4,4,4,4
.long 0x614d,0x76543210,0x1e,0x4320,0x4360,0x43a0,0x43e0,4,4,4,4,4,4,4,4,4,4,4,4,4,4,4,4,4,4,4,4,4,4,4,4,4
.long 0x15d,0x10,0x1047155,0xe,0x5060,0x5120,0x1e,0x51e0,0x52a0,4,4,4,4,4,4,4,4,4,4,4,4,4,4,4,4,4,4,4,4,4,4,4
.long 0x115d,0x32,0x846155,0x56,0x30,0x90,0xf0,0x150,0x1b0,0x210,0x270,0x2d0,0x330,0x390,0x3f0,4,4,4,4,4,4,4,4,4,4,4,4,4,4,4,4,4
.long 0x215d,0x54,0x1055155,0x1850155,0xe,0x5070,0x5130,0x1e,0x51f0,0x52b0,4,4,4,4,4,4,4,4,4,4,4,4,4,4,4,4,4,4,4,4,4,4
.long 0x315d,0x76,0x854155,0x2051155,0xe,0x5080,0x5140,0x1e,0x5200,0x52c0,4,4,4,4,4,4,4,4,4,4,4,4,4,4,4,4,4,4,4,4,4,4
.long 0x415d,0x3276,0x2043155,0x56,0x50,0xb0,0x110,0x170,0x1d0,0x230,0x290,0x2f0,0x350,0x3b0,4,4,4,4,4,4,4,4,4,4,4,4,4,4,4,4,4,4
.long 0x515d,0x1054,0x1842155,0x56,0x10,0x70,0xd0,0x130,0x190,0x1f0,0x250,0x2b0,0x310,0x370,0x3d0,4,4,4,4,4,4,4,4,4,4,4,4,4,4,4,4,4
.long 0x615d,0x76543210,0x1e,0x5320,0x5360,0x53a0,0x53e0,4,4,4,4,4,4,4,4,4,4,4,4,4,4,4,4,4,4,4,4,4,4,4,4,4
.long 0x16d,0x10,0x1047165,0xe,0x6060,0x6120,0x1e,0x61e0,0x62a0,4,4,4,4,4,4,4,4,4,4,4,4,4,4,4,4,4,4,4,4,4,4,4
.long 0x116d,0x32,0x846165,0x66,0x30,0x90,0xf0,0x150,0x1b0,0x210,0x270,0x2d0,0x330,0x390,0x3f0,4,4,4,4,4,4,4,4,4,4,4,4,4,4,4,4,4
.long 0x216d,0x54,0x1055165,0x1850165,0xe,0x6070,0x6130,0x1e,0x61f0,0x62b0,4,4,4,4,4,4,4,4,4,4,4,4,4,4,4,4,4,4,4,4,4,4
.long 0x316d,0x76,0x854165,0x2051165,0xe,0x6080,0x6140,0x1e,0x6200,0x62c0,4,4,4,4,4,4,4,4,4,4,4,4,4,4,4,4,4,4,4,4,4,4
.long 0x416d,0x3276,0x2043165,0x66,0x50,0xb0,0x110,0x170,0x1d0,0x230,0x290,0x2f0,0x350,0x3b0,4,4,4,4,4,4,4,4,4,4,4,4,4,4,4,4,4,4
.long 0x516d,0x1054,0x1842165,0x66,0x10,0x70,0xd0,0x130,0x190,0x1f0,0x250,0x2b0,0x310,0x370,0x3d0,4,4,4,4,4,4,4,4,4,4,4,4,4,4,4,4,4
.long 0x616d,0x76543210,0x1e,0x6320,0x6360,0x63a0,0x63e0,4,4,4,4,4,4,4,4,4,4,4,4,4,4,4,4,4,4,4,4,4,4,4,4,4
.long 0x17d,0x10,0x1047175,0xe,0x7060,0x7120,0x1e,0x71e0,0x72a0,4,4,4,4,4,4,4,4,4,4,4,4,4,4,4,4,4,4,4,4,4,4,4
.long 0x117d,0x32,0x846175,0x76,0x30,0x90,0xf0,0x150,0x1b0,0x210,0x270,0x2d0,0x330,0x390,0x3f0,4,4,4,4,4,4,4,4,4,4,4,4,4,4,4,4,4
.long 0x217d,0x54,0x1055175,0x1850175,0xe,0x7070,0x7130,0x1e,0x71f0,0x72b0,4,4,4,4,4,4,4,4,4,4,4,4,4,4,4,4,4,4,4,4,4,4
.long 0x317d,0x76,0x854175,0x2051175,0xe,0x7080,0x7140,0x1e,0x7200,0x72c0,4,4,4,4,4,4,4,4,4,4,4,4,4,4,4,4,4,4,4,4,4,4
.long 0x417d,0x3276,0x2043175,0x76,0x50,0xb0,0x110,0x170,0x1d0,0x230,0x290,0x2f0,0x350,0x3b0,4,4,4,4,4,4,4,4,4,4,4,4,4,4,4,4,4,4
.long 0x517d,0x1054,0x1842175,0x76,0x10,0x70,0xd0,0x130,0x190,0x1f0,0x250,0x2b0,0x310,0x370,0x3d0,4,4,4,4,4,4,4,4,4,4,4,4,4,4,4,4,4
.long 0x617d,0x76543210,0x1e,0x7320,0x7360,0x73a0,0x73e0,4,4,4,4,4,4,4,4,4,4,4,4,4,4,4,4,4,4,4,4,4,4,4,4,4
.long 0x18d,0x10,0x1047185,0xe,0x90,0x150,0x1e,0x210,0x2d0,4,4,4,4,4,4,4,4,4,4,4,4,4,4,4,4,4,4,4,4,4,4,4
.long 0x118d,0x32,0x846185,0x86,0x30,0x90,0xf0,0x150,0x1b0,0x210,0x270,0x2d0,0x330,0x390,0x3f0,4,4,4,4,4,4,4,4,4,4,4,4,4,4,4,4,4
.long 0x218d,0x54,0x1055185,0x1850185,0xe,0xa0,0x160,0x1e,0x220,0x2e0,4,4,4,4,4,4,4,4,4,4,4,4,4,4,4,4,4,4,4,4,4,4
.long 0x318d,0x76,0x854185,0x2051185,0xe,0xb0,0x170,0x1e,0x230,0x2f0,4,4,4,4,4,4,4,4,4,4,4,4,4,4,4,4,4,4,4,4,4,4
.long 0x418d,0x3276,0x2043185,0x86,0x50,0xb0,0x110,0x170,0x1d0,0x230,0x290,0x2f0,0x350,0x3b0,4,4,4,4,4,4,4,4,4,4,4,4,4,4,4,4,4,4
.long 0x518d,0x1054,0x1842185,0x86,0x10,0x70,0xd0,0x130,0x190,0x1f0,0x250,0x2b0,0x310,0x370,0x3d0,4,4,4,4,4,4,4,4,4,4,4,4,4,4,4,4,4
.long 0x618d,0x76543210,0x1e,0x330,0x370,0x3b0,0x3f0,4,4,4,4,4,4,4,4,4,4,4,4,4,4,4,4,4,4,4,4,4,4,4,4,4
.long 0x19d,0x10,0x1047195,0xe,0x1090,0x1150,0x1e,0x1210,0x12d0,4,4,4,4,4,4,4,4,4,4,4,4,4,4,4,4,4,4,4,4,4,4,4
.long 0x119d,0x32,0x846195,0x96,0x30,0x90,0xf0,0x150,0x1b0,0x210,0x270,0x2d0,0x330,0x390,0x3f0,4,4,4,4,4,4,4,4,4,4,4,4,4,4,4,4,4
.long 0x219d,0x54,0x1055195,0x1850195,0xe,0x10a0,0x1160,0x1e,0x1220,0x12e0,4,4,4,4,4,4,4,4,4,4,4,4,4,4,4,4,4,4,4,4,4,4
.long 0x319d,0x76,0x854195,0x2051195,0xe,0x10b0,0x1170,0x1e,0x1230,0x12f0,4,4,4,4,4,4,4,4,4,4,4,4,4,4,4,4,4,4,4,4,4,4
.long 0x419d,0x3276,0x2043195,0x96,0x50,0xb0,0x110,0x170,0x1d0,0x230,0x290,0x2f0,0x350,0x3b0,4,4,4,4,4,4,4,4,4,4,4,4,4,4,4,4,4,4
.long 0x519d,0x1054,0x1842195,0x96,0x10,0x70,0xd0,0x130,0x190,0x1f0,0x250,0x2b0,0x310,0x370,0x3d0,4,4,4,4,4,4,4,4,4,4,4,4,4,4,4,4,4
.long 0x619d,0x76543210,0x1e,0x1330,0x1370,0x13b0,0x13f0,4,4,4,4,4,4,4,4,4,4,4,4,4,4,4,4,4,4,4,4,4,4,4,4,4
.long 0x1ad,0x10,0x10471a5,0xe,0x2090,0x2150,0x1e,0x2210,0x22d0,4,4,4,4,4,4,4,4,4,4,4,4,4,4,4,4,4,4,4,4,4,4,4
.long 0x11ad,0x32,0x8461a5,0xa6,0x30,0x90,0xf0,0x150,0x1b0,0x210,0x270,0x2d0,0x330,0x390,0x3f0,4,4,4,4,4,4,4,4,4,4,4,4,4,4,4,4,4
.long 0x21ad,0x54,0x10551a5,0x18501a5,0xe,0x20a0,0x2160,0x1e,0x2220,0x22e0,4,4,4,4,4,4,4,4,4,4,4,4,4,4,4,4,4,4,4,4,4,4
.long 0x31ad,0x76,0x8541a5,0x20511a5,0xe,0x20b0,0x2170,0x1e,0x2230,0x22f0,4,4,4,4,4,4,4,4,4,4,4,4,4,4,4,4,4,4,4,4,4,4
.long 0x41ad,0x3276,0x20431a5,0xa6,0x50,0xb0,0x110,0x170,0x1d0,0x230,0x290,0x2f0,0x350,0x3b0,4,4,4,4,4,4,4,4,4,4,4,4,4,4,4,4,4,4
.long 0x51ad,0x1054,0x18421a5,0xa6,0x10,0x70,0xd0,0x130,0x190,0x1f0,0x250,0x2b0,0x310,0x370,0x3d0,4,4,4,4,4,4,4,4,4,4,4,4,4,4,4,4,4
.long 0x61ad,0x76543210,0x1e,0x2330,0x2370,0x23b0,0x23f0,4,4,4,4,4,4,4,4,4,4,4,4,4,4,4,4,4,4,4,4,4,4,4,4,4
.long 0x1bd,0x10,0x10471b5,0xe,0x3090,0x3150,0x1e,0x3210,0x32d0,4,4,4,4,4,4,4,4,4,4,4,4,4,4,4,4,4,4,4,4,4,4,4
.long 0x11bd,0x32,0x8461b5,0xb6,0x30,0x90,0xf0,0x150,0x1b0,0x210,0x270,0x2d0,0x330,0x390,0x3f0,4,4,4,4,4,4,4,4,4,4,4,4,4,4,4,4,4
.long 0x21bd,0x54,0x10551b5,0x18501b5,0xe,0x30a0,0x3160,0x1e,0x3220,0x32e0,4,4,4,4,4,4,4,4,4,4,4,4,4,4,4,4,4,4,4,4,4,4
.long 0x31bd,0x76,0x8541b5,0x20511b5,0xe,0x30b0,0x3170,0x1e,0x3230,0x32f0,4,4,4,4,4,4,4,4,4,4,4,4,4,4,4,4,4,4,4,4,4,4
.long 0x41bd,0x3276,0x20431b5,0xb6,0x50,0xb0,0x110,0x170,0x1d0,0x230,0x290,0x2f0,0x350,0x3b0,4,4,4,4,4,4,4,4,4,4,4,4,4,4,4,4,4,4
.long 0x51bd,0x1054,0x18421b5,0xb6,0x10,0x70,0xd0,0x130,0x190,0x1f0,0x250,0x2b0,0x310,0x370,0x3d0,4,4,4,4,4,4,4,4,4,4,4,4,4,4,4,4,4
.long 0x61bd,0x76543210,0x1e,0x3330,0x3370,0x33b0,0x33f0,4,4,4,4,4,4,4,4,4,4,4,4,4,4,4,4,4,4,4,4,4,4,4,4,4
.long 0x1cd,0x10,0x10471c5,0xe,0x4090,0x4150,0x1e,0x4210,0x42d0,4,4,4,4,4,4,4,4,4,4,4,4,4,4,4,4,4,4,4,4,4,4,4
.long 0x11cd,0x32,0x8461c5,0xc6,0x30,0x90,0xf0,0x150,0x1b0,0x210,0x270,0x2d0,0x330,0x390,0x3f0,4,4,4,4,4,4,4,4,4,4,4,4,4,4,4,4,4
.long 0x21cd,0x54,0x10551c5,0x18501c5,0xe,0x40a0,0x4160,0x1e,0x4220,0x42e0,4,4,4,4,4,4,4,4,4,4,4,4,4,4,4,4,4,4,4,4,4,4
.long 0x31cd,0x76,0x8541c5,0x20511c5,0xe,0x40b0,0x4170,0x1e,0x4230,0x42f0,4,4,4,4,4,4,4,4,4,4,4,4,4,4,4,4,4,4,4,4,4,4
.long 0x41cd,0x3276,0x20431c5,0xc6,0x50,0xb0,0x110,0x170,0x1d0,0x230,0x290,0x2f0,0x350,0x3b0,4,4,4,4,4,4,4,4,4,4,4,4,4,4,4,4,4,4
.long 0x51cd,0x1054,0x18421c5,0xc6,0x10,0x70,0xd0,0x130,0x190,0x1f0,0x250,0x2b0,0x310,0x370,0x3d0,4,4,4,4,4,4,4,4,4,4,4,4,4,4,4,4,4
.long 0x61cd,0x76543210,0x1e,0x4330,0x4370,0x43b0,0x43f0,4,4,4,4,4,4,4,4,4,4,4,4,4,4,4,4,4,4,4,4,4,4,4,4,4
.long 0x1dd,0x10,0x10471d5,0xe,0x5090,0x5150,0x1e,0x5210,0x52d0,4,4,4,4,4,4,4,4,4,4,4,4,4,4,4,4,4,4,4,4,4,4,4
.long 0x11dd,0x32,0x8461d5,0xd6,0x30,0x90,0xf0,0x150,0x1b0,0x210,0x270,0x2d0,0x330,0x390,0x3f0,4,4,4,4,4,4,4,4,4,4,4,4,4,4,4,4,4
.long 0x21dd,0x54,0x10551d5,0x18501d5,0xe,0x50a0,0x5160,0x1e,0x5220,0x52e0,4,4,4,4,4,4,4,4,4,4,4,4,4,4,4,4,4,4,4,4,4,4
.long 0x31dd,0x76,0x8541d5,0x20511d5,0xe,0x50b0,0x5170,0x1e,0x5230,0x52f0,4,4,4,4,4,4,4,4,4,4,4,4,4,4,4,4,4,4,4,4,4,4
.long 0x41dd,0x3276,0x20431d5,0xd6,0x50,0xb0,0x110,0x170,0x1d0,0x230,0x290,0x2f0,0x350,0x3b0,4,4,4,4,4,4,4,4,4,4,4,4,4,4,4,4,4,4
.long 0x51dd,0x1054,0x18421d5,0xd6,0x10,0x70,0xd0,0x130,0x190,0x1f0,0x250,0x2b0,0x310,0x370,0x3d0,4,4,4,4,4,4,4,4,4,4,4,4,4,4,4,4,4
.long 0x61dd,0x76543210,0x1e,0x5330,0x5370,0x53b0,0x53f0,4,4,4,4,4,4,4,4,4,4,4,4,4,4,4,4,4,4,4,4,4,4,4,4,4
.long 0x1ed,0x10,0x10471e5,0xe,0x6090,0x6150,0x1e,0x6210,0x62d0,4,4,4,4,4,4,4,4,4,4,4,4,4,4,4,4,4,4,4,4,4,4,4
.long 0x11ed,0x32,0x8461e5,0xe6,0x30,0x90,0xf0,0x150,0x1b0,0x210,0x270,0x2d0,0x330,0x390,0x3f0,4,4,4,4,4,4,4,4,4,4,4,4,4,4,4,4,4
.long 0x21ed,0x54,0x10551e5,0x18501e5,0xe,0x60a0,0x6160,0x1e,0x6220,0x62e0,4,4,4,4,4,4,4,4,4,4,4,4,4,4,4,4,4,4,4,4,4,4
.long 0x31ed,0x76,0x8541e5,0x20511e5,0xe,0x60b0,0x6170,0x1e,0x6230,0x62f0,4,4,4,4,4,4,4,4,4,4,4,4,4,4,4,4,4,4,4,4,4,4
.long 0x41ed,0x3276,0x20431e5,0xe6,0x50,0xb0,0x110,0x170,0x1d0,0x230,0x290,0x2f0,0x350,0x3b0,4,4,4,4,4,4,4,4,4,4,4,4,4,4,4,4,4,4
.long 0x51ed,0x1054,0x18421e5,0xe6,0x10,0x70,0xd0,0x130,0x190,0x1f0,0x250,0x2b0,0x310,0x370,0x3d0,4,4,4,4,4,4,4,4,4,4,4,4,4,4,4,4,4
.long 0x61ed,0x76543210,0x1e,0x6330,0x6370,0x63b0,0x63f0,4,4,4,4,4,4,4,4,4,4,4,4,4,4,4,4,4,4,4,4,4,4,4,4,4
.long 0x1fd,0x10,0x10471f5,0xe,0x7090,0x7150,0x1e,0x7210,0x72d0,4,4,4,4,4,4,4,4,4,4,4,4,4,4,4,4,4,4,4,4,4,4,4
.long 0x11fd,0x32,0x8461f5,0xf6,0x30,0x90,0xf0,0x150,0x1b0,0x210,0x270,0x2d0,0x330,0x390,0x3f0,4,4,4,4,4,4,4,4,4,4,4,4,4,4,4,4,4
.long 0x21fd,0x54,0x10551f5,0x18501f5,0xe,0x70a0,0x7160,0x1e,0x7220,0x72e0,4,4,4,4,4,4,4,4,4,4,4,4,4,4,4,4,4,4,4,4,4,4
.long 0x31fd,0x76,0x8541f5,0x20511f5,0xe,0x70b0,0x7170,0x1e,0x7230,0x72f0,4,4,4,4,4,4,4,4,4,4,4,4,4,4,4,4,4,4,4,4,4,4
.long 0x41fd,0x3276,0x20431f5,0xf6,0x50,0xb0,0x110,0x170,0x1d0,0x230,0x290,0x2f0,0x350,0x3b0,4,4,4,4,4,4,4,4,4,4,4,4,4,4,4,4,4,4
.long 0x51fd,0x1054,0x18421f5,0xf6,0x10,0x70,0xd0,0x130,0x190,0x1f0,0x250,0x2b0,0x310,0x370,0x3d0,4,4,4,4,4,4,4,4,4,4,4,4,4,4,4,4,4
.long 0x61fd,0x76543210,0x1e,0x7330,0x7370,0x73b0,0x73f0,4,4,4,4,4,4,4,4,4,4,4,4,4,4,4,4,4,4,4,4,4,4,4,4,4
.section .rodata,"a"
.p2align 6
.amdhsa_kernel gated_mix__compressed_kv_cla__memory_aug_recurrent_mem_tr__prompt_kernel
  .amdhsa_next_free_vgpr 512
  .amdhsa_next_free_sgpr 102
  .amdhsa_accum_offset 256
  .amdhsa_group_segment_fixed_size 0
  .amdhsa_kernarg_size 136
  .amdhsa_user_sgpr_count 2
  .amdhsa_user_sgpr_kernarg_segment_ptr 1
  .amdhsa_system_sgpr_workgroup_id_x 1
  .amdhsa_float_denorm_mode_32 3
.end_amdhsa_kernel
```

```asm
; @launch grid=(256,1,1) block=(256,1,1) lds=163840
.amdgcn_target "amdgcn-amd-amdhsa--gfx950"
.text
.globl gated_mix__compressed_kv_cla__memory_aug_recurrent_mem_tr__prompt_kernel
.p2align 8
.type gated_mix__compressed_kv_cla__memory_aug_recurrent_mem_tr__prompt_kernel,@function
gated_mix__compressed_kv_cla__memory_aug_recurrent_mem_tr__prompt_kernel:
  s_cmp_ge_u32 s2, 256
  s_cbranch_scc1 L_exit
  s_load_dwordx16 s[8:23], s[0:1], 0
  s_load_dwordx16 s[24:39], s[0:1], 64
  s_load_dwordx2 s[40:41], s[0:1], 128
  s_and_b32 s47, s2, 7
  s_lshr_b32 s45, s2, 3
  s_max_u32 s3, s47, 1
  s_sub_u32 s3, s3, 1
  s_lshl_b32 s3, s3, 5
  s_add_u32 s94, s3, s45
  s_getpc_b64 s[4:5]
L_pc0:
  s_add_u32 s4, s4, L_ptab-L_pc0
  s_addc_u32 s5, s5, 0
  s_lshl_b32 s3, s94, 7
  v_and_b32 v2, 31, v0
  v_lshl_add_u32 v2, v2, 2, s3
  global_load_dword v1, v2, s[4:5]
  s_getreg_b32 s46, hwreg(HW_REG_XCC_ID, 0, 4)
  v_lshrrev_b32 v3, 6, v0
  v_and_b32 v0, 63, v0
  v_readfirstlane_b32 s44, v3
  s_sub_u32 s4, s4, L_ptab-L_pc0
  s_subb_u32 s5, s5, 0
  s_and_b32 s3, s45, 15
  s_lshl_b32 s3, s3, 13
  v_lshl_add_u32 v2, v0, 7, s3
  v_min_u32 v2, L_ptab-L_pc0, v2
  s_cmp_lg_u32 s44, 3
  s_cbranch_scc1 L_nocodepf
  global_load_dword v31, v2, s[4:5]
L_nocodepf:
  s_and_b32 s46, s46, 7
  s_waitcnt lgkmcnt(0)
  s_add_u32 s40, s40, 0x0
  s_addc_u32 s41, s41, 0
  s_and_b32 s41, s41, 0xffff
  s_mov_b32 s42, 0x10000000
  s_mov_b32 s43, 0x20000
  s_cmp_eq_u32 s47, 0
  s_cbranch_scc1 L_team
  s_lshl2_add_u32 s3, s94, s44
  v_lshlrev_b32 v2, 7, v0
  s_mov_b32 s95, 0
  s_mov_b32 s50, 0x200000
  s_mov_b32 s51, 0x20000
  s_waitcnt vmcnt(0)
L_next:
  v_readlane_b32 s3, v1, s95
  s_add_u32 s95, s95, 1
  s_nop 0
  s_and_b32 s4, s3, 3
  s_cmp_eq_u32 s4, 0
  s_cbranch_scc1 L_after_p
  s_cmp_eq_u32 s4, 2
  s_cbranch_scc1 L_go_outx
L_go_att:
  s_bfe_u32 s56, s3, 0x50004
  s_bfe_u32 s57, s3, 0x3000c
  s_bitcmp1_b32 s3, 3
  s_cbranch_scc1 L_feed
L_att:
  v_lshlrev_b32 v2, 4, v0
  s_lshl_b32 s65, s44, 11
  v_add_u32 v3, s65, v2
  s_mov_b32 s74, 0
  v_and_b32 v6, 7, v0
  s_lshl3_add_u32 s67, s57, 8
  v_lshlrev_b32 v7, 4, v6
  v_sub_u32 v7, s67, v7
  v_med3_i32 v7, v7, 0, 16
  s_lshl_b32 s66, s56, 7
  s_add_u32 s66, s66, 0xd080000
  v_lshl_add_u32 v6, v6, 2, s66
  s_bfe_u32 m0, s3, 0x30010
  s_bfe_u32 s67, s3, 0x60014
  s_nop 0
  v_writelane_b32 v7, s67, m0
  s_lshl_b32 s66, s57, 7
  s_add_u32 s66, s66, 0xd086400
  v_writelane_b32 v6, s66, 63
  v_writelane_b32 v7, 16, 63
  buffer_load_dword v24, v6, s[40:43], 0 offen sc1
  v_mov_b64 v[128:129], 0
  v_mov_b64 v[130:131], 0
  v_mov_b64 v[132:133], 0
  v_mov_b64 v[134:135], 0
  v_mov_b64 v[136:137], 0
  v_mov_b64 v[138:139], 0
  v_mov_b64 v[140:141], 0
  v_mov_b64 v[142:143], 0
  v_mov_b64 v[144:145], 0
  v_mov_b64 v[146:147], 0
  v_mov_b64 v[148:149], 0
  v_mov_b64 v[150:151], 0
  v_mov_b64 v[152:153], 0
  v_mov_b64 v[154:155], 0
  v_mov_b64 v[156:157], 0
  v_mov_b64 v[158:159], 0
  v_mov_b64 v[160:161], 0
  v_mov_b64 v[162:163], 0
  v_mov_b64 v[164:165], 0
  v_mov_b64 v[166:167], 0
  v_mov_b64 v[168:169], 0
  v_mov_b64 v[170:171], 0
  v_mov_b64 v[172:173], 0
  v_mov_b64 v[174:175], 0
  v_mov_b64 v[176:177], 0
  v_mov_b64 v[178:179], 0
  v_mov_b64 v[180:181], 0
  v_mov_b64 v[182:183], 0
  v_mov_b64 v[184:185], 0
  v_mov_b64 v[186:187], 0
  v_mov_b64 v[188:189], 0
  v_mov_b64 v[190:191], 0
  v_mov_b64 v[192:193], 0
  v_mov_b64 v[194:195], 0
  v_mov_b64 v[196:197], 0
  v_mov_b64 v[198:199], 0
  v_mov_b64 v[200:201], 0
  v_mov_b64 v[202:203], 0
  v_mov_b64 v[204:205], 0
  v_mov_b64 v[206:207], 0
  v_mov_b64 v[208:209], 0
  v_mov_b64 v[210:211], 0
  v_mov_b64 v[212:213], 0
  v_mov_b64 v[214:215], 0
  v_mov_b64 v[216:217], 0
  v_mov_b64 v[218:219], 0
  v_mov_b64 v[220:221], 0
  v_mov_b64 v[222:223], 0
  v_mov_b64 v[224:225], 0
  v_mov_b64 v[226:227], 0
  v_mov_b64 v[228:229], 0
  v_mov_b64 v[230:231], 0
  v_mov_b64 v[232:233], 0
  v_mov_b64 v[234:235], 0
  v_mov_b64 v[236:237], 0
  v_mov_b64 v[238:239], 0
  v_mov_b64 v[240:241], 0
  v_mov_b64 v[242:243], 0
  v_mov_b64 v[244:245], 0
  v_mov_b64 v[246:247], 0
  v_mov_b64 v[248:249], 0
  v_mov_b64 v[250:251], 0
  v_mov_b64 v[252:253], 0
  v_mov_b64 v[254:255], 0
  v_mov_b64 v[96:97], 0
  v_accvgpr_write_b32 a128, 0
  v_mov_b64 v[98:99], 0
  v_accvgpr_write_b32 a129, 0
  v_mov_b64 v[100:101], 0
  v_accvgpr_write_b32 a130, 0
  v_mov_b64 v[102:103], 0
  v_accvgpr_write_b32 a131, 0
  v_mov_b64 v[104:105], 0
  v_accvgpr_write_b32 a132, 0
  v_mov_b64 v[106:107], 0
  v_accvgpr_write_b32 a133, 0
  v_mov_b64 v[108:109], 0
  v_accvgpr_write_b32 a134, 0
  v_mov_b64 v[110:111], 0
  v_accvgpr_write_b32 a135, 0
  v_mov_b64 v[112:113], 0
  v_accvgpr_write_b32 a136, 0
  v_mov_b64 v[114:115], 0
  v_accvgpr_write_b32 a137, 0
  v_mov_b64 v[116:117], 0
  v_accvgpr_write_b32 a138, 0
  v_mov_b64 v[118:119], 0
  v_accvgpr_write_b32 a139, 0
  v_mov_b64 v[120:121], 0
  v_accvgpr_write_b32 a140, 0
  v_mov_b64 v[122:123], 0
  v_accvgpr_write_b32 a141, 0
  v_mov_b64 v[124:125], 0
  v_accvgpr_write_b32 a142, 0
  v_mov_b64 v[126:127], 0
  v_accvgpr_write_b32 a143, 0
  v_mov_b32 v16, 0x3f803f80
  v_mov_b32 v17, 0x3f803f80
  v_mov_b32 v18, 0x3f803f80
  v_mov_b32 v19, 0x3f803f80
  s_mov_b32 s48, s18
  s_and_b32 s49, s19, 0xffff
  s_mov_b32 s50, 0x400000
  s_mov_b32 s51, 0x20000
  s_lshl_b32 s66, s56, 19
  s_add_u32 s60, s66, 0x1000000
  s_add_u32 s61, s66, 0x2000000
  s_lshl_b32 s59, s57, 3
  s_lshr_b32 s67, s44, 1
  s_add_u32 s67, s67, s59
  s_lshl_b32 s68, s67, 13
  s_add_u32 s68, s68, s66
  s_and_b32 s67, s44, 1
  s_lshl_b32 s67, s67, 10
  s_add_u32 s68, s68, s67
  s_lshl4_add_u32 s69, s57, s44
  s_add_u32 s63, s59, 7
  s_lshl_b32 s63, s63, 13
  s_add_u32 s63, s63, s60
  s_sub_u32 s59, s59, 1
  s_add_u32 s62, s60, 0x4000
  s_mov_b32 s64, 0
  s_mov_b32 s70, 0x40004000
  s_lshl_b32 s73, s44, 12
  s_lshl_b32 s72, s56, 17
  s_lshl_b32 s67, s44, 15
  s_add_u32 s72, s72, s67
  v_lshrrev_b32 v8, 4, v0
  v_and_b32 v9, 15, v0
  s_lshl_b32 s67, s44, 4
  v_add_u32 v25, s67, v9
  v_lshlrev_b32 v10, 2, v8
  v_sub_u32 v25, v25, v10
  v_lshlrev_b32 v8, 1, v8
  v_and_b32 v10, 7, v0
  v_xor_b32 v8, v8, v10
  v_lshlrev_b32 v8, 4, v8
  v_lshrrev_b32 v10, 3, v0
  v_lshl_add_u32 v26, v10, 10, v8
  v_lshlrev_b32 v9, 2, v9
  v_add_u32 v4, 122880, v2
L_a_wait:
  s_waitcnt vmcnt(0)
  v_cmp_gt_u32 vcc, v7, v24
  s_cbranch_vccz L_a_go
  s_sleep 4
  buffer_load_dword v24, v6, s[40:43], 0 offen sc1
  s_add_u32 s74, s74, 1
  s_cmp_gt_u32 s74, 1048576
  s_cbranch_scc1 L_exit
  s_branch L_a_wait
L_a_go:
  s_add_u32 m0, s65, 131072
  s_add_u32 s66, s60, 0x2000
  buffer_load_dwordx4 v3, s[40:43], s60 offen sc1 lds
  buffer_load_dwordx4 v3, s[40:43], s60 offen offset:1024 sc1 lds
  s_add_u32 m0, s65, 139264
  s_lshl_b32 s67, s69, 6
  buffer_load_dwordx4 v3, s[40:43], s66 offen sc1 lds
  buffer_load_dwordx4 v3, s[40:43], s66 offen offset:1024 sc1 lds
  s_add_u32 s67, s67, 0xd0c0000
  s_add_u32 s58, s68, 0x1000
  buffer_load_dwordx4 a[0:3], v2, s[40:43], s68 offen offset:0 sc1
  buffer_load_dwordx4 a[4:7], v2, s[40:43], s68 offen offset:2048 sc1
  buffer_load_dwordx4 a[8:11], v2, s[40:43], s58 offen offset:0 sc1
  buffer_load_dwordx4 a[12:15], v2, s[40:43], s58 offen offset:2048 sc1
  s_add_u32 s68, s68, 0x4000
  s_add_u32 s58, s68, 0x1000
  buffer_load_dwordx4 a[16:19], v2, s[40:43], s68 offen offset:0 sc1
  buffer_load_dwordx4 a[20:23], v2, s[40:43], s68 offen offset:2048 sc1
  buffer_load_dwordx4 a[24:27], v2, s[40:43], s58 offen offset:0 sc1
  buffer_load_dwordx4 a[28:31], v2, s[40:43], s58 offen offset:2048 sc1
  s_add_u32 s68, s68, 0x4000
  s_add_u32 s58, s68, 0x1000
  buffer_load_dwordx4 a[32:35], v2, s[40:43], s68 offen offset:0 sc1
  buffer_load_dwordx4 a[36:39], v2, s[40:43], s68 offen offset:2048 sc1
  buffer_load_dwordx4 a[40:43], v2, s[40:43], s58 offen offset:0 sc1
  buffer_load_dwordx4 a[44:47], v2, s[40:43], s58 offen offset:2048 sc1
  s_add_u32 s68, s68, 0x4000
  s_add_u32 s58, s68, 0x1000
  buffer_load_dwordx4 a[48:51], v2, s[40:43], s68 offen offset:0 sc1
  buffer_load_dwordx4 a[52:55], v2, s[40:43], s68 offen offset:2048 sc1
  buffer_load_dwordx4 a[56:59], v2, s[40:43], s58 offen offset:0 sc1
  buffer_load_dwordx4 a[60:63], v2, s[40:43], s58 offen offset:2048 sc1
  s_add_u32 s68, s68, 0x4000
  buffer_load_dword v20, v9, s[40:43], s67 offen offset:0 sc1
  buffer_load_dword v21, v9, s[40:43], s67 offen offset:256 sc1
  buffer_load_dword v22, v9, s[40:43], s67 offen offset:512 sc1
  buffer_load_dword v23, v9, s[40:43], s67 offen offset:768 sc1
  s_add_u32 m0, s64, s65
  s_nop 0
  buffer_load_dwordx4 v3, s[40:43], s61 offen sc1 lds
  s_min_u32 s66, s62, s63
  s_nop 0
  buffer_load_dwordx4 v3, s[40:43], s61 offen offset:1024 sc1 lds
  s_add_u32 m0, m0, 0x2000
  s_nop 0
  buffer_load_dwordx4 v3, s[40:43], s66 offen sc1 lds
  s_add_u32 s61, s61, 0x2000
  s_nop 0
  buffer_load_dwordx4 v3, s[40:43], s66 offen offset:1024 sc1 lds
  s_add_u32 s62, s62, 0x2000
  s_add_u32 s64, s64, 0x4000
  s_and_b32 s64, s64, 0x1ffff
  s_add_u32 m0, s64, s65
  s_nop 0
  buffer_load_dwordx4 v3, s[40:43], s61 offen sc1 lds
  s_min_u32 s66, s62, s63
  s_nop 0
  buffer_load_dwordx4 v3, s[40:43], s61 offen offset:1024 sc1 lds
  s_add_u32 m0, m0, 0x2000
  s_nop 0
  buffer_load_dwordx4 v3, s[40:43], s66 offen sc1 lds
  s_add_u32 s61, s61, 0x2000
  s_nop 0
  buffer_load_dwordx4 v3, s[40:43], s66 offen offset:1024 sc1 lds
  s_add_u32 s62, s62, 0x2000
  s_add_u32 s64, s64, 0x4000
  s_and_b32 s64, s64, 0x1ffff
  s_mul_i32 s69, s69, 786432
  s_lshl_b32 s67, s56, 14
  s_add_u32 s69, s69, s67
  s_add_u32 s76, s69, 0x6000000
  s_add_u32 s77, s69, 0x6300000
  s_add_u32 s78, s69, 0x6600000
  s_add_u32 s79, s69, 0x6900000
  v_mov_b32 v24, 0xff800000
  s_cmp_lg_u32 s57, 0
  s_cbranch_scc1 L_a_nomask0
  v_cmp_gt_i32 s[80:81], 0, v25
  v_cmp_gt_i32 s[82:83], 1, v25
  v_cmp_gt_i32 s[84:85], 2, v25
  v_cmp_gt_i32 s[86:87], 3, v25
  v_cndmask_b32 v96, v96, v24, s[80:81]
  v_cndmask_b32 v97, v97, v24, s[82:83]
  v_cndmask_b32 v98, v98, v24, s[84:85]
  v_cndmask_b32 v99, v99, v24, s[86:87]
  v_cmp_gt_i32 s[80:81], 16, v25
  v_cmp_gt_i32 s[82:83], 17, v25
  v_cmp_gt_i32 s[84:85], 18, v25
  v_cmp_gt_i32 s[86:87], 19, v25
  v_cndmask_b32 v100, v100, v24, s[80:81]
  v_cndmask_b32 v101, v101, v24, s[82:83]
  v_cndmask_b32 v102, v102, v24, s[84:85]
  v_cndmask_b32 v103, v103, v24, s[86:87]
L_a_nomask0:
  s_waitcnt vmcnt(28)
  s_barrier
  ds_read_b128 a[64:67], v4 offset:8192
  ds_read_b128 a[68:71], v4 offset:9216
  ds_read_b128 a[72:75], v4 offset:10240
  ds_read_b128 a[76:79], v4 offset:11264
  ds_read_b128 a[80:83], v4 offset:12288
  ds_read_b128 a[84:87], v4 offset:13312
  ds_read_b128 a[88:91], v4 offset:14336
  ds_read_b128 a[92:95], v4 offset:15360
  v_add_u32 v4, 0x2000, v4
  s_waitcnt vmcnt(24) lgkmcnt(0)
  v_mfma_f32_16x16x32_bf16 v[32:35], a[64:67], a[0:3], v[96:99]
  v_mfma_f32_16x16x32_bf16 v[32:35], a[72:75], a[4:7], v[32:35]
  v_mfma_f32_16x16x32_bf16 v[32:35], a[80:83], a[8:11], v[32:35]
  v_mfma_f32_16x16x32_bf16 v[32:35], a[88:91], a[12:15], v[32:35]
  v_mfma_f32_16x16x32_bf16 v[36:39], a[68:71], a[0:3], v[100:103]
  v_mfma_f32_16x16x32_bf16 v[36:39], a[76:79], a[4:7], v[36:39]
  v_mfma_f32_16x16x32_bf16 v[36:39], a[84:87], a[8:11], v[36:39]
  v_mfma_f32_16x16x32_bf16 v[36:39], a[92:95], a[12:15], v[36:39]
  s_waitcnt vmcnt(20) lgkmcnt(0)
  v_mfma_f32_16x16x32_bf16 v[40:43], a[64:67], a[16:19], v[104:107]
  v_mfma_f32_16x16x32_bf16 v[40:43], a[72:75], a[20:23], v[40:43]
  v_mfma_f32_16x16x32_bf16 v[40:43], a[80:83], a[24:27], v[40:43]
  v_mfma_f32_16x16x32_bf16 v[40:43], a[88:91], a[28:31], v[40:43]
  v_mfma_f32_16x16x32_bf16 v[44:47], a[68:71], a[16:19], v[108:111]
  v_mfma_f32_16x16x32_bf16 v[44:47], a[76:79], a[20:23], v[44:47]
  v_mfma_f32_16x16x32_bf16 v[44:47], a[84:87], a[24:27], v[44:47]
  v_mfma_f32_16x16x32_bf16 v[44:47], a[92:95], a[28:31], v[44:47]
  s_waitcnt vmcnt(16) lgkmcnt(0)
  v_mfma_f32_16x16x32_bf16 v[48:51], a[64:67], a[32:35], v[112:115]
  v_mfma_f32_16x16x32_bf16 v[48:51], a[72:75], a[36:39], v[48:51]
  v_mfma_f32_16x16x32_bf16 v[48:51], a[80:83], a[40:43], v[48:51]
  v_mfma_f32_16x16x32_bf16 v[48:51], a[88:91], a[44:47], v[48:51]
  v_mfma_f32_16x16x32_bf16 v[52:55], a[68:71], a[32:35], v[116:119]
  v_mfma_f32_16x16x32_bf16 v[52:55], a[76:79], a[36:39], v[52:55]
  v_mfma_f32_16x16x32_bf16 v[52:55], a[84:87], a[40:43], v[52:55]
  v_mfma_f32_16x16x32_bf16 v[52:55], a[92:95], a[44:47], v[52:55]
  s_waitcnt vmcnt(12) lgkmcnt(0)
  v_mfma_f32_16x16x32_bf16 v[56:59], a[64:67], a[48:51], v[120:123]
  v_mfma_f32_16x16x32_bf16 v[56:59], a[72:75], a[52:55], v[56:59]
  v_mfma_f32_16x16x32_bf16 v[56:59], a[80:83], a[56:59], v[56:59]
  v_mfma_f32_16x16x32_bf16 v[56:59], a[88:91], a[60:63], v[56:59]
  v_mfma_f32_16x16x32_bf16 v[60:63], a[68:71], a[48:51], v[124:127]
  v_mfma_f32_16x16x32_bf16 v[60:63], a[76:79], a[52:55], v[60:63]
  v_mfma_f32_16x16x32_bf16 v[60:63], a[84:87], a[56:59], v[60:63]
  v_mfma_f32_16x16x32_bf16 v[60:63], a[92:95], a[60:63], v[60:63]
  ds_read_b128 a[64:67], v4 offset:8192
  ds_read_b128 a[68:71], v4 offset:9216
  ds_read_b128 a[72:75], v4 offset:10240
  ds_read_b128 a[76:79], v4 offset:11264
  ds_read_b128 a[80:83], v4 offset:12288
  ds_read_b128 a[84:87], v4 offset:13312
  ds_read_b128 a[88:91], v4 offset:14336
  ds_read_b128 a[92:95], v4 offset:15360
  v_mov_b32 v4, v2
  s_add_u32 m0, s64, s65
  s_nop 0
  buffer_load_dwordx4 v3, s[40:43], s61 offen sc1 lds
  s_min_u32 s66, s62, s63
  s_nop 0
  buffer_load_dwordx4 v3, s[40:43], s61 offen offset:1024 sc1 lds
  s_add_u32 m0, m0, 0x2000
  s_nop 0
  buffer_load_dwordx4 v3, s[40:43], s66 offen sc1 lds
  s_add_u32 s61, s61, 0x2000
  s_nop 0
  buffer_load_dwordx4 v3, s[40:43], s66 offen offset:1024 sc1 lds
  s_add_u32 s62, s62, 0x2000
  s_add_u32 s64, s64, 0x4000
  s_and_b32 s64, s64, 0x1ffff
  v_max3_f32 v6, v32, v33, v34
  v_max3_f32 v7, v35, v36, v37
  v_max3_f32 v6, v6, v38, v39
  v_max_f32 v6, v6, v7
  v_mov_b32 v7, v6
  s_nop 1
  v_permlane32_swap_b32 v7, v6
  v_max_f32 v6, v6, v7
  v_mov_b32 v7, v6
  s_nop 1
  v_permlane16_swap_b32 v7, v6
  v_max_f32 v6, v6, v7
  v_add_f32 v6, 0x41800000, v6
  v_sub_f32 v96, v96, v6
  v_sub_f32 v97, v97, v6
  v_sub_f32 v98, v98, v6
  v_sub_f32 v99, v99, v6
  v_sub_f32 v100, v100, v6
  v_sub_f32 v101, v101, v6
  v_sub_f32 v102, v102, v6
  v_sub_f32 v103, v103, v6
  v_sub_f32 v8, v32, v6
  v_sub_f32 v9, v33, v6
  v_sub_f32 v10, v34, v6
  v_sub_f32 v11, v35, v6
  v_sub_f32 v12, v36, v6
  v_sub_f32 v13, v37, v6
  v_sub_f32 v14, v38, v6
  v_sub_f32 v15, v39, v6
  v_exp_f32 v8, v8
  v_exp_f32 v9, v9
  v_exp_f32 v10, v10
  v_exp_f32 v11, v11
  v_exp_f32 v12, v12
  v_exp_f32 v13, v13
  v_exp_f32 v14, v14
  v_exp_f32 v15, v15
  v_cvt_pk_bf16_f32 v64, v8, v9
  v_cvt_pk_bf16_f32 v65, v10, v11
  v_cvt_pk_bf16_f32 v66, v12, v13
  v_cvt_pk_bf16_f32 v67, v14, v15
  s_add_u32 m0, s64, s65
  s_nop 0
  buffer_load_dwordx4 v3, s[40:43], s61 offen sc1 lds
  s_min_u32 s66, s62, s63
  s_nop 0
  buffer_load_dwordx4 v3, s[40:43], s61 offen offset:1024 sc1 lds
  s_add_u32 m0, m0, 0x2000
  s_nop 0
  buffer_load_dwordx4 v3, s[40:43], s66 offen sc1 lds
  s_add_u32 s61, s61, 0x2000
  s_nop 0
  buffer_load_dwordx4 v3, s[40:43], s66 offen offset:1024 sc1 lds
  s_add_u32 s62, s62, 0x2000
  s_add_u32 s64, s64, 0x4000
  s_and_b32 s64, s64, 0x1ffff
  v_max3_f32 v6, v40, v41, v42
  v_max3_f32 v7, v43, v44, v45
  v_max3_f32 v6, v6, v46, v47
  v_max_f32 v6, v6, v7
  v_mov_b32 v7, v6
  s_nop 1
  v_permlane32_swap_b32 v7, v6
  v_max_f32 v6, v6, v7
  v_mov_b32 v7, v6
  s_nop 1
  v_permlane16_swap_b32 v7, v6
  v_max_f32 v6, v6, v7
  v_add_f32 v6, 0x41800000, v6
  v_sub_f32 v104, v104, v6
  v_sub_f32 v105, v105, v6
  v_sub_f32 v106, v106, v6
  v_sub_f32 v107, v107, v6
  v_sub_f32 v108, v108, v6
  v_sub_f32 v109, v109, v6
  v_sub_f32 v110, v110, v6
  v_sub_f32 v111, v111, v6
  v_sub_f32 v8, v40, v6
  v_sub_f32 v9, v41, v6
  v_sub_f32 v10, v42, v6
  v_sub_f32 v11, v43, v6
  v_sub_f32 v12, v44, v6
  v_sub_f32 v13, v45, v6
  v_sub_f32 v14, v46, v6
  v_sub_f32 v15, v47, v6
  v_exp_f32 v8, v8
  v_exp_f32 v9, v9
  v_exp_f32 v10, v10
  v_exp_f32 v11, v11
  v_exp_f32 v12, v12
  v_exp_f32 v13, v13
  v_exp_f32 v14, v14
  v_exp_f32 v15, v15
  v_cvt_pk_bf16_f32 v68, v8, v9
  v_cvt_pk_bf16_f32 v69, v10, v11
  v_cvt_pk_bf16_f32 v70, v12, v13
  v_cvt_pk_bf16_f32 v71, v14, v15
  s_add_u32 m0, s64, s65
  s_nop 0
  buffer_load_dwordx4 v3, s[40:43], s61 offen sc1 lds
  s_min_u32 s66, s62, s63
  s_nop 0
  buffer_load_dwordx4 v3, s[40:43], s61 offen offset:1024 sc1 lds
  s_add_u32 m0, m0, 0x2000
  s_nop 0
  buffer_load_dwordx4 v3, s[40:43], s66 offen sc1 lds
  s_add_u32 s61, s61, 0x2000
  s_nop 0
  buffer_load_dwordx4 v3, s[40:43], s66 offen offset:1024 sc1 lds
  s_add_u32 s62, s62, 0x2000
  s_add_u32 s64, s64, 0x4000
  s_and_b32 s64, s64, 0x1ffff
  v_max3_f32 v6, v48, v49, v50
  v_max3_f32 v7, v51, v52, v53
  v_max3_f32 v6, v6, v54, v55
  v_max_f32 v6, v6, v7
  v_mov_b32 v7, v6
  s_nop 1
  v_permlane32_swap_b32 v7, v6
  v_max_f32 v6, v6, v7
  v_mov_b32 v7, v6
  s_nop 1
  v_permlane16_swap_b32 v7, v6
  v_max_f32 v6, v6, v7
  v_add_f32 v6, 0x41800000, v6
  v_sub_f32 v112, v112, v6
  v_sub_f32 v113, v113, v6
  v_sub_f32 v114, v114, v6
  v_sub_f32 v115, v115, v6
  v_sub_f32 v116, v116, v6
  v_sub_f32 v117, v117, v6
  v_sub_f32 v118, v118, v6
  v_sub_f32 v119, v119, v6
  v_sub_f32 v8, v48, v6
  v_sub_f32 v9, v49, v6
  v_sub_f32 v10, v50, v6
  v_sub_f32 v11, v51, v6
  v_sub_f32 v12, v52, v6
  v_sub_f32 v13, v53, v6
  v_sub_f32 v14, v54, v6
  v_sub_f32 v15, v55, v6
  v_exp_f32 v8, v8
  v_exp_f32 v9, v9
  v_exp_f32 v10, v10
  v_exp_f32 v11, v11
  v_exp_f32 v12, v12
  v_exp_f32 v13, v13
  v_exp_f32 v14, v14
  v_exp_f32 v15, v15
  v_cvt_pk_bf16_f32 v72, v8, v9
  v_cvt_pk_bf16_f32 v73, v10, v11
  v_cvt_pk_bf16_f32 v74, v12, v13
  v_cvt_pk_bf16_f32 v75, v14, v15
  s_add_u32 m0, s64, s65
  s_nop 0
  buffer_load_dwordx4 v3, s[40:43], s61 offen sc1 lds
  s_min_u32 s66, s62, s63
  s_nop 0
  buffer_load_dwordx4 v3, s[40:43], s61 offen offset:1024 sc1 lds
  s_add_u32 m0, m0, 0x2000
  s_nop 0
  buffer_load_dwordx4 v3, s[40:43], s66 offen sc1 lds
  s_add_u32 s61, s61, 0x2000
  s_nop 0
  buffer_load_dwordx4 v3, s[40:43], s66 offen offset:1024 sc1 lds
  s_add_u32 s62, s62, 0x2000
  s_add_u32 s64, s64, 0x4000
  s_and_b32 s64, s64, 0x1ffff
  v_max3_f32 v6, v56, v57, v58
  v_max3_f32 v7, v59, v60, v61
  v_max3_f32 v6, v6, v62, v63
  v_max_f32 v6, v6, v7
  v_mov_b32 v7, v6
  s_nop 1
  v_permlane32_swap_b32 v7, v6
  v_max_f32 v6, v6, v7
  v_mov_b32 v7, v6
  s_nop 1
  v_permlane16_swap_b32 v7, v6
  v_max_f32 v6, v6, v7
  v_add_f32 v6, 0x41800000, v6
  v_sub_f32 v120, v120, v6
  v_sub_f32 v121, v121, v6
  v_sub_f32 v122, v122, v6
  v_sub_f32 v123, v123, v6
  v_sub_f32 v124, v124, v6
  v_sub_f32 v125, v125, v6
  v_sub_f32 v126, v126, v6
  v_sub_f32 v127, v127, v6
  v_sub_f32 v8, v56, v6
  v_sub_f32 v9, v57, v6
  v_sub_f32 v10, v58, v6
  v_sub_f32 v11, v59, v6
  v_sub_f32 v12, v60, v6
  v_sub_f32 v13, v61, v6
  v_sub_f32 v14, v62, v6
  v_sub_f32 v15, v63, v6
  v_exp_f32 v8, v8
  v_exp_f32 v9, v9
  v_exp_f32 v10, v10
  v_exp_f32 v11, v11
  v_exp_f32 v12, v12
  v_exp_f32 v13, v13
  v_exp_f32 v14, v14
  v_exp_f32 v15, v15
  v_cvt_pk_bf16_f32 v76, v8, v9
  v_cvt_pk_bf16_f32 v77, v10, v11
  v_cvt_pk_bf16_f32 v78, v12, v13
  v_cvt_pk_bf16_f32 v79, v14, v15
  s_add_u32 m0, s64, s65
  s_nop 0
  buffer_load_dwordx4 v3, s[40:43], s61 offen sc1 lds
  s_min_u32 s66, s62, s63
  s_nop 0
  buffer_load_dwordx4 v3, s[40:43], s61 offen offset:1024 sc1 lds
  s_add_u32 m0, m0, 0x2000
  s_nop 0
  buffer_load_dwordx4 v3, s[40:43], s66 offen sc1 lds
  s_add_u32 s61, s61, 0x2000
  s_nop 0
  buffer_load_dwordx4 v3, s[40:43], s66 offen offset:1024 sc1 lds
  s_add_u32 s62, s62, 0x2000
  s_add_u32 s64, s64, 0x4000
  s_and_b32 s64, s64, 0x1ffff
  s_mov_b32 s58, 0
  s_cmp_lg_u32 s57, 0
  s_cbranch_scc1 L_a_s0
  v_cmp_gt_i32 s[80:81], 32, v25
  v_cmp_gt_i32 s[82:83], 33, v25
  v_cmp_gt_i32 s[84:85], 34, v25
  v_cmp_gt_i32 s[86:87], 35, v25
  v_cndmask_b32 v96, v96, v24, s[80:81]
  v_cndmask_b32 v97, v97, v24, s[82:83]
  v_cndmask_b32 v98, v98, v24, s[84:85]
  v_cndmask_b32 v99, v99, v24, s[86:87]
  v_cmp_gt_i32 s[80:81], 48, v25
  v_cmp_gt_i32 s[82:83], 49, v25
  v_cmp_gt_i32 s[84:85], 50, v25
  v_cmp_gt_i32 s[86:87], 51, v25
  v_cndmask_b32 v100, v100, v24, s[80:81]
  v_cndmask_b32 v101, v101, v24, s[82:83]
  v_cndmask_b32 v102, v102, v24, s[84:85]
  v_cndmask_b32 v103, v103, v24, s[86:87]
  s_branch L_a_d1
L_a_s1:
  s_waitcnt vmcnt(24) lgkmcnt(0)
  v_mfma_f32_16x16x32_bf16 v[32:35], a[64:67], a[0:3], v[96:99]
  s_barrier
  ds_read_b128 a[96:99], v4 offset:0
  v_mfma_f32_16x16x32_bf16 v[32:35], a[72:75], a[4:7], v[32:35]
  s_nop 0
  ds_read_b128 a[100:103], v4 offset:1024
  v_mfma_f32_16x16x32_bf16 v[32:35], a[80:83], a[8:11], v[32:35]
  s_nop 0
  ds_read_b128 a[104:107], v4 offset:2048
  v_mfma_f32_16x16x32_bf16 v[32:35], a[88:91], a[12:15], v[32:35]
  s_nop 0
  ds_read_b128 a[108:111], v4 offset:3072
  v_mfma_f32_16x16x32_bf16 v[36:39], a[68:71], a[0:3], v[100:103]
  s_nop 0
  ds_read_b128 a[112:115], v4 offset:4096
  v_mfma_f32_16x16x32_bf16 v[36:39], a[76:79], a[4:7], v[36:39]
  s_nop 0
  ds_read_b128 a[116:119], v4 offset:5120
  v_mfma_f32_16x16x32_bf16 v[36:39], a[84:87], a[8:11], v[36:39]
  s_nop 0
  ds_read_b128 a[120:123], v4 offset:6144
  v_mfma_f32_16x16x32_bf16 v[36:39], a[92:95], a[12:15], v[36:39]
  s_nop 0
  ds_read_b128 a[124:127], v4 offset:7168
  v_mfma_f32_16x16x32_bf16 v[40:43], a[64:67], a[16:19], v[104:107]
  s_nop 0
  v_exp_f32 v8, v32
  v_mfma_f32_16x16x32_bf16 v[40:43], a[72:75], a[20:23], v[40:43]
  s_nop 0
  v_exp_f32 v9, v33
  v_mfma_f32_16x16x32_bf16 v[40:43], a[80:83], a[24:27], v[40:43]
  s_nop 0
  v_exp_f32 v10, v34
  v_mfma_f32_16x16x32_bf16 v[40:43], a[88:91], a[28:31], v[40:43]
  s_nop 0
  v_exp_f32 v11, v35
  v_mfma_f32_16x16x32_bf16 v[44:47], a[68:71], a[16:19], v[108:111]
  s_nop 0
  v_cvt_pk_bf16_f32 v64, v8, v9
  v_cvt_pk_bf16_f32 v65, v10, v11
  v_mfma_f32_16x16x32_bf16 v[44:47], a[76:79], a[20:23], v[44:47]
  s_nop 0
  v_or_b32 v5, v64, v65
  v_mfma_f32_16x16x32_bf16 v[44:47], a[84:87], a[24:27], v[44:47]
  s_nop 0
  v_exp_f32 v12, v36
  v_mfma_f32_16x16x32_bf16 v[44:47], a[92:95], a[28:31], v[44:47]
  s_nop 0
  v_exp_f32 v13, v37
  v_mfma_f32_16x16x32_bf16 v[48:51], a[64:67], a[32:35], v[112:115]
  s_nop 0
  v_exp_f32 v14, v38
  v_mfma_f32_16x16x32_bf16 v[48:51], a[72:75], a[36:39], v[48:51]
  s_nop 0
  v_exp_f32 v15, v39
  v_mfma_f32_16x16x32_bf16 v[48:51], a[80:83], a[40:43], v[48:51]
  s_nop 0
  v_cvt_pk_bf16_f32 v66, v12, v13
  v_cvt_pk_bf16_f32 v67, v14, v15
  v_mfma_f32_16x16x32_bf16 v[48:51], a[88:91], a[44:47], v[48:51]
  s_add_u32 m0, s64, s65
  s_nop 0
  buffer_load_dwordx4 v3, s[40:43], s61 offen sc1 lds
  v_or3_b32 v5, v5, v66, v67
  v_mfma_f32_16x16x32_bf16 v[52:55], a[68:71], a[32:35], v[116:119]
  s_nop 0
  v_exp_f32 v8, v40
  v_mfma_f32_16x16x32_bf16 v[52:55], a[76:79], a[36:39], v[52:55]
  s_nop 0
  v_exp_f32 v9, v41
  v_mfma_f32_16x16x32_bf16 v[52:55], a[84:87], a[40:43], v[52:55]
  s_min_u32 s66, s62, s63
  buffer_load_dwordx4 v3, s[40:43], s61 offen offset:1024 sc1 lds
  v_mfma_f32_16x16x32_bf16 v[52:55], a[92:95], a[44:47], v[52:55]
  s_nop 0
  v_exp_f32 v10, v42
  v_mfma_f32_16x16x32_bf16 v[56:59], a[64:67], a[48:51], v[120:123]
  s_nop 0
  v_exp_f32 v11, v43
  v_mfma_f32_16x16x32_bf16 v[56:59], a[72:75], a[52:55], v[56:59]
  s_add_u32 m0, m0, 0x2000
  s_nop 0
  buffer_load_dwordx4 v3, s[40:43], s66 offen sc1 lds
  v_cvt_pk_bf16_f32 v68, v8, v9
  v_mfma_f32_16x16x32_bf16 v[56:59], a[80:83], a[56:59], v[56:59]
  s_nop 0
  v_cvt_pk_bf16_f32 v69, v10, v11
  v_or3_b32 v5, v5, v68, v69
  v_mfma_f32_16x16x32_bf16 v[56:59], a[88:91], a[60:63], v[56:59]
  s_nop 0
  v_exp_f32 v12, v44
  v_mfma_f32_16x16x32_bf16 v[60:63], a[68:71], a[48:51], v[124:127]
  s_add_u32 s61, s61, 0x2000
  buffer_load_dwordx4 v3, s[40:43], s66 offen offset:1024 sc1 lds
  v_mfma_f32_16x16x32_bf16 v[60:63], a[76:79], a[52:55], v[60:63]
  s_add_u32 s62, s62, 0x2000
  v_exp_f32 v13, v45
  v_mfma_f32_16x16x32_bf16 v[60:63], a[84:87], a[56:59], v[60:63]
  s_add_u32 s64, s64, 0x4000
  v_exp_f32 v14, v46
  v_mfma_f32_16x16x32_bf16 v[60:63], a[92:95], a[60:63], v[60:63]
  s_and_b32 s64, s64, 0x1ffff
  v_exp_f32 v15, v47
  v_mfma_f32_16x16x32_bf16 a[128:131], v[16:19], v[80:83], a[128:131]
  s_add_u32 s58, s58, 1
  v_cvt_pk_bf16_f32 v70, v12, v13
  v_cvt_pk_bf16_f32 v71, v14, v15
  v_mfma_f32_16x16x32_bf16 a[132:135], v[16:19], v[84:87], a[132:135]
  s_nop 0
  ds_read_b128 a[64:67], v4 offset:8192
  v_or3_b32 v5, v5, v70, v71
  v_mfma_f32_16x16x32_bf16 a[136:139], v[16:19], v[88:91], a[136:139]
  s_nop 0
  v_exp_f32 v8, v48
  v_mfma_f32_16x16x32_bf16 a[140:143], v[16:19], v[92:95], a[140:143]
  s_nop 0
  v_exp_f32 v9, v49
  s_waitcnt lgkmcnt(1)
  v_mfma_f32_16x16x32_bf16 v[128:131], a[96:99], v[80:83], v[128:131]
  ds_read_b128 a[68:71], v4 offset:9216
  v_mfma_f32_16x16x32_bf16 v[160:163], a[96:99], v[84:87], v[160:163]
  v_exp_f32 v10, v50
  v_mfma_f32_16x16x32_bf16 v[192:195], a[96:99], v[88:91], v[192:195]
  v_exp_f32 v11, v51
  v_mfma_f32_16x16x32_bf16 v[224:227], a[96:99], v[92:95], v[224:227]
  ds_read_b128 a[72:75], v4 offset:10240
  v_cvt_pk_bf16_f32 v72, v8, v9
  v_mfma_f32_16x16x32_bf16 v[132:135], a[100:103], v[80:83], v[132:135]
  v_cvt_pk_bf16_f32 v73, v10, v11
  v_or3_b32 v5, v5, v72, v73
  v_mfma_f32_16x16x32_bf16 v[164:167], a[100:103], v[84:87], v[164:167]
  v_exp_f32 v12, v52
  v_mfma_f32_16x16x32_bf16 v[196:199], a[100:103], v[88:91], v[196:199]
  ds_read_b128 a[76:79], v4 offset:11264
  v_mfma_f32_16x16x32_bf16 v[228:231], a[100:103], v[92:95], v[228:231]
  v_exp_f32 v13, v53
  v_mfma_f32_16x16x32_bf16 v[136:139], a[104:107], v[80:83], v[136:139]
  v_exp_f32 v14, v54
  v_mfma_f32_16x16x32_bf16 v[168:171], a[104:107], v[84:87], v[168:171]
  ds_read_b128 a[80:83], v4 offset:12288
  v_mfma_f32_16x16x32_bf16 v[200:203], a[104:107], v[88:91], v[200:203]
  v_exp_f32 v15, v55
  v_mfma_f32_16x16x32_bf16 v[232:235], a[104:107], v[92:95], v[232:235]
  v_cvt_pk_bf16_f32 v74, v12, v13
  v_cvt_pk_bf16_f32 v75, v14, v15
  v_mfma_f32_16x16x32_bf16 v[140:143], a[108:111], v[80:83], v[140:143]
  ds_read_b128 a[84:87], v4 offset:13312
  v_or3_b32 v5, v5, v74, v75
  v_mfma_f32_16x16x32_bf16 v[172:175], a[108:111], v[84:87], v[172:175]
  v_exp_f32 v8, v56
  v_mfma_f32_16x16x32_bf16 v[204:207], a[108:111], v[88:91], v[204:207]
  v_exp_f32 v9, v57
  v_mfma_f32_16x16x32_bf16 v[236:239], a[108:111], v[92:95], v[236:239]
  ds_read_b128 a[88:91], v4 offset:14336
  v_mfma_f32_16x16x32_bf16 v[144:147], a[112:115], v[80:83], v[144:147]
  v_exp_f32 v10, v58
  v_mfma_f32_16x16x32_bf16 v[176:179], a[112:115], v[84:87], v[176:179]
  v_exp_f32 v11, v59
  v_mfma_f32_16x16x32_bf16 v[208:211], a[112:115], v[88:91], v[208:211]
  ds_read_b128 a[92:95], v4 offset:15360
  v_cvt_pk_bf16_f32 v76, v8, v9
  v_mfma_f32_16x16x32_bf16 v[240:243], a[112:115], v[92:95], v[240:243]
  v_cvt_pk_bf16_f32 v77, v10, v11
  v_or3_b32 v5, v5, v76, v77
  v_mfma_f32_16x16x32_bf16 v[148:151], a[116:119], v[80:83], v[148:151]
  v_exp_f32 v12, v60
  v_mfma_f32_16x16x32_bf16 v[180:183], a[116:119], v[84:87], v[180:183]
  v_exp_f32 v13, v61
  v_mfma_f32_16x16x32_bf16 v[212:215], a[116:119], v[88:91], v[212:215]
  v_exp_f32 v14, v62
  v_mfma_f32_16x16x32_bf16 v[244:247], a[116:119], v[92:95], v[244:247]
  v_exp_f32 v15, v63
  v_mfma_f32_16x16x32_bf16 v[152:155], a[120:123], v[80:83], v[152:155]
  v_cvt_pk_bf16_f32 v78, v12, v13
  v_cvt_pk_bf16_f32 v79, v14, v15
  v_mfma_f32_16x16x32_bf16 v[184:187], a[120:123], v[84:87], v[184:187]
  v_or3_b32 v5, v5, v78, v79
  v_and_b32 v5, s70, v5
  v_mfma_f32_16x16x32_bf16 v[216:219], a[120:123], v[88:91], v[216:219]
  v_cmp_ne_u32 vcc, 0, v5
  v_add_u32 v4, 0x4000, v4
  v_mfma_f32_16x16x32_bf16 v[248:251], a[120:123], v[92:95], v[248:251]
  v_and_b32 v4, 0x1ffff, v4
  v_mfma_f32_16x16x32_bf16 v[156:159], a[124:127], v[80:83], v[156:159]
  v_mfma_f32_16x16x32_bf16 v[188:191], a[124:127], v[84:87], v[188:191]
  v_mfma_f32_16x16x32_bf16 v[220:223], a[124:127], v[88:91], v[220:223]
  v_mfma_f32_16x16x32_bf16 v[252:255], a[124:127], v[92:95], v[252:255]
  s_cbranch_vccnz L_a_s1_t
L_a_s1_r:
L_a_s0:
  s_waitcnt vmcnt(24) lgkmcnt(0)
  v_mfma_f32_16x16x32_bf16 v[32:35], a[64:67], a[0:3], v[96:99]
  s_barrier
  ds_read_b128 a[96:99], v4 offset:0
  v_mfma_f32_16x16x32_bf16 v[32:35], a[72:75], a[4:7], v[32:35]
  s_nop 0
  ds_read_b128 a[100:103], v4 offset:1024
  v_mfma_f32_16x16x32_bf16 v[32:35], a[80:83], a[8:11], v[32:35]
  s_nop 0
  ds_read_b128 a[104:107], v4 offset:2048
  v_mfma_f32_16x16x32_bf16 v[32:35], a[88:91], a[12:15], v[32:35]
  s_nop 0
  ds_read_b128 a[108:111], v4 offset:3072
  v_mfma_f32_16x16x32_bf16 v[36:39], a[68:71], a[0:3], v[100:103]
  s_nop 0
  ds_read_b128 a[112:115], v4 offset:4096
  v_mfma_f32_16x16x32_bf16 v[36:39], a[76:79], a[4:7], v[36:39]
  s_nop 0
  ds_read_b128 a[116:119], v4 offset:5120
  v_mfma_f32_16x16x32_bf16 v[36:39], a[84:87], a[8:11], v[36:39]
  s_nop 0
  ds_read_b128 a[120:123], v4 offset:6144
  v_mfma_f32_16x16x32_bf16 v[36:39], a[92:95], a[12:15], v[36:39]
  s_nop 0
  ds_read_b128 a[124:127], v4 offset:7168
  v_mfma_f32_16x16x32_bf16 v[40:43], a[64:67], a[16:19], v[104:107]
  s_nop 0
  v_exp_f32 v8, v32
  v_mfma_f32_16x16x32_bf16 v[40:43], a[72:75], a[20:23], v[40:43]
  s_nop 0
  v_exp_f32 v9, v33
  v_mfma_f32_16x16x32_bf16 v[40:43], a[80:83], a[24:27], v[40:43]
  s_nop 0
  v_exp_f32 v10, v34
  v_mfma_f32_16x16x32_bf16 v[40:43], a[88:91], a[28:31], v[40:43]
  s_nop 0
  v_exp_f32 v11, v35
  v_mfma_f32_16x16x32_bf16 v[44:47], a[68:71], a[16:19], v[108:111]
  s_nop 0
  v_cvt_pk_bf16_f32 v80, v8, v9
  v_cvt_pk_bf16_f32 v81, v10, v11
  v_mfma_f32_16x16x32_bf16 v[44:47], a[76:79], a[20:23], v[44:47]
  s_nop 0
  v_or_b32 v5, v80, v81
  v_mfma_f32_16x16x32_bf16 v[44:47], a[84:87], a[24:27], v[44:47]
  s_nop 0
  v_exp_f32 v12, v36
  v_mfma_f32_16x16x32_bf16 v[44:47], a[92:95], a[28:31], v[44:47]
  s_nop 0
  v_exp_f32 v13, v37
  v_mfma_f32_16x16x32_bf16 v[48:51], a[64:67], a[32:35], v[112:115]
  s_nop 0
  v_exp_f32 v14, v38
  v_mfma_f32_16x16x32_bf16 v[48:51], a[72:75], a[36:39], v[48:51]
  s_nop 0
  v_exp_f32 v15, v39
  v_mfma_f32_16x16x32_bf16 v[48:51], a[80:83], a[40:43], v[48:51]
  s_nop 0
  v_cvt_pk_bf16_f32 v82, v12, v13
  v_cvt_pk_bf16_f32 v83, v14, v15
  v_mfma_f32_16x16x32_bf16 v[48:51], a[88:91], a[44:47], v[48:51]
  s_add_u32 m0, s64, s65
  s_nop 0
  buffer_load_dwordx4 v3, s[40:43], s61 offen sc1 lds
  v_or3_b32 v5, v5, v82, v83
  v_mfma_f32_16x16x32_bf16 v[52:55], a[68:71], a[32:35], v[116:119]
  s_nop 0
  v_exp_f32 v8, v40
  v_mfma_f32_16x16x32_bf16 v[52:55], a[76:79], a[36:39], v[52:55]
  s_nop 0
  v_exp_f32 v9, v41
  v_mfma_f32_16x16x32_bf16 v[52:55], a[84:87], a[40:43], v[52:55]
  s_min_u32 s66, s62, s63
  buffer_load_dwordx4 v3, s[40:43], s61 offen offset:1024 sc1 lds
  v_mfma_f32_16x16x32_bf16 v[52:55], a[92:95], a[44:47], v[52:55]
  s_nop 0
  v_exp_f32 v10, v42
  v_mfma_f32_16x16x32_bf16 v[56:59], a[64:67], a[48:51], v[120:123]
  s_nop 0
  v_exp_f32 v11, v43
  v_mfma_f32_16x16x32_bf16 v[56:59], a[72:75], a[52:55], v[56:59]
  s_add_u32 m0, m0, 0x2000
  s_nop 0
  buffer_load_dwordx4 v3, s[40:43], s66 offen sc1 lds
  v_cvt_pk_bf16_f32 v84, v8, v9
  v_mfma_f32_16x16x32_bf16 v[56:59], a[80:83], a[56:59], v[56:59]
  s_nop 0
  v_cvt_pk_bf16_f32 v85, v10, v11
  v_or3_b32 v5, v5, v84, v85
  v_mfma_f32_16x16x32_bf16 v[56:59], a[88:91], a[60:63], v[56:59]
  s_nop 0
  v_exp_f32 v12, v44
  v_mfma_f32_16x16x32_bf16 v[60:63], a[68:71], a[48:51], v[124:127]
  s_add_u32 s61, s61, 0x2000
  buffer_load_dwordx4 v3, s[40:43], s66 offen offset:1024 sc1 lds
  v_mfma_f32_16x16x32_bf16 v[60:63], a[76:79], a[52:55], v[60:63]
  s_add_u32 s62, s62, 0x2000
  v_exp_f32 v13, v45
  v_mfma_f32_16x16x32_bf16 v[60:63], a[84:87], a[56:59], v[60:63]
  s_add_u32 s64, s64, 0x4000
  v_exp_f32 v14, v46
  v_mfma_f32_16x16x32_bf16 v[60:63], a[92:95], a[60:63], v[60:63]
  s_and_b32 s64, s64, 0x1ffff
  v_exp_f32 v15, v47
  v_mfma_f32_16x16x32_bf16 a[128:131], v[16:19], v[64:67], a[128:131]
  s_add_u32 s58, s58, 1
  v_cvt_pk_bf16_f32 v86, v12, v13
  v_cvt_pk_bf16_f32 v87, v14, v15
  v_mfma_f32_16x16x32_bf16 a[132:135], v[16:19], v[68:71], a[132:135]
  s_nop 0
  ds_read_b128 a[64:67], v4 offset:8192
  v_or3_b32 v5, v5, v86, v87
  v_mfma_f32_16x16x32_bf16 a[136:139], v[16:19], v[72:75], a[136:139]
  s_nop 0
  v_exp_f32 v8, v48
  v_mfma_f32_16x16x32_bf16 a[140:143], v[16:19], v[76:79], a[140:143]
  s_nop 0
  v_exp_f32 v9, v49
  s_waitcnt lgkmcnt(1)
  v_mfma_f32_16x16x32_bf16 v[128:131], a[96:99], v[64:67], v[128:131]
  ds_read_b128 a[68:71], v4 offset:9216
  v_mfma_f32_16x16x32_bf16 v[160:163], a[96:99], v[68:71], v[160:163]
  v_exp_f32 v10, v50
  v_mfma_f32_16x16x32_bf16 v[192:195], a[96:99], v[72:75], v[192:195]
  v_exp_f32 v11, v51
  v_mfma_f32_16x16x32_bf16 v[224:227], a[96:99], v[76:79], v[224:227]
  ds_read_b128 a[72:75], v4 offset:10240
  v_cvt_pk_bf16_f32 v88, v8, v9
  v_mfma_f32_16x16x32_bf16 v[132:135], a[100:103], v[64:67], v[132:135]
  v_cvt_pk_bf16_f32 v89, v10, v11
  v_or3_b32 v5, v5, v88, v89
  v_mfma_f32_16x16x32_bf16 v[164:167], a[100:103], v[68:71], v[164:167]
  v_exp_f32 v12, v52
  v_mfma_f32_16x16x32_bf16 v[196:199], a[100:103], v[72:75], v[196:199]
  ds_read_b128 a[76:79], v4 offset:11264
  v_mfma_f32_16x16x32_bf16 v[228:231], a[100:103], v[76:79], v[228:231]
  v_exp_f32 v13, v53
  v_mfma_f32_16x16x32_bf16 v[136:139], a[104:107], v[64:67], v[136:139]
  v_exp_f32 v14, v54
  v_mfma_f32_16x16x32_bf16 v[168:171], a[104:107], v[68:71], v[168:171]
  ds_read_b128 a[80:83], v4 offset:12288
  v_mfma_f32_16x16x32_bf16 v[200:203], a[104:107], v[72:75], v[200:203]
  v_exp_f32 v15, v55
  v_mfma_f32_16x16x32_bf16 v[232:235], a[104:107], v[76:79], v[232:235]
  v_cvt_pk_bf16_f32 v90, v12, v13
  v_cvt_pk_bf16_f32 v91, v14, v15
  v_mfma_f32_16x16x32_bf16 v[140:143], a[108:111], v[64:67], v[140:143]
  ds_read_b128 a[84:87], v4 offset:13312
  v_or3_b32 v5, v5, v90, v91
  v_mfma_f32_16x16x32_bf16 v[172:175], a[108:111], v[68:71], v[172:175]
  v_exp_f32 v8, v56
  v_mfma_f32_16x16x32_bf16 v[204:207], a[108:111], v[72:75], v[204:207]
  v_exp_f32 v9, v57
  v_mfma_f32_16x16x32_bf16 v[236:239], a[108:111], v[76:79], v[236:239]
  ds_read_b128 a[88:91], v4 offset:14336
  v_mfma_f32_16x16x32_bf16 v[144:147], a[112:115], v[64:67], v[144:147]
  v_exp_f32 v10, v58
  v_mfma_f32_16x16x32_bf16 v[176:179], a[112:115], v[68:71], v[176:179]
  v_exp_f32 v11, v59
  v_mfma_f32_16x16x32_bf16 v[208:211], a[112:115], v[72:75], v[208:211]
  ds_read_b128 a[92:95], v4 offset:15360
  v_cvt_pk_bf16_f32 v92, v8, v9
  v_mfma_f32_16x16x32_bf16 v[240:243], a[112:115], v[76:79], v[240:243]
  v_cvt_pk_bf16_f32 v93, v10, v11
  v_or3_b32 v5, v5, v92, v93
  v_mfma_f32_16x16x32_bf16 v[148:151], a[116:119], v[64:67], v[148:151]
  v_exp_f32 v12, v60
  v_mfma_f32_16x16x32_bf16 v[180:183], a[116:119], v[68:71], v[180:183]
  v_exp_f32 v13, v61
  v_mfma_f32_16x16x32_bf16 v[212:215], a[116:119], v[72:75], v[212:215]
  v_exp_f32 v14, v62
  v_mfma_f32_16x16x32_bf16 v[244:247], a[116:119], v[76:79], v[244:247]
  v_exp_f32 v15, v63
  v_mfma_f32_16x16x32_bf16 v[152:155], a[120:123], v[64:67], v[152:155]
  v_cvt_pk_bf16_f32 v94, v12, v13
  v_cvt_pk_bf16_f32 v95, v14, v15
  v_mfma_f32_16x16x32_bf16 v[184:187], a[120:123], v[68:71], v[184:187]
  v_or3_b32 v5, v5, v94, v95
  v_and_b32 v5, s70, v5
  v_mfma_f32_16x16x32_bf16 v[216:219], a[120:123], v[72:75], v[216:219]
  v_cmp_ne_u32 vcc, 0, v5
  v_add_u32 v4, 0x4000, v4
  v_mfma_f32_16x16x32_bf16 v[248:251], a[120:123], v[76:79], v[248:251]
  v_and_b32 v4, 0x1ffff, v4
  v_mfma_f32_16x16x32_bf16 v[156:159], a[124:127], v[64:67], v[156:159]
  v_mfma_f32_16x16x32_bf16 v[188:191], a[124:127], v[68:71], v[188:191]
  v_mfma_f32_16x16x32_bf16 v[220:223], a[124:127], v[72:75], v[220:223]
  v_mfma_f32_16x16x32_bf16 v[252:255], a[124:127], v[76:79], v[252:255]
  s_cbranch_vccnz L_a_s0_t
L_a_s0_r:
  s_cmp_eq_u32 s58, s59
  s_cbranch_scc0 L_a_s1
  v_cmp_gt_i32 s[80:81], 0, v25
  v_cmp_gt_i32 s[82:83], 1, v25
  v_cmp_gt_i32 s[84:85], 2, v25
  v_cmp_gt_i32 s[86:87], 3, v25
  v_cndmask_b32 v96, v96, v24, s[80:81]
  v_cndmask_b32 v97, v97, v24, s[82:83]
  v_cndmask_b32 v98, v98, v24, s[84:85]
  v_cndmask_b32 v99, v99, v24, s[86:87]
  v_cmp_gt_i32 s[80:81], 16, v25
  v_cmp_gt_i32 s[82:83], 17, v25
  v_cmp_gt_i32 s[84:85], 18, v25
  v_cmp_gt_i32 s[86:87], 19, v25
  v_cndmask_b32 v100, v100, v24, s[80:81]
  v_cndmask_b32 v101, v101, v24, s[82:83]
  v_cndmask_b32 v102, v102, v24, s[84:85]
  v_cndmask_b32 v103, v103, v24, s[86:87]
  s_nop 0
L_a_d0:
  s_waitcnt vmcnt(24) lgkmcnt(0)
  v_mfma_f32_16x16x32_bf16 v[32:35], a[64:67], a[0:3], v[96:99]
  s_barrier
  ds_read_b128 a[96:99], v4 offset:0
  v_mfma_f32_16x16x32_bf16 v[32:35], a[72:75], a[4:7], v[32:35]
  s_nop 0
  ds_read_b128 a[100:103], v4 offset:1024
  v_mfma_f32_16x16x32_bf16 v[32:35], a[80:83], a[8:11], v[32:35]
  s_nop 0
  ds_read_b128 a[104:107], v4 offset:2048
  v_mfma_f32_16x16x32_bf16 v[32:35], a[88:91], a[12:15], v[32:35]
  s_nop 0
  ds_read_b128 a[108:111], v4 offset:3072
  v_mfma_f32_16x16x32_bf16 v[36:39], a[68:71], a[0:3], v[100:103]
  s_nop 0
  ds_read_b128 a[112:115], v4 offset:4096
  v_mfma_f32_16x16x32_bf16 v[36:39], a[76:79], a[4:7], v[36:39]
  s_nop 0
  ds_read_b128 a[116:119], v4 offset:5120
  v_mfma_f32_16x16x32_bf16 v[36:39], a[84:87], a[8:11], v[36:39]
  s_nop 0
  ds_read_b128 a[120:123], v4 offset:6144
  v_mfma_f32_16x16x32_bf16 v[36:39], a[92:95], a[12:15], v[36:39]
  s_nop 0
  ds_read_b128 a[124:127], v4 offset:7168
  v_mfma_f32_16x16x32_bf16 v[40:43], a[64:67], a[16:19], v[104:107]
  s_nop 0
  v_exp_f32 v8, v32
  v_mfma_f32_16x16x32_bf16 v[40:43], a[72:75], a[20:23], v[40:43]
  s_nop 0
  v_exp_f32 v9, v33
  v_mfma_f32_16x16x32_bf16 v[40:43], a[80:83], a[24:27], v[40:43]
  s_nop 0
  v_exp_f32 v10, v34
  v_mfma_f32_16x16x32_bf16 v[40:43], a[88:91], a[28:31], v[40:43]
  s_nop 0
  v_exp_f32 v11, v35
  v_mfma_f32_16x16x32_bf16 v[44:47], a[68:71], a[16:19], v[108:111]
  s_nop 0
  v_cvt_pk_bf16_f32 v64, v8, v9
  v_cvt_pk_bf16_f32 v65, v10, v11
  v_mfma_f32_16x16x32_bf16 v[44:47], a[76:79], a[20:23], v[44:47]
  s_nop 0
  v_or_b32 v5, v64, v65
  v_mfma_f32_16x16x32_bf16 v[44:47], a[84:87], a[24:27], v[44:47]
  s_nop 0
  v_exp_f32 v12, v36
  v_mfma_f32_16x16x32_bf16 v[44:47], a[92:95], a[28:31], v[44:47]
  s_nop 0
  v_exp_f32 v13, v37
  v_mfma_f32_16x16x32_bf16 v[48:51], a[64:67], a[32:35], v[112:115]
  s_nop 0
  v_exp_f32 v14, v38
  v_mfma_f32_16x16x32_bf16 v[48:51], a[72:75], a[36:39], v[48:51]
  s_nop 0
  v_exp_f32 v15, v39
  v_mfma_f32_16x16x32_bf16 v[48:51], a[80:83], a[40:43], v[48:51]
  s_nop 0
  v_cvt_pk_bf16_f32 v66, v12, v13
  v_cvt_pk_bf16_f32 v67, v14, v15
  v_mfma_f32_16x16x32_bf16 v[48:51], a[88:91], a[44:47], v[48:51]
  s_add_u32 m0, s64, s65
  s_nop 0
  buffer_load_dwordx4 v3, s[40:43], s61 offen sc1 lds
  v_or3_b32 v5, v5, v66, v67
  v_mfma_f32_16x16x32_bf16 v[52:55], a[68:71], a[32:35], v[116:119]
  s_nop 0
  v_exp_f32 v8, v40
  v_mfma_f32_16x16x32_bf16 v[52:55], a[76:79], a[36:39], v[52:55]
  s_nop 0
  v_exp_f32 v9, v41
  v_mfma_f32_16x16x32_bf16 v[52:55], a[84:87], a[40:43], v[52:55]
  s_min_u32 s66, s62, s63
  buffer_load_dwordx4 v3, s[40:43], s61 offen offset:1024 sc1 lds
  v_mfma_f32_16x16x32_bf16 v[52:55], a[92:95], a[44:47], v[52:55]
  s_nop 0
  v_exp_f32 v10, v42
  v_mfma_f32_16x16x32_bf16 v[56:59], a[64:67], a[48:51], v[120:123]
  s_nop 0
  v_exp_f32 v11, v43
  v_mfma_f32_16x16x32_bf16 v[56:59], a[72:75], a[52:55], v[56:59]
  s_add_u32 m0, m0, 0x2000
  s_nop 0
  buffer_load_dwordx4 v3, s[40:43], s66 offen sc1 lds
  v_cvt_pk_bf16_f32 v68, v8, v9
  v_mfma_f32_16x16x32_bf16 v[56:59], a[80:83], a[56:59], v[56:59]
  s_nop 0
  v_cvt_pk_bf16_f32 v69, v10, v11
  v_or3_b32 v5, v5, v68, v69
  v_mfma_f32_16x16x32_bf16 v[56:59], a[88:91], a[60:63], v[56:59]
  s_nop 0
  v_exp_f32 v12, v44
  v_mfma_f32_16x16x32_bf16 v[60:63], a[68:71], a[48:51], v[124:127]
  s_add_u32 s61, s61, 0x2000
  buffer_load_dwordx4 v3, s[40:43], s66 offen offset:1024 sc1 lds
  v_mfma_f32_16x16x32_bf16 v[60:63], a[76:79], a[52:55], v[60:63]
  s_add_u32 s62, s62, 0x2000
  v_exp_f32 v13, v45
  v_mfma_f32_16x16x32_bf16 v[60:63], a[84:87], a[56:59], v[60:63]
  s_add_u32 s64, s64, 0x4000
  v_exp_f32 v14, v46
  v_mfma_f32_16x16x32_bf16 v[60:63], a[92:95], a[60:63], v[60:63]
  s_and_b32 s64, s64, 0x1ffff
  v_exp_f32 v15, v47
  v_mfma_f32_16x16x32_bf16 a[128:131], v[16:19], v[80:83], a[128:131]
  s_add_u32 s58, s58, 1
  v_cvt_pk_bf16_f32 v70, v12, v13
  v_cvt_pk_bf16_f32 v71, v14, v15
  v_mfma_f32_16x16x32_bf16 a[132:135], v[16:19], v[84:87], a[132:135]
  s_nop 0
  ds_read_b128 a[64:67], v4 offset:8192
  v_or3_b32 v5, v5, v70, v71
  v_mfma_f32_16x16x32_bf16 a[136:139], v[16:19], v[88:91], a[136:139]
  s_nop 0
  v_exp_f32 v8, v48
  v_mfma_f32_16x16x32_bf16 a[140:143], v[16:19], v[92:95], a[140:143]
  s_nop 0
  v_exp_f32 v9, v49
  s_waitcnt lgkmcnt(1)
  v_mfma_f32_16x16x32_bf16 v[128:131], a[96:99], v[80:83], v[128:131]
  ds_read_b128 a[68:71], v4 offset:9216
  v_mfma_f32_16x16x32_bf16 v[160:163], a[96:99], v[84:87], v[160:163]
  v_exp_f32 v10, v50
  v_mfma_f32_16x16x32_bf16 v[192:195], a[96:99], v[88:91], v[192:195]
  v_exp_f32 v11, v51
  v_mfma_f32_16x16x32_bf16 v[224:227], a[96:99], v[92:95], v[224:227]
  ds_read_b128 a[72:75], v4 offset:10240
  v_cvt_pk_bf16_f32 v72, v8, v9
  v_mfma_f32_16x16x32_bf16 v[132:135], a[100:103], v[80:83], v[132:135]
  v_cvt_pk_bf16_f32 v73, v10, v11
  v_or3_b32 v5, v5, v72, v73
  v_mfma_f32_16x16x32_bf16 v[164:167], a[100:103], v[84:87], v[164:167]
  v_exp_f32 v12, v52
  v_mfma_f32_16x16x32_bf16 v[196:199], a[100:103], v[88:91], v[196:199]
  ds_read_b128 a[76:79], v4 offset:11264
  v_mfma_f32_16x16x32_bf16 v[228:231], a[100:103], v[92:95], v[228:231]
  v_exp_f32 v13, v53
  v_mfma_f32_16x16x32_bf16 v[136:139], a[104:107], v[80:83], v[136:139]
  v_exp_f32 v14, v54
  v_mfma_f32_16x16x32_bf16 v[168:171], a[104:107], v[84:87], v[168:171]
  ds_read_b128 a[80:83], v4 offset:12288
  v_mfma_f32_16x16x32_bf16 v[200:203], a[104:107], v[88:91], v[200:203]
  v_exp_f32 v15, v55
  v_mfma_f32_16x16x32_bf16 v[232:235], a[104:107], v[92:95], v[232:235]
  v_cvt_pk_bf16_f32 v74, v12, v13
  v_cvt_pk_bf16_f32 v75, v14, v15
  v_mfma_f32_16x16x32_bf16 v[140:143], a[108:111], v[80:83], v[140:143]
  ds_read_b128 a[84:87], v4 offset:13312
  v_or3_b32 v5, v5, v74, v75
  v_mfma_f32_16x16x32_bf16 v[172:175], a[108:111], v[84:87], v[172:175]
  v_exp_f32 v8, v56
  v_mfma_f32_16x16x32_bf16 v[204:207], a[108:111], v[88:91], v[204:207]
  v_exp_f32 v9, v57
  v_mfma_f32_16x16x32_bf16 v[236:239], a[108:111], v[92:95], v[236:239]
  ds_read_b128 a[88:91], v4 offset:14336
  v_mfma_f32_16x16x32_bf16 v[144:147], a[112:115], v[80:83], v[144:147]
  v_exp_f32 v10, v58
  v_mfma_f32_16x16x32_bf16 v[176:179], a[112:115], v[84:87], v[176:179]
  v_exp_f32 v11, v59
  v_mfma_f32_16x16x32_bf16 v[208:211], a[112:115], v[88:91], v[208:211]
  ds_read_b128 a[92:95], v4 offset:15360
  v_cvt_pk_bf16_f32 v76, v8, v9
  v_mfma_f32_16x16x32_bf16 v[240:243], a[112:115], v[92:95], v[240:243]
  v_cvt_pk_bf16_f32 v77, v10, v11
  v_or3_b32 v5, v5, v76, v77
  v_mfma_f32_16x16x32_bf16 v[148:151], a[116:119], v[80:83], v[148:151]
  v_exp_f32 v12, v60
  v_mfma_f32_16x16x32_bf16 v[180:183], a[116:119], v[84:87], v[180:183]
  v_exp_f32 v13, v61
  v_mfma_f32_16x16x32_bf16 v[212:215], a[116:119], v[88:91], v[212:215]
  v_exp_f32 v14, v62
  v_mfma_f32_16x16x32_bf16 v[244:247], a[116:119], v[92:95], v[244:247]
  v_exp_f32 v15, v63
  v_mfma_f32_16x16x32_bf16 v[152:155], a[120:123], v[80:83], v[152:155]
  v_cvt_pk_bf16_f32 v78, v12, v13
  v_cvt_pk_bf16_f32 v79, v14, v15
  v_mfma_f32_16x16x32_bf16 v[184:187], a[120:123], v[84:87], v[184:187]
  v_or3_b32 v5, v5, v78, v79
  v_and_b32 v5, s70, v5
  v_mfma_f32_16x16x32_bf16 v[216:219], a[120:123], v[88:91], v[216:219]
  v_cmp_ne_u32 vcc, 0, v5
  v_cmp_gt_i32 s[80:81], 32, v25
  v_mfma_f32_16x16x32_bf16 v[248:251], a[120:123], v[92:95], v[248:251]
  v_cmp_gt_i32 s[82:83], 33, v25
  v_cmp_gt_i32 s[84:85], 34, v25
  v_mfma_f32_16x16x32_bf16 v[156:159], a[124:127], v[80:83], v[156:159]
  v_cmp_gt_i32 s[86:87], 35, v25
  v_cndmask_b32 v96, v96, v24, s[80:81]
  v_mfma_f32_16x16x32_bf16 v[188:191], a[124:127], v[84:87], v[188:191]
  v_cndmask_b32 v97, v97, v24, s[82:83]
  v_cndmask_b32 v98, v98, v24, s[84:85]
  v_mfma_f32_16x16x32_bf16 v[220:223], a[124:127], v[88:91], v[220:223]
  v_cndmask_b32 v99, v99, v24, s[86:87]
  v_cmp_gt_i32 s[80:81], 48, v25
  v_mfma_f32_16x16x32_bf16 v[252:255], a[124:127], v[92:95], v[252:255]
  v_cmp_gt_i32 s[82:83], 49, v25
  v_cmp_gt_i32 s[84:85], 50, v25
  v_cmp_gt_i32 s[86:87], 51, v25
  v_cndmask_b32 v100, v100, v24, s[80:81]
  v_cndmask_b32 v101, v101, v24, s[82:83]
  v_cndmask_b32 v102, v102, v24, s[84:85]
  v_cndmask_b32 v103, v103, v24, s[86:87]
  v_add_u32 v4, 0x4000, v4
  v_and_b32 v4, 0x1ffff, v4
  s_cbranch_vccnz L_a_d0_t
L_a_d0_r:
L_a_d1:
  s_waitcnt vmcnt(24) lgkmcnt(0)
  v_mfma_f32_16x16x32_bf16 v[32:35], a[64:67], a[0:3], v[96:99]
  s_barrier
  ds_read_b128 a[96:99], v4 offset:0
  v_mfma_f32_16x16x32_bf16 v[32:35], a[72:75], a[4:7], v[32:35]
  s_nop 0
  ds_read_b128 a[100:103], v4 offset:1024
  v_mfma_f32_16x16x32_bf16 v[32:35], a[80:83], a[8:11], v[32:35]
  s_nop 0
  ds_read_b128 a[104:107], v4 offset:2048
  v_mfma_f32_16x16x32_bf16 v[32:35], a[88:91], a[12:15], v[32:35]
  s_nop 0
  ds_read_b128 a[108:111], v4 offset:3072
  v_mfma_f32_16x16x32_bf16 v[36:39], a[68:71], a[0:3], v[100:103]
  s_nop 0
  ds_read_b128 a[112:115], v4 offset:4096
  v_mfma_f32_16x16x32_bf16 v[36:39], a[76:79], a[4:7], v[36:39]
  s_nop 0
  ds_read_b128 a[116:119], v4 offset:5120
  v_mfma_f32_16x16x32_bf16 v[36:39], a[84:87], a[8:11], v[36:39]
  s_nop 0
  ds_read_b128 a[120:123], v4 offset:6144
  v_mfma_f32_16x16x32_bf16 v[36:39], a[92:95], a[12:15], v[36:39]
  s_nop 0
  ds_read_b128 a[124:127], v4 offset:7168
  v_mfma_f32_16x16x32_bf16 v[40:43], a[64:67], a[16:19], v[104:107]
  s_nop 0
  v_exp_f32 v8, v32
  v_mfma_f32_16x16x32_bf16 v[40:43], a[72:75], a[20:23], v[40:43]
  s_nop 0
  v_exp_f32 v9, v33
  v_mfma_f32_16x16x32_bf16 v[40:43], a[80:83], a[24:27], v[40:43]
  s_nop 0
  v_exp_f32 v10, v34
  v_mfma_f32_16x16x32_bf16 v[40:43], a[88:91], a[28:31], v[40:43]
  s_nop 0
  v_exp_f32 v11, v35
  v_mfma_f32_16x16x32_bf16 v[44:47], a[68:71], a[16:19], v[108:111]
  s_nop 0
  v_cvt_pk_bf16_f32 v80, v8, v9
  v_cvt_pk_bf16_f32 v81, v10, v11
  v_mfma_f32_16x16x32_bf16 v[44:47], a[76:79], a[20:23], v[44:47]
  s_nop 0
  v_or_b32 v5, v80, v81
  v_mfma_f32_16x16x32_bf16 v[44:47], a[84:87], a[24:27], v[44:47]
  s_nop 0
  v_exp_f32 v12, v36
  v_mfma_f32_16x16x32_bf16 v[44:47], a[92:95], a[28:31], v[44:47]
  s_nop 0
  v_exp_f32 v13, v37
  v_mfma_f32_16x16x32_bf16 v[48:51], a[64:67], a[32:35], v[112:115]
  s_nop 0
  v_exp_f32 v14, v38
  v_mfma_f32_16x16x32_bf16 v[48:51], a[72:75], a[36:39], v[48:51]
  s_nop 0
  v_exp_f32 v15, v39
  v_mfma_f32_16x16x32_bf16 v[48:51], a[80:83], a[40:43], v[48:51]
  s_nop 0
  v_cvt_pk_bf16_f32 v82, v12, v13
  v_cvt_pk_bf16_f32 v83, v14, v15
  v_mfma_f32_16x16x32_bf16 v[48:51], a[88:91], a[44:47], v[48:51]
  s_add_u32 m0, s64, s65
  s_nop 0
  buffer_load_dwordx4 v3, s[40:43], s61 offen sc1 lds
  v_or3_b32 v5, v5, v82, v83
  v_mfma_f32_16x16x32_bf16 v[52:55], a[68:71], a[32:35], v[116:119]
  s_nop 0
  v_exp_f32 v8, v40
  v_mfma_f32_16x16x32_bf16 v[52:55], a[76:79], a[36:39], v[52:55]
  s_nop 0
  v_exp_f32 v9, v41
  v_mfma_f32_16x16x32_bf16 v[52:55], a[84:87], a[40:43], v[52:55]
  s_min_u32 s66, s62, s63
  buffer_load_dwordx4 v3, s[40:43], s61 offen offset:1024 sc1 lds
  v_mfma_f32_16x16x32_bf16 v[52:55], a[92:95], a[44:47], v[52:55]
  s_nop 0
  v_exp_f32 v10, v42
  v_mfma_f32_16x16x32_bf16 v[56:59], a[64:67], a[48:51], v[120:123]
  s_nop 0
  v_exp_f32 v11, v43
  v_mfma_f32_16x16x32_bf16 v[56:59], a[72:75], a[52:55], v[56:59]
  s_add_u32 m0, m0, 0x2000
  s_nop 0
  buffer_load_dwordx4 v3, s[40:43], s66 offen sc1 lds
  v_cvt_pk_bf16_f32 v84, v8, v9
  v_mfma_f32_16x16x32_bf16 v[56:59], a[80:83], a[56:59], v[56:59]
  s_nop 0
  v_cvt_pk_bf16_f32 v85, v10, v11
  v_or3_b32 v5, v5, v84, v85
  v_mfma_f32_16x16x32_bf16 v[56:59], a[88:91], a[60:63], v[56:59]
  s_nop 0
  v_exp_f32 v12, v44
  v_mfma_f32_16x16x32_bf16 v[60:63], a[68:71], a[48:51], v[124:127]
  s_add_u32 s61, s61, 0x2000
  buffer_load_dwordx4 v3, s[40:43], s66 offen offset:1024 sc1 lds
  v_mfma_f32_16x16x32_bf16 v[60:63], a[76:79], a[52:55], v[60:63]
  s_add_u32 s62, s62, 0x2000
  v_exp_f32 v13, v45
  v_mfma_f32_16x16x32_bf16 v[60:63], a[84:87], a[56:59], v[60:63]
  s_add_u32 s64, s64, 0x4000
  v_exp_f32 v14, v46
  v_mfma_f32_16x16x32_bf16 v[60:63], a[92:95], a[60:63], v[60:63]
  s_and_b32 s64, s64, 0x1ffff
  v_exp_f32 v15, v47
  v_mfma_f32_16x16x32_bf16 a[128:131], v[16:19], v[64:67], a[128:131]
  s_add_u32 s58, s58, 1
  v_cvt_pk_bf16_f32 v86, v12, v13
  v_cvt_pk_bf16_f32 v87, v14, v15
  v_mfma_f32_16x16x32_bf16 a[132:135], v[16:19], v[68:71], a[132:135]
  s_nop 0
  ds_read_b128 a[64:67], v4 offset:8192
  v_or3_b32 v5, v5, v86, v87
  v_mfma_f32_16x16x32_bf16 a[136:139], v[16:19], v[72:75], a[136:139]
  s_nop 0
  v_exp_f32 v8, v48
  v_mfma_f32_16x16x32_bf16 a[140:143], v[16:19], v[76:79], a[140:143]
  s_nop 0
  v_exp_f32 v9, v49
  s_waitcnt lgkmcnt(1)
  v_mfma_f32_16x16x32_bf16 v[128:131], a[96:99], v[64:67], v[128:131]
  ds_read_b128 a[68:71], v4 offset:9216
  v_mfma_f32_16x16x32_bf16 v[160:163], a[96:99], v[68:71], v[160:163]
  v_exp_f32 v10, v50
  v_mfma_f32_16x16x32_bf16 v[192:195], a[96:99], v[72:75], v[192:195]
  v_exp_f32 v11, v51
  v_mfma_f32_16x16x32_bf16 v[224:227], a[96:99], v[76:79], v[224:227]
  ds_read_b128 a[72:75], v4 offset:10240
  v_cvt_pk_bf16_f32 v88, v8, v9
  v_mfma_f32_16x16x32_bf16 v[132:135], a[100:103], v[64:67], v[132:135]
  v_cvt_pk_bf16_f32 v89, v10, v11
  v_or3_b32 v5, v5, v88, v89
  v_mfma_f32_16x16x32_bf16 v[164:167], a[100:103], v[68:71], v[164:167]
  v_exp_f32 v12, v52
  v_mfma_f32_16x16x32_bf16 v[196:199], a[100:103], v[72:75], v[196:199]
  ds_read_b128 a[76:79], v4 offset:11264
  v_mfma_f32_16x16x32_bf16 v[228:231], a[100:103], v[76:79], v[228:231]
  v_exp_f32 v13, v53
  v_mfma_f32_16x16x32_bf16 v[136:139], a[104:107], v[64:67], v[136:139]
  v_exp_f32 v14, v54
  v_mfma_f32_16x16x32_bf16 v[168:171], a[104:107], v[68:71], v[168:171]
  ds_read_b128 a[80:83], v4 offset:12288
  v_mfma_f32_16x16x32_bf16 v[200:203], a[104:107], v[72:75], v[200:203]
  v_exp_f32 v15, v55
  v_mfma_f32_16x16x32_bf16 v[232:235], a[104:107], v[76:79], v[232:235]
  v_cvt_pk_bf16_f32 v90, v12, v13
  v_cvt_pk_bf16_f32 v91, v14, v15
  v_mfma_f32_16x16x32_bf16 v[140:143], a[108:111], v[64:67], v[140:143]
  ds_read_b128 a[84:87], v4 offset:13312
  v_or3_b32 v5, v5, v90, v91
  v_mfma_f32_16x16x32_bf16 v[172:175], a[108:111], v[68:71], v[172:175]
  v_exp_f32 v8, v56
  v_mfma_f32_16x16x32_bf16 v[204:207], a[108:111], v[72:75], v[204:207]
  v_exp_f32 v9, v57
  v_mfma_f32_16x16x32_bf16 v[236:239], a[108:111], v[76:79], v[236:239]
  ds_read_b128 a[88:91], v4 offset:14336
  v_mfma_f32_16x16x32_bf16 v[144:147], a[112:115], v[64:67], v[144:147]
  v_exp_f32 v10, v58
  v_mfma_f32_16x16x32_bf16 v[176:179], a[112:115], v[68:71], v[176:179]
  v_exp_f32 v11, v59
  v_mfma_f32_16x16x32_bf16 v[208:211], a[112:115], v[72:75], v[208:211]
  ds_read_b128 a[92:95], v4 offset:15360
  v_cvt_pk_bf16_f32 v92, v8, v9
  v_mfma_f32_16x16x32_bf16 v[240:243], a[112:115], v[76:79], v[240:243]
  v_cvt_pk_bf16_f32 v93, v10, v11
  v_or3_b32 v5, v5, v92, v93
  v_mfma_f32_16x16x32_bf16 v[148:151], a[116:119], v[64:67], v[148:151]
  v_exp_f32 v12, v60
  v_mfma_f32_16x16x32_bf16 v[180:183], a[116:119], v[68:71], v[180:183]
  v_exp_f32 v13, v61
  v_mfma_f32_16x16x32_bf16 v[212:215], a[116:119], v[72:75], v[212:215]
  v_exp_f32 v14, v62
  v_mfma_f32_16x16x32_bf16 v[244:247], a[116:119], v[76:79], v[244:247]
  v_exp_f32 v15, v63
  v_mfma_f32_16x16x32_bf16 v[152:155], a[120:123], v[64:67], v[152:155]
  v_cvt_pk_bf16_f32 v94, v12, v13
  v_cvt_pk_bf16_f32 v95, v14, v15
  v_mfma_f32_16x16x32_bf16 v[184:187], a[120:123], v[68:71], v[184:187]
  v_or3_b32 v5, v5, v94, v95
  v_and_b32 v5, s70, v5
  v_mfma_f32_16x16x32_bf16 v[216:219], a[120:123], v[72:75], v[216:219]
  v_cmp_ne_u32 vcc, 0, v5
  v_cmp_gt_i32 s[80:81], 0, v25
  v_mfma_f32_16x16x32_bf16 v[248:251], a[120:123], v[76:79], v[248:251]
  v_cmp_gt_i32 s[82:83], 1, v25
  v_cmp_gt_i32 s[84:85], 2, v25
  v_mfma_f32_16x16x32_bf16 v[156:159], a[124:127], v[64:67], v[156:159]
  v_cmp_gt_i32 s[86:87], 3, v25
  v_cndmask_b32 v104, v104, v24, s[80:81]
  v_mfma_f32_16x16x32_bf16 v[188:191], a[124:127], v[68:71], v[188:191]
  v_cndmask_b32 v105, v105, v24, s[82:83]
  v_cndmask_b32 v106, v106, v24, s[84:85]
  v_mfma_f32_16x16x32_bf16 v[220:223], a[124:127], v[72:75], v[220:223]
  v_cndmask_b32 v107, v107, v24, s[86:87]
  v_cmp_gt_i32 s[80:81], 16, v25
  v_mfma_f32_16x16x32_bf16 v[252:255], a[124:127], v[76:79], v[252:255]
  v_cmp_gt_i32 s[82:83], 17, v25
  v_cmp_gt_i32 s[84:85], 18, v25
  v_cmp_gt_i32 s[86:87], 19, v25
  v_cndmask_b32 v108, v108, v24, s[80:81]
  v_cndmask_b32 v109, v109, v24, s[82:83]
  v_cndmask_b32 v110, v110, v24, s[84:85]
  v_cndmask_b32 v111, v111, v24, s[86:87]
  v_add_u32 v4, 0x4000, v4
  v_and_b32 v4, 0x1ffff, v4
  s_cbranch_vccnz L_a_d1_t
L_a_d1_r:
L_a_d2:
  s_waitcnt vmcnt(24) lgkmcnt(0)
  v_mfma_f32_16x16x32_bf16 v[40:43], a[64:67], a[16:19], v[104:107]
  s_barrier
  ds_read_b128 a[96:99], v4 offset:0
  v_mfma_f32_16x16x32_bf16 v[40:43], a[72:75], a[20:23], v[40:43]
  s_nop 0
  ds_read_b128 a[100:103], v4 offset:1024
  v_mfma_f32_16x16x32_bf16 v[40:43], a[80:83], a[24:27], v[40:43]
  s_nop 0
  ds_read_b128 a[104:107], v4 offset:2048
  v_mfma_f32_16x16x32_bf16 v[40:43], a[88:91], a[28:31], v[40:43]
  s_nop 0
  ds_read_b128 a[108:111], v4 offset:3072
  v_mfma_f32_16x16x32_bf16 v[44:47], a[68:71], a[16:19], v[108:111]
  s_nop 0
  ds_read_b128 a[112:115], v4 offset:4096
  v_mfma_f32_16x16x32_bf16 v[44:47], a[76:79], a[20:23], v[44:47]
  s_nop 0
  ds_read_b128 a[116:119], v4 offset:5120
  v_mfma_f32_16x16x32_bf16 v[44:47], a[84:87], a[24:27], v[44:47]
  s_nop 0
  ds_read_b128 a[120:123], v4 offset:6144
  v_mfma_f32_16x16x32_bf16 v[44:47], a[92:95], a[28:31], v[44:47]
  s_nop 0
  ds_read_b128 a[124:127], v4 offset:7168
  v_mfma_f32_16x16x32_bf16 v[48:51], a[64:67], a[32:35], v[112:115]
  s_add_u32 m0, s73, 0
  s_add_u32 s66, s72, 0
  buffer_load_dwordx4 v26, s[48:51], s66 offen lds
  v_mfma_f32_16x16x32_bf16 v[48:51], a[72:75], a[36:39], v[48:51]
  s_add_u32 m0, s73, 1024
  s_add_u32 s66, s72, 8192
  buffer_load_dwordx4 v26, s[48:51], s66 offen lds
  v_mfma_f32_16x16x32_bf16 v[48:51], a[80:83], a[40:43], v[48:51]
  s_add_u32 m0, s73, 2048
  s_add_u32 s66, s72, 16384
  buffer_load_dwordx4 v26, s[48:51], s66 offen lds
  v_mfma_f32_16x16x32_bf16 v[48:51], a[88:91], a[44:47], v[48:51]
  s_add_u32 m0, s73, 3072
  s_add_u32 s66, s72, 24576
  buffer_load_dwordx4 v26, s[48:51], s66 offen lds
  v_mfma_f32_16x16x32_bf16 v[52:55], a[68:71], a[32:35], v[116:119]
  s_add_u32 s58, s58, 1
  v_exp_f32 v8, v40
  v_mfma_f32_16x16x32_bf16 v[52:55], a[76:79], a[36:39], v[52:55]
  s_nop 0
  v_exp_f32 v9, v41
  v_mfma_f32_16x16x32_bf16 v[52:55], a[84:87], a[40:43], v[52:55]
  s_nop 0
  v_exp_f32 v10, v42
  v_mfma_f32_16x16x32_bf16 v[52:55], a[92:95], a[44:47], v[52:55]
  s_nop 0
  v_exp_f32 v11, v43
  v_mfma_f32_16x16x32_bf16 v[56:59], a[64:67], a[48:51], v[120:123]
  s_nop 0
  v_cvt_pk_bf16_f32 v68, v8, v9
  v_cvt_pk_bf16_f32 v69, v10, v11
  v_mfma_f32_16x16x32_bf16 v[56:59], a[72:75], a[52:55], v[56:59]
  s_nop 0
  v_or_b32 v5, v68, v69
  v_mfma_f32_16x16x32_bf16 v[56:59], a[80:83], a[56:59], v[56:59]
  s_nop 0
  v_exp_f32 v12, v44
  v_mfma_f32_16x16x32_bf16 v[56:59], a[88:91], a[60:63], v[56:59]
  s_nop 0
  v_exp_f32 v13, v45
  v_mfma_f32_16x16x32_bf16 v[60:63], a[68:71], a[48:51], v[124:127]
  s_nop 0
  v_exp_f32 v14, v46
  v_mfma_f32_16x16x32_bf16 v[60:63], a[76:79], a[52:55], v[60:63]
  s_nop 0
  v_exp_f32 v15, v47
  v_mfma_f32_16x16x32_bf16 v[60:63], a[84:87], a[56:59], v[60:63]
  s_nop 0
  v_cvt_pk_bf16_f32 v70, v12, v13
  v_cvt_pk_bf16_f32 v71, v14, v15
  v_mfma_f32_16x16x32_bf16 v[60:63], a[92:95], a[60:63], v[60:63]
  s_nop 0
  v_or3_b32 v5, v5, v70, v71
  v_mfma_f32_16x16x32_bf16 a[128:131], v[16:19], v[80:83], a[128:131]
  s_nop 0
  v_exp_f32 v8, v48
  v_mfma_f32_16x16x32_bf16 a[132:135], v[16:19], v[84:87], a[132:135]
  s_nop 0
  ds_read_b128 a[64:67], v4 offset:8192
  v_mfma_f32_16x16x32_bf16 a[136:139], v[16:19], v[88:91], a[136:139]
  s_nop 0
  v_exp_f32 v9, v49
  v_mfma_f32_16x16x32_bf16 a[140:143], v[16:19], v[92:95], a[140:143]
  s_nop 0
  v_exp_f32 v10, v50
  s_waitcnt lgkmcnt(1)
  v_mfma_f32_16x16x32_bf16 v[128:131], a[96:99], v[80:83], v[128:131]
  ds_read_b128 a[68:71], v4 offset:9216
  v_mfma_f32_16x16x32_bf16 v[160:163], a[96:99], v[84:87], v[160:163]
  v_exp_f32 v11, v51
  v_mfma_f32_16x16x32_bf16 v[192:195], a[96:99], v[88:91], v[192:195]
  v_cvt_pk_bf16_f32 v72, v8, v9
  v_cvt_pk_bf16_f32 v73, v10, v11
  v_mfma_f32_16x16x32_bf16 v[224:227], a[96:99], v[92:95], v[224:227]
  ds_read_b128 a[72:75], v4 offset:10240
  v_or3_b32 v5, v5, v72, v73
  v_mfma_f32_16x16x32_bf16 v[132:135], a[100:103], v[80:83], v[132:135]
  v_exp_f32 v12, v52
  v_mfma_f32_16x16x32_bf16 v[164:167], a[100:103], v[84:87], v[164:167]
  v_exp_f32 v13, v53
  v_mfma_f32_16x16x32_bf16 v[196:199], a[100:103], v[88:91], v[196:199]
  ds_read_b128 a[76:79], v4 offset:11264
  v_mfma_f32_16x16x32_bf16 v[228:231], a[100:103], v[92:95], v[228:231]
  v_exp_f32 v14, v54
  v_mfma_f32_16x16x32_bf16 v[136:139], a[104:107], v[80:83], v[136:139]
  v_exp_f32 v15, v55
  v_mfma_f32_16x16x32_bf16 v[168:171], a[104:107], v[84:87], v[168:171]
  ds_read_b128 a[80:83], v4 offset:12288
  v_cvt_pk_bf16_f32 v74, v12, v13
  v_mfma_f32_16x16x32_bf16 v[200:203], a[104:107], v[88:91], v[200:203]
  v_cvt_pk_bf16_f32 v75, v14, v15
  v_or3_b32 v5, v5, v74, v75
  v_mfma_f32_16x16x32_bf16 v[232:235], a[104:107], v[92:95], v[232:235]
  v_exp_f32 v8, v56
  v_mfma_f32_16x16x32_bf16 v[140:143], a[108:111], v[80:83], v[140:143]
  ds_read_b128 a[84:87], v4 offset:13312
  v_mfma_f32_16x16x32_bf16 v[172:175], a[108:111], v[84:87], v[172:175]
  v_exp_f32 v9, v57
  v_mfma_f32_16x16x32_bf16 v[204:207], a[108:111], v[88:91], v[204:207]
  v_exp_f32 v10, v58
  v_mfma_f32_16x16x32_bf16 v[236:239], a[108:111], v[92:95], v[236:239]
  ds_read_b128 a[88:91], v4 offset:14336
  v_mfma_f32_16x16x32_bf16 v[144:147], a[112:115], v[80:83], v[144:147]
  v_exp_f32 v11, v59
  v_mfma_f32_16x16x32_bf16 v[176:179], a[112:115], v[84:87], v[176:179]
  v_cvt_pk_bf16_f32 v76, v8, v9
  v_cvt_pk_bf16_f32 v77, v10, v11
  v_mfma_f32_16x16x32_bf16 v[208:211], a[112:115], v[88:91], v[208:211]
  ds_read_b128 a[92:95], v4 offset:15360
  v_or3_b32 v5, v5, v76, v77
  v_mfma_f32_16x16x32_bf16 v[240:243], a[112:115], v[92:95], v[240:243]
  v_exp_f32 v12, v60
  v_mfma_f32_16x16x32_bf16 v[148:151], a[116:119], v[80:83], v[148:151]
  v_exp_f32 v13, v61
  v_mfma_f32_16x16x32_bf16 v[180:183], a[116:119], v[84:87], v[180:183]
  v_exp_f32 v14, v62
  v_mfma_f32_16x16x32_bf16 v[212:215], a[116:119], v[88:91], v[212:215]
  v_exp_f32 v15, v63
  v_mfma_f32_16x16x32_bf16 v[244:247], a[116:119], v[92:95], v[244:247]
  v_cvt_pk_bf16_f32 v78, v12, v13
  v_cvt_pk_bf16_f32 v79, v14, v15
  v_mfma_f32_16x16x32_bf16 v[152:155], a[120:123], v[80:83], v[152:155]
  v_or3_b32 v5, v5, v78, v79
  v_and_b32 v5, s70, v5
  v_mfma_f32_16x16x32_bf16 v[184:187], a[120:123], v[84:87], v[184:187]
  v_cmp_ne_u32 vcc, 0, v5
  v_cmp_gt_i32 s[80:81], 32, v25
  v_mfma_f32_16x16x32_bf16 v[216:219], a[120:123], v[88:91], v[216:219]
  v_cmp_gt_i32 s[82:83], 33, v25
  v_cmp_gt_i32 s[84:85], 34, v25
  v_mfma_f32_16x16x32_bf16 v[248:251], a[120:123], v[92:95], v[248:251]
  v_cmp_gt_i32 s[86:87], 35, v25
  v_cndmask_b32 v104, v104, v24, s[80:81]
  v_mfma_f32_16x16x32_bf16 v[156:159], a[124:127], v[80:83], v[156:159]
  v_cndmask_b32 v105, v105, v24, s[82:83]
  v_cndmask_b32 v106, v106, v24, s[84:85]
  v_mfma_f32_16x16x32_bf16 v[188:191], a[124:127], v[84:87], v[188:191]
  v_cndmask_b32 v107, v107, v24, s[86:87]
  v_cmp_gt_i32 s[80:81], 48, v25
  v_mfma_f32_16x16x32_bf16 v[220:223], a[124:127], v[88:91], v[220:223]
  v_cmp_gt_i32 s[82:83], 49, v25
  v_cmp_gt_i32 s[84:85], 50, v25
  v_mfma_f32_16x16x32_bf16 v[252:255], a[124:127], v[92:95], v[252:255]
  v_cmp_gt_i32 s[86:87], 51, v25
  v_cndmask_b32 v108, v108, v24, s[80:81]
  v_cndmask_b32 v109, v109, v24, s[82:83]
  v_cndmask_b32 v110, v110, v24, s[84:85]
  v_cndmask_b32 v111, v111, v24, s[86:87]
  v_add_u32 v4, 0x4000, v4
  v_and_b32 v4, 0x1ffff, v4
  s_cbranch_vccnz L_a_d2_t
L_a_d2_r:
L_a_d3:
  s_waitcnt vmcnt(24) lgkmcnt(0)
  v_mfma_f32_16x16x32_bf16 v[40:43], a[64:67], a[16:19], v[104:107]
  s_barrier
  ds_read_b128 a[96:99], v4 offset:0
  v_mfma_f32_16x16x32_bf16 v[40:43], a[72:75], a[20:23], v[40:43]
  s_nop 0
  ds_read_b128 a[100:103], v4 offset:1024
  v_mfma_f32_16x16x32_bf16 v[40:43], a[80:83], a[24:27], v[40:43]
  s_nop 0
  ds_read_b128 a[104:107], v4 offset:2048
  v_mfma_f32_16x16x32_bf16 v[40:43], a[88:91], a[28:31], v[40:43]
  s_nop 0
  ds_read_b128 a[108:111], v4 offset:3072
  v_mfma_f32_16x16x32_bf16 v[44:47], a[68:71], a[16:19], v[108:111]
  s_nop 0
  ds_read_b128 a[112:115], v4 offset:4096
  v_mfma_f32_16x16x32_bf16 v[44:47], a[76:79], a[20:23], v[44:47]
  s_nop 0
  ds_read_b128 a[116:119], v4 offset:5120
  v_mfma_f32_16x16x32_bf16 v[44:47], a[84:87], a[24:27], v[44:47]
  s_nop 0
  ds_read_b128 a[120:123], v4 offset:6144
  v_mfma_f32_16x16x32_bf16 v[44:47], a[92:95], a[28:31], v[44:47]
  s_nop 0
  ds_read_b128 a[124:127], v4 offset:7168
  v_mfma_f32_16x16x32_bf16 v[48:51], a[64:67], a[32:35], v[112:115]
  s_add_u32 m0, s73, 16384
  s_add_u32 s66, s72, 128
  buffer_load_dwordx4 v26, s[48:51], s66 offen lds
  v_mfma_f32_16x16x32_bf16 v[48:51], a[72:75], a[36:39], v[48:51]
  s_add_u32 m0, s73, 17408
  s_add_u32 s66, s72, 8320
  buffer_load_dwordx4 v26, s[48:51], s66 offen lds
  v_mfma_f32_16x16x32_bf16 v[48:51], a[80:83], a[40:43], v[48:51]
  s_add_u32 m0, s73, 18432
  s_add_u32 s66, s72, 16512
  buffer_load_dwordx4 v26, s[48:51], s66 offen lds
  v_mfma_f32_16x16x32_bf16 v[48:51], a[88:91], a[44:47], v[48:51]
  s_add_u32 m0, s73, 19456
  s_add_u32 s66, s72, 24704
  buffer_load_dwordx4 v26, s[48:51], s66 offen lds
  v_mfma_f32_16x16x32_bf16 v[52:55], a[68:71], a[32:35], v[116:119]
  s_add_u32 s58, s58, 1
  v_exp_f32 v8, v40
  v_mfma_f32_16x16x32_bf16 v[52:55], a[76:79], a[36:39], v[52:55]
  s_nop 0
  v_exp_f32 v9, v41
  v_mfma_f32_16x16x32_bf16 v[52:55], a[84:87], a[40:43], v[52:55]
  s_nop 0
  v_exp_f32 v10, v42
  v_mfma_f32_16x16x32_bf16 v[52:55], a[92:95], a[44:47], v[52:55]
  s_nop 0
  v_exp_f32 v11, v43
  v_mfma_f32_16x16x32_bf16 v[56:59], a[64:67], a[48:51], v[120:123]
  s_nop 0
  v_cvt_pk_bf16_f32 v84, v8, v9
  v_cvt_pk_bf16_f32 v85, v10, v11
  v_mfma_f32_16x16x32_bf16 v[56:59], a[72:75], a[52:55], v[56:59]
  s_nop 0
  v_or_b32 v5, v84, v85
  v_mfma_f32_16x16x32_bf16 v[56:59], a[80:83], a[56:59], v[56:59]
  s_nop 0
  v_exp_f32 v12, v44
  v_mfma_f32_16x16x32_bf16 v[56:59], a[88:91], a[60:63], v[56:59]
  s_nop 0
  v_exp_f32 v13, v45
  v_mfma_f32_16x16x32_bf16 v[60:63], a[68:71], a[48:51], v[124:127]
  s_nop 0
  v_exp_f32 v14, v46
  v_mfma_f32_16x16x32_bf16 v[60:63], a[76:79], a[52:55], v[60:63]
  s_nop 0
  v_exp_f32 v15, v47
  v_mfma_f32_16x16x32_bf16 v[60:63], a[84:87], a[56:59], v[60:63]
  s_nop 0
  v_cvt_pk_bf16_f32 v86, v12, v13
  v_cvt_pk_bf16_f32 v87, v14, v15
  v_mfma_f32_16x16x32_bf16 v[60:63], a[92:95], a[60:63], v[60:63]
  s_nop 0
  v_or3_b32 v5, v5, v86, v87
  v_mfma_f32_16x16x32_bf16 a[132:135], v[16:19], v[68:71], a[132:135]
  s_nop 0
  ds_read_b128 a[64:67], v4 offset:8192
  v_mfma_f32_16x16x32_bf16 a[136:139], v[16:19], v[72:75], a[136:139]
  s_nop 0
  ds_read_b128 a[68:71], v4 offset:9216
  v_mfma_f32_16x16x32_bf16 a[140:143], v[16:19], v[76:79], a[140:143]
  s_nop 0
  ds_read_b128 a[72:75], v4 offset:10240
  s_waitcnt lgkmcnt(3)
  v_mfma_f32_16x16x32_bf16 v[160:163], a[96:99], v[68:71], v[160:163]
  s_nop 0
  ds_read_b128 a[76:79], v4 offset:11264
  v_mfma_f32_16x16x32_bf16 v[192:195], a[96:99], v[72:75], v[192:195]
  ds_read_b128 a[80:83], v4 offset:12288
  v_mfma_f32_16x16x32_bf16 v[224:227], a[96:99], v[76:79], v[224:227]
  ds_read_b128 a[84:87], v4 offset:13312
  v_mfma_f32_16x16x32_bf16 v[164:167], a[100:103], v[68:71], v[164:167]
  ds_read_b128 a[88:91], v4 offset:14336
  v_mfma_f32_16x16x32_bf16 v[196:199], a[100:103], v[72:75], v[196:199]
  ds_read_b128 a[92:95], v4 offset:15360
  v_mfma_f32_16x16x32_bf16 v[228:231], a[100:103], v[76:79], v[228:231]
  v_exp_f32 v8, v48
  v_mfma_f32_16x16x32_bf16 v[168:171], a[104:107], v[68:71], v[168:171]
  v_exp_f32 v9, v49
  v_mfma_f32_16x16x32_bf16 v[200:203], a[104:107], v[72:75], v[200:203]
  v_exp_f32 v10, v50
  v_mfma_f32_16x16x32_bf16 v[232:235], a[104:107], v[76:79], v[232:235]
  v_exp_f32 v11, v51
  v_mfma_f32_16x16x32_bf16 v[172:175], a[108:111], v[68:71], v[172:175]
  v_cvt_pk_bf16_f32 v88, v8, v9
  v_cvt_pk_bf16_f32 v89, v10, v11
  v_mfma_f32_16x16x32_bf16 v[204:207], a[108:111], v[72:75], v[204:207]
  v_or3_b32 v5, v5, v88, v89
  v_mfma_f32_16x16x32_bf16 v[236:239], a[108:111], v[76:79], v[236:239]
  v_exp_f32 v12, v52
  v_mfma_f32_16x16x32_bf16 v[176:179], a[112:115], v[68:71], v[176:179]
  v_exp_f32 v13, v53
  v_mfma_f32_16x16x32_bf16 v[208:211], a[112:115], v[72:75], v[208:211]
  v_exp_f32 v14, v54
  v_mfma_f32_16x16x32_bf16 v[240:243], a[112:115], v[76:79], v[240:243]
  v_exp_f32 v15, v55
  v_mfma_f32_16x16x32_bf16 v[180:183], a[116:119], v[68:71], v[180:183]
  v_cvt_pk_bf16_f32 v90, v12, v13
  v_cvt_pk_bf16_f32 v91, v14, v15
  v_mfma_f32_16x16x32_bf16 v[212:215], a[116:119], v[72:75], v[212:215]
  v_or3_b32 v5, v5, v90, v91
  v_mfma_f32_16x16x32_bf16 v[244:247], a[116:119], v[76:79], v[244:247]
  v_exp_f32 v8, v56
  v_mfma_f32_16x16x32_bf16 v[184:187], a[120:123], v[68:71], v[184:187]
  v_exp_f32 v9, v57
  v_mfma_f32_16x16x32_bf16 v[216:219], a[120:123], v[72:75], v[216:219]
  v_exp_f32 v10, v58
  v_mfma_f32_16x16x32_bf16 v[248:251], a[120:123], v[76:79], v[248:251]
  v_exp_f32 v11, v59
  v_mfma_f32_16x16x32_bf16 v[188:191], a[124:127], v[68:71], v[188:191]
  v_cvt_pk_bf16_f32 v92, v8, v9
  v_cvt_pk_bf16_f32 v93, v10, v11
  v_mfma_f32_16x16x32_bf16 v[220:223], a[124:127], v[72:75], v[220:223]
  v_or3_b32 v5, v5, v92, v93
  v_mfma_f32_16x16x32_bf16 v[252:255], a[124:127], v[76:79], v[252:255]
  v_exp_f32 v12, v60
  v_exp_f32 v13, v61
  v_exp_f32 v14, v62
  v_exp_f32 v15, v63
  s_nop 0
  v_cvt_pk_bf16_f32 v94, v12, v13
  v_cvt_pk_bf16_f32 v95, v14, v15
  v_or3_b32 v5, v5, v94, v95
  v_and_b32 v5, s70, v5
  v_cmp_ne_u32 vcc, 0, v5
  v_cmp_gt_i32 s[80:81], 0, v25
  v_cmp_gt_i32 s[82:83], 1, v25
  v_cmp_gt_i32 s[84:85], 2, v25
  v_cmp_gt_i32 s[86:87], 3, v25
  v_cndmask_b32 v112, v112, v24, s[80:81]
  v_cndmask_b32 v113, v113, v24, s[82:83]
  v_cndmask_b32 v114, v114, v24, s[84:85]
  v_cndmask_b32 v115, v115, v24, s[86:87]
  v_cmp_gt_i32 s[80:81], 16, v25
  v_cmp_gt_i32 s[82:83], 17, v25
  v_cmp_gt_i32 s[84:85], 18, v25
  v_cmp_gt_i32 s[86:87], 19, v25
  v_cndmask_b32 v116, v116, v24, s[80:81]
  v_cndmask_b32 v117, v117, v24, s[82:83]
  v_cndmask_b32 v118, v118, v24, s[84:85]
  v_cndmask_b32 v119, v119, v24, s[86:87]
  v_add_u32 v4, 0x4000, v4
  v_and_b32 v4, 0x1ffff, v4
  s_cbranch_vccnz L_a_d3_t
L_a_d3_r:
L_a_d4:
  s_waitcnt vmcnt(24) lgkmcnt(0)
  v_mfma_f32_16x16x32_bf16 v[48:51], a[64:67], a[32:35], v[112:115]
  s_barrier
  ds_read_b128 a[96:99], v4 offset:0
  v_mfma_f32_16x16x32_bf16 v[48:51], a[72:75], a[36:39], v[48:51]
  s_nop 0
  ds_read_b128 a[100:103], v4 offset:1024
  v_mfma_f32_16x16x32_bf16 v[48:51], a[80:83], a[40:43], v[48:51]
  s_nop 0
  ds_read_b128 a[104:107], v4 offset:2048
  v_mfma_f32_16x16x32_bf16 v[48:51], a[88:91], a[44:47], v[48:51]
  s_nop 0
  ds_read_b128 a[108:111], v4 offset:3072
  v_mfma_f32_16x16x32_bf16 v[52:55], a[68:71], a[32:35], v[116:119]
  s_nop 0
  ds_read_b128 a[112:115], v4 offset:4096
  v_mfma_f32_16x16x32_bf16 v[52:55], a[76:79], a[36:39], v[52:55]
  s_nop 0
  ds_read_b128 a[116:119], v4 offset:5120
  v_mfma_f32_16x16x32_bf16 v[52:55], a[84:87], a[40:43], v[52:55]
  s_nop 0
  ds_read_b128 a[120:123], v4 offset:6144
  v_mfma_f32_16x16x32_bf16 v[52:55], a[92:95], a[44:47], v[52:55]
  s_nop 0
  ds_read_b128 a[124:127], v4 offset:7168
  v_mfma_f32_16x16x32_bf16 v[56:59], a[64:67], a[48:51], v[120:123]
  s_add_u32 m0, s73, 32768
  s_add_u32 s66, s72, 256
  buffer_load_dwordx4 v26, s[48:51], s66 offen lds
  v_mfma_f32_16x16x32_bf16 v[56:59], a[72:75], a[52:55], v[56:59]
  s_add_u32 m0, s73, 33792
  s_add_u32 s66, s72, 8448
  buffer_load_dwordx4 v26, s[48:51], s66 offen lds
  v_mfma_f32_16x16x32_bf16 v[56:59], a[80:83], a[56:59], v[56:59]
  s_add_u32 m0, s73, 34816
  s_add_u32 s66, s72, 16640
  buffer_load_dwordx4 v26, s[48:51], s66 offen lds
  v_mfma_f32_16x16x32_bf16 v[56:59], a[88:91], a[60:63], v[56:59]
  s_add_u32 m0, s73, 35840
  s_add_u32 s66, s72, 24832
  buffer_load_dwordx4 v26, s[48:51], s66 offen lds
  v_mfma_f32_16x16x32_bf16 v[60:63], a[68:71], a[48:51], v[124:127]
  s_add_u32 s58, s58, 1
  v_exp_f32 v8, v48
  v_mfma_f32_16x16x32_bf16 v[60:63], a[76:79], a[52:55], v[60:63]
  s_nop 0
  v_exp_f32 v9, v49
  v_mfma_f32_16x16x32_bf16 v[60:63], a[84:87], a[56:59], v[60:63]
  s_nop 0
  v_exp_f32 v10, v50
  v_mfma_f32_16x16x32_bf16 v[60:63], a[92:95], a[60:63], v[60:63]
  s_nop 0
  v_exp_f32 v11, v51
  v_mfma_f32_16x16x32_bf16 a[132:135], v[16:19], v[84:87], a[132:135]
  s_nop 0
  ds_read_b128 a[64:67], v4 offset:8192
  v_cvt_pk_bf16_f32 v72, v8, v9
  v_mfma_f32_16x16x32_bf16 a[136:139], v[16:19], v[88:91], a[136:139]
  s_nop 0
  ds_read_b128 a[68:71], v4 offset:9216
  v_cvt_pk_bf16_f32 v73, v10, v11
  v_mfma_f32_16x16x32_bf16 a[140:143], v[16:19], v[92:95], a[140:143]
  s_nop 0
  ds_read_b128 a[72:75], v4 offset:10240
  v_or_b32 v5, v72, v73
  s_waitcnt lgkmcnt(3)
  v_mfma_f32_16x16x32_bf16 v[160:163], a[96:99], v[84:87], v[160:163]
  s_nop 0
  ds_read_b128 a[76:79], v4 offset:11264
  v_mfma_f32_16x16x32_bf16 v[192:195], a[96:99], v[88:91], v[192:195]
  ds_read_b128 a[80:83], v4 offset:12288
  v_mfma_f32_16x16x32_bf16 v[224:227], a[96:99], v[92:95], v[224:227]
  ds_read_b128 a[84:87], v4 offset:13312
  v_mfma_f32_16x16x32_bf16 v[164:167], a[100:103], v[84:87], v[164:167]
  ds_read_b128 a[88:91], v4 offset:14336
  v_mfma_f32_16x16x32_bf16 v[196:199], a[100:103], v[88:91], v[196:199]
  ds_read_b128 a[92:95], v4 offset:15360
  v_mfma_f32_16x16x32_bf16 v[228:231], a[100:103], v[92:95], v[228:231]
  v_exp_f32 v12, v52
  v_mfma_f32_16x16x32_bf16 v[168:171], a[104:107], v[84:87], v[168:171]
  v_exp_f32 v13, v53
  v_mfma_f32_16x16x32_bf16 v[200:203], a[104:107], v[88:91], v[200:203]
  v_exp_f32 v14, v54
  v_mfma_f32_16x16x32_bf16 v[232:235], a[104:107], v[92:95], v[232:235]
  v_exp_f32 v15, v55
  v_mfma_f32_16x16x32_bf16 v[172:175], a[108:111], v[84:87], v[172:175]
  v_cvt_pk_bf16_f32 v74, v12, v13
  v_cvt_pk_bf16_f32 v75, v14, v15
  v_mfma_f32_16x16x32_bf16 v[204:207], a[108:111], v[88:91], v[204:207]
  v_or3_b32 v5, v5, v74, v75
  v_mfma_f32_16x16x32_bf16 v[236:239], a[108:111], v[92:95], v[236:239]
  v_exp_f32 v8, v56
  v_mfma_f32_16x16x32_bf16 v[176:179], a[112:115], v[84:87], v[176:179]
  v_exp_f32 v9, v57
  v_mfma_f32_16x16x32_bf16 v[208:211], a[112:115], v[88:91], v[208:211]
  v_exp_f32 v10, v58
  v_mfma_f32_16x16x32_bf16 v[240:243], a[112:115], v[92:95], v[240:243]
  v_exp_f32 v11, v59
  v_mfma_f32_16x16x32_bf16 v[180:183], a[116:119], v[84:87], v[180:183]
  v_cvt_pk_bf16_f32 v76, v8, v9
  v_cvt_pk_bf16_f32 v77, v10, v11
  v_mfma_f32_16x16x32_bf16 v[212:215], a[116:119], v[88:91], v[212:215]
  v_or3_b32 v5, v5, v76, v77
  v_mfma_f32_16x16x32_bf16 v[244:247], a[116:119], v[92:95], v[244:247]
  v_exp_f32 v12, v60
  v_mfma_f32_16x16x32_bf16 v[184:187], a[120:123], v[84:87], v[184:187]
  v_exp_f32 v13, v61
  v_mfma_f32_16x16x32_bf16 v[216:219], a[120:123], v[88:91], v[216:219]
  v_exp_f32 v14, v62
  v_mfma_f32_16x16x32_bf16 v[248:251], a[120:123], v[92:95], v[248:251]
  v_exp_f32 v15, v63
  v_mfma_f32_16x16x32_bf16 v[188:191], a[124:127], v[84:87], v[188:191]
  v_cvt_pk_bf16_f32 v78, v12, v13
  v_cvt_pk_bf16_f32 v79, v14, v15
  v_mfma_f32_16x16x32_bf16 v[220:223], a[124:127], v[88:91], v[220:223]
  v_or3_b32 v5, v5, v78, v79
  v_and_b32 v5, s70, v5
  v_mfma_f32_16x16x32_bf16 v[252:255], a[124:127], v[92:95], v[252:255]
  v_cmp_ne_u32 vcc, 0, v5
  v_cmp_gt_i32 s[80:81], 32, v25
  v_cmp_gt_i32 s[82:83], 33, v25
  v_cmp_gt_i32 s[84:85], 34, v25
  v_cmp_gt_i32 s[86:87], 35, v25
  v_cndmask_b32 v112, v112, v24, s[80:81]
  v_cndmask_b32 v113, v113, v24, s[82:83]
  v_cndmask_b32 v114, v114, v24, s[84:85]
  v_cndmask_b32 v115, v115, v24, s[86:87]
  v_cmp_gt_i32 s[80:81], 48, v25
  v_cmp_gt_i32 s[82:83], 49, v25
  v_cmp_gt_i32 s[84:85], 50, v25
  v_cmp_gt_i32 s[86:87], 51, v25
  v_cndmask_b32 v116, v116, v24, s[80:81]
  v_cndmask_b32 v117, v117, v24, s[82:83]
  v_cndmask_b32 v118, v118, v24, s[84:85]
  v_cndmask_b32 v119, v119, v24, s[86:87]
  v_add_u32 v4, 0x4000, v4
  v_and_b32 v4, 0x1ffff, v4
  s_cbranch_vccnz L_a_d4_t
L_a_d4_r:
L_a_d5:
  s_waitcnt vmcnt(24) lgkmcnt(0)
  v_mfma_f32_16x16x32_bf16 v[48:51], a[64:67], a[32:35], v[112:115]
  s_barrier
  ds_read_b128 a[96:99], v4 offset:0
  v_mfma_f32_16x16x32_bf16 v[48:51], a[72:75], a[36:39], v[48:51]
  s_nop 0
  ds_read_b128 a[100:103], v4 offset:1024
  v_mfma_f32_16x16x32_bf16 v[48:51], a[80:83], a[40:43], v[48:51]
  s_nop 0
  ds_read_b128 a[104:107], v4 offset:2048
  v_mfma_f32_16x16x32_bf16 v[48:51], a[88:91], a[44:47], v[48:51]
  s_nop 0
  ds_read_b128 a[108:111], v4 offset:3072
  v_mfma_f32_16x16x32_bf16 v[52:55], a[68:71], a[32:35], v[116:119]
  s_nop 0
  ds_read_b128 a[112:115], v4 offset:4096
  v_mfma_f32_16x16x32_bf16 v[52:55], a[76:79], a[36:39], v[52:55]
  s_nop 0
  ds_read_b128 a[116:119], v4 offset:5120
  v_mfma_f32_16x16x32_bf16 v[52:55], a[84:87], a[40:43], v[52:55]
  s_nop 0
  ds_read_b128 a[120:123], v4 offset:6144
  v_mfma_f32_16x16x32_bf16 v[52:55], a[92:95], a[44:47], v[52:55]
  s_nop 0
  ds_read_b128 a[124:127], v4 offset:7168
  v_mfma_f32_16x16x32_bf16 v[56:59], a[64:67], a[48:51], v[120:123]
  s_add_u32 m0, s73, 49152
  s_add_u32 s66, s72, 384
  buffer_load_dwordx4 v26, s[48:51], s66 offen lds
  v_mfma_f32_16x16x32_bf16 v[56:59], a[72:75], a[52:55], v[56:59]
  s_add_u32 m0, s73, 50176
  s_add_u32 s66, s72, 8576
  buffer_load_dwordx4 v26, s[48:51], s66 offen lds
  v_mfma_f32_16x16x32_bf16 v[56:59], a[80:83], a[56:59], v[56:59]
  s_add_u32 m0, s73, 51200
  s_add_u32 s66, s72, 16768
  buffer_load_dwordx4 v26, s[48:51], s66 offen lds
  v_mfma_f32_16x16x32_bf16 v[56:59], a[88:91], a[60:63], v[56:59]
  s_add_u32 m0, s73, 52224
  s_add_u32 s66, s72, 24960
  buffer_load_dwordx4 v26, s[48:51], s66 offen lds
  v_mfma_f32_16x16x32_bf16 v[60:63], a[68:71], a[48:51], v[124:127]
  s_add_u32 s58, s58, 1
  v_exp_f32 v8, v48
  v_mfma_f32_16x16x32_bf16 v[60:63], a[76:79], a[52:55], v[60:63]
  s_nop 0
  v_exp_f32 v9, v49
  v_mfma_f32_16x16x32_bf16 v[60:63], a[84:87], a[56:59], v[60:63]
  s_nop 0
  v_exp_f32 v10, v50
  v_mfma_f32_16x16x32_bf16 v[60:63], a[92:95], a[60:63], v[60:63]
  s_nop 0
  v_exp_f32 v11, v51
  v_mfma_f32_16x16x32_bf16 a[136:139], v[16:19], v[72:75], a[136:139]
  s_nop 0
  ds_read_b128 a[64:67], v4 offset:8192
  v_cvt_pk_bf16_f32 v88, v8, v9
  v_mfma_f32_16x16x32_bf16 a[140:143], v[16:19], v[76:79], a[140:143]
  s_nop 0
  ds_read_b128 a[68:71], v4 offset:9216
  v_cvt_pk_bf16_f32 v89, v10, v11
  s_waitcnt lgkmcnt(2)
  v_mfma_f32_16x16x32_bf16 v[192:195], a[96:99], v[72:75], v[192:195]
  s_nop 0
  ds_read_b128 a[72:75], v4 offset:10240
  v_or_b32 v5, v88, v89
  v_mfma_f32_16x16x32_bf16 v[224:227], a[96:99], v[76:79], v[224:227]
  s_nop 0
  ds_read_b128 a[76:79], v4 offset:11264
  v_mfma_f32_16x16x32_bf16 v[196:199], a[100:103], v[72:75], v[196:199]
  ds_read_b128 a[80:83], v4 offset:12288
  v_mfma_f32_16x16x32_bf16 v[228:231], a[100:103], v[76:79], v[228:231]
  ds_read_b128 a[84:87], v4 offset:13312
  v_mfma_f32_16x16x32_bf16 v[200:203], a[104:107], v[72:75], v[200:203]
  ds_read_b128 a[88:91], v4 offset:14336
  v_mfma_f32_16x16x32_bf16 v[232:235], a[104:107], v[76:79], v[232:235]
  ds_read_b128 a[92:95], v4 offset:15360
  v_mfma_f32_16x16x32_bf16 v[204:207], a[108:111], v[72:75], v[204:207]
  v_exp_f32 v12, v52
  v_mfma_f32_16x16x32_bf16 v[236:239], a[108:111], v[76:79], v[236:239]
  v_exp_f32 v13, v53
  v_mfma_f32_16x16x32_bf16 v[208:211], a[112:115], v[72:75], v[208:211]
  v_exp_f32 v14, v54
  v_mfma_f32_16x16x32_bf16 v[240:243], a[112:115], v[76:79], v[240:243]
  v_exp_f32 v15, v55
  v_mfma_f32_16x16x32_bf16 v[212:215], a[116:119], v[72:75], v[212:215]
  v_cvt_pk_bf16_f32 v90, v12, v13
  v_cvt_pk_bf16_f32 v91, v14, v15
  v_mfma_f32_16x16x32_bf16 v[244:247], a[116:119], v[76:79], v[244:247]
  v_or3_b32 v5, v5, v90, v91
  v_mfma_f32_16x16x32_bf16 v[216:219], a[120:123], v[72:75], v[216:219]
  v_exp_f32 v8, v56
  v_mfma_f32_16x16x32_bf16 v[248:251], a[120:123], v[76:79], v[248:251]
  v_exp_f32 v9, v57
  v_mfma_f32_16x16x32_bf16 v[220:223], a[124:127], v[72:75], v[220:223]
  v_exp_f32 v10, v58
  v_mfma_f32_16x16x32_bf16 v[252:255], a[124:127], v[76:79], v[252:255]
  v_exp_f32 v11, v59
  s_nop 0
  v_cvt_pk_bf16_f32 v92, v8, v9
  v_cvt_pk_bf16_f32 v93, v10, v11
  v_or3_b32 v5, v5, v92, v93
  v_exp_f32 v12, v60
  v_exp_f32 v13, v61
  v_exp_f32 v14, v62
  v_exp_f32 v15, v63
  s_nop 0
  v_cvt_pk_bf16_f32 v94, v12, v13
  v_cvt_pk_bf16_f32 v95, v14, v15
  v_or3_b32 v5, v5, v94, v95
  v_and_b32 v5, s70, v5
  v_cmp_ne_u32 vcc, 0, v5
  v_cmp_gt_i32 s[80:81], 0, v25
  v_cmp_gt_i32 s[82:83], 1, v25
  v_cmp_gt_i32 s[84:85], 2, v25
  v_cmp_gt_i32 s[86:87], 3, v25
  v_cndmask_b32 v120, v120, v24, s[80:81]
  v_cndmask_b32 v121, v121, v24, s[82:83]
  v_cndmask_b32 v122, v122, v24, s[84:85]
  v_cndmask_b32 v123, v123, v24, s[86:87]
  v_cmp_gt_i32 s[80:81], 16, v25
  v_cmp_gt_i32 s[82:83], 17, v25
  v_cmp_gt_i32 s[84:85], 18, v25
  v_cmp_gt_i32 s[86:87], 19, v25
  v_cndmask_b32 v124, v124, v24, s[80:81]
  v_cndmask_b32 v125, v125, v24, s[82:83]
  v_cndmask_b32 v126, v126, v24, s[84:85]
  v_cndmask_b32 v127, v127, v24, s[86:87]
  v_add_u32 v4, 0x4000, v4
  v_and_b32 v4, 0x1ffff, v4
  s_cbranch_vccnz L_a_d5_t
L_a_d5_r:
L_a_d6:
  s_waitcnt vmcnt(24) lgkmcnt(0)
  v_mfma_f32_16x16x32_bf16 v[56:59], a[64:67], a[48:51], v[120:123]
  s_barrier
  ds_read_b128 a[96:99], v4 offset:0
  v_mfma_f32_16x16x32_bf16 v[56:59], a[72:75], a[52:55], v[56:59]
  s_nop 0
  ds_read_b128 a[100:103], v4 offset:1024
  v_mfma_f32_16x16x32_bf16 v[56:59], a[80:83], a[56:59], v[56:59]
  s_nop 0
  ds_read_b128 a[104:107], v4 offset:2048
  v_mfma_f32_16x16x32_bf16 v[56:59], a[88:91], a[60:63], v[56:59]
  s_nop 0
  ds_read_b128 a[108:111], v4 offset:3072
  v_mfma_f32_16x16x32_bf16 v[60:63], a[68:71], a[48:51], v[124:127]
  s_nop 0
  ds_read_b128 a[112:115], v4 offset:4096
  v_mfma_f32_16x16x32_bf16 v[60:63], a[76:79], a[52:55], v[60:63]
  s_nop 0
  ds_read_b128 a[116:119], v4 offset:5120
  v_mfma_f32_16x16x32_bf16 v[60:63], a[84:87], a[56:59], v[60:63]
  s_nop 0
  ds_read_b128 a[120:123], v4 offset:6144
  v_mfma_f32_16x16x32_bf16 v[60:63], a[92:95], a[60:63], v[60:63]
  s_nop 0
  ds_read_b128 a[124:127], v4 offset:7168
  v_mfma_f32_16x16x32_bf16 a[136:139], v[16:19], v[88:91], a[136:139]
  s_add_u32 m0, s73, 65536
  s_add_u32 s66, s72, 512
  buffer_load_dwordx4 v26, s[48:51], s66 offen lds
  v_mfma_f32_16x16x32_bf16 a[140:143], v[16:19], v[92:95], a[140:143]
  s_add_u32 m0, s73, 66560
  s_add_u32 s66, s72, 8704
  buffer_load_dwordx4 v26, s[48:51], s66 offen lds
  s_waitcnt lgkmcnt(0)
  v_mfma_f32_16x16x32_bf16 v[192:195], a[96:99], v[88:91], v[192:195]
  s_add_u32 m0, s73, 67584
  s_add_u32 s66, s72, 16896
  buffer_load_dwordx4 v26, s[48:51], s66 offen lds
  v_mfma_f32_16x16x32_bf16 v[224:227], a[96:99], v[92:95], v[224:227]
  s_add_u32 m0, s73, 68608
  s_add_u32 s66, s72, 25088
  buffer_load_dwordx4 v26, s[48:51], s66 offen lds
  v_mfma_f32_16x16x32_bf16 v[196:199], a[100:103], v[88:91], v[196:199]
  s_add_u32 s58, s58, 1
  ds_read_b128 a[64:67], v4 offset:8192
  v_mfma_f32_16x16x32_bf16 v[228:231], a[100:103], v[92:95], v[228:231]
  ds_read_b128 a[68:71], v4 offset:9216
  v_mfma_f32_16x16x32_bf16 v[200:203], a[104:107], v[88:91], v[200:203]
  ds_read_b128 a[72:75], v4 offset:10240
  v_mfma_f32_16x16x32_bf16 v[232:235], a[104:107], v[92:95], v[232:235]
  ds_read_b128 a[76:79], v4 offset:11264
  v_mfma_f32_16x16x32_bf16 v[204:207], a[108:111], v[88:91], v[204:207]
  ds_read_b128 a[80:83], v4 offset:12288
  v_mfma_f32_16x16x32_bf16 v[236:239], a[108:111], v[92:95], v[236:239]
  ds_read_b128 a[84:87], v4 offset:13312
  v_mfma_f32_16x16x32_bf16 v[208:211], a[112:115], v[88:91], v[208:211]
  ds_read_b128 a[88:91], v4 offset:14336
  v_mfma_f32_16x16x32_bf16 v[240:243], a[112:115], v[92:95], v[240:243]
  ds_read_b128 a[92:95], v4 offset:15360
  v_mfma_f32_16x16x32_bf16 v[212:215], a[116:119], v[88:91], v[212:215]
  v_exp_f32 v8, v56
  v_mfma_f32_16x16x32_bf16 v[244:247], a[116:119], v[92:95], v[244:247]
  v_exp_f32 v9, v57
  v_mfma_f32_16x16x32_bf16 v[216:219], a[120:123], v[88:91], v[216:219]
  v_exp_f32 v10, v58
  v_mfma_f32_16x16x32_bf16 v[248:251], a[120:123], v[92:95], v[248:251]
  v_exp_f32 v11, v59
  v_mfma_f32_16x16x32_bf16 v[220:223], a[124:127], v[88:91], v[220:223]
  v_cvt_pk_bf16_f32 v76, v8, v9
  v_cvt_pk_bf16_f32 v77, v10, v11
  v_mfma_f32_16x16x32_bf16 v[252:255], a[124:127], v[92:95], v[252:255]
  v_or_b32 v5, v76, v77
  v_exp_f32 v12, v60
  v_exp_f32 v13, v61
  v_exp_f32 v14, v62
  v_exp_f32 v15, v63
  s_nop 0
  v_cvt_pk_bf16_f32 v78, v12, v13
  v_cvt_pk_bf16_f32 v79, v14, v15
  v_or3_b32 v5, v5, v78, v79
  v_and_b32 v5, s70, v5
  v_cmp_ne_u32 vcc, 0, v5
  v_cmp_gt_i32 s[80:81], 32, v25
  v_cmp_gt_i32 s[82:83], 33, v25
  v_cmp_gt_i32 s[84:85], 34, v25
  v_cmp_gt_i32 s[86:87], 35, v25
  v_cndmask_b32 v120, v120, v24, s[80:81]
  v_cndmask_b32 v121, v121, v24, s[82:83]
  v_cndmask_b32 v122, v122, v24, s[84:85]
  v_cndmask_b32 v123, v123, v24, s[86:87]
  v_cmp_gt_i32 s[80:81], 48, v25
  v_cmp_gt_i32 s[82:83], 49, v25
  v_cmp_gt_i32 s[84:85], 50, v25
  v_cmp_gt_i32 s[86:87], 51, v25
  v_cndmask_b32 v124, v124, v24, s[80:81]
  v_cndmask_b32 v125, v125, v24, s[82:83]
  v_cndmask_b32 v126, v126, v24, s[84:85]
  v_cndmask_b32 v127, v127, v24, s[86:87]
  v_add_u32 v4, 0x4000, v4
  v_and_b32 v4, 0x1ffff, v4
  s_cbranch_vccnz L_a_d6_t
L_a_d6_r:
L_a_d7:
  s_waitcnt vmcnt(24) lgkmcnt(0)
  v_mfma_f32_16x16x32_bf16 v[56:59], a[64:67], a[48:51], v[120:123]
  s_barrier
  ds_read_b128 a[96:99], v4 offset:0
  v_mfma_f32_16x16x32_bf16 v[56:59], a[72:75], a[52:55], v[56:59]
  s_nop 0
  ds_read_b128 a[100:103], v4 offset:1024
  v_mfma_f32_16x16x32_bf16 v[56:59], a[80:83], a[56:59], v[56:59]
  s_nop 0
  ds_read_b128 a[104:107], v4 offset:2048
  v_mfma_f32_16x16x32_bf16 v[56:59], a[88:91], a[60:63], v[56:59]
  s_nop 0
  ds_read_b128 a[108:111], v4 offset:3072
  v_mfma_f32_16x16x32_bf16 v[60:63], a[68:71], a[48:51], v[124:127]
  s_nop 0
  ds_read_b128 a[112:115], v4 offset:4096
  v_mfma_f32_16x16x32_bf16 v[60:63], a[76:79], a[52:55], v[60:63]
  s_nop 0
  ds_read_b128 a[116:119], v4 offset:5120
  v_mfma_f32_16x16x32_bf16 v[60:63], a[84:87], a[56:59], v[60:63]
  s_nop 0
  ds_read_b128 a[120:123], v4 offset:6144
  v_mfma_f32_16x16x32_bf16 v[60:63], a[92:95], a[60:63], v[60:63]
  s_nop 0
  ds_read_b128 a[124:127], v4 offset:7168
  v_mfma_f32_16x16x32_bf16 a[140:143], v[16:19], v[76:79], a[140:143]
  s_add_u32 m0, s73, 81920
  s_add_u32 s66, s72, 640
  buffer_load_dwordx4 v26, s[48:51], s66 offen lds
  s_waitcnt lgkmcnt(0)
  v_mfma_f32_16x16x32_bf16 v[224:227], a[96:99], v[76:79], v[224:227]
  s_add_u32 m0, s73, 82944
  s_add_u32 s66, s72, 8832
  buffer_load_dwordx4 v26, s[48:51], s66 offen lds
  v_mfma_f32_16x16x32_bf16 v[228:231], a[100:103], v[76:79], v[228:231]
  s_add_u32 m0, s73, 83968
  s_add_u32 s66, s72, 17024
  buffer_load_dwordx4 v26, s[48:51], s66 offen lds
  v_mfma_f32_16x16x32_bf16 v[232:235], a[104:107], v[76:79], v[232:235]
  s_add_u32 m0, s73, 84992
  s_add_u32 s66, s72, 25216
  buffer_load_dwordx4 v26, s[48:51], s66 offen lds
  v_mfma_f32_16x16x32_bf16 v[236:239], a[108:111], v[76:79], v[236:239]
  s_add_u32 s58, s58, 1
  v_exp_f32 v8, v56
  v_mfma_f32_16x16x32_bf16 v[240:243], a[112:115], v[76:79], v[240:243]
  v_exp_f32 v9, v57
  v_mfma_f32_16x16x32_bf16 v[244:247], a[116:119], v[76:79], v[244:247]
  v_exp_f32 v10, v58
  v_mfma_f32_16x16x32_bf16 v[248:251], a[120:123], v[76:79], v[248:251]
  v_exp_f32 v11, v59
  v_mfma_f32_16x16x32_bf16 v[252:255], a[124:127], v[76:79], v[252:255]
  v_cvt_pk_bf16_f32 v92, v8, v9
  v_cvt_pk_bf16_f32 v93, v10, v11
  v_or_b32 v5, v92, v93
  v_exp_f32 v12, v60
  v_exp_f32 v13, v61
  v_exp_f32 v14, v62
  v_exp_f32 v15, v63
  s_nop 0
  v_cvt_pk_bf16_f32 v94, v12, v13
  v_cvt_pk_bf16_f32 v95, v14, v15
  v_or3_b32 v5, v5, v94, v95
  v_and_b32 v5, s70, v5
  v_cmp_ne_u32 vcc, 0, v5
  v_add_u32 v4, 0x4000, v4
  v_and_b32 v4, 0x1ffff, v4
  s_cbranch_vccnz L_a_d7_t
L_a_d7_r:
  s_waitcnt vmcnt(24)
  s_barrier
  ds_read_b128 a[96:99], v4 offset:0
  ds_read_b128 a[100:103], v4 offset:1024
  ds_read_b128 a[104:107], v4 offset:2048
  ds_read_b128 a[108:111], v4 offset:3072
  ds_read_b128 a[112:115], v4 offset:4096
  ds_read_b128 a[116:119], v4 offset:5120
  ds_read_b128 a[120:123], v4 offset:6144
  ds_read_b128 a[124:127], v4 offset:7168
  s_add_u32 m0, s73, 98304
  s_add_u32 s66, s72, 768
  buffer_load_dwordx4 v26, s[48:51], s66 offen lds
  s_add_u32 m0, s73, 99328
  s_add_u32 s66, s72, 8960
  buffer_load_dwordx4 v26, s[48:51], s66 offen lds
  s_add_u32 m0, s73, 100352
  s_add_u32 s66, s72, 17152
  buffer_load_dwordx4 v26, s[48:51], s66 offen lds
  s_add_u32 m0, s73, 101376
  s_add_u32 s66, s72, 25344
  buffer_load_dwordx4 v26, s[48:51], s66 offen lds
  v_mfma_f32_16x16x32_bf16 a[140:143], v[16:19], v[92:95], a[140:143]
  s_waitcnt lgkmcnt(7)
  v_mfma_f32_16x16x32_bf16 v[224:227], a[96:99], v[92:95], v[224:227]
  s_waitcnt lgkmcnt(6)
  v_mfma_f32_16x16x32_bf16 v[228:231], a[100:103], v[92:95], v[228:231]
  s_waitcnt lgkmcnt(5)
  v_mfma_f32_16x16x32_bf16 v[232:235], a[104:107], v[92:95], v[232:235]
  s_waitcnt lgkmcnt(4)
  v_mfma_f32_16x16x32_bf16 v[236:239], a[108:111], v[92:95], v[236:239]
  s_waitcnt lgkmcnt(3)
  v_mfma_f32_16x16x32_bf16 v[240:243], a[112:115], v[92:95], v[240:243]
  s_waitcnt lgkmcnt(2)
  v_mfma_f32_16x16x32_bf16 v[244:247], a[116:119], v[92:95], v[244:247]
  s_waitcnt lgkmcnt(1)
  v_mfma_f32_16x16x32_bf16 v[248:251], a[120:123], v[92:95], v[248:251]
  s_waitcnt lgkmcnt(0)
  v_mfma_f32_16x16x32_bf16 v[252:255], a[124:127], v[92:95], v[252:255]
  s_barrier
  s_add_u32 m0, s73, 114688
  s_add_u32 s66, s72, 896
  buffer_load_dwordx4 v26, s[48:51], s66 offen lds
  s_add_u32 m0, s73, 115712
  s_add_u32 s66, s72, 9088
  buffer_load_dwordx4 v26, s[48:51], s66 offen lds
  s_add_u32 m0, s73, 116736
  s_add_u32 s66, s72, 17280
  buffer_load_dwordx4 v26, s[48:51], s66 offen lds
  s_add_u32 m0, s73, 117760
  s_add_u32 s66, s72, 25472
  buffer_load_dwordx4 v26, s[48:51], s66 offen lds
  v_accvgpr_read_b32 v6, a128
  v_rcp_f32 v6, v6
  s_nop 0
  v_mul_f32 v20, v20, v6
  v_accvgpr_read_b32 v6, a132
  v_rcp_f32 v6, v6
  s_nop 0
  v_mul_f32 v21, v21, v6
  v_accvgpr_read_b32 v6, a136
  v_rcp_f32 v6, v6
  s_nop 0
  v_mul_f32 v22, v22, v6
  v_accvgpr_read_b32 v6, a140
  v_rcp_f32 v6, v6
  s_nop 0
  v_mul_f32 v23, v23, v6
  v_mul_f32 v128, v128, v20
  v_mul_f32 v129, v129, v20
  v_mul_f32 v130, v130, v20
  v_mul_f32 v131, v131, v20
  v_mul_f32 v132, v132, v20
  v_mul_f32 v133, v133, v20
  v_mul_f32 v134, v134, v20
  v_mul_f32 v135, v135, v20
  v_cvt_pk_bf16_f32 v32, v128, v129
  v_cvt_pk_bf16_f32 v33, v130, v131
  v_cvt_pk_bf16_f32 v34, v132, v133
  v_cvt_pk_bf16_f32 v35, v134, v135
  v_mul_f32 v136, v136, v20
  v_mul_f32 v137, v137, v20
  v_mul_f32 v138, v138, v20
  v_mul_f32 v139, v139, v20
  v_mul_f32 v140, v140, v20
  v_mul_f32 v141, v141, v20
  v_mul_f32 v142, v142, v20
  v_mul_f32 v143, v143, v20
  v_cvt_pk_bf16_f32 v36, v136, v137
  v_cvt_pk_bf16_f32 v37, v138, v139
  v_cvt_pk_bf16_f32 v38, v140, v141
  v_cvt_pk_bf16_f32 v39, v142, v143
  v_mul_f32 v144, v144, v20
  v_mul_f32 v145, v145, v20
  v_mul_f32 v146, v146, v20
  v_mul_f32 v147, v147, v20
  v_mul_f32 v148, v148, v20
  v_mul_f32 v149, v149, v20
  v_mul_f32 v150, v150, v20
  v_mul_f32 v151, v151, v20
  v_cvt_pk_bf16_f32 v40, v144, v145
  v_cvt_pk_bf16_f32 v41, v146, v147
  v_cvt_pk_bf16_f32 v42, v148, v149
  v_cvt_pk_bf16_f32 v43, v150, v151
  v_mul_f32 v152, v152, v20
  v_mul_f32 v153, v153, v20
  v_mul_f32 v154, v154, v20
  v_mul_f32 v155, v155, v20
  v_mul_f32 v156, v156, v20
  v_mul_f32 v157, v157, v20
  v_mul_f32 v158, v158, v20
  v_mul_f32 v159, v159, v20
  v_cvt_pk_bf16_f32 v44, v152, v153
  v_cvt_pk_bf16_f32 v45, v154, v155
  v_cvt_pk_bf16_f32 v46, v156, v157
  v_cvt_pk_bf16_f32 v47, v158, v159
  v_mul_f32 v160, v160, v21
  v_mul_f32 v161, v161, v21
  v_mul_f32 v162, v162, v21
  v_mul_f32 v163, v163, v21
  v_mul_f32 v164, v164, v21
  v_mul_f32 v165, v165, v21
  v_mul_f32 v166, v166, v21
  v_mul_f32 v167, v167, v21
  v_cvt_pk_bf16_f32 v48, v160, v161
  v_cvt_pk_bf16_f32 v49, v162, v163
  v_cvt_pk_bf16_f32 v50, v164, v165
  v_cvt_pk_bf16_f32 v51, v166, v167
  v_mul_f32 v168, v168, v21
  v_mul_f32 v169, v169, v21
  v_mul_f32 v170, v170, v21
  v_mul_f32 v171, v171, v21
  v_mul_f32 v172, v172, v21
  v_mul_f32 v173, v173, v21
  v_mul_f32 v174, v174, v21
  v_mul_f32 v175, v175, v21
  v_cvt_pk_bf16_f32 v52, v168, v169
  v_cvt_pk_bf16_f32 v53, v170, v171
  v_cvt_pk_bf16_f32 v54, v172, v173
  v_cvt_pk_bf16_f32 v55, v174, v175
  v_mul_f32 v176, v176, v21
  v_mul_f32 v177, v177, v21
  v_mul_f32 v178, v178, v21
  v_mul_f32 v179, v179, v21
  v_mul_f32 v180, v180, v21
  v_mul_f32 v181, v181, v21
  v_mul_f32 v182, v182, v21
  v_mul_f32 v183, v183, v21
  v_cvt_pk_bf16_f32 v56, v176, v177
  v_cvt_pk_bf16_f32 v57, v178, v179
  v_cvt_pk_bf16_f32 v58, v180, v181
  v_cvt_pk_bf16_f32 v59, v182, v183
  v_mul_f32 v184, v184, v21
  v_mul_f32 v185, v185, v21
  v_mul_f32 v186, v186, v21
  v_mul_f32 v187, v187, v21
  v_mul_f32 v188, v188, v21
  v_mul_f32 v189, v189, v21
  v_mul_f32 v190, v190, v21
  v_mul_f32 v191, v191, v21
  v_cvt_pk_bf16_f32 v60, v184, v185
  v_cvt_pk_bf16_f32 v61, v186, v187
  v_cvt_pk_bf16_f32 v62, v188, v189
  v_cvt_pk_bf16_f32 v63, v190, v191
  v_mul_f32 v192, v192, v22
  v_mul_f32 v193, v193, v22
  v_mul_f32 v194, v194, v22
  v_mul_f32 v195, v195, v22
  v_mul_f32 v196, v196, v22
  v_mul_f32 v197, v197, v22
  v_mul_f32 v198, v198, v22
  v_mul_f32 v199, v199, v22
  v_cvt_pk_bf16_f32 v64, v192, v193
  v_cvt_pk_bf16_f32 v65, v194, v195
  v_cvt_pk_bf16_f32 v66, v196, v197
  v_cvt_pk_bf16_f32 v67, v198, v199
  v_mul_f32 v200, v200, v22
  v_mul_f32 v201, v201, v22
  v_mul_f32 v202, v202, v22
  v_mul_f32 v203, v203, v22
  v_mul_f32 v204, v204, v22
  v_mul_f32 v205, v205, v22
  v_mul_f32 v206, v206, v22
  v_mul_f32 v207, v207, v22
  v_cvt_pk_bf16_f32 v68, v200, v201
  v_cvt_pk_bf16_f32 v69, v202, v203
  v_cvt_pk_bf16_f32 v70, v204, v205
  v_cvt_pk_bf16_f32 v71, v206, v207
  v_mul_f32 v208, v208, v22
  v_mul_f32 v209, v209, v22
  v_mul_f32 v210, v210, v22
  v_mul_f32 v211, v211, v22
  v_mul_f32 v212, v212, v22
  v_mul_f32 v213, v213, v22
  v_mul_f32 v214, v214, v22
  v_mul_f32 v215, v215, v22
  v_cvt_pk_bf16_f32 v72, v208, v209
  v_cvt_pk_bf16_f32 v73, v210, v211
  v_cvt_pk_bf16_f32 v74, v212, v213
  v_cvt_pk_bf16_f32 v75, v214, v215
  v_mul_f32 v216, v216, v22
  v_mul_f32 v217, v217, v22
  v_mul_f32 v218, v218, v22
  v_mul_f32 v219, v219, v22
  v_mul_f32 v220, v220, v22
  v_mul_f32 v221, v221, v22
  v_mul_f32 v222, v222, v22
  v_mul_f32 v223, v223, v22
  v_cvt_pk_bf16_f32 v76, v216, v217
  v_cvt_pk_bf16_f32 v77, v218, v219
  v_cvt_pk_bf16_f32 v78, v220, v221
  v_cvt_pk_bf16_f32 v79, v222, v223
  v_mul_f32 v224, v224, v23
  v_mul_f32 v225, v225, v23
  v_mul_f32 v226, v226, v23
  v_mul_f32 v227, v227, v23
  v_mul_f32 v228, v228, v23
  v_mul_f32 v229, v229, v23
  v_mul_f32 v230, v230, v23
  v_mul_f32 v231, v231, v23
  v_cvt_pk_bf16_f32 v80, v224, v225
  v_cvt_pk_bf16_f32 v81, v226, v227
  v_cvt_pk_bf16_f32 v82, v228, v229
  v_cvt_pk_bf16_f32 v83, v230, v231
  v_mul_f32 v232, v232, v23
  v_mul_f32 v233, v233, v23
  v_mul_f32 v234, v234, v23
  v_mul_f32 v235, v235, v23
  v_mul_f32 v236, v236, v23
  v_mul_f32 v237, v237, v23
  v_mul_f32 v238, v238, v23
  v_mul_f32 v239, v239, v23
  v_cvt_pk_bf16_f32 v84, v232, v233
  v_cvt_pk_bf16_f32 v85, v234, v235
  v_cvt_pk_bf16_f32 v86, v236, v237
  v_cvt_pk_bf16_f32 v87, v238, v239
  v_mul_f32 v240, v240, v23
  v_mul_f32 v241, v241, v23
  v_mul_f32 v242, v242, v23
  v_mul_f32 v243, v243, v23
  v_mul_f32 v244, v244, v23
  v_mul_f32 v245, v245, v23
  v_mul_f32 v246, v246, v23
  v_mul_f32 v247, v247, v23
  v_cvt_pk_bf16_f32 v88, v240, v241
  v_cvt_pk_bf16_f32 v89, v242, v243
  v_cvt_pk_bf16_f32 v90, v244, v245
  v_cvt_pk_bf16_f32 v91, v246, v247
  v_mul_f32 v248, v248, v23
  v_mul_f32 v249, v249, v23
  v_mul_f32 v250, v250, v23
  v_mul_f32 v251, v251, v23
  v_mul_f32 v252, v252, v23
  v_mul_f32 v253, v253, v23
  v_mul_f32 v254, v254, v23
  v_mul_f32 v255, v255, v23
  v_cvt_pk_bf16_f32 v92, v248, v249
  v_cvt_pk_bf16_f32 v93, v250, v251
  v_cvt_pk_bf16_f32 v94, v252, v253
  v_cvt_pk_bf16_f32 v95, v254, v255
  v_lshrrev_b32 v6, 2, v0
  v_lshlrev_b32 v8, 7, v6
  v_bfe_u32 v6, v0, 3, 2
  v_lshl_add_u32 v8, v6, 5, v8
  v_and_b32 v6, 3, v0
  v_lshl_add_u32 v8, v6, 3, v8
  v_xor_b32 v9, 32, v8
  v_xor_b32 v10, 64, v8
  v_xor_b32 v11, 96, v8
  v_add_u32 v12, 0x10000, v8
  v_add_u32 v13, 0x10000, v9
  v_add_u32 v14, 0x10000, v10
  v_add_u32 v15, 0x10000, v11
  s_waitcnt vmcnt(4)
  s_barrier
  ds_read_b64_tr_b16 a[64:65], v8 offset:0
  ds_read_b64_tr_b16 a[66:67], v8 offset:2048
  ds_read_b64_tr_b16 a[68:69], v8 offset:4096
  ds_read_b64_tr_b16 a[70:71], v8 offset:6144
  ds_read_b64_tr_b16 a[72:73], v8 offset:8192
  ds_read_b64_tr_b16 a[74:75], v8 offset:10240
  ds_read_b64_tr_b16 a[76:77], v8 offset:12288
  ds_read_b64_tr_b16 a[78:79], v8 offset:14336
  ds_read_b64_tr_b16 a[80:81], v9 offset:0
  ds_read_b64_tr_b16 a[82:83], v9 offset:2048
  ds_read_b64_tr_b16 a[84:85], v9 offset:4096
  ds_read_b64_tr_b16 a[86:87], v9 offset:6144
  ds_read_b64_tr_b16 a[88:89], v9 offset:8192
  ds_read_b64_tr_b16 a[90:91], v9 offset:10240
  ds_read_b64_tr_b16 a[92:93], v9 offset:12288
  ds_read_b64_tr_b16 a[94:95], v9 offset:14336
  s_waitcnt lgkmcnt(8)
  v_mfma_f32_16x16x32_bf16 v[128:131], a[64:67], v[32:35], 0
  ds_read_b64_tr_b16 a[96:97], v10 offset:0
  v_mfma_f32_16x16x32_bf16 v[128:131], a[68:71], v[36:39], v[128:131]
  v_mfma_f32_16x16x32_bf16 v[128:131], a[72:75], v[40:43], v[128:131]
  ds_read_b64_tr_b16 a[98:99], v10 offset:2048
  v_mfma_f32_16x16x32_bf16 v[128:131], a[76:79], v[44:47], v[128:131]
  v_mfma_f32_16x16x32_bf16 v[136:139], a[64:67], v[48:51], 0
  ds_read_b64_tr_b16 a[100:101], v10 offset:4096
  v_mfma_f32_16x16x32_bf16 v[136:139], a[68:71], v[52:55], v[136:139]
  v_mfma_f32_16x16x32_bf16 v[136:139], a[72:75], v[56:59], v[136:139]
  ds_read_b64_tr_b16 a[102:103], v10 offset:6144
  v_mfma_f32_16x16x32_bf16 v[136:139], a[76:79], v[60:63], v[136:139]
  v_mfma_f32_16x16x32_bf16 v[144:147], a[64:67], v[64:67], 0
  ds_read_b64_tr_b16 a[104:105], v10 offset:8192
  v_mfma_f32_16x16x32_bf16 v[144:147], a[68:71], v[68:71], v[144:147]
  v_mfma_f32_16x16x32_bf16 v[144:147], a[72:75], v[72:75], v[144:147]
  ds_read_b64_tr_b16 a[106:107], v10 offset:10240
  v_mfma_f32_16x16x32_bf16 v[144:147], a[76:79], v[76:79], v[144:147]
  v_mfma_f32_16x16x32_bf16 v[152:155], a[64:67], v[80:83], 0
  ds_read_b64_tr_b16 a[108:109], v10 offset:12288
  v_mfma_f32_16x16x32_bf16 v[152:155], a[68:71], v[84:87], v[152:155]
  v_mfma_f32_16x16x32_bf16 v[152:155], a[72:75], v[88:91], v[152:155]
  ds_read_b64_tr_b16 a[110:111], v10 offset:14336
  v_mfma_f32_16x16x32_bf16 v[152:155], a[76:79], v[92:95], v[152:155]
  s_waitcnt lgkmcnt(8)
  v_mfma_f32_16x16x32_bf16 v[132:135], a[80:83], v[32:35], 0
  ds_read_b64_tr_b16 a[112:113], v11 offset:0
  v_mfma_f32_16x16x32_bf16 v[132:135], a[84:87], v[36:39], v[132:135]
  v_mfma_f32_16x16x32_bf16 v[132:135], a[88:91], v[40:43], v[132:135]
  ds_read_b64_tr_b16 a[114:115], v11 offset:2048
  v_mfma_f32_16x16x32_bf16 v[132:135], a[92:95], v[44:47], v[132:135]
  v_mfma_f32_16x16x32_bf16 v[140:143], a[80:83], v[48:51], 0
  ds_read_b64_tr_b16 a[116:117], v11 offset:4096
  v_mfma_f32_16x16x32_bf16 v[140:143], a[84:87], v[52:55], v[140:143]
  v_mfma_f32_16x16x32_bf16 v[140:143], a[88:91], v[56:59], v[140:143]
  ds_read_b64_tr_b16 a[118:119], v11 offset:6144
  v_mfma_f32_16x16x32_bf16 v[140:143], a[92:95], v[60:63], v[140:143]
  v_mfma_f32_16x16x32_bf16 v[148:151], a[80:83], v[64:67], 0
  ds_read_b64_tr_b16 a[120:121], v11 offset:8192
  v_mfma_f32_16x16x32_bf16 v[148:151], a[84:87], v[68:71], v[148:151]
  v_mfma_f32_16x16x32_bf16 v[148:151], a[88:91], v[72:75], v[148:151]
  ds_read_b64_tr_b16 a[122:123], v11 offset:10240
  v_mfma_f32_16x16x32_bf16 v[148:151], a[92:95], v[76:79], v[148:151]
  v_mfma_f32_16x16x32_bf16 v[156:159], a[80:83], v[80:83], 0
  ds_read_b64_tr_b16 a[124:125], v11 offset:12288
  v_mfma_f32_16x16x32_bf16 v[156:159], a[84:87], v[84:87], v[156:159]
  v_mfma_f32_16x16x32_bf16 v[156:159], a[88:91], v[88:91], v[156:159]
  ds_read_b64_tr_b16 a[126:127], v11 offset:14336
  v_mfma_f32_16x16x32_bf16 v[156:159], a[92:95], v[92:95], v[156:159]
  s_waitcnt lgkmcnt(8)
  v_mfma_f32_16x16x32_bf16 v[160:163], a[96:99], v[32:35], 0
  ds_read_b64_tr_b16 a[64:65], v8 offset:16384
  v_mfma_f32_16x16x32_bf16 v[160:163], a[100:103], v[36:39], v[160:163]
  s_nop 1
  v_mfma_f32_16x16x32_bf16 v[160:163], a[104:107], v[40:43], v[160:163]
  ds_read_b64_tr_b16 a[66:67], v8 offset:18432
  v_mfma_f32_16x16x32_bf16 v[160:163], a[108:111], v[44:47], v[160:163]
  v_cvt_pk_bf16_f32 v96, v128, v129
  v_cvt_pk_bf16_f32 v97, v130, v131
  v_mfma_f32_16x16x32_bf16 v[168:171], a[96:99], v[48:51], 0
  ds_read_b64_tr_b16 a[68:69], v8 offset:20480
  v_mfma_f32_16x16x32_bf16 v[168:171], a[100:103], v[52:55], v[168:171]
  v_cvt_pk_bf16_f32 v98, v132, v133
  v_cvt_pk_bf16_f32 v99, v134, v135
  v_mfma_f32_16x16x32_bf16 v[168:171], a[104:107], v[56:59], v[168:171]
  ds_read_b64_tr_b16 a[70:71], v8 offset:22528
  v_mfma_f32_16x16x32_bf16 v[168:171], a[108:111], v[60:63], v[168:171]
  buffer_store_dwordx4 v[96:99], v2, s[40:43], s76 offen offset:0 sc1
  v_mfma_f32_16x16x32_bf16 v[176:179], a[96:99], v[64:67], 0
  ds_read_b64_tr_b16 a[72:73], v8 offset:24576
  v_mfma_f32_16x16x32_bf16 v[176:179], a[100:103], v[68:71], v[176:179]
  v_cvt_pk_bf16_f32 v100, v136, v137
  v_cvt_pk_bf16_f32 v101, v138, v139
  v_mfma_f32_16x16x32_bf16 v[176:179], a[104:107], v[72:75], v[176:179]
  ds_read_b64_tr_b16 a[74:75], v8 offset:26624
  v_mfma_f32_16x16x32_bf16 v[176:179], a[108:111], v[76:79], v[176:179]
  v_cvt_pk_bf16_f32 v102, v140, v141
  v_cvt_pk_bf16_f32 v103, v142, v143
  v_mfma_f32_16x16x32_bf16 v[184:187], a[96:99], v[80:83], 0
  ds_read_b64_tr_b16 a[76:77], v8 offset:28672
  v_mfma_f32_16x16x32_bf16 v[184:187], a[100:103], v[84:87], v[184:187]
  buffer_store_dwordx4 v[100:103], v2, s[40:43], s77 offen offset:0 sc1
  v_mfma_f32_16x16x32_bf16 v[184:187], a[104:107], v[88:91], v[184:187]
  ds_read_b64_tr_b16 a[78:79], v8 offset:30720
  v_mfma_f32_16x16x32_bf16 v[184:187], a[108:111], v[92:95], v[184:187]
  s_waitcnt lgkmcnt(8)
  v_cvt_pk_bf16_f32 v104, v144, v145
  v_cvt_pk_bf16_f32 v105, v146, v147
  v_mfma_f32_16x16x32_bf16 v[164:167], a[112:115], v[32:35], 0
  ds_read_b64_tr_b16 a[80:81], v9 offset:16384
  v_mfma_f32_16x16x32_bf16 v[164:167], a[116:119], v[36:39], v[164:167]
  v_cvt_pk_bf16_f32 v106, v148, v149
  v_cvt_pk_bf16_f32 v107, v150, v151
  v_mfma_f32_16x16x32_bf16 v[164:167], a[120:123], v[40:43], v[164:167]
  ds_read_b64_tr_b16 a[82:83], v9 offset:18432
  v_mfma_f32_16x16x32_bf16 v[164:167], a[124:127], v[44:47], v[164:167]
  buffer_store_dwordx4 v[104:107], v2, s[40:43], s78 offen offset:0 sc1
  v_mfma_f32_16x16x32_bf16 v[172:175], a[112:115], v[48:51], 0
  ds_read_b64_tr_b16 a[84:85], v9 offset:20480
  v_mfma_f32_16x16x32_bf16 v[172:175], a[116:119], v[52:55], v[172:175]
  v_cvt_pk_bf16_f32 v108, v152, v153
  v_cvt_pk_bf16_f32 v109, v154, v155
  v_mfma_f32_16x16x32_bf16 v[172:175], a[120:123], v[56:59], v[172:175]
  ds_read_b64_tr_b16 a[86:87], v9 offset:22528
  v_mfma_f32_16x16x32_bf16 v[172:175], a[124:127], v[60:63], v[172:175]
  v_cvt_pk_bf16_f32 v110, v156, v157
  v_cvt_pk_bf16_f32 v111, v158, v159
  v_mfma_f32_16x16x32_bf16 v[180:183], a[112:115], v[64:67], 0
  ds_read_b64_tr_b16 a[88:89], v9 offset:24576
  v_mfma_f32_16x16x32_bf16 v[180:183], a[116:119], v[68:71], v[180:183]
  buffer_store_dwordx4 v[108:111], v2, s[40:43], s79 offen offset:0 sc1
  v_mfma_f32_16x16x32_bf16 v[180:183], a[120:123], v[72:75], v[180:183]
  ds_read_b64_tr_b16 a[90:91], v9 offset:26624
  v_mfma_f32_16x16x32_bf16 v[180:183], a[124:127], v[76:79], v[180:183]
  v_mfma_f32_16x16x32_bf16 v[188:191], a[112:115], v[80:83], 0
  ds_read_b64_tr_b16 a[92:93], v9 offset:28672
  v_mfma_f32_16x16x32_bf16 v[188:191], a[116:119], v[84:87], v[188:191]
  v_mfma_f32_16x16x32_bf16 v[188:191], a[120:123], v[88:91], v[188:191]
  ds_read_b64_tr_b16 a[94:95], v9 offset:30720
  v_mfma_f32_16x16x32_bf16 v[188:191], a[124:127], v[92:95], v[188:191]
  s_waitcnt lgkmcnt(8)
  v_mfma_f32_16x16x32_bf16 v[128:131], a[64:67], v[32:35], 0
  ds_read_b64_tr_b16 a[96:97], v10 offset:16384
  v_mfma_f32_16x16x32_bf16 v[128:131], a[68:71], v[36:39], v[128:131]
  s_nop 1
  v_mfma_f32_16x16x32_bf16 v[128:131], a[72:75], v[40:43], v[128:131]
  ds_read_b64_tr_b16 a[98:99], v10 offset:18432
  v_mfma_f32_16x16x32_bf16 v[128:131], a[76:79], v[44:47], v[128:131]
  v_cvt_pk_bf16_f32 v112, v160, v161
  v_cvt_pk_bf16_f32 v113, v162, v163
  v_mfma_f32_16x16x32_bf16 v[136:139], a[64:67], v[48:51], 0
  ds_read_b64_tr_b16 a[100:101], v10 offset:20480
  v_mfma_f32_16x16x32_bf16 v[136:139], a[68:71], v[52:55], v[136:139]
  v_cvt_pk_bf16_f32 v114, v164, v165
  v_cvt_pk_bf16_f32 v115, v166, v167
  v_mfma_f32_16x16x32_bf16 v[136:139], a[72:75], v[56:59], v[136:139]
  ds_read_b64_tr_b16 a[102:103], v10 offset:22528
  v_mfma_f32_16x16x32_bf16 v[136:139], a[76:79], v[60:63], v[136:139]
  buffer_store_dwordx4 v[112:115], v2, s[40:43], s76 offen offset:1024 sc1
  v_mfma_f32_16x16x32_bf16 v[144:147], a[64:67], v[64:67], 0
  ds_read_b64_tr_b16 a[104:105], v10 offset:24576
  v_mfma_f32_16x16x32_bf16 v[144:147], a[68:71], v[68:71], v[144:147]
  v_cvt_pk_bf16_f32 v116, v168, v169
  v_cvt_pk_bf16_f32 v117, v170, v171
  v_mfma_f32_16x16x32_bf16 v[144:147], a[72:75], v[72:75], v[144:147]
  ds_read_b64_tr_b16 a[106:107], v10 offset:26624
  v_mfma_f32_16x16x32_bf16 v[144:147], a[76:79], v[76:79], v[144:147]
  v_cvt_pk_bf16_f32 v118, v172, v173
  v_cvt_pk_bf16_f32 v119, v174, v175
  v_mfma_f32_16x16x32_bf16 v[152:155], a[64:67], v[80:83], 0
  ds_read_b64_tr_b16 a[108:109], v10 offset:28672
  v_mfma_f32_16x16x32_bf16 v[152:155], a[68:71], v[84:87], v[152:155]
  buffer_store_dwordx4 v[116:119], v2, s[40:43], s77 offen offset:1024 sc1
  v_mfma_f32_16x16x32_bf16 v[152:155], a[72:75], v[88:91], v[152:155]
  ds_read_b64_tr_b16 a[110:111], v10 offset:30720
  v_mfma_f32_16x16x32_bf16 v[152:155], a[76:79], v[92:95], v[152:155]
  s_waitcnt lgkmcnt(8)
  v_cvt_pk_bf16_f32 v120, v176, v177
  v_cvt_pk_bf16_f32 v121, v178, v179
  v_mfma_f32_16x16x32_bf16 v[132:135], a[80:83], v[32:35], 0
  ds_read_b64_tr_b16 a[112:113], v11 offset:16384
  v_mfma_f32_16x16x32_bf16 v[132:135], a[84:87], v[36:39], v[132:135]
  v_cvt_pk_bf16_f32 v122, v180, v181
  v_cvt_pk_bf16_f32 v123, v182, v183
  v_mfma_f32_16x16x32_bf16 v[132:135], a[88:91], v[40:43], v[132:135]
  ds_read_b64_tr_b16 a[114:115], v11 offset:18432
  v_mfma_f32_16x16x32_bf16 v[132:135], a[92:95], v[44:47], v[132:135]
  buffer_store_dwordx4 v[120:123], v2, s[40:43], s78 offen offset:1024 sc1
  v_mfma_f32_16x16x32_bf16 v[140:143], a[80:83], v[48:51], 0
  ds_read_b64_tr_b16 a[116:117], v11 offset:20480
  v_mfma_f32_16x16x32_bf16 v[140:143], a[84:87], v[52:55], v[140:143]
  v_cvt_pk_bf16_f32 v124, v184, v185
  v_cvt_pk_bf16_f32 v125, v186, v187
  v_mfma_f32_16x16x32_bf16 v[140:143], a[88:91], v[56:59], v[140:143]
  ds_read_b64_tr_b16 a[118:119], v11 offset:22528
  v_mfma_f32_16x16x32_bf16 v[140:143], a[92:95], v[60:63], v[140:143]
  v_cvt_pk_bf16_f32 v126, v188, v189
  v_cvt_pk_bf16_f32 v127, v190, v191
  v_mfma_f32_16x16x32_bf16 v[148:151], a[80:83], v[64:67], 0
  ds_read_b64_tr_b16 a[120:121], v11 offset:24576
  v_mfma_f32_16x16x32_bf16 v[148:151], a[84:87], v[68:71], v[148:151]
  buffer_store_dwordx4 v[124:127], v2, s[40:43], s79 offen offset:1024 sc1
  v_mfma_f32_16x16x32_bf16 v[148:151], a[88:91], v[72:75], v[148:151]
  ds_read_b64_tr_b16 a[122:123], v11 offset:26624
  v_mfma_f32_16x16x32_bf16 v[148:151], a[92:95], v[76:79], v[148:151]
  v_mfma_f32_16x16x32_bf16 v[156:159], a[80:83], v[80:83], 0
  ds_read_b64_tr_b16 a[124:125], v11 offset:28672
  v_mfma_f32_16x16x32_bf16 v[156:159], a[84:87], v[84:87], v[156:159]
  v_mfma_f32_16x16x32_bf16 v[156:159], a[88:91], v[88:91], v[156:159]
  ds_read_b64_tr_b16 a[126:127], v11 offset:30720
  v_mfma_f32_16x16x32_bf16 v[156:159], a[92:95], v[92:95], v[156:159]
  s_waitcnt lgkmcnt(8)
  v_mfma_f32_16x16x32_bf16 v[160:163], a[96:99], v[32:35], 0
  ds_read_b64_tr_b16 a[64:65], v8 offset:32768
  v_mfma_f32_16x16x32_bf16 v[160:163], a[100:103], v[36:39], v[160:163]
  s_nop 1
  v_mfma_f32_16x16x32_bf16 v[160:163], a[104:107], v[40:43], v[160:163]
  ds_read_b64_tr_b16 a[66:67], v8 offset:34816
  v_mfma_f32_16x16x32_bf16 v[160:163], a[108:111], v[44:47], v[160:163]
  v_cvt_pk_bf16_f32 v96, v128, v129
  v_cvt_pk_bf16_f32 v97, v130, v131
  v_mfma_f32_16x16x32_bf16 v[168:171], a[96:99], v[48:51], 0
  ds_read_b64_tr_b16 a[68:69], v8 offset:36864
  v_mfma_f32_16x16x32_bf16 v[168:171], a[100:103], v[52:55], v[168:171]
  v_cvt_pk_bf16_f32 v98, v132, v133
  v_cvt_pk_bf16_f32 v99, v134, v135
  v_mfma_f32_16x16x32_bf16 v[168:171], a[104:107], v[56:59], v[168:171]
  ds_read_b64_tr_b16 a[70:71], v8 offset:38912
  v_mfma_f32_16x16x32_bf16 v[168:171], a[108:111], v[60:63], v[168:171]
  buffer_store_dwordx4 v[96:99], v2, s[40:43], s76 offen offset:2048 sc1
  v_mfma_f32_16x16x32_bf16 v[176:179], a[96:99], v[64:67], 0
  ds_read_b64_tr_b16 a[72:73], v8 offset:40960
  v_mfma_f32_16x16x32_bf16 v[176:179], a[100:103], v[68:71], v[176:179]
  v_cvt_pk_bf16_f32 v100, v136, v137
  v_cvt_pk_bf16_f32 v101, v138, v139
  v_mfma_f32_16x16x32_bf16 v[176:179], a[104:107], v[72:75], v[176:179]
  ds_read_b64_tr_b16 a[74:75], v8 offset:43008
  v_mfma_f32_16x16x32_bf16 v[176:179], a[108:111], v[76:79], v[176:179]
  v_cvt_pk_bf16_f32 v102, v140, v141
  v_cvt_pk_bf16_f32 v103, v142, v143
  v_mfma_f32_16x16x32_bf16 v[184:187], a[96:99], v[80:83], 0
  ds_read_b64_tr_b16 a[76:77], v8 offset:45056
  v_mfma_f32_16x16x32_bf16 v[184:187], a[100:103], v[84:87], v[184:187]
  buffer_store_dwordx4 v[100:103], v2, s[40:43], s77 offen offset:2048 sc1
  v_mfma_f32_16x16x32_bf16 v[184:187], a[104:107], v[88:91], v[184:187]
  ds_read_b64_tr_b16 a[78:79], v8 offset:47104
  v_mfma_f32_16x16x32_bf16 v[184:187], a[108:111], v[92:95], v[184:187]
  s_waitcnt lgkmcnt(8)
  v_cvt_pk_bf16_f32 v104, v144, v145
  v_cvt_pk_bf16_f32 v105, v146, v147
  v_mfma_f32_16x16x32_bf16 v[164:167], a[112:115], v[32:35], 0
  ds_read_b64_tr_b16 a[80:81], v9 offset:32768
  v_mfma_f32_16x16x32_bf16 v[164:167], a[116:119], v[36:39], v[164:167]
  v_cvt_pk_bf16_f32 v106, v148, v149
  v_cvt_pk_bf16_f32 v107, v150, v151
  v_mfma_f32_16x16x32_bf16 v[164:167], a[120:123], v[40:43], v[164:167]
  ds_read_b64_tr_b16 a[82:83], v9 offset:34816
  v_mfma_f32_16x16x32_bf16 v[164:167], a[124:127], v[44:47], v[164:167]
  buffer_store_dwordx4 v[104:107], v2, s[40:43], s78 offen offset:2048 sc1
  v_mfma_f32_16x16x32_bf16 v[172:175], a[112:115], v[48:51], 0
  ds_read_b64_tr_b16 a[84:85], v9 offset:36864
  v_mfma_f32_16x16x32_bf16 v[172:175], a[116:119], v[52:55], v[172:175]
  v_cvt_pk_bf16_f32 v108, v152, v153
  v_cvt_pk_bf16_f32 v109, v154, v155
  v_mfma_f32_16x16x32_bf16 v[172:175], a[120:123], v[56:59], v[172:175]
  ds_read_b64_tr_b16 a[86:87], v9 offset:38912
  v_mfma_f32_16x16x32_bf16 v[172:175], a[124:127], v[60:63], v[172:175]
  v_cvt_pk_bf16_f32 v110, v156, v157
  v_cvt_pk_bf16_f32 v111, v158, v159
  v_mfma_f32_16x16x32_bf16 v[180:183], a[112:115], v[64:67], 0
  ds_read_b64_tr_b16 a[88:89], v9 offset:40960
  v_mfma_f32_16x16x32_bf16 v[180:183], a[116:119], v[68:71], v[180:183]
  buffer_store_dwordx4 v[108:111], v2, s[40:43], s79 offen offset:2048 sc1
  v_mfma_f32_16x16x32_bf16 v[180:183], a[120:123], v[72:75], v[180:183]
  ds_read_b64_tr_b16 a[90:91], v9 offset:43008
  v_mfma_f32_16x16x32_bf16 v[180:183], a[124:127], v[76:79], v[180:183]
  v_mfma_f32_16x16x32_bf16 v[188:191], a[112:115], v[80:83], 0
  ds_read_b64_tr_b16 a[92:93], v9 offset:45056
  v_mfma_f32_16x16x32_bf16 v[188:191], a[116:119], v[84:87], v[188:191]
  v_mfma_f32_16x16x32_bf16 v[188:191], a[120:123], v[88:91], v[188:191]
  ds_read_b64_tr_b16 a[94:95], v9 offset:47104
  v_mfma_f32_16x16x32_bf16 v[188:191], a[124:127], v[92:95], v[188:191]
  s_waitcnt lgkmcnt(8)
  v_mfma_f32_16x16x32_bf16 v[128:131], a[64:67], v[32:35], 0
  ds_read_b64_tr_b16 a[96:97], v10 offset:32768
  v_mfma_f32_16x16x32_bf16 v[128:131], a[68:71], v[36:39], v[128:131]
  s_nop 1
  v_mfma_f32_16x16x32_bf16 v[128:131], a[72:75], v[40:43], v[128:131]
  ds_read_b64_tr_b16 a[98:99], v10 offset:34816
  v_mfma_f32_16x16x32_bf16 v[128:131], a[76:79], v[44:47], v[128:131]
  v_cvt_pk_bf16_f32 v112, v160, v161
  v_cvt_pk_bf16_f32 v113, v162, v163
  v_mfma_f32_16x16x32_bf16 v[136:139], a[64:67], v[48:51], 0
  ds_read_b64_tr_b16 a[100:101], v10 offset:36864
  v_mfma_f32_16x16x32_bf16 v[136:139], a[68:71], v[52:55], v[136:139]
  v_cvt_pk_bf16_f32 v114, v164, v165
  v_cvt_pk_bf16_f32 v115, v166, v167
  v_mfma_f32_16x16x32_bf16 v[136:139], a[72:75], v[56:59], v[136:139]
  ds_read_b64_tr_b16 a[102:103], v10 offset:38912
  v_mfma_f32_16x16x32_bf16 v[136:139], a[76:79], v[60:63], v[136:139]
  buffer_store_dwordx4 v[112:115], v2, s[40:43], s76 offen offset:3072 sc1
  v_mfma_f32_16x16x32_bf16 v[144:147], a[64:67], v[64:67], 0
  ds_read_b64_tr_b16 a[104:105], v10 offset:40960
  v_mfma_f32_16x16x32_bf16 v[144:147], a[68:71], v[68:71], v[144:147]
  v_cvt_pk_bf16_f32 v116, v168, v169
  v_cvt_pk_bf16_f32 v117, v170, v171
  v_mfma_f32_16x16x32_bf16 v[144:147], a[72:75], v[72:75], v[144:147]
  ds_read_b64_tr_b16 a[106:107], v10 offset:43008
  v_mfma_f32_16x16x32_bf16 v[144:147], a[76:79], v[76:79], v[144:147]
  v_cvt_pk_bf16_f32 v118, v172, v173
  v_cvt_pk_bf16_f32 v119, v174, v175
  v_mfma_f32_16x16x32_bf16 v[152:155], a[64:67], v[80:83], 0
  ds_read_b64_tr_b16 a[108:109], v10 offset:45056
  v_mfma_f32_16x16x32_bf16 v[152:155], a[68:71], v[84:87], v[152:155]
  buffer_store_dwordx4 v[116:119], v2, s[40:43], s77 offen offset:3072 sc1
  v_mfma_f32_16x16x32_bf16 v[152:155], a[72:75], v[88:91], v[152:155]
  ds_read_b64_tr_b16 a[110:111], v10 offset:47104
  v_mfma_f32_16x16x32_bf16 v[152:155], a[76:79], v[92:95], v[152:155]
  s_waitcnt lgkmcnt(8)
  v_cvt_pk_bf16_f32 v120, v176, v177
  v_cvt_pk_bf16_f32 v121, v178, v179
  v_mfma_f32_16x16x32_bf16 v[132:135], a[80:83], v[32:35], 0
  ds_read_b64_tr_b16 a[112:113], v11 offset:32768
  v_mfma_f32_16x16x32_bf16 v[132:135], a[84:87], v[36:39], v[132:135]
  v_cvt_pk_bf16_f32 v122, v180, v181
  v_cvt_pk_bf16_f32 v123, v182, v183
  v_mfma_f32_16x16x32_bf16 v[132:135], a[88:91], v[40:43], v[132:135]
  ds_read_b64_tr_b16 a[114:115], v11 offset:34816
  v_mfma_f32_16x16x32_bf16 v[132:135], a[92:95], v[44:47], v[132:135]
  buffer_store_dwordx4 v[120:123], v2, s[40:43], s78 offen offset:3072 sc1
  v_mfma_f32_16x16x32_bf16 v[140:143], a[80:83], v[48:51], 0
  ds_read_b64_tr_b16 a[116:117], v11 offset:36864
  v_mfma_f32_16x16x32_bf16 v[140:143], a[84:87], v[52:55], v[140:143]
  v_cvt_pk_bf16_f32 v124, v184, v185
  v_cvt_pk_bf16_f32 v125, v186, v187
  v_mfma_f32_16x16x32_bf16 v[140:143], a[88:91], v[56:59], v[140:143]
  ds_read_b64_tr_b16 a[118:119], v11 offset:38912
  v_mfma_f32_16x16x32_bf16 v[140:143], a[92:95], v[60:63], v[140:143]
  v_cvt_pk_bf16_f32 v126, v188, v189
  v_cvt_pk_bf16_f32 v127, v190, v191
  v_mfma_f32_16x16x32_bf16 v[148:151], a[80:83], v[64:67], 0
  ds_read_b64_tr_b16 a[120:121], v11 offset:40960
  v_mfma_f32_16x16x32_bf16 v[148:151], a[84:87], v[68:71], v[148:151]
  buffer_store_dwordx4 v[124:127], v2, s[40:43], s79 offen offset:3072 sc1
  v_mfma_f32_16x16x32_bf16 v[148:151], a[88:91], v[72:75], v[148:151]
  ds_read_b64_tr_b16 a[122:123], v11 offset:43008
  v_mfma_f32_16x16x32_bf16 v[148:151], a[92:95], v[76:79], v[148:151]
  v_mfma_f32_16x16x32_bf16 v[156:159], a[80:83], v[80:83], 0
  ds_read_b64_tr_b16 a[124:125], v11 offset:45056
  v_mfma_f32_16x16x32_bf16 v[156:159], a[84:87], v[84:87], v[156:159]
  v_mfma_f32_16x16x32_bf16 v[156:159], a[88:91], v[88:91], v[156:159]
  ds_read_b64_tr_b16 a[126:127], v11 offset:47104
  v_mfma_f32_16x16x32_bf16 v[156:159], a[92:95], v[92:95], v[156:159]
  s_waitcnt lgkmcnt(8)
  v_mfma_f32_16x16x32_bf16 v[160:163], a[96:99], v[32:35], 0
  ds_read_b64_tr_b16 a[64:65], v8 offset:49152
  v_mfma_f32_16x16x32_bf16 v[160:163], a[100:103], v[36:39], v[160:163]
  s_add_u32 s76, s76, 0x1000
  s_add_u32 s77, s77, 0x1000
  s_add_u32 s78, s78, 0x1000
  s_add_u32 s79, s79, 0x1000
  v_mfma_f32_16x16x32_bf16 v[160:163], a[104:107], v[40:43], v[160:163]
  ds_read_b64_tr_b16 a[66:67], v8 offset:51200
  v_mfma_f32_16x16x32_bf16 v[160:163], a[108:111], v[44:47], v[160:163]
  v_cvt_pk_bf16_f32 v96, v128, v129
  v_cvt_pk_bf16_f32 v97, v130, v131
  v_mfma_f32_16x16x32_bf16 v[168:171], a[96:99], v[48:51], 0
  ds_read_b64_tr_b16 a[68:69], v8 offset:53248
  v_mfma_f32_16x16x32_bf16 v[168:171], a[100:103], v[52:55], v[168:171]
  v_cvt_pk_bf16_f32 v98, v132, v133
  v_cvt_pk_bf16_f32 v99, v134, v135
  v_mfma_f32_16x16x32_bf16 v[168:171], a[104:107], v[56:59], v[168:171]
  ds_read_b64_tr_b16 a[70:71], v8 offset:55296
  v_mfma_f32_16x16x32_bf16 v[168:171], a[108:111], v[60:63], v[168:171]
  buffer_store_dwordx4 v[96:99], v2, s[40:43], s76 offen offset:0 sc1
  v_mfma_f32_16x16x32_bf16 v[176:179], a[96:99], v[64:67], 0
  ds_read_b64_tr_b16 a[72:73], v8 offset:57344
  v_mfma_f32_16x16x32_bf16 v[176:179], a[100:103], v[68:71], v[176:179]
  v_cvt_pk_bf16_f32 v100, v136, v137
  v_cvt_pk_bf16_f32 v101, v138, v139
  v_mfma_f32_16x16x32_bf16 v[176:179], a[104:107], v[72:75], v[176:179]
  ds_read_b64_tr_b16 a[74:75], v8 offset:59392
  v_mfma_f32_16x16x32_bf16 v[176:179], a[108:111], v[76:79], v[176:179]
  v_cvt_pk_bf16_f32 v102, v140, v141
  v_cvt_pk_bf16_f32 v103, v142, v143
  v_mfma_f32_16x16x32_bf16 v[184:187], a[96:99], v[80:83], 0
  ds_read_b64_tr_b16 a[76:77], v8 offset:61440
  v_mfma_f32_16x16x32_bf16 v[184:187], a[100:103], v[84:87], v[184:187]
  buffer_store_dwordx4 v[100:103], v2, s[40:43], s77 offen offset:0 sc1
  v_mfma_f32_16x16x32_bf16 v[184:187], a[104:107], v[88:91], v[184:187]
  ds_read_b64_tr_b16 a[78:79], v8 offset:63488
  v_mfma_f32_16x16x32_bf16 v[184:187], a[108:111], v[92:95], v[184:187]
  s_waitcnt lgkmcnt(8)
  v_cvt_pk_bf16_f32 v104, v144, v145
  v_cvt_pk_bf16_f32 v105, v146, v147
  v_mfma_f32_16x16x32_bf16 v[164:167], a[112:115], v[32:35], 0
  ds_read_b64_tr_b16 a[80:81], v9 offset:49152
  v_mfma_f32_16x16x32_bf16 v[164:167], a[116:119], v[36:39], v[164:167]
  v_cvt_pk_bf16_f32 v106, v148, v149
  v_cvt_pk_bf16_f32 v107, v150, v151
  v_mfma_f32_16x16x32_bf16 v[164:167], a[120:123], v[40:43], v[164:167]
  ds_read_b64_tr_b16 a[82:83], v9 offset:51200
  v_mfma_f32_16x16x32_bf16 v[164:167], a[124:127], v[44:47], v[164:167]
  buffer_store_dwordx4 v[104:107], v2, s[40:43], s78 offen offset:0 sc1
  v_mfma_f32_16x16x32_bf16 v[172:175], a[112:115], v[48:51], 0
  ds_read_b64_tr_b16 a[84:85], v9 offset:53248
  v_mfma_f32_16x16x32_bf16 v[172:175], a[116:119], v[52:55], v[172:175]
  v_cvt_pk_bf16_f32 v108, v152, v153
  v_cvt_pk_bf16_f32 v109, v154, v155
  v_mfma_f32_16x16x32_bf16 v[172:175], a[120:123], v[56:59], v[172:175]
  ds_read_b64_tr_b16 a[86:87], v9 offset:55296
  v_mfma_f32_16x16x32_bf16 v[172:175], a[124:127], v[60:63], v[172:175]
  v_cvt_pk_bf16_f32 v110, v156, v157
  v_cvt_pk_bf16_f32 v111, v158, v159
  v_mfma_f32_16x16x32_bf16 v[180:183], a[112:115], v[64:67], 0
  ds_read_b64_tr_b16 a[88:89], v9 offset:57344
  v_mfma_f32_16x16x32_bf16 v[180:183], a[116:119], v[68:71], v[180:183]
  buffer_store_dwordx4 v[108:111], v2, s[40:43], s79 offen offset:0 sc1
  v_mfma_f32_16x16x32_bf16 v[180:183], a[120:123], v[72:75], v[180:183]
  ds_read_b64_tr_b16 a[90:91], v9 offset:59392
  v_mfma_f32_16x16x32_bf16 v[180:183], a[124:127], v[76:79], v[180:183]
  v_mfma_f32_16x16x32_bf16 v[188:191], a[112:115], v[80:83], 0
  ds_read_b64_tr_b16 a[92:93], v9 offset:61440
  v_mfma_f32_16x16x32_bf16 v[188:191], a[116:119], v[84:87], v[188:191]
  v_mfma_f32_16x16x32_bf16 v[188:191], a[120:123], v[88:91], v[188:191]
  ds_read_b64_tr_b16 a[94:95], v9 offset:63488
  v_mfma_f32_16x16x32_bf16 v[188:191], a[124:127], v[92:95], v[188:191]
  s_waitcnt lgkmcnt(8)
  v_mfma_f32_16x16x32_bf16 v[128:131], a[64:67], v[32:35], 0
  ds_read_b64_tr_b16 a[96:97], v10 offset:49152
  v_mfma_f32_16x16x32_bf16 v[128:131], a[68:71], v[36:39], v[128:131]
  s_nop 1
  v_mfma_f32_16x16x32_bf16 v[128:131], a[72:75], v[40:43], v[128:131]
  ds_read_b64_tr_b16 a[98:99], v10 offset:51200
  v_mfma_f32_16x16x32_bf16 v[128:131], a[76:79], v[44:47], v[128:131]
  v_cvt_pk_bf16_f32 v112, v160, v161
  v_cvt_pk_bf16_f32 v113, v162, v163
  v_mfma_f32_16x16x32_bf16 v[136:139], a[64:67], v[48:51], 0
  ds_read_b64_tr_b16 a[100:101], v10 offset:53248
  v_mfma_f32_16x16x32_bf16 v[136:139], a[68:71], v[52:55], v[136:139]
  v_cvt_pk_bf16_f32 v114, v164, v165
  v_cvt_pk_bf16_f32 v115, v166, v167
  v_mfma_f32_16x16x32_bf16 v[136:139], a[72:75], v[56:59], v[136:139]
  ds_read_b64_tr_b16 a[102:103], v10 offset:55296
  v_mfma_f32_16x16x32_bf16 v[136:139], a[76:79], v[60:63], v[136:139]
  buffer_store_dwordx4 v[112:115], v2, s[40:43], s76 offen offset:1024 sc1
  v_mfma_f32_16x16x32_bf16 v[144:147], a[64:67], v[64:67], 0
  ds_read_b64_tr_b16 a[104:105], v10 offset:57344
  v_mfma_f32_16x16x32_bf16 v[144:147], a[68:71], v[68:71], v[144:147]
  v_cvt_pk_bf16_f32 v116, v168, v169
  v_cvt_pk_bf16_f32 v117, v170, v171
  v_mfma_f32_16x16x32_bf16 v[144:147], a[72:75], v[72:75], v[144:147]
  ds_read_b64_tr_b16 a[106:107], v10 offset:59392
  v_mfma_f32_16x16x32_bf16 v[144:147], a[76:79], v[76:79], v[144:147]
  v_cvt_pk_bf16_f32 v118, v172, v173
  v_cvt_pk_bf16_f32 v119, v174, v175
  v_mfma_f32_16x16x32_bf16 v[152:155], a[64:67], v[80:83], 0
  ds_read_b64_tr_b16 a[108:109], v10 offset:61440
  v_mfma_f32_16x16x32_bf16 v[152:155], a[68:71], v[84:87], v[152:155]
  buffer_store_dwordx4 v[116:119], v2, s[40:43], s77 offen offset:1024 sc1
  v_mfma_f32_16x16x32_bf16 v[152:155], a[72:75], v[88:91], v[152:155]
  ds_read_b64_tr_b16 a[110:111], v10 offset:63488
  v_mfma_f32_16x16x32_bf16 v[152:155], a[76:79], v[92:95], v[152:155]
  s_waitcnt lgkmcnt(8)
  v_cvt_pk_bf16_f32 v120, v176, v177
  v_cvt_pk_bf16_f32 v121, v178, v179
  v_mfma_f32_16x16x32_bf16 v[132:135], a[80:83], v[32:35], 0
  ds_read_b64_tr_b16 a[112:113], v11 offset:49152
  v_mfma_f32_16x16x32_bf16 v[132:135], a[84:87], v[36:39], v[132:135]
  v_cvt_pk_bf16_f32 v122, v180, v181
  v_cvt_pk_bf16_f32 v123, v182, v183
  v_mfma_f32_16x16x32_bf16 v[132:135], a[88:91], v[40:43], v[132:135]
  ds_read_b64_tr_b16 a[114:115], v11 offset:51200
  v_mfma_f32_16x16x32_bf16 v[132:135], a[92:95], v[44:47], v[132:135]
  buffer_store_dwordx4 v[120:123], v2, s[40:43], s78 offen offset:1024 sc1
  v_mfma_f32_16x16x32_bf16 v[140:143], a[80:83], v[48:51], 0
  ds_read_b64_tr_b16 a[116:117], v11 offset:53248
  v_mfma_f32_16x16x32_bf16 v[140:143], a[84:87], v[52:55], v[140:143]
  v_cvt_pk_bf16_f32 v124, v184, v185
  v_cvt_pk_bf16_f32 v125, v186, v187
  v_mfma_f32_16x16x32_bf16 v[140:143], a[88:91], v[56:59], v[140:143]
  ds_read_b64_tr_b16 a[118:119], v11 offset:55296
  v_mfma_f32_16x16x32_bf16 v[140:143], a[92:95], v[60:63], v[140:143]
  v_cvt_pk_bf16_f32 v126, v188, v189
  v_cvt_pk_bf16_f32 v127, v190, v191
  v_mfma_f32_16x16x32_bf16 v[148:151], a[80:83], v[64:67], 0
  ds_read_b64_tr_b16 a[120:121], v11 offset:57344
  v_mfma_f32_16x16x32_bf16 v[148:151], a[84:87], v[68:71], v[148:151]
  buffer_store_dwordx4 v[124:127], v2, s[40:43], s79 offen offset:1024 sc1
  v_mfma_f32_16x16x32_bf16 v[148:151], a[88:91], v[72:75], v[148:151]
  ds_read_b64_tr_b16 a[122:123], v11 offset:59392
  v_mfma_f32_16x16x32_bf16 v[148:151], a[92:95], v[76:79], v[148:151]
  v_mfma_f32_16x16x32_bf16 v[156:159], a[80:83], v[80:83], 0
  ds_read_b64_tr_b16 a[124:125], v11 offset:61440
  v_mfma_f32_16x16x32_bf16 v[156:159], a[84:87], v[84:87], v[156:159]
  v_mfma_f32_16x16x32_bf16 v[156:159], a[88:91], v[88:91], v[156:159]
  ds_read_b64_tr_b16 a[126:127], v11 offset:63488
  v_mfma_f32_16x16x32_bf16 v[156:159], a[92:95], v[92:95], v[156:159]
  s_waitcnt lgkmcnt(8)
  v_mfma_f32_16x16x32_bf16 v[160:163], a[96:99], v[32:35], 0
  ds_read_b64_tr_b16 a[64:65], v12 offset:0
  v_mfma_f32_16x16x32_bf16 v[160:163], a[100:103], v[36:39], v[160:163]
  s_nop 1
  v_mfma_f32_16x16x32_bf16 v[160:163], a[104:107], v[40:43], v[160:163]
  ds_read_b64_tr_b16 a[66:67], v12 offset:2048
  v_mfma_f32_16x16x32_bf16 v[160:163], a[108:111], v[44:47], v[160:163]
  v_cvt_pk_bf16_f32 v96, v128, v129
  v_cvt_pk_bf16_f32 v97, v130, v131
  v_mfma_f32_16x16x32_bf16 v[168:171], a[96:99], v[48:51], 0
  ds_read_b64_tr_b16 a[68:69], v12 offset:4096
  v_mfma_f32_16x16x32_bf16 v[168:171], a[100:103], v[52:55], v[168:171]
  v_cvt_pk_bf16_f32 v98, v132, v133
  v_cvt_pk_bf16_f32 v99, v134, v135
  v_mfma_f32_16x16x32_bf16 v[168:171], a[104:107], v[56:59], v[168:171]
  ds_read_b64_tr_b16 a[70:71], v12 offset:6144
  v_mfma_f32_16x16x32_bf16 v[168:171], a[108:111], v[60:63], v[168:171]
  buffer_store_dwordx4 v[96:99], v2, s[40:43], s76 offen offset:2048 sc1
  v_mfma_f32_16x16x32_bf16 v[176:179], a[96:99], v[64:67], 0
  ds_read_b64_tr_b16 a[72:73], v12 offset:8192
  v_mfma_f32_16x16x32_bf16 v[176:179], a[100:103], v[68:71], v[176:179]
  v_cvt_pk_bf16_f32 v100, v136, v137
  v_cvt_pk_bf16_f32 v101, v138, v139
  v_mfma_f32_16x16x32_bf16 v[176:179], a[104:107], v[72:75], v[176:179]
  ds_read_b64_tr_b16 a[74:75], v12 offset:10240
  v_mfma_f32_16x16x32_bf16 v[176:179], a[108:111], v[76:79], v[176:179]
  v_cvt_pk_bf16_f32 v102, v140, v141
  v_cvt_pk_bf16_f32 v103, v142, v143
  v_mfma_f32_16x16x32_bf16 v[184:187], a[96:99], v[80:83], 0
  ds_read_b64_tr_b16 a[76:77], v12 offset:12288
  v_mfma_f32_16x16x32_bf16 v[184:187], a[100:103], v[84:87], v[184:187]
  buffer_store_dwordx4 v[100:103], v2, s[40:43], s77 offen offset:2048 sc1
  v_mfma_f32_16x16x32_bf16 v[184:187], a[104:107], v[88:91], v[184:187]
  ds_read_b64_tr_b16 a[78:79], v12 offset:14336
  v_mfma_f32_16x16x32_bf16 v[184:187], a[108:111], v[92:95], v[184:187]
  s_waitcnt lgkmcnt(8)
  v_cvt_pk_bf16_f32 v104, v144, v145
  v_cvt_pk_bf16_f32 v105, v146, v147
  v_mfma_f32_16x16x32_bf16 v[164:167], a[112:115], v[32:35], 0
  ds_read_b64_tr_b16 a[80:81], v13 offset:0
  v_mfma_f32_16x16x32_bf16 v[164:167], a[116:119], v[36:39], v[164:167]
  v_cvt_pk_bf16_f32 v106, v148, v149
  v_cvt_pk_bf16_f32 v107, v150, v151
  v_mfma_f32_16x16x32_bf16 v[164:167], a[120:123], v[40:43], v[164:167]
  ds_read_b64_tr_b16 a[82:83], v13 offset:2048
  v_mfma_f32_16x16x32_bf16 v[164:167], a[124:127], v[44:47], v[164:167]
  buffer_store_dwordx4 v[104:107], v2, s[40:43], s78 offen offset:2048 sc1
  v_mfma_f32_16x16x32_bf16 v[172:175], a[112:115], v[48:51], 0
  ds_read_b64_tr_b16 a[84:85], v13 offset:4096
  v_mfma_f32_16x16x32_bf16 v[172:175], a[116:119], v[52:55], v[172:175]
  v_cvt_pk_bf16_f32 v108, v152, v153
  v_cvt_pk_bf16_f32 v109, v154, v155
  v_mfma_f32_16x16x32_bf16 v[172:175], a[120:123], v[56:59], v[172:175]
  ds_read_b64_tr_b16 a[86:87], v13 offset:6144
  v_mfma_f32_16x16x32_bf16 v[172:175], a[124:127], v[60:63], v[172:175]
  v_cvt_pk_bf16_f32 v110, v156, v157
  v_cvt_pk_bf16_f32 v111, v158, v159
  v_mfma_f32_16x16x32_bf16 v[180:183], a[112:115], v[64:67], 0
  ds_read_b64_tr_b16 a[88:89], v13 offset:8192
  v_mfma_f32_16x16x32_bf16 v[180:183], a[116:119], v[68:71], v[180:183]
  buffer_store_dwordx4 v[108:111], v2, s[40:43], s79 offen offset:2048 sc1
  v_mfma_f32_16x16x32_bf16 v[180:183], a[120:123], v[72:75], v[180:183]
  ds_read_b64_tr_b16 a[90:91], v13 offset:10240
  v_mfma_f32_16x16x32_bf16 v[180:183], a[124:127], v[76:79], v[180:183]
  v_mfma_f32_16x16x32_bf16 v[188:191], a[112:115], v[80:83], 0
  ds_read_b64_tr_b16 a[92:93], v13 offset:12288
  v_mfma_f32_16x16x32_bf16 v[188:191], a[116:119], v[84:87], v[188:191]
  v_mfma_f32_16x16x32_bf16 v[188:191], a[120:123], v[88:91], v[188:191]
  ds_read_b64_tr_b16 a[94:95], v13 offset:14336
  v_mfma_f32_16x16x32_bf16 v[188:191], a[124:127], v[92:95], v[188:191]
  s_waitcnt lgkmcnt(8)
  v_mfma_f32_16x16x32_bf16 v[128:131], a[64:67], v[32:35], 0
  ds_read_b64_tr_b16 a[96:97], v14 offset:0
  v_mfma_f32_16x16x32_bf16 v[128:131], a[68:71], v[36:39], v[128:131]
  s_nop 1
  v_mfma_f32_16x16x32_bf16 v[128:131], a[72:75], v[40:43], v[128:131]
  ds_read_b64_tr_b16 a[98:99], v14 offset:2048
  v_mfma_f32_16x16x32_bf16 v[128:131], a[76:79], v[44:47], v[128:131]
  v_cvt_pk_bf16_f32 v112, v160, v161
  v_cvt_pk_bf16_f32 v113, v162, v163
  v_mfma_f32_16x16x32_bf16 v[136:139], a[64:67], v[48:51], 0
  ds_read_b64_tr_b16 a[100:101], v14 offset:4096
  v_mfma_f32_16x16x32_bf16 v[136:139], a[68:71], v[52:55], v[136:139]
  v_cvt_pk_bf16_f32 v114, v164, v165
  v_cvt_pk_bf16_f32 v115, v166, v167
  v_mfma_f32_16x16x32_bf16 v[136:139], a[72:75], v[56:59], v[136:139]
  ds_read_b64_tr_b16 a[102:103], v14 offset:6144
  v_mfma_f32_16x16x32_bf16 v[136:139], a[76:79], v[60:63], v[136:139]
  buffer_store_dwordx4 v[112:115], v2, s[40:43], s76 offen offset:3072 sc1
  v_mfma_f32_16x16x32_bf16 v[144:147], a[64:67], v[64:67], 0
  ds_read_b64_tr_b16 a[104:105], v14 offset:8192
  v_mfma_f32_16x16x32_bf16 v[144:147], a[68:71], v[68:71], v[144:147]
  v_cvt_pk_bf16_f32 v116, v168, v169
  v_cvt_pk_bf16_f32 v117, v170, v171
  v_mfma_f32_16x16x32_bf16 v[144:147], a[72:75], v[72:75], v[144:147]
  ds_read_b64_tr_b16 a[106:107], v14 offset:10240
  v_mfma_f32_16x16x32_bf16 v[144:147], a[76:79], v[76:79], v[144:147]
  v_cvt_pk_bf16_f32 v118, v172, v173
  v_cvt_pk_bf16_f32 v119, v174, v175
  v_mfma_f32_16x16x32_bf16 v[152:155], a[64:67], v[80:83], 0
  ds_read_b64_tr_b16 a[108:109], v14 offset:12288
  v_mfma_f32_16x16x32_bf16 v[152:155], a[68:71], v[84:87], v[152:155]
  buffer_store_dwordx4 v[116:119], v2, s[40:43], s77 offen offset:3072 sc1
  v_mfma_f32_16x16x32_bf16 v[152:155], a[72:75], v[88:91], v[152:155]
  ds_read_b64_tr_b16 a[110:111], v14 offset:14336
  v_mfma_f32_16x16x32_bf16 v[152:155], a[76:79], v[92:95], v[152:155]
  s_waitcnt lgkmcnt(8)
  v_cvt_pk_bf16_f32 v120, v176, v177
  v_cvt_pk_bf16_f32 v121, v178, v179
  v_mfma_f32_16x16x32_bf16 v[132:135], a[80:83], v[32:35], 0
  ds_read_b64_tr_b16 a[112:113], v15 offset:0
  v_mfma_f32_16x16x32_bf16 v[132:135], a[84:87], v[36:39], v[132:135]
  v_cvt_pk_bf16_f32 v122, v180, v181
  v_cvt_pk_bf16_f32 v123, v182, v183
  v_mfma_f32_16x16x32_bf16 v[132:135], a[88:91], v[40:43], v[132:135]
  ds_read_b64_tr_b16 a[114:115], v15 offset:2048
  v_mfma_f32_16x16x32_bf16 v[132:135], a[92:95], v[44:47], v[132:135]
  buffer_store_dwordx4 v[120:123], v2, s[40:43], s78 offen offset:3072 sc1
  v_mfma_f32_16x16x32_bf16 v[140:143], a[80:83], v[48:51], 0
  ds_read_b64_tr_b16 a[116:117], v15 offset:4096
  v_mfma_f32_16x16x32_bf16 v[140:143], a[84:87], v[52:55], v[140:143]
  v_cvt_pk_bf16_f32 v124, v184, v185
  v_cvt_pk_bf16_f32 v125, v186, v187
  v_mfma_f32_16x16x32_bf16 v[140:143], a[88:91], v[56:59], v[140:143]
  ds_read_b64_tr_b16 a[118:119], v15 offset:6144
  v_mfma_f32_16x16x32_bf16 v[140:143], a[92:95], v[60:63], v[140:143]
  v_cvt_pk_bf16_f32 v126, v188, v189
  v_cvt_pk_bf16_f32 v127, v190, v191
  v_mfma_f32_16x16x32_bf16 v[148:151], a[80:83], v[64:67], 0
  ds_read_b64_tr_b16 a[120:121], v15 offset:8192
  v_mfma_f32_16x16x32_bf16 v[148:151], a[84:87], v[68:71], v[148:151]
  buffer_store_dwordx4 v[124:127], v2, s[40:43], s79 offen offset:3072 sc1
  v_mfma_f32_16x16x32_bf16 v[148:151], a[88:91], v[72:75], v[148:151]
  ds_read_b64_tr_b16 a[122:123], v15 offset:10240
  v_mfma_f32_16x16x32_bf16 v[148:151], a[92:95], v[76:79], v[148:151]
  v_mfma_f32_16x16x32_bf16 v[156:159], a[80:83], v[80:83], 0
  ds_read_b64_tr_b16 a[124:125], v15 offset:12288
  v_mfma_f32_16x16x32_bf16 v[156:159], a[84:87], v[84:87], v[156:159]
  v_mfma_f32_16x16x32_bf16 v[156:159], a[88:91], v[88:91], v[156:159]
  ds_read_b64_tr_b16 a[126:127], v15 offset:14336
  v_mfma_f32_16x16x32_bf16 v[156:159], a[92:95], v[92:95], v[156:159]
  s_waitcnt lgkmcnt(8)
  v_mfma_f32_16x16x32_bf16 v[160:163], a[96:99], v[32:35], 0
  ds_read_b64_tr_b16 a[64:65], v12 offset:16384
  v_mfma_f32_16x16x32_bf16 v[160:163], a[100:103], v[36:39], v[160:163]
  s_add_u32 s76, s76, 0x1000
  s_add_u32 s77, s77, 0x1000
  s_add_u32 s78, s78, 0x1000
  s_add_u32 s79, s79, 0x1000
  v_mfma_f32_16x16x32_bf16 v[160:163], a[104:107], v[40:43], v[160:163]
  ds_read_b64_tr_b16 a[66:67], v12 offset:18432
  v_mfma_f32_16x16x32_bf16 v[160:163], a[108:111], v[44:47], v[160:163]
  v_cvt_pk_bf16_f32 v96, v128, v129
  v_cvt_pk_bf16_f32 v97, v130, v131
  v_mfma_f32_16x16x32_bf16 v[168:171], a[96:99], v[48:51], 0
  ds_read_b64_tr_b16 a[68:69], v12 offset:20480
  v_mfma_f32_16x16x32_bf16 v[168:171], a[100:103], v[52:55], v[168:171]
  v_cvt_pk_bf16_f32 v98, v132, v133
  v_cvt_pk_bf16_f32 v99, v134, v135
  v_mfma_f32_16x16x32_bf16 v[168:171], a[104:107], v[56:59], v[168:171]
  ds_read_b64_tr_b16 a[70:71], v12 offset:22528
  v_mfma_f32_16x16x32_bf16 v[168:171], a[108:111], v[60:63], v[168:171]
  buffer_store_dwordx4 v[96:99], v2, s[40:43], s76 offen offset:0 sc1
  v_mfma_f32_16x16x32_bf16 v[176:179], a[96:99], v[64:67], 0
  ds_read_b64_tr_b16 a[72:73], v12 offset:24576
  v_mfma_f32_16x16x32_bf16 v[176:179], a[100:103], v[68:71], v[176:179]
  v_cvt_pk_bf16_f32 v100, v136, v137
  v_cvt_pk_bf16_f32 v101, v138, v139
  v_mfma_f32_16x16x32_bf16 v[176:179], a[104:107], v[72:75], v[176:179]
  ds_read_b64_tr_b16 a[74:75], v12 offset:26624
  v_mfma_f32_16x16x32_bf16 v[176:179], a[108:111], v[76:79], v[176:179]
  v_cvt_pk_bf16_f32 v102, v140, v141
  v_cvt_pk_bf16_f32 v103, v142, v143
  v_mfma_f32_16x16x32_bf16 v[184:187], a[96:99], v[80:83], 0
  ds_read_b64_tr_b16 a[76:77], v12 offset:28672
  v_mfma_f32_16x16x32_bf16 v[184:187], a[100:103], v[84:87], v[184:187]
  buffer_store_dwordx4 v[100:103], v2, s[40:43], s77 offen offset:0 sc1
  v_mfma_f32_16x16x32_bf16 v[184:187], a[104:107], v[88:91], v[184:187]
  ds_read_b64_tr_b16 a[78:79], v12 offset:30720
  v_mfma_f32_16x16x32_bf16 v[184:187], a[108:111], v[92:95], v[184:187]
  s_waitcnt lgkmcnt(8)
  v_cvt_pk_bf16_f32 v104, v144, v145
  v_cvt_pk_bf16_f32 v105, v146, v147
  v_mfma_f32_16x16x32_bf16 v[164:167], a[112:115], v[32:35], 0
  ds_read_b64_tr_b16 a[80:81], v13 offset:16384
  v_mfma_f32_16x16x32_bf16 v[164:167], a[116:119], v[36:39], v[164:167]
  v_cvt_pk_bf16_f32 v106, v148, v149
  v_cvt_pk_bf16_f32 v107, v150, v151
  v_mfma_f32_16x16x32_bf16 v[164:167], a[120:123], v[40:43], v[164:167]
  ds_read_b64_tr_b16 a[82:83], v13 offset:18432
  v_mfma_f32_16x16x32_bf16 v[164:167], a[124:127], v[44:47], v[164:167]
  buffer_store_dwordx4 v[104:107], v2, s[40:43], s78 offen offset:0 sc1
  v_mfma_f32_16x16x32_bf16 v[172:175], a[112:115], v[48:51], 0
  ds_read_b64_tr_b16 a[84:85], v13 offset:20480
  v_mfma_f32_16x16x32_bf16 v[172:175], a[116:119], v[52:55], v[172:175]
  v_cvt_pk_bf16_f32 v108, v152, v153
  v_cvt_pk_bf16_f32 v109, v154, v155
  v_mfma_f32_16x16x32_bf16 v[172:175], a[120:123], v[56:59], v[172:175]
  ds_read_b64_tr_b16 a[86:87], v13 offset:22528
  v_mfma_f32_16x16x32_bf16 v[172:175], a[124:127], v[60:63], v[172:175]
  v_cvt_pk_bf16_f32 v110, v156, v157
  v_cvt_pk_bf16_f32 v111, v158, v159
  v_mfma_f32_16x16x32_bf16 v[180:183], a[112:115], v[64:67], 0
  ds_read_b64_tr_b16 a[88:89], v13 offset:24576
  v_mfma_f32_16x16x32_bf16 v[180:183], a[116:119], v[68:71], v[180:183]
  buffer_store_dwordx4 v[108:111], v2, s[40:43], s79 offen offset:0 sc1
  v_mfma_f32_16x16x32_bf16 v[180:183], a[120:123], v[72:75], v[180:183]
  ds_read_b64_tr_b16 a[90:91], v13 offset:26624
  v_mfma_f32_16x16x32_bf16 v[180:183], a[124:127], v[76:79], v[180:183]
  v_mfma_f32_16x16x32_bf16 v[188:191], a[112:115], v[80:83], 0
  ds_read_b64_tr_b16 a[92:93], v13 offset:28672
  v_mfma_f32_16x16x32_bf16 v[188:191], a[116:119], v[84:87], v[188:191]
  v_mfma_f32_16x16x32_bf16 v[188:191], a[120:123], v[88:91], v[188:191]
  ds_read_b64_tr_b16 a[94:95], v13 offset:30720
  v_mfma_f32_16x16x32_bf16 v[188:191], a[124:127], v[92:95], v[188:191]
  s_waitcnt lgkmcnt(8)
  v_mfma_f32_16x16x32_bf16 v[128:131], a[64:67], v[32:35], 0
  ds_read_b64_tr_b16 a[96:97], v14 offset:16384
  v_mfma_f32_16x16x32_bf16 v[128:131], a[68:71], v[36:39], v[128:131]
  s_nop 1
  v_mfma_f32_16x16x32_bf16 v[128:131], a[72:75], v[40:43], v[128:131]
  ds_read_b64_tr_b16 a[98:99], v14 offset:18432
  v_mfma_f32_16x16x32_bf16 v[128:131], a[76:79], v[44:47], v[128:131]
  v_cvt_pk_bf16_f32 v112, v160, v161
  v_cvt_pk_bf16_f32 v113, v162, v163
  v_mfma_f32_16x16x32_bf16 v[136:139], a[64:67], v[48:51], 0
  ds_read_b64_tr_b16 a[100:101], v14 offset:20480
  v_mfma_f32_16x16x32_bf16 v[136:139], a[68:71], v[52:55], v[136:139]
  v_cvt_pk_bf16_f32 v114, v164, v165
  v_cvt_pk_bf16_f32 v115, v166, v167
  v_mfma_f32_16x16x32_bf16 v[136:139], a[72:75], v[56:59], v[136:139]
  ds_read_b64_tr_b16 a[102:103], v14 offset:22528
  v_mfma_f32_16x16x32_bf16 v[136:139], a[76:79], v[60:63], v[136:139]
  buffer_store_dwordx4 v[112:115], v2, s[40:43], s76 offen offset:1024 sc1
  v_mfma_f32_16x16x32_bf16 v[144:147], a[64:67], v[64:67], 0
  ds_read_b64_tr_b16 a[104:105], v14 offset:24576
  v_mfma_f32_16x16x32_bf16 v[144:147], a[68:71], v[68:71], v[144:147]
  v_cvt_pk_bf16_f32 v116, v168, v169
  v_cvt_pk_bf16_f32 v117, v170, v171
  v_mfma_f32_16x16x32_bf16 v[144:147], a[72:75], v[72:75], v[144:147]
  ds_read_b64_tr_b16 a[106:107], v14 offset:26624
  v_mfma_f32_16x16x32_bf16 v[144:147], a[76:79], v[76:79], v[144:147]
  v_cvt_pk_bf16_f32 v118, v172, v173
  v_cvt_pk_bf16_f32 v119, v174, v175
  v_mfma_f32_16x16x32_bf16 v[152:155], a[64:67], v[80:83], 0
  ds_read_b64_tr_b16 a[108:109], v14 offset:28672
  v_mfma_f32_16x16x32_bf16 v[152:155], a[68:71], v[84:87], v[152:155]
  buffer_store_dwordx4 v[116:119], v2, s[40:43], s77 offen offset:1024 sc1
  v_mfma_f32_16x16x32_bf16 v[152:155], a[72:75], v[88:91], v[152:155]
  ds_read_b64_tr_b16 a[110:111], v14 offset:30720
  v_mfma_f32_16x16x32_bf16 v[152:155], a[76:79], v[92:95], v[152:155]
  s_waitcnt lgkmcnt(8)
  v_cvt_pk_bf16_f32 v120, v176, v177
  v_cvt_pk_bf16_f32 v121, v178, v179
  v_mfma_f32_16x16x32_bf16 v[132:135], a[80:83], v[32:35], 0
  ds_read_b64_tr_b16 a[112:113], v15 offset:16384
  v_mfma_f32_16x16x32_bf16 v[132:135], a[84:87], v[36:39], v[132:135]
  v_cvt_pk_bf16_f32 v122, v180, v181
  v_cvt_pk_bf16_f32 v123, v182, v183
  v_mfma_f32_16x16x32_bf16 v[132:135], a[88:91], v[40:43], v[132:135]
  ds_read_b64_tr_b16 a[114:115], v15 offset:18432
  v_mfma_f32_16x16x32_bf16 v[132:135], a[92:95], v[44:47], v[132:135]
  buffer_store_dwordx4 v[120:123], v2, s[40:43], s78 offen offset:1024 sc1
  v_mfma_f32_16x16x32_bf16 v[140:143], a[80:83], v[48:51], 0
  ds_read_b64_tr_b16 a[116:117], v15 offset:20480
  v_mfma_f32_16x16x32_bf16 v[140:143], a[84:87], v[52:55], v[140:143]
  v_cvt_pk_bf16_f32 v124, v184, v185
  v_cvt_pk_bf16_f32 v125, v186, v187
  v_mfma_f32_16x16x32_bf16 v[140:143], a[88:91], v[56:59], v[140:143]
  ds_read_b64_tr_b16 a[118:119], v15 offset:22528
  v_mfma_f32_16x16x32_bf16 v[140:143], a[92:95], v[60:63], v[140:143]
  v_cvt_pk_bf16_f32 v126, v188, v189
  v_cvt_pk_bf16_f32 v127, v190, v191
  v_mfma_f32_16x16x32_bf16 v[148:151], a[80:83], v[64:67], 0
  ds_read_b64_tr_b16 a[120:121], v15 offset:24576
  v_mfma_f32_16x16x32_bf16 v[148:151], a[84:87], v[68:71], v[148:151]
  buffer_store_dwordx4 v[124:127], v2, s[40:43], s79 offen offset:1024 sc1
  v_mfma_f32_16x16x32_bf16 v[148:151], a[88:91], v[72:75], v[148:151]
  ds_read_b64_tr_b16 a[122:123], v15 offset:26624
  v_mfma_f32_16x16x32_bf16 v[148:151], a[92:95], v[76:79], v[148:151]
  v_mfma_f32_16x16x32_bf16 v[156:159], a[80:83], v[80:83], 0
  ds_read_b64_tr_b16 a[124:125], v15 offset:28672
  v_mfma_f32_16x16x32_bf16 v[156:159], a[84:87], v[84:87], v[156:159]
  v_mfma_f32_16x16x32_bf16 v[156:159], a[88:91], v[88:91], v[156:159]
  ds_read_b64_tr_b16 a[126:127], v15 offset:30720
  v_mfma_f32_16x16x32_bf16 v[156:159], a[92:95], v[92:95], v[156:159]
  s_waitcnt lgkmcnt(8)
  v_mfma_f32_16x16x32_bf16 v[160:163], a[96:99], v[32:35], 0
  ds_read_b64_tr_b16 a[64:65], v12 offset:32768
  v_mfma_f32_16x16x32_bf16 v[160:163], a[100:103], v[36:39], v[160:163]
  s_nop 1
  v_mfma_f32_16x16x32_bf16 v[160:163], a[104:107], v[40:43], v[160:163]
  ds_read_b64_tr_b16 a[66:67], v12 offset:34816
  v_mfma_f32_16x16x32_bf16 v[160:163], a[108:111], v[44:47], v[160:163]
  v_cvt_pk_bf16_f32 v96, v128, v129
  v_cvt_pk_bf16_f32 v97, v130, v131
  v_mfma_f32_16x16x32_bf16 v[168:171], a[96:99], v[48:51], 0
  ds_read_b64_tr_b16 a[68:69], v12 offset:36864
  v_mfma_f32_16x16x32_bf16 v[168:171], a[100:103], v[52:55], v[168:171]
  v_cvt_pk_bf16_f32 v98, v132, v133
  v_cvt_pk_bf16_f32 v99, v134, v135
  v_mfma_f32_16x16x32_bf16 v[168:171], a[104:107], v[56:59], v[168:171]
  ds_read_b64_tr_b16 a[70:71], v12 offset:38912
  v_mfma_f32_16x16x32_bf16 v[168:171], a[108:111], v[60:63], v[168:171]
  buffer_store_dwordx4 v[96:99], v2, s[40:43], s76 offen offset:2048 sc1
  v_mfma_f32_16x16x32_bf16 v[176:179], a[96:99], v[64:67], 0
  ds_read_b64_tr_b16 a[72:73], v12 offset:40960
  v_mfma_f32_16x16x32_bf16 v[176:179], a[100:103], v[68:71], v[176:179]
  v_cvt_pk_bf16_f32 v100, v136, v137
  v_cvt_pk_bf16_f32 v101, v138, v139
  v_mfma_f32_16x16x32_bf16 v[176:179], a[104:107], v[72:75], v[176:179]
  ds_read_b64_tr_b16 a[74:75], v12 offset:43008
  v_mfma_f32_16x16x32_bf16 v[176:179], a[108:111], v[76:79], v[176:179]
  v_cvt_pk_bf16_f32 v102, v140, v141
  v_cvt_pk_bf16_f32 v103, v142, v143
  v_mfma_f32_16x16x32_bf16 v[184:187], a[96:99], v[80:83], 0
  ds_read_b64_tr_b16 a[76:77], v12 offset:45056
  v_mfma_f32_16x16x32_bf16 v[184:187], a[100:103], v[84:87], v[184:187]
  buffer_store_dwordx4 v[100:103], v2, s[40:43], s77 offen offset:2048 sc1
  v_mfma_f32_16x16x32_bf16 v[184:187], a[104:107], v[88:91], v[184:187]
  ds_read_b64_tr_b16 a[78:79], v12 offset:47104
  v_mfma_f32_16x16x32_bf16 v[184:187], a[108:111], v[92:95], v[184:187]
  s_waitcnt lgkmcnt(8)
  v_cvt_pk_bf16_f32 v104, v144, v145
  v_cvt_pk_bf16_f32 v105, v146, v147
  v_mfma_f32_16x16x32_bf16 v[164:167], a[112:115], v[32:35], 0
  ds_read_b64_tr_b16 a[80:81], v13 offset:32768
  v_mfma_f32_16x16x32_bf16 v[164:167], a[116:119], v[36:39], v[164:167]
  v_cvt_pk_bf16_f32 v106, v148, v149
  v_cvt_pk_bf16_f32 v107, v150, v151
  v_mfma_f32_16x16x32_bf16 v[164:167], a[120:123], v[40:43], v[164:167]
  ds_read_b64_tr_b16 a[82:83], v13 offset:34816
  v_mfma_f32_16x16x32_bf16 v[164:167], a[124:127], v[44:47], v[164:167]
  buffer_store_dwordx4 v[104:107], v2, s[40:43], s78 offen offset:2048 sc1
  v_mfma_f32_16x16x32_bf16 v[172:175], a[112:115], v[48:51], 0
  ds_read_b64_tr_b16 a[84:85], v13 offset:36864
  v_mfma_f32_16x16x32_bf16 v[172:175], a[116:119], v[52:55], v[172:175]
  v_cvt_pk_bf16_f32 v108, v152, v153
  v_cvt_pk_bf16_f32 v109, v154, v155
  v_mfma_f32_16x16x32_bf16 v[172:175], a[120:123], v[56:59], v[172:175]
  ds_read_b64_tr_b16 a[86:87], v13 offset:38912
  v_mfma_f32_16x16x32_bf16 v[172:175], a[124:127], v[60:63], v[172:175]
  v_cvt_pk_bf16_f32 v110, v156, v157
  v_cvt_pk_bf16_f32 v111, v158, v159
  v_mfma_f32_16x16x32_bf16 v[180:183], a[112:115], v[64:67], 0
  ds_read_b64_tr_b16 a[88:89], v13 offset:40960
  v_mfma_f32_16x16x32_bf16 v[180:183], a[116:119], v[68:71], v[180:183]
  buffer_store_dwordx4 v[108:111], v2, s[40:43], s79 offen offset:2048 sc1
  v_mfma_f32_16x16x32_bf16 v[180:183], a[120:123], v[72:75], v[180:183]
  ds_read_b64_tr_b16 a[90:91], v13 offset:43008
  v_mfma_f32_16x16x32_bf16 v[180:183], a[124:127], v[76:79], v[180:183]
  v_mfma_f32_16x16x32_bf16 v[188:191], a[112:115], v[80:83], 0
  ds_read_b64_tr_b16 a[92:93], v13 offset:45056
  v_mfma_f32_16x16x32_bf16 v[188:191], a[116:119], v[84:87], v[188:191]
  v_mfma_f32_16x16x32_bf16 v[188:191], a[120:123], v[88:91], v[188:191]
  ds_read_b64_tr_b16 a[94:95], v13 offset:47104
  v_mfma_f32_16x16x32_bf16 v[188:191], a[124:127], v[92:95], v[188:191]
  s_waitcnt lgkmcnt(8)
  v_mfma_f32_16x16x32_bf16 v[128:131], a[64:67], v[32:35], 0
  ds_read_b64_tr_b16 a[96:97], v14 offset:32768
  v_mfma_f32_16x16x32_bf16 v[128:131], a[68:71], v[36:39], v[128:131]
  s_nop 1
  v_mfma_f32_16x16x32_bf16 v[128:131], a[72:75], v[40:43], v[128:131]
  ds_read_b64_tr_b16 a[98:99], v14 offset:34816
  v_mfma_f32_16x16x32_bf16 v[128:131], a[76:79], v[44:47], v[128:131]
  v_cvt_pk_bf16_f32 v112, v160, v161
  v_cvt_pk_bf16_f32 v113, v162, v163
  v_mfma_f32_16x16x32_bf16 v[136:139], a[64:67], v[48:51], 0
  ds_read_b64_tr_b16 a[100:101], v14 offset:36864
  v_mfma_f32_16x16x32_bf16 v[136:139], a[68:71], v[52:55], v[136:139]
  v_cvt_pk_bf16_f32 v114, v164, v165
  v_cvt_pk_bf16_f32 v115, v166, v167
  v_mfma_f32_16x16x32_bf16 v[136:139], a[72:75], v[56:59], v[136:139]
  ds_read_b64_tr_b16 a[102:103], v14 offset:38912
  v_mfma_f32_16x16x32_bf16 v[136:139], a[76:79], v[60:63], v[136:139]
  buffer_store_dwordx4 v[112:115], v2, s[40:43], s76 offen offset:3072 sc1
  v_mfma_f32_16x16x32_bf16 v[144:147], a[64:67], v[64:67], 0
  ds_read_b64_tr_b16 a[104:105], v14 offset:40960
  v_mfma_f32_16x16x32_bf16 v[144:147], a[68:71], v[68:71], v[144:147]
  v_cvt_pk_bf16_f32 v116, v168, v169
  v_cvt_pk_bf16_f32 v117, v170, v171
  v_mfma_f32_16x16x32_bf16 v[144:147], a[72:75], v[72:75], v[144:147]
  ds_read_b64_tr_b16 a[106:107], v14 offset:43008
  v_mfma_f32_16x16x32_bf16 v[144:147], a[76:79], v[76:79], v[144:147]
  v_cvt_pk_bf16_f32 v118, v172, v173
  v_cvt_pk_bf16_f32 v119, v174, v175
  v_mfma_f32_16x16x32_bf16 v[152:155], a[64:67], v[80:83], 0
  ds_read_b64_tr_b16 a[108:109], v14 offset:45056
  v_mfma_f32_16x16x32_bf16 v[152:155], a[68:71], v[84:87], v[152:155]
  buffer_store_dwordx4 v[116:119], v2, s[40:43], s77 offen offset:3072 sc1
  v_mfma_f32_16x16x32_bf16 v[152:155], a[72:75], v[88:91], v[152:155]
  ds_read_b64_tr_b16 a[110:111], v14 offset:47104
  v_mfma_f32_16x16x32_bf16 v[152:155], a[76:79], v[92:95], v[152:155]
  s_waitcnt lgkmcnt(8)
  v_cvt_pk_bf16_f32 v120, v176, v177
  v_cvt_pk_bf16_f32 v121, v178, v179
  v_mfma_f32_16x16x32_bf16 v[132:135], a[80:83], v[32:35], 0
  ds_read_b64_tr_b16 a[112:113], v15 offset:32768
  v_mfma_f32_16x16x32_bf16 v[132:135], a[84:87], v[36:39], v[132:135]
  v_cvt_pk_bf16_f32 v122, v180, v181
  v_cvt_pk_bf16_f32 v123, v182, v183
  v_mfma_f32_16x16x32_bf16 v[132:135], a[88:91], v[40:43], v[132:135]
  ds_read_b64_tr_b16 a[114:115], v15 offset:34816
  v_mfma_f32_16x16x32_bf16 v[132:135], a[92:95], v[44:47], v[132:135]
  buffer_store_dwordx4 v[120:123], v2, s[40:43], s78 offen offset:3072 sc1
  v_mfma_f32_16x16x32_bf16 v[140:143], a[80:83], v[48:51], 0
  ds_read_b64_tr_b16 a[116:117], v15 offset:36864
  v_mfma_f32_16x16x32_bf16 v[140:143], a[84:87], v[52:55], v[140:143]
  v_cvt_pk_bf16_f32 v124, v184, v185
  v_cvt_pk_bf16_f32 v125, v186, v187
  v_mfma_f32_16x16x32_bf16 v[140:143], a[88:91], v[56:59], v[140:143]
  ds_read_b64_tr_b16 a[118:119], v15 offset:38912
  v_mfma_f32_16x16x32_bf16 v[140:143], a[92:95], v[60:63], v[140:143]
  v_cvt_pk_bf16_f32 v126, v188, v189
  v_cvt_pk_bf16_f32 v127, v190, v191
  v_mfma_f32_16x16x32_bf16 v[148:151], a[80:83], v[64:67], 0
  ds_read_b64_tr_b16 a[120:121], v15 offset:40960
  v_mfma_f32_16x16x32_bf16 v[148:151], a[84:87], v[68:71], v[148:151]
  buffer_store_dwordx4 v[124:127], v2, s[40:43], s79 offen offset:3072 sc1
  v_mfma_f32_16x16x32_bf16 v[148:151], a[88:91], v[72:75], v[148:151]
  ds_read_b64_tr_b16 a[122:123], v15 offset:43008
  v_mfma_f32_16x16x32_bf16 v[148:151], a[92:95], v[76:79], v[148:151]
  v_mfma_f32_16x16x32_bf16 v[156:159], a[80:83], v[80:83], 0
  ds_read_b64_tr_b16 a[124:125], v15 offset:45056
  v_mfma_f32_16x16x32_bf16 v[156:159], a[84:87], v[84:87], v[156:159]
  v_mfma_f32_16x16x32_bf16 v[156:159], a[88:91], v[88:91], v[156:159]
  s_waitcnt vmcnt(32)
  s_barrier
  ds_read_b64_tr_b16 a[126:127], v15 offset:47104
  v_mfma_f32_16x16x32_bf16 v[156:159], a[92:95], v[92:95], v[156:159]
  s_waitcnt lgkmcnt(8)
  v_mfma_f32_16x16x32_bf16 v[160:163], a[96:99], v[32:35], 0
  ds_read_b64_tr_b16 a[64:65], v12 offset:49152
  v_mfma_f32_16x16x32_bf16 v[160:163], a[100:103], v[36:39], v[160:163]
  s_add_u32 s76, s76, 0x1000
  s_add_u32 s77, s77, 0x1000
  s_add_u32 s78, s78, 0x1000
  s_add_u32 s79, s79, 0x1000
  v_mfma_f32_16x16x32_bf16 v[160:163], a[104:107], v[40:43], v[160:163]
  ds_read_b64_tr_b16 a[66:67], v12 offset:51200
  v_mfma_f32_16x16x32_bf16 v[160:163], a[108:111], v[44:47], v[160:163]
  v_cvt_pk_bf16_f32 v96, v128, v129
  v_cvt_pk_bf16_f32 v97, v130, v131
  v_mfma_f32_16x16x32_bf16 v[168:171], a[96:99], v[48:51], 0
  ds_read_b64_tr_b16 a[68:69], v12 offset:53248
  v_mfma_f32_16x16x32_bf16 v[168:171], a[100:103], v[52:55], v[168:171]
  v_cvt_pk_bf16_f32 v98, v132, v133
  v_cvt_pk_bf16_f32 v99, v134, v135
  v_mfma_f32_16x16x32_bf16 v[168:171], a[104:107], v[56:59], v[168:171]
  ds_read_b64_tr_b16 a[70:71], v12 offset:55296
  v_mfma_f32_16x16x32_bf16 v[168:171], a[108:111], v[60:63], v[168:171]
  buffer_store_dwordx4 v[96:99], v2, s[40:43], s76 offen offset:0 sc1
  v_mfma_f32_16x16x32_bf16 v[176:179], a[96:99], v[64:67], 0
  ds_read_b64_tr_b16 a[72:73], v12 offset:57344
  v_mfma_f32_16x16x32_bf16 v[176:179], a[100:103], v[68:71], v[176:179]
  v_cvt_pk_bf16_f32 v100, v136, v137
  v_cvt_pk_bf16_f32 v101, v138, v139
  v_mfma_f32_16x16x32_bf16 v[176:179], a[104:107], v[72:75], v[176:179]
  ds_read_b64_tr_b16 a[74:75], v12 offset:59392
  v_mfma_f32_16x16x32_bf16 v[176:179], a[108:111], v[76:79], v[176:179]
  v_cvt_pk_bf16_f32 v102, v140, v141
  v_cvt_pk_bf16_f32 v103, v142, v143
  v_mfma_f32_16x16x32_bf16 v[184:187], a[96:99], v[80:83], 0
  ds_read_b64_tr_b16 a[76:77], v12 offset:61440
  v_mfma_f32_16x16x32_bf16 v[184:187], a[100:103], v[84:87], v[184:187]
  buffer_store_dwordx4 v[100:103], v2, s[40:43], s77 offen offset:0 sc1
  v_mfma_f32_16x16x32_bf16 v[184:187], a[104:107], v[88:91], v[184:187]
  ds_read_b64_tr_b16 a[78:79], v12 offset:63488
  v_mfma_f32_16x16x32_bf16 v[184:187], a[108:111], v[92:95], v[184:187]
  s_waitcnt lgkmcnt(8)
  v_cvt_pk_bf16_f32 v104, v144, v145
  v_cvt_pk_bf16_f32 v105, v146, v147
  v_mfma_f32_16x16x32_bf16 v[164:167], a[112:115], v[32:35], 0
  ds_read_b64_tr_b16 a[80:81], v13 offset:49152
  v_mfma_f32_16x16x32_bf16 v[164:167], a[116:119], v[36:39], v[164:167]
  v_cvt_pk_bf16_f32 v106, v148, v149
  v_cvt_pk_bf16_f32 v107, v150, v151
  v_mfma_f32_16x16x32_bf16 v[164:167], a[120:123], v[40:43], v[164:167]
  ds_read_b64_tr_b16 a[82:83], v13 offset:51200
  v_mfma_f32_16x16x32_bf16 v[164:167], a[124:127], v[44:47], v[164:167]
  buffer_store_dwordx4 v[104:107], v2, s[40:43], s78 offen offset:0 sc1
  v_mfma_f32_16x16x32_bf16 v[172:175], a[112:115], v[48:51], 0
  ds_read_b64_tr_b16 a[84:85], v13 offset:53248
  v_mfma_f32_16x16x32_bf16 v[172:175], a[116:119], v[52:55], v[172:175]
  v_cvt_pk_bf16_f32 v108, v152, v153
  v_cvt_pk_bf16_f32 v109, v154, v155
  v_mfma_f32_16x16x32_bf16 v[172:175], a[120:123], v[56:59], v[172:175]
  ds_read_b64_tr_b16 a[86:87], v13 offset:55296
  v_mfma_f32_16x16x32_bf16 v[172:175], a[124:127], v[60:63], v[172:175]
  v_cvt_pk_bf16_f32 v110, v156, v157
  v_cvt_pk_bf16_f32 v111, v158, v159
  v_mfma_f32_16x16x32_bf16 v[180:183], a[112:115], v[64:67], 0
  ds_read_b64_tr_b16 a[88:89], v13 offset:57344
  v_mfma_f32_16x16x32_bf16 v[180:183], a[116:119], v[68:71], v[180:183]
  buffer_store_dwordx4 v[108:111], v2, s[40:43], s79 offen offset:0 sc1
  v_mfma_f32_16x16x32_bf16 v[180:183], a[120:123], v[72:75], v[180:183]
  ds_read_b64_tr_b16 a[90:91], v13 offset:59392
  v_mfma_f32_16x16x32_bf16 v[180:183], a[124:127], v[76:79], v[180:183]
  v_mfma_f32_16x16x32_bf16 v[188:191], a[112:115], v[80:83], 0
  ds_read_b64_tr_b16 a[92:93], v13 offset:61440
  v_mfma_f32_16x16x32_bf16 v[188:191], a[116:119], v[84:87], v[188:191]
  v_mfma_f32_16x16x32_bf16 v[188:191], a[120:123], v[88:91], v[188:191]
  ds_read_b64_tr_b16 a[94:95], v13 offset:63488
  v_mfma_f32_16x16x32_bf16 v[188:191], a[124:127], v[92:95], v[188:191]
  s_waitcnt lgkmcnt(8)
  v_mfma_f32_16x16x32_bf16 v[128:131], a[64:67], v[32:35], 0
  ds_read_b64_tr_b16 a[96:97], v14 offset:49152
  v_mfma_f32_16x16x32_bf16 v[128:131], a[68:71], v[36:39], v[128:131]
  s_nop 1
  v_mfma_f32_16x16x32_bf16 v[128:131], a[72:75], v[40:43], v[128:131]
  ds_read_b64_tr_b16 a[98:99], v14 offset:51200
  v_mfma_f32_16x16x32_bf16 v[128:131], a[76:79], v[44:47], v[128:131]
  v_cvt_pk_bf16_f32 v112, v160, v161
  v_cvt_pk_bf16_f32 v113, v162, v163
  v_mfma_f32_16x16x32_bf16 v[136:139], a[64:67], v[48:51], 0
  ds_read_b64_tr_b16 a[100:101], v14 offset:53248
  v_mfma_f32_16x16x32_bf16 v[136:139], a[68:71], v[52:55], v[136:139]
  v_cvt_pk_bf16_f32 v114, v164, v165
  v_cvt_pk_bf16_f32 v115, v166, v167
  v_mfma_f32_16x16x32_bf16 v[136:139], a[72:75], v[56:59], v[136:139]
  ds_read_b64_tr_b16 a[102:103], v14 offset:55296
  v_mfma_f32_16x16x32_bf16 v[136:139], a[76:79], v[60:63], v[136:139]
  buffer_store_dwordx4 v[112:115], v2, s[40:43], s76 offen offset:1024 sc1
  v_mfma_f32_16x16x32_bf16 v[144:147], a[64:67], v[64:67], 0
  ds_read_b64_tr_b16 a[104:105], v14 offset:57344
  v_mfma_f32_16x16x32_bf16 v[144:147], a[68:71], v[68:71], v[144:147]
  v_cvt_pk_bf16_f32 v116, v168, v169
  v_cvt_pk_bf16_f32 v117, v170, v171
  v_mfma_f32_16x16x32_bf16 v[144:147], a[72:75], v[72:75], v[144:147]
  ds_read_b64_tr_b16 a[106:107], v14 offset:59392
  v_mfma_f32_16x16x32_bf16 v[144:147], a[76:79], v[76:79], v[144:147]
  v_cvt_pk_bf16_f32 v118, v172, v173
  v_cvt_pk_bf16_f32 v119, v174, v175
  v_mfma_f32_16x16x32_bf16 v[152:155], a[64:67], v[80:83], 0
  ds_read_b64_tr_b16 a[108:109], v14 offset:61440
  v_mfma_f32_16x16x32_bf16 v[152:155], a[68:71], v[84:87], v[152:155]
  buffer_store_dwordx4 v[116:119], v2, s[40:43], s77 offen offset:1024 sc1
  v_mfma_f32_16x16x32_bf16 v[152:155], a[72:75], v[88:91], v[152:155]
  ds_read_b64_tr_b16 a[110:111], v14 offset:63488
  v_mfma_f32_16x16x32_bf16 v[152:155], a[76:79], v[92:95], v[152:155]
  s_waitcnt lgkmcnt(8)
  v_cvt_pk_bf16_f32 v120, v176, v177
  v_cvt_pk_bf16_f32 v121, v178, v179
  v_mfma_f32_16x16x32_bf16 v[132:135], a[80:83], v[32:35], 0
  ds_read_b64_tr_b16 a[112:113], v15 offset:49152
  v_mfma_f32_16x16x32_bf16 v[132:135], a[84:87], v[36:39], v[132:135]
  v_cvt_pk_bf16_f32 v122, v180, v181
  v_cvt_pk_bf16_f32 v123, v182, v183
  v_mfma_f32_16x16x32_bf16 v[132:135], a[88:91], v[40:43], v[132:135]
  ds_read_b64_tr_b16 a[114:115], v15 offset:51200
  v_mfma_f32_16x16x32_bf16 v[132:135], a[92:95], v[44:47], v[132:135]
  buffer_store_dwordx4 v[120:123], v2, s[40:43], s78 offen offset:1024 sc1
  v_mfma_f32_16x16x32_bf16 v[140:143], a[80:83], v[48:51], 0
  ds_read_b64_tr_b16 a[116:117], v15 offset:53248
  v_mfma_f32_16x16x32_bf16 v[140:143], a[84:87], v[52:55], v[140:143]
  v_cvt_pk_bf16_f32 v124, v184, v185
  v_cvt_pk_bf16_f32 v125, v186, v187
  v_mfma_f32_16x16x32_bf16 v[140:143], a[88:91], v[56:59], v[140:143]
  ds_read_b64_tr_b16 a[118:119], v15 offset:55296
  v_mfma_f32_16x16x32_bf16 v[140:143], a[92:95], v[60:63], v[140:143]
  v_cvt_pk_bf16_f32 v126, v188, v189
  v_cvt_pk_bf16_f32 v127, v190, v191
  v_mfma_f32_16x16x32_bf16 v[148:151], a[80:83], v[64:67], 0
  ds_read_b64_tr_b16 a[120:121], v15 offset:57344
  v_mfma_f32_16x16x32_bf16 v[148:151], a[84:87], v[68:71], v[148:151]
  buffer_store_dwordx4 v[124:127], v2, s[40:43], s79 offen offset:1024 sc1
  v_mfma_f32_16x16x32_bf16 v[148:151], a[88:91], v[72:75], v[148:151]
  ds_read_b64_tr_b16 a[122:123], v15 offset:59392
  v_mfma_f32_16x16x32_bf16 v[148:151], a[92:95], v[76:79], v[148:151]
  v_mfma_f32_16x16x32_bf16 v[156:159], a[80:83], v[80:83], 0
  ds_read_b64_tr_b16 a[124:125], v15 offset:61440
  v_mfma_f32_16x16x32_bf16 v[156:159], a[84:87], v[84:87], v[156:159]
  v_mfma_f32_16x16x32_bf16 v[156:159], a[88:91], v[88:91], v[156:159]
  ds_read_b64_tr_b16 a[126:127], v15 offset:63488
  v_mfma_f32_16x16x32_bf16 v[156:159], a[92:95], v[92:95], v[156:159]
  s_waitcnt lgkmcnt(8)
  v_mfma_f32_16x16x32_bf16 v[160:163], a[96:99], v[32:35], 0
  v_mfma_f32_16x16x32_bf16 v[160:163], a[100:103], v[36:39], v[160:163]
  s_nop 1
  v_mfma_f32_16x16x32_bf16 v[160:163], a[104:107], v[40:43], v[160:163]
  v_mfma_f32_16x16x32_bf16 v[160:163], a[108:111], v[44:47], v[160:163]
  v_cvt_pk_bf16_f32 v96, v128, v129
  v_cvt_pk_bf16_f32 v97, v130, v131
  v_mfma_f32_16x16x32_bf16 v[168:171], a[96:99], v[48:51], 0
  v_mfma_f32_16x16x32_bf16 v[168:171], a[100:103], v[52:55], v[168:171]
  v_cvt_pk_bf16_f32 v98, v132, v133
  v_cvt_pk_bf16_f32 v99, v134, v135
  v_mfma_f32_16x16x32_bf16 v[168:171], a[104:107], v[56:59], v[168:171]
  v_mfma_f32_16x16x32_bf16 v[168:171], a[108:111], v[60:63], v[168:171]
  buffer_store_dwordx4 v[96:99], v2, s[40:43], s76 offen offset:2048 sc1
  v_mfma_f32_16x16x32_bf16 v[176:179], a[96:99], v[64:67], 0
  v_mfma_f32_16x16x32_bf16 v[176:179], a[100:103], v[68:71], v[176:179]
  v_cvt_pk_bf16_f32 v100, v136, v137
  v_cvt_pk_bf16_f32 v101, v138, v139
  v_mfma_f32_16x16x32_bf16 v[176:179], a[104:107], v[72:75], v[176:179]
  v_mfma_f32_16x16x32_bf16 v[176:179], a[108:111], v[76:79], v[176:179]
  v_cvt_pk_bf16_f32 v102, v140, v141
  v_cvt_pk_bf16_f32 v103, v142, v143
  v_mfma_f32_16x16x32_bf16 v[184:187], a[96:99], v[80:83], 0
  v_mfma_f32_16x16x32_bf16 v[184:187], a[100:103], v[84:87], v[184:187]
  buffer_store_dwordx4 v[100:103], v2, s[40:43], s77 offen offset:2048 sc1
  v_mfma_f32_16x16x32_bf16 v[184:187], a[104:107], v[88:91], v[184:187]
  v_mfma_f32_16x16x32_bf16 v[184:187], a[108:111], v[92:95], v[184:187]
  s_waitcnt lgkmcnt(0)
  v_cvt_pk_bf16_f32 v104, v144, v145
  v_cvt_pk_bf16_f32 v105, v146, v147
  v_mfma_f32_16x16x32_bf16 v[164:167], a[112:115], v[32:35], 0
  v_mfma_f32_16x16x32_bf16 v[164:167], a[116:119], v[36:39], v[164:167]
  v_cvt_pk_bf16_f32 v106, v148, v149
  v_cvt_pk_bf16_f32 v107, v150, v151
  v_mfma_f32_16x16x32_bf16 v[164:167], a[120:123], v[40:43], v[164:167]
  v_mfma_f32_16x16x32_bf16 v[164:167], a[124:127], v[44:47], v[164:167]
  buffer_store_dwordx4 v[104:107], v2, s[40:43], s78 offen offset:2048 sc1
  v_mfma_f32_16x16x32_bf16 v[172:175], a[112:115], v[48:51], 0
  v_mfma_f32_16x16x32_bf16 v[172:175], a[116:119], v[52:55], v[172:175]
  v_cvt_pk_bf16_f32 v108, v152, v153
  v_cvt_pk_bf16_f32 v109, v154, v155
  v_mfma_f32_16x16x32_bf16 v[172:175], a[120:123], v[56:59], v[172:175]
  v_mfma_f32_16x16x32_bf16 v[172:175], a[124:127], v[60:63], v[172:175]
  v_cvt_pk_bf16_f32 v110, v156, v157
  v_cvt_pk_bf16_f32 v111, v158, v159
  v_mfma_f32_16x16x32_bf16 v[180:183], a[112:115], v[64:67], 0
  v_mfma_f32_16x16x32_bf16 v[180:183], a[116:119], v[68:71], v[180:183]
  buffer_store_dwordx4 v[108:111], v2, s[40:43], s79 offen offset:2048 sc1
  v_mfma_f32_16x16x32_bf16 v[180:183], a[120:123], v[72:75], v[180:183]
  v_mfma_f32_16x16x32_bf16 v[180:183], a[124:127], v[76:79], v[180:183]
  v_mfma_f32_16x16x32_bf16 v[188:191], a[112:115], v[80:83], 0
  v_mfma_f32_16x16x32_bf16 v[188:191], a[116:119], v[84:87], v[188:191]
  v_mfma_f32_16x16x32_bf16 v[188:191], a[120:123], v[88:91], v[188:191]
  v_mfma_f32_16x16x32_bf16 v[188:191], a[124:127], v[92:95], v[188:191]
  s_nop 7
  v_cvt_pk_bf16_f32 v112, v160, v161
  v_cvt_pk_bf16_f32 v113, v162, v163
  v_cvt_pk_bf16_f32 v114, v164, v165
  v_cvt_pk_bf16_f32 v115, v166, v167
  buffer_store_dwordx4 v[112:115], v2, s[40:43], s76 offen offset:3072 sc1
  v_cvt_pk_bf16_f32 v116, v168, v169
  v_cvt_pk_bf16_f32 v117, v170, v171
  v_cvt_pk_bf16_f32 v118, v172, v173
  v_cvt_pk_bf16_f32 v119, v174, v175
  buffer_store_dwordx4 v[116:119], v2, s[40:43], s77 offen offset:3072 sc1
  v_cvt_pk_bf16_f32 v120, v176, v177
  v_cvt_pk_bf16_f32 v121, v178, v179
  v_cvt_pk_bf16_f32 v122, v180, v181
  v_cvt_pk_bf16_f32 v123, v182, v183
  buffer_store_dwordx4 v[120:123], v2, s[40:43], s78 offen offset:3072 sc1
  v_cvt_pk_bf16_f32 v124, v184, v185
  v_cvt_pk_bf16_f32 v125, v186, v187
  v_cvt_pk_bf16_f32 v126, v188, v189
  v_cvt_pk_bf16_f32 v127, v190, v191
  buffer_store_dwordx4 v[124:127], v2, s[40:43], s79 offen offset:3072 sc1
  s_lshl_b32 s66, s57, 7
  s_add_u32 s66, s66, 0xd086000
  s_cmp_eq_u32 s44, 0
  s_cselect_b32 s66, s66, 0x40000000
  v_mov_b32 v6, 1
  s_waitcnt vmcnt(0)
  s_barrier
  s_mov_b64 exec, 1
  buffer_atomic_add v6, v2, s[40:43], s66 offen
  s_mov_b64 exec, -1
  s_branch L_att_end
L_a_s1_t:
  s_mov_b32 s71, 0
  s_nop 6
  s_branch L_a_slow0_0
L_a_s0_t:
  s_mov_b32 s71, 1
  s_nop 6
  s_branch L_a_slow1_0
L_a_d0_t:
  s_mov_b32 s71, 2
  s_nop 6
  s_branch L_a_slow0_0
L_a_d1_t:
  s_mov_b32 s71, 3
  s_nop 6
  s_branch L_a_slow1_0
L_a_d2_t:
  s_mov_b32 s71, 4
  s_nop 6
  s_branch L_a_slow0_1
L_a_d3_t:
  s_mov_b32 s71, 5
  s_nop 6
  s_branch L_a_slow1_1
L_a_d4_t:
  s_mov_b32 s71, 6
  s_nop 6
  s_branch L_a_slow0_2
L_a_d5_t:
  s_mov_b32 s71, 7
  s_nop 6
  s_branch L_a_slow1_2
L_a_d6_t:
  s_mov_b32 s71, 8
  s_nop 6
  s_branch L_a_slow0_3
L_a_d7_t:
  s_mov_b32 s71, 9
  s_nop 6
  s_branch L_a_slow1_3
L_a_slow0_0:
  v_max3_f32 v6, v32, v33, v34
  v_max3_f32 v7, v35, v36, v37
  v_max3_f32 v6, v6, v38, v39
  v_max_f32 v6, v6, v7
  v_mov_b32 v7, v6
  s_nop 1
  v_permlane32_swap_b32 v7, v6
  v_max_f32 v6, v6, v7
  v_mov_b32 v7, v6
  s_nop 1
  v_permlane16_swap_b32 v7, v6
  v_max_f32 v6, v6, v7
  v_add_f32 v6, 0x41800000, v6
  v_max_f32 v6, 0, v6
  v_exp_f32 v7, -v6
  v_sub_f32 v96, v96, v6
  v_sub_f32 v97, v97, v6
  v_sub_f32 v98, v98, v6
  v_sub_f32 v99, v99, v6
  v_sub_f32 v100, v100, v6
  v_sub_f32 v101, v101, v6
  v_sub_f32 v102, v102, v6
  v_sub_f32 v103, v103, v6
  v_mul_f32 v128, v128, v7
  v_mul_f32 v129, v129, v7
  v_mul_f32 v130, v130, v7
  v_mul_f32 v131, v131, v7
  v_mul_f32 v132, v132, v7
  v_mul_f32 v133, v133, v7
  v_mul_f32 v134, v134, v7
  v_mul_f32 v135, v135, v7
  v_mul_f32 v136, v136, v7
  v_mul_f32 v137, v137, v7
  v_mul_f32 v138, v138, v7
  v_mul_f32 v139, v139, v7
  v_mul_f32 v140, v140, v7
  v_mul_f32 v141, v141, v7
  v_mul_f32 v142, v142, v7
  v_mul_f32 v143, v143, v7
  v_mul_f32 v144, v144, v7
  v_mul_f32 v145, v145, v7
  v_mul_f32 v146, v146, v7
  v_mul_f32 v147, v147, v7
  v_mul_f32 v148, v148, v7
  v_mul_f32 v149, v149, v7
  v_mul_f32 v150, v150, v7
  v_mul_f32 v151, v151, v7
  v_mul_f32 v152, v152, v7
  v_mul_f32 v153, v153, v7
  v_mul_f32 v154, v154, v7
  v_mul_f32 v155, v155, v7
  v_mul_f32 v156, v156, v7
  v_mul_f32 v157, v157, v7
  v_mul_f32 v158, v158, v7
  v_mul_f32 v159, v159, v7
  v_accvgpr_read_b32 v8, a128
  v_mul_f32 v8, v8, v7
  v_accvgpr_write_b32 a128, v8
  v_accvgpr_read_b32 v8, a129
  v_mul_f32 v8, v8, v7
  v_accvgpr_write_b32 a129, v8
  v_accvgpr_read_b32 v8, a130
  v_mul_f32 v8, v8, v7
  v_accvgpr_write_b32 a130, v8
  v_accvgpr_read_b32 v8, a131
  v_mul_f32 v8, v8, v7
  v_accvgpr_write_b32 a131, v8
  v_sub_f32 v8, v32, v6
  v_sub_f32 v9, v33, v6
  v_sub_f32 v10, v34, v6
  v_sub_f32 v11, v35, v6
  v_sub_f32 v12, v36, v6
  v_sub_f32 v13, v37, v6
  v_sub_f32 v14, v38, v6
  v_sub_f32 v15, v39, v6
  v_exp_f32 v8, v8
  v_exp_f32 v9, v9
  v_exp_f32 v10, v10
  v_exp_f32 v11, v11
  v_exp_f32 v12, v12
  v_exp_f32 v13, v13
  v_exp_f32 v14, v14
  v_exp_f32 v15, v15
  v_cvt_pk_bf16_f32 v64, v8, v9
  v_cvt_pk_bf16_f32 v65, v10, v11
  v_cvt_pk_bf16_f32 v66, v12, v13
  v_cvt_pk_bf16_f32 v67, v14, v15
L_a_slow0_1:
  v_max3_f32 v6, v40, v41, v42
  v_max3_f32 v7, v43, v44, v45
  v_max3_f32 v6, v6, v46, v47
  v_max_f32 v6, v6, v7
  v_mov_b32 v7, v6
  s_nop 1
  v_permlane32_swap_b32 v7, v6
  v_max_f32 v6, v6, v7
  v_mov_b32 v7, v6
  s_nop 1
  v_permlane16_swap_b32 v7, v6
  v_max_f32 v6, v6, v7
  v_add_f32 v6, 0x41800000, v6
  v_max_f32 v6, 0, v6
  v_exp_f32 v7, -v6
  v_sub_f32 v104, v104, v6
  v_sub_f32 v105, v105, v6
  v_sub_f32 v106, v106, v6
  v_sub_f32 v107, v107, v6
  v_sub_f32 v108, v108, v6
  v_sub_f32 v109, v109, v6
  v_sub_f32 v110, v110, v6
  v_sub_f32 v111, v111, v6
  v_mul_f32 v160, v160, v7
  v_mul_f32 v161, v161, v7
  v_mul_f32 v162, v162, v7
  v_mul_f32 v163, v163, v7
  v_mul_f32 v164, v164, v7
  v_mul_f32 v165, v165, v7
  v_mul_f32 v166, v166, v7
  v_mul_f32 v167, v167, v7
  v_mul_f32 v168, v168, v7
  v_mul_f32 v169, v169, v7
  v_mul_f32 v170, v170, v7
  v_mul_f32 v171, v171, v7
  v_mul_f32 v172, v172, v7
  v_mul_f32 v173, v173, v7
  v_mul_f32 v174, v174, v7
  v_mul_f32 v175, v175, v7
  v_mul_f32 v176, v176, v7
  v_mul_f32 v177, v177, v7
  v_mul_f32 v178, v178, v7
  v_mul_f32 v179, v179, v7
  v_mul_f32 v180, v180, v7
  v_mul_f32 v181, v181, v7
  v_mul_f32 v182, v182, v7
  v_mul_f32 v183, v183, v7
  v_mul_f32 v184, v184, v7
  v_mul_f32 v185, v185, v7
  v_mul_f32 v186, v186, v7
  v_mul_f32 v187, v187, v7
  v_mul_f32 v188, v188, v7
  v_mul_f32 v189, v189, v7
  v_mul_f32 v190, v190, v7
  v_mul_f32 v191, v191, v7
  v_accvgpr_read_b32 v8, a132
  v_mul_f32 v8, v8, v7
  v_accvgpr_write_b32 a132, v8
  v_accvgpr_read_b32 v8, a133
  v_mul_f32 v8, v8, v7
  v_accvgpr_write_b32 a133, v8
  v_accvgpr_read_b32 v8, a134
  v_mul_f32 v8, v8, v7
  v_accvgpr_write_b32 a134, v8
  v_accvgpr_read_b32 v8, a135
  v_mul_f32 v8, v8, v7
  v_accvgpr_write_b32 a135, v8
  v_sub_f32 v8, v40, v6
  v_sub_f32 v9, v41, v6
  v_sub_f32 v10, v42, v6
  v_sub_f32 v11, v43, v6
  v_sub_f32 v12, v44, v6
  v_sub_f32 v13, v45, v6
  v_sub_f32 v14, v46, v6
  v_sub_f32 v15, v47, v6
  v_exp_f32 v8, v8
  v_exp_f32 v9, v9
  v_exp_f32 v10, v10
  v_exp_f32 v11, v11
  v_exp_f32 v12, v12
  v_exp_f32 v13, v13
  v_exp_f32 v14, v14
  v_exp_f32 v15, v15
  v_cvt_pk_bf16_f32 v68, v8, v9
  v_cvt_pk_bf16_f32 v69, v10, v11
  v_cvt_pk_bf16_f32 v70, v12, v13
  v_cvt_pk_bf16_f32 v71, v14, v15
L_a_slow0_2:
  v_max3_f32 v6, v48, v49, v50
  v_max3_f32 v7, v51, v52, v53
  v_max3_f32 v6, v6, v54, v55
  v_max_f32 v6, v6, v7
  v_mov_b32 v7, v6
  s_nop 1
  v_permlane32_swap_b32 v7, v6
  v_max_f32 v6, v6, v7
  v_mov_b32 v7, v6
  s_nop 1
  v_permlane16_swap_b32 v7, v6
  v_max_f32 v6, v6, v7
  v_add_f32 v6, 0x41800000, v6
  v_max_f32 v6, 0, v6
  v_exp_f32 v7, -v6
  v_sub_f32 v112, v112, v6
  v_sub_f32 v113, v113, v6
  v_sub_f32 v114, v114, v6
  v_sub_f32 v115, v115, v6
  v_sub_f32 v116, v116, v6
  v_sub_f32 v117, v117, v6
  v_sub_f32 v118, v118, v6
  v_sub_f32 v119, v119, v6
  v_mul_f32 v192, v192, v7
  v_mul_f32 v193, v193, v7
  v_mul_f32 v194, v194, v7
  v_mul_f32 v195, v195, v7
  v_mul_f32 v196, v196, v7
  v_mul_f32 v197, v197, v7
  v_mul_f32 v198, v198, v7
  v_mul_f32 v199, v199, v7
  v_mul_f32 v200, v200, v7
  v_mul_f32 v201, v201, v7
  v_mul_f32 v202, v202, v7
  v_mul_f32 v203, v203, v7
  v_mul_f32 v204, v204, v7
  v_mul_f32 v205, v205, v7
  v_mul_f32 v206, v206, v7
  v_mul_f32 v207, v207, v7
  v_mul_f32 v208, v208, v7
  v_mul_f32 v209, v209, v7
  v_mul_f32 v210, v210, v7
  v_mul_f32 v211, v211, v7
  v_mul_f32 v212, v212, v7
  v_mul_f32 v213, v213, v7
  v_mul_f32 v214, v214, v7
  v_mul_f32 v215, v215, v7
  v_mul_f32 v216, v216, v7
  v_mul_f32 v217, v217, v7
  v_mul_f32 v218, v218, v7
  v_mul_f32 v219, v219, v7
  v_mul_f32 v220, v220, v7
  v_mul_f32 v221, v221, v7
  v_mul_f32 v222, v222, v7
  v_mul_f32 v223, v223, v7
  v_accvgpr_read_b32 v8, a136
  v_mul_f32 v8, v8, v7
  v_accvgpr_write_b32 a136, v8
  v_accvgpr_read_b32 v8, a137
  v_mul_f32 v8, v8, v7
  v_accvgpr_write_b32 a137, v8
  v_accvgpr_read_b32 v8, a138
  v_mul_f32 v8, v8, v7
  v_accvgpr_write_b32 a138, v8
  v_accvgpr_read_b32 v8, a139
  v_mul_f32 v8, v8, v7
  v_accvgpr_write_b32 a139, v8
  v_sub_f32 v8, v48, v6
  v_sub_f32 v9, v49, v6
  v_sub_f32 v10, v50, v6
  v_sub_f32 v11, v51, v6
  v_sub_f32 v12, v52, v6
  v_sub_f32 v13, v53, v6
  v_sub_f32 v14, v54, v6
  v_sub_f32 v15, v55, v6
  v_exp_f32 v8, v8
  v_exp_f32 v9, v9
  v_exp_f32 v10, v10
  v_exp_f32 v11, v11
  v_exp_f32 v12, v12
  v_exp_f32 v13, v13
  v_exp_f32 v14, v14
  v_exp_f32 v15, v15
  v_cvt_pk_bf16_f32 v72, v8, v9
  v_cvt_pk_bf16_f32 v73, v10, v11
  v_cvt_pk_bf16_f32 v74, v12, v13
  v_cvt_pk_bf16_f32 v75, v14, v15
L_a_slow0_3:
  v_max3_f32 v6, v56, v57, v58
  v_max3_f32 v7, v59, v60, v61
  v_max3_f32 v6, v6, v62, v63
  v_max_f32 v6, v6, v7
  v_mov_b32 v7, v6
  s_nop 1
  v_permlane32_swap_b32 v7, v6
  v_max_f32 v6, v6, v7
  v_mov_b32 v7, v6
  s_nop 1
  v_permlane16_swap_b32 v7, v6
  v_max_f32 v6, v6, v7
  v_add_f32 v6, 0x41800000, v6
  v_max_f32 v6, 0, v6
  v_exp_f32 v7, -v6
  v_sub_f32 v120, v120, v6
  v_sub_f32 v121, v121, v6
  v_sub_f32 v122, v122, v6
  v_sub_f32 v123, v123, v6
  v_sub_f32 v124, v124, v6
  v_sub_f32 v125, v125, v6
  v_sub_f32 v126, v126, v6
  v_sub_f32 v127, v127, v6
  v_mul_f32 v224, v224, v7
  v_mul_f32 v225, v225, v7
  v_mul_f32 v226, v226, v7
  v_mul_f32 v227, v227, v7
  v_mul_f32 v228, v228, v7
  v_mul_f32 v229, v229, v7
  v_mul_f32 v230, v230, v7
  v_mul_f32 v231, v231, v7
  v_mul_f32 v232, v232, v7
  v_mul_f32 v233, v233, v7
  v_mul_f32 v234, v234, v7
  v_mul_f32 v235, v235, v7
  v_mul_f32 v236, v236, v7
  v_mul_f32 v237, v237, v7
  v_mul_f32 v238, v238, v7
  v_mul_f32 v239, v239, v7
  v_mul_f32 v240, v240, v7
  v_mul_f32 v241, v241, v7
  v_mul_f32 v242, v242, v7
  v_mul_f32 v243, v243, v7
  v_mul_f32 v244, v244, v7
  v_mul_f32 v245, v245, v7
  v_mul_f32 v246, v246, v7
  v_mul_f32 v247, v247, v7
  v_mul_f32 v248, v248, v7
  v_mul_f32 v249, v249, v7
  v_mul_f32 v250, v250, v7
  v_mul_f32 v251, v251, v7
  v_mul_f32 v252, v252, v7
  v_mul_f32 v253, v253, v7
  v_mul_f32 v254, v254, v7
  v_mul_f32 v255, v255, v7
  v_accvgpr_read_b32 v8, a140
  v_mul_f32 v8, v8, v7
  v_accvgpr_write_b32 a140, v8
  v_accvgpr_read_b32 v8, a141
  v_mul_f32 v8, v8, v7
  v_accvgpr_write_b32 a141, v8
  v_accvgpr_read_b32 v8, a142
  v_mul_f32 v8, v8, v7
  v_accvgpr_write_b32 a142, v8
  v_accvgpr_read_b32 v8, a143
  v_mul_f32 v8, v8, v7
  v_accvgpr_write_b32 a143, v8
  v_sub_f32 v8, v56, v6
  v_sub_f32 v9, v57, v6
  v_sub_f32 v10, v58, v6
  v_sub_f32 v11, v59, v6
  v_sub_f32 v12, v60, v6
  v_sub_f32 v13, v61, v6
  v_sub_f32 v14, v62, v6
  v_sub_f32 v15, v63, v6
  v_exp_f32 v8, v8
  v_exp_f32 v9, v9
  v_exp_f32 v10, v10
  v_exp_f32 v11, v11
  v_exp_f32 v12, v12
  v_exp_f32 v13, v13
  v_exp_f32 v14, v14
  v_exp_f32 v15, v15
  v_cvt_pk_bf16_f32 v76, v8, v9
  v_cvt_pk_bf16_f32 v77, v10, v11
  v_cvt_pk_bf16_f32 v78, v12, v13
  v_cvt_pk_bf16_f32 v79, v14, v15
  s_cmp_eq_u32 s71, 0
  s_cbranch_scc1 L_a_s1_r
  s_cmp_eq_u32 s71, 2
  s_cbranch_scc1 L_a_d0_r
  s_cmp_eq_u32 s71, 4
  s_cbranch_scc1 L_a_d2_r
  s_cmp_eq_u32 s71, 6
  s_cbranch_scc1 L_a_d4_r
  s_branch L_a_d6_r
L_a_slow1_0:
  v_max3_f32 v6, v32, v33, v34
  v_max3_f32 v7, v35, v36, v37
  v_max3_f32 v6, v6, v38, v39
  v_max_f32 v6, v6, v7
  v_mov_b32 v7, v6
  s_nop 1
  v_permlane32_swap_b32 v7, v6
  v_max_f32 v6, v6, v7
  v_mov_b32 v7, v6
  s_nop 1
  v_permlane16_swap_b32 v7, v6
  v_max_f32 v6, v6, v7
  v_add_f32 v6, 0x41800000, v6
  v_max_f32 v6, 0, v6
  v_exp_f32 v7, -v6
  v_sub_f32 v96, v96, v6
  v_sub_f32 v97, v97, v6
  v_sub_f32 v98, v98, v6
  v_sub_f32 v99, v99, v6
  v_sub_f32 v100, v100, v6
  v_sub_f32 v101, v101, v6
  v_sub_f32 v102, v102, v6
  v_sub_f32 v103, v103, v6
  v_mul_f32 v128, v128, v7
  v_mul_f32 v129, v129, v7
  v_mul_f32 v130, v130, v7
  v_mul_f32 v131, v131, v7
  v_mul_f32 v132, v132, v7
  v_mul_f32 v133, v133, v7
  v_mul_f32 v134, v134, v7
  v_mul_f32 v135, v135, v7
  v_mul_f32 v136, v136, v7
  v_mul_f32 v137, v137, v7
  v_mul_f32 v138, v138, v7
  v_mul_f32 v139, v139, v7
  v_mul_f32 v140, v140, v7
  v_mul_f32 v141, v141, v7
  v_mul_f32 v142, v142, v7
  v_mul_f32 v143, v143, v7
  v_mul_f32 v144, v144, v7
  v_mul_f32 v145, v145, v7
  v_mul_f32 v146, v146, v7
  v_mul_f32 v147, v147, v7
  v_mul_f32 v148, v148, v7
  v_mul_f32 v149, v149, v7
  v_mul_f32 v150, v150, v7
  v_mul_f32 v151, v151, v7
  v_mul_f32 v152, v152, v7
  v_mul_f32 v153, v153, v7
  v_mul_f32 v154, v154, v7
  v_mul_f32 v155, v155, v7
  v_mul_f32 v156, v156, v7
  v_mul_f32 v157, v157, v7
  v_mul_f32 v158, v158, v7
  v_mul_f32 v159, v159, v7
  v_accvgpr_read_b32 v8, a128
  v_mul_f32 v8, v8, v7
  v_accvgpr_write_b32 a128, v8
  v_accvgpr_read_b32 v8, a129
  v_mul_f32 v8, v8, v7
  v_accvgpr_write_b32 a129, v8
  v_accvgpr_read_b32 v8, a130
  v_mul_f32 v8, v8, v7
  v_accvgpr_write_b32 a130, v8
  v_accvgpr_read_b32 v8, a131
  v_mul_f32 v8, v8, v7
  v_accvgpr_write_b32 a131, v8
  v_sub_f32 v8, v32, v6
  v_sub_f32 v9, v33, v6
  v_sub_f32 v10, v34, v6
  v_sub_f32 v11, v35, v6
  v_sub_f32 v12, v36, v6
  v_sub_f32 v13, v37, v6
  v_sub_f32 v14, v38, v6
  v_sub_f32 v15, v39, v6
  v_exp_f32 v8, v8
  v_exp_f32 v9, v9
  v_exp_f32 v10, v10
  v_exp_f32 v11, v11
  v_exp_f32 v12, v12
  v_exp_f32 v13, v13
  v_exp_f32 v14, v14
  v_exp_f32 v15, v15
  v_cvt_pk_bf16_f32 v80, v8, v9
  v_cvt_pk_bf16_f32 v81, v10, v11
  v_cvt_pk_bf16_f32 v82, v12, v13
  v_cvt_pk_bf16_f32 v83, v14, v15
L_a_slow1_1:
  v_max3_f32 v6, v40, v41, v42
  v_max3_f32 v7, v43, v44, v45
  v_max3_f32 v6, v6, v46, v47
  v_max_f32 v6, v6, v7
  v_mov_b32 v7, v6
  s_nop 1
  v_permlane32_swap_b32 v7, v6
  v_max_f32 v6, v6, v7
  v_mov_b32 v7, v6
  s_nop 1
  v_permlane16_swap_b32 v7, v6
  v_max_f32 v6, v6, v7
  v_add_f32 v6, 0x41800000, v6
  v_max_f32 v6, 0, v6
  v_exp_f32 v7, -v6
  v_sub_f32 v104, v104, v6
  v_sub_f32 v105, v105, v6
  v_sub_f32 v106, v106, v6
  v_sub_f32 v107, v107, v6
  v_sub_f32 v108, v108, v6
  v_sub_f32 v109, v109, v6
  v_sub_f32 v110, v110, v6
  v_sub_f32 v111, v111, v6
  v_mul_f32 v160, v160, v7
  v_mul_f32 v161, v161, v7
  v_mul_f32 v162, v162, v7
  v_mul_f32 v163, v163, v7
  v_mul_f32 v164, v164, v7
  v_mul_f32 v165, v165, v7
  v_mul_f32 v166, v166, v7
  v_mul_f32 v167, v167, v7
  v_mul_f32 v168, v168, v7
  v_mul_f32 v169, v169, v7
  v_mul_f32 v170, v170, v7
  v_mul_f32 v171, v171, v7
  v_mul_f32 v172, v172, v7
  v_mul_f32 v173, v173, v7
  v_mul_f32 v174, v174, v7
  v_mul_f32 v175, v175, v7
  v_mul_f32 v176, v176, v7
  v_mul_f32 v177, v177, v7
  v_mul_f32 v178, v178, v7
  v_mul_f32 v179, v179, v7
  v_mul_f32 v180, v180, v7
  v_mul_f32 v181, v181, v7
  v_mul_f32 v182, v182, v7
  v_mul_f32 v183, v183, v7
  v_mul_f32 v184, v184, v7
  v_mul_f32 v185, v185, v7
  v_mul_f32 v186, v186, v7
  v_mul_f32 v187, v187, v7
  v_mul_f32 v188, v188, v7
  v_mul_f32 v189, v189, v7
  v_mul_f32 v190, v190, v7
  v_mul_f32 v191, v191, v7
  v_accvgpr_read_b32 v8, a132
  v_mul_f32 v8, v8, v7
  v_accvgpr_write_b32 a132, v8
  v_accvgpr_read_b32 v8, a133
  v_mul_f32 v8, v8, v7
  v_accvgpr_write_b32 a133, v8
  v_accvgpr_read_b32 v8, a134
  v_mul_f32 v8, v8, v7
  v_accvgpr_write_b32 a134, v8
  v_accvgpr_read_b32 v8, a135
  v_mul_f32 v8, v8, v7
  v_accvgpr_write_b32 a135, v8
  v_sub_f32 v8, v40, v6
  v_sub_f32 v9, v41, v6
  v_sub_f32 v10, v42, v6
  v_sub_f32 v11, v43, v6
  v_sub_f32 v12, v44, v6
  v_sub_f32 v13, v45, v6
  v_sub_f32 v14, v46, v6
  v_sub_f32 v15, v47, v6
  v_exp_f32 v8, v8
  v_exp_f32 v9, v9
  v_exp_f32 v10, v10
  v_exp_f32 v11, v11
  v_exp_f32 v12, v12
  v_exp_f32 v13, v13
  v_exp_f32 v14, v14
  v_exp_f32 v15, v15
  v_cvt_pk_bf16_f32 v84, v8, v9
  v_cvt_pk_bf16_f32 v85, v10, v11
  v_cvt_pk_bf16_f32 v86, v12, v13
  v_cvt_pk_bf16_f32 v87, v14, v15
L_a_slow1_2:
  v_max3_f32 v6, v48, v49, v50
  v_max3_f32 v7, v51, v52, v53
  v_max3_f32 v6, v6, v54, v55
  v_max_f32 v6, v6, v7
  v_mov_b32 v7, v6
  s_nop 1
  v_permlane32_swap_b32 v7, v6
  v_max_f32 v6, v6, v7
  v_mov_b32 v7, v6
  s_nop 1
  v_permlane16_swap_b32 v7, v6
  v_max_f32 v6, v6, v7
  v_add_f32 v6, 0x41800000, v6
  v_max_f32 v6, 0, v6
  v_exp_f32 v7, -v6
  v_sub_f32 v112, v112, v6
  v_sub_f32 v113, v113, v6
  v_sub_f32 v114, v114, v6
  v_sub_f32 v115, v115, v6
  v_sub_f32 v116, v116, v6
  v_sub_f32 v117, v117, v6
  v_sub_f32 v118, v118, v6
  v_sub_f32 v119, v119, v6
  v_mul_f32 v192, v192, v7
  v_mul_f32 v193, v193, v7
  v_mul_f32 v194, v194, v7
  v_mul_f32 v195, v195, v7
  v_mul_f32 v196, v196, v7
  v_mul_f32 v197, v197, v7
  v_mul_f32 v198, v198, v7
  v_mul_f32 v199, v199, v7
  v_mul_f32 v200, v200, v7
  v_mul_f32 v201, v201, v7
  v_mul_f32 v202, v202, v7
  v_mul_f32 v203, v203, v7
  v_mul_f32 v204, v204, v7
  v_mul_f32 v205, v205, v7
  v_mul_f32 v206, v206, v7
  v_mul_f32 v207, v207, v7
  v_mul_f32 v208, v208, v7
  v_mul_f32 v209, v209, v7
  v_mul_f32 v210, v210, v7
  v_mul_f32 v211, v211, v7
  v_mul_f32 v212, v212, v7
  v_mul_f32 v213, v213, v7
  v_mul_f32 v214, v214, v7
  v_mul_f32 v215, v215, v7
  v_mul_f32 v216, v216, v7
  v_mul_f32 v217, v217, v7
  v_mul_f32 v218, v218, v7
  v_mul_f32 v219, v219, v7
  v_mul_f32 v220, v220, v7
  v_mul_f32 v221, v221, v7
  v_mul_f32 v222, v222, v7
  v_mul_f32 v223, v223, v7
  v_accvgpr_read_b32 v8, a136
  v_mul_f32 v8, v8, v7
  v_accvgpr_write_b32 a136, v8
  v_accvgpr_read_b32 v8, a137
  v_mul_f32 v8, v8, v7
  v_accvgpr_write_b32 a137, v8
  v_accvgpr_read_b32 v8, a138
  v_mul_f32 v8, v8, v7
  v_accvgpr_write_b32 a138, v8
  v_accvgpr_read_b32 v8, a139
  v_mul_f32 v8, v8, v7
  v_accvgpr_write_b32 a139, v8
  v_sub_f32 v8, v48, v6
  v_sub_f32 v9, v49, v6
  v_sub_f32 v10, v50, v6
  v_sub_f32 v11, v51, v6
  v_sub_f32 v12, v52, v6
  v_sub_f32 v13, v53, v6
  v_sub_f32 v14, v54, v6
  v_sub_f32 v15, v55, v6
  v_exp_f32 v8, v8
  v_exp_f32 v9, v9
  v_exp_f32 v10, v10
  v_exp_f32 v11, v11
  v_exp_f32 v12, v12
  v_exp_f32 v13, v13
  v_exp_f32 v14, v14
  v_exp_f32 v15, v15
  v_cvt_pk_bf16_f32 v88, v8, v9
  v_cvt_pk_bf16_f32 v89, v10, v11
  v_cvt_pk_bf16_f32 v90, v12, v13
  v_cvt_pk_bf16_f32 v91, v14, v15
L_a_slow1_3:
  v_max3_f32 v6, v56, v57, v58
  v_max3_f32 v7, v59, v60, v61
  v_max3_f32 v6, v6, v62, v63
  v_max_f32 v6, v6, v7
  v_mov_b32 v7, v6
  s_nop 1
  v_permlane32_swap_b32 v7, v6
  v_max_f32 v6, v6, v7
  v_mov_b32 v7, v6
  s_nop 1
  v_permlane16_swap_b32 v7, v6
  v_max_f32 v6, v6, v7
  v_add_f32 v6, 0x41800000, v6
  v_max_f32 v6, 0, v6
  v_exp_f32 v7, -v6
  v_sub_f32 v120, v120, v6
  v_sub_f32 v121, v121, v6
  v_sub_f32 v122, v122, v6
  v_sub_f32 v123, v123, v6
  v_sub_f32 v124, v124, v6
  v_sub_f32 v125, v125, v6
  v_sub_f32 v126, v126, v6
  v_sub_f32 v127, v127, v6
  v_mul_f32 v224, v224, v7
  v_mul_f32 v225, v225, v7
  v_mul_f32 v226, v226, v7
  v_mul_f32 v227, v227, v7
  v_mul_f32 v228, v228, v7
  v_mul_f32 v229, v229, v7
  v_mul_f32 v230, v230, v7
  v_mul_f32 v231, v231, v7
  v_mul_f32 v232, v232, v7
  v_mul_f32 v233, v233, v7
  v_mul_f32 v234, v234, v7
  v_mul_f32 v235, v235, v7
  v_mul_f32 v236, v236, v7
  v_mul_f32 v237, v237, v7
  v_mul_f32 v238, v238, v7
  v_mul_f32 v239, v239, v7
  v_mul_f32 v240, v240, v7
  v_mul_f32 v241, v241, v7
  v_mul_f32 v242, v242, v7
  v_mul_f32 v243, v243, v7
  v_mul_f32 v244, v244, v7
  v_mul_f32 v245, v245, v7
  v_mul_f32 v246, v246, v7
  v_mul_f32 v247, v247, v7
  v_mul_f32 v248, v248, v7
  v_mul_f32 v249, v249, v7
  v_mul_f32 v250, v250, v7
  v_mul_f32 v251, v251, v7
  v_mul_f32 v252, v252, v7
  v_mul_f32 v253, v253, v7
  v_mul_f32 v254, v254, v7
  v_mul_f32 v255, v255, v7
  v_accvgpr_read_b32 v8, a140
  v_mul_f32 v8, v8, v7
  v_accvgpr_write_b32 a140, v8
  v_accvgpr_read_b32 v8, a141
  v_mul_f32 v8, v8, v7
  v_accvgpr_write_b32 a141, v8
  v_accvgpr_read_b32 v8, a142
  v_mul_f32 v8, v8, v7
  v_accvgpr_write_b32 a142, v8
  v_accvgpr_read_b32 v8, a143
  v_mul_f32 v8, v8, v7
  v_accvgpr_write_b32 a143, v8
  v_sub_f32 v8, v56, v6
  v_sub_f32 v9, v57, v6
  v_sub_f32 v10, v58, v6
  v_sub_f32 v11, v59, v6
  v_sub_f32 v12, v60, v6
  v_sub_f32 v13, v61, v6
  v_sub_f32 v14, v62, v6
  v_sub_f32 v15, v63, v6
  v_exp_f32 v8, v8
  v_exp_f32 v9, v9
  v_exp_f32 v10, v10
  v_exp_f32 v11, v11
  v_exp_f32 v12, v12
  v_exp_f32 v13, v13
  v_exp_f32 v14, v14
  v_exp_f32 v15, v15
  v_cvt_pk_bf16_f32 v92, v8, v9
  v_cvt_pk_bf16_f32 v93, v10, v11
  v_cvt_pk_bf16_f32 v94, v12, v13
  v_cvt_pk_bf16_f32 v95, v14, v15
  s_cmp_eq_u32 s71, 1
  s_cbranch_scc1 L_a_s0_r
  s_cmp_eq_u32 s71, 3
  s_cbranch_scc1 L_a_d1_r
  s_cmp_eq_u32 s71, 5
  s_cbranch_scc1 L_a_d3_r
  s_cmp_eq_u32 s71, 7
  s_cbranch_scc1 L_a_d5_r
  s_branch L_a_d7_r
L_att_end:
  s_branch L_next
L_go_outx:
  s_bfe_u32 s56, s3, 0x40004
  s_bfe_u32 s62, s3, 0x10004
  s_bitcmp1_b32 s3, 3
  s_cbranch_scc1 L_red
L_barr:
  s_mov_b32 s48, s30
  s_and_b32 s49, s31, 0xffff
  s_mov_b32 s50, 0x400000
  s_mov_b32 s51, 0x20000
  v_lshlrev_b32 v2, 4, v0
  v_mov_b32 v7, 0
  s_mov_b32 s57, 0
  v_lshrrev_b32 v3, 4, v0
  v_and_b32 v4, 15, v0
  v_lshlrev_b32 v5, 1, v3
  v_xor_b32 v5, v5, v4
  v_lshlrev_b32 v5, 4, v5
  v_lshl_add_u32 v80, v3, 10, v5
  v_xor_b32 v81, 128, v80
  s_lshl_b32 s66, s44, 15
  s_lshl_b32 s60, s56, 18
  s_lshl_b32 s58, s44, 8
  s_add_u32 s60, s60, s58
  s_add_u32 m0, s66, 0
  s_add_u32 s58, s60, 0
  buffer_load_dwordx4 v80, s[48:51], s58 offen lds
  s_add_u32 m0, s66, 1024
  s_add_u32 s58, s60, 4096
  buffer_load_dwordx4 v81, s[48:51], s58 offen lds
  s_add_u32 m0, s66, 2048
  s_add_u32 s58, s60, 8192
  buffer_load_dwordx4 v80, s[48:51], s58 offen lds
  s_add_u32 m0, s66, 3072
  s_add_u32 s58, s60, 12288
  buffer_load_dwordx4 v81, s[48:51], s58 offen lds
  s_add_u32 m0, s66, 4096
  s_add_u32 s58, s60, 16384
  buffer_load_dwordx4 v80, s[48:51], s58 offen lds
  s_add_u32 m0, s66, 5120
  s_add_u32 s58, s60, 20480
  buffer_load_dwordx4 v81, s[48:51], s58 offen lds
  s_add_u32 m0, s66, 6144
  s_add_u32 s58, s60, 24576
  buffer_load_dwordx4 v80, s[48:51], s58 offen lds
  s_add_u32 m0, s66, 7168
  s_add_u32 s58, s60, 28672
  buffer_load_dwordx4 v81, s[48:51], s58 offen lds
  s_add_u32 m0, s66, 8192
  s_add_u32 s58, s60, 32768
  buffer_load_dwordx4 v80, s[48:51], s58 offen lds
  s_add_u32 m0, s66, 9216
  s_add_u32 s58, s60, 36864
  buffer_load_dwordx4 v81, s[48:51], s58 offen lds
  s_add_u32 m0, s66, 10240
  s_add_u32 s58, s60, 40960
  buffer_load_dwordx4 v80, s[48:51], s58 offen lds
  s_add_u32 m0, s66, 11264
  s_add_u32 s58, s60, 45056
  buffer_load_dwordx4 v81, s[48:51], s58 offen lds
  s_add_u32 m0, s66, 12288
  s_add_u32 s58, s60, 49152
  buffer_load_dwordx4 v80, s[48:51], s58 offen lds
  s_add_u32 m0, s66, 13312
  s_add_u32 s58, s60, 53248
  buffer_load_dwordx4 v81, s[48:51], s58 offen lds
  s_add_u32 m0, s66, 14336
  s_add_u32 s58, s60, 57344
  buffer_load_dwordx4 v80, s[48:51], s58 offen lds
  s_add_u32 m0, s66, 15360
  s_add_u32 s58, s60, 61440
  buffer_load_dwordx4 v81, s[48:51], s58 offen lds
  s_add_u32 m0, s66, 16384
  s_add_u32 s58, s60, 65536
  buffer_load_dwordx4 v80, s[48:51], s58 offen lds
  s_add_u32 m0, s66, 17408
  s_add_u32 s58, s60, 69632
  buffer_load_dwordx4 v81, s[48:51], s58 offen lds
  s_add_u32 m0, s66, 18432
  s_add_u32 s58, s60, 73728
  buffer_load_dwordx4 v80, s[48:51], s58 offen lds
  s_add_u32 m0, s66, 19456
  s_add_u32 s58, s60, 77824
  buffer_load_dwordx4 v81, s[48:51], s58 offen lds
  s_add_u32 m0, s66, 20480
  s_add_u32 s58, s60, 81920
  buffer_load_dwordx4 v80, s[48:51], s58 offen lds
  s_add_u32 m0, s66, 21504
  s_add_u32 s58, s60, 86016
  buffer_load_dwordx4 v81, s[48:51], s58 offen lds
  s_add_u32 m0, s66, 22528
  s_add_u32 s58, s60, 90112
  buffer_load_dwordx4 v80, s[48:51], s58 offen lds
  s_add_u32 m0, s66, 23552
  s_add_u32 s58, s60, 94208
  buffer_load_dwordx4 v81, s[48:51], s58 offen lds
  s_add_u32 m0, s66, 24576
  s_add_u32 s58, s60, 98304
  buffer_load_dwordx4 v80, s[48:51], s58 offen lds
  s_add_u32 m0, s66, 25600
  s_add_u32 s58, s60, 102400
  buffer_load_dwordx4 v81, s[48:51], s58 offen lds
  s_add_u32 m0, s66, 26624
  s_add_u32 s58, s60, 106496
  buffer_load_dwordx4 v80, s[48:51], s58 offen lds
  s_add_u32 m0, s66, 27648
  s_add_u32 s58, s60, 110592
  buffer_load_dwordx4 v81, s[48:51], s58 offen lds
  s_add_u32 m0, s66, 28672
  s_add_u32 s58, s60, 114688
  buffer_load_dwordx4 v80, s[48:51], s58 offen lds
  s_add_u32 m0, s66, 29696
  s_add_u32 s58, s60, 118784
  buffer_load_dwordx4 v81, s[48:51], s58 offen lds
  s_add_u32 m0, s66, 30720
  s_add_u32 s58, s60, 122880
  buffer_load_dwordx4 v80, s[48:51], s58 offen lds
  s_add_u32 m0, s66, 31744
  s_add_u32 s58, s60, 126976
  buffer_load_dwordx4 v81, s[48:51], s58 offen lds
  v_lshrrev_b32 v5, 2, v0
  v_lshl_add_u32 v112, v5, 8, s66
  v_and_b32 v5, 7, v5
  v_lshl_add_u32 v112, v5, 5, v112
  v_and_b32 v5, 3, v0
  v_lshl_add_u32 v112, v5, 3, v112
  v_xor_b32 v113, 32, v112
  v_xor_b32 v114, 64, v112
  v_xor_b32 v115, 96, v112
  v_xor_b32 v116, 128, v112
  v_xor_b32 v117, 160, v112
  v_xor_b32 v118, 192, v112
  v_xor_b32 v119, 224, v112
  s_waitcnt vmcnt(24)
  ds_read_b64_tr_b16 a[0:1], v112 offset:0
  ds_read_b64_tr_b16 a[2:3], v112 offset:4096
  ds_read_b64_tr_b16 a[32:33], v113 offset:0
  ds_read_b64_tr_b16 a[34:35], v113 offset:4096
  ds_read_b64_tr_b16 a[64:65], v114 offset:0
  ds_read_b64_tr_b16 a[66:67], v114 offset:4096
  ds_read_b64_tr_b16 a[96:97], v115 offset:0
  ds_read_b64_tr_b16 a[98:99], v115 offset:4096
  ds_read_b64_tr_b16 a[128:129], v116 offset:0
  ds_read_b64_tr_b16 a[130:131], v116 offset:4096
  ds_read_b64_tr_b16 a[160:161], v117 offset:0
  ds_read_b64_tr_b16 a[162:163], v117 offset:4096
  ds_read_b64_tr_b16 a[192:193], v118 offset:0
  ds_read_b64_tr_b16 a[194:195], v118 offset:4096
  ds_read_b64_tr_b16 a[224:225], v119 offset:0
  ds_read_b64_tr_b16 a[226:227], v119 offset:4096
  s_waitcnt vmcnt(16)
  ds_read_b64_tr_b16 a[4:5], v112 offset:8192
  ds_read_b64_tr_b16 a[6:7], v112 offset:12288
  ds_read_b64_tr_b16 a[36:37], v113 offset:8192
  ds_read_b64_tr_b16 a[38:39], v113 offset:12288
  ds_read_b64_tr_b16 a[68:69], v114 offset:8192
  ds_read_b64_tr_b16 a[70:71], v114 offset:12288
  ds_read_b64_tr_b16 a[100:101], v115 offset:8192
  ds_read_b64_tr_b16 a[102:103], v115 offset:12288
  ds_read_b64_tr_b16 a[132:133], v116 offset:8192
  ds_read_b64_tr_b16 a[134:135], v116 offset:12288
  ds_read_b64_tr_b16 a[164:165], v117 offset:8192
  ds_read_b64_tr_b16 a[166:167], v117 offset:12288
  ds_read_b64_tr_b16 a[196:197], v118 offset:8192
  ds_read_b64_tr_b16 a[198:199], v118 offset:12288
  ds_read_b64_tr_b16 a[228:229], v119 offset:8192
  ds_read_b64_tr_b16 a[230:231], v119 offset:12288
  s_waitcnt vmcnt(8)
  ds_read_b64_tr_b16 a[8:9], v112 offset:16384
  ds_read_b64_tr_b16 a[10:11], v112 offset:20480
  ds_read_b64_tr_b16 a[40:41], v113 offset:16384
  ds_read_b64_tr_b16 a[42:43], v113 offset:20480
  ds_read_b64_tr_b16 a[72:73], v114 offset:16384
  ds_read_b64_tr_b16 a[74:75], v114 offset:20480
  ds_read_b64_tr_b16 a[104:105], v115 offset:16384
  ds_read_b64_tr_b16 a[106:107], v115 offset:20480
  ds_read_b64_tr_b16 a[136:137], v116 offset:16384
  ds_read_b64_tr_b16 a[138:139], v116 offset:20480
  ds_read_b64_tr_b16 a[168:169], v117 offset:16384
  ds_read_b64_tr_b16 a[170:171], v117 offset:20480
  ds_read_b64_tr_b16 a[200:201], v118 offset:16384
  ds_read_b64_tr_b16 a[202:203], v118 offset:20480
  ds_read_b64_tr_b16 a[232:233], v119 offset:16384
  ds_read_b64_tr_b16 a[234:235], v119 offset:20480
  s_waitcnt vmcnt(0)
  ds_read_b64_tr_b16 a[12:13], v112 offset:24576
  ds_read_b64_tr_b16 a[14:15], v112 offset:28672
  ds_read_b64_tr_b16 a[44:45], v113 offset:24576
  ds_read_b64_tr_b16 a[46:47], v113 offset:28672
  ds_read_b64_tr_b16 a[76:77], v114 offset:24576
  ds_read_b64_tr_b16 a[78:79], v114 offset:28672
  ds_read_b64_tr_b16 a[108:109], v115 offset:24576
  ds_read_b64_tr_b16 a[110:111], v115 offset:28672
  ds_read_b64_tr_b16 a[140:141], v116 offset:24576
  ds_read_b64_tr_b16 a[142:143], v116 offset:28672
  ds_read_b64_tr_b16 a[172:173], v117 offset:24576
  ds_read_b64_tr_b16 a[174:175], v117 offset:28672
  ds_read_b64_tr_b16 a[204:205], v118 offset:24576
  ds_read_b64_tr_b16 a[206:207], v118 offset:28672
  ds_read_b64_tr_b16 a[236:237], v119 offset:24576
  ds_read_b64_tr_b16 a[238:239], v119 offset:28672
  s_waitcnt lgkmcnt(0)
  s_add_u32 m0, s66, 0
  s_add_u32 s58, s60, 131072
  buffer_load_dwordx4 v80, s[48:51], s58 offen lds
  s_add_u32 m0, s66, 1024
  s_add_u32 s58, s60, 135168
  buffer_load_dwordx4 v81, s[48:51], s58 offen lds
  s_add_u32 m0, s66, 2048
  s_add_u32 s58, s60, 139264
  buffer_load_dwordx4 v80, s[48:51], s58 offen lds
  s_add_u32 m0, s66, 3072
  s_add_u32 s58, s60, 143360
  buffer_load_dwordx4 v81, s[48:51], s58 offen lds
  s_add_u32 m0, s66, 4096
  s_add_u32 s58, s60, 147456
  buffer_load_dwordx4 v80, s[48:51], s58 offen lds
  s_add_u32 m0, s66, 5120
  s_add_u32 s58, s60, 151552
  buffer_load_dwordx4 v81, s[48:51], s58 offen lds
  s_add_u32 m0, s66, 6144
  s_add_u32 s58, s60, 155648
  buffer_load_dwordx4 v80, s[48:51], s58 offen lds
  s_add_u32 m0, s66, 7168
  s_add_u32 s58, s60, 159744
  buffer_load_dwordx4 v81, s[48:51], s58 offen lds
  s_add_u32 m0, s66, 8192
  s_add_u32 s58, s60, 163840
  buffer_load_dwordx4 v80, s[48:51], s58 offen lds
  s_add_u32 m0, s66, 9216
  s_add_u32 s58, s60, 167936
  buffer_load_dwordx4 v81, s[48:51], s58 offen lds
  s_add_u32 m0, s66, 10240
  s_add_u32 s58, s60, 172032
  buffer_load_dwordx4 v80, s[48:51], s58 offen lds
  s_add_u32 m0, s66, 11264
  s_add_u32 s58, s60, 176128
  buffer_load_dwordx4 v81, s[48:51], s58 offen lds
  s_add_u32 m0, s66, 12288
  s_add_u32 s58, s60, 180224
  buffer_load_dwordx4 v80, s[48:51], s58 offen lds
  s_add_u32 m0, s66, 13312
  s_add_u32 s58, s60, 184320
  buffer_load_dwordx4 v81, s[48:51], s58 offen lds
  s_add_u32 m0, s66, 14336
  s_add_u32 s58, s60, 188416
  buffer_load_dwordx4 v80, s[48:51], s58 offen lds
  s_add_u32 m0, s66, 15360
  s_add_u32 s58, s60, 192512
  buffer_load_dwordx4 v81, s[48:51], s58 offen lds
  s_add_u32 m0, s66, 16384
  s_add_u32 s58, s60, 196608
  buffer_load_dwordx4 v80, s[48:51], s58 offen lds
  s_add_u32 m0, s66, 17408
  s_add_u32 s58, s60, 200704
  buffer_load_dwordx4 v81, s[48:51], s58 offen lds
  s_add_u32 m0, s66, 18432
  s_add_u32 s58, s60, 204800
  buffer_load_dwordx4 v80, s[48:51], s58 offen lds
  s_add_u32 m0, s66, 19456
  s_add_u32 s58, s60, 208896
  buffer_load_dwordx4 v81, s[48:51], s58 offen lds
  s_add_u32 m0, s66, 20480
  s_add_u32 s58, s60, 212992
  buffer_load_dwordx4 v80, s[48:51], s58 offen lds
  s_add_u32 m0, s66, 21504
  s_add_u32 s58, s60, 217088
  buffer_load_dwordx4 v81, s[48:51], s58 offen lds
  s_add_u32 m0, s66, 22528
  s_add_u32 s58, s60, 221184
  buffer_load_dwordx4 v80, s[48:51], s58 offen lds
  s_add_u32 m0, s66, 23552
  s_add_u32 s58, s60, 225280
  buffer_load_dwordx4 v81, s[48:51], s58 offen lds
  s_add_u32 m0, s66, 24576
  s_add_u32 s58, s60, 229376
  buffer_load_dwordx4 v80, s[48:51], s58 offen lds
  s_add_u32 m0, s66, 25600
  s_add_u32 s58, s60, 233472
  buffer_load_dwordx4 v81, s[48:51], s58 offen lds
  s_add_u32 m0, s66, 26624
  s_add_u32 s58, s60, 237568
  buffer_load_dwordx4 v80, s[48:51], s58 offen lds
  s_add_u32 m0, s66, 27648
  s_add_u32 s58, s60, 241664
  buffer_load_dwordx4 v81, s[48:51], s58 offen lds
  s_add_u32 m0, s66, 28672
  s_add_u32 s58, s60, 245760
  buffer_load_dwordx4 v80, s[48:51], s58 offen lds
  s_add_u32 m0, s66, 29696
  s_add_u32 s58, s60, 249856
  buffer_load_dwordx4 v81, s[48:51], s58 offen lds
  s_add_u32 m0, s66, 30720
  s_add_u32 s58, s60, 253952
  buffer_load_dwordx4 v80, s[48:51], s58 offen lds
  s_add_u32 m0, s66, 31744
  s_add_u32 s58, s60, 258048
  buffer_load_dwordx4 v81, s[48:51], s58 offen lds
  s_lshr_b32 s58, s44, 1
  s_lshl1_add_u32 s61, s56, s58
  s_and_b32 s59, s44, 1
  s_lshl_b32 s60, s44, 12
  s_add_u32 s60, s60, 131072
  v_bfe_u32 v6, v0, 3, 1
  v_lshl_add_u32 v8, v6, 8, s60
  v_lshl_add_u32 v8, v3, 6, v8
  v_and_b32 v6, 7, v0
  v_lshl_add_u32 v8, v6, 3, v8
  v_lshrrev_b32 v6, 5, v0
  v_lshl_add_u32 v9, v6, 8, s60
  v_and_b32 v6, 3, v0
  v_lshl_add_u32 v9, v6, 6, v9
  v_bfe_u32 v6, v0, 2, 3
  v_lshl_add_u32 v9, v6, 3, v9
  s_mul_i32 s60, s58, 24576
  v_add_u32 v12, s60, v2
  s_lshl_b32 s66, s59, 10
  v_add_u32 v15, s66, v12
  s_lshl_b32 s66, s59, 12
  s_lshl_b32 s67, s61, 19
  s_add_u32 s67, s67, s66
  s_add_u32 s67, s67, 0x3000000
  s_add_u32 s66, s66, s60
  s_lshl1_add_u32 s60, s59, s58
  s_lshl_b32 s60, s60, 12
  s_add_u32 s60, s60, 98304
  v_add_u32 v13, s60, v2
  v_add_u32 v14, 98304, v2
  s_lshl_b32 s60, s59, 4
  v_add_u32 v4, s60, v4
  v_lshlrev_b32 v31, 2, v4
  v_add_u32 v31, 0xd0c0000, v31
  v_lshlrev_b32 v3, 2, v3
  v_sub_u32 v4, v4, v3
  v_mov_b32 v6, 0xff800000
  s_lshl_b32 s73, s61, 7
  s_add_u32 s73, s73, 0xd081000
  s_lshl_b32 s69, s61, 12
  s_add_u32 s69, s69, 0xc020000
  s_lshl2_add_u32 s70, s56, s44
  s_lshl_b32 s70, s70, 12
  s_add_u32 s70, s70, 0x6080000
  v_mov_b32 v241, 1
  v_lshlrev_b32 v5, 2, v0
  v_add_u32 v5, 147456, v5
  ds_write_b32 v5, v7
  v_cmp_gt_i32 vcc, 0, v4
  v_mov_b32 v16, 0x3f803f80
  s_nop 0
  v_cndmask_b32 v20, 0, v6, vcc
  v_cmp_gt_i32 vcc, 1, v4
  v_mov_b32 v17, 0x3f803f80
  s_nop 0
  v_cndmask_b32 v21, 0, v6, vcc
  v_cmp_gt_i32 vcc, 2, v4
  v_mov_b32 v18, 0x3f803f80
  s_nop 0
  v_cndmask_b32 v22, 0, v6, vcc
  v_cmp_gt_i32 vcc, 3, v4
  v_mov_b32 v19, 0x3f803f80
  s_nop 0
  v_cndmask_b32 v23, 0, v6, vcc
  v_cmp_gt_i32 vcc, 16, v4
  v_mov_b32 v16, 0x3f803f80
  s_nop 0
  v_cndmask_b32 v24, 0, v6, vcc
  v_cmp_gt_i32 vcc, 17, v4
  v_mov_b32 v17, 0x3f803f80
  s_nop 0
  v_cndmask_b32 v25, 0, v6, vcc
  v_cmp_gt_i32 vcc, 18, v4
  v_mov_b32 v18, 0x3f803f80
  s_nop 0
  v_cndmask_b32 v26, 0, v6, vcc
  v_cmp_gt_i32 vcc, 19, v4
  v_mov_b32 v19, 0x3f803f80
  s_nop 0
  v_cndmask_b32 v27, 0, v6, vcc
  v_mov_b32 v33, 0
  v_mov_b32 v34, 0
  s_waitcnt vmcnt(24)
  ds_read_b64_tr_b16 a[16:17], v112 offset:0
  ds_read_b64_tr_b16 a[18:19], v112 offset:4096
  ds_read_b64_tr_b16 a[48:49], v113 offset:0
  ds_read_b64_tr_b16 a[50:51], v113 offset:4096
  ds_read_b64_tr_b16 a[80:81], v114 offset:0
  ds_read_b64_tr_b16 a[82:83], v114 offset:4096
  ds_read_b64_tr_b16 a[112:113], v115 offset:0
  ds_read_b64_tr_b16 a[114:115], v115 offset:4096
  ds_read_b64_tr_b16 a[144:145], v116 offset:0
  ds_read_b64_tr_b16 a[146:147], v116 offset:4096
  ds_read_b64_tr_b16 a[176:177], v117 offset:0
  ds_read_b64_tr_b16 a[178:179], v117 offset:4096
  ds_read_b64_tr_b16 a[208:209], v118 offset:0
  ds_read_b64_tr_b16 a[210:211], v118 offset:4096
  ds_read_b64_tr_b16 a[240:241], v119 offset:0
  ds_read_b64_tr_b16 a[242:243], v119 offset:4096
  s_waitcnt vmcnt(16)
  ds_read_b64_tr_b16 a[20:21], v112 offset:8192
  ds_read_b64_tr_b16 a[22:23], v112 offset:12288
  ds_read_b64_tr_b16 a[52:53], v113 offset:8192
  ds_read_b64_tr_b16 a[54:55], v113 offset:12288
  ds_read_b64_tr_b16 a[84:85], v114 offset:8192
  ds_read_b64_tr_b16 a[86:87], v114 offset:12288
  ds_read_b64_tr_b16 a[116:117], v115 offset:8192
  ds_read_b64_tr_b16 a[118:119], v115 offset:12288
  ds_read_b64_tr_b16 a[148:149], v116 offset:8192
  ds_read_b64_tr_b16 a[150:151], v116 offset:12288
  ds_read_b64_tr_b16 a[180:181], v117 offset:8192
  ds_read_b64_tr_b16 a[182:183], v117 offset:12288
  ds_read_b64_tr_b16 a[212:213], v118 offset:8192
  ds_read_b64_tr_b16 a[214:215], v118 offset:12288
  ds_read_b64_tr_b16 a[244:245], v119 offset:8192
  ds_read_b64_tr_b16 a[246:247], v119 offset:12288
  s_waitcnt vmcnt(8)
  ds_read_b64_tr_b16 a[24:25], v112 offset:16384
  ds_read_b64_tr_b16 a[26:27], v112 offset:20480
  ds_read_b64_tr_b16 a[56:57], v113 offset:16384
  ds_read_b64_tr_b16 a[58:59], v113 offset:20480
  ds_read_b64_tr_b16 a[88:89], v114 offset:16384
  ds_read_b64_tr_b16 a[90:91], v114 offset:20480
  ds_read_b64_tr_b16 a[120:121], v115 offset:16384
  ds_read_b64_tr_b16 a[122:123], v115 offset:20480
  ds_read_b64_tr_b16 a[152:153], v116 offset:16384
  ds_read_b64_tr_b16 a[154:155], v116 offset:20480
  ds_read_b64_tr_b16 a[184:185], v117 offset:16384
  ds_read_b64_tr_b16 a[186:187], v117 offset:20480
  ds_read_b64_tr_b16 a[216:217], v118 offset:16384
  ds_read_b64_tr_b16 a[218:219], v118 offset:20480
  ds_read_b64_tr_b16 a[248:249], v119 offset:16384
  ds_read_b64_tr_b16 a[250:251], v119 offset:20480
  s_waitcnt vmcnt(0)
  ds_read_b64_tr_b16 a[28:29], v112 offset:24576
  ds_read_b64_tr_b16 a[30:31], v112 offset:28672
  ds_read_b64_tr_b16 a[60:61], v113 offset:24576
  ds_read_b64_tr_b16 a[62:63], v113 offset:28672
  ds_read_b64_tr_b16 a[92:93], v114 offset:24576
  ds_read_b64_tr_b16 a[94:95], v114 offset:28672
  ds_read_b64_tr_b16 a[124:125], v115 offset:24576
  ds_read_b64_tr_b16 a[126:127], v115 offset:28672
  ds_read_b64_tr_b16 a[156:157], v116 offset:24576
  ds_read_b64_tr_b16 a[158:159], v116 offset:28672
  ds_read_b64_tr_b16 a[188:189], v117 offset:24576
  ds_read_b64_tr_b16 a[190:191], v117 offset:28672
  ds_read_b64_tr_b16 a[220:221], v118 offset:24576
  ds_read_b64_tr_b16 a[222:223], v118 offset:28672
  ds_read_b64_tr_b16 a[252:253], v119 offset:24576
  ds_read_b64_tr_b16 a[254:255], v119 offset:28672
  s_waitcnt lgkmcnt(0)
  s_lshl_b32 s58, s61, 7
  s_add_u32 s58, s58, 0xd080010
  v_lshl_add_u32 v3, v0, 2, s58
  v_and_b32 v4, 7, v0
  v_lshlrev_b32 v4, 7, v4
  v_add_u32 v4, 0xd086400, v4
  v_cmp_gt_u32 vcc, 2, v0
  v_mov_b32 v240, 0
  s_nop 0
  v_cndmask_b32 v3, v4, v3, vcc
  v_cndmask_b32 v4, 16, 32, vcc
L_b_w0:
  buffer_load_dword v5, v3, s[40:43], 0 offen sc1
  s_add_u32 s57, s57, 1
  s_cmp_gt_u32 s57, 1048576
  s_cbranch_scc1 L_exit
  s_waitcnt vmcnt(0)
  v_cmp_ne_u32 vcc, v4, v5
  s_cbranch_vccnz L_b_w0
  v_readlane_b32 s63, v1, s95
  s_add_u32 s95, s95, 1
  s_mov_b32 s64, 4
  v_readlane_b32 s65, v1, s95
  s_barrier
  s_lshr_b32 s59, s63, 4
  s_lshl_b32 s68, s63, 9
  s_add_u32 s68, s68, s67
  s_lshl_b32 s74, s63, 3
  s_bitcmp1_b32 s63, 2
  s_cselect_b32 s68, 0x40000000, s68
  s_cselect_b32 s74, 0x40000000, s74
  s_cselect_b32 s59, -1, s59
L_b_ff_1c:
  v_cmp_lt_i32 vcc, s59, v240
  s_cbranch_vccz L_b_ff_1
  s_add_u32 m0, s66, 0
  s_add_u32 s59, s68, 0x0
  buffer_load_dwordx4 v2, s[40:43], s59 offen offset:0 sc1 lds
  buffer_load_dwordx4 v2, s[40:43], s59 offen offset:1024 sc1 lds
  buffer_load_dwordx4 v2, s[40:43], s59 offen offset:2048 sc1 lds
  buffer_load_dwordx4 v2, s[40:43], s59 offen offset:3072 sc1 lds
  s_add_u32 m0, s66, 8192
  s_add_u32 s59, s68, 0x1000000
  buffer_load_dwordx4 v2, s[40:43], s59 offen offset:0 sc1 lds
  buffer_load_dwordx4 v2, s[40:43], s59 offen offset:1024 sc1 lds
  buffer_load_dwordx4 v2, s[40:43], s59 offen offset:2048 sc1 lds
  buffer_load_dwordx4 v2, s[40:43], s59 offen offset:3072 sc1 lds
  s_add_u32 m0, s66, 16384
  s_add_u32 s59, s68, 0x2000000
  buffer_load_dwordx4 v2, s[40:43], s59 offen offset:0 sc1 lds
  buffer_load_dwordx4 v2, s[40:43], s59 offen offset:1024 sc1 lds
  buffer_load_dwordx4 v2, s[40:43], s59 offen offset:2048 sc1 lds
  buffer_load_dwordx4 v2, s[40:43], s59 offen offset:3072 sc1 lds
  buffer_load_dword v11, v31, s[40:43], s74 offen sc1
  buffer_load_dword v240, v7, s[40:43], s73 offen sc1
  s_lshl_b32 s58, s63, 13
  s_add_u32 s58, s58, s69
  buffer_load_dwordx4 v[56:59], v2, s[40:43], s58 offen offset:0 sc1
  buffer_load_dwordx4 v[60:63], v2, s[40:43], s58 offen offset:1024 sc1
  buffer_load_dwordx4 v[64:67], v2, s[40:43], s58 offen offset:2048 sc1
  buffer_load_dwordx4 v[68:71], v2, s[40:43], s58 offen offset:3072 sc1
  s_cmp_ge_u32 s66, 49152
  s_mov_b32 s60, 49152
  s_cmov_b32 s60, -49152
  s_add_u32 s66, s66, s60
  s_waitcnt vmcnt(0)
  s_barrier
  v_sub_f32 v10, 1.0, v11
  s_lshr_b32 s59, s65, 4
  s_lshl_b32 s68, s65, 9
  s_add_u32 s68, s68, s67
  s_lshl_b32 s74, s65, 3
  s_bitcmp1_b32 s65, 2
  s_cselect_b32 s68, 0x40000000, s68
  s_cselect_b32 s74, 0x40000000, s74
  s_cselect_b32 s59, -1, s59
L_b_ff_2c:
  v_cmp_lt_i32 vcc, s59, v240
  s_cbranch_vccz L_b_ff_2
  s_add_u32 m0, s66, 0
  s_add_u32 s59, s68, 0x0
  buffer_load_dwordx4 v2, s[40:43], s59 offen offset:0 sc1 lds
  buffer_load_dwordx4 v2, s[40:43], s59 offen offset:1024 sc1 lds
  buffer_load_dwordx4 v2, s[40:43], s59 offen offset:2048 sc1 lds
  buffer_load_dwordx4 v2, s[40:43], s59 offen offset:3072 sc1 lds
  s_add_u32 m0, s66, 8192
  s_add_u32 s59, s68, 0x1000000
  buffer_load_dwordx4 v2, s[40:43], s59 offen offset:0 sc1 lds
  buffer_load_dwordx4 v2, s[40:43], s59 offen offset:1024 sc1 lds
  buffer_load_dwordx4 v2, s[40:43], s59 offen offset:2048 sc1 lds
  buffer_load_dwordx4 v2, s[40:43], s59 offen offset:3072 sc1 lds
  s_add_u32 m0, s66, 16384
  s_add_u32 s59, s68, 0x2000000
  buffer_load_dwordx4 v2, s[40:43], s59 offen offset:0 sc1 lds
  buffer_load_dwordx4 v2, s[40:43], s59 offen offset:1024 sc1 lds
  buffer_load_dwordx4 v2, s[40:43], s59 offen offset:2048 sc1 lds
  buffer_load_dwordx4 v2, s[40:43], s59 offen offset:3072 sc1 lds
  buffer_load_dword v11, v31, s[40:43], s74 offen sc1
  buffer_load_dword v240, v7, s[40:43], s73 offen sc1
  s_cmp_ge_u32 s66, 49152
  s_mov_b32 s60, 49152
  s_cmov_b32 s60, -49152
  s_add_u32 s66, s66, s60
L_b_chk:
  v_max3_u32 v3, v56, v60, v64
  v_max_u32 v3, v3, v68
  v_cmp_eq_u32 vcc, -1, v3
  s_cbranch_vccnz L_b_late
  ds_write2st64_b32 v8, v56, v57 offset0:0 offset1:8
  ds_write2st64_b32 v8, v60, v61 offset0:2 offset1:10
  ds_write2st64_b32 v8, v64, v65 offset0:4 offset1:12
  ds_write2st64_b32 v8, v68, v69 offset0:6 offset1:14
  ds_read_b128 v[80:83], v15 offset:0
  ds_read_b128 v[112:115], v12 offset:8192
  ds_read_b128 v[116:119], v12 offset:9216
  ds_read_b128 v[84:87], v15 offset:2048
  ds_read_b128 v[120:123], v12 offset:10240
  ds_read_b128 v[124:127], v12 offset:11264
  ds_read_b128 v[88:91], v15 offset:4096
  ds_read_b128 v[128:131], v12 offset:12288
  ds_read_b128 v[132:135], v12 offset:13312
  ds_read_b128 v[92:95], v15 offset:6144
  ds_read_b128 v[136:139], v12 offset:14336
  ds_read_b128 v[140:143], v12 offset:15360
  v_mov_b64 v[72:73], v[58:59]
  v_mov_b64 v[74:75], v[62:63]
  v_mov_b64 v[76:77], v[66:67]
  v_mov_b64 v[78:79], v[70:71]
  s_waitcnt lgkmcnt(12)
  s_lshl_b32 s58, s65, 13
  s_add_u32 s58, s58, s69
  buffer_load_dwordx4 v[56:59], v2, s[40:43], s58 offen offset:0 sc1
  buffer_load_dwordx4 v[60:63], v2, s[40:43], s58 offen offset:1024 sc1
  buffer_load_dwordx4 v[64:67], v2, s[40:43], s58 offen offset:2048 sc1
  buffer_load_dwordx4 v[68:71], v2, s[40:43], s58 offen offset:3072 sc1
  s_waitcnt lgkmcnt(9)
  v_mfma_f32_16x16x32_bf16 v[40:43], v[112:115], v[80:83], v[20:23]
  ds_read_b64_tr_b16 v[96:97], v9 offset:0
  v_mfma_f32_16x16x32_bf16 v[44:47], v[116:119], v[80:83], v[24:27]
  ds_read_b64_tr_b16 v[98:99], v9 offset:2048
  s_waitcnt lgkmcnt(8)
  v_mfma_f32_16x16x32_bf16 v[40:43], v[120:123], v[84:87], v[40:43]
  ds_read_b64_tr_b16 v[100:101], v9 offset:512
  v_mfma_f32_16x16x32_bf16 v[44:47], v[124:127], v[84:87], v[44:47]
  ds_read_b64_tr_b16 v[102:103], v9 offset:2560
  s_waitcnt lgkmcnt(7)
  v_mfma_f32_16x16x32_bf16 v[40:43], v[128:131], v[88:91], v[40:43]
  ds_read_b64_tr_b16 v[104:105], v9 offset:1024
  v_mfma_f32_16x16x32_bf16 v[44:47], v[132:135], v[88:91], v[44:47]
  ds_read_b64_tr_b16 v[106:107], v9 offset:3072
  s_waitcnt lgkmcnt(6)
  v_mfma_f32_16x16x32_bf16 v[40:43], v[136:139], v[92:95], v[40:43]
  ds_read_b64_tr_b16 v[108:109], v9 offset:1536
  v_mfma_f32_16x16x32_bf16 v[44:47], v[140:143], v[92:95], v[44:47]
  ds_read_b64_tr_b16 v[110:111], v9 offset:3584
  ds_read_b128 v[112:115], v12 offset:16384
  ds_read_b128 v[116:119], v12 offset:17408
  ds_read_b128 v[120:123], v12 offset:18432
  ds_read_b128 v[124:127], v12 offset:19456
  s_waitcnt lgkmcnt(4)
  v_mfma_f32_16x16x32_bf16 v[48:51], v[96:99], v[80:83], 0
  ds_read_b128 v[128:131], v12 offset:20480
  v_mfma_f32_16x16x32_bf16 v[48:51], v[100:103], v[84:87], v[48:51]
  ds_read_b128 v[132:135], v12 offset:21504
  v_mfma_f32_16x16x32_bf16 v[48:51], v[104:107], v[88:91], v[48:51]
  ds_read_b128 v[136:139], v12 offset:22528
  v_mfma_f32_16x16x32_bf16 v[48:51], v[108:111], v[92:95], v[48:51]
  ds_read_b128 v[140:143], v12 offset:23552
  v_subrev_u32 v12, s60, v12
  v_subrev_u32 v15, s60, v15
  v_max_f32 v3, v40, v41
  v_max3_f32 v3, v3, v42, v43
  v_max3_f32 v3, v3, v44, v45
  v_max3_f32 v3, v3, v46, v47
  s_nop 0
  v_max3_f32 v3, v3, v48, v49
  v_mov_b32 v4, v3
  s_nop 1
  v_permlane32_swap_b32 v4, v3
  v_max_f32 v3, v3, v4
  v_mov_b32 v4, v3
  s_nop 1
  v_permlane16_swap_b32 v4, v3
  v_max_f32 v3, v3, v4
  v_sub_f32 v40, v40, v3
  v_sub_f32 v41, v41, v3
  v_sub_f32 v42, v42, v3
  v_sub_f32 v43, v43, v3
  v_sub_f32 v44, v44, v3
  v_sub_f32 v45, v45, v3
  v_sub_f32 v46, v46, v3
  v_sub_f32 v47, v47, v3
  v_sub_f32 v48, v48, v3
  v_sub_f32 v49, v49, v3
  v_exp_f32 v40, v40
  v_exp_f32 v41, v41
  v_exp_f32 v42, v42
  v_exp_f32 v43, v43
  v_exp_f32 v44, v44
  v_exp_f32 v45, v45
  v_exp_f32 v46, v46
  v_exp_f32 v47, v47
  v_exp_f32 v48, v48
  v_exp_f32 v49, v49
  v_cvt_pk_bf16_f32 v36, v40, v41
  v_cvt_pk_bf16_f32 v37, v42, v43
  v_cvt_pk_bf16_f32 v38, v44, v45
  v_cvt_pk_bf16_f32 v39, v46, v47
  v_cvt_pk_bf16_f32 v32, v48, v49
  v_cvt_pk_bf16_f32 v35, v48, v49
  s_waitcnt lgkmcnt(0)
  v_mfma_f32_16x16x32_bf16 v[52:55], v[16:19], v[36:39], 0
  v_mfma_f32_16x16x32_bf16 v[80:83], v[112:115], v[36:39], 0
  v_mfma_f32_16x16x32_bf16 v[84:87], v[116:119], v[36:39], 0
  v_mfma_f32_16x16x32_bf16 v[88:91], v[120:123], v[36:39], 0
  v_mfma_f32_16x16x32_bf16 v[92:95], v[124:127], v[36:39], 0
  v_mfma_f32_16x16x32_bf16 v[96:99], v[128:131], v[36:39], 0
  v_mfma_f32_16x16x32_bf16 v[100:103], v[132:135], v[36:39], 0
  v_mfma_f32_16x16x16_bf16 v[52:55], v[16:17], v[32:33], v[52:55]
  v_mfma_f32_16x16x32_bf16 v[104:107], v[136:139], v[36:39], 0
  v_mfma_f32_16x16x32_bf16 v[108:111], v[140:143], v[36:39], 0
  v_mfma_f32_16x16x16_bf16 v[80:83], v[72:73], v[32:33], v[80:83]
  v_mfma_f32_16x16x16_bf16 v[84:87], v[72:73], v[34:35], v[84:87]
  v_mfma_f32_16x16x16_bf16 v[88:91], v[74:75], v[32:33], v[88:91]
  v_mfma_f32_16x16x16_bf16 v[92:95], v[74:75], v[34:35], v[92:95]
  v_mfma_f32_16x16x16_bf16 v[96:99], v[76:77], v[32:33], v[96:99]
  v_mfma_f32_16x16x16_bf16 v[100:103], v[76:77], v[34:35], v[100:103]
  v_rcp_f32 v3, v52
  v_mfma_f32_16x16x16_bf16 v[104:107], v[78:79], v[32:33], v[104:107]
  v_mul_f32 v3, v3, v10
  v_mfma_f32_16x16x16_bf16 v[108:111], v[78:79], v[34:35], v[108:111]
  v_mul_f32 v80, v80, v3
  v_mul_f32 v81, v81, v3
  v_mul_f32 v82, v82, v3
  v_mul_f32 v83, v83, v3
  v_mul_f32 v84, v84, v3
  v_mul_f32 v85, v85, v3
  v_mul_f32 v86, v86, v3
  v_mul_f32 v87, v87, v3
  v_cvt_pk_bf16_f32 v144, v80, v81
  v_cvt_pk_bf16_f32 v145, v82, v83
  v_cvt_pk_bf16_f32 v146, v84, v85
  v_cvt_pk_bf16_f32 v147, v86, v87
  ds_write_b128 v13, v[144:147] offset:0
  v_mul_f32 v88, v88, v3
  v_mul_f32 v89, v89, v3
  v_mul_f32 v90, v90, v3
  v_mul_f32 v91, v91, v3
  v_mul_f32 v92, v92, v3
  v_mul_f32 v93, v93, v3
  v_mul_f32 v94, v94, v3
  v_mul_f32 v95, v95, v3
  v_cvt_pk_bf16_f32 v148, v88, v89
  v_cvt_pk_bf16_f32 v149, v90, v91
  v_cvt_pk_bf16_f32 v150, v92, v93
  v_cvt_pk_bf16_f32 v151, v94, v95
  ds_write_b128 v13, v[148:151] offset:1024
  v_mul_f32 v96, v96, v3
  v_mul_f32 v97, v97, v3
  v_mul_f32 v98, v98, v3
  v_mul_f32 v99, v99, v3
  v_mul_f32 v100, v100, v3
  v_mul_f32 v101, v101, v3
  v_mul_f32 v102, v102, v3
  v_mul_f32 v103, v103, v3
  s_waitcnt lgkmcnt(1)
  v_cvt_pk_bf16_f32 v144, v96, v97
  v_cvt_pk_bf16_f32 v145, v98, v99
  v_cvt_pk_bf16_f32 v146, v100, v101
  v_cvt_pk_bf16_f32 v147, v102, v103
  ds_write_b128 v13, v[144:147] offset:2048
  v_mul_f32 v104, v104, v3
  v_mul_f32 v105, v105, v3
  v_mul_f32 v106, v106, v3
  v_mul_f32 v107, v107, v3
  v_mul_f32 v108, v108, v3
  v_mul_f32 v109, v109, v3
  v_mul_f32 v110, v110, v3
  v_mul_f32 v111, v111, v3
  s_waitcnt lgkmcnt(1)
  v_cvt_pk_bf16_f32 v148, v104, v105
  v_cvt_pk_bf16_f32 v149, v106, v107
  v_cvt_pk_bf16_f32 v150, v108, v109
  v_cvt_pk_bf16_f32 v151, v110, v111
  ds_write_b128 v13, v[148:151] offset:3072
  v_xor_b32 v13, 0x4000, v13
  s_waitcnt vmcnt(0)
L_b_join:
  s_mov_b32 s62, s63
  s_mov_b32 s63, s65
  s_bitcmp1_b32 s63, 2
  s_cselect_b32 s58, 0, 1
  s_add_u32 s95, s95, s58
  v_sub_f32 v10, 1.0, v11
  v_readlane_b32 s65, v1, s95
  s_mul_i32 s71, s62, 98304
  s_add_u32 s71, s71, s70
  s_lshr_b32 s59, s65, 4
  s_lshl_b32 s68, s65, 9
  s_add_u32 s68, s68, s67
  s_lshl_b32 s74, s65, 3
  s_bitcmp1_b32 s65, 2
  s_cselect_b32 s68, 0x40000000, s68
  s_cselect_b32 s74, 0x40000000, s74
  s_cselect_b32 s59, -1, s59
L_b_ff_3c:
  v_cmp_lt_i32 vcc, s59, v240
  s_cbranch_vccz L_b_ff_3
  v_max3_u32 v3, v56, v60, v64
  v_max_u32 v3, v3, v68
  v_cmp_eq_u32 vcc, -1, v3
  s_bitcmp1_b32 s63, 2
  s_waitcnt lgkmcnt(0)
  s_barrier
  s_cbranch_scc1 L_b_alone
  s_cbranch_vccnz L_b_alone
  s_sub_u32 s60, 0, s60
  ds_read_b128 v[152:155], v14 offset:0
  ds_read_b128 v[156:159], v14 offset:1024
  ds_read_b128 v[160:163], v14 offset:2048
  ds_read_b128 v[164:167], v14 offset:3072
  ds_read_b128 v[168:171], v14 offset:4096
  ds_read_b128 v[172:175], v14 offset:5120
  ds_read_b128 v[176:179], v14 offset:6144
  ds_read_b128 v[180:183], v14 offset:7168
  s_waitcnt lgkmcnt(7)
  v_mfma_f32_16x16x32_bf16 v[216:219], a[0:3], v[152:155], 0
  s_waitcnt lgkmcnt(6)
  v_mfma_f32_16x16x32_bf16 v[216:219], a[4:7], v[156:159], v[216:219]
  s_waitcnt lgkmcnt(5)
  v_mfma_f32_16x16x32_bf16 v[216:219], a[8:11], v[160:163], v[216:219]
  s_waitcnt lgkmcnt(4)
  v_mfma_f32_16x16x32_bf16 v[216:219], a[12:15], v[164:167], v[216:219]
  s_waitcnt lgkmcnt(3)
  ds_write2st64_b32 v8, v56, v57 offset0:0 offset1:8
  ds_write2st64_b32 v8, v60, v61 offset0:2 offset1:10
  v_mfma_f32_16x16x32_bf16 v[216:219], a[16:19], v[168:171], v[216:219]
  s_waitcnt lgkmcnt(4)
  ds_write2st64_b32 v8, v64, v65 offset0:4 offset1:12
  ds_write2st64_b32 v8, v68, v69 offset0:6 offset1:14
  v_mfma_f32_16x16x32_bf16 v[216:219], a[20:23], v[172:175], v[216:219]
  s_waitcnt lgkmcnt(5)
  ds_read_b128 v[80:83], v15 offset:0
  ds_read_b128 v[112:115], v12 offset:8192
  v_mfma_f32_16x16x32_bf16 v[216:219], a[24:27], v[176:179], v[216:219]
  s_waitcnt lgkmcnt(6)
  ds_read_b128 v[116:119], v12 offset:9216
  ds_read_b128 v[84:87], v15 offset:2048
  v_mfma_f32_16x16x32_bf16 v[216:219], a[28:31], v[180:183], v[216:219]
  s_nop 0
  ds_read_b128 v[120:123], v12 offset:10240
  ds_read_b128 v[124:127], v12 offset:11264
  v_mfma_f32_16x16x32_bf16 v[220:223], a[32:35], v[152:155], 0
  s_nop 0
  ds_read_b128 v[88:91], v15 offset:4096
  ds_read_b128 v[128:131], v12 offset:12288
  v_mfma_f32_16x16x32_bf16 v[220:223], a[36:39], v[156:159], v[220:223]
  s_nop 0
  ds_read_b128 v[132:135], v12 offset:13312
  ds_read_b128 v[92:95], v15 offset:6144
  v_mfma_f32_16x16x32_bf16 v[220:223], a[40:43], v[160:163], v[220:223]
  s_nop 0
  ds_read_b128 v[136:139], v12 offset:14336
  ds_read_b128 v[140:143], v12 offset:15360
  v_mfma_f32_16x16x32_bf16 v[220:223], a[44:47], v[164:167], v[220:223]
  s_nop 0
  v_mov_b64 v[72:73], v[58:59]
  v_mov_b64 v[74:75], v[62:63]
  v_mfma_f32_16x16x32_bf16 v[220:223], a[48:51], v[168:171], v[220:223]
  s_nop 0
  v_mov_b64 v[76:77], v[66:67]
  v_mov_b64 v[78:79], v[70:71]
  v_mfma_f32_16x16x32_bf16 v[220:223], a[52:55], v[172:175], v[220:223]
  s_waitcnt lgkmcnt(12)
  s_lshl_b32 s58, s65, 13
  s_add_u32 s58, s58, s69
  buffer_load_dwordx4 v[56:59], v2, s[40:43], s58 offen offset:0 sc1
  v_mfma_f32_16x16x32_bf16 v[220:223], a[56:59], v[176:179], v[220:223]
  s_nop 0
  buffer_load_dwordx4 v[60:63], v2, s[40:43], s58 offen offset:1024 sc1
  v_mfma_f32_16x16x32_bf16 v[220:223], a[60:63], v[180:183], v[220:223]
  s_nop 0
  buffer_load_dwordx4 v[64:67], v2, s[40:43], s58 offen offset:2048 sc1
  v_mfma_f32_16x16x32_bf16 v[224:227], a[64:67], v[152:155], 0
  s_nop 0
  buffer_load_dwordx4 v[68:71], v2, s[40:43], s58 offen offset:3072 sc1
  v_mfma_f32_16x16x32_bf16 v[224:227], a[68:71], v[156:159], v[224:227]
  s_waitcnt lgkmcnt(9)
  v_mfma_f32_16x16x32_bf16 v[40:43], v[112:115], v[80:83], v[20:23]
  s_nop 0
  ds_read_b64_tr_b16 v[96:97], v9 offset:0
  v_mfma_f32_16x16x32_bf16 v[44:47], v[116:119], v[80:83], v[24:27]
  s_nop 0
  ds_read_b64_tr_b16 v[98:99], v9 offset:2048
  v_mfma_f32_16x16x32_bf16 v[224:227], a[72:75], v[160:163], v[224:227]
  s_waitcnt lgkmcnt(8)
  v_mfma_f32_16x16x32_bf16 v[40:43], v[120:123], v[84:87], v[40:43]
  s_nop 0
  ds_read_b64_tr_b16 v[100:101], v9 offset:512
  v_mfma_f32_16x16x32_bf16 v[44:47], v[124:127], v[84:87], v[44:47]
  s_nop 0
  ds_read_b64_tr_b16 v[102:103], v9 offset:2560
  v_mfma_f32_16x16x32_bf16 v[224:227], a[76:79], v[164:167], v[224:227]
  s_waitcnt lgkmcnt(7)
  v_mfma_f32_16x16x32_bf16 v[40:43], v[128:131], v[88:91], v[40:43]
  s_nop 0
  ds_read_b64_tr_b16 v[104:105], v9 offset:1024
  v_mfma_f32_16x16x32_bf16 v[44:47], v[132:135], v[88:91], v[44:47]
  s_nop 0
  ds_read_b64_tr_b16 v[106:107], v9 offset:3072
  v_mfma_f32_16x16x32_bf16 v[224:227], a[80:83], v[168:171], v[224:227]
  s_waitcnt lgkmcnt(6)
  v_mfma_f32_16x16x32_bf16 v[40:43], v[136:139], v[92:95], v[40:43]
  s_nop 0
  ds_read_b64_tr_b16 v[108:109], v9 offset:1536
  v_mfma_f32_16x16x32_bf16 v[44:47], v[140:143], v[92:95], v[44:47]
  s_nop 0
  ds_read_b64_tr_b16 v[110:111], v9 offset:3584
  ds_read_b128 v[112:115], v12 offset:16384
  v_mfma_f32_16x16x32_bf16 v[224:227], a[84:87], v[172:175], v[224:227]
  s_nop 0
  ds_read_b128 v[116:119], v12 offset:17408
  ds_read_b128 v[120:123], v12 offset:18432
  v_mfma_f32_16x16x32_bf16 v[224:227], a[88:91], v[176:179], v[224:227]
  s_nop 0
  ds_read_b128 v[124:127], v12 offset:19456
  v_mfma_f32_16x16x32_bf16 v[224:227], a[92:95], v[180:183], v[224:227]
  s_nop 0
  v_cvt_pk_bf16_f32 v232, v216, v217
  v_cvt_pk_bf16_f32 v233, v218, v219
  v_mfma_f32_16x16x32_bf16 v[228:231], a[96:99], v[152:155], 0
  s_nop 0
  v_cvt_pk_bf16_f32 v234, v220, v221
  v_cvt_pk_bf16_f32 v235, v222, v223
  v_mfma_f32_16x16x32_bf16 v[228:231], a[100:103], v[156:159], v[228:231]
  s_nop 0
  buffer_store_dwordx4 v[232:235], v2, s[40:43], s71 offen offset:0 sc1
  v_mfma_f32_16x16x32_bf16 v[228:231], a[104:107], v[160:163], v[228:231]
  s_waitcnt lgkmcnt(4)
  v_mfma_f32_16x16x32_bf16 v[48:51], v[96:99], v[80:83], 0
  s_nop 0
  ds_read_b128 v[128:131], v12 offset:20480
  v_mfma_f32_16x16x32_bf16 v[48:51], v[100:103], v[84:87], v[48:51]
  s_nop 0
  ds_read_b128 v[132:135], v12 offset:21504
  v_mfma_f32_16x16x32_bf16 v[48:51], v[104:107], v[88:91], v[48:51]
  s_nop 0
  ds_read_b128 v[136:139], v12 offset:22528
  v_mfma_f32_16x16x32_bf16 v[48:51], v[108:111], v[92:95], v[48:51]
  s_nop 0
  ds_read_b128 v[140:143], v12 offset:23552
  v_subrev_u32 v12, s60, v12
  v_mfma_f32_16x16x32_bf16 v[228:231], a[108:111], v[164:167], v[228:231]
  s_add_u32 m0, s66, 0
  s_add_u32 s59, s68, 0x0
  buffer_load_dwordx4 v2, s[40:43], s59 offen offset:0 sc1 lds
  v_subrev_u32 v15, s60, v15
  v_mfma_f32_16x16x32_bf16 v[228:231], a[112:115], v[168:171], v[228:231]
  s_nop 0
  v_max_f32 v3, v40, v41
  v_max3_f32 v3, v3, v42, v43
  v_mfma_f32_16x16x32_bf16 v[228:231], a[116:119], v[172:175], v[228:231]
  s_nop 0
  v_max3_f32 v3, v3, v44, v45
  v_max3_f32 v3, v3, v46, v47
  v_mfma_f32_16x16x32_bf16 v[228:231], a[120:123], v[176:179], v[228:231]
  s_nop 0
  buffer_load_dwordx4 v2, s[40:43], s59 offen offset:1024 sc1 lds
  v_max3_f32 v3, v3, v48, v49
  v_mfma_f32_16x16x32_bf16 v[228:231], a[124:127], v[180:183], v[228:231]
  s_nop 0
  v_mov_b32 v4, v3
  v_mfma_f32_16x16x32_bf16 v[216:219], a[128:131], v[152:155], 0
  s_nop 0
  v_permlane32_swap_b32 v4, v3
  v_mfma_f32_16x16x32_bf16 v[216:219], a[132:135], v[156:159], v[216:219]
  s_nop 0
  buffer_load_dwordx4 v2, s[40:43], s59 offen offset:2048 sc1 lds
  v_max_f32 v3, v3, v4
  v_mfma_f32_16x16x32_bf16 v[216:219], a[136:139], v[160:163], v[216:219]
  s_nop 0
  v_mov_b32 v4, v3
  v_mfma_f32_16x16x32_bf16 v[216:219], a[140:143], v[164:167], v[216:219]
  s_nop 0
  v_permlane16_swap_b32 v4, v3
  v_mfma_f32_16x16x32_bf16 v[216:219], a[144:147], v[168:171], v[216:219]
  s_nop 0
  buffer_load_dwordx4 v2, s[40:43], s59 offen offset:3072 sc1 lds
  v_max_f32 v3, v3, v4
  v_mfma_f32_16x16x32_bf16 v[216:219], a[148:151], v[172:175], v[216:219]
  s_nop 0
  v_sub_f32 v40, v40, v3
  v_sub_f32 v41, v41, v3
  v_mfma_f32_16x16x32_bf16 v[216:219], a[152:155], v[176:179], v[216:219]
  s_nop 0
  v_sub_f32 v42, v42, v3
  v_sub_f32 v43, v43, v3
  v_mfma_f32_16x16x32_bf16 v[216:219], a[156:159], v[180:183], v[216:219]
  s_nop 0
  v_cvt_pk_bf16_f32 v236, v224, v225
  v_cvt_pk_bf16_f32 v237, v226, v227
  v_mfma_f32_16x16x32_bf16 v[220:223], a[160:163], v[152:155], 0
  s_nop 0
  ds_read_b128 v[184:187], v14 offset:8192
  v_cvt_pk_bf16_f32 v238, v228, v229
  v_cvt_pk_bf16_f32 v239, v230, v231
  v_mfma_f32_16x16x32_bf16 v[220:223], a[164:167], v[156:159], v[220:223]
  s_nop 0
  buffer_store_dwordx4 v[236:239], v2, s[40:43], s71 offen offset:1024 sc1
  v_sub_f32 v44, v44, v3
  v_mfma_f32_16x16x32_bf16 v[220:223], a[168:171], v[160:163], v[220:223]
  s_nop 0
  ds_read_b128 v[188:191], v14 offset:9216
  v_sub_f32 v45, v45, v3
  v_mfma_f32_16x16x32_bf16 v[220:223], a[172:175], v[164:167], v[220:223]
  s_add_u32 m0, s66, 8192
  s_add_u32 s59, s68, 0x1000000
  buffer_load_dwordx4 v2, s[40:43], s59 offen offset:0 sc1 lds
  v_sub_f32 v46, v46, v3
  v_mfma_f32_16x16x32_bf16 v[220:223], a[176:179], v[168:171], v[220:223]
  s_nop 0
  ds_read_b128 v[192:195], v14 offset:10240
  v_sub_f32 v47, v47, v3
  v_mfma_f32_16x16x32_bf16 v[220:223], a[180:183], v[172:175], v[220:223]
  s_nop 0
  v_sub_f32 v48, v48, v3
  v_sub_f32 v49, v49, v3
  v_mfma_f32_16x16x32_bf16 v[220:223], a[184:187], v[176:179], v[220:223]
  s_nop 0
  ds_read_b128 v[196:199], v14 offset:11264
  v_mfma_f32_16x16x32_bf16 v[220:223], a[188:191], v[180:183], v[220:223]
  s_nop 0
  buffer_load_dwordx4 v2, s[40:43], s59 offen offset:1024 sc1 lds
  v_mfma_f32_16x16x32_bf16 v[224:227], a[192:195], v[152:155], 0
  s_nop 0
  ds_read_b128 v[200:203], v14 offset:12288
  v_mfma_f32_16x16x32_bf16 v[224:227], a[196:199], v[156:159], v[224:227]
  s_nop 0
  v_exp_f32 v40, v40
  v_mfma_f32_16x16x32_bf16 v[224:227], a[200:203], v[160:163], v[224:227]
  s_nop 0
  ds_read_b128 v[204:207], v14 offset:13312
  v_mfma_f32_16x16x32_bf16 v[224:227], a[204:207], v[164:167], v[224:227]
  s_nop 0
  buffer_load_dwordx4 v2, s[40:43], s59 offen offset:2048 sc1 lds
  v_mfma_f32_16x16x32_bf16 v[224:227], a[208:211], v[168:171], v[224:227]
  s_nop 0
  ds_read_b128 v[208:211], v14 offset:14336
  v_mfma_f32_16x16x32_bf16 v[224:227], a[212:215], v[172:175], v[224:227]
  s_nop 0
  v_exp_f32 v41, v41
  v_mfma_f32_16x16x32_bf16 v[224:227], a[216:219], v[176:179], v[224:227]
  s_nop 0
  ds_read_b128 v[212:215], v14 offset:15360
  v_mfma_f32_16x16x32_bf16 v[224:227], a[220:223], v[180:183], v[224:227]
  s_nop 0
  v_cvt_pk_bf16_f32 v232, v216, v217
  v_cvt_pk_bf16_f32 v233, v218, v219
  v_mfma_f32_16x16x32_bf16 v[228:231], a[224:227], v[152:155], 0
  s_nop 0
  v_cvt_pk_bf16_f32 v234, v220, v221
  v_cvt_pk_bf16_f32 v235, v222, v223
  v_mfma_f32_16x16x32_bf16 v[228:231], a[228:231], v[156:159], v[228:231]
  s_nop 0
  buffer_store_dwordx4 v[232:235], v2, s[40:43], s71 offen offset:2048 sc1
  v_mfma_f32_16x16x32_bf16 v[228:231], a[232:235], v[160:163], v[228:231]
  s_nop 0
  buffer_load_dwordx4 v2, s[40:43], s59 offen offset:3072 sc1 lds
  v_mfma_f32_16x16x32_bf16 v[228:231], a[236:239], v[164:167], v[228:231]
  s_nop 0
  v_exp_f32 v42, v42
  v_mfma_f32_16x16x32_bf16 v[228:231], a[240:243], v[168:171], v[228:231]
  s_nop 0
  v_exp_f32 v43, v43
  v_mfma_f32_16x16x32_bf16 v[228:231], a[244:247], v[172:175], v[228:231]
  s_add_u32 m0, s66, 16384
  s_add_u32 s59, s68, 0x2000000
  buffer_load_dwordx4 v2, s[40:43], s59 offen offset:0 sc1 lds
  v_mfma_f32_16x16x32_bf16 v[228:231], a[248:251], v[176:179], v[228:231]
  s_nop 0
  v_exp_f32 v44, v44
  v_mfma_f32_16x16x32_bf16 v[228:231], a[252:255], v[180:183], v[228:231]
  s_waitcnt lgkmcnt(0)
  v_exp_f32 v45, v45
  v_mfma_f32_16x16x32_bf16 v[216:219], a[0:3], v[184:187], 0
  s_nop 0
  buffer_load_dwordx4 v2, s[40:43], s59 offen offset:1024 sc1 lds
  v_mfma_f32_16x16x32_bf16 v[216:219], a[4:7], v[188:191], v[216:219]
  s_nop 0
  v_exp_f32 v46, v46
  v_mfma_f32_16x16x32_bf16 v[216:219], a[8:11], v[192:195], v[216:219]
  s_nop 0
  v_xor_b32 v14, 0x4000, v14
  v_mfma_f32_16x16x32_bf16 v[216:219], a[12:15], v[196:199], v[216:219]
  s_nop 0
  buffer_load_dwordx4 v2, s[40:43], s59 offen offset:2048 sc1 lds
  v_mfma_f32_16x16x32_bf16 v[216:219], a[16:19], v[200:203], v[216:219]
  s_nop 0
  v_exp_f32 v47, v47
  v_mfma_f32_16x16x32_bf16 v[216:219], a[20:23], v[204:207], v[216:219]
  s_nop 0
  v_exp_f32 v48, v48
  v_mfma_f32_16x16x32_bf16 v[216:219], a[24:27], v[208:211], v[216:219]
  s_nop 0
  buffer_load_dwordx4 v2, s[40:43], s59 offen offset:3072 sc1 lds
  v_mfma_f32_16x16x32_bf16 v[216:219], a[28:31], v[212:215], v[216:219]
  s_nop 0
  v_cvt_pk_bf16_f32 v236, v224, v225
  v_cvt_pk_bf16_f32 v237, v226, v227
  v_mfma_f32_16x16x32_bf16 v[220:223], a[32:35], v[184:187], 0
  s_nop 0
  v_cvt_pk_bf16_f32 v238, v228, v229
  v_cvt_pk_bf16_f32 v239, v230, v231
  v_mfma_f32_16x16x32_bf16 v[220:223], a[36:39], v[188:191], v[220:223]
  s_nop 0
  buffer_store_dwordx4 v[236:239], v2, s[40:43], s71 offen offset:3072 sc1
  v_mfma_f32_16x16x32_bf16 v[220:223], a[40:43], v[192:195], v[220:223]
  s_nop 0
  buffer_load_dword v11, v31, s[40:43], s74 offen sc1
  v_mfma_f32_16x16x32_bf16 v[220:223], a[44:47], v[196:199], v[220:223]
  s_nop 0
  v_exp_f32 v49, v49
  v_mfma_f32_16x16x32_bf16 v[220:223], a[48:51], v[200:203], v[220:223]
  s_nop 0
  v_cvt_pk_bf16_f32 v36, v40, v41
  v_cvt_pk_bf16_f32 v37, v42, v43
  v_mfma_f32_16x16x32_bf16 v[220:223], a[52:55], v[204:207], v[220:223]
  s_nop 0
  buffer_load_dword v240, v7, s[40:43], s73 offen sc1
  v_cvt_pk_bf16_f32 v38, v44, v45
  v_mfma_f32_16x16x32_bf16 v[220:223], a[56:59], v[208:211], v[220:223]
  s_nop 0
  v_cvt_pk_bf16_f32 v39, v46, v47
  v_cvt_pk_bf16_f32 v32, v48, v49
  v_mfma_f32_16x16x32_bf16 v[220:223], a[60:63], v[212:215], v[220:223]
  s_nop 0
  v_cvt_pk_bf16_f32 v35, v48, v49
  v_mfma_f32_16x16x32_bf16 v[224:227], a[64:67], v[184:187], 0
  s_nop 0
  v_mfma_f32_16x16x32_bf16 v[52:55], v[16:19], v[36:39], 0
  s_nop 0
  v_mfma_f32_16x16x32_bf16 v[80:83], v[112:115], v[36:39], 0
  s_nop 0
  v_mfma_f32_16x16x32_bf16 v[84:87], v[116:119], v[36:39], 0
  s_nop 0
  v_mfma_f32_16x16x32_bf16 v[88:91], v[120:123], v[36:39], 0
  s_nop 0
  v_mfma_f32_16x16x32_bf16 v[92:95], v[124:127], v[36:39], 0
  s_nop 0
  v_mfma_f32_16x16x32_bf16 v[96:99], v[128:131], v[36:39], 0
  s_nop 0
  v_mfma_f32_16x16x32_bf16 v[100:103], v[132:135], v[36:39], 0
  s_nop 0
  v_mfma_f32_16x16x16_bf16 v[52:55], v[16:17], v[32:33], v[52:55]
  s_nop 0
  v_mfma_f32_16x16x32_bf16 v[104:107], v[136:139], v[36:39], 0
  s_nop 0
  v_mfma_f32_16x16x32_bf16 v[108:111], v[140:143], v[36:39], 0
  s_nop 0
  v_mfma_f32_16x16x16_bf16 v[80:83], v[72:73], v[32:33], v[80:83]
  s_nop 0
  v_mfma_f32_16x16x16_bf16 v[84:87], v[72:73], v[34:35], v[84:87]
  s_nop 0
  v_mfma_f32_16x16x16_bf16 v[88:91], v[74:75], v[32:33], v[88:91]
  s_nop 0
  v_mfma_f32_16x16x16_bf16 v[92:95], v[74:75], v[34:35], v[92:95]
  s_nop 0
  v_mfma_f32_16x16x16_bf16 v[96:99], v[76:77], v[32:33], v[96:99]
  s_nop 0
  v_mfma_f32_16x16x16_bf16 v[100:103], v[76:77], v[34:35], v[100:103]
  s_nop 0
  v_rcp_f32 v3, v52
  v_mfma_f32_16x16x16_bf16 v[104:107], v[78:79], v[32:33], v[104:107]
  s_nop 0
  v_mul_f32 v3, v3, v10
  v_mfma_f32_16x16x16_bf16 v[108:111], v[78:79], v[34:35], v[108:111]
  s_nop 0
  v_mul_f32 v80, v80, v3
  v_mul_f32 v81, v81, v3
  v_mfma_f32_16x16x32_bf16 v[224:227], a[68:71], v[188:191], v[224:227]
  s_nop 0
  v_mul_f32 v82, v82, v3
  v_mul_f32 v83, v83, v3
  v_mfma_f32_16x16x32_bf16 v[224:227], a[72:75], v[192:195], v[224:227]
  s_nop 0
  v_mul_f32 v84, v84, v3
  v_mul_f32 v85, v85, v3
  v_mfma_f32_16x16x32_bf16 v[224:227], a[76:79], v[196:199], v[224:227]
  s_nop 0
  v_mul_f32 v86, v86, v3
  v_mul_f32 v87, v87, v3
  v_mfma_f32_16x16x32_bf16 v[224:227], a[80:83], v[200:203], v[224:227]
  s_nop 0
  v_cvt_pk_bf16_f32 v144, v80, v81
  v_cvt_pk_bf16_f32 v145, v82, v83
  v_mfma_f32_16x16x32_bf16 v[224:227], a[84:87], v[204:207], v[224:227]
  s_nop 0
  v_cvt_pk_bf16_f32 v146, v84, v85
  v_cvt_pk_bf16_f32 v147, v86, v87
  v_mfma_f32_16x16x32_bf16 v[224:227], a[88:91], v[208:211], v[224:227]
  s_add_u32 s71, s71, 786432
  ds_write_b128 v13, v[144:147] offset:0
  v_mul_f32 v88, v88, v3
  v_mfma_f32_16x16x32_bf16 v[224:227], a[92:95], v[212:215], v[224:227]
  s_nop 0
  v_cvt_pk_bf16_f32 v232, v216, v217
  v_cvt_pk_bf16_f32 v233, v218, v219
  v_mfma_f32_16x16x32_bf16 v[228:231], a[96:99], v[184:187], 0
  s_nop 0
  v_cvt_pk_bf16_f32 v234, v220, v221
  v_cvt_pk_bf16_f32 v235, v222, v223
  v_mfma_f32_16x16x32_bf16 v[228:231], a[100:103], v[188:191], v[228:231]
  s_nop 0
  buffer_store_dwordx4 v[232:235], v2, s[40:43], s71 offen offset:0 sc1
  v_mul_f32 v89, v89, v3
  v_mfma_f32_16x16x32_bf16 v[228:231], a[104:107], v[192:195], v[228:231]
  s_nop 0
  v_mul_f32 v90, v90, v3
  v_mul_f32 v91, v91, v3
  v_mfma_f32_16x16x32_bf16 v[228:231], a[108:111], v[196:199], v[228:231]
  s_nop 0
  v_mul_f32 v92, v92, v3
  v_mul_f32 v93, v93, v3
  v_mfma_f32_16x16x32_bf16 v[228:231], a[112:115], v[200:203], v[228:231]
  s_nop 0
  v_mul_f32 v94, v94, v3
  v_mul_f32 v95, v95, v3
  v_mfma_f32_16x16x32_bf16 v[228:231], a[116:119], v[204:207], v[228:231]
  s_nop 0
  v_cvt_pk_bf16_f32 v148, v88, v89
  v_cvt_pk_bf16_f32 v149, v90, v91
  v_mfma_f32_16x16x32_bf16 v[228:231], a[120:123], v[208:211], v[228:231]
  s_nop 0
  v_cvt_pk_bf16_f32 v150, v92, v93
  v_cvt_pk_bf16_f32 v151, v94, v95
  v_mfma_f32_16x16x32_bf16 v[228:231], a[124:127], v[212:215], v[228:231]
  s_nop 0
  ds_write_b128 v13, v[148:151] offset:1024
  v_mul_f32 v96, v96, v3
  v_mfma_f32_16x16x32_bf16 v[216:219], a[128:131], v[184:187], 0
  s_nop 0
  v_mul_f32 v97, v97, v3
  v_mul_f32 v98, v98, v3
  v_mfma_f32_16x16x32_bf16 v[216:219], a[132:135], v[188:191], v[216:219]
  s_nop 0
  v_mul_f32 v99, v99, v3
  v_mul_f32 v100, v100, v3
  v_mfma_f32_16x16x32_bf16 v[216:219], a[136:139], v[192:195], v[216:219]
  s_nop 0
  v_mul_f32 v101, v101, v3
  v_mul_f32 v102, v102, v3
  v_mfma_f32_16x16x32_bf16 v[216:219], a[140:143], v[196:199], v[216:219]
  s_nop 0
  v_mul_f32 v103, v103, v3
  v_mfma_f32_16x16x32_bf16 v[216:219], a[144:147], v[200:203], v[216:219]
  s_waitcnt lgkmcnt(1)
  v_cvt_pk_bf16_f32 v144, v96, v97
  v_cvt_pk_bf16_f32 v145, v98, v99
  v_mfma_f32_16x16x32_bf16 v[216:219], a[148:151], v[204:207], v[216:219]
  s_nop 0
  v_cvt_pk_bf16_f32 v146, v100, v101
  v_cvt_pk_bf16_f32 v147, v102, v103
  v_mfma_f32_16x16x32_bf16 v[216:219], a[152:155], v[208:211], v[216:219]
  s_nop 0
  ds_write_b128 v13, v[144:147] offset:2048
  v_mul_f32 v104, v104, v3
  v_mfma_f32_16x16x32_bf16 v[216:219], a[156:159], v[212:215], v[216:219]
  s_nop 0
  v_cvt_pk_bf16_f32 v236, v224, v225
  v_cvt_pk_bf16_f32 v237, v226, v227
  v_mfma_f32_16x16x32_bf16 v[220:223], a[160:163], v[184:187], 0
  s_nop 0
  v_cvt_pk_bf16_f32 v238, v228, v229
  v_cvt_pk_bf16_f32 v239, v230, v231
  v_mfma_f32_16x16x32_bf16 v[220:223], a[164:167], v[188:191], v[220:223]
  s_nop 0
  buffer_store_dwordx4 v[236:239], v2, s[40:43], s71 offen offset:1024 sc1
  v_mul_f32 v105, v105, v3
  v_mfma_f32_16x16x32_bf16 v[220:223], a[168:171], v[192:195], v[220:223]
  s_nop 0
  v_mul_f32 v106, v106, v3
  v_mul_f32 v107, v107, v3
  v_mfma_f32_16x16x32_bf16 v[220:223], a[172:175], v[196:199], v[220:223]
  s_nop 0
  v_mul_f32 v108, v108, v3
  v_mul_f32 v109, v109, v3
  v_mfma_f32_16x16x32_bf16 v[220:223], a[176:179], v[200:203], v[220:223]
  s_nop 0
  v_mul_f32 v110, v110, v3
  v_mul_f32 v111, v111, v3
  v_mfma_f32_16x16x32_bf16 v[220:223], a[180:183], v[204:207], v[220:223]
  s_waitcnt lgkmcnt(1)
  v_cvt_pk_bf16_f32 v148, v104, v105
  v_cvt_pk_bf16_f32 v149, v106, v107
  v_mfma_f32_16x16x32_bf16 v[220:223], a[184:187], v[208:211], v[220:223]
  s_nop 0
  v_cvt_pk_bf16_f32 v150, v108, v109
  v_cvt_pk_bf16_f32 v151, v110, v111
  v_mfma_f32_16x16x32_bf16 v[220:223], a[188:191], v[212:215], v[220:223]
  s_nop 0
  ds_write_b128 v13, v[148:151] offset:3072
  v_xor_b32 v13, 0x4000, v13
  v_mfma_f32_16x16x32_bf16 v[224:227], a[192:195], v[184:187], 0
  s_nop 0
  v_mfma_f32_16x16x32_bf16 v[224:227], a[196:199], v[188:191], v[224:227]
  s_nop 0
  v_mfma_f32_16x16x32_bf16 v[224:227], a[200:203], v[192:195], v[224:227]
  s_nop 0
  v_mfma_f32_16x16x32_bf16 v[224:227], a[204:207], v[196:199], v[224:227]
  s_nop 0
  v_mfma_f32_16x16x32_bf16 v[224:227], a[208:211], v[200:203], v[224:227]
  s_nop 0
  v_mfma_f32_16x16x32_bf16 v[224:227], a[212:215], v[204:207], v[224:227]
  s_nop 0
  v_mfma_f32_16x16x32_bf16 v[224:227], a[216:219], v[208:211], v[224:227]
  s_nop 0
  v_mfma_f32_16x16x32_bf16 v[224:227], a[220:223], v[212:215], v[224:227]
  s_nop 0
  v_cvt_pk_bf16_f32 v232, v216, v217
  v_cvt_pk_bf16_f32 v233, v218, v219
  v_mfma_f32_16x16x32_bf16 v[228:231], a[224:227], v[184:187], 0
  s_nop 0
  v_cvt_pk_bf16_f32 v234, v220, v221
  v_cvt_pk_bf16_f32 v235, v222, v223
  v_mfma_f32_16x16x32_bf16 v[228:231], a[228:231], v[188:191], v[228:231]
  s_nop 0
  buffer_store_dwordx4 v[232:235], v2, s[40:43], s71 offen offset:2048 sc1
  v_mfma_f32_16x16x32_bf16 v[228:231], a[232:235], v[192:195], v[228:231]
  s_nop 0
  v_mfma_f32_16x16x32_bf16 v[228:231], a[236:239], v[196:199], v[228:231]
  s_nop 0
  v_mfma_f32_16x16x32_bf16 v[228:231], a[240:243], v[200:203], v[228:231]
  s_nop 0
  v_mfma_f32_16x16x32_bf16 v[228:231], a[244:247], v[204:207], v[228:231]
  s_nop 0
  v_mfma_f32_16x16x32_bf16 v[228:231], a[248:251], v[208:211], v[228:231]
  s_nop 0
  v_mfma_f32_16x16x32_bf16 v[228:231], a[252:255], v[212:215], v[228:231]
  s_nop 0
  s_nop 6
  v_cvt_pk_bf16_f32 v236, v224, v225
  v_cvt_pk_bf16_f32 v237, v226, v227
  v_cvt_pk_bf16_f32 v238, v228, v229
  v_cvt_pk_bf16_f32 v239, v230, v231
  buffer_store_dwordx4 v[236:239], v2, s[40:43], s71 offen offset:3072 sc1
  s_cmp_ge_u32 s66, 49152
  s_mov_b32 s60, 49152
  s_cmov_b32 s60, -49152
  s_add_u32 s66, s66, s60
  s_waitcnt vmcnt(4)
  s_bitcmp1_b32 s64, 2
  s_cbranch_scc1 L_b_sig_4
  s_lshr_b32 s58, s64, 2
  s_add_u32 s58, s58, 147456
  v_mov_b32 v3, s58
  s_mov_b64 exec, 1
  ds_add_rtn_u32 v3, v3, v241
  s_lshl_b32 s58, s64, 3
  s_add_u32 s58, s58, 0xd087000
  s_waitcnt lgkmcnt(0)
  v_cmp_eq_u32 vcc, 3, v3
  s_cbranch_vccz L_b_sig_4x
  buffer_atomic_add v241, v7, s[40:43], s58 offen
L_b_sig_4x:
  s_mov_b64 exec, -1
L_b_sig_4:
  s_mov_b32 s64, s62
  s_branch L_b_join
L_b_alone:
  ds_read_b128 v[152:155], v14 offset:0
  ds_read_b128 v[156:159], v14 offset:1024
  ds_read_b128 v[160:163], v14 offset:2048
  ds_read_b128 v[164:167], v14 offset:3072
  ds_read_b128 v[168:171], v14 offset:4096
  ds_read_b128 v[172:175], v14 offset:5120
  ds_read_b128 v[176:179], v14 offset:6144
  ds_read_b128 v[180:183], v14 offset:7168
  s_waitcnt lgkmcnt(7)
  v_mfma_f32_16x16x32_bf16 v[216:219], a[0:3], v[152:155], 0
  s_waitcnt lgkmcnt(6)
  v_mfma_f32_16x16x32_bf16 v[216:219], a[4:7], v[156:159], v[216:219]
  s_waitcnt lgkmcnt(5)
  v_mfma_f32_16x16x32_bf16 v[216:219], a[8:11], v[160:163], v[216:219]
  s_waitcnt lgkmcnt(4)
  v_mfma_f32_16x16x32_bf16 v[216:219], a[12:15], v[164:167], v[216:219]
  s_waitcnt lgkmcnt(3)
  v_mfma_f32_16x16x32_bf16 v[216:219], a[16:19], v[168:171], v[216:219]
  s_waitcnt lgkmcnt(2)
  v_mfma_f32_16x16x32_bf16 v[216:219], a[20:23], v[172:175], v[216:219]
  s_waitcnt lgkmcnt(1)
  v_mfma_f32_16x16x32_bf16 v[216:219], a[24:27], v[176:179], v[216:219]
  s_waitcnt lgkmcnt(0)
  v_mfma_f32_16x16x32_bf16 v[216:219], a[28:31], v[180:183], v[216:219]
  s_nop 0
  v_mfma_f32_16x16x32_bf16 v[220:223], a[32:35], v[152:155], 0
  s_add_u32 m0, s66, 0
  s_add_u32 s59, s68, 0x0
  buffer_load_dwordx4 v2, s[40:43], s59 offen offset:0 sc1 lds
  v_mfma_f32_16x16x32_bf16 v[220:223], a[36:39], v[156:159], v[220:223]
  s_nop 0
  v_mfma_f32_16x16x32_bf16 v[220:223], a[40:43], v[160:163], v[220:223]
  s_nop 0
  buffer_load_dwordx4 v2, s[40:43], s59 offen offset:1024 sc1 lds
  v_mfma_f32_16x16x32_bf16 v[220:223], a[44:47], v[164:167], v[220:223]
  s_nop 0
  v_mfma_f32_16x16x32_bf16 v[220:223], a[48:51], v[168:171], v[220:223]
  s_nop 0
  buffer_load_dwordx4 v2, s[40:43], s59 offen offset:2048 sc1 lds
  v_mfma_f32_16x16x32_bf16 v[220:223], a[52:55], v[172:175], v[220:223]
  s_nop 0
  v_mfma_f32_16x16x32_bf16 v[220:223], a[56:59], v[176:179], v[220:223]
  s_nop 0
  buffer_load_dwordx4 v2, s[40:43], s59 offen offset:3072 sc1 lds
  v_mfma_f32_16x16x32_bf16 v[220:223], a[60:63], v[180:183], v[220:223]
  s_nop 0
  v_mfma_f32_16x16x32_bf16 v[224:227], a[64:67], v[152:155], 0
  s_add_u32 m0, s66, 8192
  s_add_u32 s59, s68, 0x1000000
  buffer_load_dwordx4 v2, s[40:43], s59 offen offset:0 sc1 lds
  v_mfma_f32_16x16x32_bf16 v[224:227], a[68:71], v[156:159], v[224:227]
  s_nop 0
  v_mfma_f32_16x16x32_bf16 v[224:227], a[72:75], v[160:163], v[224:227]
  s_nop 0
  buffer_load_dwordx4 v2, s[40:43], s59 offen offset:1024 sc1 lds
  v_mfma_f32_16x16x32_bf16 v[224:227], a[76:79], v[164:167], v[224:227]
  s_nop 0
  v_mfma_f32_16x16x32_bf16 v[224:227], a[80:83], v[168:171], v[224:227]
  s_nop 0
  buffer_load_dwordx4 v2, s[40:43], s59 offen offset:2048 sc1 lds
  v_mfma_f32_16x16x32_bf16 v[224:227], a[84:87], v[172:175], v[224:227]
  s_nop 0
  v_mfma_f32_16x16x32_bf16 v[224:227], a[88:91], v[176:179], v[224:227]
  s_nop 0
  buffer_load_dwordx4 v2, s[40:43], s59 offen offset:3072 sc1 lds
  v_mfma_f32_16x16x32_bf16 v[224:227], a[92:95], v[180:183], v[224:227]
  s_nop 0
  v_cvt_pk_bf16_f32 v232, v216, v217
  v_cvt_pk_bf16_f32 v233, v218, v219
  v_mfma_f32_16x16x32_bf16 v[228:231], a[96:99], v[152:155], 0
  s_nop 0
  v_cvt_pk_bf16_f32 v234, v220, v221
  v_cvt_pk_bf16_f32 v235, v222, v223
  v_mfma_f32_16x16x32_bf16 v[228:231], a[100:103], v[156:159], v[228:231]
  s_nop 0
  buffer_store_dwordx4 v[232:235], v2, s[40:43], s71 offen offset:0 sc1
  v_mfma_f32_16x16x32_bf16 v[228:231], a[104:107], v[160:163], v[228:231]
  s_add_u32 m0, s66, 16384
  s_add_u32 s59, s68, 0x2000000
  buffer_load_dwordx4 v2, s[40:43], s59 offen offset:0 sc1 lds
  v_mfma_f32_16x16x32_bf16 v[228:231], a[108:111], v[164:167], v[228:231]
  s_nop 0
  v_mfma_f32_16x16x32_bf16 v[228:231], a[112:115], v[168:171], v[228:231]
  s_nop 0
  buffer_load_dwordx4 v2, s[40:43], s59 offen offset:1024 sc1 lds
  v_mfma_f32_16x16x32_bf16 v[228:231], a[116:119], v[172:175], v[228:231]
  s_nop 0
  v_mfma_f32_16x16x32_bf16 v[228:231], a[120:123], v[176:179], v[228:231]
  s_nop 0
  buffer_load_dwordx4 v2, s[40:43], s59 offen offset:2048 sc1 lds
  v_mfma_f32_16x16x32_bf16 v[228:231], a[124:127], v[180:183], v[228:231]
  s_nop 0
  v_mfma_f32_16x16x32_bf16 v[216:219], a[128:131], v[152:155], 0
  s_nop 0
  buffer_load_dwordx4 v2, s[40:43], s59 offen offset:3072 sc1 lds
  v_mfma_f32_16x16x32_bf16 v[216:219], a[132:135], v[156:159], v[216:219]
  s_nop 0
  v_mfma_f32_16x16x32_bf16 v[216:219], a[136:139], v[160:163], v[216:219]
  s_nop 0
  buffer_load_dword v11, v31, s[40:43], s74 offen sc1
  v_mfma_f32_16x16x32_bf16 v[216:219], a[140:143], v[164:167], v[216:219]
  s_nop 0
  v_mfma_f32_16x16x32_bf16 v[216:219], a[144:147], v[168:171], v[216:219]
  s_nop 0
  buffer_load_dword v240, v7, s[40:43], s73 offen sc1
  v_mfma_f32_16x16x32_bf16 v[216:219], a[148:151], v[172:175], v[216:219]
  s_nop 0
  v_mfma_f32_16x16x32_bf16 v[216:219], a[152:155], v[176:179], v[216:219]
  s_nop 0
  v_mfma_f32_16x16x32_bf16 v[216:219], a[156:159], v[180:183], v[216:219]
  s_nop 0
  v_cvt_pk_bf16_f32 v236, v224, v225
  v_cvt_pk_bf16_f32 v237, v226, v227
  v_mfma_f32_16x16x32_bf16 v[220:223], a[160:163], v[152:155], 0
  s_nop 0
  ds_read_b128 v[184:187], v14 offset:8192
  v_cvt_pk_bf16_f32 v238, v228, v229
  v_cvt_pk_bf16_f32 v239, v230, v231
  v_mfma_f32_16x16x32_bf16 v[220:223], a[164:167], v[156:159], v[220:223]
  s_nop 0
  buffer_store_dwordx4 v[236:239], v2, s[40:43], s71 offen offset:1024 sc1
  v_mfma_f32_16x16x32_bf16 v[220:223], a[168:171], v[160:163], v[220:223]
  s_nop 0
  ds_read_b128 v[188:191], v14 offset:9216
  v_mfma_f32_16x16x32_bf16 v[220:223], a[172:175], v[164:167], v[220:223]
  s_nop 0
  v_mfma_f32_16x16x32_bf16 v[220:223], a[176:179], v[168:171], v[220:223]
  s_nop 0
  ds_read_b128 v[192:195], v14 offset:10240
  v_mfma_f32_16x16x32_bf16 v[220:223], a[180:183], v[172:175], v[220:223]
  s_nop 0
  v_mfma_f32_16x16x32_bf16 v[220:223], a[184:187], v[176:179], v[220:223]
  s_nop 0
  ds_read_b128 v[196:199], v14 offset:11264
  v_mfma_f32_16x16x32_bf16 v[220:223], a[188:191], v[180:183], v[220:223]
  s_nop 0
  v_mfma_f32_16x16x32_bf16 v[224:227], a[192:195], v[152:155], 0
  s_nop 0
  ds_read_b128 v[200:203], v14 offset:12288
  v_mfma_f32_16x16x32_bf16 v[224:227], a[196:199], v[156:159], v[224:227]
  s_nop 0
  v_mfma_f32_16x16x32_bf16 v[224:227], a[200:203], v[160:163], v[224:227]
  s_nop 0
  ds_read_b128 v[204:207], v14 offset:13312
  v_mfma_f32_16x16x32_bf16 v[224:227], a[204:207], v[164:167], v[224:227]
  s_nop 0
  v_mfma_f32_16x16x32_bf16 v[224:227], a[208:211], v[168:171], v[224:227]
  s_nop 0
  ds_read_b128 v[208:211], v14 offset:14336
  v_mfma_f32_16x16x32_bf16 v[224:227], a[212:215], v[172:175], v[224:227]
  s_nop 0
  v_mfma_f32_16x16x32_bf16 v[224:227], a[216:219], v[176:179], v[224:227]
  s_nop 0
  ds_read_b128 v[212:215], v14 offset:15360
  v_mfma_f32_16x16x32_bf16 v[224:227], a[220:223], v[180:183], v[224:227]
  s_nop 0
  v_cvt_pk_bf16_f32 v232, v216, v217
  v_cvt_pk_bf16_f32 v233, v218, v219
  v_mfma_f32_16x16x32_bf16 v[228:231], a[224:227], v[152:155], 0
  s_nop 0
  v_cvt_pk_bf16_f32 v234, v220, v221
  v_cvt_pk_bf16_f32 v235, v222, v223
  v_mfma_f32_16x16x32_bf16 v[228:231], a[228:231], v[156:159], v[228:231]
  s_nop 0
  buffer_store_dwordx4 v[232:235], v2, s[40:43], s71 offen offset:2048 sc1
  v_mfma_f32_16x16x32_bf16 v[228:231], a[232:235], v[160:163], v[228:231]
  s_nop 0
  v_mfma_f32_16x16x32_bf16 v[228:231], a[236:239], v[164:167], v[228:231]
  s_nop 0
  v_mfma_f32_16x16x32_bf16 v[228:231], a[240:243], v[168:171], v[228:231]
  s_nop 0
  v_mfma_f32_16x16x32_bf16 v[228:231], a[244:247], v[172:175], v[228:231]
  s_nop 0
  v_mfma_f32_16x16x32_bf16 v[228:231], a[248:251], v[176:179], v[228:231]
  s_nop 0
  v_mfma_f32_16x16x32_bf16 v[228:231], a[252:255], v[180:183], v[228:231]
  s_waitcnt lgkmcnt(0)
  v_mfma_f32_16x16x32_bf16 v[216:219], a[0:3], v[184:187], 0
  s_nop 0
  v_mfma_f32_16x16x32_bf16 v[216:219], a[4:7], v[188:191], v[216:219]
  s_nop 0
  v_mfma_f32_16x16x32_bf16 v[216:219], a[8:11], v[192:195], v[216:219]
  s_nop 0
  v_xor_b32 v14, 0x4000, v14
  v_mfma_f32_16x16x32_bf16 v[216:219], a[12:15], v[196:199], v[216:219]
  s_nop 0
  v_mfma_f32_16x16x32_bf16 v[216:219], a[16:19], v[200:203], v[216:219]
  s_nop 0
  v_mfma_f32_16x16x32_bf16 v[216:219], a[20:23], v[204:207], v[216:219]
  s_nop 0
  v_mfma_f32_16x16x32_bf16 v[216:219], a[24:27], v[208:211], v[216:219]
  s_nop 0
  v_mfma_f32_16x16x32_bf16 v[216:219], a[28:31], v[212:215], v[216:219]
  s_nop 0
  v_cvt_pk_bf16_f32 v236, v224, v225
  v_cvt_pk_bf16_f32 v237, v226, v227
  v_mfma_f32_16x16x32_bf16 v[220:223], a[32:35], v[184:187], 0
  s_nop 0
  v_cvt_pk_bf16_f32 v238, v228, v229
  v_cvt_pk_bf16_f32 v239, v230, v231
  v_mfma_f32_16x16x32_bf16 v[220:223], a[36:39], v[188:191], v[220:223]
  s_nop 0
  buffer_store_dwordx4 v[236:239], v2, s[40:43], s71 offen offset:3072 sc1
  v_mfma_f32_16x16x32_bf16 v[220:223], a[40:43], v[192:195], v[220:223]
  s_nop 0
  v_mfma_f32_16x16x32_bf16 v[220:223], a[44:47], v[196:199], v[220:223]
  s_nop 0
  v_mfma_f32_16x16x32_bf16 v[220:223], a[48:51], v[200:203], v[220:223]
  s_nop 0
  v_mfma_f32_16x16x32_bf16 v[220:223], a[52:55], v[204:207], v[220:223]
  s_nop 0
  v_mfma_f32_16x16x32_bf16 v[220:223], a[56:59], v[208:211], v[220:223]
  s_nop 0
  v_mfma_f32_16x16x32_bf16 v[220:223], a[60:63], v[212:215], v[220:223]
  s_nop 0
  v_mfma_f32_16x16x32_bf16 v[224:227], a[64:67], v[184:187], 0
  s_nop 0
  v_mfma_f32_16x16x32_bf16 v[224:227], a[68:71], v[188:191], v[224:227]
  s_nop 0
  v_mfma_f32_16x16x32_bf16 v[224:227], a[72:75], v[192:195], v[224:227]
  s_nop 0
  v_mfma_f32_16x16x32_bf16 v[224:227], a[76:79], v[196:199], v[224:227]
  s_nop 0
  v_mfma_f32_16x16x32_bf16 v[224:227], a[80:83], v[200:203], v[224:227]
  s_nop 0
  v_mfma_f32_16x16x32_bf16 v[224:227], a[84:87], v[204:207], v[224:227]
  s_nop 0
  v_mfma_f32_16x16x32_bf16 v[224:227], a[88:91], v[208:211], v[224:227]
  s_add_u32 s71, s71, 786432
  v_mfma_f32_16x16x32_bf16 v[224:227], a[92:95], v[212:215], v[224:227]
  s_nop 0
  v_cvt_pk_bf16_f32 v232, v216, v217
  v_cvt_pk_bf16_f32 v233, v218, v219
  v_mfma_f32_16x16x32_bf16 v[228:231], a[96:99], v[184:187], 0
  s_nop 0
  v_cvt_pk_bf16_f32 v234, v220, v221
  v_cvt_pk_bf16_f32 v235, v222, v223
  v_mfma_f32_16x16x32_bf16 v[228:231], a[100:103], v[188:191], v[228:231]
  s_nop 0
  buffer_store_dwordx4 v[232:235], v2, s[40:43], s71 offen offset:0 sc1
  v_mfma_f32_16x16x32_bf16 v[228:231], a[104:107], v[192:195], v[228:231]
  s_nop 0
  v_mfma_f32_16x16x32_bf16 v[228:231], a[108:111], v[196:199], v[228:231]
  s_nop 0
  v_mfma_f32_16x16x32_bf16 v[228:231], a[112:115], v[200:203], v[228:231]
  s_nop 0
  v_mfma_f32_16x16x32_bf16 v[228:231], a[116:119], v[204:207], v[228:231]
  s_nop 0
  v_mfma_f32_16x16x32_bf16 v[228:231], a[120:123], v[208:211], v[228:231]
  s_nop 0
  v_mfma_f32_16x16x32_bf16 v[228:231], a[124:127], v[212:215], v[228:231]
  s_nop 0
  v_mfma_f32_16x16x32_bf16 v[216:219], a[128:131], v[184:187], 0
  s_nop 0
  v_mfma_f32_16x16x32_bf16 v[216:219], a[132:135], v[188:191], v[216:219]
  s_nop 0
  v_mfma_f32_16x16x32_bf16 v[216:219], a[136:139], v[192:195], v[216:219]
  s_nop 0
  v_mfma_f32_16x16x32_bf16 v[216:219], a[140:143], v[196:199], v[216:219]
  s_nop 0
  v_mfma_f32_16x16x32_bf16 v[216:219], a[144:147], v[200:203], v[216:219]
  s_nop 0
  v_mfma_f32_16x16x32_bf16 v[216:219], a[148:151], v[204:207], v[216:219]
  s_nop 0
  v_mfma_f32_16x16x32_bf16 v[216:219], a[152:155], v[208:211], v[216:219]
  s_nop 0
  v_mfma_f32_16x16x32_bf16 v[216:219], a[156:159], v[212:215], v[216:219]
  s_nop 0
  v_cvt_pk_bf16_f32 v236, v224, v225
  v_cvt_pk_bf16_f32 v237, v226, v227
  v_mfma_f32_16x16x32_bf16 v[220:223], a[160:163], v[184:187], 0
  s_nop 0
  v_cvt_pk_bf16_f32 v238, v228, v229
  v_cvt_pk_bf16_f32 v239, v230, v231
  v_mfma_f32_16x16x32_bf16 v[220:223], a[164:167], v[188:191], v[220:223]
  s_nop 0
  buffer_store_dwordx4 v[236:239], v2, s[40:43], s71 offen offset:1024 sc1
  v_mfma_f32_16x16x32_bf16 v[220:223], a[168:171], v[192:195], v[220:223]
  s_nop 0
  v_mfma_f32_16x16x32_bf16 v[220:223], a[172:175], v[196:199], v[220:223]
  s_nop 0
  v_mfma_f32_16x16x32_bf16 v[220:223], a[176:179], v[200:203], v[220:223]
  s_nop 0
  v_mfma_f32_16x16x32_bf16 v[220:223], a[180:183], v[204:207], v[220:223]
  s_nop 0
  v_mfma_f32_16x16x32_bf16 v[220:223], a[184:187], v[208:211], v[220:223]
  s_nop 0
  v_mfma_f32_16x16x32_bf16 v[220:223], a[188:191], v[212:215], v[220:223]
  s_nop 0
  v_mfma_f32_16x16x32_bf16 v[224:227], a[192:195], v[184:187], 0
  s_nop 0
  v_mfma_f32_16x16x32_bf16 v[224:227], a[196:199], v[188:191], v[224:227]
  s_nop 0
  v_mfma_f32_16x16x32_bf16 v[224:227], a[200:203], v[192:195], v[224:227]
  s_nop 0
  v_mfma_f32_16x16x32_bf16 v[224:227], a[204:207], v[196:199], v[224:227]
  s_nop 0
  v_mfma_f32_16x16x32_bf16 v[224:227], a[208:211], v[200:203], v[224:227]
  s_nop 0
  v_mfma_f32_16x16x32_bf16 v[224:227], a[212:215], v[204:207], v[224:227]
  s_nop 0
  v_mfma_f32_16x16x32_bf16 v[224:227], a[216:219], v[208:211], v[224:227]
  s_nop 0
  v_mfma_f32_16x16x32_bf16 v[224:227], a[220:223], v[212:215], v[224:227]
  s_nop 0
  v_cvt_pk_bf16_f32 v232, v216, v217
  v_cvt_pk_bf16_f32 v233, v218, v219
  v_mfma_f32_16x16x32_bf16 v[228:231], a[224:227], v[184:187], 0
  s_nop 0
  v_cvt_pk_bf16_f32 v234, v220, v221
  v_cvt_pk_bf16_f32 v235, v222, v223
  v_mfma_f32_16x16x32_bf16 v[228:231], a[228:231], v[188:191], v[228:231]
  s_nop 0
  buffer_store_dwordx4 v[232:235], v2, s[40:43], s71 offen offset:2048 sc1
  v_mfma_f32_16x16x32_bf16 v[228:231], a[232:235], v[192:195], v[228:231]
  s_nop 0
  v_mfma_f32_16x16x32_bf16 v[228:231], a[236:239], v[196:199], v[228:231]
  s_nop 0
  v_mfma_f32_16x16x32_bf16 v[228:231], a[240:243], v[200:203], v[228:231]
  s_nop 0
  v_mfma_f32_16x16x32_bf16 v[228:231], a[244:247], v[204:207], v[228:231]
  s_nop 0
  v_mfma_f32_16x16x32_bf16 v[228:231], a[248:251], v[208:211], v[228:231]
  s_nop 0
  v_mfma_f32_16x16x32_bf16 v[228:231], a[252:255], v[212:215], v[228:231]
  s_nop 0
  s_nop 6
  v_cvt_pk_bf16_f32 v236, v224, v225
  v_cvt_pk_bf16_f32 v237, v226, v227
  v_cvt_pk_bf16_f32 v238, v228, v229
  v_cvt_pk_bf16_f32 v239, v230, v231
  buffer_store_dwordx4 v[236:239], v2, s[40:43], s71 offen offset:3072 sc1
  s_cmp_ge_u32 s66, 49152
  s_mov_b32 s60, 49152
  s_cmov_b32 s60, -49152
  s_add_u32 s66, s66, s60
  s_waitcnt vmcnt(0)
  s_bitcmp1_b32 s62, 2
  s_cbranch_scc1 L_b_sig_5
  s_lshr_b32 s58, s62, 2
  s_add_u32 s58, s58, 147456
  v_mov_b32 v3, s58
  s_mov_b64 exec, 1
  ds_add_rtn_u32 v3, v3, v241
  s_lshl_b32 s58, s62, 3
  s_add_u32 s58, s58, 0xd087000
  s_waitcnt lgkmcnt(0)
  v_cmp_eq_u32 vcc, 3, v3
  s_cbranch_vccz L_b_sig_5x
  buffer_atomic_add v241, v7, s[40:43], s58 offen
L_b_sig_5x:
  s_mov_b64 exec, -1
L_b_sig_5:
  s_bitcmp1_b32 s64, 2
  s_cbranch_scc1 L_b_sig_6
  s_lshr_b32 s58, s64, 2
  s_add_u32 s58, s58, 147456
  v_mov_b32 v3, s58
  s_mov_b64 exec, 1
  ds_add_rtn_u32 v3, v3, v241
  s_lshl_b32 s58, s64, 3
  s_add_u32 s58, s58, 0xd087000
  s_waitcnt lgkmcnt(0)
  v_cmp_eq_u32 vcc, 3, v3
  s_cbranch_vccz L_b_sig_6x
  buffer_atomic_add v241, v7, s[40:43], s58 offen
L_b_sig_6x:
  s_mov_b64 exec, -1
L_b_sig_6:
  s_mov_b32 s64, 4
  s_bitcmp1_b32 s63, 2
  s_cbranch_scc0 L_b_chk
  s_barrier
  s_branch L_next
L_b_late:
  s_sleep 2
  s_lshl_b32 s58, s63, 13
  s_add_u32 s58, s58, s69
  buffer_load_dwordx4 v[56:59], v2, s[40:43], s58 offen offset:0 sc1
  buffer_load_dwordx4 v[60:63], v2, s[40:43], s58 offen offset:1024 sc1
  buffer_load_dwordx4 v[64:67], v2, s[40:43], s58 offen offset:2048 sc1
  buffer_load_dwordx4 v[68:71], v2, s[40:43], s58 offen offset:3072 sc1
  s_add_u32 s57, s57, 1
  s_cmp_gt_u32 s57, 1048576
  s_cbranch_scc1 L_exit
  s_waitcnt vmcnt(0)
  s_branch L_b_chk
L_b_ff_1:
  buffer_load_dword v240, v7, s[40:43], s73 offen sc1
  s_add_u32 s57, s57, 1
  s_cmp_gt_u32 s57, 1048576
  s_cbranch_scc1 L_exit
  s_waitcnt vmcnt(0)
  s_branch L_b_ff_1c
L_b_ff_2:
  buffer_load_dword v240, v7, s[40:43], s73 offen sc1
  s_add_u32 s57, s57, 1
  s_cmp_gt_u32 s57, 1048576
  s_cbranch_scc1 L_exit
  s_waitcnt vmcnt(0)
  s_branch L_b_ff_2c
L_b_ff_3:
  buffer_load_dword v240, v7, s[40:43], s73 offen sc1
  s_add_u32 s57, s57, 1
  s_cmp_gt_u32 s57, 1048576
  s_cbranch_scc1 L_exit
  s_waitcnt vmcnt(0)
  s_branch L_b_ff_3c
L_red:
  s_mov_b32 s48, s36
  s_and_b32 s49, s37, 0xffff
  s_mov_b32 s50, 0x200000
  s_mov_b32 s51, 0x20000
  v_lshlrev_b32 v2, 4, v0
  v_mov_b32 v7, 0
  s_mov_b32 s57, 0
  v_and_b32 v3, 4, v1
  v_cmp_ne_u32 vcc, 0, v3
  v_bfe_u32 v3, v1, 4, 6
  v_lshrrev_b32 v4, 3, v3
  s_lshr_b32 s58, vcc_lo, s95
  s_ff1_i32_b32 s58, s58
  s_bfm_b32 s58, s58, s95
  s_cmp_eq_u32 s62, 0
  s_cselect_b32 s59, s58, 0
  v_lshlrev_b32 v4, 7, v4
  v_add_u32 v4, 0xd086000, v4
  v_lshlrev_b32 v3, 7, v3
  v_add_u32 v3, 0xd087000, v3
  v_cmp_gt_u32 vcc, 32, v0
  v_and_b32 v5, 15, v0
  v_lshrrev_b32 v6, 4, v0
  v_cndmask_b32 v3, v3, v4, vcc
  v_cndmask_b32 v4, 16, 32, vcc
  buffer_load_dword v16, v3, s[40:43], 0 offen sc1
  v_lshlrev_b32 v24, 10, v5
  v_lshl_add_u32 v24, v6, 4, v24
  v_bfe_u32 v17, v0, 2, 1
  v_lshlrev_b32 v17, 1, v17
  v_sub_u32 v17, v6, v17
  v_bfe_u32 v18, v0, 3, 1
  v_bfe_u32 v19, v0, 1, 1
  v_lshl_add_u32 v18, v18, 1, v19
  v_lshl_add_u32 v17, v17, 2, v18
  v_and_b32 v18, 1, v0
  v_lshlrev_b32 v18, 4, v18
  v_mov_b32 v19, 0x3f80
  v_lshlrev_b32 v18, v18, v19
  v_cmp_eq_u32 vcc, 0, v17
  s_nop 1
  v_cndmask_b32 v8, 0, v18, vcc
  v_cmp_eq_u32 vcc, 1, v17
  s_nop 1
  v_cndmask_b32 v9, 0, v18, vcc
  v_cmp_eq_u32 vcc, 2, v17
  s_nop 1
  v_cndmask_b32 v10, 0, v18, vcc
  v_cmp_eq_u32 vcc, 3, v17
  s_nop 1
  v_cndmask_b32 v11, 0, v18, vcc
  v_cmp_eq_u32 vcc, 4, v17
  s_nop 1
  v_cndmask_b32 v12, 0, v18, vcc
  v_cmp_eq_u32 vcc, 5, v17
  s_nop 1
  v_cndmask_b32 v13, 0, v18, vcc
  v_cmp_eq_u32 vcc, 6, v17
  s_nop 1
  v_cndmask_b32 v14, 0, v18, vcc
  v_cmp_eq_u32 vcc, 7, v17
  s_nop 1
  v_cndmask_b32 v15, 0, v18, vcc
  v_readlane_b32 s63, v1, s95
L_r_wait:
  s_waitcnt vmcnt(0)
  v_cmp_gt_u32 vcc, v4, v16
  s_nop 0
  s_and_b64 vcc, vcc, s[58:59]
  s_cbranch_scc0 L_r_go
  s_sleep 4
  buffer_load_dword v16, v3, s[40:43], 0 offen sc1
  s_add_u32 s57, s57, 1
  s_cmp_gt_u32 s57, 1048576
  s_cbranch_scc1 L_exit
  s_branch L_r_wait
L_r_go:
  s_bfe_u32 s58, s63, 0x60004
  s_bfe_u32 s59, s63, 0x1000e
  s_lshl1_add_u32 s58, s58, s59
  s_mul_i32 s64, s58, 786432
  s_bfe_u32 s59, s63, 0x2000c
  s_lshl2_add_u32 s59, s59, s44
  s_lshl_b32 s58, s58, 14
  s_lshl_b32 s71, s59, 6
  s_add_u32 s71, s71, s58
  s_lshl_b32 s59, s59, 10
  s_add_u32 s64, s64, s59
  s_add_u32 s64, s64, 0x6000000
  s_bitcmp1_b32 s63, 2
  s_cselect_b32 s64, 0x40000000, s64
  buffer_load_dwordx4 v[64:67], v2, s[40:43], s64 offen sc1
  s_add_u32 s64, s64, 0x4000
  buffer_load_dwordx4 v[68:71], v2, s[40:43], s64 offen sc1
  s_add_u32 s64, s64, 0x4000
  buffer_load_dwordx4 v[72:75], v2, s[40:43], s64 offen sc1
  s_add_u32 s64, s64, 0x4000
  buffer_load_dwordx4 v[76:79], v2, s[40:43], s64 offen sc1
  s_add_u32 s64, s64, 0x4000
  buffer_load_dwordx4 v[80:83], v2, s[40:43], s64 offen sc1
  s_add_u32 s64, s64, 0x4000
  buffer_load_dwordx4 v[84:87], v2, s[40:43], s64 offen sc1
  s_add_u32 s64, s64, 0x4000
  buffer_load_dwordx4 v[88:91], v2, s[40:43], s64 offen sc1
  s_add_u32 s64, s64, 0x4000
  buffer_load_dwordx4 v[92:95], v2, s[40:43], s64 offen sc1
  s_add_u32 s64, s64, 0x4000
  buffer_load_dwordx4 v[96:99], v2, s[40:43], s64 offen sc1
  s_add_u32 s64, s64, 0x4000
  buffer_load_dwordx4 v[100:103], v2, s[40:43], s64 offen sc1
  s_add_u32 s64, s64, 0x4000
  buffer_load_dwordx4 v[104:107], v2, s[40:43], s64 offen sc1
  s_add_u32 s64, s64, 0x4000
  buffer_load_dwordx4 v[108:111], v2, s[40:43], s64 offen sc1
  s_add_u32 s64, s64, 0x4000
  buffer_load_dwordx4 v[112:115], v2, s[40:43], s64 offen sc1
  s_add_u32 s64, s64, 0x4000
  buffer_load_dwordx4 v[116:119], v2, s[40:43], s64 offen sc1
  s_add_u32 s64, s64, 0x4000
  buffer_load_dwordx4 v[120:123], v2, s[40:43], s64 offen sc1
  s_add_u32 s64, s64, 0x4000
L_r_loop:
  s_mov_b32 s61, s63
  s_mov_b32 s65, s71
  s_add_u32 s95, s95, 1
  s_nop 0
  v_readlane_b32 s63, v1, s95
  buffer_load_dwordx4 v[124:127], v2, s[40:43], s64 offen sc1
  s_add_u32 s64, s64, 0x4000
  s_waitcnt vmcnt(15)
  v_mfma_f32_16x16x32_bf16 v[16:19], v[8:11], v[64:67], 0
  v_mfma_f32_16x16x32_bf16 v[20:23], v[12:15], v[64:67], 0
  buffer_load_dwordx4 v[64:67], v2, s[40:43], s64 offen sc1
  s_add_u32 s64, s64, 0x4000
  s_waitcnt vmcnt(15)
  v_mfma_f32_16x16x32_bf16 v[16:19], v[8:11], v[68:71], v[16:19]
  v_mfma_f32_16x16x32_bf16 v[20:23], v[12:15], v[68:71], v[20:23]
  buffer_load_dwordx4 v[68:71], v2, s[40:43], s64 offen sc1
  s_add_u32 s64, s64, 0x4000
  s_waitcnt vmcnt(15)
  v_mfma_f32_16x16x32_bf16 v[16:19], v[8:11], v[72:75], v[16:19]
  v_mfma_f32_16x16x32_bf16 v[20:23], v[12:15], v[72:75], v[20:23]
  buffer_load_dwordx4 v[72:75], v2, s[40:43], s64 offen sc1
  s_add_u32 s64, s64, 0x4000
  s_waitcnt vmcnt(15)
  v_mfma_f32_16x16x32_bf16 v[16:19], v[8:11], v[76:79], v[16:19]
  v_mfma_f32_16x16x32_bf16 v[20:23], v[12:15], v[76:79], v[20:23]
  buffer_load_dwordx4 v[76:79], v2, s[40:43], s64 offen sc1
  s_add_u32 s64, s64, 0x4000
  s_waitcnt vmcnt(15)
  v_mfma_f32_16x16x32_bf16 v[16:19], v[8:11], v[80:83], v[16:19]
  v_mfma_f32_16x16x32_bf16 v[20:23], v[12:15], v[80:83], v[20:23]
  buffer_load_dwordx4 v[80:83], v2, s[40:43], s64 offen sc1
  s_add_u32 s64, s64, 0x4000
  s_waitcnt vmcnt(15)
  v_mfma_f32_16x16x32_bf16 v[16:19], v[8:11], v[84:87], v[16:19]
  v_mfma_f32_16x16x32_bf16 v[20:23], v[12:15], v[84:87], v[20:23]
  buffer_load_dwordx4 v[84:87], v2, s[40:43], s64 offen sc1
  s_add_u32 s64, s64, 0x4000
  s_waitcnt vmcnt(15)
  v_mfma_f32_16x16x32_bf16 v[16:19], v[8:11], v[88:91], v[16:19]
  v_mfma_f32_16x16x32_bf16 v[20:23], v[12:15], v[88:91], v[20:23]
  buffer_load_dwordx4 v[88:91], v2, s[40:43], s64 offen sc1
  s_add_u32 s64, s64, 0x4000
  s_waitcnt vmcnt(15)
  v_mfma_f32_16x16x32_bf16 v[16:19], v[8:11], v[92:95], v[16:19]
  v_mfma_f32_16x16x32_bf16 v[20:23], v[12:15], v[92:95], v[20:23]
  buffer_load_dwordx4 v[92:95], v2, s[40:43], s64 offen sc1
  s_add_u32 s64, s64, 0x4000
  s_waitcnt vmcnt(15)
  v_mfma_f32_16x16x32_bf16 v[16:19], v[8:11], v[96:99], v[16:19]
  v_mfma_f32_16x16x32_bf16 v[20:23], v[12:15], v[96:99], v[20:23]
  buffer_load_dwordx4 v[96:99], v2, s[40:43], s64 offen sc1
  s_add_u32 s64, s64, 0x4000
  s_waitcnt vmcnt(15)
  v_mfma_f32_16x16x32_bf16 v[16:19], v[8:11], v[100:103], v[16:19]
  v_mfma_f32_16x16x32_bf16 v[20:23], v[12:15], v[100:103], v[20:23]
  buffer_load_dwordx4 v[100:103], v2, s[40:43], s64 offen sc1
  s_add_u32 s64, s64, 0x4000
  s_waitcnt vmcnt(15)
  v_mfma_f32_16x16x32_bf16 v[16:19], v[8:11], v[104:107], v[16:19]
  v_mfma_f32_16x16x32_bf16 v[20:23], v[12:15], v[104:107], v[20:23]
  buffer_load_dwordx4 v[104:107], v2, s[40:43], s64 offen sc1
  s_add_u32 s64, s64, 0x4000
  s_waitcnt vmcnt(15)
  v_mfma_f32_16x16x32_bf16 v[16:19], v[8:11], v[108:111], v[16:19]
  v_mfma_f32_16x16x32_bf16 v[20:23], v[12:15], v[108:111], v[20:23]
  buffer_load_dwordx4 v[108:111], v2, s[40:43], s64 offen sc1
  s_add_u32 s64, s64, 0x4000
  s_waitcnt vmcnt(15)
  v_mfma_f32_16x16x32_bf16 v[16:19], v[8:11], v[112:115], v[16:19]
  v_mfma_f32_16x16x32_bf16 v[20:23], v[12:15], v[112:115], v[20:23]
  buffer_load_dwordx4 v[112:115], v2, s[40:43], s64 offen sc1
  s_add_u32 s64, s64, 0x4000
  s_waitcnt vmcnt(15)
  v_mfma_f32_16x16x32_bf16 v[16:19], v[8:11], v[116:119], v[16:19]
  v_mfma_f32_16x16x32_bf16 v[20:23], v[12:15], v[116:119], v[20:23]
  buffer_load_dwordx4 v[116:119], v2, s[40:43], s64 offen sc1
  s_add_u32 s64, s64, 0x4000
  s_waitcnt vmcnt(15)
  v_mfma_f32_16x16x32_bf16 v[16:19], v[8:11], v[120:123], v[16:19]
  v_mfma_f32_16x16x32_bf16 v[20:23], v[12:15], v[120:123], v[20:23]
  buffer_load_dwordx4 v[120:123], v2, s[40:43], s64 offen sc1
  s_add_u32 s64, s64, 0x4000
  s_waitcnt vmcnt(15)
  v_mfma_f32_16x16x32_bf16 v[16:19], v[8:11], v[124:127], v[16:19]
  v_mfma_f32_16x16x32_bf16 v[20:23], v[12:15], v[124:127], v[20:23]
  buffer_load_dwordx4 v[124:127], v2, s[40:43], s64 offen sc1
  s_add_u32 s64, s64, 0x4000
  s_waitcnt vmcnt(15)
  v_mfma_f32_16x16x32_bf16 v[16:19], v[8:11], v[64:67], v[16:19]
  v_mfma_f32_16x16x32_bf16 v[20:23], v[12:15], v[64:67], v[20:23]
  s_cmp_lg_u32 s62, 0
  s_cbranch_scc1 L_r_stage
L_r_stageback:
  buffer_load_dwordx4 v[64:67], v2, s[40:43], s64 offen sc1
  s_add_u32 s64, s64, 0x4000
  s_waitcnt vmcnt(15)
  v_mfma_f32_16x16x32_bf16 v[16:19], v[8:11], v[68:71], v[16:19]
  v_mfma_f32_16x16x32_bf16 v[20:23], v[12:15], v[68:71], v[20:23]
  buffer_load_dwordx4 v[68:71], v2, s[40:43], s64 offen sc1
  s_add_u32 s64, s64, 0x4000
  s_waitcnt vmcnt(15)
  v_mfma_f32_16x16x32_bf16 v[16:19], v[8:11], v[72:75], v[16:19]
  v_mfma_f32_16x16x32_bf16 v[20:23], v[12:15], v[72:75], v[20:23]
  buffer_load_dwordx4 v[72:75], v2, s[40:43], s64 offen sc1
  s_add_u32 s64, s64, 0x4000
  s_waitcnt vmcnt(15)
  v_mfma_f32_16x16x32_bf16 v[16:19], v[8:11], v[76:79], v[16:19]
  v_mfma_f32_16x16x32_bf16 v[20:23], v[12:15], v[76:79], v[20:23]
  buffer_load_dwordx4 v[76:79], v2, s[40:43], s64 offen sc1
  s_add_u32 s64, s64, 0x4000
  s_waitcnt vmcnt(15)
  v_mfma_f32_16x16x32_bf16 v[16:19], v[8:11], v[80:83], v[16:19]
  v_mfma_f32_16x16x32_bf16 v[20:23], v[12:15], v[80:83], v[20:23]
  buffer_load_dwordx4 v[80:83], v2, s[40:43], s64 offen sc1
  s_add_u32 s64, s64, 0x4000
  s_waitcnt vmcnt(15)
  v_mfma_f32_16x16x32_bf16 v[16:19], v[8:11], v[84:87], v[16:19]
  v_mfma_f32_16x16x32_bf16 v[20:23], v[12:15], v[84:87], v[20:23]
  buffer_load_dwordx4 v[84:87], v2, s[40:43], s64 offen sc1
  s_add_u32 s64, s64, 0x4000
  s_waitcnt vmcnt(15)
  v_mfma_f32_16x16x32_bf16 v[16:19], v[8:11], v[88:91], v[16:19]
  v_mfma_f32_16x16x32_bf16 v[20:23], v[12:15], v[88:91], v[20:23]
  buffer_load_dwordx4 v[88:91], v2, s[40:43], s64 offen sc1
  s_add_u32 s64, s64, 0x4000
  s_waitcnt vmcnt(15)
  v_mfma_f32_16x16x32_bf16 v[16:19], v[8:11], v[92:95], v[16:19]
  v_mfma_f32_16x16x32_bf16 v[20:23], v[12:15], v[92:95], v[20:23]
  buffer_load_dwordx4 v[92:95], v2, s[40:43], s64 offen sc1
  s_add_u32 s64, s64, 0x4000
  s_waitcnt vmcnt(15)
  v_mfma_f32_16x16x32_bf16 v[16:19], v[8:11], v[96:99], v[16:19]
  v_mfma_f32_16x16x32_bf16 v[20:23], v[12:15], v[96:99], v[20:23]
  buffer_load_dwordx4 v[96:99], v2, s[40:43], s64 offen sc1
  s_add_u32 s64, s64, 0x4000
  s_waitcnt vmcnt(15)
  v_mfma_f32_16x16x32_bf16 v[16:19], v[8:11], v[100:103], v[16:19]
  v_mfma_f32_16x16x32_bf16 v[20:23], v[12:15], v[100:103], v[20:23]
  buffer_load_dwordx4 v[100:103], v2, s[40:43], s64 offen sc1
  s_add_u32 s64, s64, 0x4000
  s_waitcnt vmcnt(15)
  v_mfma_f32_16x16x32_bf16 v[16:19], v[8:11], v[104:107], v[16:19]
  v_mfma_f32_16x16x32_bf16 v[20:23], v[12:15], v[104:107], v[20:23]
  buffer_load_dwordx4 v[104:107], v2, s[40:43], s64 offen sc1
  s_add_u32 s64, s64, 0x4000
  s_waitcnt vmcnt(15)
  v_mfma_f32_16x16x32_bf16 v[16:19], v[8:11], v[108:111], v[16:19]
  v_mfma_f32_16x16x32_bf16 v[20:23], v[12:15], v[108:111], v[20:23]
  buffer_load_dwordx4 v[108:111], v2, s[40:43], s64 offen sc1
  s_add_u32 s64, s64, 0x4000
  s_waitcnt vmcnt(15)
  v_mfma_f32_16x16x32_bf16 v[16:19], v[8:11], v[112:115], v[16:19]
  v_mfma_f32_16x16x32_bf16 v[20:23], v[12:15], v[112:115], v[20:23]
  buffer_load_dwordx4 v[112:115], v2, s[40:43], s64 offen sc1
  s_add_u32 s64, s64, 0x4000
  s_waitcnt vmcnt(15)
  v_mfma_f32_16x16x32_bf16 v[16:19], v[8:11], v[116:119], v[16:19]
  v_mfma_f32_16x16x32_bf16 v[20:23], v[12:15], v[116:119], v[20:23]
  buffer_load_dwordx4 v[116:119], v2, s[40:43], s64 offen sc1
  s_add_u32 s64, s64, 0x4000
  s_waitcnt vmcnt(15)
  v_mfma_f32_16x16x32_bf16 v[16:19], v[8:11], v[120:123], v[16:19]
  v_mfma_f32_16x16x32_bf16 v[20:23], v[12:15], v[120:123], v[20:23]
  buffer_load_dwordx4 v[120:123], v2, s[40:43], s64 offen sc1
  s_add_u32 s64, s64, 0x4000
  s_waitcnt vmcnt(15)
  v_mfma_f32_16x16x32_bf16 v[16:19], v[8:11], v[124:127], v[16:19]
  v_mfma_f32_16x16x32_bf16 v[20:23], v[12:15], v[124:127], v[20:23]
  buffer_load_dwordx4 v[124:127], v2, s[40:43], s64 offen sc1
  s_add_u32 s64, s64, 0x4000
  s_waitcnt vmcnt(15)
  v_mfma_f32_16x16x32_bf16 v[16:19], v[8:11], v[64:67], v[16:19]
  v_mfma_f32_16x16x32_bf16 v[20:23], v[12:15], v[64:67], v[20:23]
  s_bfe_u32 s58, s63, 0x60004
  s_bfe_u32 s59, s63, 0x1000e
  s_lshl1_add_u32 s58, s58, s59
  s_mul_i32 s64, s58, 786432
  s_bfe_u32 s59, s63, 0x2000c
  s_lshl2_add_u32 s59, s59, s44
  s_lshl_b32 s58, s58, 14
  s_lshl_b32 s71, s59, 6
  s_add_u32 s71, s71, s58
  s_lshl_b32 s59, s59, 10
  s_add_u32 s64, s64, s59
  s_add_u32 s64, s64, 0x6000000
  s_bitcmp1_b32 s63, 2
  s_cselect_b32 s64, 0x40000000, s64
  buffer_load_dwordx4 v[64:67], v2, s[40:43], s64 offen sc1
  s_add_u32 s64, s64, 0x4000
  s_waitcnt vmcnt(15)
  v_mfma_f32_16x16x32_bf16 v[16:19], v[8:11], v[68:71], v[16:19]
  v_mfma_f32_16x16x32_bf16 v[20:23], v[12:15], v[68:71], v[20:23]
  buffer_load_dwordx4 v[68:71], v2, s[40:43], s64 offen sc1
  s_add_u32 s64, s64, 0x4000
  s_waitcnt vmcnt(15)
  v_mfma_f32_16x16x32_bf16 v[16:19], v[8:11], v[72:75], v[16:19]
  v_mfma_f32_16x16x32_bf16 v[20:23], v[12:15], v[72:75], v[20:23]
  buffer_load_dwordx4 v[72:75], v2, s[40:43], s64 offen sc1
  s_add_u32 s64, s64, 0x4000
  s_waitcnt vmcnt(15)
  v_mfma_f32_16x16x32_bf16 v[16:19], v[8:11], v[76:79], v[16:19]
  v_mfma_f32_16x16x32_bf16 v[20:23], v[12:15], v[76:79], v[20:23]
  buffer_load_dwordx4 v[76:79], v2, s[40:43], s64 offen sc1
  s_add_u32 s64, s64, 0x4000
  s_waitcnt vmcnt(15)
  v_mfma_f32_16x16x32_bf16 v[16:19], v[8:11], v[80:83], v[16:19]
  v_mfma_f32_16x16x32_bf16 v[20:23], v[12:15], v[80:83], v[20:23]
  buffer_load_dwordx4 v[80:83], v2, s[40:43], s64 offen sc1
  s_add_u32 s64, s64, 0x4000
  s_waitcnt vmcnt(15)
  v_mfma_f32_16x16x32_bf16 v[16:19], v[8:11], v[84:87], v[16:19]
  v_mfma_f32_16x16x32_bf16 v[20:23], v[12:15], v[84:87], v[20:23]
  buffer_load_dwordx4 v[84:87], v2, s[40:43], s64 offen sc1
  s_add_u32 s64, s64, 0x4000
  s_waitcnt vmcnt(15)
  v_mfma_f32_16x16x32_bf16 v[16:19], v[8:11], v[88:91], v[16:19]
  v_mfma_f32_16x16x32_bf16 v[20:23], v[12:15], v[88:91], v[20:23]
  buffer_load_dwordx4 v[88:91], v2, s[40:43], s64 offen sc1
  s_add_u32 s64, s64, 0x4000
  s_waitcnt vmcnt(15)
  v_mfma_f32_16x16x32_bf16 v[16:19], v[8:11], v[92:95], v[16:19]
  v_mfma_f32_16x16x32_bf16 v[20:23], v[12:15], v[92:95], v[20:23]
  buffer_load_dwordx4 v[92:95], v2, s[40:43], s64 offen sc1
  s_add_u32 s64, s64, 0x4000
  s_waitcnt vmcnt(15)
  v_mfma_f32_16x16x32_bf16 v[16:19], v[8:11], v[96:99], v[16:19]
  v_mfma_f32_16x16x32_bf16 v[20:23], v[12:15], v[96:99], v[20:23]
  buffer_load_dwordx4 v[96:99], v2, s[40:43], s64 offen sc1
  s_add_u32 s64, s64, 0x4000
  s_waitcnt vmcnt(15)
  v_mfma_f32_16x16x32_bf16 v[16:19], v[8:11], v[100:103], v[16:19]
  v_mfma_f32_16x16x32_bf16 v[20:23], v[12:15], v[100:103], v[20:23]
  buffer_load_dwordx4 v[100:103], v2, s[40:43], s64 offen sc1
  s_add_u32 s64, s64, 0x4000
  s_waitcnt vmcnt(15)
  v_mfma_f32_16x16x32_bf16 v[16:19], v[8:11], v[104:107], v[16:19]
  v_mfma_f32_16x16x32_bf16 v[20:23], v[12:15], v[104:107], v[20:23]
  buffer_load_dwordx4 v[104:107], v2, s[40:43], s64 offen sc1
  s_add_u32 s64, s64, 0x4000
  s_waitcnt vmcnt(15)
  v_mfma_f32_16x16x32_bf16 v[16:19], v[8:11], v[108:111], v[16:19]
  v_mfma_f32_16x16x32_bf16 v[20:23], v[12:15], v[108:111], v[20:23]
  buffer_load_dwordx4 v[108:111], v2, s[40:43], s64 offen sc1
  s_add_u32 s64, s64, 0x4000
  s_waitcnt vmcnt(15)
  v_mfma_f32_16x16x32_bf16 v[16:19], v[8:11], v[112:115], v[16:19]
  v_mfma_f32_16x16x32_bf16 v[20:23], v[12:15], v[112:115], v[20:23]
  buffer_load_dwordx4 v[112:115], v2, s[40:43], s64 offen sc1
  s_add_u32 s64, s64, 0x4000
  s_waitcnt vmcnt(15)
  v_mfma_f32_16x16x32_bf16 v[16:19], v[8:11], v[116:119], v[16:19]
  v_mfma_f32_16x16x32_bf16 v[20:23], v[12:15], v[116:119], v[20:23]
  buffer_load_dwordx4 v[116:119], v2, s[40:43], s64 offen sc1
  s_add_u32 s64, s64, 0x4000
  s_waitcnt vmcnt(15)
  v_mfma_f32_16x16x32_bf16 v[16:19], v[8:11], v[120:123], v[16:19]
  v_mfma_f32_16x16x32_bf16 v[20:23], v[12:15], v[120:123], v[20:23]
  buffer_load_dwordx4 v[120:123], v2, s[40:43], s64 offen sc1
  s_add_u32 s64, s64, 0x4000
  s_waitcnt vmcnt(15)
  v_mfma_f32_16x16x32_bf16 v[16:19], v[8:11], v[124:127], v[16:19]
  v_mfma_f32_16x16x32_bf16 v[20:23], v[12:15], v[124:127], v[20:23]
  s_nop 6
  v_cvt_pk_bf16_f32 v32, v16, v17
  v_cvt_pk_bf16_f32 v33, v18, v19
  v_cvt_pk_bf16_f32 v34, v20, v21
  v_cvt_pk_bf16_f32 v35, v22, v23
  buffer_store_dwordx4 v[32:35], v24, s[48:51], s65 offen
  s_bitcmp1_b32 s63, 2
  s_cbranch_scc0 L_r_loop
  s_waitcnt vmcnt(1)
  s_branch L_next
L_r_stage:
  s_bfe_u32 s66, s61, 0x60004
  s_lshl_b32 s66, s66, 7
  s_add_u32 s66, s66, 0xd087000
L_r_st2:
  buffer_load_dword v3, v7, s[40:43], s66 offen sc1
  s_add_u32 s57, s57, 1
  s_cmp_gt_u32 s57, 1048576
  s_cbranch_scc1 L_exit
  s_waitcnt vmcnt(0)
  v_cmp_gt_u32 vcc, 16, v3
  s_cbranch_vccz L_r_stageback
  s_sleep 4
  s_branch L_r_st2
L_feed:
  s_cmp_lt_u32 s57, 4
  s_cselect_b64 s[52:53], s[10:11], s[8:9]
  s_cselect_b64 s[48:49], s[14:15], s[12:13]
  s_cselect_b64 s[4:5], s[16:17], s[24:25]
  s_cselect_b32 s72, 0x21, 0x30
  s_cselect_b32 s67, 16, 32
  s_cselect_b32 s69, 1.0, 0x3e0293ee
  s_cselect_b32 s74, 2, 4
  s_cmp_eq_u32 s57, 6
  s_cselect_b64 s[48:49], s[26:27], s[48:49]
  s_cselect_b64 s[4:5], s[28:29], s[4:5]
  s_cselect_b32 s72, 0x54, s72
  s_cselect_b32 s67, 64, s67
  s_cselect_b32 s80, 4, 0
  s_cselect_b32 s69, 1.0, s69
  s_cselect_b32 s74, 2, s74
  v_readlane_b32 s73, v1, s95
  s_add_u32 s95, s95, 1
  s_and_b32 s53, s53, 0xffff
  s_mov_b32 s54, 0x200000
  s_mov_b32 s55, 0x20000
  s_cmp_lt_u32 s44, 2
  s_cselect_b64 s[48:49], s[48:49], s[4:5]
  s_cselect_b32 s58, 0, 4
  s_lshr_b32 s72, s72, s58
  s_and_b32 s72, s72, 15
  s_and_b32 s49, s49, 0xffff
  s_mov_b32 s50, 0x400000
  s_mov_b32 s51, 0x20000
  v_lshlrev_b32 v2, 4, v0
  v_mov_b32 v6, 0
  v_lshrrev_b32 v3, 3, v0
  v_lshlrev_b32 v20, 13, v3
  v_and_b32 v3, 2, v3
  v_and_b32 v4, 7, v0
  v_xor_b32 v3, v3, v4
  v_lshl_add_u32 v20, v3, 4, v20
  v_xor_b32 v21, 64, v20
  s_lshl_b32 s60, s44, 14
  s_add_u32 s60, s60, 0x18000
  s_and_b32 s59, s44, 1
  s_lshl1_add_u32 s75, s56, s59
  s_lshl_b32 s75, s75, 7
  s_lshl_b32 s58, s57, 2
  s_lshr_b32 s78, 0, s58
  s_and_b32 s78, s78, 15
  s_lshl_b32 s58, s78, 20
  s_or_b32 s75, s75, s58
  s_cmp_lt_u32 s72, 3
  s_cbranch_scc1 L_f_w_7
  s_add_u32 m0, s60, 0
  s_xor_b32 s58, s75, 0
  buffer_load_dwordx4 v20, s[48:51], s58 offen  lds
  s_add_u32 m0, s60, 1024
  s_xor_b32 s58, s75, 65536
  buffer_load_dwordx4 v21, s[48:51], s58 offen  lds
  s_add_u32 m0, s60, 2048
  s_xor_b32 s58, s75, 131072
  buffer_load_dwordx4 v20, s[48:51], s58 offen  lds
  s_add_u32 m0, s60, 3072
  s_xor_b32 s58, s75, 196608
  buffer_load_dwordx4 v21, s[48:51], s58 offen  lds
  s_branch L_f_w_7e
L_f_w_7:
  s_add_u32 m0, s60, 0
  s_xor_b32 s58, s75, 0
  buffer_load_dwordx4 v20, s[48:51], s58 offen nt lds
  s_add_u32 m0, s60, 1024
  s_xor_b32 s58, s75, 65536
  buffer_load_dwordx4 v21, s[48:51], s58 offen nt lds
  s_add_u32 m0, s60, 2048
  s_xor_b32 s58, s75, 131072
  buffer_load_dwordx4 v20, s[48:51], s58 offen nt lds
  s_add_u32 m0, s60, 3072
  s_xor_b32 s58, s75, 196608
  buffer_load_dwordx4 v21, s[48:51], s58 offen nt lds
L_f_w_7e:
  s_cmp_lt_u32 s72, 3
  s_cbranch_scc1 L_f_w_8
  s_add_u32 m0, s60, 4096
  s_xor_b32 s58, s75, 262144
  buffer_load_dwordx4 v20, s[48:51], s58 offen  lds
  s_add_u32 m0, s60, 5120
  s_xor_b32 s58, s75, 327680
  buffer_load_dwordx4 v21, s[48:51], s58 offen  lds
  s_add_u32 m0, s60, 6144
  s_xor_b32 s58, s75, 393216
  buffer_load_dwordx4 v20, s[48:51], s58 offen  lds
  s_add_u32 m0, s60, 7168
  s_xor_b32 s58, s75, 458752
  buffer_load_dwordx4 v21, s[48:51], s58 offen  lds
  s_branch L_f_w_8e
L_f_w_8:
  s_add_u32 m0, s60, 4096
  s_xor_b32 s58, s75, 262144
  buffer_load_dwordx4 v20, s[48:51], s58 offen nt lds
  s_add_u32 m0, s60, 5120
  s_xor_b32 s58, s75, 327680
  buffer_load_dwordx4 v21, s[48:51], s58 offen nt lds
  s_add_u32 m0, s60, 6144
  s_xor_b32 s58, s75, 393216
  buffer_load_dwordx4 v20, s[48:51], s58 offen nt lds
  s_add_u32 m0, s60, 7168
  s_xor_b32 s58, s75, 458752
  buffer_load_dwordx4 v21, s[48:51], s58 offen nt lds
L_f_w_8e:
  s_cmp_lt_u32 s72, 3
  s_cbranch_scc1 L_f_w_9
  s_add_u32 m0, s60, 8192
  s_xor_b32 s58, s75, 524288
  buffer_load_dwordx4 v20, s[48:51], s58 offen  lds
  s_add_u32 m0, s60, 9216
  s_xor_b32 s58, s75, 589824
  buffer_load_dwordx4 v21, s[48:51], s58 offen  lds
  s_add_u32 m0, s60, 10240
  s_xor_b32 s58, s75, 655360
  buffer_load_dwordx4 v20, s[48:51], s58 offen  lds
  s_add_u32 m0, s60, 11264
  s_xor_b32 s58, s75, 720896
  buffer_load_dwordx4 v21, s[48:51], s58 offen  lds
  s_branch L_f_w_9e
L_f_w_9:
  s_add_u32 m0, s60, 8192
  s_xor_b32 s58, s75, 524288
  buffer_load_dwordx4 v20, s[48:51], s58 offen nt lds
  s_add_u32 m0, s60, 9216
  s_xor_b32 s58, s75, 589824
  buffer_load_dwordx4 v21, s[48:51], s58 offen nt lds
  s_add_u32 m0, s60, 10240
  s_xor_b32 s58, s75, 655360
  buffer_load_dwordx4 v20, s[48:51], s58 offen nt lds
  s_add_u32 m0, s60, 11264
  s_xor_b32 s58, s75, 720896
  buffer_load_dwordx4 v21, s[48:51], s58 offen nt lds
L_f_w_9e:
  s_cmp_lt_u32 s72, 3
  s_cbranch_scc1 L_f_w_10
  s_add_u32 m0, s60, 12288
  s_xor_b32 s58, s75, 786432
  buffer_load_dwordx4 v20, s[48:51], s58 offen  lds
  s_add_u32 m0, s60, 13312
  s_xor_b32 s58, s75, 851968
  buffer_load_dwordx4 v21, s[48:51], s58 offen  lds
  s_add_u32 m0, s60, 14336
  s_xor_b32 s58, s75, 917504
  buffer_load_dwordx4 v20, s[48:51], s58 offen  lds
  s_add_u32 m0, s60, 15360
  s_xor_b32 s58, s75, 983040
  buffer_load_dwordx4 v21, s[48:51], s58 offen  lds
  s_branch L_f_w_10e
L_f_w_10:
  s_add_u32 m0, s60, 12288
  s_xor_b32 s58, s75, 786432
  buffer_load_dwordx4 v20, s[48:51], s58 offen nt lds
  s_add_u32 m0, s60, 13312
  s_xor_b32 s58, s75, 851968
  buffer_load_dwordx4 v21, s[48:51], s58 offen nt lds
  s_add_u32 m0, s60, 14336
  s_xor_b32 s58, s75, 917504
  buffer_load_dwordx4 v20, s[48:51], s58 offen nt lds
  s_add_u32 m0, s60, 15360
  s_xor_b32 s58, s75, 983040
  buffer_load_dwordx4 v21, s[48:51], s58 offen nt lds
L_f_w_10e:
  s_mov_b32 s76, 0x40000000
  v_and_b32 v32, 15, v0
  v_mov_b32 v33, 1
  s_lshl2_add_u32 s58, s44, s57
  s_cmp_ge_u32 s58, 4
  s_cbranch_scc1 L_f_nogate
  s_mov_b64 s[4:5], s[8:9]
  s_mov_b64 s[6:7], s[34:35]
  v_lshrrev_b32 v4, 4, v0
  v_lshlrev_b32 v4, 4, v4
  v_lshl_add_u32 v5, v32, 10, v4
  s_lshl2_add_u32 s77, s56, s57
  s_lshl_b32 s58, s77, 14
  v_add_u32 v5, s58, v5
  global_load_dwordx4 v[64:67], v5, s[4:5] offset:0
  global_load_dwordx4 v[128:131], v4, s[6:7] offset:0
  global_load_dwordx4 v[68:71], v5, s[4:5] offset:64
  global_load_dwordx4 v[132:135], v4, s[6:7] offset:64
  global_load_dwordx4 v[72:75], v5, s[4:5] offset:128
  global_load_dwordx4 v[136:139], v4, s[6:7] offset:128
  global_load_dwordx4 v[76:79], v5, s[4:5] offset:192
  global_load_dwordx4 v[140:143], v4, s[6:7] offset:192
  global_load_dwordx4 v[80:83], v5, s[4:5] offset:256
  global_load_dwordx4 v[144:147], v4, s[6:7] offset:256
  global_load_dwordx4 v[84:87], v5, s[4:5] offset:320
  global_load_dwordx4 v[148:151], v4, s[6:7] offset:320
  global_load_dwordx4 v[88:91], v5, s[4:5] offset:384
  global_load_dwordx4 v[152:155], v4, s[6:7] offset:384
  global_load_dwordx4 v[92:95], v5, s[4:5] offset:448
  global_load_dwordx4 v[156:159], v4, s[6:7] offset:448
  global_load_dwordx4 v[96:99], v5, s[4:5] offset:512
  global_load_dwordx4 v[160:163], v4, s[6:7] offset:512
  global_load_dwordx4 v[100:103], v5, s[4:5] offset:576
  global_load_dwordx4 v[164:167], v4, s[6:7] offset:576
  global_load_dwordx4 v[104:107], v5, s[4:5] offset:640
  global_load_dwordx4 v[168:171], v4, s[6:7] offset:640
  global_load_dwordx4 v[108:111], v5, s[4:5] offset:704
  global_load_dwordx4 v[172:175], v4, s[6:7] offset:704
  global_load_dwordx4 v[112:115], v5, s[4:5] offset:768
  global_load_dwordx4 v[176:179], v4, s[6:7] offset:768
  global_load_dwordx4 v[116:119], v5, s[4:5] offset:832
  global_load_dwordx4 v[180:183], v4, s[6:7] offset:832
  global_load_dwordx4 v[120:123], v5, s[4:5] offset:896
  global_load_dwordx4 v[184:187], v4, s[6:7] offset:896
  global_load_dwordx4 v[124:127], v5, s[4:5] offset:960
  global_load_dwordx4 v[188:191], v4, s[6:7] offset:960
  v_lshlrev_b32 v32, 2, v32
  s_lshl_b32 s77, s77, 6
  s_add_u32 s77, s77, 0xd0c0000
  s_lshr_b32 s76, s56, 2
  s_lshl_b32 s76, s76, 7
  s_add_u32 s76, s76, 0xd086400
L_f_nogate:
  v_lshrrev_b32 v3, 4, v0
  v_lshl_add_u32 v24, v3, 10, s60
  v_bfe_u32 v4, v0, 2, 2
  v_lshl_add_u32 v24, v4, 7, v24
  v_bfe_u32 v4, v0, 3, 2
  v_lshl_add_u32 v24, v4, 5, v24
  v_and_b32 v4, 3, v0
  v_lshl_add_u32 v24, v4, 3, v24
  v_and_b32 v4, 15, v0
  v_xor_b32 v3, v3, v4
  v_lshlrev_b32 v3, 4, v3
  v_lshl_add_u32 v16, v4, 10, v3
  s_lshl1_add_u32 s58, s78, s59
  s_lshl_b32 s58, s58, 7
  v_xor_b32 v8, s58, v2
  s_lshl_b32 s62, s72, 24
  s_lshl_b32 s58, s56, 19
  s_add_u32 s62, s62, s58
  s_lshl_b32 s58, s59, 12
  s_add_u32 s62, s62, s58
  s_add_u32 s65, s62, 0x0
  s_mov_b32 s62, 0x40000000
  s_lshl_b32 s58, s57, 2
  s_cmp_eq_u32 s57, 6
  s_cselect_b32 s58, 0x1000, s58
  s_lshl_b32 s64, s56, 7
  s_add_u32 s64, s64, s58
  s_add_u32 s64, s64, 0xd080000
  s_cmp_eq_u32 s44, 0
  s_cselect_b32 s64, s64, 0x40000000
  v_xor_b32 v25, 32, v24
  v_xor_b32 v17, 64, v16
  v_xor_b32 v26, 64, v24
  v_xor_b32 v18, 128, v16
  v_xor_b32 v27, 96, v24
  v_xor_b32 v19, 192, v16
  v_xor_b32 v9, 16, v8
  v_xor_b32 v10, 32, v8
  v_xor_b32 v11, 48, v8
  v_xor_b32 v12, 64, v8
  v_xor_b32 v13, 80, v8
  v_xor_b32 v14, 96, v8
  v_xor_b32 v15, 112, v8
  s_lshl_b32 s66, s44, 13
  s_mov_b32 s71, s66
  s_and_b32 s61, s73, 7
  s_lshl_b32 s61, s61, 18
  s_add_u32 s61, s61, s71
  s_mov_b32 s70, 0
  s_mov_b32 s63, 0
  s_mov_b32 s68, 0
  s_lshl2_add_u32 s79, s56, s44
  s_lshl_b32 s79, s79, 10
  s_add_u32 s79, s79, 0xc020000
  v_mov_b64 v[36:37], -1
  v_mov_b64 v[38:39], -1
  s_waitcnt vmcnt(12)
  ds_read_b64_tr_b16 a[0:1], v24 offset:0
  ds_read_b64_tr_b16 a[2:3], v24 offset:512
  ds_read_b64_tr_b16 a[64:65], v25 offset:0
  ds_read_b64_tr_b16 a[66:67], v25 offset:512
  ds_read_b64_tr_b16 a[128:129], v26 offset:0
  ds_read_b64_tr_b16 a[130:131], v26 offset:512
  ds_read_b64_tr_b16 a[192:193], v27 offset:0
  ds_read_b64_tr_b16 a[194:195], v27 offset:512
  s_waitcnt lgkmcnt(0)
  s_cmp_lt_u32 s72, 3
  s_cbranch_scc1 L_f_w_11
  s_add_u32 m0, s60, 0
  s_xor_b32 s58, s75, 1048576
  buffer_load_dwordx4 v20, s[48:51], s58 offen  lds
  s_add_u32 m0, s60, 1024
  s_xor_b32 s58, s75, 1114112
  buffer_load_dwordx4 v21, s[48:51], s58 offen  lds
  s_add_u32 m0, s60, 2048
  s_xor_b32 s58, s75, 1179648
  buffer_load_dwordx4 v20, s[48:51], s58 offen  lds
  s_add_u32 m0, s60, 3072
  s_xor_b32 s58, s75, 1245184
  buffer_load_dwordx4 v21, s[48:51], s58 offen  lds
  s_branch L_f_w_11e
L_f_w_11:
  s_add_u32 m0, s60, 0
  s_xor_b32 s58, s75, 1048576
  buffer_load_dwordx4 v20, s[48:51], s58 offen nt lds
  s_add_u32 m0, s60, 1024
  s_xor_b32 s58, s75, 1114112
  buffer_load_dwordx4 v21, s[48:51], s58 offen nt lds
  s_add_u32 m0, s60, 2048
  s_xor_b32 s58, s75, 1179648
  buffer_load_dwordx4 v20, s[48:51], s58 offen nt lds
  s_add_u32 m0, s60, 3072
  s_xor_b32 s58, s75, 1245184
  buffer_load_dwordx4 v21, s[48:51], s58 offen nt lds
L_f_w_11e:
  s_waitcnt vmcnt(12)
  ds_read_b64_tr_b16 a[4:5], v24 offset:4096
  ds_read_b64_tr_b16 a[6:7], v24 offset:4608
  ds_read_b64_tr_b16 a[68:69], v25 offset:4096
  ds_read_b64_tr_b16 a[70:71], v25 offset:4608
  ds_read_b64_tr_b16 a[132:133], v26 offset:4096
  ds_read_b64_tr_b16 a[134:135], v26 offset:4608
  ds_read_b64_tr_b16 a[196:197], v27 offset:4096
  ds_read_b64_tr_b16 a[198:199], v27 offset:4608
  s_waitcnt lgkmcnt(0)
  s_cmp_lt_u32 s72, 3
  s_cbranch_scc1 L_f_w_12
  s_add_u32 m0, s60, 4096
  s_xor_b32 s58, s75, 1310720
  buffer_load_dwordx4 v20, s[48:51], s58 offen  lds
  s_add_u32 m0, s60, 5120
  s_xor_b32 s58, s75, 1376256
  buffer_load_dwordx4 v21, s[48:51], s58 offen  lds
  s_add_u32 m0, s60, 6144
  s_xor_b32 s58, s75, 1441792
  buffer_load_dwordx4 v20, s[48:51], s58 offen  lds
  s_add_u32 m0, s60, 7168
  s_xor_b32 s58, s75, 1507328
  buffer_load_dwordx4 v21, s[48:51], s58 offen  lds
  s_branch L_f_w_12e
L_f_w_12:
  s_add_u32 m0, s60, 4096
  s_xor_b32 s58, s75, 1310720
  buffer_load_dwordx4 v20, s[48:51], s58 offen nt lds
  s_add_u32 m0, s60, 5120
  s_xor_b32 s58, s75, 1376256
  buffer_load_dwordx4 v21, s[48:51], s58 offen nt lds
  s_add_u32 m0, s60, 6144
  s_xor_b32 s58, s75, 1441792
  buffer_load_dwordx4 v20, s[48:51], s58 offen nt lds
  s_add_u32 m0, s60, 7168
  s_xor_b32 s58, s75, 1507328
  buffer_load_dwordx4 v21, s[48:51], s58 offen nt lds
L_f_w_12e:
  s_waitcnt vmcnt(12)
  ds_read_b64_tr_b16 a[8:9], v24 offset:8192
  ds_read_b64_tr_b16 a[10:11], v24 offset:8704
  ds_read_b64_tr_b16 a[72:73], v25 offset:8192
  ds_read_b64_tr_b16 a[74:75], v25 offset:8704
  ds_read_b64_tr_b16 a[136:137], v26 offset:8192
  ds_read_b64_tr_b16 a[138:139], v26 offset:8704
  ds_read_b64_tr_b16 a[200:201], v27 offset:8192
  ds_read_b64_tr_b16 a[202:203], v27 offset:8704
  s_waitcnt lgkmcnt(0)
  s_cmp_lt_u32 s72, 3
  s_cbranch_scc1 L_f_w_13
  s_add_u32 m0, s60, 8192
  s_xor_b32 s58, s75, 1572864
  buffer_load_dwordx4 v20, s[48:51], s58 offen  lds
  s_add_u32 m0, s60, 9216
  s_xor_b32 s58, s75, 1638400
  buffer_load_dwordx4 v21, s[48:51], s58 offen  lds
  s_add_u32 m0, s60, 10240
  s_xor_b32 s58, s75, 1703936
  buffer_load_dwordx4 v20, s[48:51], s58 offen  lds
  s_add_u32 m0, s60, 11264
  s_xor_b32 s58, s75, 1769472
  buffer_load_dwordx4 v21, s[48:51], s58 offen  lds
  s_branch L_f_w_13e
L_f_w_13:
  s_add_u32 m0, s60, 8192
  s_xor_b32 s58, s75, 1572864
  buffer_load_dwordx4 v20, s[48:51], s58 offen nt lds
  s_add_u32 m0, s60, 9216
  s_xor_b32 s58, s75, 1638400
  buffer_load_dwordx4 v21, s[48:51], s58 offen nt lds
  s_add_u32 m0, s60, 10240
  s_xor_b32 s58, s75, 1703936
  buffer_load_dwordx4 v20, s[48:51], s58 offen nt lds
  s_add_u32 m0, s60, 11264
  s_xor_b32 s58, s75, 1769472
  buffer_load_dwordx4 v21, s[48:51], s58 offen nt lds
L_f_w_13e:
  s_waitcnt vmcnt(12)
  ds_read_b64_tr_b16 a[12:13], v24 offset:12288
  ds_read_b64_tr_b16 a[14:15], v24 offset:12800
  ds_read_b64_tr_b16 a[76:77], v25 offset:12288
  ds_read_b64_tr_b16 a[78:79], v25 offset:12800
  ds_read_b64_tr_b16 a[140:141], v26 offset:12288
  ds_read_b64_tr_b16 a[142:143], v26 offset:12800
  ds_read_b64_tr_b16 a[204:205], v27 offset:12288
  ds_read_b64_tr_b16 a[206:207], v27 offset:12800
  s_waitcnt lgkmcnt(0)
  s_cmp_lt_u32 s72, 3
  s_cbranch_scc1 L_f_w_14
  s_add_u32 m0, s60, 12288
  s_xor_b32 s58, s75, 1835008
  buffer_load_dwordx4 v20, s[48:51], s58 offen  lds
  s_add_u32 m0, s60, 13312
  s_xor_b32 s58, s75, 1900544
  buffer_load_dwordx4 v21, s[48:51], s58 offen  lds
  s_add_u32 m0, s60, 14336
  s_xor_b32 s58, s75, 1966080
  buffer_load_dwordx4 v20, s[48:51], s58 offen  lds
  s_add_u32 m0, s60, 15360
  s_xor_b32 s58, s75, 2031616
  buffer_load_dwordx4 v21, s[48:51], s58 offen  lds
  s_branch L_f_w_14e
L_f_w_14:
  s_add_u32 m0, s60, 12288
  s_xor_b32 s58, s75, 1835008
  buffer_load_dwordx4 v20, s[48:51], s58 offen nt lds
  s_add_u32 m0, s60, 13312
  s_xor_b32 s58, s75, 1900544
  buffer_load_dwordx4 v21, s[48:51], s58 offen nt lds
  s_add_u32 m0, s60, 14336
  s_xor_b32 s58, s75, 1966080
  buffer_load_dwordx4 v20, s[48:51], s58 offen nt lds
  s_add_u32 m0, s60, 15360
  s_xor_b32 s58, s75, 2031616
  buffer_load_dwordx4 v21, s[48:51], s58 offen nt lds
L_f_w_14e:
  s_waitcnt vmcnt(12)
  ds_read_b64_tr_b16 a[16:17], v24 offset:0
  ds_read_b64_tr_b16 a[18:19], v24 offset:512
  ds_read_b64_tr_b16 a[80:81], v25 offset:0
  ds_read_b64_tr_b16 a[82:83], v25 offset:512
  ds_read_b64_tr_b16 a[144:145], v26 offset:0
  ds_read_b64_tr_b16 a[146:147], v26 offset:512
  ds_read_b64_tr_b16 a[208:209], v27 offset:0
  ds_read_b64_tr_b16 a[210:211], v27 offset:512
  s_waitcnt lgkmcnt(0)
  s_cmp_lt_u32 s72, 3
  s_cbranch_scc1 L_f_w_15
  s_add_u32 m0, s60, 0
  s_xor_b32 s58, s75, 2097152
  buffer_load_dwordx4 v20, s[48:51], s58 offen  lds
  s_add_u32 m0, s60, 1024
  s_xor_b32 s58, s75, 2162688
  buffer_load_dwordx4 v21, s[48:51], s58 offen  lds
  s_add_u32 m0, s60, 2048
  s_xor_b32 s58, s75, 2228224
  buffer_load_dwordx4 v20, s[48:51], s58 offen  lds
  s_add_u32 m0, s60, 3072
  s_xor_b32 s58, s75, 2293760
  buffer_load_dwordx4 v21, s[48:51], s58 offen  lds
  s_branch L_f_w_15e
L_f_w_15:
  s_add_u32 m0, s60, 0
  s_xor_b32 s58, s75, 2097152
  buffer_load_dwordx4 v20, s[48:51], s58 offen nt lds
  s_add_u32 m0, s60, 1024
  s_xor_b32 s58, s75, 2162688
  buffer_load_dwordx4 v21, s[48:51], s58 offen nt lds
  s_add_u32 m0, s60, 2048
  s_xor_b32 s58, s75, 2228224
  buffer_load_dwordx4 v20, s[48:51], s58 offen nt lds
  s_add_u32 m0, s60, 3072
  s_xor_b32 s58, s75, 2293760
  buffer_load_dwordx4 v21, s[48:51], s58 offen nt lds
L_f_w_15e:
  s_waitcnt vmcnt(12)
  ds_read_b64_tr_b16 a[20:21], v24 offset:4096
  ds_read_b64_tr_b16 a[22:23], v24 offset:4608
  ds_read_b64_tr_b16 a[84:85], v25 offset:4096
  ds_read_b64_tr_b16 a[86:87], v25 offset:4608
  ds_read_b64_tr_b16 a[148:149], v26 offset:4096
  ds_read_b64_tr_b16 a[150:151], v26 offset:4608
  ds_read_b64_tr_b16 a[212:213], v27 offset:4096
  ds_read_b64_tr_b16 a[214:215], v27 offset:4608
  s_waitcnt lgkmcnt(0)
  s_cmp_lt_u32 s72, 3
  s_cbranch_scc1 L_f_w_16
  s_add_u32 m0, s60, 4096
  s_xor_b32 s58, s75, 2359296
  buffer_load_dwordx4 v20, s[48:51], s58 offen  lds
  s_add_u32 m0, s60, 5120
  s_xor_b32 s58, s75, 2424832
  buffer_load_dwordx4 v21, s[48:51], s58 offen  lds
  s_add_u32 m0, s60, 6144
  s_xor_b32 s58, s75, 2490368
  buffer_load_dwordx4 v20, s[48:51], s58 offen  lds
  s_add_u32 m0, s60, 7168
  s_xor_b32 s58, s75, 2555904
  buffer_load_dwordx4 v21, s[48:51], s58 offen  lds
  s_branch L_f_w_16e
L_f_w_16:
  s_add_u32 m0, s60, 4096
  s_xor_b32 s58, s75, 2359296
  buffer_load_dwordx4 v20, s[48:51], s58 offen nt lds
  s_add_u32 m0, s60, 5120
  s_xor_b32 s58, s75, 2424832
  buffer_load_dwordx4 v21, s[48:51], s58 offen nt lds
  s_add_u32 m0, s60, 6144
  s_xor_b32 s58, s75, 2490368
  buffer_load_dwordx4 v20, s[48:51], s58 offen nt lds
  s_add_u32 m0, s60, 7168
  s_xor_b32 s58, s75, 2555904
  buffer_load_dwordx4 v21, s[48:51], s58 offen nt lds
L_f_w_16e:
  s_cmp_eq_u32 s76, 0x40000000
  s_cbranch_scc1 L_f_nogate2
  v_mfma_f32_16x16x32_bf16 v[192:195], v[128:131], v[64:67], 0
  v_mfma_f32_16x16x32_bf16 v[192:195], v[132:135], v[68:71], v[192:195]
  v_mfma_f32_16x16x32_bf16 v[192:195], v[136:139], v[72:75], v[192:195]
  v_mfma_f32_16x16x32_bf16 v[192:195], v[140:143], v[76:79], v[192:195]
  v_mfma_f32_16x16x32_bf16 v[192:195], v[144:147], v[80:83], v[192:195]
  v_mfma_f32_16x16x32_bf16 v[192:195], v[148:151], v[84:87], v[192:195]
  v_mfma_f32_16x16x32_bf16 v[192:195], v[152:155], v[88:91], v[192:195]
  v_mfma_f32_16x16x32_bf16 v[192:195], v[156:159], v[92:95], v[192:195]
  v_mfma_f32_16x16x32_bf16 v[192:195], v[160:163], v[96:99], v[192:195]
  v_mfma_f32_16x16x32_bf16 v[192:195], v[164:167], v[100:103], v[192:195]
  v_mfma_f32_16x16x32_bf16 v[192:195], v[168:171], v[104:107], v[192:195]
  v_mfma_f32_16x16x32_bf16 v[192:195], v[172:175], v[108:111], v[192:195]
  v_mfma_f32_16x16x32_bf16 v[192:195], v[176:179], v[112:115], v[192:195]
  v_mfma_f32_16x16x32_bf16 v[192:195], v[180:183], v[116:119], v[192:195]
  v_mfma_f32_16x16x32_bf16 v[192:195], v[184:187], v[120:123], v[192:195]
  v_mfma_f32_16x16x32_bf16 v[192:195], v[188:191], v[124:127], v[192:195]
  s_nop 7
  v_mul_f32 v192, 0xbfb8aa3b, v192
  v_exp_f32 v192, v192
  s_nop 0
  v_add_f32 v192, 1.0, v192
  v_rcp_f32 v192, v192
  s_nop 0
  buffer_store_dword v192, v32, s[40:43], s77 offen sc1
L_f_nogate2:
  s_waitcnt vmcnt(12)
  ds_read_b64_tr_b16 a[24:25], v24 offset:8192
  ds_read_b64_tr_b16 a[26:27], v24 offset:8704
  ds_read_b64_tr_b16 a[88:89], v25 offset:8192
  ds_read_b64_tr_b16 a[90:91], v25 offset:8704
  ds_read_b64_tr_b16 a[152:153], v26 offset:8192
  ds_read_b64_tr_b16 a[154:155], v26 offset:8704
  ds_read_b64_tr_b16 a[216:217], v27 offset:8192
  ds_read_b64_tr_b16 a[218:219], v27 offset:8704
  s_waitcnt lgkmcnt(0)
  s_cmp_lt_u32 s72, 3
  s_cbranch_scc1 L_f_w_17
  s_add_u32 m0, s60, 8192
  s_xor_b32 s58, s75, 2621440
  buffer_load_dwordx4 v20, s[48:51], s58 offen  lds
  s_add_u32 m0, s60, 9216
  s_xor_b32 s58, s75, 2686976
  buffer_load_dwordx4 v21, s[48:51], s58 offen  lds
  s_add_u32 m0, s60, 10240
  s_xor_b32 s58, s75, 2752512
  buffer_load_dwordx4 v20, s[48:51], s58 offen  lds
  s_add_u32 m0, s60, 11264
  s_xor_b32 s58, s75, 2818048
  buffer_load_dwordx4 v21, s[48:51], s58 offen  lds
  s_branch L_f_w_17e
L_f_w_17:
  s_add_u32 m0, s60, 8192
  s_xor_b32 s58, s75, 2621440
  buffer_load_dwordx4 v20, s[48:51], s58 offen nt lds
  s_add_u32 m0, s60, 9216
  s_xor_b32 s58, s75, 2686976
  buffer_load_dwordx4 v21, s[48:51], s58 offen nt lds
  s_add_u32 m0, s60, 10240
  s_xor_b32 s58, s75, 2752512
  buffer_load_dwordx4 v20, s[48:51], s58 offen nt lds
  s_add_u32 m0, s60, 11264
  s_xor_b32 s58, s75, 2818048
  buffer_load_dwordx4 v21, s[48:51], s58 offen nt lds
L_f_w_17e:
  s_waitcnt vmcnt(12)
  ds_read_b64_tr_b16 a[28:29], v24 offset:12288
  ds_read_b64_tr_b16 a[30:31], v24 offset:12800
  ds_read_b64_tr_b16 a[92:93], v25 offset:12288
  ds_read_b64_tr_b16 a[94:95], v25 offset:12800
  ds_read_b64_tr_b16 a[156:157], v26 offset:12288
  ds_read_b64_tr_b16 a[158:159], v26 offset:12800
  ds_read_b64_tr_b16 a[220:221], v27 offset:12288
  ds_read_b64_tr_b16 a[222:223], v27 offset:12800
  s_waitcnt lgkmcnt(0)
  s_cmp_lt_u32 s72, 3
  s_cbranch_scc1 L_f_w_18
  s_add_u32 m0, s60, 12288
  s_xor_b32 s58, s75, 2883584
  buffer_load_dwordx4 v20, s[48:51], s58 offen  lds
  s_add_u32 m0, s60, 13312
  s_xor_b32 s58, s75, 2949120
  buffer_load_dwordx4 v21, s[48:51], s58 offen  lds
  s_add_u32 m0, s60, 14336
  s_xor_b32 s58, s75, 3014656
  buffer_load_dwordx4 v20, s[48:51], s58 offen  lds
  s_add_u32 m0, s60, 15360
  s_xor_b32 s58, s75, 3080192
  buffer_load_dwordx4 v21, s[48:51], s58 offen  lds
  s_branch L_f_w_18e
L_f_w_18:
  s_add_u32 m0, s60, 12288
  s_xor_b32 s58, s75, 2883584
  buffer_load_dwordx4 v20, s[48:51], s58 offen nt lds
  s_add_u32 m0, s60, 13312
  s_xor_b32 s58, s75, 2949120
  buffer_load_dwordx4 v21, s[48:51], s58 offen nt lds
  s_add_u32 m0, s60, 14336
  s_xor_b32 s58, s75, 3014656
  buffer_load_dwordx4 v20, s[48:51], s58 offen nt lds
  s_add_u32 m0, s60, 15360
  s_xor_b32 s58, s75, 3080192
  buffer_load_dwordx4 v21, s[48:51], s58 offen nt lds
L_f_w_18e:
  s_waitcnt vmcnt(12)
  ds_read_b64_tr_b16 a[32:33], v24 offset:0
  ds_read_b64_tr_b16 a[34:35], v24 offset:512
  ds_read_b64_tr_b16 a[96:97], v25 offset:0
  ds_read_b64_tr_b16 a[98:99], v25 offset:512
  ds_read_b64_tr_b16 a[160:161], v26 offset:0
  ds_read_b64_tr_b16 a[162:163], v26 offset:512
  ds_read_b64_tr_b16 a[224:225], v27 offset:0
  ds_read_b64_tr_b16 a[226:227], v27 offset:512
  s_waitcnt lgkmcnt(0)
  s_cmp_lt_u32 s72, 3
  s_cbranch_scc1 L_f_w_19
  s_add_u32 m0, s60, 0
  s_xor_b32 s58, s75, 3145728
  buffer_load_dwordx4 v20, s[48:51], s58 offen  lds
  s_add_u32 m0, s60, 1024
  s_xor_b32 s58, s75, 3211264
  buffer_load_dwordx4 v21, s[48:51], s58 offen  lds
  s_add_u32 m0, s60, 2048
  s_xor_b32 s58, s75, 3276800
  buffer_load_dwordx4 v20, s[48:51], s58 offen  lds
  s_add_u32 m0, s60, 3072
  s_xor_b32 s58, s75, 3342336
  buffer_load_dwordx4 v21, s[48:51], s58 offen  lds
  s_branch L_f_w_19e
L_f_w_19:
  s_add_u32 m0, s60, 0
  s_xor_b32 s58, s75, 3145728
  buffer_load_dwordx4 v20, s[48:51], s58 offen nt lds
  s_add_u32 m0, s60, 1024
  s_xor_b32 s58, s75, 3211264
  buffer_load_dwordx4 v21, s[48:51], s58 offen nt lds
  s_add_u32 m0, s60, 2048
  s_xor_b32 s58, s75, 3276800
  buffer_load_dwordx4 v20, s[48:51], s58 offen nt lds
  s_add_u32 m0, s60, 3072
  s_xor_b32 s58, s75, 3342336
  buffer_load_dwordx4 v21, s[48:51], s58 offen nt lds
L_f_w_19e:
  s_waitcnt vmcnt(12)
  ds_read_b64_tr_b16 a[36:37], v24 offset:4096
  ds_read_b64_tr_b16 a[38:39], v24 offset:4608
  ds_read_b64_tr_b16 a[100:101], v25 offset:4096
  ds_read_b64_tr_b16 a[102:103], v25 offset:4608
  ds_read_b64_tr_b16 a[164:165], v26 offset:4096
  ds_read_b64_tr_b16 a[166:167], v26 offset:4608
  ds_read_b64_tr_b16 a[228:229], v27 offset:4096
  ds_read_b64_tr_b16 a[230:231], v27 offset:4608
  s_waitcnt lgkmcnt(0)
  s_cmp_lt_u32 s72, 3
  s_cbranch_scc1 L_f_w_20
  s_add_u32 m0, s60, 4096
  s_xor_b32 s58, s75, 3407872
  buffer_load_dwordx4 v20, s[48:51], s58 offen  lds
  s_add_u32 m0, s60, 5120
  s_xor_b32 s58, s75, 3473408
  buffer_load_dwordx4 v21, s[48:51], s58 offen  lds
  s_add_u32 m0, s60, 6144
  s_xor_b32 s58, s75, 3538944
  buffer_load_dwordx4 v20, s[48:51], s58 offen  lds
  s_add_u32 m0, s60, 7168
  s_xor_b32 s58, s75, 3604480
  buffer_load_dwordx4 v21, s[48:51], s58 offen  lds
  s_branch L_f_w_20e
L_f_w_20:
  s_add_u32 m0, s60, 4096
  s_xor_b32 s58, s75, 3407872
  buffer_load_dwordx4 v20, s[48:51], s58 offen nt lds
  s_add_u32 m0, s60, 5120
  s_xor_b32 s58, s75, 3473408
  buffer_load_dwordx4 v21, s[48:51], s58 offen nt lds
  s_add_u32 m0, s60, 6144
  s_xor_b32 s58, s75, 3538944
  buffer_load_dwordx4 v20, s[48:51], s58 offen nt lds
  s_add_u32 m0, s60, 7168
  s_xor_b32 s58, s75, 3604480
  buffer_load_dwordx4 v21, s[48:51], s58 offen nt lds
L_f_w_20e:
  s_waitcnt vmcnt(12)
  ds_read_b64_tr_b16 a[40:41], v24 offset:8192
  ds_read_b64_tr_b16 a[42:43], v24 offset:8704
  ds_read_b64_tr_b16 a[104:105], v25 offset:8192
  ds_read_b64_tr_b16 a[106:107], v25 offset:8704
  ds_read_b64_tr_b16 a[168:169], v26 offset:8192
  ds_read_b64_tr_b16 a[170:171], v26 offset:8704
  ds_read_b64_tr_b16 a[232:233], v27 offset:8192
  ds_read_b64_tr_b16 a[234:235], v27 offset:8704
  s_waitcnt lgkmcnt(0)
  s_cmp_lt_u32 s72, 3
  s_cbranch_scc1 L_f_w_21
  s_add_u32 m0, s60, 8192
  s_xor_b32 s58, s75, 3670016
  buffer_load_dwordx4 v20, s[48:51], s58 offen  lds
  s_add_u32 m0, s60, 9216
  s_xor_b32 s58, s75, 3735552
  buffer_load_dwordx4 v21, s[48:51], s58 offen  lds
  s_add_u32 m0, s60, 10240
  s_xor_b32 s58, s75, 3801088
  buffer_load_dwordx4 v20, s[48:51], s58 offen  lds
  s_add_u32 m0, s60, 11264
  s_xor_b32 s58, s75, 3866624
  buffer_load_dwordx4 v21, s[48:51], s58 offen  lds
  s_branch L_f_w_21e
L_f_w_21:
  s_add_u32 m0, s60, 8192
  s_xor_b32 s58, s75, 3670016
  buffer_load_dwordx4 v20, s[48:51], s58 offen nt lds
  s_add_u32 m0, s60, 9216
  s_xor_b32 s58, s75, 3735552
  buffer_load_dwordx4 v21, s[48:51], s58 offen nt lds
  s_add_u32 m0, s60, 10240
  s_xor_b32 s58, s75, 3801088
  buffer_load_dwordx4 v20, s[48:51], s58 offen nt lds
  s_add_u32 m0, s60, 11264
  s_xor_b32 s58, s75, 3866624
  buffer_load_dwordx4 v21, s[48:51], s58 offen nt lds
L_f_w_21e:
  s_waitcnt vmcnt(12)
  ds_read_b64_tr_b16 a[44:45], v24 offset:12288
  ds_read_b64_tr_b16 a[46:47], v24 offset:12800
  ds_read_b64_tr_b16 a[108:109], v25 offset:12288
  ds_read_b64_tr_b16 a[110:111], v25 offset:12800
  ds_read_b64_tr_b16 a[172:173], v26 offset:12288
  ds_read_b64_tr_b16 a[174:175], v26 offset:12800
  ds_read_b64_tr_b16 a[236:237], v27 offset:12288
  ds_read_b64_tr_b16 a[238:239], v27 offset:12800
  s_waitcnt lgkmcnt(0)
  s_cmp_lt_u32 s72, 3
  s_cbranch_scc1 L_f_w_22
  s_add_u32 m0, s60, 12288
  s_xor_b32 s58, s75, 3932160
  buffer_load_dwordx4 v20, s[48:51], s58 offen  lds
  s_add_u32 m0, s60, 13312
  s_xor_b32 s58, s75, 3997696
  buffer_load_dwordx4 v21, s[48:51], s58 offen  lds
  s_add_u32 m0, s60, 14336
  s_xor_b32 s58, s75, 4063232
  buffer_load_dwordx4 v20, s[48:51], s58 offen  lds
  s_add_u32 m0, s60, 15360
  s_xor_b32 s58, s75, 4128768
  buffer_load_dwordx4 v21, s[48:51], s58 offen  lds
  s_branch L_f_w_22e
L_f_w_22:
  s_add_u32 m0, s60, 12288
  s_xor_b32 s58, s75, 3932160
  buffer_load_dwordx4 v20, s[48:51], s58 offen nt lds
  s_add_u32 m0, s60, 13312
  s_xor_b32 s58, s75, 3997696
  buffer_load_dwordx4 v21, s[48:51], s58 offen nt lds
  s_add_u32 m0, s60, 14336
  s_xor_b32 s58, s75, 4063232
  buffer_load_dwordx4 v20, s[48:51], s58 offen nt lds
  s_add_u32 m0, s60, 15360
  s_xor_b32 s58, s75, 4128768
  buffer_load_dwordx4 v21, s[48:51], s58 offen nt lds
L_f_w_22e:
  s_waitcnt vmcnt(12)
  ds_read_b64_tr_b16 a[48:49], v24 offset:0
  ds_read_b64_tr_b16 a[50:51], v24 offset:512
  ds_read_b64_tr_b16 a[112:113], v25 offset:0
  ds_read_b64_tr_b16 a[114:115], v25 offset:512
  ds_read_b64_tr_b16 a[176:177], v26 offset:0
  ds_read_b64_tr_b16 a[178:179], v26 offset:512
  ds_read_b64_tr_b16 a[240:241], v27 offset:0
  ds_read_b64_tr_b16 a[242:243], v27 offset:512
  s_mov_b32 s48, s38
  s_and_b32 s49, s39, 0xffff
  s_mov_b32 s50, 0x100
  s_mov_b32 s51, 0x20000
  buffer_load_dwordx2 v[4:5], v6, s[48:51], 0 offen sc1
  s_add_u32 m0, s66, 0
  s_add_u32 s58, s61, 0
  buffer_load_dwordx4 v8, s[52:55], s58 offen lds
  s_add_u32 m0, s66, 1024
  s_add_u32 s58, s61, 1024
  buffer_load_dwordx4 v9, s[52:55], s58 offen lds
  s_add_u32 m0, s66, 2048
  s_add_u32 s58, s61, 2048
  buffer_load_dwordx4 v10, s[52:55], s58 offen lds
  s_add_u32 m0, s66, 3072
  s_add_u32 s58, s61, 3072
  buffer_load_dwordx4 v11, s[52:55], s58 offen lds
  s_add_u32 m0, s66, 4096
  s_add_u32 s58, s61, 4096
  buffer_load_dwordx4 v12, s[52:55], s58 offen lds
  s_add_u32 m0, s66, 5120
  s_add_u32 s58, s61, 5120
  buffer_load_dwordx4 v13, s[52:55], s58 offen lds
  s_add_u32 m0, s66, 6144
  s_add_u32 s58, s61, 6144
  buffer_load_dwordx4 v14, s[52:55], s58 offen lds
  s_add_u32 m0, s66, 7168
  s_add_u32 s58, s61, 7168
  buffer_load_dwordx4 v15, s[52:55], s58 offen lds
  s_add_u32 s70, s70, 1
  s_lshr_b32 s61, s70, 3
  s_lshl_b32 s61, s61, 2
  s_lshr_b32 s61, s73, s61
  s_and_b32 s61, s61, 7
  s_and_b32 s59, s70, 7
  s_lshl3_add_u32 s61, s61, s59
  s_lshl_b32 s61, s61, 15
  s_add_u32 s61, s61, s71
  s_add_u32 s66, s66, 0x8000
  s_and_b32 s66, s66, 0x1ffff
  s_waitcnt vmcnt(17)
  ds_read_b64_tr_b16 a[52:53], v24 offset:4096
  ds_read_b64_tr_b16 a[54:55], v24 offset:4608
  ds_read_b64_tr_b16 a[116:117], v25 offset:4096
  ds_read_b64_tr_b16 a[118:119], v25 offset:4608
  ds_read_b64_tr_b16 a[180:181], v26 offset:4096
  ds_read_b64_tr_b16 a[182:183], v26 offset:4608
  ds_read_b64_tr_b16 a[244:245], v27 offset:4096
  ds_read_b64_tr_b16 a[246:247], v27 offset:4608
  s_waitcnt vmcnt(13)
  ds_read_b64_tr_b16 a[56:57], v24 offset:8192
  ds_read_b64_tr_b16 a[58:59], v24 offset:8704
  ds_read_b64_tr_b16 a[120:121], v25 offset:8192
  ds_read_b64_tr_b16 a[122:123], v25 offset:8704
  ds_read_b64_tr_b16 a[184:185], v26 offset:8192
  ds_read_b64_tr_b16 a[186:187], v26 offset:8704
  ds_read_b64_tr_b16 a[248:249], v27 offset:8192
  ds_read_b64_tr_b16 a[250:251], v27 offset:8704
  s_waitcnt vmcnt(9)
  ds_read_b64_tr_b16 a[60:61], v24 offset:12288
  ds_read_b64_tr_b16 a[62:63], v24 offset:12800
  ds_read_b64_tr_b16 a[124:125], v25 offset:12288
  ds_read_b64_tr_b16 a[126:127], v25 offset:12800
  ds_read_b64_tr_b16 a[188:189], v26 offset:12288
  ds_read_b64_tr_b16 a[190:191], v26 offset:12800
  ds_read_b64_tr_b16 a[252:253], v27 offset:12288
  ds_read_b64_tr_b16 a[254:255], v27 offset:12800
  s_waitcnt vmcnt(0) lgkmcnt(0)
L_f_init:
  v_sad_u8 v3, v4, 0, 0
  v_sad_u8 v3, v5, 0, v3
  v_cmp_gt_u32 vcc, 32, v3
  s_cbranch_vccz L_f_go
  buffer_load_dwordx2 v[4:5], v6, s[48:51], 0 offen sc1
  s_add_u32 s68, s68, 1
  s_cmp_gt_u32 s68, 1048576
  s_cbranch_scc1 L_exit
  s_waitcnt vmcnt(0)
  s_branch L_f_init
L_f_go:
  s_barrier
  ds_read_b128 v[64:67], v16 offset:0
  ds_read_b128 v[68:71], v16 offset:16384
  ds_read_b128 v[72:75], v17 offset:0
  ds_read_b128 v[76:79], v17 offset:16384
  ds_read_b128 v[80:83], v18 offset:0
  ds_read_b128 v[84:87], v18 offset:16384
  ds_read_b128 v[88:91], v19 offset:0
  ds_read_b128 v[92:95], v19 offset:16384
  s_cmp_lt_u32 s44, s74
  s_waitcnt lgkmcnt(0)
  s_cbranch_scc0 L_f_10f
L_f_00f:
  v_mfma_f32_16x16x32_bf16 v[128:131], a[0:3], v[64:67], 0
  v_mfma_f32_16x16x32_bf16 v[128:131], a[4:7], v[72:75], v[128:131]
  v_mfma_f32_16x16x32_bf16 v[128:131], a[8:11], v[80:83], v[128:131]
  ds_read_b128 v[96:99], v16 offset:256
  v_mfma_f32_16x16x32_bf16 v[128:131], a[12:15], v[88:91], v[128:131]
  s_cmp_lg_u32 s57, 6
  s_cbranch_scc1 L_f_pw_23
  buffer_store_dwordx4 v[36:39], v2, s[40:43], s79 offen sc1
  s_add_u32 s79, s79, 0x20000
L_f_pw_23:
  v_mfma_f32_16x16x32_bf16 v[136:139], a[0:3], v[68:71], 0
  ds_read_b128 v[100:103], v16 offset:16640
  v_mfma_f32_16x16x32_bf16 v[136:139], a[4:7], v[76:79], v[136:139]
  s_add_u32 m0, s66, 0
  s_add_u32 s58, s61, 0
  buffer_load_dwordx4 v8, s[52:55], s58 offen lds
  v_mfma_f32_16x16x32_bf16 v[136:139], a[8:11], v[84:87], v[136:139]
  ds_read_b128 v[104:107], v17 offset:256
  v_mfma_f32_16x16x32_bf16 v[136:139], a[12:15], v[92:95], v[136:139]
  s_add_u32 m0, s66, 1024
  s_add_u32 s58, s61, 1024
  buffer_load_dwordx4 v9, s[52:55], s58 offen lds
  v_mfma_f32_16x16x32_bf16 v[132:135], a[64:67], v[64:67], 0
  ds_read_b128 v[108:111], v17 offset:16640
  v_mfma_f32_16x16x32_bf16 v[132:135], a[68:71], v[72:75], v[132:135]
  s_add_u32 m0, s66, 2048
  s_add_u32 s58, s61, 2048
  buffer_load_dwordx4 v10, s[52:55], s58 offen lds
  v_mfma_f32_16x16x32_bf16 v[132:135], a[72:75], v[80:83], v[132:135]
  ds_read_b128 v[112:115], v18 offset:256
  v_mfma_f32_16x16x32_bf16 v[132:135], a[76:79], v[88:91], v[132:135]
  s_add_u32 m0, s66, 3072
  s_add_u32 s58, s61, 3072
  buffer_load_dwordx4 v11, s[52:55], s58 offen lds
  v_mfma_f32_16x16x32_bf16 v[140:143], a[64:67], v[68:71], 0
  ds_read_b128 v[116:119], v18 offset:16640
  v_mfma_f32_16x16x32_bf16 v[140:143], a[68:71], v[76:79], v[140:143]
  s_add_u32 m0, s66, 4096
  s_add_u32 s58, s61, 4096
  buffer_load_dwordx4 v12, s[52:55], s58 offen lds
  v_mfma_f32_16x16x32_bf16 v[140:143], a[72:75], v[84:87], v[140:143]
  ds_read_b128 v[120:123], v19 offset:256
  v_mfma_f32_16x16x32_bf16 v[140:143], a[76:79], v[92:95], v[140:143]
  s_add_u32 m0, s66, 5120
  s_add_u32 s58, s61, 5120
  buffer_load_dwordx4 v13, s[52:55], s58 offen lds
  v_mfma_f32_16x16x32_bf16 v[144:147], a[128:131], v[64:67], 0
  ds_read_b128 v[124:127], v19 offset:16640
  v_mfma_f32_16x16x32_bf16 v[144:147], a[132:135], v[72:75], v[144:147]
  s_add_u32 m0, s66, 6144
  s_add_u32 s58, s61, 6144
  buffer_load_dwordx4 v14, s[52:55], s58 offen lds
  v_mfma_f32_16x16x32_bf16 v[144:147], a[136:139], v[80:83], v[144:147]
  v_mfma_f32_16x16x32_bf16 v[144:147], a[140:143], v[88:91], v[144:147]
  s_add_u32 m0, s66, 7168
  s_add_u32 s58, s61, 7168
  buffer_load_dwordx4 v15, s[52:55], s58 offen lds
  v_mfma_f32_16x16x32_bf16 v[152:155], a[128:131], v[68:71], 0
  v_mfma_f32_16x16x32_bf16 v[152:155], a[132:135], v[76:79], v[152:155]
  s_add_u32 s70, s70, 1
  s_lshr_b32 s61, s70, 3
  v_mfma_f32_16x16x32_bf16 v[152:155], a[136:139], v[84:87], v[152:155]
  s_lshl_b32 s61, s61, 2
  s_lshr_b32 s61, s73, s61
  v_mfma_f32_16x16x32_bf16 v[152:155], a[140:143], v[92:95], v[152:155]
  s_and_b32 s61, s61, 7
  s_and_b32 s59, s70, 7
  v_mfma_f32_16x16x32_bf16 v[148:151], a[192:195], v[64:67], 0
  s_lshl3_add_u32 s61, s61, s59
  s_lshl_b32 s61, s61, 15
  v_mfma_f32_16x16x32_bf16 v[148:151], a[196:199], v[72:75], v[148:151]
  s_add_u32 s61, s61, s71
  s_add_u32 s66, s66, 0x8000
  v_mfma_f32_16x16x32_bf16 v[148:151], a[200:203], v[80:83], v[148:151]
  s_and_b32 s66, s66, 0x1ffff
  v_mfma_f32_16x16x32_bf16 v[148:151], a[204:207], v[88:91], v[148:151]
  v_mfma_f32_16x16x32_bf16 v[156:159], a[192:195], v[68:71], 0
  s_add_u32 m0, s66, 0
  s_add_u32 s58, s61, 0
  buffer_load_dwordx4 v8, s[52:55], s58 offen lds
  v_mfma_f32_16x16x32_bf16 v[156:159], a[196:199], v[76:79], v[156:159]
  v_mfma_f32_16x16x32_bf16 v[156:159], a[200:203], v[84:87], v[156:159]
  s_add_u32 m0, s66, 1024
  s_add_u32 s58, s61, 1024
  buffer_load_dwordx4 v9, s[52:55], s58 offen lds
  v_mfma_f32_16x16x32_bf16 v[156:159], a[204:207], v[92:95], v[156:159]
  s_waitcnt lgkmcnt(0)
  v_mfma_f32_16x16x32_bf16 v[128:131], a[16:19], v[96:99], v[128:131]
  s_add_u32 m0, s66, 2048
  s_add_u32 s58, s61, 2048
  buffer_load_dwordx4 v10, s[52:55], s58 offen lds
  v_mfma_f32_16x16x32_bf16 v[128:131], a[20:23], v[104:107], v[128:131]
  s_add_u32 m0, s66, 3072
  s_add_u32 s58, s61, 3072
  buffer_load_dwordx4 v11, s[52:55], s58 offen lds
  v_mfma_f32_16x16x32_bf16 v[128:131], a[24:27], v[112:115], v[128:131]
  ds_read_b128 v[64:67], v16 offset:512
  v_mfma_f32_16x16x32_bf16 v[128:131], a[28:31], v[120:123], v[128:131]
  s_add_u32 m0, s66, 4096
  s_add_u32 s58, s61, 4096
  buffer_load_dwordx4 v12, s[52:55], s58 offen lds
  v_mfma_f32_16x16x32_bf16 v[136:139], a[16:19], v[100:103], v[136:139]
  ds_read_b128 v[68:71], v16 offset:16896
  v_mfma_f32_16x16x32_bf16 v[136:139], a[20:23], v[108:111], v[136:139]
  s_add_u32 m0, s66, 5120
  s_add_u32 s58, s61, 5120
  buffer_load_dwordx4 v13, s[52:55], s58 offen lds
  v_mfma_f32_16x16x32_bf16 v[136:139], a[24:27], v[116:119], v[136:139]
  ds_read_b128 v[72:75], v17 offset:512
  v_mfma_f32_16x16x32_bf16 v[136:139], a[28:31], v[124:127], v[136:139]
  s_add_u32 m0, s66, 6144
  s_add_u32 s58, s61, 6144
  buffer_load_dwordx4 v14, s[52:55], s58 offen lds
  v_mfma_f32_16x16x32_bf16 v[132:135], a[80:83], v[96:99], v[132:135]
  ds_read_b128 v[76:79], v17 offset:16896
  v_mfma_f32_16x16x32_bf16 v[132:135], a[84:87], v[104:107], v[132:135]
  s_add_u32 m0, s66, 7168
  s_add_u32 s58, s61, 7168
  buffer_load_dwordx4 v15, s[52:55], s58 offen lds
  v_mfma_f32_16x16x32_bf16 v[132:135], a[88:91], v[112:115], v[132:135]
  ds_read_b128 v[80:83], v18 offset:512
  v_mfma_f32_16x16x32_bf16 v[132:135], a[92:95], v[120:123], v[132:135]
  v_mfma_f32_16x16x32_bf16 v[140:143], a[80:83], v[100:103], v[140:143]
  ds_read_b128 v[84:87], v18 offset:16896
  s_add_u32 s70, s70, 1
  s_lshr_b32 s61, s70, 3
  v_mfma_f32_16x16x32_bf16 v[140:143], a[84:87], v[108:111], v[140:143]
  s_lshl_b32 s61, s61, 2
  s_lshr_b32 s61, s73, s61
  v_mfma_f32_16x16x32_bf16 v[140:143], a[88:91], v[116:119], v[140:143]
  ds_read_b128 v[88:91], v19 offset:512
  s_and_b32 s61, s61, 7
  s_and_b32 s59, s70, 7
  v_mfma_f32_16x16x32_bf16 v[140:143], a[92:95], v[124:127], v[140:143]
  s_lshl3_add_u32 s61, s61, s59
  s_lshl_b32 s61, s61, 15
  v_mfma_f32_16x16x32_bf16 v[144:147], a[144:147], v[96:99], v[144:147]
  ds_read_b128 v[92:95], v19 offset:16896
  s_add_u32 s61, s61, s71
  s_add_u32 s66, s66, 0x8000
  v_mfma_f32_16x16x32_bf16 v[144:147], a[148:151], v[104:107], v[144:147]
  s_and_b32 s66, s66, 0x1ffff
  v_mfma_f32_16x16x32_bf16 v[144:147], a[152:155], v[112:115], v[144:147]
  v_mfma_f32_16x16x32_bf16 v[144:147], a[156:159], v[120:123], v[144:147]
  s_add_u32 m0, s66, 0
  s_add_u32 s58, s61, 0
  v_mfma_f32_16x16x32_bf16 v[152:155], a[144:147], v[100:103], v[152:155]
  v_mfma_f32_16x16x32_bf16 v[152:155], a[148:151], v[108:111], v[152:155]
  buffer_load_dwordx4 v8, s[52:55], s58 offen lds
  v_mfma_f32_16x16x32_bf16 v[152:155], a[152:155], v[116:119], v[152:155]
  v_mfma_f32_16x16x32_bf16 v[152:155], a[156:159], v[124:127], v[152:155]
  s_add_u32 m0, s66, 1024
  s_add_u32 s58, s61, 1024
  v_mfma_f32_16x16x32_bf16 v[148:151], a[208:211], v[96:99], v[148:151]
  v_mfma_f32_16x16x32_bf16 v[148:151], a[212:215], v[104:107], v[148:151]
  buffer_load_dwordx4 v9, s[52:55], s58 offen lds
  v_mfma_f32_16x16x32_bf16 v[148:151], a[216:219], v[112:115], v[148:151]
  v_mfma_f32_16x16x32_bf16 v[148:151], a[220:223], v[120:123], v[148:151]
  s_add_u32 m0, s66, 2048
  s_add_u32 s58, s61, 2048
  v_mfma_f32_16x16x32_bf16 v[156:159], a[208:211], v[100:103], v[156:159]
  v_mfma_f32_16x16x32_bf16 v[156:159], a[212:215], v[108:111], v[156:159]
  buffer_load_dwordx4 v10, s[52:55], s58 offen lds
  v_mfma_f32_16x16x32_bf16 v[156:159], a[216:219], v[116:119], v[156:159]
  v_mfma_f32_16x16x32_bf16 v[156:159], a[220:223], v[124:127], v[156:159]
  s_waitcnt lgkmcnt(0)
  s_add_u32 m0, s66, 3072
  s_add_u32 s58, s61, 3072
  v_mfma_f32_16x16x32_bf16 v[128:131], a[32:35], v[64:67], v[128:131]
  v_mfma_f32_16x16x32_bf16 v[128:131], a[36:39], v[72:75], v[128:131]
  buffer_load_dwordx4 v11, s[52:55], s58 offen lds
  v_mfma_f32_16x16x32_bf16 v[128:131], a[40:43], v[80:83], v[128:131]
  ds_read_b128 v[96:99], v16 offset:768
  v_mfma_f32_16x16x32_bf16 v[128:131], a[44:47], v[88:91], v[128:131]
  s_add_u32 m0, s66, 4096
  s_add_u32 s58, s61, 4096
  v_mfma_f32_16x16x32_bf16 v[136:139], a[32:35], v[68:71], v[136:139]
  ds_read_b128 v[100:103], v16 offset:17152
  v_mfma_f32_16x16x32_bf16 v[136:139], a[36:39], v[76:79], v[136:139]
  buffer_load_dwordx4 v12, s[52:55], s58 offen lds
  v_mfma_f32_16x16x32_bf16 v[136:139], a[40:43], v[84:87], v[136:139]
  ds_read_b128 v[104:107], v17 offset:768
  v_mfma_f32_16x16x32_bf16 v[136:139], a[44:47], v[92:95], v[136:139]
  s_add_u32 m0, s66, 5120
  s_add_u32 s58, s61, 5120
  v_mfma_f32_16x16x32_bf16 v[132:135], a[96:99], v[64:67], v[132:135]
  ds_read_b128 v[108:111], v17 offset:17152
  v_mfma_f32_16x16x32_bf16 v[132:135], a[100:103], v[72:75], v[132:135]
  buffer_load_dwordx4 v13, s[52:55], s58 offen lds
  v_mfma_f32_16x16x32_bf16 v[132:135], a[104:107], v[80:83], v[132:135]
  ds_read_b128 v[112:115], v18 offset:768
  v_mfma_f32_16x16x32_bf16 v[132:135], a[108:111], v[88:91], v[132:135]
  s_add_u32 m0, s66, 6144
  s_add_u32 s58, s61, 6144
  v_mfma_f32_16x16x32_bf16 v[140:143], a[96:99], v[68:71], v[140:143]
  ds_read_b128 v[116:119], v18 offset:17152
  v_mfma_f32_16x16x32_bf16 v[140:143], a[100:103], v[76:79], v[140:143]
  buffer_load_dwordx4 v14, s[52:55], s58 offen lds
  v_mfma_f32_16x16x32_bf16 v[140:143], a[104:107], v[84:87], v[140:143]
  ds_read_b128 v[120:123], v19 offset:768
  v_mfma_f32_16x16x32_bf16 v[140:143], a[108:111], v[92:95], v[140:143]
  s_add_u32 m0, s66, 7168
  s_add_u32 s58, s61, 7168
  v_mfma_f32_16x16x32_bf16 v[144:147], a[160:163], v[64:67], v[144:147]
  ds_read_b128 v[124:127], v19 offset:17152
  v_mfma_f32_16x16x32_bf16 v[144:147], a[164:167], v[72:75], v[144:147]
  buffer_load_dwordx4 v15, s[52:55], s58 offen lds
  v_mfma_f32_16x16x32_bf16 v[144:147], a[168:171], v[80:83], v[144:147]
  v_mfma_f32_16x16x32_bf16 v[144:147], a[172:175], v[88:91], v[144:147]
  v_mfma_f32_16x16x32_bf16 v[152:155], a[160:163], v[68:71], v[152:155]
  v_add_u32 v16, 0x8000, v16
  v_mfma_f32_16x16x32_bf16 v[152:155], a[164:167], v[76:79], v[152:155]
  v_and_b32 v16, 0x1ffff, v16
  v_mfma_f32_16x16x32_bf16 v[152:155], a[168:171], v[84:87], v[152:155]
  v_add_u32 v17, 0x8000, v17
  v_mfma_f32_16x16x32_bf16 v[152:155], a[172:175], v[92:95], v[152:155]
  v_and_b32 v17, 0x1ffff, v17
  v_mfma_f32_16x16x32_bf16 v[148:151], a[224:227], v[64:67], v[148:151]
  v_add_u32 v18, 0x8000, v18
  v_mfma_f32_16x16x32_bf16 v[148:151], a[228:231], v[72:75], v[148:151]
  v_and_b32 v18, 0x1ffff, v18
  v_mfma_f32_16x16x32_bf16 v[148:151], a[232:235], v[80:83], v[148:151]
  v_add_u32 v19, 0x8000, v19
  v_mfma_f32_16x16x32_bf16 v[148:151], a[236:239], v[88:91], v[148:151]
  v_and_b32 v19, 0x1ffff, v19
  v_mfma_f32_16x16x32_bf16 v[156:159], a[224:227], v[68:71], v[156:159]
  s_sub_u32 s59, s63, 1
  s_max_i32 s59, s59, 0
  v_mfma_f32_16x16x32_bf16 v[156:159], a[228:231], v[76:79], v[156:159]
  v_mov_b32 v7, s59
  v_mfma_f32_16x16x32_bf16 v[156:159], a[232:235], v[84:87], v[156:159]
  s_cmp_lt_u32 s63, s80
  v_mfma_f32_16x16x32_bf16 v[156:159], a[236:239], v[92:95], v[156:159]
  s_waitcnt lgkmcnt(0)
  v_mfma_f32_16x16x32_bf16 v[128:131], a[48:51], v[96:99], v[128:131]
  s_waitcnt vmcnt(16)
  v_mfma_f32_16x16x32_bf16 v[128:131], a[52:55], v[104:107], v[128:131]
  s_barrier
  v_mfma_f32_16x16x32_bf16 v[128:131], a[56:59], v[112:115], v[128:131]
  ds_read_b128 v[64:67], v16 offset:0
  v_mfma_f32_16x16x32_bf16 v[128:131], a[60:63], v[120:123], v[128:131]
  buffer_store_dword v7, v6, s[40:43], s64 offen sc1
  v_mfma_f32_16x16x32_bf16 v[136:139], a[48:51], v[100:103], v[136:139]
  s_lshr_b32 s62, s63, 3
  ds_read_b128 v[68:71], v16 offset:16384
  v_mfma_f32_16x16x32_bf16 v[136:139], a[52:55], v[108:111], v[136:139]
  s_lshl_b32 s62, s62, 2
  v_mfma_f32_16x16x32_bf16 v[136:139], a[56:59], v[116:119], v[136:139]
  s_lshr_b32 s62, s73, s62
  ds_read_b128 v[72:75], v17 offset:0
  v_mfma_f32_16x16x32_bf16 v[136:139], a[60:63], v[124:127], v[136:139]
  s_and_b32 s62, s62, 7
  v_mfma_f32_16x16x32_bf16 v[132:135], a[112:115], v[96:99], v[132:135]
  s_and_b32 s59, s63, 7
  ds_read_b128 v[76:79], v17 offset:16384
  v_mfma_f32_16x16x32_bf16 v[132:135], a[116:119], v[104:107], v[132:135]
  s_lshl3_add_u32 s62, s62, s59
  v_mfma_f32_16x16x32_bf16 v[132:135], a[120:123], v[112:115], v[132:135]
  s_lshl_b32 s62, s62, 13
  ds_read_b128 v[80:83], v18 offset:0
  v_mfma_f32_16x16x32_bf16 v[132:135], a[124:127], v[120:123], v[132:135]
  s_add_u32 s62, s62, s65
  v_mfma_f32_16x16x32_bf16 v[140:143], a[112:115], v[100:103], v[140:143]
  s_add_u32 s70, s70, 1
  ds_read_b128 v[84:87], v18 offset:16384
  v_mfma_f32_16x16x32_bf16 v[140:143], a[116:119], v[108:111], v[140:143]
  s_lshr_b32 s61, s70, 3
  v_mfma_f32_16x16x32_bf16 v[140:143], a[120:123], v[116:119], v[140:143]
  s_lshl_b32 s61, s61, 2
  ds_read_b128 v[88:91], v19 offset:0
  v_mfma_f32_16x16x32_bf16 v[140:143], a[124:127], v[124:127], v[140:143]
  s_lshr_b32 s61, s73, s61
  v_mfma_f32_16x16x32_bf16 v[144:147], a[176:179], v[96:99], v[144:147]
  s_and_b32 s61, s61, 7
  ds_read_b128 v[92:95], v19 offset:16384
  v_mfma_f32_16x16x32_bf16 v[144:147], a[180:183], v[104:107], v[144:147]
  s_and_b32 s59, s70, 7
  v_mfma_f32_16x16x32_bf16 v[144:147], a[184:187], v[112:115], v[144:147]
  s_lshl3_add_u32 s61, s61, s59
  v_mfma_f32_16x16x32_bf16 v[144:147], a[188:191], v[120:123], v[144:147]
  s_lshl_b32 s61, s61, 15
  v_mfma_f32_16x16x32_bf16 v[152:155], a[176:179], v[100:103], v[152:155]
  s_add_u32 s61, s61, s71
  v_mfma_f32_16x16x32_bf16 v[152:155], a[180:183], v[108:111], v[152:155]
  s_add_u32 s66, s66, 0x8000
  v_mfma_f32_16x16x32_bf16 v[152:155], a[184:187], v[116:119], v[152:155]
  s_and_b32 s66, s66, 0x1ffff
  v_mfma_f32_16x16x32_bf16 v[152:155], a[188:191], v[124:127], v[152:155]
  v_mfma_f32_16x16x32_bf16 v[148:151], a[240:243], v[96:99], v[148:151]
  s_add_u32 s63, s63, 1
  v_mfma_f32_16x16x32_bf16 v[148:151], a[244:247], v[104:107], v[148:151]
  v_mfma_f32_16x16x32_bf16 v[148:151], a[248:251], v[112:115], v[148:151]
  v_mfma_f32_16x16x32_bf16 v[148:151], a[252:255], v[120:123], v[148:151]
  v_mfma_f32_16x16x32_bf16 v[156:159], a[240:243], v[100:103], v[156:159]
  v_mfma_f32_16x16x32_bf16 v[156:159], a[244:247], v[108:111], v[156:159]
  v_mfma_f32_16x16x32_bf16 v[156:159], a[248:251], v[116:119], v[156:159]
  s_cmp_lt_u32 s63, s67
  v_mfma_f32_16x16x32_bf16 v[156:159], a[252:255], v[124:127], v[156:159]
  s_waitcnt lgkmcnt(0)
  s_branch L_f_01
L_f_10f:
  v_mfma_f32_16x16x32_bf16 v[128:131], v[64:67], a[0:3], 0
  v_mfma_f32_16x16x32_bf16 v[128:131], v[72:75], a[4:7], v[128:131]
  v_mfma_f32_16x16x32_bf16 v[128:131], v[80:83], a[8:11], v[128:131]
  ds_read_b128 v[96:99], v16 offset:256
  v_mfma_f32_16x16x32_bf16 v[128:131], v[88:91], a[12:15], v[128:131]
  s_cmp_lg_u32 s57, 6
  s_cbranch_scc1 L_f_pw_24
  buffer_store_dwordx4 v[36:39], v2, s[40:43], s79 offen sc1
  s_add_u32 s79, s79, 0x20000
L_f_pw_24:
  v_mfma_f32_16x16x32_bf16 v[132:135], v[68:71], a[0:3], 0
  ds_read_b128 v[100:103], v16 offset:16640
  v_mfma_f32_16x16x32_bf16 v[132:135], v[76:79], a[4:7], v[132:135]
  s_add_u32 m0, s66, 0
  s_add_u32 s58, s61, 0
  buffer_load_dwordx4 v8, s[52:55], s58 offen lds
  v_mfma_f32_16x16x32_bf16 v[132:135], v[84:87], a[8:11], v[132:135]
  ds_read_b128 v[104:107], v17 offset:256
  v_mfma_f32_16x16x32_bf16 v[132:135], v[92:95], a[12:15], v[132:135]
  s_add_u32 m0, s66, 1024
  s_add_u32 s58, s61, 1024
  buffer_load_dwordx4 v9, s[52:55], s58 offen lds
  v_mfma_f32_16x16x32_bf16 v[136:139], v[64:67], a[64:67], 0
  ds_read_b128 v[108:111], v17 offset:16640
  v_mfma_f32_16x16x32_bf16 v[136:139], v[72:75], a[68:71], v[136:139]
  s_add_u32 m0, s66, 2048
  s_add_u32 s58, s61, 2048
  buffer_load_dwordx4 v10, s[52:55], s58 offen lds
  v_mfma_f32_16x16x32_bf16 v[136:139], v[80:83], a[72:75], v[136:139]
  ds_read_b128 v[112:115], v18 offset:256
  v_mfma_f32_16x16x32_bf16 v[136:139], v[88:91], a[76:79], v[136:139]
  s_add_u32 m0, s66, 3072
  s_add_u32 s58, s61, 3072
  buffer_load_dwordx4 v11, s[52:55], s58 offen lds
  v_mfma_f32_16x16x32_bf16 v[140:143], v[68:71], a[64:67], 0
  ds_read_b128 v[116:119], v18 offset:16640
  v_mfma_f32_16x16x32_bf16 v[140:143], v[76:79], a[68:71], v[140:143]
  s_add_u32 m0, s66, 4096
  s_add_u32 s58, s61, 4096
  buffer_load_dwordx4 v12, s[52:55], s58 offen lds
  v_mfma_f32_16x16x32_bf16 v[140:143], v[84:87], a[72:75], v[140:143]
  ds_read_b128 v[120:123], v19 offset:256
  v_mfma_f32_16x16x32_bf16 v[140:143], v[92:95], a[76:79], v[140:143]
  s_add_u32 m0, s66, 5120
  s_add_u32 s58, s61, 5120
  buffer_load_dwordx4 v13, s[52:55], s58 offen lds
  v_mfma_f32_16x16x32_bf16 v[144:147], v[64:67], a[128:131], 0
  ds_read_b128 v[124:127], v19 offset:16640
  v_mfma_f32_16x16x32_bf16 v[144:147], v[72:75], a[132:135], v[144:147]
  s_add_u32 m0, s66, 6144
  s_add_u32 s58, s61, 6144
  buffer_load_dwordx4 v14, s[52:55], s58 offen lds
  v_mfma_f32_16x16x32_bf16 v[144:147], v[80:83], a[136:139], v[144:147]
  v_mfma_f32_16x16x32_bf16 v[144:147], v[88:91], a[140:143], v[144:147]
  s_add_u32 m0, s66, 7168
  s_add_u32 s58, s61, 7168
  buffer_load_dwordx4 v15, s[52:55], s58 offen lds
  v_mfma_f32_16x16x32_bf16 v[148:151], v[68:71], a[128:131], 0
  v_mfma_f32_16x16x32_bf16 v[148:151], v[76:79], a[132:135], v[148:151]
  s_add_u32 s70, s70, 1
  s_lshr_b32 s61, s70, 3
  v_mfma_f32_16x16x32_bf16 v[148:151], v[84:87], a[136:139], v[148:151]
  s_lshl_b32 s61, s61, 2
  s_lshr_b32 s61, s73, s61
  v_mfma_f32_16x16x32_bf16 v[148:151], v[92:95], a[140:143], v[148:151]
  s_and_b32 s61, s61, 7
  s_and_b32 s59, s70, 7
  v_mfma_f32_16x16x32_bf16 v[152:155], v[64:67], a[192:195], 0
  s_lshl3_add_u32 s61, s61, s59
  s_lshl_b32 s61, s61, 15
  v_mfma_f32_16x16x32_bf16 v[152:155], v[72:75], a[196:199], v[152:155]
  s_add_u32 s61, s61, s71
  s_add_u32 s66, s66, 0x8000
  v_mfma_f32_16x16x32_bf16 v[152:155], v[80:83], a[200:203], v[152:155]
  s_and_b32 s66, s66, 0x1ffff
  v_mfma_f32_16x16x32_bf16 v[152:155], v[88:91], a[204:207], v[152:155]
  v_mfma_f32_16x16x32_bf16 v[156:159], v[68:71], a[192:195], 0
  s_add_u32 m0, s66, 0
  s_add_u32 s58, s61, 0
  buffer_load_dwordx4 v8, s[52:55], s58 offen lds
  v_mfma_f32_16x16x32_bf16 v[156:159], v[76:79], a[196:199], v[156:159]
  v_mfma_f32_16x16x32_bf16 v[156:159], v[84:87], a[200:203], v[156:159]
  s_add_u32 m0, s66, 1024
  s_add_u32 s58, s61, 1024
  buffer_load_dwordx4 v9, s[52:55], s58 offen lds
  v_mfma_f32_16x16x32_bf16 v[156:159], v[92:95], a[204:207], v[156:159]
  s_waitcnt lgkmcnt(0)
  v_mfma_f32_16x16x32_bf16 v[128:131], v[96:99], a[16:19], v[128:131]
  s_add_u32 m0, s66, 2048
  s_add_u32 s58, s61, 2048
  buffer_load_dwordx4 v10, s[52:55], s58 offen lds
  v_mfma_f32_16x16x32_bf16 v[128:131], v[104:107], a[20:23], v[128:131]
  s_add_u32 m0, s66, 3072
  s_add_u32 s58, s61, 3072
  buffer_load_dwordx4 v11, s[52:55], s58 offen lds
  v_mfma_f32_16x16x32_bf16 v[128:131], v[112:115], a[24:27], v[128:131]
  ds_read_b128 v[64:67], v16 offset:512
  v_mfma_f32_16x16x32_bf16 v[128:131], v[120:123], a[28:31], v[128:131]
  s_add_u32 m0, s66, 4096
  s_add_u32 s58, s61, 4096
  buffer_load_dwordx4 v12, s[52:55], s58 offen lds
  v_mfma_f32_16x16x32_bf16 v[132:135], v[100:103], a[16:19], v[132:135]
  ds_read_b128 v[68:71], v16 offset:16896
  v_mfma_f32_16x16x32_bf16 v[132:135], v[108:111], a[20:23], v[132:135]
  s_add_u32 m0, s66, 5120
  s_add_u32 s58, s61, 5120
  buffer_load_dwordx4 v13, s[52:55], s58 offen lds
  v_mfma_f32_16x16x32_bf16 v[132:135], v[116:119], a[24:27], v[132:135]
  ds_read_b128 v[72:75], v17 offset:512
  v_mfma_f32_16x16x32_bf16 v[132:135], v[124:127], a[28:31], v[132:135]
  s_add_u32 m0, s66, 6144
  s_add_u32 s58, s61, 6144
  buffer_load_dwordx4 v14, s[52:55], s58 offen lds
  v_mfma_f32_16x16x32_bf16 v[136:139], v[96:99], a[80:83], v[136:139]
  ds_read_b128 v[76:79], v17 offset:16896
  v_mfma_f32_16x16x32_bf16 v[136:139], v[104:107], a[84:87], v[136:139]
  s_add_u32 m0, s66, 7168
  s_add_u32 s58, s61, 7168
  buffer_load_dwordx4 v15, s[52:55], s58 offen lds
  v_mfma_f32_16x16x32_bf16 v[136:139], v[112:115], a[88:91], v[136:139]
  ds_read_b128 v[80:83], v18 offset:512
  v_mfma_f32_16x16x32_bf16 v[136:139], v[120:123], a[92:95], v[136:139]
  v_mfma_f32_16x16x32_bf16 v[140:143], v[100:103], a[80:83], v[140:143]
  ds_read_b128 v[84:87], v18 offset:16896
  s_add_u32 s70, s70, 1
  s_lshr_b32 s61, s70, 3
  v_mfma_f32_16x16x32_bf16 v[140:143], v[108:111], a[84:87], v[140:143]
  s_lshl_b32 s61, s61, 2
  s_lshr_b32 s61, s73, s61
  v_mfma_f32_16x16x32_bf16 v[140:143], v[116:119], a[88:91], v[140:143]
  ds_read_b128 v[88:91], v19 offset:512
  s_and_b32 s61, s61, 7
  s_and_b32 s59, s70, 7
  v_mfma_f32_16x16x32_bf16 v[140:143], v[124:127], a[92:95], v[140:143]
  s_lshl3_add_u32 s61, s61, s59
  s_lshl_b32 s61, s61, 15
  v_mfma_f32_16x16x32_bf16 v[144:147], v[96:99], a[144:147], v[144:147]
  ds_read_b128 v[92:95], v19 offset:16896
  s_add_u32 s61, s61, s71
  s_add_u32 s66, s66, 0x8000
  v_mfma_f32_16x16x32_bf16 v[144:147], v[104:107], a[148:151], v[144:147]
  s_and_b32 s66, s66, 0x1ffff
  v_mfma_f32_16x16x32_bf16 v[144:147], v[112:115], a[152:155], v[144:147]
  v_mfma_f32_16x16x32_bf16 v[144:147], v[120:123], a[156:159], v[144:147]
  s_add_u32 m0, s66, 0
  s_add_u32 s58, s61, 0
  v_mfma_f32_16x16x32_bf16 v[148:151], v[100:103], a[144:147], v[148:151]
  v_mfma_f32_16x16x32_bf16 v[148:151], v[108:111], a[148:151], v[148:151]
  buffer_load_dwordx4 v8, s[52:55], s58 offen lds
  v_mfma_f32_16x16x32_bf16 v[148:151], v[116:119], a[152:155], v[148:151]
  v_mfma_f32_16x16x32_bf16 v[148:151], v[124:127], a[156:159], v[148:151]
  s_add_u32 m0, s66, 1024
  s_add_u32 s58, s61, 1024
  v_mfma_f32_16x16x32_bf16 v[152:155], v[96:99], a[208:211], v[152:155]
  v_mfma_f32_16x16x32_bf16 v[152:155], v[104:107], a[212:215], v[152:155]
  buffer_load_dwordx4 v9, s[52:55], s58 offen lds
  v_mfma_f32_16x16x32_bf16 v[152:155], v[112:115], a[216:219], v[152:155]
  v_mfma_f32_16x16x32_bf16 v[152:155], v[120:123], a[220:223], v[152:155]
  s_add_u32 m0, s66, 2048
  s_add_u32 s58, s61, 2048
  v_mfma_f32_16x16x32_bf16 v[156:159], v[100:103], a[208:211], v[156:159]
  v_mfma_f32_16x16x32_bf16 v[156:159], v[108:111], a[212:215], v[156:159]
  buffer_load_dwordx4 v10, s[52:55], s58 offen lds
  v_mfma_f32_16x16x32_bf16 v[156:159], v[116:119], a[216:219], v[156:159]
  v_mfma_f32_16x16x32_bf16 v[156:159], v[124:127], a[220:223], v[156:159]
  s_waitcnt lgkmcnt(0)
  s_add_u32 m0, s66, 3072
  s_add_u32 s58, s61, 3072
  v_mfma_f32_16x16x32_bf16 v[128:131], v[64:67], a[32:35], v[128:131]
  v_mfma_f32_16x16x32_bf16 v[128:131], v[72:75], a[36:39], v[128:131]
  buffer_load_dwordx4 v11, s[52:55], s58 offen lds
  v_mfma_f32_16x16x32_bf16 v[128:131], v[80:83], a[40:43], v[128:131]
  ds_read_b128 v[96:99], v16 offset:768
  v_mfma_f32_16x16x32_bf16 v[128:131], v[88:91], a[44:47], v[128:131]
  s_add_u32 m0, s66, 4096
  s_add_u32 s58, s61, 4096
  v_mfma_f32_16x16x32_bf16 v[132:135], v[68:71], a[32:35], v[132:135]
  ds_read_b128 v[100:103], v16 offset:17152
  v_mfma_f32_16x16x32_bf16 v[132:135], v[76:79], a[36:39], v[132:135]
  buffer_load_dwordx4 v12, s[52:55], s58 offen lds
  v_mfma_f32_16x16x32_bf16 v[132:135], v[84:87], a[40:43], v[132:135]
  ds_read_b128 v[104:107], v17 offset:768
  v_mfma_f32_16x16x32_bf16 v[132:135], v[92:95], a[44:47], v[132:135]
  s_add_u32 m0, s66, 5120
  s_add_u32 s58, s61, 5120
  v_mfma_f32_16x16x32_bf16 v[136:139], v[64:67], a[96:99], v[136:139]
  ds_read_b128 v[108:111], v17 offset:17152
  v_mfma_f32_16x16x32_bf16 v[136:139], v[72:75], a[100:103], v[136:139]
  buffer_load_dwordx4 v13, s[52:55], s58 offen lds
  v_mfma_f32_16x16x32_bf16 v[136:139], v[80:83], a[104:107], v[136:139]
  ds_read_b128 v[112:115], v18 offset:768
  v_mfma_f32_16x16x32_bf16 v[136:139], v[88:91], a[108:111], v[136:139]
  s_add_u32 m0, s66, 6144
  s_add_u32 s58, s61, 6144
  v_mfma_f32_16x16x32_bf16 v[140:143], v[68:71], a[96:99], v[140:143]
  ds_read_b128 v[116:119], v18 offset:17152
  v_mfma_f32_16x16x32_bf16 v[140:143], v[76:79], a[100:103], v[140:143]
  buffer_load_dwordx4 v14, s[52:55], s58 offen lds
  v_mfma_f32_16x16x32_bf16 v[140:143], v[84:87], a[104:107], v[140:143]
  ds_read_b128 v[120:123], v19 offset:768
  v_mfma_f32_16x16x32_bf16 v[140:143], v[92:95], a[108:111], v[140:143]
  s_add_u32 m0, s66, 7168
  s_add_u32 s58, s61, 7168
  v_mfma_f32_16x16x32_bf16 v[144:147], v[64:67], a[160:163], v[144:147]
  ds_read_b128 v[124:127], v19 offset:17152
  v_mfma_f32_16x16x32_bf16 v[144:147], v[72:75], a[164:167], v[144:147]
  buffer_load_dwordx4 v15, s[52:55], s58 offen lds
  v_mfma_f32_16x16x32_bf16 v[144:147], v[80:83], a[168:171], v[144:147]
  v_mfma_f32_16x16x32_bf16 v[144:147], v[88:91], a[172:175], v[144:147]
  v_mfma_f32_16x16x32_bf16 v[148:151], v[68:71], a[160:163], v[148:151]
  v_add_u32 v16, 0x8000, v16
  v_mfma_f32_16x16x32_bf16 v[148:151], v[76:79], a[164:167], v[148:151]
  v_and_b32 v16, 0x1ffff, v16
  v_mfma_f32_16x16x32_bf16 v[148:151], v[84:87], a[168:171], v[148:151]
  v_add_u32 v17, 0x8000, v17
  v_mfma_f32_16x16x32_bf16 v[148:151], v[92:95], a[172:175], v[148:151]
  v_and_b32 v17, 0x1ffff, v17
  v_mfma_f32_16x16x32_bf16 v[152:155], v[64:67], a[224:227], v[152:155]
  v_add_u32 v18, 0x8000, v18
  v_mfma_f32_16x16x32_bf16 v[152:155], v[72:75], a[228:231], v[152:155]
  v_and_b32 v18, 0x1ffff, v18
  v_mfma_f32_16x16x32_bf16 v[152:155], v[80:83], a[232:235], v[152:155]
  v_add_u32 v19, 0x8000, v19
  v_mfma_f32_16x16x32_bf16 v[152:155], v[88:91], a[236:239], v[152:155]
  v_and_b32 v19, 0x1ffff, v19
  v_mfma_f32_16x16x32_bf16 v[156:159], v[68:71], a[224:227], v[156:159]
  s_sub_u32 s59, s63, 1
  s_max_i32 s59, s59, 0
  v_mfma_f32_16x16x32_bf16 v[156:159], v[76:79], a[228:231], v[156:159]
  v_mov_b32 v7, s59
  v_mfma_f32_16x16x32_bf16 v[156:159], v[84:87], a[232:235], v[156:159]
  s_cmp_lt_u32 s63, s80
  v_mfma_f32_16x16x32_bf16 v[156:159], v[92:95], a[236:239], v[156:159]
  s_waitcnt lgkmcnt(0)
  v_mfma_f32_16x16x32_bf16 v[128:131], v[96:99], a[48:51], v[128:131]
  s_waitcnt vmcnt(16)
  v_mfma_f32_16x16x32_bf16 v[128:131], v[104:107], a[52:55], v[128:131]
  s_barrier
  v_mfma_f32_16x16x32_bf16 v[128:131], v[112:115], a[56:59], v[128:131]
  ds_read_b128 v[64:67], v16 offset:0
  v_mfma_f32_16x16x32_bf16 v[128:131], v[120:123], a[60:63], v[128:131]
  buffer_store_dword v7, v6, s[40:43], s64 offen sc1
  v_mfma_f32_16x16x32_bf16 v[132:135], v[100:103], a[48:51], v[132:135]
  s_lshr_b32 s62, s63, 3
  ds_read_b128 v[68:71], v16 offset:16384
  v_mfma_f32_16x16x32_bf16 v[132:135], v[108:111], a[52:55], v[132:135]
  s_lshl_b32 s62, s62, 2
  v_mfma_f32_16x16x32_bf16 v[132:135], v[116:119], a[56:59], v[132:135]
  s_lshr_b32 s62, s73, s62
  ds_read_b128 v[72:75], v17 offset:0
  v_mfma_f32_16x16x32_bf16 v[132:135], v[124:127], a[60:63], v[132:135]
  s_and_b32 s62, s62, 7
  v_mfma_f32_16x16x32_bf16 v[136:139], v[96:99], a[112:115], v[136:139]
  s_and_b32 s59, s63, 7
  ds_read_b128 v[76:79], v17 offset:16384
  v_mfma_f32_16x16x32_bf16 v[136:139], v[104:107], a[116:119], v[136:139]
  s_lshl3_add_u32 s62, s62, s59
  v_mfma_f32_16x16x32_bf16 v[136:139], v[112:115], a[120:123], v[136:139]
  s_lshl_b32 s62, s62, 13
  ds_read_b128 v[80:83], v18 offset:0
  v_mfma_f32_16x16x32_bf16 v[136:139], v[120:123], a[124:127], v[136:139]
  s_add_u32 s62, s62, s65
  v_mfma_f32_16x16x32_bf16 v[140:143], v[100:103], a[112:115], v[140:143]
  s_add_u32 s70, s70, 1
  ds_read_b128 v[84:87], v18 offset:16384
  v_mfma_f32_16x16x32_bf16 v[140:143], v[108:111], a[116:119], v[140:143]
  s_lshr_b32 s61, s70, 3
  v_mfma_f32_16x16x32_bf16 v[140:143], v[116:119], a[120:123], v[140:143]
  s_lshl_b32 s61, s61, 2
  ds_read_b128 v[88:91], v19 offset:0
  v_mfma_f32_16x16x32_bf16 v[140:143], v[124:127], a[124:127], v[140:143]
  s_lshr_b32 s61, s73, s61
  v_mfma_f32_16x16x32_bf16 v[144:147], v[96:99], a[176:179], v[144:147]
  s_and_b32 s61, s61, 7
  ds_read_b128 v[92:95], v19 offset:16384
  v_mfma_f32_16x16x32_bf16 v[144:147], v[104:107], a[180:183], v[144:147]
  s_and_b32 s59, s70, 7
  v_mfma_f32_16x16x32_bf16 v[144:147], v[112:115], a[184:187], v[144:147]
  s_lshl3_add_u32 s61, s61, s59
  v_mfma_f32_16x16x32_bf16 v[144:147], v[120:123], a[188:191], v[144:147]
  s_lshl_b32 s61, s61, 15
  v_mfma_f32_16x16x32_bf16 v[148:151], v[100:103], a[176:179], v[148:151]
  s_add_u32 s61, s61, s71
  v_mfma_f32_16x16x32_bf16 v[148:151], v[108:111], a[180:183], v[148:151]
  s_add_u32 s66, s66, 0x8000
  v_mfma_f32_16x16x32_bf16 v[148:151], v[116:119], a[184:187], v[148:151]
  s_and_b32 s66, s66, 0x1ffff
  v_mfma_f32_16x16x32_bf16 v[148:151], v[124:127], a[188:191], v[148:151]
  v_mfma_f32_16x16x32_bf16 v[152:155], v[96:99], a[240:243], v[152:155]
  s_add_u32 s63, s63, 1
  v_mfma_f32_16x16x32_bf16 v[152:155], v[104:107], a[244:247], v[152:155]
  v_mfma_f32_16x16x32_bf16 v[152:155], v[112:115], a[248:251], v[152:155]
  v_mfma_f32_16x16x32_bf16 v[152:155], v[120:123], a[252:255], v[152:155]
  v_mfma_f32_16x16x32_bf16 v[156:159], v[100:103], a[240:243], v[156:159]
  v_mfma_f32_16x16x32_bf16 v[156:159], v[108:111], a[244:247], v[156:159]
  v_mfma_f32_16x16x32_bf16 v[156:159], v[116:119], a[248:251], v[156:159]
  s_cmp_lt_u32 s63, s67
  v_mfma_f32_16x16x32_bf16 v[156:159], v[124:127], a[252:255], v[156:159]
  s_waitcnt lgkmcnt(0)
  s_branch L_f_11
L_f_00:
  v_mfma_f32_16x16x32_bf16 v[128:131], a[0:3], v[64:67], 0
  v_mfma_f32_16x16x32_bf16 v[128:131], a[4:7], v[72:75], v[128:131]
  v_mfma_f32_16x16x32_bf16 v[128:131], a[8:11], v[80:83], v[128:131]
  ds_read_b128 v[96:99], v16 offset:256
  v_mfma_f32_16x16x32_bf16 v[128:131], a[12:15], v[88:91], v[128:131]
  s_cmp_lg_u32 s57, 6
  s_cbranch_scc1 L_f_pw_26
  buffer_store_dwordx4 v[36:39], v2, s[40:43], s79 offen sc1
  s_add_u32 s79, s79, 0x20000
L_f_pw_26:
  v_mfma_f32_16x16x32_bf16 v[136:139], a[0:3], v[68:71], 0
  ds_read_b128 v[100:103], v16 offset:16640
  v_mfma_f32_16x16x32_bf16 v[136:139], a[4:7], v[76:79], v[136:139]
  v_mfma_f32_16x16x32_bf16 v[136:139], a[8:11], v[84:87], v[136:139]
  ds_read_b128 v[104:107], v17 offset:256
  v_mfma_f32_16x16x32_bf16 v[136:139], a[12:15], v[92:95], v[136:139]
  v_mfma_f32_16x16x32_bf16 v[132:135], a[64:67], v[64:67], 0
  ds_read_b128 v[108:111], v17 offset:16640
  v_mfma_f32_16x16x32_bf16 v[132:135], a[68:71], v[72:75], v[132:135]
  v_mul_f32 v160, s69, v160
  v_mul_f32 v161, s69, v161
  v_mfma_f32_16x16x32_bf16 v[132:135], a[72:75], v[80:83], v[132:135]
  ds_read_b128 v[112:115], v18 offset:256
  v_mul_f32 v162, s69, v162
  v_mfma_f32_16x16x32_bf16 v[132:135], a[76:79], v[88:91], v[132:135]
  v_mul_f32 v163, s69, v163
  v_mul_f32 v164, s69, v164
  v_mfma_f32_16x16x32_bf16 v[140:143], a[64:67], v[68:71], 0
  ds_read_b128 v[116:119], v18 offset:16640
  v_mul_f32 v165, s69, v165
  v_mfma_f32_16x16x32_bf16 v[140:143], a[68:71], v[76:79], v[140:143]
  v_mul_f32 v166, s69, v166
  v_mul_f32 v167, s69, v167
  v_mfma_f32_16x16x32_bf16 v[140:143], a[72:75], v[84:87], v[140:143]
  ds_read_b128 v[120:123], v19 offset:256
  v_cvt_pk_bf16_f32 v192, v160, v161
  v_mfma_f32_16x16x32_bf16 v[140:143], a[76:79], v[92:95], v[140:143]
  v_cvt_pk_bf16_f32 v193, v162, v163
  v_cvt_pk_bf16_f32 v194, v164, v165
  v_mfma_f32_16x16x32_bf16 v[144:147], a[128:131], v[64:67], 0
  ds_read_b128 v[124:127], v19 offset:16640
  v_cvt_pk_bf16_f32 v195, v166, v167
  v_mfma_f32_16x16x32_bf16 v[144:147], a[132:135], v[72:75], v[144:147]
  buffer_store_dwordx4 v[192:195], v2, s[40:43], s62 offen offset:0 sc1
  v_mfma_f32_16x16x32_bf16 v[144:147], a[136:139], v[80:83], v[144:147]
  v_mul_f32 v168, s69, v168
  v_mul_f32 v169, s69, v169
  v_mfma_f32_16x16x32_bf16 v[144:147], a[140:143], v[88:91], v[144:147]
  v_mul_f32 v170, s69, v170
  v_mul_f32 v171, s69, v171
  v_mfma_f32_16x16x32_bf16 v[152:155], a[128:131], v[68:71], 0
  v_mul_f32 v172, s69, v172
  v_mul_f32 v173, s69, v173
  v_mfma_f32_16x16x32_bf16 v[152:155], a[132:135], v[76:79], v[152:155]
  v_mul_f32 v174, s69, v174
  v_mul_f32 v175, s69, v175
  v_mfma_f32_16x16x32_bf16 v[152:155], a[136:139], v[84:87], v[152:155]
  v_cvt_pk_bf16_f32 v196, v168, v169
  v_cvt_pk_bf16_f32 v197, v170, v171
  v_mfma_f32_16x16x32_bf16 v[152:155], a[140:143], v[92:95], v[152:155]
  v_cvt_pk_bf16_f32 v198, v172, v173
  v_cvt_pk_bf16_f32 v199, v174, v175
  v_mfma_f32_16x16x32_bf16 v[148:151], a[192:195], v[64:67], 0
  buffer_store_dwordx4 v[196:199], v2, s[40:43], s62 offen offset:1024 sc1
  v_mfma_f32_16x16x32_bf16 v[148:151], a[196:199], v[72:75], v[148:151]
  v_mul_f32 v176, s69, v176
  v_mul_f32 v177, s69, v177
  v_mfma_f32_16x16x32_bf16 v[148:151], a[200:203], v[80:83], v[148:151]
  v_mul_f32 v178, s69, v178
  v_mul_f32 v179, s69, v179
  v_mfma_f32_16x16x32_bf16 v[148:151], a[204:207], v[88:91], v[148:151]
  v_mul_f32 v180, s69, v180
  v_mul_f32 v181, s69, v181
  v_mfma_f32_16x16x32_bf16 v[156:159], a[192:195], v[68:71], 0
  v_mul_f32 v182, s69, v182
  v_mul_f32 v183, s69, v183
  v_mfma_f32_16x16x32_bf16 v[156:159], a[196:199], v[76:79], v[156:159]
  v_cvt_pk_bf16_f32 v200, v176, v177
  v_cvt_pk_bf16_f32 v201, v178, v179
  v_mfma_f32_16x16x32_bf16 v[156:159], a[200:203], v[84:87], v[156:159]
  v_cvt_pk_bf16_f32 v202, v180, v181
  v_cvt_pk_bf16_f32 v203, v182, v183
  v_mfma_f32_16x16x32_bf16 v[156:159], a[204:207], v[92:95], v[156:159]
  s_waitcnt lgkmcnt(0)
  buffer_store_dwordx4 v[200:203], v2, s[40:43], s62 offen offset:2048 sc1
  v_mfma_f32_16x16x32_bf16 v[128:131], a[16:19], v[96:99], v[128:131]
  v_mul_f32 v184, s69, v184
  v_mul_f32 v185, s69, v185
  v_mfma_f32_16x16x32_bf16 v[128:131], a[20:23], v[104:107], v[128:131]
  v_mul_f32 v186, s69, v186
  v_mul_f32 v187, s69, v187
  v_mfma_f32_16x16x32_bf16 v[128:131], a[24:27], v[112:115], v[128:131]
  ds_read_b128 v[64:67], v16 offset:512
  v_mul_f32 v188, s69, v188
  v_mfma_f32_16x16x32_bf16 v[128:131], a[28:31], v[120:123], v[128:131]
  v_mul_f32 v189, s69, v189
  v_mul_f32 v190, s69, v190
  v_mfma_f32_16x16x32_bf16 v[136:139], a[16:19], v[100:103], v[136:139]
  ds_read_b128 v[68:71], v16 offset:16896
  v_mul_f32 v191, s69, v191
  v_mfma_f32_16x16x32_bf16 v[136:139], a[20:23], v[108:111], v[136:139]
  v_cvt_pk_bf16_f32 v204, v184, v185
  v_cvt_pk_bf16_f32 v205, v186, v187
  v_mfma_f32_16x16x32_bf16 v[136:139], a[24:27], v[116:119], v[136:139]
  ds_read_b128 v[72:75], v17 offset:512
  v_cvt_pk_bf16_f32 v206, v188, v189
  v_mfma_f32_16x16x32_bf16 v[136:139], a[28:31], v[124:127], v[136:139]
  v_cvt_pk_bf16_f32 v207, v190, v191
  v_mfma_f32_16x16x32_bf16 v[132:135], a[80:83], v[96:99], v[132:135]
  ds_read_b128 v[76:79], v17 offset:16896
  v_mfma_f32_16x16x32_bf16 v[132:135], a[84:87], v[104:107], v[132:135]
  buffer_store_dwordx4 v[204:207], v2, s[40:43], s62 offen offset:3072 sc1
  v_mfma_f32_16x16x32_bf16 v[132:135], a[88:91], v[112:115], v[132:135]
  ds_read_b128 v[80:83], v18 offset:512
  v_mfma_f32_16x16x32_bf16 v[132:135], a[92:95], v[120:123], v[132:135]
  v_mfma_f32_16x16x32_bf16 v[140:143], a[80:83], v[100:103], v[140:143]
  ds_read_b128 v[84:87], v18 offset:16896
  v_mfma_f32_16x16x32_bf16 v[140:143], a[84:87], v[108:111], v[140:143]
  v_mfma_f32_16x16x32_bf16 v[140:143], a[88:91], v[116:119], v[140:143]
  ds_read_b128 v[88:91], v19 offset:512
  v_mfma_f32_16x16x32_bf16 v[140:143], a[92:95], v[124:127], v[140:143]
  v_mfma_f32_16x16x32_bf16 v[144:147], a[144:147], v[96:99], v[144:147]
  ds_read_b128 v[92:95], v19 offset:16896
  v_mfma_f32_16x16x32_bf16 v[144:147], a[148:151], v[104:107], v[144:147]
  v_mfma_f32_16x16x32_bf16 v[144:147], a[152:155], v[112:115], v[144:147]
  v_mfma_f32_16x16x32_bf16 v[144:147], a[156:159], v[120:123], v[144:147]
  s_add_u32 m0, s66, 0
  s_add_u32 s58, s61, 0
  v_mfma_f32_16x16x32_bf16 v[152:155], a[144:147], v[100:103], v[152:155]
  v_mfma_f32_16x16x32_bf16 v[152:155], a[148:151], v[108:111], v[152:155]
  buffer_load_dwordx4 v8, s[52:55], s58 offen lds
  v_mfma_f32_16x16x32_bf16 v[152:155], a[152:155], v[116:119], v[152:155]
  v_mfma_f32_16x16x32_bf16 v[152:155], a[156:159], v[124:127], v[152:155]
  s_add_u32 m0, s66, 1024
  s_add_u32 s58, s61, 1024
  v_mfma_f32_16x16x32_bf16 v[148:151], a[208:211], v[96:99], v[148:151]
  v_mfma_f32_16x16x32_bf16 v[148:151], a[212:215], v[104:107], v[148:151]
  buffer_load_dwordx4 v9, s[52:55], s58 offen lds
  v_mfma_f32_16x16x32_bf16 v[148:151], a[216:219], v[112:115], v[148:151]
  v_mfma_f32_16x16x32_bf16 v[148:151], a[220:223], v[120:123], v[148:151]
  s_add_u32 m0, s66, 2048
  s_add_u32 s58, s61, 2048
  v_mfma_f32_16x16x32_bf16 v[156:159], a[208:211], v[100:103], v[156:159]
  v_mfma_f32_16x16x32_bf16 v[156:159], a[212:215], v[108:111], v[156:159]
  buffer_load_dwordx4 v10, s[52:55], s58 offen lds
  v_mfma_f32_16x16x32_bf16 v[156:159], a[216:219], v[116:119], v[156:159]
  v_mfma_f32_16x16x32_bf16 v[156:159], a[220:223], v[124:127], v[156:159]
  s_waitcnt lgkmcnt(0)
  s_add_u32 m0, s66, 3072
  s_add_u32 s58, s61, 3072
  v_mfma_f32_16x16x32_bf16 v[128:131], a[32:35], v[64:67], v[128:131]
  v_mfma_f32_16x16x32_bf16 v[128:131], a[36:39], v[72:75], v[128:131]
  buffer_load_dwordx4 v11, s[52:55], s58 offen lds
  v_mfma_f32_16x16x32_bf16 v[128:131], a[40:43], v[80:83], v[128:131]
  ds_read_b128 v[96:99], v16 offset:768
  v_mfma_f32_16x16x32_bf16 v[128:131], a[44:47], v[88:91], v[128:131]
  s_add_u32 m0, s66, 4096
  s_add_u32 s58, s61, 4096
  v_mfma_f32_16x16x32_bf16 v[136:139], a[32:35], v[68:71], v[136:139]
  ds_read_b128 v[100:103], v16 offset:17152
  v_mfma_f32_16x16x32_bf16 v[136:139], a[36:39], v[76:79], v[136:139]
  buffer_load_dwordx4 v12, s[52:55], s58 offen lds
  v_mfma_f32_16x16x32_bf16 v[136:139], a[40:43], v[84:87], v[136:139]
  ds_read_b128 v[104:107], v17 offset:768
  v_mfma_f32_16x16x32_bf16 v[136:139], a[44:47], v[92:95], v[136:139]
  s_add_u32 m0, s66, 5120
  s_add_u32 s58, s61, 5120
  v_mfma_f32_16x16x32_bf16 v[132:135], a[96:99], v[64:67], v[132:135]
  ds_read_b128 v[108:111], v17 offset:17152
  v_mfma_f32_16x16x32_bf16 v[132:135], a[100:103], v[72:75], v[132:135]
  buffer_load_dwordx4 v13, s[52:55], s58 offen lds
  v_mfma_f32_16x16x32_bf16 v[132:135], a[104:107], v[80:83], v[132:135]
  ds_read_b128 v[112:115], v18 offset:768
  v_mfma_f32_16x16x32_bf16 v[132:135], a[108:111], v[88:91], v[132:135]
  s_add_u32 m0, s66, 6144
  s_add_u32 s58, s61, 6144
  v_mfma_f32_16x16x32_bf16 v[140:143], a[96:99], v[68:71], v[140:143]
  ds_read_b128 v[116:119], v18 offset:17152
  v_mfma_f32_16x16x32_bf16 v[140:143], a[100:103], v[76:79], v[140:143]
  buffer_load_dwordx4 v14, s[52:55], s58 offen lds
  v_mfma_f32_16x16x32_bf16 v[140:143], a[104:107], v[84:87], v[140:143]
  ds_read_b128 v[120:123], v19 offset:768
  v_mfma_f32_16x16x32_bf16 v[140:143], a[108:111], v[92:95], v[140:143]
  s_add_u32 m0, s66, 7168
  s_add_u32 s58, s61, 7168
  v_mfma_f32_16x16x32_bf16 v[144:147], a[160:163], v[64:67], v[144:147]
  ds_read_b128 v[124:127], v19 offset:17152
  v_mfma_f32_16x16x32_bf16 v[144:147], a[164:167], v[72:75], v[144:147]
  buffer_load_dwordx4 v15, s[52:55], s58 offen lds
  v_mfma_f32_16x16x32_bf16 v[144:147], a[168:171], v[80:83], v[144:147]
  v_mfma_f32_16x16x32_bf16 v[144:147], a[172:175], v[88:91], v[144:147]
  v_mfma_f32_16x16x32_bf16 v[152:155], a[160:163], v[68:71], v[152:155]
  v_add_u32 v16, 0x8000, v16
  v_mfma_f32_16x16x32_bf16 v[152:155], a[164:167], v[76:79], v[152:155]
  v_and_b32 v16, 0x1ffff, v16
  v_mfma_f32_16x16x32_bf16 v[152:155], a[168:171], v[84:87], v[152:155]
  v_add_u32 v17, 0x8000, v17
  v_mfma_f32_16x16x32_bf16 v[152:155], a[172:175], v[92:95], v[152:155]
  v_and_b32 v17, 0x1ffff, v17
  v_mfma_f32_16x16x32_bf16 v[148:151], a[224:227], v[64:67], v[148:151]
  v_add_u32 v18, 0x8000, v18
  v_mfma_f32_16x16x32_bf16 v[148:151], a[228:231], v[72:75], v[148:151]
  v_and_b32 v18, 0x1ffff, v18
  v_mfma_f32_16x16x32_bf16 v[148:151], a[232:235], v[80:83], v[148:151]
  v_add_u32 v19, 0x8000, v19
  v_mfma_f32_16x16x32_bf16 v[148:151], a[236:239], v[88:91], v[148:151]
  v_and_b32 v19, 0x1ffff, v19
  v_mfma_f32_16x16x32_bf16 v[156:159], a[224:227], v[68:71], v[156:159]
  s_sub_u32 s59, s63, 1
  s_max_i32 s59, s59, 0
  v_mfma_f32_16x16x32_bf16 v[156:159], a[228:231], v[76:79], v[156:159]
  v_mov_b32 v7, s59
  v_mfma_f32_16x16x32_bf16 v[156:159], a[232:235], v[84:87], v[156:159]
  s_cmp_lt_u32 s63, s80
  v_mfma_f32_16x16x32_bf16 v[156:159], a[236:239], v[92:95], v[156:159]
  s_waitcnt lgkmcnt(0)
  v_mfma_f32_16x16x32_bf16 v[128:131], a[48:51], v[96:99], v[128:131]
  s_waitcnt vmcnt(20)
  s_cbranch_scc1 L_f_e_25
L_f_e_25b:
  v_mfma_f32_16x16x32_bf16 v[128:131], a[52:55], v[104:107], v[128:131]
  s_barrier
  v_mfma_f32_16x16x32_bf16 v[128:131], a[56:59], v[112:115], v[128:131]
  ds_read_b128 v[64:67], v16 offset:0
  v_mfma_f32_16x16x32_bf16 v[128:131], a[60:63], v[120:123], v[128:131]
  buffer_store_dword v7, v6, s[40:43], s64 offen sc1
  v_mfma_f32_16x16x32_bf16 v[136:139], a[48:51], v[100:103], v[136:139]
  s_lshr_b32 s62, s63, 3
  ds_read_b128 v[68:71], v16 offset:16384
  v_mfma_f32_16x16x32_bf16 v[136:139], a[52:55], v[108:111], v[136:139]
  s_lshl_b32 s62, s62, 2
  v_mfma_f32_16x16x32_bf16 v[136:139], a[56:59], v[116:119], v[136:139]
  s_lshr_b32 s62, s73, s62
  ds_read_b128 v[72:75], v17 offset:0
  v_mfma_f32_16x16x32_bf16 v[136:139], a[60:63], v[124:127], v[136:139]
  s_and_b32 s62, s62, 7
  v_mfma_f32_16x16x32_bf16 v[132:135], a[112:115], v[96:99], v[132:135]
  s_and_b32 s59, s63, 7
  ds_read_b128 v[76:79], v17 offset:16384
  v_mfma_f32_16x16x32_bf16 v[132:135], a[116:119], v[104:107], v[132:135]
  s_lshl3_add_u32 s62, s62, s59
  v_mfma_f32_16x16x32_bf16 v[132:135], a[120:123], v[112:115], v[132:135]
  s_lshl_b32 s62, s62, 13
  ds_read_b128 v[80:83], v18 offset:0
  v_mfma_f32_16x16x32_bf16 v[132:135], a[124:127], v[120:123], v[132:135]
  s_add_u32 s62, s62, s65
  v_mfma_f32_16x16x32_bf16 v[140:143], a[112:115], v[100:103], v[140:143]
  s_add_u32 s70, s70, 1
  ds_read_b128 v[84:87], v18 offset:16384
  v_mfma_f32_16x16x32_bf16 v[140:143], a[116:119], v[108:111], v[140:143]
  s_lshr_b32 s61, s70, 3
  v_mfma_f32_16x16x32_bf16 v[140:143], a[120:123], v[116:119], v[140:143]
  s_lshl_b32 s61, s61, 2
  ds_read_b128 v[88:91], v19 offset:0
  v_mfma_f32_16x16x32_bf16 v[140:143], a[124:127], v[124:127], v[140:143]
  s_lshr_b32 s61, s73, s61
  v_mfma_f32_16x16x32_bf16 v[144:147], a[176:179], v[96:99], v[144:147]
  s_and_b32 s61, s61, 7
  ds_read_b128 v[92:95], v19 offset:16384
  v_mfma_f32_16x16x32_bf16 v[144:147], a[180:183], v[104:107], v[144:147]
  s_and_b32 s59, s70, 7
  v_mfma_f32_16x16x32_bf16 v[144:147], a[184:187], v[112:115], v[144:147]
  s_lshl3_add_u32 s61, s61, s59
  v_mfma_f32_16x16x32_bf16 v[144:147], a[188:191], v[120:123], v[144:147]
  s_lshl_b32 s61, s61, 15
  v_mfma_f32_16x16x32_bf16 v[152:155], a[176:179], v[100:103], v[152:155]
  s_add_u32 s61, s61, s71
  v_mfma_f32_16x16x32_bf16 v[152:155], a[180:183], v[108:111], v[152:155]
  s_add_u32 s66, s66, 0x8000
  v_mfma_f32_16x16x32_bf16 v[152:155], a[184:187], v[116:119], v[152:155]
  s_and_b32 s66, s66, 0x1ffff
  v_mfma_f32_16x16x32_bf16 v[152:155], a[188:191], v[124:127], v[152:155]
  v_mfma_f32_16x16x32_bf16 v[148:151], a[240:243], v[96:99], v[148:151]
  s_add_u32 s63, s63, 1
  v_mfma_f32_16x16x32_bf16 v[148:151], a[244:247], v[104:107], v[148:151]
  v_mfma_f32_16x16x32_bf16 v[148:151], a[248:251], v[112:115], v[148:151]
  v_mfma_f32_16x16x32_bf16 v[148:151], a[252:255], v[120:123], v[148:151]
  v_mfma_f32_16x16x32_bf16 v[156:159], a[240:243], v[100:103], v[156:159]
  v_mfma_f32_16x16x32_bf16 v[156:159], a[244:247], v[108:111], v[156:159]
  v_mfma_f32_16x16x32_bf16 v[156:159], a[248:251], v[116:119], v[156:159]
  s_cmp_lt_u32 s63, s67
  v_mfma_f32_16x16x32_bf16 v[156:159], a[252:255], v[124:127], v[156:159]
  s_waitcnt lgkmcnt(0)
L_f_01:
  v_mfma_f32_16x16x32_bf16 v[160:163], a[0:3], v[64:67], 0
  v_mfma_f32_16x16x32_bf16 v[160:163], a[4:7], v[72:75], v[160:163]
  v_mfma_f32_16x16x32_bf16 v[160:163], a[8:11], v[80:83], v[160:163]
  ds_read_b128 v[96:99], v16 offset:256
  v_mfma_f32_16x16x32_bf16 v[160:163], a[12:15], v[88:91], v[160:163]
  s_cmp_lg_u32 s57, 6
  s_cbranch_scc1 L_f_pw_28
  buffer_store_dwordx4 v[36:39], v2, s[40:43], s79 offen sc1
  s_add_u32 s79, s79, 0x20000
L_f_pw_28:
  v_mfma_f32_16x16x32_bf16 v[168:171], a[0:3], v[68:71], 0
  ds_read_b128 v[100:103], v16 offset:16640
  v_mfma_f32_16x16x32_bf16 v[168:171], a[4:7], v[76:79], v[168:171]
  v_mfma_f32_16x16x32_bf16 v[168:171], a[8:11], v[84:87], v[168:171]
  ds_read_b128 v[104:107], v17 offset:256
  v_mfma_f32_16x16x32_bf16 v[168:171], a[12:15], v[92:95], v[168:171]
  v_mfma_f32_16x16x32_bf16 v[164:167], a[64:67], v[64:67], 0
  ds_read_b128 v[108:111], v17 offset:16640
  v_mfma_f32_16x16x32_bf16 v[164:167], a[68:71], v[72:75], v[164:167]
  v_mul_f32 v128, s69, v128
  v_mul_f32 v129, s69, v129
  v_mfma_f32_16x16x32_bf16 v[164:167], a[72:75], v[80:83], v[164:167]
  ds_read_b128 v[112:115], v18 offset:256
  v_mul_f32 v130, s69, v130
  v_mfma_f32_16x16x32_bf16 v[164:167], a[76:79], v[88:91], v[164:167]
  v_mul_f32 v131, s69, v131
  v_mul_f32 v132, s69, v132
  v_mfma_f32_16x16x32_bf16 v[172:175], a[64:67], v[68:71], 0
  ds_read_b128 v[116:119], v18 offset:16640
  v_mul_f32 v133, s69, v133
  v_mfma_f32_16x16x32_bf16 v[172:175], a[68:71], v[76:79], v[172:175]
  v_mul_f32 v134, s69, v134
  v_mul_f32 v135, s69, v135
  v_mfma_f32_16x16x32_bf16 v[172:175], a[72:75], v[84:87], v[172:175]
  ds_read_b128 v[120:123], v19 offset:256
  v_cvt_pk_bf16_f32 v192, v128, v129
  v_mfma_f32_16x16x32_bf16 v[172:175], a[76:79], v[92:95], v[172:175]
  v_cvt_pk_bf16_f32 v193, v130, v131
  v_cvt_pk_bf16_f32 v194, v132, v133
  v_mfma_f32_16x16x32_bf16 v[176:179], a[128:131], v[64:67], 0
  ds_read_b128 v[124:127], v19 offset:16640
  v_cvt_pk_bf16_f32 v195, v134, v135
  v_mfma_f32_16x16x32_bf16 v[176:179], a[132:135], v[72:75], v[176:179]
  buffer_store_dwordx4 v[192:195], v2, s[40:43], s62 offen offset:0 sc1
  v_mfma_f32_16x16x32_bf16 v[176:179], a[136:139], v[80:83], v[176:179]
  v_mul_f32 v136, s69, v136
  v_mul_f32 v137, s69, v137
  v_mfma_f32_16x16x32_bf16 v[176:179], a[140:143], v[88:91], v[176:179]
  v_mul_f32 v138, s69, v138
  v_mul_f32 v139, s69, v139
  v_mfma_f32_16x16x32_bf16 v[184:187], a[128:131], v[68:71], 0
  v_mul_f32 v140, s69, v140
  v_mul_f32 v141, s69, v141
  v_mfma_f32_16x16x32_bf16 v[184:187], a[132:135], v[76:79], v[184:187]
  v_mul_f32 v142, s69, v142
  v_mul_f32 v143, s69, v143
  v_mfma_f32_16x16x32_bf16 v[184:187], a[136:139], v[84:87], v[184:187]
  v_cvt_pk_bf16_f32 v196, v136, v137
  v_cvt_pk_bf16_f32 v197, v138, v139
  v_mfma_f32_16x16x32_bf16 v[184:187], a[140:143], v[92:95], v[184:187]
  v_cvt_pk_bf16_f32 v198, v140, v141
  v_cvt_pk_bf16_f32 v199, v142, v143
  v_mfma_f32_16x16x32_bf16 v[180:183], a[192:195], v[64:67], 0
  buffer_store_dwordx4 v[196:199], v2, s[40:43], s62 offen offset:1024 sc1
  v_mfma_f32_16x16x32_bf16 v[180:183], a[196:199], v[72:75], v[180:183]
  v_mul_f32 v144, s69, v144
  v_mul_f32 v145, s69, v145
  v_mfma_f32_16x16x32_bf16 v[180:183], a[200:203], v[80:83], v[180:183]
  v_mul_f32 v146, s69, v146
  v_mul_f32 v147, s69, v147
  v_mfma_f32_16x16x32_bf16 v[180:183], a[204:207], v[88:91], v[180:183]
  v_mul_f32 v148, s69, v148
  v_mul_f32 v149, s69, v149
  v_mfma_f32_16x16x32_bf16 v[188:191], a[192:195], v[68:71], 0
  v_mul_f32 v150, s69, v150
  v_mul_f32 v151, s69, v151
  v_mfma_f32_16x16x32_bf16 v[188:191], a[196:199], v[76:79], v[188:191]
  v_cvt_pk_bf16_f32 v200, v144, v145
  v_cvt_pk_bf16_f32 v201, v146, v147
  v_mfma_f32_16x16x32_bf16 v[188:191], a[200:203], v[84:87], v[188:191]
  v_cvt_pk_bf16_f32 v202, v148, v149
  v_cvt_pk_bf16_f32 v203, v150, v151
  v_mfma_f32_16x16x32_bf16 v[188:191], a[204:207], v[92:95], v[188:191]
  s_waitcnt lgkmcnt(0)
  buffer_store_dwordx4 v[200:203], v2, s[40:43], s62 offen offset:2048 sc1
  v_mfma_f32_16x16x32_bf16 v[160:163], a[16:19], v[96:99], v[160:163]
  v_mul_f32 v152, s69, v152
  v_mul_f32 v153, s69, v153
  v_mfma_f32_16x16x32_bf16 v[160:163], a[20:23], v[104:107], v[160:163]
  v_mul_f32 v154, s69, v154
  v_mul_f32 v155, s69, v155
  v_mfma_f32_16x16x32_bf16 v[160:163], a[24:27], v[112:115], v[160:163]
  ds_read_b128 v[64:67], v16 offset:512
  v_mul_f32 v156, s69, v156
  v_mfma_f32_16x16x32_bf16 v[160:163], a[28:31], v[120:123], v[160:163]
  v_mul_f32 v157, s69, v157
  v_mul_f32 v158, s69, v158
  v_mfma_f32_16x16x32_bf16 v[168:171], a[16:19], v[100:103], v[168:171]
  ds_read_b128 v[68:71], v16 offset:16896
  v_mul_f32 v159, s69, v159
  v_mfma_f32_16x16x32_bf16 v[168:171], a[20:23], v[108:111], v[168:171]
  v_cvt_pk_bf16_f32 v204, v152, v153
  v_cvt_pk_bf16_f32 v205, v154, v155
  v_mfma_f32_16x16x32_bf16 v[168:171], a[24:27], v[116:119], v[168:171]
  ds_read_b128 v[72:75], v17 offset:512
  v_cvt_pk_bf16_f32 v206, v156, v157
  v_mfma_f32_16x16x32_bf16 v[168:171], a[28:31], v[124:127], v[168:171]
  v_cvt_pk_bf16_f32 v207, v158, v159
  v_mfma_f32_16x16x32_bf16 v[164:167], a[80:83], v[96:99], v[164:167]
  ds_read_b128 v[76:79], v17 offset:16896
  v_mfma_f32_16x16x32_bf16 v[164:167], a[84:87], v[104:107], v[164:167]
  buffer_store_dwordx4 v[204:207], v2, s[40:43], s62 offen offset:3072 sc1
  v_mfma_f32_16x16x32_bf16 v[164:167], a[88:91], v[112:115], v[164:167]
  ds_read_b128 v[80:83], v18 offset:512
  v_mfma_f32_16x16x32_bf16 v[164:167], a[92:95], v[120:123], v[164:167]
  v_mfma_f32_16x16x32_bf16 v[172:175], a[80:83], v[100:103], v[172:175]
  ds_read_b128 v[84:87], v18 offset:16896
  v_mfma_f32_16x16x32_bf16 v[172:175], a[84:87], v[108:111], v[172:175]
  v_mfma_f32_16x16x32_bf16 v[172:175], a[88:91], v[116:119], v[172:175]
  ds_read_b128 v[88:91], v19 offset:512
  v_mfma_f32_16x16x32_bf16 v[172:175], a[92:95], v[124:127], v[172:175]
  v_mfma_f32_16x16x32_bf16 v[176:179], a[144:147], v[96:99], v[176:179]
  ds_read_b128 v[92:95], v19 offset:16896
  v_mfma_f32_16x16x32_bf16 v[176:179], a[148:151], v[104:107], v[176:179]
  v_mfma_f32_16x16x32_bf16 v[176:179], a[152:155], v[112:115], v[176:179]
  v_mfma_f32_16x16x32_bf16 v[176:179], a[156:159], v[120:123], v[176:179]
  s_add_u32 m0, s66, 0
  s_add_u32 s58, s61, 0
  v_mfma_f32_16x16x32_bf16 v[184:187], a[144:147], v[100:103], v[184:187]
  v_mfma_f32_16x16x32_bf16 v[184:187], a[148:151], v[108:111], v[184:187]
  buffer_load_dwordx4 v8, s[52:55], s58 offen lds
  v_mfma_f32_16x16x32_bf16 v[184:187], a[152:155], v[116:119], v[184:187]
  v_mfma_f32_16x16x32_bf16 v[184:187], a[156:159], v[124:127], v[184:187]
  s_add_u32 m0, s66, 1024
  s_add_u32 s58, s61, 1024
  v_mfma_f32_16x16x32_bf16 v[180:183], a[208:211], v[96:99], v[180:183]
  v_mfma_f32_16x16x32_bf16 v[180:183], a[212:215], v[104:107], v[180:183]
  buffer_load_dwordx4 v9, s[52:55], s58 offen lds
  v_mfma_f32_16x16x32_bf16 v[180:183], a[216:219], v[112:115], v[180:183]
  v_mfma_f32_16x16x32_bf16 v[180:183], a[220:223], v[120:123], v[180:183]
  s_add_u32 m0, s66, 2048
  s_add_u32 s58, s61, 2048
  v_mfma_f32_16x16x32_bf16 v[188:191], a[208:211], v[100:103], v[188:191]
  v_mfma_f32_16x16x32_bf16 v[188:191], a[212:215], v[108:111], v[188:191]
  buffer_load_dwordx4 v10, s[52:55], s58 offen lds
  v_mfma_f32_16x16x32_bf16 v[188:191], a[216:219], v[116:119], v[188:191]
  v_mfma_f32_16x16x32_bf16 v[188:191], a[220:223], v[124:127], v[188:191]
  s_waitcnt lgkmcnt(0)
  s_add_u32 m0, s66, 3072
  s_add_u32 s58, s61, 3072
  v_mfma_f32_16x16x32_bf16 v[160:163], a[32:35], v[64:67], v[160:163]
  v_mfma_f32_16x16x32_bf16 v[160:163], a[36:39], v[72:75], v[160:163]
  buffer_load_dwordx4 v11, s[52:55], s58 offen lds
  v_mfma_f32_16x16x32_bf16 v[160:163], a[40:43], v[80:83], v[160:163]
  ds_read_b128 v[96:99], v16 offset:768
  v_mfma_f32_16x16x32_bf16 v[160:163], a[44:47], v[88:91], v[160:163]
  s_add_u32 m0, s66, 4096
  s_add_u32 s58, s61, 4096
  v_mfma_f32_16x16x32_bf16 v[168:171], a[32:35], v[68:71], v[168:171]
  ds_read_b128 v[100:103], v16 offset:17152
  v_mfma_f32_16x16x32_bf16 v[168:171], a[36:39], v[76:79], v[168:171]
  buffer_load_dwordx4 v12, s[52:55], s58 offen lds
  v_mfma_f32_16x16x32_bf16 v[168:171], a[40:43], v[84:87], v[168:171]
  ds_read_b128 v[104:107], v17 offset:768
  v_mfma_f32_16x16x32_bf16 v[168:171], a[44:47], v[92:95], v[168:171]
  s_add_u32 m0, s66, 5120
  s_add_u32 s58, s61, 5120
  v_mfma_f32_16x16x32_bf16 v[164:167], a[96:99], v[64:67], v[164:167]
  ds_read_b128 v[108:111], v17 offset:17152
  v_mfma_f32_16x16x32_bf16 v[164:167], a[100:103], v[72:75], v[164:167]
  buffer_load_dwordx4 v13, s[52:55], s58 offen lds
  v_mfma_f32_16x16x32_bf16 v[164:167], a[104:107], v[80:83], v[164:167]
  ds_read_b128 v[112:115], v18 offset:768
  v_mfma_f32_16x16x32_bf16 v[164:167], a[108:111], v[88:91], v[164:167]
  s_add_u32 m0, s66, 6144
  s_add_u32 s58, s61, 6144
  v_mfma_f32_16x16x32_bf16 v[172:175], a[96:99], v[68:71], v[172:175]
  ds_read_b128 v[116:119], v18 offset:17152
  v_mfma_f32_16x16x32_bf16 v[172:175], a[100:103], v[76:79], v[172:175]
  buffer_load_dwordx4 v14, s[52:55], s58 offen lds
  v_mfma_f32_16x16x32_bf16 v[172:175], a[104:107], v[84:87], v[172:175]
  ds_read_b128 v[120:123], v19 offset:768
  v_mfma_f32_16x16x32_bf16 v[172:175], a[108:111], v[92:95], v[172:175]
  s_add_u32 m0, s66, 7168
  s_add_u32 s58, s61, 7168
  v_mfma_f32_16x16x32_bf16 v[176:179], a[160:163], v[64:67], v[176:179]
  ds_read_b128 v[124:127], v19 offset:17152
  v_mfma_f32_16x16x32_bf16 v[176:179], a[164:167], v[72:75], v[176:179]
  buffer_load_dwordx4 v15, s[52:55], s58 offen lds
  v_mfma_f32_16x16x32_bf16 v[176:179], a[168:171], v[80:83], v[176:179]
  v_mfma_f32_16x16x32_bf16 v[176:179], a[172:175], v[88:91], v[176:179]
  v_mfma_f32_16x16x32_bf16 v[184:187], a[160:163], v[68:71], v[184:187]
  v_add_u32 v16, 0x8000, v16
  v_mfma_f32_16x16x32_bf16 v[184:187], a[164:167], v[76:79], v[184:187]
  v_and_b32 v16, 0x1ffff, v16
  v_mfma_f32_16x16x32_bf16 v[184:187], a[168:171], v[84:87], v[184:187]
  v_add_u32 v17, 0x8000, v17
  v_mfma_f32_16x16x32_bf16 v[184:187], a[172:175], v[92:95], v[184:187]
  v_and_b32 v17, 0x1ffff, v17
  v_mfma_f32_16x16x32_bf16 v[180:183], a[224:227], v[64:67], v[180:183]
  v_add_u32 v18, 0x8000, v18
  v_mfma_f32_16x16x32_bf16 v[180:183], a[228:231], v[72:75], v[180:183]
  v_and_b32 v18, 0x1ffff, v18
  v_mfma_f32_16x16x32_bf16 v[180:183], a[232:235], v[80:83], v[180:183]
  v_add_u32 v19, 0x8000, v19
  v_mfma_f32_16x16x32_bf16 v[180:183], a[236:239], v[88:91], v[180:183]
  v_and_b32 v19, 0x1ffff, v19
  v_mfma_f32_16x16x32_bf16 v[188:191], a[224:227], v[68:71], v[188:191]
  s_sub_u32 s59, s63, 1
  s_max_i32 s59, s59, 0
  v_mfma_f32_16x16x32_bf16 v[188:191], a[228:231], v[76:79], v[188:191]
  v_mov_b32 v7, s59
  v_mfma_f32_16x16x32_bf16 v[188:191], a[232:235], v[84:87], v[188:191]
  s_cmp_lt_u32 s63, s80
  v_mfma_f32_16x16x32_bf16 v[188:191], a[236:239], v[92:95], v[188:191]
  s_waitcnt lgkmcnt(0)
  v_mfma_f32_16x16x32_bf16 v[160:163], a[48:51], v[96:99], v[160:163]
  s_waitcnt vmcnt(20)
  s_cbranch_scc1 L_f_e_27
L_f_e_27b:
  v_mfma_f32_16x16x32_bf16 v[160:163], a[52:55], v[104:107], v[160:163]
  s_barrier
  v_mfma_f32_16x16x32_bf16 v[160:163], a[56:59], v[112:115], v[160:163]
  ds_read_b128 v[64:67], v16 offset:0
  v_mfma_f32_16x16x32_bf16 v[160:163], a[60:63], v[120:123], v[160:163]
  buffer_store_dword v7, v6, s[40:43], s64 offen sc1
  v_mfma_f32_16x16x32_bf16 v[168:171], a[48:51], v[100:103], v[168:171]
  s_lshr_b32 s62, s63, 3
  ds_read_b128 v[68:71], v16 offset:16384
  v_mfma_f32_16x16x32_bf16 v[168:171], a[52:55], v[108:111], v[168:171]
  s_lshl_b32 s62, s62, 2
  v_mfma_f32_16x16x32_bf16 v[168:171], a[56:59], v[116:119], v[168:171]
  s_lshr_b32 s62, s73, s62
  ds_read_b128 v[72:75], v17 offset:0
  v_mfma_f32_16x16x32_bf16 v[168:171], a[60:63], v[124:127], v[168:171]
  s_and_b32 s62, s62, 7
  v_mfma_f32_16x16x32_bf16 v[164:167], a[112:115], v[96:99], v[164:167]
  s_and_b32 s59, s63, 7
  ds_read_b128 v[76:79], v17 offset:16384
  v_mfma_f32_16x16x32_bf16 v[164:167], a[116:119], v[104:107], v[164:167]
  s_lshl3_add_u32 s62, s62, s59
  v_mfma_f32_16x16x32_bf16 v[164:167], a[120:123], v[112:115], v[164:167]
  s_lshl_b32 s62, s62, 13
  ds_read_b128 v[80:83], v18 offset:0
  v_mfma_f32_16x16x32_bf16 v[164:167], a[124:127], v[120:123], v[164:167]
  s_add_u32 s62, s62, s65
  v_mfma_f32_16x16x32_bf16 v[172:175], a[112:115], v[100:103], v[172:175]
  s_add_u32 s70, s70, 1
  ds_read_b128 v[84:87], v18 offset:16384
  v_mfma_f32_16x16x32_bf16 v[172:175], a[116:119], v[108:111], v[172:175]
  s_lshr_b32 s61, s70, 3
  v_mfma_f32_16x16x32_bf16 v[172:175], a[120:123], v[116:119], v[172:175]
  s_lshl_b32 s61, s61, 2
  ds_read_b128 v[88:91], v19 offset:0
  v_mfma_f32_16x16x32_bf16 v[172:175], a[124:127], v[124:127], v[172:175]
  s_lshr_b32 s61, s73, s61
  v_mfma_f32_16x16x32_bf16 v[176:179], a[176:179], v[96:99], v[176:179]
  s_and_b32 s61, s61, 7
  ds_read_b128 v[92:95], v19 offset:16384
  v_mfma_f32_16x16x32_bf16 v[176:179], a[180:183], v[104:107], v[176:179]
  s_and_b32 s59, s70, 7
  v_mfma_f32_16x16x32_bf16 v[176:179], a[184:187], v[112:115], v[176:179]
  s_lshl3_add_u32 s61, s61, s59
  v_mfma_f32_16x16x32_bf16 v[176:179], a[188:191], v[120:123], v[176:179]
  s_lshl_b32 s61, s61, 15
  v_mfma_f32_16x16x32_bf16 v[184:187], a[176:179], v[100:103], v[184:187]
  s_add_u32 s61, s61, s71
  v_mfma_f32_16x16x32_bf16 v[184:187], a[180:183], v[108:111], v[184:187]
  s_add_u32 s66, s66, 0x8000
  v_mfma_f32_16x16x32_bf16 v[184:187], a[184:187], v[116:119], v[184:187]
  s_and_b32 s66, s66, 0x1ffff
  v_mfma_f32_16x16x32_bf16 v[184:187], a[188:191], v[124:127], v[184:187]
  v_mfma_f32_16x16x32_bf16 v[180:183], a[240:243], v[96:99], v[180:183]
  s_add_u32 s63, s63, 1
  v_mfma_f32_16x16x32_bf16 v[180:183], a[244:247], v[104:107], v[180:183]
  s_mov_b64 exec, 1
  buffer_atomic_add v33, v6, s[40:43], s76 offen
  s_mov_b64 exec, -1
  v_mfma_f32_16x16x32_bf16 v[180:183], a[248:251], v[112:115], v[180:183]
  s_mov_b32 s76, 0x40000000
  v_mfma_f32_16x16x32_bf16 v[180:183], a[252:255], v[120:123], v[180:183]
  v_mfma_f32_16x16x32_bf16 v[188:191], a[240:243], v[100:103], v[188:191]
  v_mfma_f32_16x16x32_bf16 v[188:191], a[244:247], v[108:111], v[188:191]
  v_mfma_f32_16x16x32_bf16 v[188:191], a[248:251], v[116:119], v[188:191]
  s_cmp_lt_u32 s63, s67
  v_mfma_f32_16x16x32_bf16 v[188:191], a[252:255], v[124:127], v[188:191]
  s_waitcnt lgkmcnt(0)
  s_cbranch_scc1 L_f_00
  s_branch L_f_done
L_f_10:
  v_mfma_f32_16x16x32_bf16 v[128:131], v[64:67], a[0:3], 0
  v_mfma_f32_16x16x32_bf16 v[128:131], v[72:75], a[4:7], v[128:131]
  v_mfma_f32_16x16x32_bf16 v[128:131], v[80:83], a[8:11], v[128:131]
  ds_read_b128 v[96:99], v16 offset:256
  v_mfma_f32_16x16x32_bf16 v[128:131], v[88:91], a[12:15], v[128:131]
  s_cmp_lg_u32 s57, 6
  s_cbranch_scc1 L_f_pw_30
  buffer_store_dwordx4 v[36:39], v2, s[40:43], s79 offen sc1
  s_add_u32 s79, s79, 0x20000
L_f_pw_30:
  v_mfma_f32_16x16x32_bf16 v[132:135], v[68:71], a[0:3], 0
  ds_read_b128 v[100:103], v16 offset:16640
  v_mfma_f32_16x16x32_bf16 v[132:135], v[76:79], a[4:7], v[132:135]
  v_mfma_f32_16x16x32_bf16 v[132:135], v[84:87], a[8:11], v[132:135]
  ds_read_b128 v[104:107], v17 offset:256
  v_mfma_f32_16x16x32_bf16 v[132:135], v[92:95], a[12:15], v[132:135]
  v_mfma_f32_16x16x32_bf16 v[136:139], v[64:67], a[64:67], 0
  ds_read_b128 v[108:111], v17 offset:16640
  v_mfma_f32_16x16x32_bf16 v[136:139], v[72:75], a[68:71], v[136:139]
  v_cvt_pk_bf16_f32 v192, v160, v161
  v_cvt_pk_bf16_f32 v193, v162, v163
  v_mfma_f32_16x16x32_bf16 v[136:139], v[80:83], a[72:75], v[136:139]
  ds_read_b128 v[112:115], v18 offset:256
  v_cvt_pk_bf16_f32 v194, v164, v165
  v_mfma_f32_16x16x32_bf16 v[136:139], v[88:91], a[76:79], v[136:139]
  v_cvt_pk_bf16_f32 v195, v166, v167
  v_mfma_f32_16x16x32_bf16 v[140:143], v[68:71], a[64:67], 0
  ds_read_b128 v[116:119], v18 offset:16640
  v_mfma_f32_16x16x32_bf16 v[140:143], v[76:79], a[68:71], v[140:143]
  buffer_store_dwordx4 v[192:195], v2, s[40:43], s62 offen offset:0 sc1
  v_mfma_f32_16x16x32_bf16 v[140:143], v[84:87], a[72:75], v[140:143]
  ds_read_b128 v[120:123], v19 offset:256
  v_cvt_pk_bf16_f32 v196, v168, v169
  v_mfma_f32_16x16x32_bf16 v[140:143], v[92:95], a[76:79], v[140:143]
  v_cvt_pk_bf16_f32 v197, v170, v171
  v_cvt_pk_bf16_f32 v198, v172, v173
  v_mfma_f32_16x16x32_bf16 v[144:147], v[64:67], a[128:131], 0
  ds_read_b128 v[124:127], v19 offset:16640
  v_cvt_pk_bf16_f32 v199, v174, v175
  v_mfma_f32_16x16x32_bf16 v[144:147], v[72:75], a[132:135], v[144:147]
  buffer_store_dwordx4 v[196:199], v2, s[40:43], s62 offen offset:1024 sc1
  v_mfma_f32_16x16x32_bf16 v[144:147], v[80:83], a[136:139], v[144:147]
  v_cvt_pk_bf16_f32 v200, v176, v177
  v_cvt_pk_bf16_f32 v201, v178, v179
  v_mfma_f32_16x16x32_bf16 v[144:147], v[88:91], a[140:143], v[144:147]
  v_cvt_pk_bf16_f32 v202, v180, v181
  v_cvt_pk_bf16_f32 v203, v182, v183
  v_mfma_f32_16x16x32_bf16 v[148:151], v[68:71], a[128:131], 0
  buffer_store_dwordx4 v[200:203], v2, s[40:43], s62 offen offset:2048 sc1
  v_mfma_f32_16x16x32_bf16 v[148:151], v[76:79], a[132:135], v[148:151]
  v_cvt_pk_bf16_f32 v204, v184, v185
  v_cvt_pk_bf16_f32 v205, v186, v187
  v_mfma_f32_16x16x32_bf16 v[148:151], v[84:87], a[136:139], v[148:151]
  v_cvt_pk_bf16_f32 v206, v188, v189
  v_cvt_pk_bf16_f32 v207, v190, v191
  v_mfma_f32_16x16x32_bf16 v[148:151], v[92:95], a[140:143], v[148:151]
  buffer_store_dwordx4 v[204:207], v2, s[40:43], s62 offen offset:3072 sc1
  v_mfma_f32_16x16x32_bf16 v[152:155], v[64:67], a[192:195], 0
  v_mfma_f32_16x16x32_bf16 v[152:155], v[72:75], a[196:199], v[152:155]
  v_mfma_f32_16x16x32_bf16 v[152:155], v[80:83], a[200:203], v[152:155]
  v_mfma_f32_16x16x32_bf16 v[152:155], v[88:91], a[204:207], v[152:155]
  v_mfma_f32_16x16x32_bf16 v[156:159], v[68:71], a[192:195], 0
  v_mfma_f32_16x16x32_bf16 v[156:159], v[76:79], a[196:199], v[156:159]
  v_mfma_f32_16x16x32_bf16 v[156:159], v[84:87], a[200:203], v[156:159]
  v_mfma_f32_16x16x32_bf16 v[156:159], v[92:95], a[204:207], v[156:159]
  s_waitcnt lgkmcnt(0)
  v_mfma_f32_16x16x32_bf16 v[128:131], v[96:99], a[16:19], v[128:131]
  v_mfma_f32_16x16x32_bf16 v[128:131], v[104:107], a[20:23], v[128:131]
  v_mfma_f32_16x16x32_bf16 v[128:131], v[112:115], a[24:27], v[128:131]
  ds_read_b128 v[64:67], v16 offset:512
  v_mfma_f32_16x16x32_bf16 v[128:131], v[120:123], a[28:31], v[128:131]
  v_mfma_f32_16x16x32_bf16 v[132:135], v[100:103], a[16:19], v[132:135]
  ds_read_b128 v[68:71], v16 offset:16896
  v_mfma_f32_16x16x32_bf16 v[132:135], v[108:111], a[20:23], v[132:135]
  v_mfma_f32_16x16x32_bf16 v[132:135], v[116:119], a[24:27], v[132:135]
  ds_read_b128 v[72:75], v17 offset:512
  v_mfma_f32_16x16x32_bf16 v[132:135], v[124:127], a[28:31], v[132:135]
  v_mfma_f32_16x16x32_bf16 v[136:139], v[96:99], a[80:83], v[136:139]
  ds_read_b128 v[76:79], v17 offset:16896
  v_mfma_f32_16x16x32_bf16 v[136:139], v[104:107], a[84:87], v[136:139]
  v_mfma_f32_16x16x32_bf16 v[136:139], v[112:115], a[88:91], v[136:139]
  ds_read_b128 v[80:83], v18 offset:512
  v_mfma_f32_16x16x32_bf16 v[136:139], v[120:123], a[92:95], v[136:139]
  v_mfma_f32_16x16x32_bf16 v[140:143], v[100:103], a[80:83], v[140:143]
  ds_read_b128 v[84:87], v18 offset:16896
  v_mfma_f32_16x16x32_bf16 v[140:143], v[108:111], a[84:87], v[140:143]
  v_mfma_f32_16x16x32_bf16 v[140:143], v[116:119], a[88:91], v[140:143]
  ds_read_b128 v[88:91], v19 offset:512
  v_mfma_f32_16x16x32_bf16 v[140:143], v[124:127], a[92:95], v[140:143]
  v_mfma_f32_16x16x32_bf16 v[144:147], v[96:99], a[144:147], v[144:147]
  ds_read_b128 v[92:95], v19 offset:16896
  v_mfma_f32_16x16x32_bf16 v[144:147], v[104:107], a[148:151], v[144:147]
  v_mfma_f32_16x16x32_bf16 v[144:147], v[112:115], a[152:155], v[144:147]
  v_mfma_f32_16x16x32_bf16 v[144:147], v[120:123], a[156:159], v[144:147]
  s_add_u32 m0, s66, 0
  s_add_u32 s58, s61, 0
  v_mfma_f32_16x16x32_bf16 v[148:151], v[100:103], a[144:147], v[148:151]
  v_mfma_f32_16x16x32_bf16 v[148:151], v[108:111], a[148:151], v[148:151]
  buffer_load_dwordx4 v8, s[52:55], s58 offen lds
  v_mfma_f32_16x16x32_bf16 v[148:151], v[116:119], a[152:155], v[148:151]
  v_mfma_f32_16x16x32_bf16 v[148:151], v[124:127], a[156:159], v[148:151]
  s_add_u32 m0, s66, 1024
  s_add_u32 s58, s61, 1024
  v_mfma_f32_16x16x32_bf16 v[152:155], v[96:99], a[208:211], v[152:155]
  v_mfma_f32_16x16x32_bf16 v[152:155], v[104:107], a[212:215], v[152:155]
  buffer_load_dwordx4 v9, s[52:55], s58 offen lds
  v_mfma_f32_16x16x32_bf16 v[152:155], v[112:115], a[216:219], v[152:155]
  v_mfma_f32_16x16x32_bf16 v[152:155], v[120:123], a[220:223], v[152:155]
  s_add_u32 m0, s66, 2048
  s_add_u32 s58, s61, 2048
  v_mfma_f32_16x16x32_bf16 v[156:159], v[100:103], a[208:211], v[156:159]
  v_mfma_f32_16x16x32_bf16 v[156:159], v[108:111], a[212:215], v[156:159]
  buffer_load_dwordx4 v10, s[52:55], s58 offen lds
  v_mfma_f32_16x16x32_bf16 v[156:159], v[116:119], a[216:219], v[156:159]
  v_mfma_f32_16x16x32_bf16 v[156:159], v[124:127], a[220:223], v[156:159]
  s_waitcnt lgkmcnt(0)
  s_add_u32 m0, s66, 3072
  s_add_u32 s58, s61, 3072
  v_mfma_f32_16x16x32_bf16 v[128:131], v[64:67], a[32:35], v[128:131]
  v_mfma_f32_16x16x32_bf16 v[128:131], v[72:75], a[36:39], v[128:131]
  buffer_load_dwordx4 v11, s[52:55], s58 offen lds
  v_mfma_f32_16x16x32_bf16 v[128:131], v[80:83], a[40:43], v[128:131]
  ds_read_b128 v[96:99], v16 offset:768
  v_mfma_f32_16x16x32_bf16 v[128:131], v[88:91], a[44:47], v[128:131]
  s_add_u32 m0, s66, 4096
  s_add_u32 s58, s61, 4096
  v_mfma_f32_16x16x32_bf16 v[132:135], v[68:71], a[32:35], v[132:135]
  ds_read_b128 v[100:103], v16 offset:17152
  v_mfma_f32_16x16x32_bf16 v[132:135], v[76:79], a[36:39], v[132:135]
  buffer_load_dwordx4 v12, s[52:55], s58 offen lds
  v_mfma_f32_16x16x32_bf16 v[132:135], v[84:87], a[40:43], v[132:135]
  ds_read_b128 v[104:107], v17 offset:768
  v_mfma_f32_16x16x32_bf16 v[132:135], v[92:95], a[44:47], v[132:135]
  s_add_u32 m0, s66, 5120
  s_add_u32 s58, s61, 5120
  v_mfma_f32_16x16x32_bf16 v[136:139], v[64:67], a[96:99], v[136:139]
  ds_read_b128 v[108:111], v17 offset:17152
  v_mfma_f32_16x16x32_bf16 v[136:139], v[72:75], a[100:103], v[136:139]
  buffer_load_dwordx4 v13, s[52:55], s58 offen lds
  v_mfma_f32_16x16x32_bf16 v[136:139], v[80:83], a[104:107], v[136:139]
  ds_read_b128 v[112:115], v18 offset:768
  v_mfma_f32_16x16x32_bf16 v[136:139], v[88:91], a[108:111], v[136:139]
  s_add_u32 m0, s66, 6144
  s_add_u32 s58, s61, 6144
  v_mfma_f32_16x16x32_bf16 v[140:143], v[68:71], a[96:99], v[140:143]
  ds_read_b128 v[116:119], v18 offset:17152
  v_mfma_f32_16x16x32_bf16 v[140:143], v[76:79], a[100:103], v[140:143]
  buffer_load_dwordx4 v14, s[52:55], s58 offen lds
  v_mfma_f32_16x16x32_bf16 v[140:143], v[84:87], a[104:107], v[140:143]
  ds_read_b128 v[120:123], v19 offset:768
  v_mfma_f32_16x16x32_bf16 v[140:143], v[92:95], a[108:111], v[140:143]
  s_add_u32 m0, s66, 7168
  s_add_u32 s58, s61, 7168
  v_mfma_f32_16x16x32_bf16 v[144:147], v[64:67], a[160:163], v[144:147]
  ds_read_b128 v[124:127], v19 offset:17152
  v_mfma_f32_16x16x32_bf16 v[144:147], v[72:75], a[164:167], v[144:147]
  buffer_load_dwordx4 v15, s[52:55], s58 offen lds
  v_mfma_f32_16x16x32_bf16 v[144:147], v[80:83], a[168:171], v[144:147]
  v_mfma_f32_16x16x32_bf16 v[144:147], v[88:91], a[172:175], v[144:147]
  v_mfma_f32_16x16x32_bf16 v[148:151], v[68:71], a[160:163], v[148:151]
  v_add_u32 v16, 0x8000, v16
  v_mfma_f32_16x16x32_bf16 v[148:151], v[76:79], a[164:167], v[148:151]
  v_and_b32 v16, 0x1ffff, v16
  v_mfma_f32_16x16x32_bf16 v[148:151], v[84:87], a[168:171], v[148:151]
  v_add_u32 v17, 0x8000, v17
  v_mfma_f32_16x16x32_bf16 v[148:151], v[92:95], a[172:175], v[148:151]
  v_and_b32 v17, 0x1ffff, v17
  v_mfma_f32_16x16x32_bf16 v[152:155], v[64:67], a[224:227], v[152:155]
  v_add_u32 v18, 0x8000, v18
  v_mfma_f32_16x16x32_bf16 v[152:155], v[72:75], a[228:231], v[152:155]
  v_and_b32 v18, 0x1ffff, v18
  v_mfma_f32_16x16x32_bf16 v[152:155], v[80:83], a[232:235], v[152:155]
  v_add_u32 v19, 0x8000, v19
  v_mfma_f32_16x16x32_bf16 v[152:155], v[88:91], a[236:239], v[152:155]
  v_and_b32 v19, 0x1ffff, v19
  v_mfma_f32_16x16x32_bf16 v[156:159], v[68:71], a[224:227], v[156:159]
  s_sub_u32 s59, s63, 1
  s_max_i32 s59, s59, 0
  v_mfma_f32_16x16x32_bf16 v[156:159], v[76:79], a[228:231], v[156:159]
  v_mov_b32 v7, s59
  v_mfma_f32_16x16x32_bf16 v[156:159], v[84:87], a[232:235], v[156:159]
  s_cmp_lt_u32 s63, s80
  v_mfma_f32_16x16x32_bf16 v[156:159], v[92:95], a[236:239], v[156:159]
  s_waitcnt lgkmcnt(0)
  v_mfma_f32_16x16x32_bf16 v[128:131], v[96:99], a[48:51], v[128:131]
  s_waitcnt vmcnt(20)
  s_cbranch_scc1 L_f_e_29
L_f_e_29b:
  v_mfma_f32_16x16x32_bf16 v[128:131], v[104:107], a[52:55], v[128:131]
  s_barrier
  v_mfma_f32_16x16x32_bf16 v[128:131], v[112:115], a[56:59], v[128:131]
  ds_read_b128 v[64:67], v16 offset:0
  v_mfma_f32_16x16x32_bf16 v[128:131], v[120:123], a[60:63], v[128:131]
  buffer_store_dword v7, v6, s[40:43], s64 offen sc1
  v_mfma_f32_16x16x32_bf16 v[132:135], v[100:103], a[48:51], v[132:135]
  s_lshr_b32 s62, s63, 3
  ds_read_b128 v[68:71], v16 offset:16384
  v_mfma_f32_16x16x32_bf16 v[132:135], v[108:111], a[52:55], v[132:135]
  s_lshl_b32 s62, s62, 2
  v_mfma_f32_16x16x32_bf16 v[132:135], v[116:119], a[56:59], v[132:135]
  s_lshr_b32 s62, s73, s62
  ds_read_b128 v[72:75], v17 offset:0
  v_mfma_f32_16x16x32_bf16 v[132:135], v[124:127], a[60:63], v[132:135]
  s_and_b32 s62, s62, 7
  v_mfma_f32_16x16x32_bf16 v[136:139], v[96:99], a[112:115], v[136:139]
  s_and_b32 s59, s63, 7
  ds_read_b128 v[76:79], v17 offset:16384
  v_mfma_f32_16x16x32_bf16 v[136:139], v[104:107], a[116:119], v[136:139]
  s_lshl3_add_u32 s62, s62, s59
  v_mfma_f32_16x16x32_bf16 v[136:139], v[112:115], a[120:123], v[136:139]
  s_lshl_b32 s62, s62, 13
  ds_read_b128 v[80:83], v18 offset:0
  v_mfma_f32_16x16x32_bf16 v[136:139], v[120:123], a[124:127], v[136:139]
  s_add_u32 s62, s62, s65
  v_mfma_f32_16x16x32_bf16 v[140:143], v[100:103], a[112:115], v[140:143]
  s_add_u32 s70, s70, 1
  ds_read_b128 v[84:87], v18 offset:16384
  v_mfma_f32_16x16x32_bf16 v[140:143], v[108:111], a[116:119], v[140:143]
  s_lshr_b32 s61, s70, 3
  v_mfma_f32_16x16x32_bf16 v[140:143], v[116:119], a[120:123], v[140:143]
  s_lshl_b32 s61, s61, 2
  ds_read_b128 v[88:91], v19 offset:0
  v_mfma_f32_16x16x32_bf16 v[140:143], v[124:127], a[124:127], v[140:143]
  s_lshr_b32 s61, s73, s61
  v_mfma_f32_16x16x32_bf16 v[144:147], v[96:99], a[176:179], v[144:147]
  s_and_b32 s61, s61, 7
  ds_read_b128 v[92:95], v19 offset:16384
  v_mfma_f32_16x16x32_bf16 v[144:147], v[104:107], a[180:183], v[144:147]
  s_and_b32 s59, s70, 7
  v_mfma_f32_16x16x32_bf16 v[144:147], v[112:115], a[184:187], v[144:147]
  s_lshl3_add_u32 s61, s61, s59
  v_mfma_f32_16x16x32_bf16 v[144:147], v[120:123], a[188:191], v[144:147]
  s_lshl_b32 s61, s61, 15
  v_mfma_f32_16x16x32_bf16 v[148:151], v[100:103], a[176:179], v[148:151]
  s_add_u32 s61, s61, s71
  v_mfma_f32_16x16x32_bf16 v[148:151], v[108:111], a[180:183], v[148:151]
  s_add_u32 s66, s66, 0x8000
  v_mfma_f32_16x16x32_bf16 v[148:151], v[116:119], a[184:187], v[148:151]
  s_and_b32 s66, s66, 0x1ffff
  v_mfma_f32_16x16x32_bf16 v[148:151], v[124:127], a[188:191], v[148:151]
  v_mfma_f32_16x16x32_bf16 v[152:155], v[96:99], a[240:243], v[152:155]
  s_add_u32 s63, s63, 1
  v_mfma_f32_16x16x32_bf16 v[152:155], v[104:107], a[244:247], v[152:155]
  v_mfma_f32_16x16x32_bf16 v[152:155], v[112:115], a[248:251], v[152:155]
  v_mfma_f32_16x16x32_bf16 v[152:155], v[120:123], a[252:255], v[152:155]
  v_mfma_f32_16x16x32_bf16 v[156:159], v[100:103], a[240:243], v[156:159]
  v_mfma_f32_16x16x32_bf16 v[156:159], v[108:111], a[244:247], v[156:159]
  v_mfma_f32_16x16x32_bf16 v[156:159], v[116:119], a[248:251], v[156:159]
  s_cmp_lt_u32 s63, s67
  v_mfma_f32_16x16x32_bf16 v[156:159], v[124:127], a[252:255], v[156:159]
  s_waitcnt lgkmcnt(0)
L_f_11:
  v_mfma_f32_16x16x32_bf16 v[160:163], v[64:67], a[0:3], 0
  v_mfma_f32_16x16x32_bf16 v[160:163], v[72:75], a[4:7], v[160:163]
  v_mfma_f32_16x16x32_bf16 v[160:163], v[80:83], a[8:11], v[160:163]
  ds_read_b128 v[96:99], v16 offset:256
  v_mfma_f32_16x16x32_bf16 v[160:163], v[88:91], a[12:15], v[160:163]
  s_cmp_lg_u32 s57, 6
  s_cbranch_scc1 L_f_pw_32
  buffer_store_dwordx4 v[36:39], v2, s[40:43], s79 offen sc1
  s_add_u32 s79, s79, 0x20000
L_f_pw_32:
  v_mfma_f32_16x16x32_bf16 v[164:167], v[68:71], a[0:3], 0
  ds_read_b128 v[100:103], v16 offset:16640
  v_mfma_f32_16x16x32_bf16 v[164:167], v[76:79], a[4:7], v[164:167]
  v_mfma_f32_16x16x32_bf16 v[164:167], v[84:87], a[8:11], v[164:167]
  ds_read_b128 v[104:107], v17 offset:256
  v_mfma_f32_16x16x32_bf16 v[164:167], v[92:95], a[12:15], v[164:167]
  v_mfma_f32_16x16x32_bf16 v[168:171], v[64:67], a[64:67], 0
  ds_read_b128 v[108:111], v17 offset:16640
  v_mfma_f32_16x16x32_bf16 v[168:171], v[72:75], a[68:71], v[168:171]
  v_cvt_pk_bf16_f32 v192, v128, v129
  v_cvt_pk_bf16_f32 v193, v130, v131
  v_mfma_f32_16x16x32_bf16 v[168:171], v[80:83], a[72:75], v[168:171]
  ds_read_b128 v[112:115], v18 offset:256
  v_cvt_pk_bf16_f32 v194, v132, v133
  v_mfma_f32_16x16x32_bf16 v[168:171], v[88:91], a[76:79], v[168:171]
  v_cvt_pk_bf16_f32 v195, v134, v135
  v_mfma_f32_16x16x32_bf16 v[172:175], v[68:71], a[64:67], 0
  ds_read_b128 v[116:119], v18 offset:16640
  v_mfma_f32_16x16x32_bf16 v[172:175], v[76:79], a[68:71], v[172:175]
  buffer_store_dwordx4 v[192:195], v2, s[40:43], s62 offen offset:0 sc1
  v_mfma_f32_16x16x32_bf16 v[172:175], v[84:87], a[72:75], v[172:175]
  ds_read_b128 v[120:123], v19 offset:256
  v_cvt_pk_bf16_f32 v196, v136, v137
  v_mfma_f32_16x16x32_bf16 v[172:175], v[92:95], a[76:79], v[172:175]
  v_cvt_pk_bf16_f32 v197, v138, v139
  v_cvt_pk_bf16_f32 v198, v140, v141
  v_mfma_f32_16x16x32_bf16 v[176:179], v[64:67], a[128:131], 0
  ds_read_b128 v[124:127], v19 offset:16640
  v_cvt_pk_bf16_f32 v199, v142, v143
  v_mfma_f32_16x16x32_bf16 v[176:179], v[72:75], a[132:135], v[176:179]
  buffer_store_dwordx4 v[196:199], v2, s[40:43], s62 offen offset:1024 sc1
  v_mfma_f32_16x16x32_bf16 v[176:179], v[80:83], a[136:139], v[176:179]
  v_cvt_pk_bf16_f32 v200, v144, v145
  v_cvt_pk_bf16_f32 v201, v146, v147
  v_mfma_f32_16x16x32_bf16 v[176:179], v[88:91], a[140:143], v[176:179]
  v_cvt_pk_bf16_f32 v202, v148, v149
  v_cvt_pk_bf16_f32 v203, v150, v151
  v_mfma_f32_16x16x32_bf16 v[180:183], v[68:71], a[128:131], 0
  buffer_store_dwordx4 v[200:203], v2, s[40:43], s62 offen offset:2048 sc1
  v_mfma_f32_16x16x32_bf16 v[180:183], v[76:79], a[132:135], v[180:183]
  v_cvt_pk_bf16_f32 v204, v152, v153
  v_cvt_pk_bf16_f32 v205, v154, v155
  v_mfma_f32_16x16x32_bf16 v[180:183], v[84:87], a[136:139], v[180:183]
  v_cvt_pk_bf16_f32 v206, v156, v157
  v_cvt_pk_bf16_f32 v207, v158, v159
  v_mfma_f32_16x16x32_bf16 v[180:183], v[92:95], a[140:143], v[180:183]
  buffer_store_dwordx4 v[204:207], v2, s[40:43], s62 offen offset:3072 sc1
  v_mfma_f32_16x16x32_bf16 v[184:187], v[64:67], a[192:195], 0
  v_mfma_f32_16x16x32_bf16 v[184:187], v[72:75], a[196:199], v[184:187]
  v_mfma_f32_16x16x32_bf16 v[184:187], v[80:83], a[200:203], v[184:187]
  v_mfma_f32_16x16x32_bf16 v[184:187], v[88:91], a[204:207], v[184:187]
  v_mfma_f32_16x16x32_bf16 v[188:191], v[68:71], a[192:195], 0
  v_mfma_f32_16x16x32_bf16 v[188:191], v[76:79], a[196:199], v[188:191]
  v_mfma_f32_16x16x32_bf16 v[188:191], v[84:87], a[200:203], v[188:191]
  v_mfma_f32_16x16x32_bf16 v[188:191], v[92:95], a[204:207], v[188:191]
  s_waitcnt lgkmcnt(0)
  v_mfma_f32_16x16x32_bf16 v[160:163], v[96:99], a[16:19], v[160:163]
  v_mfma_f32_16x16x32_bf16 v[160:163], v[104:107], a[20:23], v[160:163]
  v_mfma_f32_16x16x32_bf16 v[160:163], v[112:115], a[24:27], v[160:163]
  ds_read_b128 v[64:67], v16 offset:512
  v_mfma_f32_16x16x32_bf16 v[160:163], v[120:123], a[28:31], v[160:163]
  v_mfma_f32_16x16x32_bf16 v[164:167], v[100:103], a[16:19], v[164:167]
  ds_read_b128 v[68:71], v16 offset:16896
  v_mfma_f32_16x16x32_bf16 v[164:167], v[108:111], a[20:23], v[164:167]
  v_mfma_f32_16x16x32_bf16 v[164:167], v[116:119], a[24:27], v[164:167]
  ds_read_b128 v[72:75], v17 offset:512
  v_mfma_f32_16x16x32_bf16 v[164:167], v[124:127], a[28:31], v[164:167]
  v_mfma_f32_16x16x32_bf16 v[168:171], v[96:99], a[80:83], v[168:171]
  ds_read_b128 v[76:79], v17 offset:16896
  v_mfma_f32_16x16x32_bf16 v[168:171], v[104:107], a[84:87], v[168:171]
  v_mfma_f32_16x16x32_bf16 v[168:171], v[112:115], a[88:91], v[168:171]
  ds_read_b128 v[80:83], v18 offset:512
  v_mfma_f32_16x16x32_bf16 v[168:171], v[120:123], a[92:95], v[168:171]
  v_mfma_f32_16x16x32_bf16 v[172:175], v[100:103], a[80:83], v[172:175]
  ds_read_b128 v[84:87], v18 offset:16896
  v_mfma_f32_16x16x32_bf16 v[172:175], v[108:111], a[84:87], v[172:175]
  v_mfma_f32_16x16x32_bf16 v[172:175], v[116:119], a[88:91], v[172:175]
  ds_read_b128 v[88:91], v19 offset:512
  v_mfma_f32_16x16x32_bf16 v[172:175], v[124:127], a[92:95], v[172:175]
  v_mfma_f32_16x16x32_bf16 v[176:179], v[96:99], a[144:147], v[176:179]
  ds_read_b128 v[92:95], v19 offset:16896
  v_mfma_f32_16x16x32_bf16 v[176:179], v[104:107], a[148:151], v[176:179]
  v_mfma_f32_16x16x32_bf16 v[176:179], v[112:115], a[152:155], v[176:179]
  v_mfma_f32_16x16x32_bf16 v[176:179], v[120:123], a[156:159], v[176:179]
  s_add_u32 m0, s66, 0
  s_add_u32 s58, s61, 0
  v_mfma_f32_16x16x32_bf16 v[180:183], v[100:103], a[144:147], v[180:183]
  v_mfma_f32_16x16x32_bf16 v[180:183], v[108:111], a[148:151], v[180:183]
  buffer_load_dwordx4 v8, s[52:55], s58 offen lds
  v_mfma_f32_16x16x32_bf16 v[180:183], v[116:119], a[152:155], v[180:183]
  v_mfma_f32_16x16x32_bf16 v[180:183], v[124:127], a[156:159], v[180:183]
  s_add_u32 m0, s66, 1024
  s_add_u32 s58, s61, 1024
  v_mfma_f32_16x16x32_bf16 v[184:187], v[96:99], a[208:211], v[184:187]
  v_mfma_f32_16x16x32_bf16 v[184:187], v[104:107], a[212:215], v[184:187]
  buffer_load_dwordx4 v9, s[52:55], s58 offen lds
  v_mfma_f32_16x16x32_bf16 v[184:187], v[112:115], a[216:219], v[184:187]
  v_mfma_f32_16x16x32_bf16 v[184:187], v[120:123], a[220:223], v[184:187]
  s_add_u32 m0, s66, 2048
  s_add_u32 s58, s61, 2048
  v_mfma_f32_16x16x32_bf16 v[188:191], v[100:103], a[208:211], v[188:191]
  v_mfma_f32_16x16x32_bf16 v[188:191], v[108:111], a[212:215], v[188:191]
  buffer_load_dwordx4 v10, s[52:55], s58 offen lds
  v_mfma_f32_16x16x32_bf16 v[188:191], v[116:119], a[216:219], v[188:191]
  v_mfma_f32_16x16x32_bf16 v[188:191], v[124:127], a[220:223], v[188:191]
  s_waitcnt lgkmcnt(0)
  s_add_u32 m0, s66, 3072
  s_add_u32 s58, s61, 3072
  v_mfma_f32_16x16x32_bf16 v[160:163], v[64:67], a[32:35], v[160:163]
  v_mfma_f32_16x16x32_bf16 v[160:163], v[72:75], a[36:39], v[160:163]
  buffer_load_dwordx4 v11, s[52:55], s58 offen lds
  v_mfma_f32_16x16x32_bf16 v[160:163], v[80:83], a[40:43], v[160:163]
  ds_read_b128 v[96:99], v16 offset:768
  v_mfma_f32_16x16x32_bf16 v[160:163], v[88:91], a[44:47], v[160:163]
  s_add_u32 m0, s66, 4096
  s_add_u32 s58, s61, 4096
  v_mfma_f32_16x16x32_bf16 v[164:167], v[68:71], a[32:35], v[164:167]
  ds_read_b128 v[100:103], v16 offset:17152
  v_mfma_f32_16x16x32_bf16 v[164:167], v[76:79], a[36:39], v[164:167]
  buffer_load_dwordx4 v12, s[52:55], s58 offen lds
  v_mfma_f32_16x16x32_bf16 v[164:167], v[84:87], a[40:43], v[164:167]
  ds_read_b128 v[104:107], v17 offset:768
  v_mfma_f32_16x16x32_bf16 v[164:167], v[92:95], a[44:47], v[164:167]
  s_add_u32 m0, s66, 5120
  s_add_u32 s58, s61, 5120
  v_mfma_f32_16x16x32_bf16 v[168:171], v[64:67], a[96:99], v[168:171]
  ds_read_b128 v[108:111], v17 offset:17152
  v_mfma_f32_16x16x32_bf16 v[168:171], v[72:75], a[100:103], v[168:171]
  buffer_load_dwordx4 v13, s[52:55], s58 offen lds
  v_mfma_f32_16x16x32_bf16 v[168:171], v[80:83], a[104:107], v[168:171]
  ds_read_b128 v[112:115], v18 offset:768
  v_mfma_f32_16x16x32_bf16 v[168:171], v[88:91], a[108:111], v[168:171]
  s_add_u32 m0, s66, 6144
  s_add_u32 s58, s61, 6144
  v_mfma_f32_16x16x32_bf16 v[172:175], v[68:71], a[96:99], v[172:175]
  ds_read_b128 v[116:119], v18 offset:17152
  v_mfma_f32_16x16x32_bf16 v[172:175], v[76:79], a[100:103], v[172:175]
  buffer_load_dwordx4 v14, s[52:55], s58 offen lds
  v_mfma_f32_16x16x32_bf16 v[172:175], v[84:87], a[104:107], v[172:175]
  ds_read_b128 v[120:123], v19 offset:768
  v_mfma_f32_16x16x32_bf16 v[172:175], v[92:95], a[108:111], v[172:175]
  s_add_u32 m0, s66, 7168
  s_add_u32 s58, s61, 7168
  v_mfma_f32_16x16x32_bf16 v[176:179], v[64:67], a[160:163], v[176:179]
  ds_read_b128 v[124:127], v19 offset:17152
  v_mfma_f32_16x16x32_bf16 v[176:179], v[72:75], a[164:167], v[176:179]
  buffer_load_dwordx4 v15, s[52:55], s58 offen lds
  v_mfma_f32_16x16x32_bf16 v[176:179], v[80:83], a[168:171], v[176:179]
  v_mfma_f32_16x16x32_bf16 v[176:179], v[88:91], a[172:175], v[176:179]
  v_mfma_f32_16x16x32_bf16 v[180:183], v[68:71], a[160:163], v[180:183]
  v_add_u32 v16, 0x8000, v16
  v_mfma_f32_16x16x32_bf16 v[180:183], v[76:79], a[164:167], v[180:183]
  v_and_b32 v16, 0x1ffff, v16
  v_mfma_f32_16x16x32_bf16 v[180:183], v[84:87], a[168:171], v[180:183]
  v_add_u32 v17, 0x8000, v17
  v_mfma_f32_16x16x32_bf16 v[180:183], v[92:95], a[172:175], v[180:183]
  v_and_b32 v17, 0x1ffff, v17
  v_mfma_f32_16x16x32_bf16 v[184:187], v[64:67], a[224:227], v[184:187]
  v_add_u32 v18, 0x8000, v18
  v_mfma_f32_16x16x32_bf16 v[184:187], v[72:75], a[228:231], v[184:187]
  v_and_b32 v18, 0x1ffff, v18
  v_mfma_f32_16x16x32_bf16 v[184:187], v[80:83], a[232:235], v[184:187]
  v_add_u32 v19, 0x8000, v19
  v_mfma_f32_16x16x32_bf16 v[184:187], v[88:91], a[236:239], v[184:187]
  v_and_b32 v19, 0x1ffff, v19
  v_mfma_f32_16x16x32_bf16 v[188:191], v[68:71], a[224:227], v[188:191]
  s_sub_u32 s59, s63, 1
  s_max_i32 s59, s59, 0
  v_mfma_f32_16x16x32_bf16 v[188:191], v[76:79], a[228:231], v[188:191]
  v_mov_b32 v7, s59
  v_mfma_f32_16x16x32_bf16 v[188:191], v[84:87], a[232:235], v[188:191]
  s_cmp_lt_u32 s63, s80
  v_mfma_f32_16x16x32_bf16 v[188:191], v[92:95], a[236:239], v[188:191]
  s_waitcnt lgkmcnt(0)
  v_mfma_f32_16x16x32_bf16 v[160:163], v[96:99], a[48:51], v[160:163]
  s_waitcnt vmcnt(20)
  s_cbranch_scc1 L_f_e_31
L_f_e_31b:
  v_mfma_f32_16x16x32_bf16 v[160:163], v[104:107], a[52:55], v[160:163]
  s_barrier
  v_mfma_f32_16x16x32_bf16 v[160:163], v[112:115], a[56:59], v[160:163]
  ds_read_b128 v[64:67], v16 offset:0
  v_mfma_f32_16x16x32_bf16 v[160:163], v[120:123], a[60:63], v[160:163]
  buffer_store_dword v7, v6, s[40:43], s64 offen sc1
  v_mfma_f32_16x16x32_bf16 v[164:167], v[100:103], a[48:51], v[164:167]
  s_lshr_b32 s62, s63, 3
  ds_read_b128 v[68:71], v16 offset:16384
  v_mfma_f32_16x16x32_bf16 v[164:167], v[108:111], a[52:55], v[164:167]
  s_lshl_b32 s62, s62, 2
  v_mfma_f32_16x16x32_bf16 v[164:167], v[116:119], a[56:59], v[164:167]
  s_lshr_b32 s62, s73, s62
  ds_read_b128 v[72:75], v17 offset:0
  v_mfma_f32_16x16x32_bf16 v[164:167], v[124:127], a[60:63], v[164:167]
  s_and_b32 s62, s62, 7
  v_mfma_f32_16x16x32_bf16 v[168:171], v[96:99], a[112:115], v[168:171]
  s_and_b32 s59, s63, 7
  ds_read_b128 v[76:79], v17 offset:16384
  v_mfma_f32_16x16x32_bf16 v[168:171], v[104:107], a[116:119], v[168:171]
  s_lshl3_add_u32 s62, s62, s59
  v_mfma_f32_16x16x32_bf16 v[168:171], v[112:115], a[120:123], v[168:171]
  s_lshl_b32 s62, s62, 13
  ds_read_b128 v[80:83], v18 offset:0
  v_mfma_f32_16x16x32_bf16 v[168:171], v[120:123], a[124:127], v[168:171]
  s_add_u32 s62, s62, s65
  v_mfma_f32_16x16x32_bf16 v[172:175], v[100:103], a[112:115], v[172:175]
  s_add_u32 s70, s70, 1
  ds_read_b128 v[84:87], v18 offset:16384
  v_mfma_f32_16x16x32_bf16 v[172:175], v[108:111], a[116:119], v[172:175]
  s_lshr_b32 s61, s70, 3
  v_mfma_f32_16x16x32_bf16 v[172:175], v[116:119], a[120:123], v[172:175]
  s_lshl_b32 s61, s61, 2
  ds_read_b128 v[88:91], v19 offset:0
  v_mfma_f32_16x16x32_bf16 v[172:175], v[124:127], a[124:127], v[172:175]
  s_lshr_b32 s61, s73, s61
  v_mfma_f32_16x16x32_bf16 v[176:179], v[96:99], a[176:179], v[176:179]
  s_and_b32 s61, s61, 7
  ds_read_b128 v[92:95], v19 offset:16384
  v_mfma_f32_16x16x32_bf16 v[176:179], v[104:107], a[180:183], v[176:179]
  s_and_b32 s59, s70, 7
  v_mfma_f32_16x16x32_bf16 v[176:179], v[112:115], a[184:187], v[176:179]
  s_lshl3_add_u32 s61, s61, s59
  v_mfma_f32_16x16x32_bf16 v[176:179], v[120:123], a[188:191], v[176:179]
  s_lshl_b32 s61, s61, 15
  v_mfma_f32_16x16x32_bf16 v[180:183], v[100:103], a[176:179], v[180:183]
  s_add_u32 s61, s61, s71
  v_mfma_f32_16x16x32_bf16 v[180:183], v[108:111], a[180:183], v[180:183]
  s_add_u32 s66, s66, 0x8000
  v_mfma_f32_16x16x32_bf16 v[180:183], v[116:119], a[184:187], v[180:183]
  s_and_b32 s66, s66, 0x1ffff
  v_mfma_f32_16x16x32_bf16 v[180:183], v[124:127], a[188:191], v[180:183]
  v_mfma_f32_16x16x32_bf16 v[184:187], v[96:99], a[240:243], v[184:187]
  s_add_u32 s63, s63, 1
  v_mfma_f32_16x16x32_bf16 v[184:187], v[104:107], a[244:247], v[184:187]
  v_mfma_f32_16x16x32_bf16 v[184:187], v[112:115], a[248:251], v[184:187]
  v_mfma_f32_16x16x32_bf16 v[184:187], v[120:123], a[252:255], v[184:187]
  v_mfma_f32_16x16x32_bf16 v[188:191], v[100:103], a[240:243], v[188:191]
  v_mfma_f32_16x16x32_bf16 v[188:191], v[108:111], a[244:247], v[188:191]
  v_mfma_f32_16x16x32_bf16 v[188:191], v[116:119], a[248:251], v[188:191]
  s_cmp_lt_u32 s63, s67
  v_mfma_f32_16x16x32_bf16 v[188:191], v[124:127], a[252:255], v[188:191]
  s_waitcnt lgkmcnt(0)
  s_cbranch_scc1 L_f_10
  s_branch L_f_done
L_f_e_25:
  v_mov_b32 v7, s63
  s_waitcnt vmcnt(8)
  s_branch L_f_e_25b
L_f_e_27:
  v_mov_b32 v7, s63
  s_waitcnt vmcnt(8)
  s_branch L_f_e_27b
L_f_e_29:
  v_mov_b32 v7, s63
  s_waitcnt vmcnt(8)
  s_branch L_f_e_29b
L_f_e_31:
  v_mov_b32 v7, s63
  s_waitcnt vmcnt(8)
  s_branch L_f_e_31b
L_f_done:
  s_nop 7
  v_mul_f32 v160, s69, v160
  v_mul_f32 v161, s69, v161
  v_mul_f32 v162, s69, v162
  v_mul_f32 v163, s69, v163
  v_mul_f32 v164, s69, v164
  v_mul_f32 v165, s69, v165
  v_mul_f32 v166, s69, v166
  v_mul_f32 v167, s69, v167
  v_cvt_pk_bf16_f32 v192, v160, v161
  v_cvt_pk_bf16_f32 v193, v162, v163
  v_cvt_pk_bf16_f32 v194, v164, v165
  v_cvt_pk_bf16_f32 v195, v166, v167
  buffer_store_dwordx4 v[192:195], v2, s[40:43], s62 offen offset:0 sc1
  v_mul_f32 v168, s69, v168
  v_mul_f32 v169, s69, v169
  v_mul_f32 v170, s69, v170
  v_mul_f32 v171, s69, v171
  v_mul_f32 v172, s69, v172
  v_mul_f32 v173, s69, v173
  v_mul_f32 v174, s69, v174
  v_mul_f32 v175, s69, v175
  v_cvt_pk_bf16_f32 v196, v168, v169
  v_cvt_pk_bf16_f32 v197, v170, v171
  v_cvt_pk_bf16_f32 v198, v172, v173
  v_cvt_pk_bf16_f32 v199, v174, v175
  buffer_store_dwordx4 v[196:199], v2, s[40:43], s62 offen offset:1024 sc1
  v_mul_f32 v176, s69, v176
  v_mul_f32 v177, s69, v177
  v_mul_f32 v178, s69, v178
  v_mul_f32 v179, s69, v179
  v_mul_f32 v180, s69, v180
  v_mul_f32 v181, s69, v181
  v_mul_f32 v182, s69, v182
  v_mul_f32 v183, s69, v183
  v_cvt_pk_bf16_f32 v200, v176, v177
  v_cvt_pk_bf16_f32 v201, v178, v179
  v_cvt_pk_bf16_f32 v202, v180, v181
  v_cvt_pk_bf16_f32 v203, v182, v183
  buffer_store_dwordx4 v[200:203], v2, s[40:43], s62 offen offset:2048 sc1
  v_mul_f32 v184, s69, v184
  v_mul_f32 v185, s69, v185
  v_mul_f32 v186, s69, v186
  v_mul_f32 v187, s69, v187
  v_mul_f32 v188, s69, v188
  v_mul_f32 v189, s69, v189
  v_mul_f32 v190, s69, v190
  v_mul_f32 v191, s69, v191
  v_cvt_pk_bf16_f32 v204, v184, v185
  v_cvt_pk_bf16_f32 v205, v186, v187
  v_cvt_pk_bf16_f32 v206, v188, v189
  v_cvt_pk_bf16_f32 v207, v190, v191
  buffer_store_dwordx4 v[204:207], v2, s[40:43], s62 offen offset:3072 sc1
  v_mov_b32 v7, s67
  s_waitcnt vmcnt(0) lgkmcnt(0)
  s_barrier
  buffer_store_dword v7, v6, s[40:43], s64 offen sc1
  s_branch L_next
L_after_p:
  s_waitcnt vmcnt(0)
  s_endpgm
L_team:
  s_mov_b32 s67, 0
  v_lshrrev_b32 v20, 4, v0
  v_and_b32 v21, 15, v0
  v_bfe_u32 v22, v0, 4, 1
  v_lshrrev_b32 v23, 5, v0
  s_lshl_b32 s68, s44, 1
  v_or_b32 v24, s68, v22
  v_lshlrev_b32 v24, 1, v24
  v_xor_b32 v24, v24, v21
  v_lshlrev_b32 v24, 4, v24
  v_lshl_add_u32 v25, v22, 4, v23
  v_add_u32 v25, s68, v25
  v_lshl_add_u32 v44, v25, 13, v24
  s_lshl_b32 s69, s45, 8
  v_add_u32 v44, s69, v44
  s_lshl_b32 s68, s44, 4
  v_add_u32 v25, s68, v20
  v_lshl_add_u32 v45, v25, 10, v24
  s_lshl_b32 s69, s45, 17
  v_add_u32 v45, s69, v45
  s_mov_b32 s50, 0x400000
  s_mov_b32 s51, 0x20000
  s_lshl_b32 s56, s44, 10
  s_mov_b32 s48, s30
  s_and_b32 s49, s31, 0xffff
  s_add_u32 m0, s56, 0
  s_mov_b32 s68, 0
  buffer_load_dwordx4 v45, s[48:51], s68 offen  lds
  s_add_u32 m0, s56, 4096
  s_mov_b32 s68, 4096
  buffer_load_dwordx4 v45, s[48:51], s68 offen  lds
  s_add_u32 m0, s56, 8192
  s_mov_b32 s68, 8192
  buffer_load_dwordx4 v45, s[48:51], s68 offen  lds
  s_add_u32 m0, s56, 12288
  s_mov_b32 s68, 12288
  buffer_load_dwordx4 v45, s[48:51], s68 offen  lds
  s_add_u32 m0, s56, 16384
  s_mov_b32 s68, 65536
  buffer_load_dwordx4 v45, s[48:51], s68 offen  lds
  s_add_u32 m0, s56, 20480
  s_mov_b32 s68, 69632
  buffer_load_dwordx4 v45, s[48:51], s68 offen  lds
  s_add_u32 m0, s56, 24576
  s_mov_b32 s68, 73728
  buffer_load_dwordx4 v45, s[48:51], s68 offen  lds
  s_add_u32 m0, s56, 28672
  s_mov_b32 s68, 77824
  buffer_load_dwordx4 v45, s[48:51], s68 offen  lds
  s_lshl_b32 s68, s44, 11
  s_add_u32 s68, s68, 131072
  v_lshl_add_u32 v2, v0, 4, s68
  s_add_u32 s73, s68, 8192
  s_lshl_b32 s68, s44, 12
  v_lshl_add_u32 v3, v0, 4, s68
  s_lshl_b32 s68, s44, 9
  s_add_u32 s68, s68, 131072
  v_bfe_u32 v22, v0, 3, 1
  v_lshl_add_u32 v5, v22, 8, s68
  v_lshl_add_u32 v5, v20, 6, v5
  v_and_b32 v22, 7, v0
  v_lshl_add_u32 v5, v22, 3, v5
  v_lshrrev_b32 v22, 5, v0
  v_lshlrev_b32 v6, 8, v22
  v_and_b32 v22, 3, v0
  v_lshl_add_u32 v6, v22, 6, v6
  v_bfe_u32 v22, v0, 2, 3
  v_lshl_add_u32 v6, v22, 3, v6
  v_add_u32 v6, 131072, v6
  s_lshl_b32 s68, s44, 9
  s_add_u32 s68, s68, 147456
  v_lshrrev_b32 v22, 1, v0
  v_lshl_add_u32 v7, v22, 4, s68
  s_lshl_b32 s68, s44, 14
  s_lshl_b32 s69, s45, 6
  s_add_u32 s68, s68, s69
  v_lshrrev_b32 v22, 3, v0
  v_lshl_add_u32 v8, v22, 11, s68
  v_and_b32 v22, 7, v0
  v_lshl_add_u32 v8, v22, 3, v8
  v_lshlrev_b32 v9, 8, v20
  v_bfe_u32 v22, v0, 2, 1
  v_lshl_add_u32 v9, v22, 7, v9
  v_and_b32 v22, 1, v0
  v_lshl_add_u32 v9, v22, 6, v9
  v_bfe_u32 v22, v0, 3, 1
  v_lshl_add_u32 v9, v22, 5, v9
  v_bfe_u32 v22, v0, 1, 1
  v_lshl_add_u32 v9, v22, 4, v9
  s_lshl_b32 s68, s44, 16
  s_lshl_b32 s69, s45, 11
  s_add_u32 s68, s68, s69
  s_add_u32 s62, s68, 0xd000000
  v_bfe_u32 v22, v0, 3, 1
  v_lshlrev_b32 v10, 13, v22
  v_lshl_add_u32 v10, v20, 3, v10
  v_bfe_u32 v22, v0, 1, 1
  v_lshl_add_u32 v10, v22, 5, v10
  v_bfe_u32 v22, v0, 2, 1
  v_lshl_add_u32 v10, v22, 2, v10
  v_and_b32 v22, 1, v0
  v_lshl_add_u32 v10, v22, 1, v10
  s_lshl_b32 s64, s44, 11
  s_lshr_b32 s68, s45, 3
  s_lshl_b32 s68, s68, 9
  s_add_u32 s64, s64, s68
  s_and_b32 s68, s45, 1
  s_lshl_b32 s68, s68, 8
  s_add_u32 s64, s64, s68
  s_bfe_u32 s68, s45, 0x20001
  s_lshl_b32 s68, s68, 6
  s_add_u32 s64, s64, s68
  s_add_u32 s64, s64, 0xd040000
  s_mov_b32 s63, 0xd022000
  s_lshl_b32 s60, s45, 7
  s_add_u32 s60, s60, 0xd081000
  s_lshl_b32 s72, s45, 19
  s_add_u32 s72, s72, 0x3fe0000
  s_mov_b32 s94, 0xaaaaaaaa
  s_mov_b32 s95, 0xaaaaaaaa
  v_mov_b32 v17, 0
  v_mov_b32 v18, 0
  v_mov_b32 v16, 0
  v_mov_b32 v12, 0x3f803f80
  v_mov_b32 v13, 0x3f803f80
  v_mov_b32 v14, 0x3f803f80
  v_mov_b32 v15, 0x3f803f80
  s_mov_b32 s78, 0xff00ff00
  s_mov_b32 s79, 0xff00ff00
  s_mov_b32 s88, 0x3e0293ee
  s_mov_b32 s89, 0x21800000
  s_mov_b32 s91, 0x3c000000
  s_mov_b32 s90, 0xfffe
  s_lshl_b32 s68, s44, 11
  s_add_u32 s70, s68, 147456
  s_add_u32 s71, s68, 139264
  s_lshl_b32 s68, s45, 7
  s_add_u32 s68, s68, 0xd084000
  s_cmp_eq_u32 s44, 0
  s_cselect_b32 s66, s68, 0x40000000
  s_mov_b32 s80, 0x3030303
  s_mov_b32 s81, 0x3030303
  s_mov_b32 s74, 0xd000000
  s_mov_b32 s82, 0xc0c0c0c
  s_mov_b32 s83, 0xc0c0c0c
  s_mov_b32 s75, 0xd010000
  s_mov_b32 s84, 0x30303030
  s_mov_b32 s85, 0x30303030
  s_mov_b32 s76, 0xd020000
  s_mov_b32 s86, 0xc0c0c0c0
  s_mov_b32 s87, 0xc0c0c0c0
  s_mov_b32 s77, 0xd030000
  buffer_store_dwordx2 v[16:17], v8, s[40:43], s74 offen sc1
  buffer_store_dwordx2 v[16:17], v8, s[40:43], s75 offen sc1
  buffer_store_dwordx2 v[16:17], v8, s[40:43], s76 offen sc1
  buffer_store_dwordx2 v[16:17], v8, s[40:43], s77 offen sc1
  v_mov_b32 v22, 0xffff
  buffer_store_short v22, v10, s[40:43], s64 offen sc1
  s_mul_i32 s68, s44, 4
  s_lshr_b32 s68, 0x7640, s68
  s_and_b32 s68, s68, 15
  s_lshl_b32 s68, s68, 12
  s_lshl_b32 s69, s45, 7
  s_add_u32 s68, s68, s69
  s_add_u32 s68, s68, 0xd080000
  v_and_b32 v23, 31, v0
  v_lshlrev_b32 v23, 2, v23
  v_lshrrev_b32 v24, 5, v0
  v_lshl_add_u32 v23, v24, 12, v23
  buffer_store_dword v17, v23, s[40:43], s68 offen sc1
  s_mov_b32 s52, s22
  s_and_b32 s53, s23, 0xffff
  s_mov_b32 s54, 0x2000
  s_mov_b32 s55, 0x20000
  v_bfe_u32 v22, v0, 1, 3
  v_lshlrev_b32 v23, 10, v22
  v_lshrrev_b32 v22, 5, v0
  v_lshl_add_u32 v23, v22, 6, v23
  v_bfe_u32 v22, v0, 4, 1
  v_lshl_add_u32 v23, v22, 4, v23
  v_and_b32 v22, 1, v0
  v_lshl_add_u32 v23, v22, 3, v23
  s_lshl_b32 s68, s44, 8
  buffer_load_dwordx2 v[92:93], v23, s[52:55], s68 offen
  buffer_load_dwordx2 v[94:95], v23, s[52:55], s68 offen offset:32
  buffer_load_dwordx2 v[96:97], v23, s[52:55], s68 offen offset:128
  buffer_load_dwordx2 v[98:99], v23, s[52:55], s68 offen offset:160
  v_lshrrev_b32 v22, 5, v0
  v_lshlrev_b32 v46, 12, v22
  v_bfe_u32 v22, v0, 3, 1
  v_lshl_add_u32 v46, v22, 11, v46
  v_lshlrev_b32 v24, 2, v22
  v_bfe_u32 v22, v0, 4, 1
  v_lshl_add_u32 v46, v22, 10, v46
  v_lshl_add_u32 v24, v22, 1, v24
  v_bfe_u32 v22, v0, 2, 1
  v_lshl_add_u32 v46, v22, 8, v46
  v_add_u32 v24, v24, v22
  s_lshl_b32 s68, s44, 1
  v_xor_b32 v24, s68, v24
  v_lshl_add_u32 v46, v24, 5, v46
  v_and_b32 v22, 3, v0
  v_lshl_add_u32 v46, v22, 3, v46
  v_xor_b32 v47, 32, v46
  v_bfe_u32 v22, v0, 3, 1
  v_mul_u32_u24 v22, 2208, v22
  v_xor_b32 v50, v22, v46
  v_xor_b32 v51, 2176, v50
  s_mov_b32 s52, s38
  s_and_b32 s53, s39, 0xffff
  s_mov_b32 s54, 0x100
  s_mov_b32 s55, 0x20000
  s_add_u32 m0, s56, 32768
  s_mov_b32 s68, 256
  buffer_load_dwordx4 v45, s[48:51], s68 offen  lds
  s_add_u32 m0, s56, 36864
  s_mov_b32 s68, 4352
  buffer_load_dwordx4 v45, s[48:51], s68 offen  lds
  s_add_u32 m0, s56, 40960
  s_mov_b32 s68, 8448
  buffer_load_dwordx4 v45, s[48:51], s68 offen  lds
  s_add_u32 m0, s56, 45056
  s_mov_b32 s68, 12544
  buffer_load_dwordx4 v45, s[48:51], s68 offen  lds
  s_waitcnt vmcnt(8)
  s_barrier
  s_add_u32 m0, s56, 49152
  s_mov_b32 s68, 65792
  buffer_load_dwordx4 v45, s[48:51], s68 offen  lds
  s_add_u32 m0, s56, 53248
  s_mov_b32 s68, 69888
  buffer_load_dwordx4 v45, s[48:51], s68 offen  lds
  s_add_u32 m0, s56, 57344
  s_mov_b32 s68, 73984
  buffer_load_dwordx4 v45, s[48:51], s68 offen  lds
  s_add_u32 m0, s56, 61440
  s_mov_b32 s68, 78080
  buffer_load_dwordx4 v45, s[48:51], s68 offen  lds
  v_add_u32 v48, 0, v50
  v_add_u32 v49, 0, v51
  s_cmp_lg_u32 s44, 0
  s_cbranch_scc1 L_wr_0_1
  ds_read_b64_tr_b16 v[128:129], v48 offset:0
  ds_read_b64_tr_b16 v[130:131], v48 offset:512
  ds_read_b64_tr_b16 v[132:133], v48 offset:8192
  ds_read_b64_tr_b16 v[134:135], v48 offset:8704
  ds_read_b64_tr_b16 v[136:137], v49 offset:0
  ds_read_b64_tr_b16 v[138:139], v49 offset:512
  ds_read_b64_tr_b16 v[140:141], v49 offset:8192
  ds_read_b64_tr_b16 v[142:143], v49 offset:8704
  s_branch L_wr_0_e
L_wr_0_1:
  s_cmp_lg_u32 s44, 1
  s_cbranch_scc1 L_wr_0_2
  ds_read_b64_tr_b16 v[136:137], v48 offset:0
  ds_read_b64_tr_b16 v[138:139], v48 offset:512
  ds_read_b64_tr_b16 v[140:141], v48 offset:8192
  ds_read_b64_tr_b16 v[142:143], v48 offset:8704
  ds_read_b64_tr_b16 v[128:129], v49 offset:0
  ds_read_b64_tr_b16 v[130:131], v49 offset:512
  ds_read_b64_tr_b16 v[132:133], v49 offset:8192
  ds_read_b64_tr_b16 v[134:135], v49 offset:8704
  s_branch L_wr_0_e
L_wr_0_2:
  s_cmp_lg_u32 s44, 2
  s_cbranch_scc1 L_wr_0_3
  ds_read_b64_tr_b16 v[144:145], v48 offset:0
  ds_read_b64_tr_b16 v[146:147], v48 offset:512
  ds_read_b64_tr_b16 v[148:149], v48 offset:8192
  ds_read_b64_tr_b16 v[150:151], v48 offset:8704
  ds_read_b64_tr_b16 v[152:153], v49 offset:0
  ds_read_b64_tr_b16 v[154:155], v49 offset:512
  ds_read_b64_tr_b16 v[156:157], v49 offset:8192
  ds_read_b64_tr_b16 v[158:159], v49 offset:8704
  s_branch L_wr_0_e
L_wr_0_3:
  ds_read_b64_tr_b16 v[152:153], v48 offset:0
  ds_read_b64_tr_b16 v[154:155], v48 offset:512
  ds_read_b64_tr_b16 v[156:157], v48 offset:8192
  ds_read_b64_tr_b16 v[158:159], v48 offset:8704
  ds_read_b64_tr_b16 v[144:145], v49 offset:0
  ds_read_b64_tr_b16 v[146:147], v49 offset:512
  ds_read_b64_tr_b16 v[148:149], v49 offset:8192
  ds_read_b64_tr_b16 v[150:151], v49 offset:8704
L_wr_0_e:
  s_waitcnt lgkmcnt(0)
  s_waitcnt vmcnt(8)
  s_barrier
  s_add_u32 m0, s56, 65536
  s_mov_b32 s68, 512
  buffer_load_dwordx4 v45, s[48:51], s68 offen  lds
  s_add_u32 m0, s56, 69632
  s_mov_b32 s68, 4608
  buffer_load_dwordx4 v45, s[48:51], s68 offen  lds
  s_add_u32 m0, s56, 73728
  s_mov_b32 s68, 8704
  buffer_load_dwordx4 v45, s[48:51], s68 offen  lds
  s_add_u32 m0, s56, 77824
  s_mov_b32 s68, 12800
  buffer_load_dwordx4 v45, s[48:51], s68 offen  lds
  v_add_u32 v48, 16384, v50
  v_add_u32 v49, 16384, v51
  s_cmp_lg_u32 s44, 0
  s_cbranch_scc1 L_wr_1_1
  ds_read_b64_tr_b16 v[144:145], v48 offset:0
  ds_read_b64_tr_b16 v[146:147], v48 offset:512
  ds_read_b64_tr_b16 v[148:149], v48 offset:8192
  ds_read_b64_tr_b16 v[150:151], v48 offset:8704
  ds_read_b64_tr_b16 v[152:153], v49 offset:0
  ds_read_b64_tr_b16 v[154:155], v49 offset:512
  ds_read_b64_tr_b16 v[156:157], v49 offset:8192
  ds_read_b64_tr_b16 v[158:159], v49 offset:8704
  s_branch L_wr_1_e
L_wr_1_1:
  s_cmp_lg_u32 s44, 1
  s_cbranch_scc1 L_wr_1_2
  ds_read_b64_tr_b16 v[152:153], v48 offset:0
  ds_read_b64_tr_b16 v[154:155], v48 offset:512
  ds_read_b64_tr_b16 v[156:157], v48 offset:8192
  ds_read_b64_tr_b16 v[158:159], v48 offset:8704
  ds_read_b64_tr_b16 v[144:145], v49 offset:0
  ds_read_b64_tr_b16 v[146:147], v49 offset:512
  ds_read_b64_tr_b16 v[148:149], v49 offset:8192
  ds_read_b64_tr_b16 v[150:151], v49 offset:8704
  s_branch L_wr_1_e
L_wr_1_2:
  s_cmp_lg_u32 s44, 2
  s_cbranch_scc1 L_wr_1_3
  ds_read_b64_tr_b16 v[128:129], v48 offset:0
  ds_read_b64_tr_b16 v[130:131], v48 offset:512
  ds_read_b64_tr_b16 v[132:133], v48 offset:8192
  ds_read_b64_tr_b16 v[134:135], v48 offset:8704
  ds_read_b64_tr_b16 v[136:137], v49 offset:0
  ds_read_b64_tr_b16 v[138:139], v49 offset:512
  ds_read_b64_tr_b16 v[140:141], v49 offset:8192
  ds_read_b64_tr_b16 v[142:143], v49 offset:8704
  s_branch L_wr_1_e
L_wr_1_3:
  ds_read_b64_tr_b16 v[136:137], v48 offset:0
  ds_read_b64_tr_b16 v[138:139], v48 offset:512
  ds_read_b64_tr_b16 v[140:141], v48 offset:8192
  ds_read_b64_tr_b16 v[142:143], v48 offset:8704
  ds_read_b64_tr_b16 v[128:129], v49 offset:0
  ds_read_b64_tr_b16 v[130:131], v49 offset:512
  ds_read_b64_tr_b16 v[132:133], v49 offset:8192
  ds_read_b64_tr_b16 v[134:135], v49 offset:8704
L_wr_1_e:
  s_waitcnt lgkmcnt(0)
  s_waitcnt vmcnt(8)
  s_barrier
  s_lshl_b32 s68, s46, 3
  s_lshl_b64 s[4:5], 1, s68
  v_mov_b64 v[22:23], s[4:5]
  s_cmp_eq_u32 s44, 0
  s_cselect_b32 s69, 0, 0x40000000
  s_mov_b64 exec, 1
  buffer_atomic_add_x2 v[22:23], v17, s[52:55], s69 offen
  s_mov_b64 exec, -1
  s_add_u32 m0, s56, 81920
  s_mov_b32 s68, 66048
  buffer_load_dwordx4 v45, s[48:51], s68 offen  lds
  s_add_u32 m0, s56, 86016
  s_mov_b32 s68, 70144
  buffer_load_dwordx4 v45, s[48:51], s68 offen  lds
  s_add_u32 m0, s56, 90112
  s_mov_b32 s68, 74240
  buffer_load_dwordx4 v45, s[48:51], s68 offen  lds
  s_add_u32 m0, s56, 94208
  s_mov_b32 s68, 78336
  buffer_load_dwordx4 v45, s[48:51], s68 offen  lds
  v_add_u32 v48, 32768, v50
  v_add_u32 v49, 32768, v51
  s_cmp_lg_u32 s44, 0
  s_cbranch_scc1 L_wr_2_1
  ds_read_b64_tr_b16 v[160:161], v48 offset:0
  ds_read_b64_tr_b16 v[162:163], v48 offset:512
  ds_read_b64_tr_b16 v[164:165], v48 offset:8192
  ds_read_b64_tr_b16 v[166:167], v48 offset:8704
  ds_read_b64_tr_b16 v[168:169], v49 offset:0
  ds_read_b64_tr_b16 v[170:171], v49 offset:512
  ds_read_b64_tr_b16 v[172:173], v49 offset:8192
  ds_read_b64_tr_b16 v[174:175], v49 offset:8704
  s_branch L_wr_2_e
L_wr_2_1:
  s_cmp_lg_u32 s44, 1
  s_cbranch_scc1 L_wr_2_2
  ds_read_b64_tr_b16 v[168:169], v48 offset:0
  ds_read_b64_tr_b16 v[170:171], v48 offset:512
  ds_read_b64_tr_b16 v[172:173], v48 offset:8192
  ds_read_b64_tr_b16 v[174:175], v48 offset:8704
  ds_read_b64_tr_b16 v[160:161], v49 offset:0
  ds_read_b64_tr_b16 v[162:163], v49 offset:512
  ds_read_b64_tr_b16 v[164:165], v49 offset:8192
  ds_read_b64_tr_b16 v[166:167], v49 offset:8704
  s_branch L_wr_2_e
L_wr_2_2:
  s_cmp_lg_u32 s44, 2
  s_cbranch_scc1 L_wr_2_3
  ds_read_b64_tr_b16 v[176:177], v48 offset:0
  ds_read_b64_tr_b16 v[178:179], v48 offset:512
  ds_read_b64_tr_b16 v[180:181], v48 offset:8192
  ds_read_b64_tr_b16 v[182:183], v48 offset:8704
  ds_read_b64_tr_b16 v[184:185], v49 offset:0
  ds_read_b64_tr_b16 v[186:187], v49 offset:512
  ds_read_b64_tr_b16 v[188:189], v49 offset:8192
  ds_read_b64_tr_b16 v[190:191], v49 offset:8704
  s_branch L_wr_2_e
L_wr_2_3:
  ds_read_b64_tr_b16 v[184:185], v48 offset:0
  ds_read_b64_tr_b16 v[186:187], v48 offset:512
  ds_read_b64_tr_b16 v[188:189], v48 offset:8192
  ds_read_b64_tr_b16 v[190:191], v48 offset:8704
  ds_read_b64_tr_b16 v[176:177], v49 offset:0
  ds_read_b64_tr_b16 v[178:179], v49 offset:512
  ds_read_b64_tr_b16 v[180:181], v49 offset:8192
  ds_read_b64_tr_b16 v[182:183], v49 offset:8704
L_wr_2_e:
  s_waitcnt lgkmcnt(0)
  s_waitcnt vmcnt(8)
  s_barrier
  v_and_b32 v22, 1, v0
  v_cmp_eq_u32 vcc, 1, v22
  v_mov_b32 v23, 0x44444444
  v_mov_b32 v24, 0xeeeeeeee
  v_cndmask_b32 v1, v23, v24, vcc
  v_lshlrev_b32 v0, 4, v0
  v_add_u32 v0, 147456, v0
  s_mov_b32 s68, 0x05040100
  s_mov_b32 s69, 0x07060302
  v_perm_b32 v20, v94, v92, s68
  v_perm_b32 v21, v94, v92, s69
  v_perm_b32 v22, v95, v93, s68
  v_perm_b32 v23, v95, v93, s69
  v_min_u32 v20, -2, v20
  v_min_u32 v21, -2, v21
  v_min_u32 v22, -2, v22
  v_min_u32 v23, -2, v23
  v_perm_b32 v24, v98, v96, s68
  v_perm_b32 v25, v98, v96, s69
  v_perm_b32 v26, v99, v97, s68
  v_perm_b32 v27, v99, v97, s69
  v_min_u32 v24, -2, v24
  v_min_u32 v25, -2, v25
  v_min_u32 v26, -2, v26
  v_min_u32 v27, -2, v27
  s_add_u32 m0, s56, 98304
  s_mov_b32 s68, 768
  buffer_load_dwordx4 v45, s[48:51], s68 offen  lds
  s_add_u32 m0, s56, 102400
  s_mov_b32 s68, 4864
  buffer_load_dwordx4 v45, s[48:51], s68 offen  lds
  s_add_u32 m0, s56, 106496
  s_mov_b32 s68, 8960
  buffer_load_dwordx4 v45, s[48:51], s68 offen  lds
  s_add_u32 m0, s56, 110592
  s_mov_b32 s68, 13056
  buffer_load_dwordx4 v45, s[48:51], s68 offen  lds
  v_add_u32 v48, 49152, v50
  v_add_u32 v49, 49152, v51
  s_cmp_lg_u32 s44, 0
  s_cbranch_scc1 L_wr_3_1
  ds_read_b64_tr_b16 v[176:177], v48 offset:0
  ds_read_b64_tr_b16 v[178:179], v48 offset:512
  ds_read_b64_tr_b16 v[180:181], v48 offset:8192
  ds_read_b64_tr_b16 v[182:183], v48 offset:8704
  ds_read_b64_tr_b16 v[184:185], v49 offset:0
  ds_read_b64_tr_b16 v[186:187], v49 offset:512
  ds_read_b64_tr_b16 v[188:189], v49 offset:8192
  ds_read_b64_tr_b16 v[190:191], v49 offset:8704
  s_branch L_wr_3_e
L_wr_3_1:
  s_cmp_lg_u32 s44, 1
  s_cbranch_scc1 L_wr_3_2
  ds_read_b64_tr_b16 v[184:185], v48 offset:0
  ds_read_b64_tr_b16 v[186:187], v48 offset:512
  ds_read_b64_tr_b16 v[188:189], v48 offset:8192
  ds_read_b64_tr_b16 v[190:191], v48 offset:8704
  ds_read_b64_tr_b16 v[176:177], v49 offset:0
  ds_read_b64_tr_b16 v[178:179], v49 offset:512
  ds_read_b64_tr_b16 v[180:181], v49 offset:8192
  ds_read_b64_tr_b16 v[182:183], v49 offset:8704
  s_branch L_wr_3_e
L_wr_3_2:
  s_cmp_lg_u32 s44, 2
  s_cbranch_scc1 L_wr_3_3
  ds_read_b64_tr_b16 v[160:161], v48 offset:0
  ds_read_b64_tr_b16 v[162:163], v48 offset:512
  ds_read_b64_tr_b16 v[164:165], v48 offset:8192
  ds_read_b64_tr_b16 v[166:167], v48 offset:8704
  ds_read_b64_tr_b16 v[168:169], v49 offset:0
  ds_read_b64_tr_b16 v[170:171], v49 offset:512
  ds_read_b64_tr_b16 v[172:173], v49 offset:8192
  ds_read_b64_tr_b16 v[174:175], v49 offset:8704
  s_branch L_wr_3_e
L_wr_3_3:
  ds_read_b64_tr_b16 v[168:169], v48 offset:0
  ds_read_b64_tr_b16 v[170:171], v48 offset:512
  ds_read_b64_tr_b16 v[172:173], v48 offset:8192
  ds_read_b64_tr_b16 v[174:175], v48 offset:8704
  ds_read_b64_tr_b16 v[160:161], v49 offset:0
  ds_read_b64_tr_b16 v[162:163], v49 offset:512
  ds_read_b64_tr_b16 v[164:165], v49 offset:8192
  ds_read_b64_tr_b16 v[166:167], v49 offset:8704
L_wr_3_e:
  s_waitcnt lgkmcnt(0)
  s_waitcnt vmcnt(8)
  s_barrier
  s_add_u32 m0, s56, 114688
  s_mov_b32 s68, 66304
  buffer_load_dwordx4 v45, s[48:51], s68 offen  lds
  s_add_u32 m0, s56, 118784
  s_mov_b32 s68, 70400
  buffer_load_dwordx4 v45, s[48:51], s68 offen  lds
  s_add_u32 m0, s56, 122880
  s_mov_b32 s68, 74496
  buffer_load_dwordx4 v45, s[48:51], s68 offen  lds
  s_add_u32 m0, s56, 126976
  s_mov_b32 s68, 78592
  buffer_load_dwordx4 v45, s[48:51], s68 offen  lds
  v_add_u32 v48, 65536, v50
  v_add_u32 v49, 65536, v51
  s_cmp_lg_u32 s44, 0
  s_cbranch_scc1 L_wr_4_1
  ds_read_b64_tr_b16 v[192:193], v48 offset:0
  ds_read_b64_tr_b16 v[194:195], v48 offset:512
  ds_read_b64_tr_b16 v[196:197], v48 offset:8192
  ds_read_b64_tr_b16 v[198:199], v48 offset:8704
  ds_read_b64_tr_b16 v[200:201], v49 offset:0
  ds_read_b64_tr_b16 v[202:203], v49 offset:512
  ds_read_b64_tr_b16 v[204:205], v49 offset:8192
  ds_read_b64_tr_b16 v[206:207], v49 offset:8704
  s_branch L_wr_4_e
L_wr_4_1:
  s_cmp_lg_u32 s44, 1
  s_cbranch_scc1 L_wr_4_2
  ds_read_b64_tr_b16 v[200:201], v48 offset:0
  ds_read_b64_tr_b16 v[202:203], v48 offset:512
  ds_read_b64_tr_b16 v[204:205], v48 offset:8192
  ds_read_b64_tr_b16 v[206:207], v48 offset:8704
  ds_read_b64_tr_b16 v[192:193], v49 offset:0
  ds_read_b64_tr_b16 v[194:195], v49 offset:512
  ds_read_b64_tr_b16 v[196:197], v49 offset:8192
  ds_read_b64_tr_b16 v[198:199], v49 offset:8704
  s_branch L_wr_4_e
L_wr_4_2:
  s_cmp_lg_u32 s44, 2
  s_cbranch_scc1 L_wr_4_3
  ds_read_b64_tr_b16 v[208:209], v48 offset:0
  ds_read_b64_tr_b16 v[210:211], v48 offset:512
  ds_read_b64_tr_b16 v[212:213], v48 offset:8192
  ds_read_b64_tr_b16 v[214:215], v48 offset:8704
  ds_read_b64_tr_b16 v[216:217], v49 offset:0
  ds_read_b64_tr_b16 v[218:219], v49 offset:512
  ds_read_b64_tr_b16 v[220:221], v49 offset:8192
  ds_read_b64_tr_b16 v[222:223], v49 offset:8704
  s_branch L_wr_4_e
L_wr_4_3:
  ds_read_b64_tr_b16 v[216:217], v48 offset:0
  ds_read_b64_tr_b16 v[218:219], v48 offset:512
  ds_read_b64_tr_b16 v[220:221], v48 offset:8192
  ds_read_b64_tr_b16 v[222:223], v48 offset:8704
  ds_read_b64_tr_b16 v[208:209], v49 offset:0
  ds_read_b64_tr_b16 v[210:211], v49 offset:512
  ds_read_b64_tr_b16 v[212:213], v49 offset:8192
  ds_read_b64_tr_b16 v[214:215], v49 offset:8704
L_wr_4_e:
  s_waitcnt lgkmcnt(0)
  s_waitcnt vmcnt(8)
  s_barrier
  s_mov_b32 s48, s24
  s_and_b32 s49, s25, 0xffff
  s_add_u32 m0, s56, 0
  s_mov_b32 s68, 0
  buffer_load_dwordx4 v44, s[48:51], s68 offen  lds
  s_add_u32 m0, s56, 4096
  s_mov_b32 s68, 65536
  buffer_load_dwordx4 v44, s[48:51], s68 offen  lds
  s_add_u32 m0, s56, 8192
  s_mov_b32 s68, 262144
  buffer_load_dwordx4 v44, s[48:51], s68 offen  lds
  s_add_u32 m0, s56, 12288
  s_mov_b32 s68, 327680
  buffer_load_dwordx4 v44, s[48:51], s68 offen  lds
  v_add_u32 v48, 81920, v50
  v_add_u32 v49, 81920, v51
  s_cmp_lg_u32 s44, 0
  s_cbranch_scc1 L_wr_5_1
  ds_read_b64_tr_b16 v[208:209], v48 offset:0
  ds_read_b64_tr_b16 v[210:211], v48 offset:512
  ds_read_b64_tr_b16 v[212:213], v48 offset:8192
  ds_read_b64_tr_b16 v[214:215], v48 offset:8704
  ds_read_b64_tr_b16 v[216:217], v49 offset:0
  ds_read_b64_tr_b16 v[218:219], v49 offset:512
  ds_read_b64_tr_b16 v[220:221], v49 offset:8192
  ds_read_b64_tr_b16 v[222:223], v49 offset:8704
  s_branch L_wr_5_e
L_wr_5_1:
  s_cmp_lg_u32 s44, 1
  s_cbranch_scc1 L_wr_5_2
  ds_read_b64_tr_b16 v[216:217], v48 offset:0
  ds_read_b64_tr_b16 v[218:219], v48 offset:512
  ds_read_b64_tr_b16 v[220:221], v48 offset:8192
  ds_read_b64_tr_b16 v[222:223], v48 offset:8704
  ds_read_b64_tr_b16 v[208:209], v49 offset:0
  ds_read_b64_tr_b16 v[210:211], v49 offset:512
  ds_read_b64_tr_b16 v[212:213], v49 offset:8192
  ds_read_b64_tr_b16 v[214:215], v49 offset:8704
  s_branch L_wr_5_e
L_wr_5_2:
  s_cmp_lg_u32 s44, 2
  s_cbranch_scc1 L_wr_5_3
  ds_read_b64_tr_b16 v[192:193], v48 offset:0
  ds_read_b64_tr_b16 v[194:195], v48 offset:512
  ds_read_b64_tr_b16 v[196:197], v48 offset:8192
  ds_read_b64_tr_b16 v[198:199], v48 offset:8704
  ds_read_b64_tr_b16 v[200:201], v49 offset:0
  ds_read_b64_tr_b16 v[202:203], v49 offset:512
  ds_read_b64_tr_b16 v[204:205], v49 offset:8192
  ds_read_b64_tr_b16 v[206:207], v49 offset:8704
  s_branch L_wr_5_e
L_wr_5_3:
  ds_read_b64_tr_b16 v[200:201], v48 offset:0
  ds_read_b64_tr_b16 v[202:203], v48 offset:512
  ds_read_b64_tr_b16 v[204:205], v48 offset:8192
  ds_read_b64_tr_b16 v[206:207], v48 offset:8704
  ds_read_b64_tr_b16 v[192:193], v49 offset:0
  ds_read_b64_tr_b16 v[194:195], v49 offset:512
  ds_read_b64_tr_b16 v[196:197], v49 offset:8192
  ds_read_b64_tr_b16 v[198:199], v49 offset:8704
L_wr_5_e:
  s_waitcnt lgkmcnt(0)
  s_waitcnt vmcnt(8)
  s_barrier
  s_add_u32 m0, s56, 16384
  s_mov_b32 s68, 524288
  buffer_load_dwordx4 v44, s[48:51], s68 offen  lds
  s_add_u32 m0, s56, 20480
  s_mov_b32 s68, 589824
  buffer_load_dwordx4 v44, s[48:51], s68 offen  lds
  s_add_u32 m0, s56, 24576
  s_mov_b32 s68, 786432
  buffer_load_dwordx4 v44, s[48:51], s68 offen  lds
  s_add_u32 m0, s56, 28672
  s_mov_b32 s68, 851968
  buffer_load_dwordx4 v44, s[48:51], s68 offen  lds
  v_add_u32 v48, 98304, v50
  v_add_u32 v49, 98304, v51
  s_cmp_lg_u32 s44, 0
  s_cbranch_scc1 L_wr_6_1
  ds_read_b64_tr_b16 v[224:225], v48 offset:0
  ds_read_b64_tr_b16 v[226:227], v48 offset:512
  ds_read_b64_tr_b16 v[228:229], v48 offset:8192
  ds_read_b64_tr_b16 v[230:231], v48 offset:8704
  ds_read_b64_tr_b16 v[232:233], v49 offset:0
  ds_read_b64_tr_b16 v[234:235], v49 offset:512
  ds_read_b64_tr_b16 v[236:237], v49 offset:8192
  ds_read_b64_tr_b16 v[238:239], v49 offset:8704
  s_branch L_wr_6_e
L_wr_6_1:
  s_cmp_lg_u32 s44, 1
  s_cbranch_scc1 L_wr_6_2
  ds_read_b64_tr_b16 v[232:233], v48 offset:0
  ds_read_b64_tr_b16 v[234:235], v48 offset:512
  ds_read_b64_tr_b16 v[236:237], v48 offset:8192
  ds_read_b64_tr_b16 v[238:239], v48 offset:8704
  ds_read_b64_tr_b16 v[224:225], v49 offset:0
  ds_read_b64_tr_b16 v[226:227], v49 offset:512
  ds_read_b64_tr_b16 v[228:229], v49 offset:8192
  ds_read_b64_tr_b16 v[230:231], v49 offset:8704
  s_branch L_wr_6_e
L_wr_6_2:
  s_cmp_lg_u32 s44, 2
  s_cbranch_scc1 L_wr_6_3
  ds_read_b64_tr_b16 v[240:241], v48 offset:0
  ds_read_b64_tr_b16 v[242:243], v48 offset:512
  ds_read_b64_tr_b16 v[244:245], v48 offset:8192
  ds_read_b64_tr_b16 v[246:247], v48 offset:8704
  ds_read_b64_tr_b16 v[248:249], v49 offset:0
  ds_read_b64_tr_b16 v[250:251], v49 offset:512
  ds_read_b64_tr_b16 v[252:253], v49 offset:8192
  ds_read_b64_tr_b16 v[254:255], v49 offset:8704
  s_branch L_wr_6_e
L_wr_6_3:
  ds_read_b64_tr_b16 v[248:249], v48 offset:0
  ds_read_b64_tr_b16 v[250:251], v48 offset:512
  ds_read_b64_tr_b16 v[252:253], v48 offset:8192
  ds_read_b64_tr_b16 v[254:255], v48 offset:8704
  ds_read_b64_tr_b16 v[240:241], v49 offset:0
  ds_read_b64_tr_b16 v[242:243], v49 offset:512
  ds_read_b64_tr_b16 v[244:245], v49 offset:8192
  ds_read_b64_tr_b16 v[246:247], v49 offset:8704
L_wr_6_e:
  s_waitcnt lgkmcnt(0)
  s_waitcnt vmcnt(8)
  s_barrier
  s_add_u32 m0, s56, 32768
  s_mov_b32 s68, 1048576
  buffer_load_dwordx4 v44, s[48:51], s68 offen  lds
  s_add_u32 m0, s56, 36864
  s_mov_b32 s68, 1114112
  buffer_load_dwordx4 v44, s[48:51], s68 offen  lds
  s_add_u32 m0, s56, 40960
  s_mov_b32 s68, 1310720
  buffer_load_dwordx4 v44, s[48:51], s68 offen  lds
  s_add_u32 m0, s56, 45056
  s_mov_b32 s68, 1376256
  buffer_load_dwordx4 v44, s[48:51], s68 offen  lds
  v_add_u32 v48, 114688, v50
  v_add_u32 v49, 114688, v51
  s_cmp_lg_u32 s44, 0
  s_cbranch_scc1 L_wr_7_1
  ds_read_b64_tr_b16 v[240:241], v48 offset:0
  ds_read_b64_tr_b16 v[242:243], v48 offset:512
  ds_read_b64_tr_b16 v[244:245], v48 offset:8192
  ds_read_b64_tr_b16 v[246:247], v48 offset:8704
  ds_read_b64_tr_b16 v[248:249], v49 offset:0
  ds_read_b64_tr_b16 v[250:251], v49 offset:512
  ds_read_b64_tr_b16 v[252:253], v49 offset:8192
  ds_read_b64_tr_b16 v[254:255], v49 offset:8704
  s_branch L_wr_7_e
L_wr_7_1:
  s_cmp_lg_u32 s44, 1
  s_cbranch_scc1 L_wr_7_2
  ds_read_b64_tr_b16 v[248:249], v48 offset:0
  ds_read_b64_tr_b16 v[250:251], v48 offset:512
  ds_read_b64_tr_b16 v[252:253], v48 offset:8192
  ds_read_b64_tr_b16 v[254:255], v48 offset:8704
  ds_read_b64_tr_b16 v[240:241], v49 offset:0
  ds_read_b64_tr_b16 v[242:243], v49 offset:512
  ds_read_b64_tr_b16 v[244:245], v49 offset:8192
  ds_read_b64_tr_b16 v[246:247], v49 offset:8704
  s_branch L_wr_7_e
L_wr_7_2:
  s_cmp_lg_u32 s44, 2
  s_cbranch_scc1 L_wr_7_3
  ds_read_b64_tr_b16 v[224:225], v48 offset:0
  ds_read_b64_tr_b16 v[226:227], v48 offset:512
  ds_read_b64_tr_b16 v[228:229], v48 offset:8192
  ds_read_b64_tr_b16 v[230:231], v48 offset:8704
  ds_read_b64_tr_b16 v[232:233], v49 offset:0
  ds_read_b64_tr_b16 v[234:235], v49 offset:512
  ds_read_b64_tr_b16 v[236:237], v49 offset:8192
  ds_read_b64_tr_b16 v[238:239], v49 offset:8704
  s_branch L_wr_7_e
L_wr_7_3:
  ds_read_b64_tr_b16 v[232:233], v48 offset:0
  ds_read_b64_tr_b16 v[234:235], v48 offset:512
  ds_read_b64_tr_b16 v[236:237], v48 offset:8192
  ds_read_b64_tr_b16 v[238:239], v48 offset:8704
  ds_read_b64_tr_b16 v[224:225], v49 offset:0
  ds_read_b64_tr_b16 v[226:227], v49 offset:512
  ds_read_b64_tr_b16 v[228:229], v49 offset:8192
  ds_read_b64_tr_b16 v[230:231], v49 offset:8704
L_wr_7_e:
  s_waitcnt lgkmcnt(0)
  s_waitcnt vmcnt(8)
  s_barrier
  s_add_u32 m0, s56, 49152
  s_mov_b32 s68, 1572864
  buffer_load_dwordx4 v44, s[48:51], s68 offen  lds
  s_add_u32 m0, s56, 53248
  s_mov_b32 s68, 1638400
  buffer_load_dwordx4 v44, s[48:51], s68 offen  lds
  s_add_u32 m0, s56, 57344
  s_mov_b32 s68, 1835008
  buffer_load_dwordx4 v44, s[48:51], s68 offen  lds
  s_add_u32 m0, s56, 61440
  s_mov_b32 s68, 1900544
  buffer_load_dwordx4 v44, s[48:51], s68 offen  lds
  v_add_u32 v48, 0, v46
  v_add_u32 v49, 0, v47
  s_cmp_lg_u32 s44, 0
  s_cbranch_scc1 L_wr_8_1
  ds_read_b64_tr_b16 a[0:1], v48 offset:0
  ds_read_b64_tr_b16 a[2:3], v48 offset:512
  ds_read_b64_tr_b16 a[4:5], v48 offset:8192
  ds_read_b64_tr_b16 a[6:7], v48 offset:8704
  ds_read_b64_tr_b16 a[64:65], v49 offset:0
  ds_read_b64_tr_b16 a[66:67], v49 offset:512
  ds_read_b64_tr_b16 a[68:69], v49 offset:8192
  ds_read_b64_tr_b16 a[70:71], v49 offset:8704
  s_branch L_wr_8_e
L_wr_8_1:
  s_cmp_lg_u32 s44, 1
  s_cbranch_scc1 L_wr_8_2
  ds_read_b64_tr_b16 a[16:17], v48 offset:0
  ds_read_b64_tr_b16 a[18:19], v48 offset:512
  ds_read_b64_tr_b16 a[20:21], v48 offset:8192
  ds_read_b64_tr_b16 a[22:23], v48 offset:8704
  ds_read_b64_tr_b16 a[80:81], v49 offset:0
  ds_read_b64_tr_b16 a[82:83], v49 offset:512
  ds_read_b64_tr_b16 a[84:85], v49 offset:8192
  ds_read_b64_tr_b16 a[86:87], v49 offset:8704
  s_branch L_wr_8_e
L_wr_8_2:
  s_cmp_lg_u32 s44, 2
  s_cbranch_scc1 L_wr_8_3
  ds_read_b64_tr_b16 a[32:33], v48 offset:0
  ds_read_b64_tr_b16 a[34:35], v48 offset:512
  ds_read_b64_tr_b16 a[36:37], v48 offset:8192
  ds_read_b64_tr_b16 a[38:39], v48 offset:8704
  ds_read_b64_tr_b16 a[96:97], v49 offset:0
  ds_read_b64_tr_b16 a[98:99], v49 offset:512
  ds_read_b64_tr_b16 a[100:101], v49 offset:8192
  ds_read_b64_tr_b16 a[102:103], v49 offset:8704
  s_branch L_wr_8_e
L_wr_8_3:
  ds_read_b64_tr_b16 a[48:49], v48 offset:0
  ds_read_b64_tr_b16 a[50:51], v48 offset:512
  ds_read_b64_tr_b16 a[52:53], v48 offset:8192
  ds_read_b64_tr_b16 a[54:55], v48 offset:8704
  ds_read_b64_tr_b16 a[112:113], v49 offset:0
  ds_read_b64_tr_b16 a[114:115], v49 offset:512
  ds_read_b64_tr_b16 a[116:117], v49 offset:8192
  ds_read_b64_tr_b16 a[118:119], v49 offset:8704
L_wr_8_e:
  s_waitcnt lgkmcnt(0)
  s_waitcnt vmcnt(8)
  s_barrier
  s_add_u32 m0, s56, 65536
  s_mov_b32 s68, 2097152
  buffer_load_dwordx4 v44, s[48:51], s68 offen  lds
  s_add_u32 m0, s56, 69632
  s_mov_b32 s68, 2162688
  buffer_load_dwordx4 v44, s[48:51], s68 offen  lds
  s_add_u32 m0, s56, 73728
  s_mov_b32 s68, 2359296
  buffer_load_dwordx4 v44, s[48:51], s68 offen  lds
  s_add_u32 m0, s56, 77824
  s_mov_b32 s68, 2424832
  buffer_load_dwordx4 v44, s[48:51], s68 offen  lds
  v_add_u32 v48, 16384, v46
  v_add_u32 v49, 16384, v47
  s_cmp_lg_u32 s44, 0
  s_cbranch_scc1 L_wr_9_1
  ds_read_b64_tr_b16 a[8:9], v48 offset:0
  ds_read_b64_tr_b16 a[10:11], v48 offset:512
  ds_read_b64_tr_b16 a[12:13], v48 offset:8192
  ds_read_b64_tr_b16 a[14:15], v48 offset:8704
  ds_read_b64_tr_b16 a[72:73], v49 offset:0
  ds_read_b64_tr_b16 a[74:75], v49 offset:512
  ds_read_b64_tr_b16 a[76:77], v49 offset:8192
  ds_read_b64_tr_b16 a[78:79], v49 offset:8704
  s_branch L_wr_9_e
L_wr_9_1:
  s_cmp_lg_u32 s44, 1
  s_cbranch_scc1 L_wr_9_2
  ds_read_b64_tr_b16 a[24:25], v48 offset:0
  ds_read_b64_tr_b16 a[26:27], v48 offset:512
  ds_read_b64_tr_b16 a[28:29], v48 offset:8192
  ds_read_b64_tr_b16 a[30:31], v48 offset:8704
  ds_read_b64_tr_b16 a[88:89], v49 offset:0
  ds_read_b64_tr_b16 a[90:91], v49 offset:512
  ds_read_b64_tr_b16 a[92:93], v49 offset:8192
  ds_read_b64_tr_b16 a[94:95], v49 offset:8704
  s_branch L_wr_9_e
L_wr_9_2:
  s_cmp_lg_u32 s44, 2
  s_cbranch_scc1 L_wr_9_3
  ds_read_b64_tr_b16 a[40:41], v48 offset:0
  ds_read_b64_tr_b16 a[42:43], v48 offset:512
  ds_read_b64_tr_b16 a[44:45], v48 offset:8192
  ds_read_b64_tr_b16 a[46:47], v48 offset:8704
  ds_read_b64_tr_b16 a[104:105], v49 offset:0
  ds_read_b64_tr_b16 a[106:107], v49 offset:512
  ds_read_b64_tr_b16 a[108:109], v49 offset:8192
  ds_read_b64_tr_b16 a[110:111], v49 offset:8704
  s_branch L_wr_9_e
L_wr_9_3:
  ds_read_b64_tr_b16 a[56:57], v48 offset:0
  ds_read_b64_tr_b16 a[58:59], v48 offset:512
  ds_read_b64_tr_b16 a[60:61], v48 offset:8192
  ds_read_b64_tr_b16 a[62:63], v48 offset:8704
  ds_read_b64_tr_b16 a[120:121], v49 offset:0
  ds_read_b64_tr_b16 a[122:123], v49 offset:512
  ds_read_b64_tr_b16 a[124:125], v49 offset:8192
  ds_read_b64_tr_b16 a[126:127], v49 offset:8704
L_wr_9_e:
  s_waitcnt lgkmcnt(0)
  s_waitcnt vmcnt(8)
  s_barrier
  s_add_u32 m0, s56, 81920
  s_mov_b32 s68, 2621440
  buffer_load_dwordx4 v44, s[48:51], s68 offen  lds
  s_add_u32 m0, s56, 86016
  s_mov_b32 s68, 2686976
  buffer_load_dwordx4 v44, s[48:51], s68 offen  lds
  s_add_u32 m0, s56, 90112
  s_mov_b32 s68, 2883584
  buffer_load_dwordx4 v44, s[48:51], s68 offen  lds
  s_add_u32 m0, s56, 94208
  s_mov_b32 s68, 2949120
  buffer_load_dwordx4 v44, s[48:51], s68 offen  lds
  v_add_u32 v48, 32768, v46
  v_add_u32 v49, 32768, v47
  s_cmp_lg_u32 s44, 0
  s_cbranch_scc1 L_wr_10_1
  ds_read_b64_tr_b16 a[16:17], v48 offset:0
  ds_read_b64_tr_b16 a[18:19], v48 offset:512
  ds_read_b64_tr_b16 a[20:21], v48 offset:8192
  ds_read_b64_tr_b16 a[22:23], v48 offset:8704
  ds_read_b64_tr_b16 a[80:81], v49 offset:0
  ds_read_b64_tr_b16 a[82:83], v49 offset:512
  ds_read_b64_tr_b16 a[84:85], v49 offset:8192
  ds_read_b64_tr_b16 a[86:87], v49 offset:8704
  s_branch L_wr_10_e
L_wr_10_1:
  s_cmp_lg_u32 s44, 1
  s_cbranch_scc1 L_wr_10_2
  ds_read_b64_tr_b16 a[0:1], v48 offset:0
  ds_read_b64_tr_b16 a[2:3], v48 offset:512
  ds_read_b64_tr_b16 a[4:5], v48 offset:8192
  ds_read_b64_tr_b16 a[6:7], v48 offset:8704
  ds_read_b64_tr_b16 a[64:65], v49 offset:0
  ds_read_b64_tr_b16 a[66:67], v49 offset:512
  ds_read_b64_tr_b16 a[68:69], v49 offset:8192
  ds_read_b64_tr_b16 a[70:71], v49 offset:8704
  s_branch L_wr_10_e
L_wr_10_2:
  s_cmp_lg_u32 s44, 2
  s_cbranch_scc1 L_wr_10_3
  ds_read_b64_tr_b16 a[48:49], v48 offset:0
  ds_read_b64_tr_b16 a[50:51], v48 offset:512
  ds_read_b64_tr_b16 a[52:53], v48 offset:8192
  ds_read_b64_tr_b16 a[54:55], v48 offset:8704
  ds_read_b64_tr_b16 a[112:113], v49 offset:0
  ds_read_b64_tr_b16 a[114:115], v49 offset:512
  ds_read_b64_tr_b16 a[116:117], v49 offset:8192
  ds_read_b64_tr_b16 a[118:119], v49 offset:8704
  s_branch L_wr_10_e
L_wr_10_3:
  ds_read_b64_tr_b16 a[32:33], v48 offset:0
  ds_read_b64_tr_b16 a[34:35], v48 offset:512
  ds_read_b64_tr_b16 a[36:37], v48 offset:8192
  ds_read_b64_tr_b16 a[38:39], v48 offset:8704
  ds_read_b64_tr_b16 a[96:97], v49 offset:0
  ds_read_b64_tr_b16 a[98:99], v49 offset:512
  ds_read_b64_tr_b16 a[100:101], v49 offset:8192
  ds_read_b64_tr_b16 a[102:103], v49 offset:8704
L_wr_10_e:
  s_waitcnt lgkmcnt(0)
  s_waitcnt vmcnt(8)
  s_barrier
  s_add_u32 m0, s56, 98304
  s_mov_b32 s68, 3145728
  buffer_load_dwordx4 v44, s[48:51], s68 offen  lds
  s_add_u32 m0, s56, 102400
  s_mov_b32 s68, 3211264
  buffer_load_dwordx4 v44, s[48:51], s68 offen  lds
  s_add_u32 m0, s56, 106496
  s_mov_b32 s68, 3407872
  buffer_load_dwordx4 v44, s[48:51], s68 offen  lds
  s_add_u32 m0, s56, 110592
  s_mov_b32 s68, 3473408
  buffer_load_dwordx4 v44, s[48:51], s68 offen  lds
  v_add_u32 v48, 49152, v46
  v_add_u32 v49, 49152, v47
  s_cmp_lg_u32 s44, 0
  s_cbranch_scc1 L_wr_11_1
  ds_read_b64_tr_b16 a[24:25], v48 offset:0
  ds_read_b64_tr_b16 a[26:27], v48 offset:512
  ds_read_b64_tr_b16 a[28:29], v48 offset:8192
  ds_read_b64_tr_b16 a[30:31], v48 offset:8704
  ds_read_b64_tr_b16 a[88:89], v49 offset:0
  ds_read_b64_tr_b16 a[90:91], v49 offset:512
  ds_read_b64_tr_b16 a[92:93], v49 offset:8192
  ds_read_b64_tr_b16 a[94:95], v49 offset:8704
  s_branch L_wr_11_e
L_wr_11_1:
  s_cmp_lg_u32 s44, 1
  s_cbranch_scc1 L_wr_11_2
  ds_read_b64_tr_b16 a[8:9], v48 offset:0
  ds_read_b64_tr_b16 a[10:11], v48 offset:512
  ds_read_b64_tr_b16 a[12:13], v48 offset:8192
  ds_read_b64_tr_b16 a[14:15], v48 offset:8704
  ds_read_b64_tr_b16 a[72:73], v49 offset:0
  ds_read_b64_tr_b16 a[74:75], v49 offset:512
  ds_read_b64_tr_b16 a[76:77], v49 offset:8192
  ds_read_b64_tr_b16 a[78:79], v49 offset:8704
  s_branch L_wr_11_e
L_wr_11_2:
  s_cmp_lg_u32 s44, 2
  s_cbranch_scc1 L_wr_11_3
  ds_read_b64_tr_b16 a[56:57], v48 offset:0
  ds_read_b64_tr_b16 a[58:59], v48 offset:512
  ds_read_b64_tr_b16 a[60:61], v48 offset:8192
  ds_read_b64_tr_b16 a[62:63], v48 offset:8704
  ds_read_b64_tr_b16 a[120:121], v49 offset:0
  ds_read_b64_tr_b16 a[122:123], v49 offset:512
  ds_read_b64_tr_b16 a[124:125], v49 offset:8192
  ds_read_b64_tr_b16 a[126:127], v49 offset:8704
  s_branch L_wr_11_e
L_wr_11_3:
  ds_read_b64_tr_b16 a[40:41], v48 offset:0
  ds_read_b64_tr_b16 a[42:43], v48 offset:512
  ds_read_b64_tr_b16 a[44:45], v48 offset:8192
  ds_read_b64_tr_b16 a[46:47], v48 offset:8704
  ds_read_b64_tr_b16 a[104:105], v49 offset:0
  ds_read_b64_tr_b16 a[106:107], v49 offset:512
  ds_read_b64_tr_b16 a[108:109], v49 offset:8192
  ds_read_b64_tr_b16 a[110:111], v49 offset:8704
L_wr_11_e:
  s_waitcnt lgkmcnt(0)
  s_waitcnt vmcnt(8)
  s_barrier
  s_add_u32 m0, s56, 114688
  s_mov_b32 s68, 3670016
  buffer_load_dwordx4 v44, s[48:51], s68 offen  lds
  s_add_u32 m0, s56, 118784
  s_mov_b32 s68, 3735552
  buffer_load_dwordx4 v44, s[48:51], s68 offen  lds
  s_add_u32 m0, s56, 122880
  s_mov_b32 s68, 3932160
  buffer_load_dwordx4 v44, s[48:51], s68 offen  lds
  s_add_u32 m0, s56, 126976
  s_mov_b32 s68, 3997696
  buffer_load_dwordx4 v44, s[48:51], s68 offen  lds
  v_add_u32 v48, 65536, v46
  v_add_u32 v49, 65536, v47
  s_cmp_lg_u32 s44, 0
  s_cbranch_scc1 L_wr_12_1
  ds_read_b64_tr_b16 a[32:33], v48 offset:0
  ds_read_b64_tr_b16 a[34:35], v48 offset:512
  ds_read_b64_tr_b16 a[36:37], v48 offset:8192
  ds_read_b64_tr_b16 a[38:39], v48 offset:8704
  ds_read_b64_tr_b16 a[96:97], v49 offset:0
  ds_read_b64_tr_b16 a[98:99], v49 offset:512
  ds_read_b64_tr_b16 a[100:101], v49 offset:8192
  ds_read_b64_tr_b16 a[102:103], v49 offset:8704
  s_branch L_wr_12_e
L_wr_12_1:
  s_cmp_lg_u32 s44, 1
  s_cbranch_scc1 L_wr_12_2
  ds_read_b64_tr_b16 a[48:49], v48 offset:0
  ds_read_b64_tr_b16 a[50:51], v48 offset:512
  ds_read_b64_tr_b16 a[52:53], v48 offset:8192
  ds_read_b64_tr_b16 a[54:55], v48 offset:8704
  ds_read_b64_tr_b16 a[112:113], v49 offset:0
  ds_read_b64_tr_b16 a[114:115], v49 offset:512
  ds_read_b64_tr_b16 a[116:117], v49 offset:8192
  ds_read_b64_tr_b16 a[118:119], v49 offset:8704
  s_branch L_wr_12_e
L_wr_12_2:
  s_cmp_lg_u32 s44, 2
  s_cbranch_scc1 L_wr_12_3
  ds_read_b64_tr_b16 a[0:1], v48 offset:0
  ds_read_b64_tr_b16 a[2:3], v48 offset:512
  ds_read_b64_tr_b16 a[4:5], v48 offset:8192
  ds_read_b64_tr_b16 a[6:7], v48 offset:8704
  ds_read_b64_tr_b16 a[64:65], v49 offset:0
  ds_read_b64_tr_b16 a[66:67], v49 offset:512
  ds_read_b64_tr_b16 a[68:69], v49 offset:8192
  ds_read_b64_tr_b16 a[70:71], v49 offset:8704
  s_branch L_wr_12_e
L_wr_12_3:
  ds_read_b64_tr_b16 a[16:17], v48 offset:0
  ds_read_b64_tr_b16 a[18:19], v48 offset:512
  ds_read_b64_tr_b16 a[20:21], v48 offset:8192
  ds_read_b64_tr_b16 a[22:23], v48 offset:8704
  ds_read_b64_tr_b16 a[80:81], v49 offset:0
  ds_read_b64_tr_b16 a[82:83], v49 offset:512
  ds_read_b64_tr_b16 a[84:85], v49 offset:8192
  ds_read_b64_tr_b16 a[86:87], v49 offset:8704
L_wr_12_e:
  s_waitcnt lgkmcnt(0)
  s_waitcnt vmcnt(8)
  s_barrier
  s_mov_b32 s48, s26
  s_and_b32 s49, s27, 0xffff
  s_add_u32 m0, s56, 0
  s_mov_b32 s68, 0
  buffer_load_dwordx4 v44, s[48:51], s68 offen  lds
  s_add_u32 m0, s56, 4096
  s_mov_b32 s68, 65536
  buffer_load_dwordx4 v44, s[48:51], s68 offen  lds
  s_add_u32 m0, s56, 8192
  s_mov_b32 s68, 262144
  buffer_load_dwordx4 v44, s[48:51], s68 offen  lds
  s_add_u32 m0, s56, 12288
  s_mov_b32 s68, 327680
  buffer_load_dwordx4 v44, s[48:51], s68 offen  lds
  v_add_u32 v48, 81920, v46
  v_add_u32 v49, 81920, v47
  s_cmp_lg_u32 s44, 0
  s_cbranch_scc1 L_wr_13_1
  ds_read_b64_tr_b16 a[40:41], v48 offset:0
  ds_read_b64_tr_b16 a[42:43], v48 offset:512
  ds_read_b64_tr_b16 a[44:45], v48 offset:8192
  ds_read_b64_tr_b16 a[46:47], v48 offset:8704
  ds_read_b64_tr_b16 a[104:105], v49 offset:0
  ds_read_b64_tr_b16 a[106:107], v49 offset:512
  ds_read_b64_tr_b16 a[108:109], v49 offset:8192
  ds_read_b64_tr_b16 a[110:111], v49 offset:8704
  s_branch L_wr_13_e
L_wr_13_1:
  s_cmp_lg_u32 s44, 1
  s_cbranch_scc1 L_wr_13_2
  ds_read_b64_tr_b16 a[56:57], v48 offset:0
  ds_read_b64_tr_b16 a[58:59], v48 offset:512
  ds_read_b64_tr_b16 a[60:61], v48 offset:8192
  ds_read_b64_tr_b16 a[62:63], v48 offset:8704
  ds_read_b64_tr_b16 a[120:121], v49 offset:0
  ds_read_b64_tr_b16 a[122:123], v49 offset:512
  ds_read_b64_tr_b16 a[124:125], v49 offset:8192
  ds_read_b64_tr_b16 a[126:127], v49 offset:8704
  s_branch L_wr_13_e
L_wr_13_2:
  s_cmp_lg_u32 s44, 2
  s_cbranch_scc1 L_wr_13_3
  ds_read_b64_tr_b16 a[8:9], v48 offset:0
  ds_read_b64_tr_b16 a[10:11], v48 offset:512
  ds_read_b64_tr_b16 a[12:13], v48 offset:8192
  ds_read_b64_tr_b16 a[14:15], v48 offset:8704
  ds_read_b64_tr_b16 a[72:73], v49 offset:0
  ds_read_b64_tr_b16 a[74:75], v49 offset:512
  ds_read_b64_tr_b16 a[76:77], v49 offset:8192
  ds_read_b64_tr_b16 a[78:79], v49 offset:8704
  s_branch L_wr_13_e
L_wr_13_3:
  ds_read_b64_tr_b16 a[24:25], v48 offset:0
  ds_read_b64_tr_b16 a[26:27], v48 offset:512
  ds_read_b64_tr_b16 a[28:29], v48 offset:8192
  ds_read_b64_tr_b16 a[30:31], v48 offset:8704
  ds_read_b64_tr_b16 a[88:89], v49 offset:0
  ds_read_b64_tr_b16 a[90:91], v49 offset:512
  ds_read_b64_tr_b16 a[92:93], v49 offset:8192
  ds_read_b64_tr_b16 a[94:95], v49 offset:8704
L_wr_13_e:
  s_waitcnt lgkmcnt(0)
  s_waitcnt vmcnt(8)
  s_barrier
  s_add_u32 m0, s56, 16384
  s_mov_b32 s68, 524288
  buffer_load_dwordx4 v44, s[48:51], s68 offen  lds
  s_add_u32 m0, s56, 20480
  s_mov_b32 s68, 589824
  buffer_load_dwordx4 v44, s[48:51], s68 offen  lds
  s_add_u32 m0, s56, 24576
  s_mov_b32 s68, 786432
  buffer_load_dwordx4 v44, s[48:51], s68 offen  lds
  s_add_u32 m0, s56, 28672
  s_mov_b32 s68, 851968
  buffer_load_dwordx4 v44, s[48:51], s68 offen  lds
  v_add_u32 v48, 98304, v46
  v_add_u32 v49, 98304, v47
  s_cmp_lg_u32 s44, 0
  s_cbranch_scc1 L_wr_14_1
  ds_read_b64_tr_b16 a[48:49], v48 offset:0
  ds_read_b64_tr_b16 a[50:51], v48 offset:512
  ds_read_b64_tr_b16 a[52:53], v48 offset:8192
  ds_read_b64_tr_b16 a[54:55], v48 offset:8704
  ds_read_b64_tr_b16 a[112:113], v49 offset:0
  ds_read_b64_tr_b16 a[114:115], v49 offset:512
  ds_read_b64_tr_b16 a[116:117], v49 offset:8192
  ds_read_b64_tr_b16 a[118:119], v49 offset:8704
  s_branch L_wr_14_e
L_wr_14_1:
  s_cmp_lg_u32 s44, 1
  s_cbranch_scc1 L_wr_14_2
  ds_read_b64_tr_b16 a[32:33], v48 offset:0
  ds_read_b64_tr_b16 a[34:35], v48 offset:512
  ds_read_b64_tr_b16 a[36:37], v48 offset:8192
  ds_read_b64_tr_b16 a[38:39], v48 offset:8704
  ds_read_b64_tr_b16 a[96:97], v49 offset:0
  ds_read_b64_tr_b16 a[98:99], v49 offset:512
  ds_read_b64_tr_b16 a[100:101], v49 offset:8192
  ds_read_b64_tr_b16 a[102:103], v49 offset:8704
  s_branch L_wr_14_e
L_wr_14_2:
  s_cmp_lg_u32 s44, 2
  s_cbranch_scc1 L_wr_14_3
  ds_read_b64_tr_b16 a[16:17], v48 offset:0
  ds_read_b64_tr_b16 a[18:19], v48 offset:512
  ds_read_b64_tr_b16 a[20:21], v48 offset:8192
  ds_read_b64_tr_b16 a[22:23], v48 offset:8704
  ds_read_b64_tr_b16 a[80:81], v49 offset:0
  ds_read_b64_tr_b16 a[82:83], v49 offset:512
  ds_read_b64_tr_b16 a[84:85], v49 offset:8192
  ds_read_b64_tr_b16 a[86:87], v49 offset:8704
  s_branch L_wr_14_e
L_wr_14_3:
  ds_read_b64_tr_b16 a[0:1], v48 offset:0
  ds_read_b64_tr_b16 a[2:3], v48 offset:512
  ds_read_b64_tr_b16 a[4:5], v48 offset:8192
  ds_read_b64_tr_b16 a[6:7], v48 offset:8704
  ds_read_b64_tr_b16 a[64:65], v49 offset:0
  ds_read_b64_tr_b16 a[66:67], v49 offset:512
  ds_read_b64_tr_b16 a[68:69], v49 offset:8192
  ds_read_b64_tr_b16 a[70:71], v49 offset:8704
L_wr_14_e:
  s_waitcnt lgkmcnt(0)
  s_waitcnt vmcnt(8)
  s_barrier
  s_add_u32 m0, s56, 32768
  s_mov_b32 s68, 1048576
  buffer_load_dwordx4 v44, s[48:51], s68 offen  lds
  s_add_u32 m0, s56, 36864
  s_mov_b32 s68, 1114112
  buffer_load_dwordx4 v44, s[48:51], s68 offen  lds
  s_add_u32 m0, s56, 40960
  s_mov_b32 s68, 1310720
  buffer_load_dwordx4 v44, s[48:51], s68 offen  lds
  s_add_u32 m0, s56, 45056
  s_mov_b32 s68, 1376256
  buffer_load_dwordx4 v44, s[48:51], s68 offen  lds
  v_add_u32 v48, 114688, v46
  v_add_u32 v49, 114688, v47
  s_cmp_lg_u32 s44, 0
  s_cbranch_scc1 L_wr_15_1
  ds_read_b64_tr_b16 a[56:57], v48 offset:0
  ds_read_b64_tr_b16 a[58:59], v48 offset:512
  ds_read_b64_tr_b16 a[60:61], v48 offset:8192
  ds_read_b64_tr_b16 a[62:63], v48 offset:8704
  ds_read_b64_tr_b16 a[120:121], v49 offset:0
  ds_read_b64_tr_b16 a[122:123], v49 offset:512
  ds_read_b64_tr_b16 a[124:125], v49 offset:8192
  ds_read_b64_tr_b16 a[126:127], v49 offset:8704
  s_branch L_wr_15_e
L_wr_15_1:
  s_cmp_lg_u32 s44, 1
  s_cbranch_scc1 L_wr_15_2
  ds_read_b64_tr_b16 a[40:41], v48 offset:0
  ds_read_b64_tr_b16 a[42:43], v48 offset:512
  ds_read_b64_tr_b16 a[44:45], v48 offset:8192
  ds_read_b64_tr_b16 a[46:47], v48 offset:8704
  ds_read_b64_tr_b16 a[104:105], v49 offset:0
  ds_read_b64_tr_b16 a[106:107], v49 offset:512
  ds_read_b64_tr_b16 a[108:109], v49 offset:8192
  ds_read_b64_tr_b16 a[110:111], v49 offset:8704
  s_branch L_wr_15_e
L_wr_15_2:
  s_cmp_lg_u32 s44, 2
  s_cbranch_scc1 L_wr_15_3
  ds_read_b64_tr_b16 a[24:25], v48 offset:0
  ds_read_b64_tr_b16 a[26:27], v48 offset:512
  ds_read_b64_tr_b16 a[28:29], v48 offset:8192
  ds_read_b64_tr_b16 a[30:31], v48 offset:8704
  ds_read_b64_tr_b16 a[88:89], v49 offset:0
  ds_read_b64_tr_b16 a[90:91], v49 offset:512
  ds_read_b64_tr_b16 a[92:93], v49 offset:8192
  ds_read_b64_tr_b16 a[94:95], v49 offset:8704
  s_branch L_wr_15_e
L_wr_15_3:
  ds_read_b64_tr_b16 a[8:9], v48 offset:0
  ds_read_b64_tr_b16 a[10:11], v48 offset:512
  ds_read_b64_tr_b16 a[12:13], v48 offset:8192
  ds_read_b64_tr_b16 a[14:15], v48 offset:8704
  ds_read_b64_tr_b16 a[72:73], v49 offset:0
  ds_read_b64_tr_b16 a[74:75], v49 offset:512
  ds_read_b64_tr_b16 a[76:77], v49 offset:8192
  ds_read_b64_tr_b16 a[78:79], v49 offset:8704
L_wr_15_e:
  s_waitcnt lgkmcnt(0)
  s_waitcnt vmcnt(8)
  s_barrier
  s_add_u32 m0, s56, 49152
  s_mov_b32 s68, 1572864
  buffer_load_dwordx4 v44, s[48:51], s68 offen  lds
  s_add_u32 m0, s56, 53248
  s_mov_b32 s68, 1638400
  buffer_load_dwordx4 v44, s[48:51], s68 offen  lds
  s_add_u32 m0, s56, 57344
  s_mov_b32 s68, 1835008
  buffer_load_dwordx4 v44, s[48:51], s68 offen  lds
  s_add_u32 m0, s56, 61440
  s_mov_b32 s68, 1900544
  buffer_load_dwordx4 v44, s[48:51], s68 offen  lds
  v_add_u32 v48, 0, v46
  v_add_u32 v49, 0, v47
  s_cmp_lg_u32 s44, 0
  s_cbranch_scc1 L_wr_16_1
  ds_read_b64_tr_b16 a[128:129], v48 offset:0
  ds_read_b64_tr_b16 a[130:131], v48 offset:512
  ds_read_b64_tr_b16 a[132:133], v48 offset:8192
  ds_read_b64_tr_b16 a[134:135], v48 offset:8704
  ds_read_b64_tr_b16 a[192:193], v49 offset:0
  ds_read_b64_tr_b16 a[194:195], v49 offset:512
  ds_read_b64_tr_b16 a[196:197], v49 offset:8192
  ds_read_b64_tr_b16 a[198:199], v49 offset:8704
  s_branch L_wr_16_e
L_wr_16_1:
  s_cmp_lg_u32 s44, 1
  s_cbranch_scc1 L_wr_16_2
  ds_read_b64_tr_b16 a[144:145], v48 offset:0
  ds_read_b64_tr_b16 a[146:147], v48 offset:512
  ds_read_b64_tr_b16 a[148:149], v48 offset:8192
  ds_read_b64_tr_b16 a[150:151], v48 offset:8704
  ds_read_b64_tr_b16 a[208:209], v49 offset:0
  ds_read_b64_tr_b16 a[210:211], v49 offset:512
  ds_read_b64_tr_b16 a[212:213], v49 offset:8192
  ds_read_b64_tr_b16 a[214:215], v49 offset:8704
  s_branch L_wr_16_e
L_wr_16_2:
  s_cmp_lg_u32 s44, 2
  s_cbranch_scc1 L_wr_16_3
  ds_read_b64_tr_b16 a[160:161], v48 offset:0
  ds_read_b64_tr_b16 a[162:163], v48 offset:512
  ds_read_b64_tr_b16 a[164:165], v48 offset:8192
  ds_read_b64_tr_b16 a[166:167], v48 offset:8704
  ds_read_b64_tr_b16 a[224:225], v49 offset:0
  ds_read_b64_tr_b16 a[226:227], v49 offset:512
  ds_read_b64_tr_b16 a[228:229], v49 offset:8192
  ds_read_b64_tr_b16 a[230:231], v49 offset:8704
  s_branch L_wr_16_e
L_wr_16_3:
  ds_read_b64_tr_b16 a[176:177], v48 offset:0
  ds_read_b64_tr_b16 a[178:179], v48 offset:512
  ds_read_b64_tr_b16 a[180:181], v48 offset:8192
  ds_read_b64_tr_b16 a[182:183], v48 offset:8704
  ds_read_b64_tr_b16 a[240:241], v49 offset:0
  ds_read_b64_tr_b16 a[242:243], v49 offset:512
  ds_read_b64_tr_b16 a[244:245], v49 offset:8192
  ds_read_b64_tr_b16 a[246:247], v49 offset:8704
L_wr_16_e:
  s_waitcnt lgkmcnt(0)
  s_waitcnt vmcnt(8)
  s_barrier
  s_add_u32 m0, s56, 65536
  s_mov_b32 s68, 2097152
  buffer_load_dwordx4 v44, s[48:51], s68 offen  lds
  s_add_u32 m0, s56, 69632
  s_mov_b32 s68, 2162688
  buffer_load_dwordx4 v44, s[48:51], s68 offen  lds
  s_add_u32 m0, s56, 73728
  s_mov_b32 s68, 2359296
  buffer_load_dwordx4 v44, s[48:51], s68 offen  lds
  s_add_u32 m0, s56, 77824
  s_mov_b32 s68, 2424832
  buffer_load_dwordx4 v44, s[48:51], s68 offen  lds
  v_add_u32 v48, 16384, v46
  v_add_u32 v49, 16384, v47
  s_cmp_lg_u32 s44, 0
  s_cbranch_scc1 L_wr_17_1
  ds_read_b64_tr_b16 a[136:137], v48 offset:0
  ds_read_b64_tr_b16 a[138:139], v48 offset:512
  ds_read_b64_tr_b16 a[140:141], v48 offset:8192
  ds_read_b64_tr_b16 a[142:143], v48 offset:8704
  ds_read_b64_tr_b16 a[200:201], v49 offset:0
  ds_read_b64_tr_b16 a[202:203], v49 offset:512
  ds_read_b64_tr_b16 a[204:205], v49 offset:8192
  ds_read_b64_tr_b16 a[206:207], v49 offset:8704
  s_branch L_wr_17_e
L_wr_17_1:
  s_cmp_lg_u32 s44, 1
  s_cbranch_scc1 L_wr_17_2
  ds_read_b64_tr_b16 a[152:153], v48 offset:0
  ds_read_b64_tr_b16 a[154:155], v48 offset:512
  ds_read_b64_tr_b16 a[156:157], v48 offset:8192
  ds_read_b64_tr_b16 a[158:159], v48 offset:8704
  ds_read_b64_tr_b16 a[216:217], v49 offset:0
  ds_read_b64_tr_b16 a[218:219], v49 offset:512
  ds_read_b64_tr_b16 a[220:221], v49 offset:8192
  ds_read_b64_tr_b16 a[222:223], v49 offset:8704
  s_branch L_wr_17_e
L_wr_17_2:
  s_cmp_lg_u32 s44, 2
  s_cbranch_scc1 L_wr_17_3
  ds_read_b64_tr_b16 a[168:169], v48 offset:0
  ds_read_b64_tr_b16 a[170:171], v48 offset:512
  ds_read_b64_tr_b16 a[172:173], v48 offset:8192
  ds_read_b64_tr_b16 a[174:175], v48 offset:8704
  ds_read_b64_tr_b16 a[232:233], v49 offset:0
  ds_read_b64_tr_b16 a[234:235], v49 offset:512
  ds_read_b64_tr_b16 a[236:237], v49 offset:8192
  ds_read_b64_tr_b16 a[238:239], v49 offset:8704
  s_branch L_wr_17_e
L_wr_17_3:
  ds_read_b64_tr_b16 a[184:185], v48 offset:0
  ds_read_b64_tr_b16 a[186:187], v48 offset:512
  ds_read_b64_tr_b16 a[188:189], v48 offset:8192
  ds_read_b64_tr_b16 a[190:191], v48 offset:8704
  ds_read_b64_tr_b16 a[248:249], v49 offset:0
  ds_read_b64_tr_b16 a[250:251], v49 offset:512
  ds_read_b64_tr_b16 a[252:253], v49 offset:8192
  ds_read_b64_tr_b16 a[254:255], v49 offset:8704
L_wr_17_e:
  s_waitcnt lgkmcnt(0)
  s_waitcnt vmcnt(8)
  s_barrier
  s_add_u32 m0, s56, 81920
  s_mov_b32 s68, 2621440
  buffer_load_dwordx4 v44, s[48:51], s68 offen  lds
  s_add_u32 m0, s56, 86016
  s_mov_b32 s68, 2686976
  buffer_load_dwordx4 v44, s[48:51], s68 offen  lds
  s_add_u32 m0, s56, 90112
  s_mov_b32 s68, 2883584
  buffer_load_dwordx4 v44, s[48:51], s68 offen  lds
  s_add_u32 m0, s56, 94208
  s_mov_b32 s68, 2949120
  buffer_load_dwordx4 v44, s[48:51], s68 offen  lds
  v_add_u32 v48, 32768, v46
  v_add_u32 v49, 32768, v47
  s_cmp_lg_u32 s44, 0
  s_cbranch_scc1 L_wr_18_1
  ds_read_b64_tr_b16 a[144:145], v48 offset:0
  ds_read_b64_tr_b16 a[146:147], v48 offset:512
  ds_read_b64_tr_b16 a[148:149], v48 offset:8192
  ds_read_b64_tr_b16 a[150:151], v48 offset:8704
  ds_read_b64_tr_b16 a[208:209], v49 offset:0
  ds_read_b64_tr_b16 a[210:211], v49 offset:512
  ds_read_b64_tr_b16 a[212:213], v49 offset:8192
  ds_read_b64_tr_b16 a[214:215], v49 offset:8704
  s_branch L_wr_18_e
L_wr_18_1:
  s_cmp_lg_u32 s44, 1
  s_cbranch_scc1 L_wr_18_2
  ds_read_b64_tr_b16 a[128:129], v48 offset:0
  ds_read_b64_tr_b16 a[130:131], v48 offset:512
  ds_read_b64_tr_b16 a[132:133], v48 offset:8192
  ds_read_b64_tr_b16 a[134:135], v48 offset:8704
  ds_read_b64_tr_b16 a[192:193], v49 offset:0
  ds_read_b64_tr_b16 a[194:195], v49 offset:512
  ds_read_b64_tr_b16 a[196:197], v49 offset:8192
  ds_read_b64_tr_b16 a[198:199], v49 offset:8704
  s_branch L_wr_18_e
L_wr_18_2:
  s_cmp_lg_u32 s44, 2
  s_cbranch_scc1 L_wr_18_3
  ds_read_b64_tr_b16 a[176:177], v48 offset:0
  ds_read_b64_tr_b16 a[178:179], v48 offset:512
  ds_read_b64_tr_b16 a[180:181], v48 offset:8192
  ds_read_b64_tr_b16 a[182:183], v48 offset:8704
  ds_read_b64_tr_b16 a[240:241], v49 offset:0
  ds_read_b64_tr_b16 a[242:243], v49 offset:512
  ds_read_b64_tr_b16 a[244:245], v49 offset:8192
  ds_read_b64_tr_b16 a[246:247], v49 offset:8704
  s_branch L_wr_18_e
L_wr_18_3:
  ds_read_b64_tr_b16 a[160:161], v48 offset:0
  ds_read_b64_tr_b16 a[162:163], v48 offset:512
  ds_read_b64_tr_b16 a[164:165], v48 offset:8192
  ds_read_b64_tr_b16 a[166:167], v48 offset:8704
  ds_read_b64_tr_b16 a[224:225], v49 offset:0
  ds_read_b64_tr_b16 a[226:227], v49 offset:512
  ds_read_b64_tr_b16 a[228:229], v49 offset:8192
  ds_read_b64_tr_b16 a[230:231], v49 offset:8704
L_wr_18_e:
  s_waitcnt lgkmcnt(0)
  s_waitcnt vmcnt(8)
  s_barrier
  s_add_u32 m0, s56, 98304
  s_mov_b32 s68, 3145728
  buffer_load_dwordx4 v44, s[48:51], s68 offen  lds
  s_add_u32 m0, s56, 102400
  s_mov_b32 s68, 3211264
  buffer_load_dwordx4 v44, s[48:51], s68 offen  lds
  s_add_u32 m0, s56, 106496
  s_mov_b32 s68, 3407872
  buffer_load_dwordx4 v44, s[48:51], s68 offen  lds
  s_add_u32 m0, s56, 110592
  s_mov_b32 s68, 3473408
  buffer_load_dwordx4 v44, s[48:51], s68 offen  lds
  v_add_u32 v48, 49152, v46
  v_add_u32 v49, 49152, v47
  s_cmp_lg_u32 s44, 0
  s_cbranch_scc1 L_wr_19_1
  ds_read_b64_tr_b16 a[152:153], v48 offset:0
  ds_read_b64_tr_b16 a[154:155], v48 offset:512
  ds_read_b64_tr_b16 a[156:157], v48 offset:8192
  ds_read_b64_tr_b16 a[158:159], v48 offset:8704
  ds_read_b64_tr_b16 a[216:217], v49 offset:0
  ds_read_b64_tr_b16 a[218:219], v49 offset:512
  ds_read_b64_tr_b16 a[220:221], v49 offset:8192
  ds_read_b64_tr_b16 a[222:223], v49 offset:8704
  s_branch L_wr_19_e
L_wr_19_1:
  s_cmp_lg_u32 s44, 1
  s_cbranch_scc1 L_wr_19_2
  ds_read_b64_tr_b16 a[136:137], v48 offset:0
  ds_read_b64_tr_b16 a[138:139], v48 offset:512
  ds_read_b64_tr_b16 a[140:141], v48 offset:8192
  ds_read_b64_tr_b16 a[142:143], v48 offset:8704
  ds_read_b64_tr_b16 a[200:201], v49 offset:0
  ds_read_b64_tr_b16 a[202:203], v49 offset:512
  ds_read_b64_tr_b16 a[204:205], v49 offset:8192
  ds_read_b64_tr_b16 a[206:207], v49 offset:8704
  s_branch L_wr_19_e
L_wr_19_2:
  s_cmp_lg_u32 s44, 2
  s_cbranch_scc1 L_wr_19_3
  ds_read_b64_tr_b16 a[184:185], v48 offset:0
  ds_read_b64_tr_b16 a[186:187], v48 offset:512
  ds_read_b64_tr_b16 a[188:189], v48 offset:8192
  ds_read_b64_tr_b16 a[190:191], v48 offset:8704
  ds_read_b64_tr_b16 a[248:249], v49 offset:0
  ds_read_b64_tr_b16 a[250:251], v49 offset:512
  ds_read_b64_tr_b16 a[252:253], v49 offset:8192
  ds_read_b64_tr_b16 a[254:255], v49 offset:8704
  s_branch L_wr_19_e
L_wr_19_3:
  ds_read_b64_tr_b16 a[168:169], v48 offset:0
  ds_read_b64_tr_b16 a[170:171], v48 offset:512
  ds_read_b64_tr_b16 a[172:173], v48 offset:8192
  ds_read_b64_tr_b16 a[174:175], v48 offset:8704
  ds_read_b64_tr_b16 a[232:233], v49 offset:0
  ds_read_b64_tr_b16 a[234:235], v49 offset:512
  ds_read_b64_tr_b16 a[236:237], v49 offset:8192
  ds_read_b64_tr_b16 a[238:239], v49 offset:8704
L_wr_19_e:
  s_waitcnt lgkmcnt(0)
  s_waitcnt vmcnt(8)
  s_barrier
  s_add_u32 m0, s56, 114688
  s_mov_b32 s68, 3670016
  buffer_load_dwordx4 v44, s[48:51], s68 offen  lds
  s_add_u32 m0, s56, 118784
  s_mov_b32 s68, 3735552
  buffer_load_dwordx4 v44, s[48:51], s68 offen  lds
  s_add_u32 m0, s56, 122880
  s_mov_b32 s68, 3932160
  buffer_load_dwordx4 v44, s[48:51], s68 offen  lds
  s_add_u32 m0, s56, 126976
  s_mov_b32 s68, 3997696
  buffer_load_dwordx4 v44, s[48:51], s68 offen  lds
  v_add_u32 v48, 65536, v46
  v_add_u32 v49, 65536, v47
  s_cmp_lg_u32 s44, 0
  s_cbranch_scc1 L_wr_20_1
  ds_read_b64_tr_b16 a[160:161], v48 offset:0
  ds_read_b64_tr_b16 a[162:163], v48 offset:512
  ds_read_b64_tr_b16 a[164:165], v48 offset:8192
  ds_read_b64_tr_b16 a[166:167], v48 offset:8704
  ds_read_b64_tr_b16 a[224:225], v49 offset:0
  ds_read_b64_tr_b16 a[226:227], v49 offset:512
  ds_read_b64_tr_b16 a[228:229], v49 offset:8192
  ds_read_b64_tr_b16 a[230:231], v49 offset:8704
  s_branch L_wr_20_e
L_wr_20_1:
  s_cmp_lg_u32 s44, 1
  s_cbranch_scc1 L_wr_20_2
  ds_read_b64_tr_b16 a[176:177], v48 offset:0
  ds_read_b64_tr_b16 a[178:179], v48 offset:512
  ds_read_b64_tr_b16 a[180:181], v48 offset:8192
  ds_read_b64_tr_b16 a[182:183], v48 offset:8704
  ds_read_b64_tr_b16 a[240:241], v49 offset:0
  ds_read_b64_tr_b16 a[242:243], v49 offset:512
  ds_read_b64_tr_b16 a[244:245], v49 offset:8192
  ds_read_b64_tr_b16 a[246:247], v49 offset:8704
  s_branch L_wr_20_e
L_wr_20_2:
  s_cmp_lg_u32 s44, 2
  s_cbranch_scc1 L_wr_20_3
  ds_read_b64_tr_b16 a[128:129], v48 offset:0
  ds_read_b64_tr_b16 a[130:131], v48 offset:512
  ds_read_b64_tr_b16 a[132:133], v48 offset:8192
  ds_read_b64_tr_b16 a[134:135], v48 offset:8704
  ds_read_b64_tr_b16 a[192:193], v49 offset:0
  ds_read_b64_tr_b16 a[194:195], v49 offset:512
  ds_read_b64_tr_b16 a[196:197], v49 offset:8192
  ds_read_b64_tr_b16 a[198:199], v49 offset:8704
  s_branch L_wr_20_e
L_wr_20_3:
  ds_read_b64_tr_b16 a[144:145], v48 offset:0
  ds_read_b64_tr_b16 a[146:147], v48 offset:512
  ds_read_b64_tr_b16 a[148:149], v48 offset:8192
  ds_read_b64_tr_b16 a[150:151], v48 offset:8704
  ds_read_b64_tr_b16 a[208:209], v49 offset:0
  ds_read_b64_tr_b16 a[210:211], v49 offset:512
  ds_read_b64_tr_b16 a[212:213], v49 offset:8192
  ds_read_b64_tr_b16 a[214:215], v49 offset:8704
L_wr_20_e:
  s_waitcnt lgkmcnt(0)
  s_waitcnt vmcnt(8)
  s_barrier
  s_mov_b32 s48, s28
  s_and_b32 s49, s29, 0xffff
  s_add_u32 m0, s56, 0
  s_mov_b32 s68, 0
  buffer_load_dwordx4 v44, s[48:51], s68 offen  lds
  s_add_u32 m0, s56, 4096
  s_mov_b32 s68, 65536
  buffer_load_dwordx4 v44, s[48:51], s68 offen  lds
  s_add_u32 m0, s56, 8192
  s_mov_b32 s68, 262144
  buffer_load_dwordx4 v44, s[48:51], s68 offen  lds
  s_add_u32 m0, s56, 12288
  s_mov_b32 s68, 327680
  buffer_load_dwordx4 v44, s[48:51], s68 offen  lds
  v_add_u32 v48, 81920, v46
  v_add_u32 v49, 81920, v47
  s_cmp_lg_u32 s44, 0
  s_cbranch_scc1 L_wr_21_1
  ds_read_b64_tr_b16 a[168:169], v48 offset:0
  ds_read_b64_tr_b16 a[170:171], v48 offset:512
  ds_read_b64_tr_b16 a[172:173], v48 offset:8192
  ds_read_b64_tr_b16 a[174:175], v48 offset:8704
  ds_read_b64_tr_b16 a[232:233], v49 offset:0
  ds_read_b64_tr_b16 a[234:235], v49 offset:512
  ds_read_b64_tr_b16 a[236:237], v49 offset:8192
  ds_read_b64_tr_b16 a[238:239], v49 offset:8704
  s_branch L_wr_21_e
L_wr_21_1:
  s_cmp_lg_u32 s44, 1
  s_cbranch_scc1 L_wr_21_2
  ds_read_b64_tr_b16 a[184:185], v48 offset:0
  ds_read_b64_tr_b16 a[186:187], v48 offset:512
  ds_read_b64_tr_b16 a[188:189], v48 offset:8192
  ds_read_b64_tr_b16 a[190:191], v48 offset:8704
  ds_read_b64_tr_b16 a[248:249], v49 offset:0
  ds_read_b64_tr_b16 a[250:251], v49 offset:512
  ds_read_b64_tr_b16 a[252:253], v49 offset:8192
  ds_read_b64_tr_b16 a[254:255], v49 offset:8704
  s_branch L_wr_21_e
L_wr_21_2:
  s_cmp_lg_u32 s44, 2
  s_cbranch_scc1 L_wr_21_3
  ds_read_b64_tr_b16 a[136:137], v48 offset:0
  ds_read_b64_tr_b16 a[138:139], v48 offset:512
  ds_read_b64_tr_b16 a[140:141], v48 offset:8192
  ds_read_b64_tr_b16 a[142:143], v48 offset:8704
  ds_read_b64_tr_b16 a[200:201], v49 offset:0
  ds_read_b64_tr_b16 a[202:203], v49 offset:512
  ds_read_b64_tr_b16 a[204:205], v49 offset:8192
  ds_read_b64_tr_b16 a[206:207], v49 offset:8704
  s_branch L_wr_21_e
L_wr_21_3:
  ds_read_b64_tr_b16 a[152:153], v48 offset:0
  ds_read_b64_tr_b16 a[154:155], v48 offset:512
  ds_read_b64_tr_b16 a[156:157], v48 offset:8192
  ds_read_b64_tr_b16 a[158:159], v48 offset:8704
  ds_read_b64_tr_b16 a[216:217], v49 offset:0
  ds_read_b64_tr_b16 a[218:219], v49 offset:512
  ds_read_b64_tr_b16 a[220:221], v49 offset:8192
  ds_read_b64_tr_b16 a[222:223], v49 offset:8704
L_wr_21_e:
  s_waitcnt lgkmcnt(0)
  s_waitcnt vmcnt(8)
  s_barrier
  s_add_u32 m0, s56, 16384
  s_mov_b32 s68, 524288
  buffer_load_dwordx4 v44, s[48:51], s68 offen  lds
  s_add_u32 m0, s56, 20480
  s_mov_b32 s68, 589824
  buffer_load_dwordx4 v44, s[48:51], s68 offen  lds
  s_add_u32 m0, s56, 24576
  s_mov_b32 s68, 786432
  buffer_load_dwordx4 v44, s[48:51], s68 offen  lds
  s_add_u32 m0, s56, 28672
  s_mov_b32 s68, 851968
  buffer_load_dwordx4 v44, s[48:51], s68 offen  lds
  v_add_u32 v48, 98304, v46
  v_add_u32 v49, 98304, v47
  s_cmp_lg_u32 s44, 0
  s_cbranch_scc1 L_wr_22_1
  ds_read_b64_tr_b16 a[176:177], v48 offset:0
  ds_read_b64_tr_b16 a[178:179], v48 offset:512
  ds_read_b64_tr_b16 a[180:181], v48 offset:8192
  ds_read_b64_tr_b16 a[182:183], v48 offset:8704
  ds_read_b64_tr_b16 a[240:241], v49 offset:0
  ds_read_b64_tr_b16 a[242:243], v49 offset:512
  ds_read_b64_tr_b16 a[244:245], v49 offset:8192
  ds_read_b64_tr_b16 a[246:247], v49 offset:8704
  s_branch L_wr_22_e
L_wr_22_1:
  s_cmp_lg_u32 s44, 1
  s_cbranch_scc1 L_wr_22_2
  ds_read_b64_tr_b16 a[160:161], v48 offset:0
  ds_read_b64_tr_b16 a[162:163], v48 offset:512
  ds_read_b64_tr_b16 a[164:165], v48 offset:8192
  ds_read_b64_tr_b16 a[166:167], v48 offset:8704
  ds_read_b64_tr_b16 a[224:225], v49 offset:0
  ds_read_b64_tr_b16 a[226:227], v49 offset:512
  ds_read_b64_tr_b16 a[228:229], v49 offset:8192
  ds_read_b64_tr_b16 a[230:231], v49 offset:8704
  s_branch L_wr_22_e
L_wr_22_2:
  s_cmp_lg_u32 s44, 2
  s_cbranch_scc1 L_wr_22_3
  ds_read_b64_tr_b16 a[144:145], v48 offset:0
  ds_read_b64_tr_b16 a[146:147], v48 offset:512
  ds_read_b64_tr_b16 a[148:149], v48 offset:8192
  ds_read_b64_tr_b16 a[150:151], v48 offset:8704
  ds_read_b64_tr_b16 a[208:209], v49 offset:0
  ds_read_b64_tr_b16 a[210:211], v49 offset:512
  ds_read_b64_tr_b16 a[212:213], v49 offset:8192
  ds_read_b64_tr_b16 a[214:215], v49 offset:8704
  s_branch L_wr_22_e
L_wr_22_3:
  ds_read_b64_tr_b16 a[128:129], v48 offset:0
  ds_read_b64_tr_b16 a[130:131], v48 offset:512
  ds_read_b64_tr_b16 a[132:133], v48 offset:8192
  ds_read_b64_tr_b16 a[134:135], v48 offset:8704
  ds_read_b64_tr_b16 a[192:193], v49 offset:0
  ds_read_b64_tr_b16 a[194:195], v49 offset:512
  ds_read_b64_tr_b16 a[196:197], v49 offset:8192
  ds_read_b64_tr_b16 a[198:199], v49 offset:8704
L_wr_22_e:
  s_waitcnt lgkmcnt(0)
  s_waitcnt vmcnt(8)
  s_barrier
  s_add_u32 m0, s56, 32768
  s_mov_b32 s68, 1048576
  buffer_load_dwordx4 v44, s[48:51], s68 offen  lds
  s_add_u32 m0, s56, 36864
  s_mov_b32 s68, 1114112
  buffer_load_dwordx4 v44, s[48:51], s68 offen  lds
  s_add_u32 m0, s56, 40960
  s_mov_b32 s68, 1310720
  buffer_load_dwordx4 v44, s[48:51], s68 offen  lds
  s_add_u32 m0, s56, 45056
  s_mov_b32 s68, 1376256
  buffer_load_dwordx4 v44, s[48:51], s68 offen  lds
  v_add_u32 v48, 114688, v46
  v_add_u32 v49, 114688, v47
  s_cmp_lg_u32 s44, 0
  s_cbranch_scc1 L_wr_23_1
  ds_read_b64_tr_b16 a[184:185], v48 offset:0
  ds_read_b64_tr_b16 a[186:187], v48 offset:512
  ds_read_b64_tr_b16 a[188:189], v48 offset:8192
  ds_read_b64_tr_b16 a[190:191], v48 offset:8704
  ds_read_b64_tr_b16 a[248:249], v49 offset:0
  ds_read_b64_tr_b16 a[250:251], v49 offset:512
  ds_read_b64_tr_b16 a[252:253], v49 offset:8192
  ds_read_b64_tr_b16 a[254:255], v49 offset:8704
  s_branch L_wr_23_e
L_wr_23_1:
  s_cmp_lg_u32 s44, 1
  s_cbranch_scc1 L_wr_23_2
  ds_read_b64_tr_b16 a[168:169], v48 offset:0
  ds_read_b64_tr_b16 a[170:171], v48 offset:512
  ds_read_b64_tr_b16 a[172:173], v48 offset:8192
  ds_read_b64_tr_b16 a[174:175], v48 offset:8704
  ds_read_b64_tr_b16 a[232:233], v49 offset:0
  ds_read_b64_tr_b16 a[234:235], v49 offset:512
  ds_read_b64_tr_b16 a[236:237], v49 offset:8192
  ds_read_b64_tr_b16 a[238:239], v49 offset:8704
  s_branch L_wr_23_e
L_wr_23_2:
  s_cmp_lg_u32 s44, 2
  s_cbranch_scc1 L_wr_23_3
  ds_read_b64_tr_b16 a[152:153], v48 offset:0
  ds_read_b64_tr_b16 a[154:155], v48 offset:512
  ds_read_b64_tr_b16 a[156:157], v48 offset:8192
  ds_read_b64_tr_b16 a[158:159], v48 offset:8704
  ds_read_b64_tr_b16 a[216:217], v49 offset:0
  ds_read_b64_tr_b16 a[218:219], v49 offset:512
  ds_read_b64_tr_b16 a[220:221], v49 offset:8192
  ds_read_b64_tr_b16 a[222:223], v49 offset:8704
  s_branch L_wr_23_e
L_wr_23_3:
  ds_read_b64_tr_b16 a[136:137], v48 offset:0
  ds_read_b64_tr_b16 a[138:139], v48 offset:512
  ds_read_b64_tr_b16 a[140:141], v48 offset:8192
  ds_read_b64_tr_b16 a[142:143], v48 offset:8704
  ds_read_b64_tr_b16 a[200:201], v49 offset:0
  ds_read_b64_tr_b16 a[202:203], v49 offset:512
  ds_read_b64_tr_b16 a[204:205], v49 offset:8192
  ds_read_b64_tr_b16 a[206:207], v49 offset:8704
L_wr_23_e:
  s_waitcnt lgkmcnt(0)
  s_waitcnt vmcnt(8)
  s_barrier
  s_add_u32 m0, s56, 49152
  s_mov_b32 s68, 1572864
  buffer_load_dwordx4 v44, s[48:51], s68 offen  lds
  s_add_u32 m0, s56, 53248
  s_mov_b32 s68, 1638400
  buffer_load_dwordx4 v44, s[48:51], s68 offen  lds
  s_add_u32 m0, s56, 57344
  s_mov_b32 s68, 1835008
  buffer_load_dwordx4 v44, s[48:51], s68 offen  lds
  s_add_u32 m0, s56, 61440
  s_mov_b32 s68, 1900544
  buffer_load_dwordx4 v44, s[48:51], s68 offen  lds
  v_add_u32 v48, 0, v46
  v_add_u32 v49, 0, v47
  ds_read_b64_tr_b16 v[108:109], v48 offset:0
  ds_read_b64_tr_b16 v[110:111], v48 offset:512
  ds_read_b64_tr_b16 v[112:113], v48 offset:8192
  ds_read_b64_tr_b16 v[114:115], v48 offset:8704
  ds_read_b64_tr_b16 v[116:117], v49 offset:0
  ds_read_b64_tr_b16 v[118:119], v49 offset:512
  ds_read_b64_tr_b16 v[120:121], v49 offset:8192
  ds_read_b64_tr_b16 v[122:123], v49 offset:8704
  s_waitcnt lgkmcnt(0)
  s_barrier
  v_add_u32 v48, 0, v3
  ds_write_b128 v48, v[108:111] offset:0
  ds_write_b128 v48, v[112:115] offset:1024
  ds_write_b128 v48, v[116:119] offset:2048
  ds_write_b128 v48, v[120:123] offset:3072
  s_waitcnt lgkmcnt(0)
  s_waitcnt vmcnt(8)
  s_barrier
  s_add_u32 m0, s56, 65536
  s_mov_b32 s68, 2097152
  buffer_load_dwordx4 v44, s[48:51], s68 offen  lds
  s_add_u32 m0, s56, 69632
  s_mov_b32 s68, 2162688
  buffer_load_dwordx4 v44, s[48:51], s68 offen  lds
  s_add_u32 m0, s56, 73728
  s_mov_b32 s68, 2359296
  buffer_load_dwordx4 v44, s[48:51], s68 offen  lds
  s_add_u32 m0, s56, 77824
  s_mov_b32 s68, 2424832
  buffer_load_dwordx4 v44, s[48:51], s68 offen  lds
  v_add_u32 v48, 16384, v46
  v_add_u32 v49, 16384, v47
  ds_read_b64_tr_b16 v[108:109], v48 offset:0
  ds_read_b64_tr_b16 v[110:111], v48 offset:512
  ds_read_b64_tr_b16 v[112:113], v48 offset:8192
  ds_read_b64_tr_b16 v[114:115], v48 offset:8704
  ds_read_b64_tr_b16 v[116:117], v49 offset:0
  ds_read_b64_tr_b16 v[118:119], v49 offset:512
  ds_read_b64_tr_b16 v[120:121], v49 offset:8192
  ds_read_b64_tr_b16 v[122:123], v49 offset:8704
  s_waitcnt lgkmcnt(0)
  s_barrier
  v_add_u32 v48, 16384, v3
  ds_write_b128 v48, v[108:111] offset:0
  ds_write_b128 v48, v[112:115] offset:1024
  ds_write_b128 v48, v[116:119] offset:2048
  ds_write_b128 v48, v[120:123] offset:3072
  s_waitcnt lgkmcnt(0)
  s_waitcnt vmcnt(8)
  s_barrier
  s_add_u32 m0, s56, 81920
  s_mov_b32 s68, 2621440
  buffer_load_dwordx4 v44, s[48:51], s68 offen  lds
  s_add_u32 m0, s56, 86016
  s_mov_b32 s68, 2686976
  buffer_load_dwordx4 v44, s[48:51], s68 offen  lds
  s_add_u32 m0, s56, 90112
  s_mov_b32 s68, 2883584
  buffer_load_dwordx4 v44, s[48:51], s68 offen  lds
  s_add_u32 m0, s56, 94208
  s_mov_b32 s68, 2949120
  buffer_load_dwordx4 v44, s[48:51], s68 offen  lds
  v_add_u32 v48, 32768, v46
  v_add_u32 v49, 32768, v47
  ds_read_b64_tr_b16 v[108:109], v48 offset:0
  ds_read_b64_tr_b16 v[110:111], v48 offset:512
  ds_read_b64_tr_b16 v[112:113], v48 offset:8192
  ds_read_b64_tr_b16 v[114:115], v48 offset:8704
  ds_read_b64_tr_b16 v[116:117], v49 offset:0
  ds_read_b64_tr_b16 v[118:119], v49 offset:512
  ds_read_b64_tr_b16 v[120:121], v49 offset:8192
  ds_read_b64_tr_b16 v[122:123], v49 offset:8704
  s_waitcnt lgkmcnt(0)
  s_barrier
  v_add_u32 v48, 32768, v3
  ds_write_b128 v48, v[108:111] offset:0
  ds_write_b128 v48, v[112:115] offset:1024
  ds_write_b128 v48, v[116:119] offset:2048
  ds_write_b128 v48, v[120:123] offset:3072
  s_waitcnt lgkmcnt(0)
  s_waitcnt vmcnt(8)
  s_barrier
  buffer_load_dwordx2 v[52:53], v17, s[52:55], 0 offen sc1
  buffer_load_dword v4, v17, s[40:43], s60 offen sc1
  s_add_u32 m0, s56, 98304
  s_mov_b32 s68, 3145728
  buffer_load_dwordx4 v44, s[48:51], s68 offen  lds
  s_add_u32 m0, s56, 102400
  s_mov_b32 s68, 3211264
  buffer_load_dwordx4 v44, s[48:51], s68 offen  lds
  s_add_u32 m0, s56, 106496
  s_mov_b32 s68, 3407872
  buffer_load_dwordx4 v44, s[48:51], s68 offen  lds
  s_add_u32 m0, s56, 110592
  s_mov_b32 s68, 3473408
  buffer_load_dwordx4 v44, s[48:51], s68 offen  lds
  v_add_u32 v48, 49152, v46
  v_add_u32 v49, 49152, v47
  ds_read_b64_tr_b16 v[108:109], v48 offset:0
  ds_read_b64_tr_b16 v[110:111], v48 offset:512
  ds_read_b64_tr_b16 v[112:113], v48 offset:8192
  ds_read_b64_tr_b16 v[114:115], v48 offset:8704
  ds_read_b64_tr_b16 v[116:117], v49 offset:0
  ds_read_b64_tr_b16 v[118:119], v49 offset:512
  ds_read_b64_tr_b16 v[120:121], v49 offset:8192
  ds_read_b64_tr_b16 v[122:123], v49 offset:8704
  s_waitcnt lgkmcnt(0)
  s_barrier
  v_add_u32 v48, 49152, v3
  ds_write_b128 v48, v[108:111] offset:0
  ds_write_b128 v48, v[112:115] offset:1024
  ds_write_b128 v48, v[116:119] offset:2048
  ds_write_b128 v48, v[120:123] offset:3072
  s_waitcnt lgkmcnt(0)
  s_waitcnt vmcnt(8)
  s_barrier
  s_add_u32 m0, s56, 114688
  s_mov_b32 s68, 3670016
  buffer_load_dwordx4 v44, s[48:51], s68 offen  lds
  s_add_u32 m0, s56, 118784
  s_mov_b32 s68, 3735552
  buffer_load_dwordx4 v44, s[48:51], s68 offen  lds
  s_add_u32 m0, s56, 122880
  s_mov_b32 s68, 3932160
  buffer_load_dwordx4 v44, s[48:51], s68 offen  lds
  s_add_u32 m0, s56, 126976
  s_mov_b32 s68, 3997696
  buffer_load_dwordx4 v44, s[48:51], s68 offen  lds
  v_add_u32 v48, 65536, v46
  v_add_u32 v49, 65536, v47
  ds_read_b64_tr_b16 v[108:109], v48 offset:0
  ds_read_b64_tr_b16 v[110:111], v48 offset:512
  ds_read_b64_tr_b16 v[112:113], v48 offset:8192
  ds_read_b64_tr_b16 v[114:115], v48 offset:8704
  ds_read_b64_tr_b16 v[116:117], v49 offset:0
  ds_read_b64_tr_b16 v[118:119], v49 offset:512
  ds_read_b64_tr_b16 v[120:121], v49 offset:8192
  ds_read_b64_tr_b16 v[122:123], v49 offset:8704
  s_waitcnt lgkmcnt(0)
  s_barrier
  v_add_u32 v48, 65536, v3
  ds_write_b128 v48, v[108:111] offset:0
  ds_write_b128 v48, v[112:115] offset:1024
  ds_write_b128 v48, v[116:119] offset:2048
  ds_write_b128 v48, v[120:123] offset:3072
  s_waitcnt lgkmcnt(0)
  s_waitcnt vmcnt(8)
  s_barrier
  v_add_u32 v48, 81920, v46
  v_add_u32 v49, 81920, v47
  ds_read_b64_tr_b16 v[108:109], v48 offset:0
  ds_read_b64_tr_b16 v[110:111], v48 offset:512
  ds_read_b64_tr_b16 v[112:113], v48 offset:8192
  ds_read_b64_tr_b16 v[114:115], v48 offset:8704
  ds_read_b64_tr_b16 v[116:117], v49 offset:0
  ds_read_b64_tr_b16 v[118:119], v49 offset:512
  ds_read_b64_tr_b16 v[120:121], v49 offset:8192
  ds_read_b64_tr_b16 v[122:123], v49 offset:8704
  s_waitcnt lgkmcnt(0)
  s_barrier
  v_add_u32 v48, 81920, v3
  ds_write_b128 v48, v[108:111] offset:0
  ds_write_b128 v48, v[112:115] offset:1024
  ds_write_b128 v48, v[116:119] offset:2048
  ds_write_b128 v48, v[120:123] offset:3072
  s_waitcnt lgkmcnt(0)
  s_waitcnt vmcnt(4)
  s_barrier
L_team_init:
  v_sad_u8 v54, v52, 0, 0
  v_sad_u8 v54, v53, 0, v54
  v_cmp_gt_u32 vcc, 32, v54
  v_cmp_gt_u32 s[4:5], 2, v4
  s_nop 0
  s_or_b64 vcc, vcc, s[4:5]
  s_cbranch_scc0 L_team_ready
  buffer_load_dwordx2 v[52:53], v17, s[52:55], 0 offen sc1
  buffer_load_dword v4, v17, s[40:43], s60 offen sc1
  s_add_u32 s67, s67, 1
  s_cmp_gt_u32 s67, 1048576
  s_cbranch_scc1 L_exit
  s_waitcnt vmcnt(0)
  s_branch L_team_init
L_team_ready:
  s_lshl_b32 s69, s46, 3
  s_mov_b32 m0, s70
  s_mov_b32 s57, s72
  buffer_load_dwordx4 v2, s[40:43], s57 offen sc1 lds
  buffer_load_dwordx4 v2, s[40:43], s57 offen offset:1024 sc1 lds
  s_mov_b32 m0, s71
  s_add_u32 s58, s57, 0x1000000
  buffer_load_dwordx4 v2, s[40:43], s58 offen sc1 lds
  buffer_load_dwordx4 v2, s[40:43], s58 offen offset:1024 sc1 lds
  v_lshrrev_b64 v[52:53], s69, v[52:53]
  v_and_b32 v52, 0xff, v52
  v_cmp_eq_u32 s[4:5], v52, v54
  v_add_u32 v48, 98304, v46
  v_add_u32 v49, 98304, v47
  ds_read_b64_tr_b16 v[108:109], v48 offset:0
  ds_read_b64_tr_b16 v[110:111], v48 offset:512
  ds_read_b64_tr_b16 v[112:113], v48 offset:8192
  ds_read_b64_tr_b16 v[114:115], v48 offset:8704
  ds_read_b64_tr_b16 v[116:117], v49 offset:0
  ds_read_b64_tr_b16 v[118:119], v49 offset:512
  ds_read_b64_tr_b16 v[120:121], v49 offset:8192
  ds_read_b64_tr_b16 v[122:123], v49 offset:8704
  s_waitcnt lgkmcnt(0)
  s_barrier
  v_add_u32 v48, 98304, v3
  ds_write_b128 v48, v[108:111] offset:0
  ds_write_b128 v48, v[112:115] offset:1024
  ds_write_b128 v48, v[116:119] offset:2048
  ds_write_b128 v48, v[120:123] offset:3072
  s_waitcnt lgkmcnt(0)
  s_waitcnt vmcnt(4)
  s_barrier
  v_add_u32 v48, 114688, v46
  v_add_u32 v49, 114688, v47
  ds_read_b64_tr_b16 v[108:109], v48 offset:0
  ds_read_b64_tr_b16 v[110:111], v48 offset:512
  ds_read_b64_tr_b16 v[112:113], v48 offset:8192
  ds_read_b64_tr_b16 v[114:115], v48 offset:8704
  ds_read_b64_tr_b16 v[116:117], v49 offset:0
  ds_read_b64_tr_b16 v[118:119], v49 offset:512
  ds_read_b64_tr_b16 v[120:121], v49 offset:8192
  ds_read_b64_tr_b16 v[122:123], v49 offset:8704
  s_waitcnt lgkmcnt(0)
  s_barrier
  v_add_u32 v48, 114688, v3
  ds_write_b128 v48, v[108:111] offset:0
  ds_write_b128 v48, v[112:115] offset:1024
  ds_write_b128 v48, v[116:119] offset:2048
  ds_write_b128 v48, v[120:123] offset:3072
  s_waitcnt lgkmcnt(0)
  s_lshl_b32 s68, s44, 15
  v_add_u32 v3, s68, v3
  s_mov_b32 s56, -1
  s_mov_b32 s65, 0
  s_lshl_b32 s61, s45, 12
  s_lshl_b32 s68, s44, 10
  s_sub_u32 s61, s61, s68
  s_add_u32 s61, s61, 0xbfc0000
  ds_read_b128 v[76:79], v3 offset:0
  ds_read_b128 v[80:83], v3 offset:1024
  ds_read_b128 v[84:87], v3 offset:2048
  ds_read_b128 v[88:91], v3 offset:3072
  ds_read_b128 v[92:95], v3 offset:16384
  ds_read_b128 v[96:99], v3 offset:17408
  ds_read_b128 v[100:103], v3 offset:18432
  ds_read_b128 v[104:107], v3 offset:19456
  v_xor_b32 v3, 0x8000, v3
  ds_read_b128 v[108:111], v3 offset:0
  ds_read_b128 v[112:115], v3 offset:1024
  s_add_u32 s56, s56, 1
  s_xor_b32 s65, s65, 1
  s_add_u32 s68, s56, 1
  s_min_u32 s68, s68, 63
  s_lshl_b32 s68, s68, 13
  s_add_u32 s57, s72, s68
  s_add_u32 s58, s57, 0x1000000
  s_add_u32 s68, s56, 3
  s_min_u32 s92, s68, 64
  s_add_u32 s61, s61, 0x20000
  s_xor_b32 s70, s70, 0x2000
  v_mov_b64 v[52:53], 0
  v_mov_b64 v[54:55], 0
  v_mov_b64 v[56:57], 0
  v_mov_b64 v[58:59], 0
  v_mov_b64 v[60:61], 0
  v_mov_b64 v[62:63], 0
  v_mov_b64 v[64:65], 0
  v_mov_b64 v[66:67], 0
  v_mov_b64 v[68:69], 0
  v_mov_b64 v[70:71], 0
  v_mov_b64 v[72:73], 0
  v_mov_b64 v[74:75], 0
  v_xor_b32 v32, 2048, v2
  v_xor_b32 v40, 4096, v2
  v_xor_b32 v48, 6144, v2
  v_min_u32 v124, -2, v124
  v_bfe_u32 v45, v2, 9, 1
  v_and_b32 v4, 0x1ff, v2
  v_lshlrev_b32 v4, 2, v4
  s_add_u32 s59, s57, s73
  v_lshl_add_u32 v4, v45, 24, v4
  s_sub_u32 s68, s60, s59
  v_writelane_b32 v4, s68, 1
  s_waitcnt vmcnt(0)
  ds_read_b128 v[116:119], v2 offset:8192
  ds_read_b128 v[120:123], v2 offset:9216
  s_cmp_eq_u32 s4, 0
  s_cbranch_scc1 L_entry_x
  s_branch L_entry_f
L_poll2_f:
  buffer_load_dwordx4 v[20:23], v2, s[40:43], s63 offen sc1
  buffer_load_dwordx4 v[24:27], v2, s[40:43], s63 offen offset:1024 sc1
  s_nop 15
  s_nop 6
  buffer_load_dwordx4 v[28:31], v2, s[40:43], s63 offen sc1
  buffer_load_dwordx4 v[36:39], v2, s[40:43], s63 offen offset:1024 sc1
  ds_read_b128 v[116:119], v2 offset:8192
  ds_read_b128 v[120:123], v2 offset:9216
  v_readlane_b32 s69, v4, 1
  v_xor_b32 v10, 0x2000, v10
  s_waitcnt vmcnt(5)
  v_xor_b32 v32, 2048, v2
  v_xor_b32 v40, 4096, v2
  v_xor_b32 v48, 6144, v2
  s_cmp_lt_u32 s69, s92
  s_cbranch_scc1 L_fs_f
L_fsback_f:
  s_add_u32 s56, s56, 1
  s_xor_b32 s65, s65, 1
  s_add_u32 s68, s56, 1
  s_min_u32 s68, s68, 63
  s_lshl_b32 s68, s68, 13
  s_add_u32 s57, s72, s68
  s_add_u32 s58, s57, 0x1000000
  s_add_u32 s68, s56, 3
  s_min_u32 s92, s68, 64
  s_add_u32 s61, s61, 0x20000
  s_xor_b32 s70, s70, 0x2000
  v_min_u32 v124, -2, v124
  v_bfe_u32 v45, v2, 9, 1
  v_and_b32 v4, 0x1ff, v2
  v_lshlrev_b32 v4, 2, v4
  s_add_u32 s59, s57, s73
  v_lshl_add_u32 v4, v45, 24, v4
  s_sub_u32 s68, s60, s59
  v_writelane_b32 v4, s68, 1
L_entry_f:
  s_waitcnt vmcnt(3)
  ds_write_b128 v2, v[20:23] offset:0
  v_smfmac_f32_16x16x64_bf16 v[52:55], v[20:23], a[0:7], v1
  s_waitcnt vmcnt(2)
  ds_write_b128 v2, v[24:27] offset:1024
  v_max3_u32 v44, v20, v21, v22
  v_max3_u32 v44, v44, v23, v24
  v_max3_u32 v44, v44, v25, v26
  v_max_u32 v44, v44, v27
  v_cmp_eq_u32 vcc, -1, v44
  v_smfmac_f32_16x16x64_bf16 v[56:59], v[20:23], a[64:71], v1
  s_mov_b32 m0, s70
  v_smfmac_f32_16x16x64_bf16 v[52:55], v[24:27], a[8:15], v1
  s_cbranch_vccnz L_retry2_f
  buffer_load_dwordx4 v2, s[40:43], s57 offen offset:0 sc1 lds
  v_smfmac_f32_16x16x64_bf16 v[56:59], v[24:27], a[72:79], v1
  buffer_load_dwordx4 v2, s[40:43], s57 offen offset:1024 sc1 lds
  s_mov_b32 m0, s71
  v_smfmac_f32_16x16x64_bf16 v[60:63], v[20:23], a[128:135], v1
  s_waitcnt lgkmcnt(2)
  buffer_load_dwordx4 v2, s[40:43], s58 offen offset:0 sc1 lds
  v_smfmac_f32_16x16x64_bf16 v[64:67], v[20:23], a[192:199], v1
  buffer_load_dwordx4 v2, s[40:43], s58 offen offset:1024 sc1 lds
  v_smfmac_f32_16x16x64_bf16 v[60:63], v[24:27], a[136:143], v1
  s_waitcnt vmcnt(4) lgkmcnt(0)
  s_barrier
  ds_read_b128 v[28:31], v32 offset:0
  ds_read_b128 v[32:35], v32 offset:1024
  v_smfmac_f32_16x16x64_bf16 v[64:67], v[24:27], a[200:207], v1
  ds_read_b128 v[36:39], v40 offset:0
  buffer_load_dword v4, v4, s[40:43], s59 offen sc1
  v_smfmac_f32_16x16x64_bf16 v[68:71], v[20:23], v[76:83], v1
  ds_read_b128 v[40:43], v40 offset:1024
  ds_read_b128 v[44:47], v48 offset:0
  v_smfmac_f32_16x16x64_bf16 v[72:75], v[20:23], v[84:91], v1
  ds_read_b128 v[48:51], v48 offset:1024
  v_smfmac_f32_16x16x64_bf16 v[68:71], v[24:27], v[92:99], v1
  buffer_store_dwordx4 v[124:127], v2, s[40:43], s61 offen sc1
  v_smfmac_f32_16x16x64_bf16 v[72:75], v[24:27], v[100:107], v1
  s_waitcnt lgkmcnt(5)
  ds_read_b128 v[76:79], v3 offset:16384
  v_smfmac_f32_16x16x64_bf16 v[52:55], v[28:31], a[16:23], v1
  s_waitcnt lgkmcnt(5)
  ds_read_b128 v[20:23], v3 offset:2048
  v_smfmac_f32_16x16x64_bf16 v[52:55], v[32:35], a[24:31], v1
  s_waitcnt lgkmcnt(5)
  ds_read_b128 v[24:27], v3 offset:3072
  v_smfmac_f32_16x16x64_bf16 v[52:55], v[36:39], a[32:39], v1
  s_waitcnt lgkmcnt(5)
  ds_read_b128 v[80:83], v3 offset:17408
  v_smfmac_f32_16x16x64_bf16 v[52:55], v[40:43], a[40:47], v1
  s_waitcnt lgkmcnt(4)
  ds_read_b128 v[84:87], v3 offset:18432
  v_smfmac_f32_16x16x64_bf16 v[52:55], v[44:47], a[48:55], v1
  ds_read_b128 v[88:91], v3 offset:19456
  v_smfmac_f32_16x16x64_bf16 v[52:55], v[48:51], a[56:63], v1
  s_nop 0
  ds_read_b128 v[92:95], v0 offset:0
  v_xor_b32 v3, 0x18000, v3
  v_smfmac_f32_16x16x64_bf16 v[68:71], v[28:31], v[108:115], v1
  s_nop 0
  ds_read_b128 v[96:99], v0 offset:2048
  v_smfmac_f32_16x16x64_bf16 v[56:59], v[28:31], a[80:87], v1
  s_nop 0
  ds_read_b128 v[108:111], v3 offset:0
  v_add_f32 v52, v52, v53
  v_smfmac_f32_16x16x64_bf16 v[56:59], v[32:35], a[88:95], v1
  s_waitcnt lgkmcnt(6)
  ds_read_b128 v[112:115], v3 offset:1024
  v_add_f32 v54, v54, v55
  v_smfmac_f32_16x16x64_bf16 v[72:75], v[28:31], v[20:27], v1
  ds_read_b128 v[100:103], v0 offset:4096
  v_mul_f32 v52, s88, v52
  v_smfmac_f32_16x16x64_bf16 v[56:59], v[36:39], a[96:103], v1
  ds_read_b128 v[20:23], v3 offset:2048
  v_mul_f32 v54, s88, v54
  v_smfmac_f32_16x16x64_bf16 v[56:59], v[40:43], a[104:111], v1
  ds_read_b128 v[24:27], v3 offset:3072
  v_cvt_pk_bf16_f32 v52, v52, v52
  v_smfmac_f32_16x16x64_bf16 v[56:59], v[44:47], a[112:119], v1
  s_barrier
  v_cvt_pk_bf16_f32 v53, v54, v54
  v_smfmac_f32_16x16x64_bf16 v[56:59], v[48:51], a[120:127], v1
  s_waitcnt lgkmcnt(7)
  ds_write_b64 v5, v[52:53] offset:0
  v_smfmac_f32_16x16x64_bf16 v[68:71], v[32:35], v[76:83], v1
  s_nop 0
  ds_read_b128 v[104:107], v0 offset:6144
  v_smfmac_f32_16x16x64_bf16 v[72:75], v[32:35], v[84:91], v1
  s_nop 0
  ds_read_b128 v[76:79], v3 offset:16384
  v_add_f32 v56, v56, v57
  v_smfmac_f32_16x16x64_bf16 v[60:63], v[28:31], a[144:151], v1
  ds_read_b128 v[80:83], v3 offset:17408
  v_add_f32 v58, v58, v59
  v_smfmac_f32_16x16x64_bf16 v[60:63], v[32:35], a[152:159], v1
  s_waitcnt lgkmcnt(4)
  ds_read_b128 v[84:87], v3 offset:18432
  v_mul_f32 v56, s88, v56
  v_smfmac_f32_16x16x64_bf16 v[68:71], v[36:39], v[108:115], v1
  ds_read_b128 v[88:91], v3 offset:19456
  v_mul_f32 v58, s88, v58
  v_smfmac_f32_16x16x64_bf16 v[60:63], v[36:39], a[160:167], v1
  v_cvt_pk_bf16_f32 v56, v56, v56
  v_smfmac_f32_16x16x64_bf16 v[72:75], v[36:39], v[20:27], v1
  v_cvt_pk_bf16_f32 v57, v58, v58
  v_smfmac_f32_16x16x64_bf16 v[60:63], v[40:43], a[168:175], v1
  ds_write_b64 v5, v[56:57] offset:2048
  v_xor_b32 v3, 0x8000, v3
  v_smfmac_f32_16x16x64_bf16 v[60:63], v[44:47], a[176:183], v1
  ds_read_b128 v[108:111], v3 offset:0
  v_smfmac_f32_16x16x64_bf16 v[60:63], v[48:51], a[184:191], v1
  s_waitcnt lgkmcnt(2)
  ds_read_b128 v[112:115], v3 offset:1024
  v_smfmac_f32_16x16x64_bf16 v[68:71], v[40:43], v[76:83], v1
  s_nop 0
  ds_read_b128 v[20:23], v3 offset:16384
  v_smfmac_f32_16x16x64_bf16 v[72:75], v[40:43], v[84:91], v1
  s_nop 0
  ds_read_b128 v[24:27], v3 offset:17408
  v_add_f32 v60, v60, v61
  v_smfmac_f32_16x16x64_bf16 v[64:67], v[28:31], a[208:215], v1
  s_waitcnt lgkmcnt(4)
  s_barrier
  v_add_f32 v62, v62, v63
  v_smfmac_f32_16x16x64_bf16 v[64:67], v[32:35], a[216:223], v1
  ds_read_b64_tr_b16 v[76:77], v6 offset:0
  ds_read_b64_tr_b16 v[78:79], v6 offset:2048
  v_smfmac_f32_16x16x64_bf16 v[64:67], v[36:39], a[224:231], v1
  ds_read_b64_tr_b16 v[80:81], v6 offset:512
  ds_read_b64_tr_b16 v[82:83], v6 offset:2560
  v_smfmac_f32_16x16x64_bf16 v[64:67], v[40:43], a[232:239], v1
  ds_read_b64_tr_b16 v[84:85], v6 offset:1024
  ds_read_b64_tr_b16 v[86:87], v6 offset:3072
  v_smfmac_f32_16x16x64_bf16 v[64:67], v[44:47], a[240:247], v1
  ds_read_b64_tr_b16 v[88:89], v6 offset:1536
  ds_read_b64_tr_b16 v[90:91], v6 offset:3584
  v_smfmac_f32_16x16x64_bf16 v[64:67], v[48:51], a[248:255], v1
  s_waitcnt lgkmcnt(8)
  ds_read_b128 v[28:31], v0 offset:1024
  v_cvt_pk_bf16_f32 v124, v60, v62
  v_smfmac_f32_16x16x64_bf16 v[68:71], v[44:47], v[108:115], v1
  s_nop 0
  ds_read_b128 v[32:35], v0 offset:3072
  v_smfmac_f32_16x16x64_bf16 v[68:71], v[48:51], v[20:27], v1
  s_waitcnt lgkmcnt(2)
  ds_read_b128 v[36:39], v0 offset:5120
  v_add_f32 v64, v64, v65
  v_mfma_f32_16x16x32_bf16 v[52:55], v[92:95], v[76:79], 0
  v_add_f32 v66, v66, v67
  v_cvt_pk_bf16_f32 v125, v64, v66
  v_mfma_f32_16x16x32_bf16 v[52:55], v[96:99], v[80:83], v[52:55]
  ds_write2st64_b32 v5, v124, v125 offset0:16 offset1:24
  ds_read_b128 v[40:43], v0 offset:7168
  v_mfma_f32_16x16x32_bf16 v[52:55], v[100:103], v[84:87], v[52:55]
  ds_read_b128 v[108:111], v3 offset:2048
  v_add_f32 v68, v68, v69
  v_mfma_f32_16x16x32_bf16 v[52:55], v[104:107], v[88:91], v[52:55]
  s_waitcnt lgkmcnt(3)
  ds_read_b128 v[112:115], v3 offset:3072
  v_add_f32 v70, v70, v71
  v_mfma_f32_16x16x32_bf16 v[56:59], v[28:31], v[76:79], 0
  ds_read_b128 v[20:23], v3 offset:18432
  v_cvt_pk_bf16_f32 v126, v68, v70
  v_mfma_f32_16x16x32_bf16 v[56:59], v[32:35], v[80:83], v[56:59]
  ds_read_b128 v[24:27], v3 offset:19456
  v_mfma_f32_16x16x32_bf16 v[56:59], v[36:39], v[84:87], v[56:59]
  s_waitcnt lgkmcnt(4)
  s_barrier
  ds_read_b64_tr_b16 v[92:93], v6 offset:4096
  ds_read_b64_tr_b16 v[94:95], v6 offset:6144
  v_mfma_f32_16x16x32_bf16 v[56:59], v[40:43], v[88:91], v[56:59]
  s_waitcnt lgkmcnt(4)
  ds_read_b64_tr_b16 v[96:97], v6 offset:4608
  ds_read_b64_tr_b16 v[98:99], v6 offset:6656
  v_smfmac_f32_16x16x64_bf16 v[72:75], v[44:47], v[108:115], v1
  s_waitcnt lgkmcnt(4)
  ds_read_b64_tr_b16 v[100:101], v6 offset:5120
  ds_read_b64_tr_b16 v[102:103], v6 offset:7168
  v_smfmac_f32_16x16x64_bf16 v[72:75], v[48:51], v[20:27], v1
  ds_read_b64_tr_b16 v[104:105], v6 offset:5632
  ds_read_b64_tr_b16 v[106:107], v6 offset:7680
  v_exp_f32 v28, v52
  v_exp_f32 v29, v53
  v_exp_f32 v30, v54
  s_waitcnt lgkmcnt(4)
  v_mfma_f32_16x16x32_bf16 v[60:63], v[92:95], v[76:79], 0
  v_exp_f32 v31, v55
  v_mfma_f32_16x16x32_bf16 v[60:63], v[96:99], v[80:83], v[60:63]
  s_waitcnt lgkmcnt(0)
  v_exp_f32 v36, v56
  v_mfma_f32_16x16x32_bf16 v[60:63], v[100:103], v[84:87], v[60:63]
  v_exp_f32 v37, v57
  v_mfma_f32_16x16x32_bf16 v[60:63], v[104:107], v[88:91], v[60:63]
  s_cmp_eq_u32 s56, 63
  v_exp_f32 v38, v58
  v_exp_f32 v39, v59
  v_cvt_pk_bf16_f32 v32, v28, v29
  v_cvt_pk_bf16_f32 v33, v30, v31
  v_cvt_pk_bf16_f32 v34, v36, v37
  v_cvt_pk_bf16_f32 v35, v38, v39
  v_add_f32 v72, v72, v73
  v_exp_f32 v28, v60
  v_mfma_f32_16x16x32_bf16 v[64:67], v[12:15], v[32:35], 0
  v_exp_f32 v29, v61
  v_mfma_f32_16x16x32_bf16 v[80:83], v[116:119], v[32:35], 0
  v_add_f32 v74, v74, v75
  v_cvt_pk_bf16_f32 v16, v28, v29
  v_mfma_f32_16x16x32_bf16 v[84:87], v[120:123], v[32:35], 0
  v_cvt_pk_bf16_f32 v127, v72, v74
  v_cvt_pk_bf16_f32 v19, v28, v29
  v_mfma_f32_16x16x16_bf16 v[64:67], v[12:13], v[16:17], v[64:67]
  s_cbranch_scc1 L_team_last
  v_xor_b32 v3, 0x18000, v3
  v_mov_b64 v[44:45], 0
  v_mfma_f32_16x16x16_bf16 v[80:83], v[126:127], v[16:17], v[80:83]
  s_nop 0
  v_mov_b64 v[46:47], 0
  v_mov_b64 v[48:49], 0
  v_mfma_f32_16x16x16_bf16 v[84:87], v[126:127], v[18:19], v[84:87]
  v_rcp_f32 v65, v64
  v_subrev_u32 v66, s89, v64
  v_cmp_le_u32 vcc, s91, v66
  v_mov_b64 v[50:51], 0
L_smback_f:
  v_mul_f32 v80, v80, v65
  v_mul_f32 v81, v81, v65
  v_mul_f32 v82, v82, v65
  v_mul_f32 v83, v83, v65
  v_cvt_pk_bf16_f32 v88, v80, v81
  v_cvt_pk_bf16_f32 v89, v82, v83
  ds_write_b64 v7, v[88:89]
  v_mul_f32 v84, v84, v65
  v_mul_f32 v85, v85, v65
  v_mul_f32 v86, v86, v65
  v_mul_f32 v87, v87, v65
  v_cvt_pk_bf16_f32 v90, v84, v85
  v_cvt_pk_bf16_f32 v91, v86, v87
  s_cbranch_vccnz L_smslow_f
  ds_write_b64 v7, v[90:91] offset:8
  v_xor_b32 v96, 512, v7
  v_xor_b32 v100, 1024, v7
  v_xor_b32 v104, 1536, v7
  v_mov_b64 v[36:37], 0
  v_mov_b64 v[38:39], 0
  v_mov_b64 v[40:41], 0
  v_mov_b64 v[42:43], 0
  v_lshrrev_b32 v24, 16, v12
  v_cndmask_b32 v24, v24, 1.0, s[94:95]
  v_cndmask_b32 v20, 0, v24, s[80:81]
  v_cndmask_b32 v21, 0, v24, s[82:83]
  v_cndmask_b32 v22, 0, v24, s[84:85]
  v_cndmask_b32 v23, 0, v24, s[86:87]
  v_smfmac_f32_16x16x64_bf16 v[48:51], v[88:91], v[224:231], v1
  s_waitcnt lgkmcnt(0)
  s_barrier
  ds_read_b128 v[96:99], v96
  v_smfmac_f32_16x16x64_bf16 v[44:47], v[88:91], v[192:199], v1
  ds_read_b128 v[100:103], v100
  ds_read_b128 v[104:107], v104
  v_smfmac_f32_16x16x64_bf16 v[40:43], v[88:91], v[160:167], v1
  v_mov_b64 v[60:61], 0
  v_smfmac_f32_16x16x64_bf16 v[36:39], v[88:91], v[128:135], v1
  v_mov_b64 v[62:63], 0
  v_mov_b64 v[64:65], 0
  v_mov_b64 v[66:67], 0
  s_waitcnt lgkmcnt(2)
  v_smfmac_f32_16x16x64_bf16 v[36:39], v[96:99], v[136:143], v1
  s_waitcnt lgkmcnt(1)
  v_mov_b64 v[52:53], 0
  v_smfmac_f32_16x16x64_bf16 v[36:39], v[100:103], v[144:151], v1
  s_waitcnt lgkmcnt(0)
  v_mov_b64 v[54:55], 0
  v_smfmac_f32_16x16x64_bf16 v[36:39], v[104:107], v[152:159], v1
  s_nop 1
  v_mov_b64 v[56:57], 0
  v_smfmac_f32_16x16x64_bf16 v[40:43], v[96:99], v[168:175], v1
  s_nop 1
  v_mov_b64 v[58:59], 0
  v_smfmac_f32_16x16x64_bf16 v[40:43], v[100:103], v[176:183], v1
  v_cvt_pk_bf16_f32 v36, v36, v37
  v_cvt_pk_bf16_f32 v37, v38, v39
  v_and_or_b32 v36, v36, -2, s65
  v_smfmac_f32_16x16x64_bf16 v[40:43], v[104:107], v[184:191], v1
  s_nop 1
  buffer_store_dwordx2 v[36:37], v8, s[40:43], s74 offen
  v_smfmac_f32_16x16x64_bf16 v[44:47], v[96:99], v[200:207], v1
  s_nop 2
  v_smfmac_f32_16x16x64_bf16 v[44:47], v[100:103], v[208:215], v1
  v_cvt_pk_bf16_f32 v40, v40, v41
  v_cvt_pk_bf16_f32 v41, v42, v43
  v_and_or_b32 v40, v40, -2, s65
  v_smfmac_f32_16x16x64_bf16 v[44:47], v[104:107], v[216:223], v1
  s_nop 1
  buffer_store_dwordx2 v[40:41], v8, s[40:43], s75 offen
  v_smfmac_f32_16x16x64_bf16 v[48:51], v[96:99], v[232:239], v1
  s_nop 2
  v_smfmac_f32_16x16x64_bf16 v[48:51], v[100:103], v[240:247], v1
  v_cvt_pk_bf16_f32 v44, v44, v45
  v_cvt_pk_bf16_f32 v45, v46, v47
  v_and_or_b32 v44, v44, -2, s65
  v_smfmac_f32_16x16x64_bf16 v[48:51], v[104:107], v[248:255], v1
  s_nop 1
  buffer_store_dwordx2 v[44:45], v8, s[40:43], s76 offen
  s_nop 4
  v_cvt_pk_bf16_f32 v48, v48, v49
  v_cvt_pk_bf16_f32 v49, v50, v51
  v_and_or_b32 v48, v48, -2, s65
  buffer_store_dwordx2 v[48:49], v8, s[40:43], s77 offen
  s_barrier
  s_nop 15
  s_nop 9
  s_cmp_lt_u32 s44, 1
  s_cbranch_scc1 L_poll1_f
  s_nop 9
  s_cmp_lt_u32 s44, 2
  s_cbranch_scc1 L_poll1_f
  s_nop 9
  s_cmp_lt_u32 s44, 3
  s_cbranch_scc1 L_poll1_f
  s_nop 9
L_poll1_f:
  buffer_load_dwordx4 v[28:31], v9, s[40:43], s62 offen sc1
  buffer_load_dwordx4 v[32:35], v9, s[40:43], s62 offen offset:1024 sc1
  v_mov_b64 v[64:65], 0
  v_mov_b64 v[66:67], 0
  v_mov_b64 v[68:69], 0
  v_mov_b64 v[70:71], 0
  v_mov_b64 v[72:73], 0
  v_mov_b64 v[74:75], 0
  s_xor_b32 s63, s63, 0x2000
  v_xor_b32 v0, 0x2000, v0
  v_xor_b32 v7, 0x2000, v7
  s_nop 15
  s_nop 3
  buffer_load_dwordx4 v[36:39], v9, s[40:43], s62 offen sc1
  buffer_load_dwordx4 v[40:43], v9, s[40:43], s62 offen offset:1024 sc1
  ds_read_b128 v[76:79], v3 offset:0
  ds_read_b128 v[80:83], v3 offset:1024
  ds_read_b128 v[84:87], v3 offset:2048
  ds_read_b128 v[88:91], v3 offset:3072
  ds_read_b128 v[92:95], v3 offset:16384
  ds_read_b128 v[96:99], v3 offset:17408
  ds_read_b128 v[100:103], v3 offset:18432
  ds_read_b128 v[104:107], v3 offset:19456
  v_xor_b32 v3, 0x8000, v3
  ds_read_b128 v[108:111], v3 offset:0
  ds_read_b128 v[112:115], v3 offset:1024
L_poll1b_f:
  s_waitcnt vmcnt(3)
  v_mfma_f32_16x16x32_bf16 v[24:27], v[28:31], v[20:23], 0
  v_bitop3_b32 v44, v28, v30, s65 bitop3:0x7e
  s_waitcnt vmcnt(2)
  v_mfma_f32_16x16x32_bf16 v[24:27], v[32:35], v[20:23], v[24:27]
  v_bitop3_b32 v45, v32, v34, s65 bitop3:0x7e
  v_or_b32 v44, v44, v45
  v_and_b32 v44, 1, v44
  v_cmp_ne_u32 vcc, 0, v44
  s_nop 2
  s_cbranch_vccnz L_retry1_f
L_got1_f:
  v_add_f32 v24, v24, v25
  v_add_f32 v26, v26, v27
  s_nop 1
  v_permlane16_swap_b32 v24, v26
  v_add_f32 v24, v24, v26
  v_cvt_pk_bf16_f32 v24, v24, v17
  v_min_u32 v24, s90, v24
  v_cndmask_b32 v24, v24, -1, s[78:79]
  buffer_store_short v24, v10, s[40:43], s64 offen
  s_nop 15
  s_nop 15
  s_nop 15
  s_nop 1
  s_branch L_poll2_f
L_retry2_f:
  s_waitcnt vmcnt(0)
  v_max3_u32 v44, v28, v29, v30
  v_max3_u32 v45, v31, v36, v37
  v_max3_u32 v44, v44, v38, v39
  v_max_u32 v44, v44, v45
  v_cmp_eq_u32 vcc, -1, v44
  v_mov_b64 v[20:21], v[28:29]
  v_mov_b64 v[22:23], v[30:31]
  v_mov_b64 v[24:25], v[36:37]
  v_mov_b64 v[26:27], v[38:39]
  v_mov_b64 v[52:53], 0
  v_mov_b64 v[54:55], 0
  v_mov_b64 v[56:57], 0
  v_mov_b64 v[58:59], 0
  s_cbranch_vccz L_entry_f
  buffer_load_dwordx4 v[20:23], v2, s[40:43], s63 offen sc1
  buffer_load_dwordx4 v[24:27], v2, s[40:43], s63 offen offset:1024 sc1
  s_add_u32 s67, s67, 1
  s_cmp_gt_u32 s67, 1048576
  s_cbranch_scc1 L_exit
  s_nop 15
  s_nop 3
  buffer_load_dwordx4 v[28:31], v2, s[40:43], s63 offen sc1
  buffer_load_dwordx4 v[36:39], v2, s[40:43], s63 offen offset:1024 sc1
  s_branch L_entry_f
L_retry1_f:
  buffer_load_dwordx4 v[28:31], v9, s[40:43], s62 offen sc1
  buffer_load_dwordx4 v[32:35], v9, s[40:43], s62 offen offset:1024 sc1
  s_waitcnt vmcnt(3)
  v_mfma_f32_16x16x32_bf16 v[24:27], v[36:39], v[20:23], 0
  v_bitop3_b32 v44, v36, v38, s65 bitop3:0x7e
  s_waitcnt vmcnt(2)
  v_mfma_f32_16x16x32_bf16 v[24:27], v[40:43], v[20:23], v[24:27]
  v_bitop3_b32 v45, v40, v42, s65 bitop3:0x7e
  v_or_b32 v44, v44, v45
  v_and_b32 v44, 1, v44
  v_cmp_ne_u32 vcc, 0, v44
  s_nop 2
  s_cbranch_vccnz L_retry1b_f
  v_add_f32 v24, v24, v25
  v_add_f32 v26, v26, v27
  s_nop 1
  v_permlane16_swap_b32 v24, v26
  v_add_f32 v24, v24, v26
  v_cvt_pk_bf16_f32 v24, v24, v17
  v_min_u32 v24, s90, v24
  v_cndmask_b32 v24, v24, -1, s[78:79]
  buffer_store_short v24, v10, s[40:43], s64 offen
  s_nop 15
  s_nop 15
  s_nop 15
  s_nop 1
  s_branch L_poll2_f
L_retry1b_f:
  buffer_load_dwordx4 v[36:39], v9, s[40:43], s62 offen sc1
  buffer_load_dwordx4 v[40:43], v9, s[40:43], s62 offen offset:1024 sc1
  s_add_u32 s67, s67, 1
  s_cmp_gt_u32 s67, 1048576
  s_cbranch_scc1 L_exit
  s_branch L_poll1b_f
L_smslow_f:
  v_max3_f32 v30, v52, v53, v54
  v_max3_f32 v30, v30, v55, v56
  v_max3_f32 v30, v30, v57, v58
  v_max3_f32 v30, v30, v59, v60
  v_max_f32 v30, v30, v61
  v_mov_b32 v28, v30
  s_nop 1
  v_permlane32_swap_b32 v28, v30
  v_max_f32 v30, v30, v28
  v_mov_b32 v28, v30
  s_nop 1
  v_permlane16_swap_b32 v28, v30
  v_max_f32 v30, v30, v28
  v_sub_f32 v28, v52, v30
  v_sub_f32 v29, v53, v30
  v_exp_f32 v28, v28
  v_exp_f32 v29, v29
  s_nop 0
  v_cvt_pk_bf16_f32 v32, v28, v29
  v_sub_f32 v28, v54, v30
  v_sub_f32 v29, v55, v30
  v_exp_f32 v28, v28
  v_exp_f32 v29, v29
  s_nop 0
  v_cvt_pk_bf16_f32 v33, v28, v29
  v_sub_f32 v28, v56, v30
  v_sub_f32 v29, v57, v30
  v_exp_f32 v28, v28
  v_exp_f32 v29, v29
  s_nop 0
  v_cvt_pk_bf16_f32 v34, v28, v29
  v_sub_f32 v28, v58, v30
  v_sub_f32 v29, v59, v30
  v_exp_f32 v28, v28
  v_exp_f32 v29, v29
  s_nop 0
  v_cvt_pk_bf16_f32 v35, v28, v29
  v_sub_f32 v28, v60, v30
  v_sub_f32 v29, v61, v30
  v_exp_f32 v28, v28
  v_exp_f32 v29, v29
  s_nop 0
  v_cvt_pk_bf16_f32 v16, v28, v29
  v_cvt_pk_bf16_f32 v19, v28, v29
  s_nop 1
  v_mfma_f32_16x16x32_bf16 v[64:67], v[12:15], v[32:35], 0
  v_mfma_f32_16x16x32_bf16 v[80:83], v[116:119], v[32:35], 0
  v_mfma_f32_16x16x32_bf16 v[84:87], v[120:123], v[32:35], 0
  s_nop 3
  v_mfma_f32_16x16x16_bf16 v[64:67], v[12:13], v[16:17], v[64:67]
  v_mfma_f32_16x16x16_bf16 v[80:83], v[126:127], v[16:17], v[80:83]
  v_mfma_f32_16x16x16_bf16 v[84:87], v[126:127], v[18:19], v[84:87]
  s_nop 7
  v_rcp_f32 v65, v64
  s_mov_b64 vcc, 0
  s_branch L_smback_f
L_fs_f:
  buffer_load_dword v4, v17, s[40:43], s60 offen sc1
  s_add_u32 s67, s67, 1
  s_cmp_gt_u32 s67, 1048576
  s_cbranch_scc1 L_exit
  s_waitcnt vmcnt(0)
  v_cmp_gt_u32 vcc, s92, v4
  s_cbranch_vccnz L_fs_f
  s_branch L_fsback_f
L_poll2_x:
  buffer_load_dwordx4 v[20:23], v2, s[40:43], s63 offen sc1
  buffer_load_dwordx4 v[24:27], v2, s[40:43], s63 offen offset:1024 sc1
  s_nop 15
  s_nop 6
  buffer_load_dwordx4 v[28:31], v2, s[40:43], s63 offen sc1
  buffer_load_dwordx4 v[36:39], v2, s[40:43], s63 offen offset:1024 sc1
  ds_read_b128 v[116:119], v2 offset:8192
  ds_read_b128 v[120:123], v2 offset:9216
  v_readlane_b32 s69, v4, 1
  v_xor_b32 v10, 0x2000, v10
  s_waitcnt vmcnt(5)
  v_xor_b32 v32, 2048, v2
  v_xor_b32 v40, 4096, v2
  v_xor_b32 v48, 6144, v2
  s_cmp_lt_u32 s69, s92
  s_cbranch_scc1 L_fs_x
L_fsback_x:
  s_add_u32 s56, s56, 1
  s_xor_b32 s65, s65, 1
  s_add_u32 s68, s56, 1
  s_min_u32 s68, s68, 63
  s_lshl_b32 s68, s68, 13
  s_add_u32 s57, s72, s68
  s_add_u32 s58, s57, 0x1000000
  s_add_u32 s68, s56, 3
  s_min_u32 s92, s68, 64
  s_add_u32 s61, s61, 0x20000
  s_xor_b32 s70, s70, 0x2000
  v_min_u32 v124, -2, v124
  v_bfe_u32 v45, v2, 9, 1
  v_and_b32 v4, 0x1ff, v2
  v_lshlrev_b32 v4, 2, v4
  s_add_u32 s59, s57, s73
  v_lshl_add_u32 v4, v45, 24, v4
  s_sub_u32 s68, s60, s59
  v_writelane_b32 v4, s68, 1
L_entry_x:
  s_waitcnt vmcnt(3)
  ds_write_b128 v2, v[20:23] offset:0
  v_smfmac_f32_16x16x64_bf16 v[52:55], v[20:23], a[0:7], v1
  s_waitcnt vmcnt(2)
  ds_write_b128 v2, v[24:27] offset:1024
  v_max3_u32 v44, v20, v21, v22
  v_max3_u32 v44, v44, v23, v24
  v_max3_u32 v44, v44, v25, v26
  v_max_u32 v44, v44, v27
  v_cmp_eq_u32 vcc, -1, v44
  v_smfmac_f32_16x16x64_bf16 v[56:59], v[20:23], a[64:71], v1
  s_mov_b32 m0, s70
  v_smfmac_f32_16x16x64_bf16 v[52:55], v[24:27], a[8:15], v1
  s_cbranch_vccnz L_retry2_x
  buffer_load_dwordx4 v2, s[40:43], s57 offen offset:0 sc1 lds
  v_smfmac_f32_16x16x64_bf16 v[56:59], v[24:27], a[72:79], v1
  buffer_load_dwordx4 v2, s[40:43], s57 offen offset:1024 sc1 lds
  s_mov_b32 m0, s71
  v_smfmac_f32_16x16x64_bf16 v[60:63], v[20:23], a[128:135], v1
  s_waitcnt lgkmcnt(2)
  buffer_load_dwordx4 v2, s[40:43], s58 offen offset:0 sc1 lds
  v_smfmac_f32_16x16x64_bf16 v[64:67], v[20:23], a[192:199], v1
  buffer_load_dwordx4 v2, s[40:43], s58 offen offset:1024 sc1 lds
  v_smfmac_f32_16x16x64_bf16 v[60:63], v[24:27], a[136:143], v1
  s_waitcnt vmcnt(4) lgkmcnt(0)
  s_barrier
  ds_read_b128 v[28:31], v32 offset:0
  ds_read_b128 v[32:35], v32 offset:1024
  v_smfmac_f32_16x16x64_bf16 v[64:67], v[24:27], a[200:207], v1
  ds_read_b128 v[36:39], v40 offset:0
  buffer_load_dword v4, v4, s[40:43], s59 offen sc1
  v_smfmac_f32_16x16x64_bf16 v[68:71], v[20:23], v[76:83], v1
  ds_read_b128 v[40:43], v40 offset:1024
  ds_read_b128 v[44:47], v48 offset:0
  v_smfmac_f32_16x16x64_bf16 v[72:75], v[20:23], v[84:91], v1
  ds_read_b128 v[48:51], v48 offset:1024
  v_smfmac_f32_16x16x64_bf16 v[68:71], v[24:27], v[92:99], v1
  buffer_store_dwordx4 v[124:127], v2, s[40:43], s61 offen sc1
  v_smfmac_f32_16x16x64_bf16 v[72:75], v[24:27], v[100:107], v1
  s_waitcnt lgkmcnt(5)
  ds_read_b128 v[76:79], v3 offset:16384
  v_smfmac_f32_16x16x64_bf16 v[52:55], v[28:31], a[16:23], v1
  s_waitcnt lgkmcnt(5)
  ds_read_b128 v[20:23], v3 offset:2048
  v_smfmac_f32_16x16x64_bf16 v[52:55], v[32:35], a[24:31], v1
  s_waitcnt lgkmcnt(5)
  ds_read_b128 v[24:27], v3 offset:3072
  v_smfmac_f32_16x16x64_bf16 v[52:55], v[36:39], a[32:39], v1
  s_waitcnt lgkmcnt(5)
  ds_read_b128 v[80:83], v3 offset:17408
  v_smfmac_f32_16x16x64_bf16 v[52:55], v[40:43], a[40:47], v1
  s_waitcnt lgkmcnt(4)
  ds_read_b128 v[84:87], v3 offset:18432
  v_smfmac_f32_16x16x64_bf16 v[52:55], v[44:47], a[48:55], v1
  ds_read_b128 v[88:91], v3 offset:19456
  v_smfmac_f32_16x16x64_bf16 v[52:55], v[48:51], a[56:63], v1
  s_nop 0
  ds_read_b128 v[92:95], v0 offset:0
  v_xor_b32 v3, 0x18000, v3
  v_smfmac_f32_16x16x64_bf16 v[68:71], v[28:31], v[108:115], v1
  s_nop 0
  ds_read_b128 v[96:99], v0 offset:2048
  v_smfmac_f32_16x16x64_bf16 v[56:59], v[28:31], a[80:87], v1
  s_nop 0
  ds_read_b128 v[108:111], v3 offset:0
  v_add_f32 v52, v52, v53
  v_smfmac_f32_16x16x64_bf16 v[56:59], v[32:35], a[88:95], v1
  s_waitcnt lgkmcnt(6)
  ds_read_b128 v[112:115], v3 offset:1024
  v_add_f32 v54, v54, v55
  v_smfmac_f32_16x16x64_bf16 v[72:75], v[28:31], v[20:27], v1
  ds_read_b128 v[100:103], v0 offset:4096
  v_mul_f32 v52, s88, v52
  v_smfmac_f32_16x16x64_bf16 v[56:59], v[36:39], a[96:103], v1
  ds_read_b128 v[20:23], v3 offset:2048
  v_mul_f32 v54, s88, v54
  v_smfmac_f32_16x16x64_bf16 v[56:59], v[40:43], a[104:111], v1
  ds_read_b128 v[24:27], v3 offset:3072
  v_cvt_pk_bf16_f32 v52, v52, v52
  v_smfmac_f32_16x16x64_bf16 v[56:59], v[44:47], a[112:119], v1
  s_barrier
  v_cvt_pk_bf16_f32 v53, v54, v54
  v_smfmac_f32_16x16x64_bf16 v[56:59], v[48:51], a[120:127], v1
  s_waitcnt lgkmcnt(7)
  ds_write_b64 v5, v[52:53] offset:0
  v_smfmac_f32_16x16x64_bf16 v[68:71], v[32:35], v[76:83], v1
  s_nop 0
  ds_read_b128 v[104:107], v0 offset:6144
  v_smfmac_f32_16x16x64_bf16 v[72:75], v[32:35], v[84:91], v1
  s_nop 0
  ds_read_b128 v[76:79], v3 offset:16384
  v_add_f32 v56, v56, v57
  v_smfmac_f32_16x16x64_bf16 v[60:63], v[28:31], a[144:151], v1
  ds_read_b128 v[80:83], v3 offset:17408
  v_add_f32 v58, v58, v59
  v_smfmac_f32_16x16x64_bf16 v[60:63], v[32:35], a[152:159], v1
  s_waitcnt lgkmcnt(4)
  ds_read_b128 v[84:87], v3 offset:18432
  v_mul_f32 v56, s88, v56
  v_smfmac_f32_16x16x64_bf16 v[68:71], v[36:39], v[108:115], v1
  ds_read_b128 v[88:91], v3 offset:19456
  v_mul_f32 v58, s88, v58
  v_smfmac_f32_16x16x64_bf16 v[60:63], v[36:39], a[160:167], v1
  v_cvt_pk_bf16_f32 v56, v56, v56
  v_smfmac_f32_16x16x64_bf16 v[72:75], v[36:39], v[20:27], v1
  v_cvt_pk_bf16_f32 v57, v58, v58
  v_smfmac_f32_16x16x64_bf16 v[60:63], v[40:43], a[168:175], v1
  ds_write_b64 v5, v[56:57] offset:2048
  v_xor_b32 v3, 0x8000, v3
  v_smfmac_f32_16x16x64_bf16 v[60:63], v[44:47], a[176:183], v1
  ds_read_b128 v[108:111], v3 offset:0
  v_smfmac_f32_16x16x64_bf16 v[60:63], v[48:51], a[184:191], v1
  s_waitcnt lgkmcnt(2)
  ds_read_b128 v[112:115], v3 offset:1024
  v_smfmac_f32_16x16x64_bf16 v[68:71], v[40:43], v[76:83], v1
  s_nop 0
  ds_read_b128 v[20:23], v3 offset:16384
  v_smfmac_f32_16x16x64_bf16 v[72:75], v[40:43], v[84:91], v1
  s_nop 0
  ds_read_b128 v[24:27], v3 offset:17408
  v_add_f32 v60, v60, v61
  v_smfmac_f32_16x16x64_bf16 v[64:67], v[28:31], a[208:215], v1
  s_waitcnt lgkmcnt(4)
  s_barrier
  v_add_f32 v62, v62, v63
  v_smfmac_f32_16x16x64_bf16 v[64:67], v[32:35], a[216:223], v1
  ds_read_b64_tr_b16 v[76:77], v6 offset:0
  ds_read_b64_tr_b16 v[78:79], v6 offset:2048
  v_smfmac_f32_16x16x64_bf16 v[64:67], v[36:39], a[224:231], v1
  ds_read_b64_tr_b16 v[80:81], v6 offset:512
  ds_read_b64_tr_b16 v[82:83], v6 offset:2560
  v_smfmac_f32_16x16x64_bf16 v[64:67], v[40:43], a[232:239], v1
  ds_read_b64_tr_b16 v[84:85], v6 offset:1024
  ds_read_b64_tr_b16 v[86:87], v6 offset:3072
  v_smfmac_f32_16x16x64_bf16 v[64:67], v[44:47], a[240:247], v1
  ds_read_b64_tr_b16 v[88:89], v6 offset:1536
  ds_read_b64_tr_b16 v[90:91], v6 offset:3584
  v_smfmac_f32_16x16x64_bf16 v[64:67], v[48:51], a[248:255], v1
  s_waitcnt lgkmcnt(8)
  ds_read_b128 v[28:31], v0 offset:1024
  v_cvt_pk_bf16_f32 v124, v60, v62
  v_smfmac_f32_16x16x64_bf16 v[68:71], v[44:47], v[108:115], v1
  s_nop 0
  ds_read_b128 v[32:35], v0 offset:3072
  v_smfmac_f32_16x16x64_bf16 v[68:71], v[48:51], v[20:27], v1
  s_waitcnt lgkmcnt(2)
  ds_read_b128 v[36:39], v0 offset:5120
  v_add_f32 v64, v64, v65
  v_mfma_f32_16x16x32_bf16 v[52:55], v[92:95], v[76:79], 0
  v_add_f32 v66, v66, v67
  v_cvt_pk_bf16_f32 v125, v64, v66
  v_mfma_f32_16x16x32_bf16 v[52:55], v[96:99], v[80:83], v[52:55]
  ds_write2st64_b32 v5, v124, v125 offset0:16 offset1:24
  ds_read_b128 v[40:43], v0 offset:7168
  v_mfma_f32_16x16x32_bf16 v[52:55], v[100:103], v[84:87], v[52:55]
  ds_read_b128 v[108:111], v3 offset:2048
  v_add_f32 v68, v68, v69
  v_mfma_f32_16x16x32_bf16 v[52:55], v[104:107], v[88:91], v[52:55]
  s_waitcnt lgkmcnt(3)
  ds_read_b128 v[112:115], v3 offset:3072
  v_add_f32 v70, v70, v71
  v_mfma_f32_16x16x32_bf16 v[56:59], v[28:31], v[76:79], 0
  ds_read_b128 v[20:23], v3 offset:18432
  v_cvt_pk_bf16_f32 v126, v68, v70
  v_mfma_f32_16x16x32_bf16 v[56:59], v[32:35], v[80:83], v[56:59]
  ds_read_b128 v[24:27], v3 offset:19456
  v_mfma_f32_16x16x32_bf16 v[56:59], v[36:39], v[84:87], v[56:59]
  s_waitcnt lgkmcnt(4)
  s_barrier
  ds_read_b64_tr_b16 v[92:93], v6 offset:4096
  ds_read_b64_tr_b16 v[94:95], v6 offset:6144
  v_mfma_f32_16x16x32_bf16 v[56:59], v[40:43], v[88:91], v[56:59]
  s_waitcnt lgkmcnt(4)
  ds_read_b64_tr_b16 v[96:97], v6 offset:4608
  ds_read_b64_tr_b16 v[98:99], v6 offset:6656
  v_smfmac_f32_16x16x64_bf16 v[72:75], v[44:47], v[108:115], v1
  s_waitcnt lgkmcnt(4)
  ds_read_b64_tr_b16 v[100:101], v6 offset:5120
  ds_read_b64_tr_b16 v[102:103], v6 offset:7168
  v_smfmac_f32_16x16x64_bf16 v[72:75], v[48:51], v[20:27], v1
  ds_read_b64_tr_b16 v[104:105], v6 offset:5632
  ds_read_b64_tr_b16 v[106:107], v6 offset:7680
  v_exp_f32 v28, v52
  v_exp_f32 v29, v53
  v_exp_f32 v30, v54
  s_waitcnt lgkmcnt(4)
  v_mfma_f32_16x16x32_bf16 v[60:63], v[92:95], v[76:79], 0
  v_exp_f32 v31, v55
  v_mfma_f32_16x16x32_bf16 v[60:63], v[96:99], v[80:83], v[60:63]
  s_waitcnt lgkmcnt(0)
  v_exp_f32 v36, v56
  v_mfma_f32_16x16x32_bf16 v[60:63], v[100:103], v[84:87], v[60:63]
  v_exp_f32 v37, v57
  v_mfma_f32_16x16x32_bf16 v[60:63], v[104:107], v[88:91], v[60:63]
  s_cmp_eq_u32 s56, 63
  v_exp_f32 v38, v58
  v_exp_f32 v39, v59
  v_cvt_pk_bf16_f32 v32, v28, v29
  v_cvt_pk_bf16_f32 v33, v30, v31
  v_cvt_pk_bf16_f32 v34, v36, v37
  v_cvt_pk_bf16_f32 v35, v38, v39
  v_add_f32 v72, v72, v73
  v_exp_f32 v28, v60
  v_mfma_f32_16x16x32_bf16 v[64:67], v[12:15], v[32:35], 0
  v_exp_f32 v29, v61
  v_mfma_f32_16x16x32_bf16 v[80:83], v[116:119], v[32:35], 0
  v_add_f32 v74, v74, v75
  v_cvt_pk_bf16_f32 v16, v28, v29
  v_mfma_f32_16x16x32_bf16 v[84:87], v[120:123], v[32:35], 0
  v_cvt_pk_bf16_f32 v127, v72, v74
  v_cvt_pk_bf16_f32 v19, v28, v29
  v_mfma_f32_16x16x16_bf16 v[64:67], v[12:13], v[16:17], v[64:67]
  s_cbranch_scc1 L_team_last
  v_xor_b32 v3, 0x18000, v3
  v_mov_b64 v[44:45], 0
  v_mfma_f32_16x16x16_bf16 v[80:83], v[126:127], v[16:17], v[80:83]
  s_nop 0
  v_mov_b64 v[46:47], 0
  v_mov_b64 v[48:49], 0
  v_mfma_f32_16x16x16_bf16 v[84:87], v[126:127], v[18:19], v[84:87]
  v_rcp_f32 v65, v64
  v_subrev_u32 v66, s89, v64
  v_cmp_le_u32 vcc, s91, v66
  v_mov_b64 v[50:51], 0
L_smback_x:
  v_mul_f32 v80, v80, v65
  v_mul_f32 v81, v81, v65
  v_mul_f32 v82, v82, v65
  v_mul_f32 v83, v83, v65
  v_cvt_pk_bf16_f32 v88, v80, v81
  v_cvt_pk_bf16_f32 v89, v82, v83
  ds_write_b64 v7, v[88:89]
  v_mul_f32 v84, v84, v65
  v_mul_f32 v85, v85, v65
  v_mul_f32 v86, v86, v65
  v_mul_f32 v87, v87, v65
  v_cvt_pk_bf16_f32 v90, v84, v85
  v_cvt_pk_bf16_f32 v91, v86, v87
  s_cbranch_vccnz L_smslow_x
  ds_write_b64 v7, v[90:91] offset:8
  v_xor_b32 v96, 512, v7
  v_xor_b32 v100, 1024, v7
  v_xor_b32 v104, 1536, v7
  v_mov_b64 v[36:37], 0
  v_mov_b64 v[38:39], 0
  v_mov_b64 v[40:41], 0
  v_mov_b64 v[42:43], 0
  v_lshrrev_b32 v24, 16, v12
  v_cndmask_b32 v24, v24, 1.0, s[94:95]
  v_cndmask_b32 v20, 0, v24, s[80:81]
  v_cndmask_b32 v21, 0, v24, s[82:83]
  v_cndmask_b32 v22, 0, v24, s[84:85]
  v_cndmask_b32 v23, 0, v24, s[86:87]
  v_smfmac_f32_16x16x64_bf16 v[48:51], v[88:91], v[224:231], v1
  s_waitcnt lgkmcnt(0)
  s_barrier
  ds_read_b128 v[96:99], v96
  v_smfmac_f32_16x16x64_bf16 v[44:47], v[88:91], v[192:199], v1
  ds_read_b128 v[100:103], v100
  ds_read_b128 v[104:107], v104
  v_smfmac_f32_16x16x64_bf16 v[40:43], v[88:91], v[160:167], v1
  v_mov_b64 v[60:61], 0
  v_smfmac_f32_16x16x64_bf16 v[36:39], v[88:91], v[128:135], v1
  v_mov_b64 v[62:63], 0
  v_mov_b64 v[64:65], 0
  v_mov_b64 v[66:67], 0
  s_waitcnt lgkmcnt(2)
  v_smfmac_f32_16x16x64_bf16 v[36:39], v[96:99], v[136:143], v1
  s_waitcnt lgkmcnt(1)
  v_mov_b64 v[52:53], 0
  v_smfmac_f32_16x16x64_bf16 v[36:39], v[100:103], v[144:151], v1
  s_waitcnt lgkmcnt(0)
  v_mov_b64 v[54:55], 0
  v_smfmac_f32_16x16x64_bf16 v[36:39], v[104:107], v[152:159], v1
  s_nop 1
  v_mov_b64 v[56:57], 0
  v_smfmac_f32_16x16x64_bf16 v[40:43], v[96:99], v[168:175], v1
  s_nop 1
  v_mov_b64 v[58:59], 0
  v_smfmac_f32_16x16x64_bf16 v[40:43], v[100:103], v[176:183], v1
  v_cvt_pk_bf16_f32 v36, v36, v37
  v_cvt_pk_bf16_f32 v37, v38, v39
  v_and_or_b32 v36, v36, -2, s65
  v_smfmac_f32_16x16x64_bf16 v[40:43], v[104:107], v[184:191], v1
  s_nop 1
  buffer_store_dwordx2 v[36:37], v8, s[40:43], s74 offen sc1
  v_smfmac_f32_16x16x64_bf16 v[44:47], v[96:99], v[200:207], v1
  s_nop 2
  v_smfmac_f32_16x16x64_bf16 v[44:47], v[100:103], v[208:215], v1
  v_cvt_pk_bf16_f32 v40, v40, v41
  v_cvt_pk_bf16_f32 v41, v42, v43
  v_and_or_b32 v40, v40, -2, s65
  v_smfmac_f32_16x16x64_bf16 v[44:47], v[104:107], v[216:223], v1
  s_nop 1
  buffer_store_dwordx2 v[40:41], v8, s[40:43], s75 offen sc1
  v_smfmac_f32_16x16x64_bf16 v[48:51], v[96:99], v[232:239], v1
  s_nop 2
  v_smfmac_f32_16x16x64_bf16 v[48:51], v[100:103], v[240:247], v1
  v_cvt_pk_bf16_f32 v44, v44, v45
  v_cvt_pk_bf16_f32 v45, v46, v47
  v_and_or_b32 v44, v44, -2, s65
  v_smfmac_f32_16x16x64_bf16 v[48:51], v[104:107], v[248:255], v1
  s_nop 1
  buffer_store_dwordx2 v[44:45], v8, s[40:43], s76 offen sc1
  s_nop 4
  v_cvt_pk_bf16_f32 v48, v48, v49
  v_cvt_pk_bf16_f32 v49, v50, v51
  v_and_or_b32 v48, v48, -2, s65
  buffer_store_dwordx2 v[48:49], v8, s[40:43], s77 offen sc1
  s_barrier
  s_nop 15
  s_nop 9
  s_cmp_lt_u32 s44, 1
  s_cbranch_scc1 L_poll1_x
  s_nop 9
  s_cmp_lt_u32 s44, 2
  s_cbranch_scc1 L_poll1_x
  s_nop 9
  s_cmp_lt_u32 s44, 3
  s_cbranch_scc1 L_poll1_x
  s_nop 9
L_poll1_x:
  buffer_load_dwordx4 v[28:31], v9, s[40:43], s62 offen sc1
  buffer_load_dwordx4 v[32:35], v9, s[40:43], s62 offen offset:1024 sc1
  v_mov_b64 v[64:65], 0
  v_mov_b64 v[66:67], 0
  v_mov_b64 v[68:69], 0
  v_mov_b64 v[70:71], 0
  v_mov_b64 v[72:73], 0
  v_mov_b64 v[74:75], 0
  s_xor_b32 s63, s63, 0x2000
  v_xor_b32 v0, 0x2000, v0
  v_xor_b32 v7, 0x2000, v7
  s_nop 15
  s_nop 3
  buffer_load_dwordx4 v[36:39], v9, s[40:43], s62 offen sc1
  buffer_load_dwordx4 v[40:43], v9, s[40:43], s62 offen offset:1024 sc1
  ds_read_b128 v[76:79], v3 offset:0
  ds_read_b128 v[80:83], v3 offset:1024
  ds_read_b128 v[84:87], v3 offset:2048
  ds_read_b128 v[88:91], v3 offset:3072
  ds_read_b128 v[92:95], v3 offset:16384
  ds_read_b128 v[96:99], v3 offset:17408
  ds_read_b128 v[100:103], v3 offset:18432
  ds_read_b128 v[104:107], v3 offset:19456
  v_xor_b32 v3, 0x8000, v3
  ds_read_b128 v[108:111], v3 offset:0
  ds_read_b128 v[112:115], v3 offset:1024
L_poll1b_x:
  s_waitcnt vmcnt(3)
  v_mfma_f32_16x16x32_bf16 v[24:27], v[28:31], v[20:23], 0
  v_bitop3_b32 v44, v28, v30, s65 bitop3:0x7e
  s_waitcnt vmcnt(2)
  v_mfma_f32_16x16x32_bf16 v[24:27], v[32:35], v[20:23], v[24:27]
  v_bitop3_b32 v45, v32, v34, s65 bitop3:0x7e
  v_or_b32 v44, v44, v45
  v_and_b32 v44, 1, v44
  v_cmp_ne_u32 vcc, 0, v44
  s_nop 2
  s_cbranch_vccnz L_retry1_x
L_got1_x:
  v_add_f32 v24, v24, v25
  v_add_f32 v26, v26, v27
  s_nop 1
  v_permlane16_swap_b32 v24, v26
  v_add_f32 v24, v24, v26
  v_cvt_pk_bf16_f32 v24, v24, v17
  v_min_u32 v24, s90, v24
  v_cndmask_b32 v24, v24, -1, s[78:79]
  buffer_store_short v24, v10, s[40:43], s64 offen sc1
  s_nop 15
  s_nop 15
  s_nop 15
  s_nop 1
  s_branch L_poll2_x
L_retry2_x:
  s_waitcnt vmcnt(0)
  v_max3_u32 v44, v28, v29, v30
  v_max3_u32 v45, v31, v36, v37
  v_max3_u32 v44, v44, v38, v39
  v_max_u32 v44, v44, v45
  v_cmp_eq_u32 vcc, -1, v44
  v_mov_b64 v[20:21], v[28:29]
  v_mov_b64 v[22:23], v[30:31]
  v_mov_b64 v[24:25], v[36:37]
  v_mov_b64 v[26:27], v[38:39]
  v_mov_b64 v[52:53], 0
  v_mov_b64 v[54:55], 0
  v_mov_b64 v[56:57], 0
  v_mov_b64 v[58:59], 0
  s_cbranch_vccz L_entry_x
  buffer_load_dwordx4 v[20:23], v2, s[40:43], s63 offen sc1
  buffer_load_dwordx4 v[24:27], v2, s[40:43], s63 offen offset:1024 sc1
  s_add_u32 s67, s67, 1
  s_cmp_gt_u32 s67, 1048576
  s_cbranch_scc1 L_exit
  s_nop 15
  s_nop 3
  buffer_load_dwordx4 v[28:31], v2, s[40:43], s63 offen sc1
  buffer_load_dwordx4 v[36:39], v2, s[40:43], s63 offen offset:1024 sc1
  s_branch L_entry_x
L_retry1_x:
  buffer_load_dwordx4 v[28:31], v9, s[40:43], s62 offen sc1
  buffer_load_dwordx4 v[32:35], v9, s[40:43], s62 offen offset:1024 sc1
  s_waitcnt vmcnt(3)
  v_mfma_f32_16x16x32_bf16 v[24:27], v[36:39], v[20:23], 0
  v_bitop3_b32 v44, v36, v38, s65 bitop3:0x7e
  s_waitcnt vmcnt(2)
  v_mfma_f32_16x16x32_bf16 v[24:27], v[40:43], v[20:23], v[24:27]
  v_bitop3_b32 v45, v40, v42, s65 bitop3:0x7e
  v_or_b32 v44, v44, v45
  v_and_b32 v44, 1, v44
  v_cmp_ne_u32 vcc, 0, v44
  s_nop 2
  s_cbranch_vccnz L_retry1b_x
  v_add_f32 v24, v24, v25
  v_add_f32 v26, v26, v27
  s_nop 1
  v_permlane16_swap_b32 v24, v26
  v_add_f32 v24, v24, v26
  v_cvt_pk_bf16_f32 v24, v24, v17
  v_min_u32 v24, s90, v24
  v_cndmask_b32 v24, v24, -1, s[78:79]
  buffer_store_short v24, v10, s[40:43], s64 offen sc1
  s_nop 15
  s_nop 15
  s_nop 15
  s_nop 1
  s_branch L_poll2_x
L_retry1b_x:
  buffer_load_dwordx4 v[36:39], v9, s[40:43], s62 offen sc1
  buffer_load_dwordx4 v[40:43], v9, s[40:43], s62 offen offset:1024 sc1
  s_add_u32 s67, s67, 1
  s_cmp_gt_u32 s67, 1048576
  s_cbranch_scc1 L_exit
  s_branch L_poll1b_x
L_smslow_x:
  v_max3_f32 v30, v52, v53, v54
  v_max3_f32 v30, v30, v55, v56
  v_max3_f32 v30, v30, v57, v58
  v_max3_f32 v30, v30, v59, v60
  v_max_f32 v30, v30, v61
  v_mov_b32 v28, v30
  s_nop 1
  v_permlane32_swap_b32 v28, v30
  v_max_f32 v30, v30, v28
  v_mov_b32 v28, v30
  s_nop 1
  v_permlane16_swap_b32 v28, v30
  v_max_f32 v30, v30, v28
  v_sub_f32 v28, v52, v30
  v_sub_f32 v29, v53, v30
  v_exp_f32 v28, v28
  v_exp_f32 v29, v29
  s_nop 0
  v_cvt_pk_bf16_f32 v32, v28, v29
  v_sub_f32 v28, v54, v30
  v_sub_f32 v29, v55, v30
  v_exp_f32 v28, v28
  v_exp_f32 v29, v29
  s_nop 0
  v_cvt_pk_bf16_f32 v33, v28, v29
  v_sub_f32 v28, v56, v30
  v_sub_f32 v29, v57, v30
  v_exp_f32 v28, v28
  v_exp_f32 v29, v29
  s_nop 0
  v_cvt_pk_bf16_f32 v34, v28, v29
  v_sub_f32 v28, v58, v30
  v_sub_f32 v29, v59, v30
  v_exp_f32 v28, v28
  v_exp_f32 v29, v29
  s_nop 0
  v_cvt_pk_bf16_f32 v35, v28, v29
  v_sub_f32 v28, v60, v30
  v_sub_f32 v29, v61, v30
  v_exp_f32 v28, v28
  v_exp_f32 v29, v29
  s_nop 0
  v_cvt_pk_bf16_f32 v16, v28, v29
  v_cvt_pk_bf16_f32 v19, v28, v29
  s_nop 1
  v_mfma_f32_16x16x32_bf16 v[64:67], v[12:15], v[32:35], 0
  v_mfma_f32_16x16x32_bf16 v[80:83], v[116:119], v[32:35], 0
  v_mfma_f32_16x16x32_bf16 v[84:87], v[120:123], v[32:35], 0
  s_nop 3
  v_mfma_f32_16x16x16_bf16 v[64:67], v[12:13], v[16:17], v[64:67]
  v_mfma_f32_16x16x16_bf16 v[80:83], v[126:127], v[16:17], v[80:83]
  v_mfma_f32_16x16x16_bf16 v[84:87], v[126:127], v[18:19], v[84:87]
  s_nop 7
  v_rcp_f32 v65, v64
  s_mov_b64 vcc, 0
  s_branch L_smback_x
L_fs_x:
  buffer_load_dword v4, v17, s[40:43], s60 offen sc1
  s_add_u32 s67, s67, 1
  s_cmp_gt_u32 s67, 1048576
  s_cbranch_scc1 L_exit
  s_waitcnt vmcnt(0)
  v_cmp_gt_u32 vcc, s92, v4
  s_cbranch_vccnz L_fs_x
  s_branch L_fsback_x
L_team_last:
  s_add_u32 s61, s61, 0x20000
  v_min_u32 v124, -2, v124
  buffer_store_dwordx4 v[124:127], v2, s[40:43], s61 offen sc1
  s_waitcnt vmcnt(0)
  s_endpgm
L_exit:
  s_endpgm
.p2align 8
.type L_ptab,@object
L_ptab:
.long 0xd,0x10,0x1047005,0xe,0,0xc0,0x1e,0x180,0x240,4,4,4,4,4,4,4,4,4,4,4,4,4,4,4,4,4,4,4,4,4,4,4
.long 0x100d,0x32,0x846005,6,0x20,0x80,0xe0,0x140,0x1a0,0x200,0x260,0x2c0,0x320,0x380,0x3e0,4,4,4,4,4,4,4,4,4,4,4,4,4,4,4,4,4
.long 0x200d,0x54,0x1055005,0x1850005,0xe,0x10,0xd0,0x1e,0x190,0x250,4,4,4,4,4,4,4,4,4,4,4,4,4,4,4,4,4,4,4,4,4,4
.long 0x300d,0x76,0x854005,0x2051005,0xe,0x20,0xe0,0x1e,0x1a0,0x260,4,4,4,4,4,4,4,4,4,4,4,4,4,4,4,4,4,4,4,4,4,4
.long 0x400d,0x3276,0x2043005,6,0x40,0xa0,0x100,0x160,0x1c0,0x220,0x280,0x2e0,0x340,0x3a0,4,4,4,4,4,4,4,4,4,4,4,4,4,4,4,4,4,4
.long 0x500d,0x1054,0x1842005,6,0,0x60,0xc0,0x120,0x180,0x1e0,0x240,0x2a0,0x300,0x360,0x3c0,4,4,4,4,4,4,4,4,4,4,4,4,4,4,4,4,4
.long 0x600d,0x76543210,0x1e,0x300,0x340,0x380,0x3c0,4,4,4,4,4,4,4,4,4,4,4,4,4,4,4,4,4,4,4,4,4,4,4,4,4
.long 0x1d,0x10,0x1047015,0xe,0x1000,0x10c0,0x1e,0x1180,0x1240,4,4,4,4,4,4,4,4,4,4,4,4,4,4,4,4,4,4,4,4,4,4,4
.long 0x101d,0x32,0x846015,0x16,0x20,0x80,0xe0,0x140,0x1a0,0x200,0x260,0x2c0,0x320,0x380,0x3e0,4,4,4,4,4,4,4,4,4,4,4,4,4,4,4,4,4
.long 0x201d,0x54,0x1055015,0x1850015,0xe,0x1010,0x10d0,0x1e,0x1190,0x1250,4,4,4,4,4,4,4,4,4,4,4,4,4,4,4,4,4,4,4,4,4,4
.long 0x301d,0x76,0x854015,0x2051015,0xe,0x1020,0x10e0,0x1e,0x11a0,0x1260,4,4,4,4,4,4,4,4,4,4,4,4,4,4,4,4,4,4,4,4,4,4
.long 0x401d,0x3276,0x2043015,0x16,0x40,0xa0,0x100,0x160,0x1c0,0x220,0x280,0x2e0,0x340,0x3a0,4,4,4,4,4,4,4,4,4,4,4,4,4,4,4,4,4,4
.long 0x501d,0x1054,0x1842015,0x16,0,0x60,0xc0,0x120,0x180,0x1e0,0x240,0x2a0,0x300,0x360,0x3c0,4,4,4,4,4,4,4,4,4,4,4,4,4,4,4,4,4
.long 0x601d,0x76543210,0x1e,0x1300,0x1340,0x1380,0x13c0,4,4,4,4,4,4,4,4,4,4,4,4,4,4,4,4,4,4,4,4,4,4,4,4,4
.long 0x2d,0x10,0x1047025,0xe,0x2000,0x20c0,0x1e,0x2180,0x2240,4,4,4,4,4,4,4,4,4,4,4,4,4,4,4,4,4,4,4,4,4,4,4
.long 0x102d,0x32,0x846025,0x26,0x20,0x80,0xe0,0x140,0x1a0,0x200,0x260,0x2c0,0x320,0x380,0x3e0,4,4,4,4,4,4,4,4,4,4,4,4,4,4,4,4,4
.long 0x202d,0x54,0x1055025,0x1850025,0xe,0x2010,0x20d0,0x1e,0x2190,0x2250,4,4,4,4,4,4,4,4,4,4,4,4,4,4,4,4,4,4,4,4,4,4
.long 0x302d,0x76,0x854025,0x2051025,0xe,0x2020,0x20e0,0x1e,0x21a0,0x2260,4,4,4,4,4,4,4,4,4,4,4,4,4,4,4,4,4,4,4,4,4,4
.long 0x402d,0x3276,0x2043025,0x26,0x40,0xa0,0x100,0x160,0x1c0,0x220,0x280,0x2e0,0x340,0x3a0,4,4,4,4,4,4,4,4,4,4,4,4,4,4,4,4,4,4
.long 0x502d,0x1054,0x1842025,0x26,0,0x60,0xc0,0x120,0x180,0x1e0,0x240,0x2a0,0x300,0x360,0x3c0,4,4,4,4,4,4,4,4,4,4,4,4,4,4,4,4,4
.long 0x602d,0x76543210,0x1e,0x2300,0x2340,0x2380,0x23c0,4,4,4,4,4,4,4,4,4,4,4,4,4,4,4,4,4,4,4,4,4,4,4,4,4
.long 0x3d,0x10,0x1047035,0xe,0x3000,0x30c0,0x1e,0x3180,0x3240,4,4,4,4,4,4,4,4,4,4,4,4,4,4,4,4,4,4,4,4,4,4,4
.long 0x103d,0x32,0x846035,0x36,0x20,0x80,0xe0,0x140,0x1a0,0x200,0x260,0x2c0,0x320,0x380,0x3e0,4,4,4,4,4,4,4,4,4,4,4,4,4,4,4,4,4
.long 0x203d,0x54,0x1055035,0x1850035,0xe,0x3010,0x30d0,0x1e,0x3190,0x3250,4,4,4,4,4,4,4,4,4,4,4,4,4,4,4,4,4,4,4,4,4,4
.long 0x303d,0x76,0x854035,0x2051035,0xe,0x3020,0x30e0,0x1e,0x31a0,0x3260,4,4,4,4,4,4,4,4,4,4,4,4,4,4,4,4,4,4,4,4,4,4
.long 0x403d,0x3276,0x2043035,0x36,0x40,0xa0,0x100,0x160,0x1c0,0x220,0x280,0x2e0,0x340,0x3a0,4,4,4,4,4,4,4,4,4,4,4,4,4,4,4,4,4,4
.long 0x503d,0x1054,0x1842035,0x36,0,0x60,0xc0,0x120,0x180,0x1e0,0x240,0x2a0,0x300,0x360,0x3c0,4,4,4,4,4,4,4,4,4,4,4,4,4,4,4,4,4
.long 0x603d,0x76543210,0x1e,0x3300,0x3340,0x3380,0x33c0,4,4,4,4,4,4,4,4,4,4,4,4,4,4,4,4,4,4,4,4,4,4,4,4,4
.long 0x4d,0x10,0x1047045,0xe,0x4000,0x40c0,0x1e,0x4180,0x4240,4,4,4,4,4,4,4,4,4,4,4,4,4,4,4,4,4,4,4,4,4,4,4
.long 0x104d,0x32,0x846045,0x46,0x20,0x80,0xe0,0x140,0x1a0,0x200,0x260,0x2c0,0x320,0x380,0x3e0,4,4,4,4,4,4,4,4,4,4,4,4,4,4,4,4,4
.long 0x204d,0x54,0x1055045,0x1850045,0xe,0x4010,0x40d0,0x1e,0x4190,0x4250,4,4,4,4,4,4,4,4,4,4,4,4,4,4,4,4,4,4,4,4,4,4
.long 0x304d,0x76,0x854045,0x2051045,0xe,0x4020,0x40e0,0x1e,0x41a0,0x4260,4,4,4,4,4,4,4,4,4,4,4,4,4,4,4,4,4,4,4,4,4,4
.long 0x404d,0x3276,0x2043045,0x46,0x40,0xa0,0x100,0x160,0x1c0,0x220,0x280,0x2e0,0x340,0x3a0,4,4,4,4,4,4,4,4,4,4,4,4,4,4,4,4,4,4
.long 0x504d,0x1054,0x1842045,0x46,0,0x60,0xc0,0x120,0x180,0x1e0,0x240,0x2a0,0x300,0x360,0x3c0,4,4,4,4,4,4,4,4,4,4,4,4,4,4,4,4,4
.long 0x604d,0x76543210,0x1e,0x4300,0x4340,0x4380,0x43c0,4,4,4,4,4,4,4,4,4,4,4,4,4,4,4,4,4,4,4,4,4,4,4,4,4
.long 0x5d,0x10,0x1047055,0xe,0x5000,0x50c0,0x1e,0x5180,0x5240,4,4,4,4,4,4,4,4,4,4,4,4,4,4,4,4,4,4,4,4,4,4,4
.long 0x105d,0x32,0x846055,0x56,0x20,0x80,0xe0,0x140,0x1a0,0x200,0x260,0x2c0,0x320,0x380,0x3e0,4,4,4,4,4,4,4,4,4,4,4,4,4,4,4,4,4
.long 0x205d,0x54,0x1055055,0x1850055,0xe,0x5010,0x50d0,0x1e,0x5190,0x5250,4,4,4,4,4,4,4,4,4,4,4,4,4,4,4,4,4,4,4,4,4,4
.long 0x305d,0x76,0x854055,0x2051055,0xe,0x5020,0x50e0,0x1e,0x51a0,0x5260,4,4,4,4,4,4,4,4,4,4,4,4,4,4,4,4,4,4,4,4,4,4
.long 0x405d,0x3276,0x2043055,0x56,0x40,0xa0,0x100,0x160,0x1c0,0x220,0x280,0x2e0,0x340,0x3a0,4,4,4,4,4,4,4,4,4,4,4,4,4,4,4,4,4,4
.long 0x505d,0x1054,0x1842055,0x56,0,0x60,0xc0,0x120,0x180,0x1e0,0x240,0x2a0,0x300,0x360,0x3c0,4,4,4,4,4,4,4,4,4,4,4,4,4,4,4,4,4
.long 0x605d,0x76543210,0x1e,0x5300,0x5340,0x5380,0x53c0,4,4,4,4,4,4,4,4,4,4,4,4,4,4,4,4,4,4,4,4,4,4,4,4,4
.long 0x6d,0x10,0x1047065,0xe,0x6000,0x60c0,0x1e,0x6180,0x6240,4,4,4,4,4,4,4,4,4,4,4,4,4,4,4,4,4,4,4,4,4,4,4
.long 0x106d,0x32,0x846065,0x66,0x20,0x80,0xe0,0x140,0x1a0,0x200,0x260,0x2c0,0x320,0x380,0x3e0,4,4,4,4,4,4,4,4,4,4,4,4,4,4,4,4,4
.long 0x206d,0x54,0x1055065,0x1850065,0xe,0x6010,0x60d0,0x1e,0x6190,0x6250,4,4,4,4,4,4,4,4,4,4,4,4,4,4,4,4,4,4,4,4,4,4
.long 0x306d,0x76,0x854065,0x2051065,0xe,0x6020,0x60e0,0x1e,0x61a0,0x6260,4,4,4,4,4,4,4,4,4,4,4,4,4,4,4,4,4,4,4,4,4,4
.long 0x406d,0x3276,0x2043065,0x66,0x40,0xa0,0x100,0x160,0x1c0,0x220,0x280,0x2e0,0x340,0x3a0,4,4,4,4,4,4,4,4,4,4,4,4,4,4,4,4,4,4
.long 0x506d,0x1054,0x1842065,0x66,0,0x60,0xc0,0x120,0x180,0x1e0,0x240,0x2a0,0x300,0x360,0x3c0,4,4,4,4,4,4,4,4,4,4,4,4,4,4,4,4,4
.long 0x606d,0x76543210,0x1e,0x6300,0x6340,0x6380,0x63c0,4,4,4,4,4,4,4,4,4,4,4,4,4,4,4,4,4,4,4,4,4,4,4,4,4
.long 0x7d,0x10,0x1047075,0xe,0x7000,0x70c0,0x1e,0x7180,0x7240,4,4,4,4,4,4,4,4,4,4,4,4,4,4,4,4,4,4,4,4,4,4,4
.long 0x107d,0x32,0x846075,0x76,0x20,0x80,0xe0,0x140,0x1a0,0x200,0x260,0x2c0,0x320,0x380,0x3e0,4,4,4,4,4,4,4,4,4,4,4,4,4,4,4,4,4
.long 0x207d,0x54,0x1055075,0x1850075,0xe,0x7010,0x70d0,0x1e,0x7190,0x7250,4,4,4,4,4,4,4,4,4,4,4,4,4,4,4,4,4,4,4,4,4,4
.long 0x307d,0x76,0x854075,0x2051075,0xe,0x7020,0x70e0,0x1e,0x71a0,0x7260,4,4,4,4,4,4,4,4,4,4,4,4,4,4,4,4,4,4,4,4,4,4
.long 0x407d,0x3276,0x2043075,0x76,0x40,0xa0,0x100,0x160,0x1c0,0x220,0x280,0x2e0,0x340,0x3a0,4,4,4,4,4,4,4,4,4,4,4,4,4,4,4,4,4,4
.long 0x507d,0x1054,0x1842075,0x76,0,0x60,0xc0,0x120,0x180,0x1e0,0x240,0x2a0,0x300,0x360,0x3c0,4,4,4,4,4,4,4,4,4,4,4,4,4,4,4,4,4
.long 0x607d,0x76543210,0x1e,0x7300,0x7340,0x7380,0x73c0,4,4,4,4,4,4,4,4,4,4,4,4,4,4,4,4,4,4,4,4,4,4,4,4,4
.long 0x8d,0x10,0x1047085,0xe,0x30,0xf0,0x1e,0x1b0,0x270,4,4,4,4,4,4,4,4,4,4,4,4,4,4,4,4,4,4,4,4,4,4,4
.long 0x108d,0x32,0x846085,0x86,0x20,0x80,0xe0,0x140,0x1a0,0x200,0x260,0x2c0,0x320,0x380,0x3e0,4,4,4,4,4,4,4,4,4,4,4,4,4,4,4,4,4
.long 0x208d,0x54,0x1055085,0x1850085,0xe,0x40,0x100,0x1e,0x1c0,0x280,4,4,4,4,4,4,4,4,4,4,4,4,4,4,4,4,4,4,4,4,4,4
.long 0x308d,0x76,0x854085,0x2051085,0xe,0x50,0x110,0x1e,0x1d0,0x290,4,4,4,4,4,4,4,4,4,4,4,4,4,4,4,4,4,4,4,4,4,4
.long 0x408d,0x3276,0x2043085,0x86,0x40,0xa0,0x100,0x160,0x1c0,0x220,0x280,0x2e0,0x340,0x3a0,4,4,4,4,4,4,4,4,4,4,4,4,4,4,4,4,4,4
.long 0x508d,0x1054,0x1842085,0x86,0,0x60,0xc0,0x120,0x180,0x1e0,0x240,0x2a0,0x300,0x360,0x3c0,4,4,4,4,4,4,4,4,4,4,4,4,4,4,4,4,4
.long 0x608d,0x76543210,0x1e,0x310,0x350,0x390,0x3d0,4,4,4,4,4,4,4,4,4,4,4,4,4,4,4,4,4,4,4,4,4,4,4,4,4
.long 0x9d,0x10,0x1047095,0xe,0x1030,0x10f0,0x1e,0x11b0,0x1270,4,4,4,4,4,4,4,4,4,4,4,4,4,4,4,4,4,4,4,4,4,4,4
.long 0x109d,0x32,0x846095,0x96,0x20,0x80,0xe0,0x140,0x1a0,0x200,0x260,0x2c0,0x320,0x380,0x3e0,4,4,4,4,4,4,4,4,4,4,4,4,4,4,4,4,4
.long 0x209d,0x54,0x1055095,0x1850095,0xe,0x1040,0x1100,0x1e,0x11c0,0x1280,4,4,4,4,4,4,4,4,4,4,4,4,4,4,4,4,4,4,4,4,4,4
.long 0x309d,0x76,0x854095,0x2051095,0xe,0x1050,0x1110,0x1e,0x11d0,0x1290,4,4,4,4,4,4,4,4,4,4,4,4,4,4,4,4,4,4,4,4,4,4
.long 0x409d,0x3276,0x2043095,0x96,0x40,0xa0,0x100,0x160,0x1c0,0x220,0x280,0x2e0,0x340,0x3a0,4,4,4,4,4,4,4,4,4,4,4,4,4,4,4,4,4,4
.long 0x509d,0x1054,0x1842095,0x96,0,0x60,0xc0,0x120,0x180,0x1e0,0x240,0x2a0,0x300,0x360,0x3c0,4,4,4,4,4,4,4,4,4,4,4,4,4,4,4,4,4
.long 0x609d,0x76543210,0x1e,0x1310,0x1350,0x1390,0x13d0,4,4,4,4,4,4,4,4,4,4,4,4,4,4,4,4,4,4,4,4,4,4,4,4,4
.long 0xad,0x10,0x10470a5,0xe,0x2030,0x20f0,0x1e,0x21b0,0x2270,4,4,4,4,4,4,4,4,4,4,4,4,4,4,4,4,4,4,4,4,4,4,4
.long 0x10ad,0x32,0x8460a5,0xa6,0x20,0x80,0xe0,0x140,0x1a0,0x200,0x260,0x2c0,0x320,0x380,0x3e0,4,4,4,4,4,4,4,4,4,4,4,4,4,4,4,4,4
.long 0x20ad,0x54,0x10550a5,0x18500a5,0xe,0x2040,0x2100,0x1e,0x21c0,0x2280,4,4,4,4,4,4,4,4,4,4,4,4,4,4,4,4,4,4,4,4,4,4
.long 0x30ad,0x76,0x8540a5,0x20510a5,0xe,0x2050,0x2110,0x1e,0x21d0,0x2290,4,4,4,4,4,4,4,4,4,4,4,4,4,4,4,4,4,4,4,4,4,4
.long 0x40ad,0x3276,0x20430a5,0xa6,0x40,0xa0,0x100,0x160,0x1c0,0x220,0x280,0x2e0,0x340,0x3a0,4,4,4,4,4,4,4,4,4,4,4,4,4,4,4,4,4,4
.long 0x50ad,0x1054,0x18420a5,0xa6,0,0x60,0xc0,0x120,0x180,0x1e0,0x240,0x2a0,0x300,0x360,0x3c0,4,4,4,4,4,4,4,4,4,4,4,4,4,4,4,4,4
.long 0x60ad,0x76543210,0x1e,0x2310,0x2350,0x2390,0x23d0,4,4,4,4,4,4,4,4,4,4,4,4,4,4,4,4,4,4,4,4,4,4,4,4,4
.long 0xbd,0x10,0x10470b5,0xe,0x3030,0x30f0,0x1e,0x31b0,0x3270,4,4,4,4,4,4,4,4,4,4,4,4,4,4,4,4,4,4,4,4,4,4,4
.long 0x10bd,0x32,0x8460b5,0xb6,0x20,0x80,0xe0,0x140,0x1a0,0x200,0x260,0x2c0,0x320,0x380,0x3e0,4,4,4,4,4,4,4,4,4,4,4,4,4,4,4,4,4
.long 0x20bd,0x54,0x10550b5,0x18500b5,0xe,0x3040,0x3100,0x1e,0x31c0,0x3280,4,4,4,4,4,4,4,4,4,4,4,4,4,4,4,4,4,4,4,4,4,4
.long 0x30bd,0x76,0x8540b5,0x20510b5,0xe,0x3050,0x3110,0x1e,0x31d0,0x3290,4,4,4,4,4,4,4,4,4,4,4,4,4,4,4,4,4,4,4,4,4,4
.long 0x40bd,0x3276,0x20430b5,0xb6,0x40,0xa0,0x100,0x160,0x1c0,0x220,0x280,0x2e0,0x340,0x3a0,4,4,4,4,4,4,4,4,4,4,4,4,4,4,4,4,4,4
.long 0x50bd,0x1054,0x18420b5,0xb6,0,0x60,0xc0,0x120,0x180,0x1e0,0x240,0x2a0,0x300,0x360,0x3c0,4,4,4,4,4,4,4,4,4,4,4,4,4,4,4,4,4
.long 0x60bd,0x76543210,0x1e,0x3310,0x3350,0x3390,0x33d0,4,4,4,4,4,4,4,4,4,4,4,4,4,4,4,4,4,4,4,4,4,4,4,4,4
.long 0xcd,0x10,0x10470c5,0xe,0x4030,0x40f0,0x1e,0x41b0,0x4270,4,4,4,4,4,4,4,4,4,4,4,4,4,4,4,4,4,4,4,4,4,4,4
.long 0x10cd,0x32,0x8460c5,0xc6,0x20,0x80,0xe0,0x140,0x1a0,0x200,0x260,0x2c0,0x320,0x380,0x3e0,4,4,4,4,4,4,4,4,4,4,4,4,4,4,4,4,4
.long 0x20cd,0x54,0x10550c5,0x18500c5,0xe,0x4040,0x4100,0x1e,0x41c0,0x4280,4,4,4,4,4,4,4,4,4,4,4,4,4,4,4,4,4,4,4,4,4,4
.long 0x30cd,0x76,0x8540c5,0x20510c5,0xe,0x4050,0x4110,0x1e,0x41d0,0x4290,4,4,4,4,4,4,4,4,4,4,4,4,4,4,4,4,4,4,4,4,4,4
.long 0x40cd,0x3276,0x20430c5,0xc6,0x40,0xa0,0x100,0x160,0x1c0,0x220,0x280,0x2e0,0x340,0x3a0,4,4,4,4,4,4,4,4,4,4,4,4,4,4,4,4,4,4
.long 0x50cd,0x1054,0x18420c5,0xc6,0,0x60,0xc0,0x120,0x180,0x1e0,0x240,0x2a0,0x300,0x360,0x3c0,4,4,4,4,4,4,4,4,4,4,4,4,4,4,4,4,4
.long 0x60cd,0x76543210,0x1e,0x4310,0x4350,0x4390,0x43d0,4,4,4,4,4,4,4,4,4,4,4,4,4,4,4,4,4,4,4,4,4,4,4,4,4
.long 0xdd,0x10,0x10470d5,0xe,0x5030,0x50f0,0x1e,0x51b0,0x5270,4,4,4,4,4,4,4,4,4,4,4,4,4,4,4,4,4,4,4,4,4,4,4
.long 0x10dd,0x32,0x8460d5,0xd6,0x20,0x80,0xe0,0x140,0x1a0,0x200,0x260,0x2c0,0x320,0x380,0x3e0,4,4,4,4,4,4,4,4,4,4,4,4,4,4,4,4,4
.long 0x20dd,0x54,0x10550d5,0x18500d5,0xe,0x5040,0x5100,0x1e,0x51c0,0x5280,4,4,4,4,4,4,4,4,4,4,4,4,4,4,4,4,4,4,4,4,4,4
.long 0x30dd,0x76,0x8540d5,0x20510d5,0xe,0x5050,0x5110,0x1e,0x51d0,0x5290,4,4,4,4,4,4,4,4,4,4,4,4,4,4,4,4,4,4,4,4,4,4
.long 0x40dd,0x3276,0x20430d5,0xd6,0x40,0xa0,0x100,0x160,0x1c0,0x220,0x280,0x2e0,0x340,0x3a0,4,4,4,4,4,4,4,4,4,4,4,4,4,4,4,4,4,4
.long 0x50dd,0x1054,0x18420d5,0xd6,0,0x60,0xc0,0x120,0x180,0x1e0,0x240,0x2a0,0x300,0x360,0x3c0,4,4,4,4,4,4,4,4,4,4,4,4,4,4,4,4,4
.long 0x60dd,0x76543210,0x1e,0x5310,0x5350,0x5390,0x53d0,4,4,4,4,4,4,4,4,4,4,4,4,4,4,4,4,4,4,4,4,4,4,4,4,4
.long 0xed,0x10,0x10470e5,0xe,0x6030,0x60f0,0x1e,0x61b0,0x6270,4,4,4,4,4,4,4,4,4,4,4,4,4,4,4,4,4,4,4,4,4,4,4
.long 0x10ed,0x32,0x8460e5,0xe6,0x20,0x80,0xe0,0x140,0x1a0,0x200,0x260,0x2c0,0x320,0x380,0x3e0,4,4,4,4,4,4,4,4,4,4,4,4,4,4,4,4,4
.long 0x20ed,0x54,0x10550e5,0x18500e5,0xe,0x6040,0x6100,0x1e,0x61c0,0x6280,4,4,4,4,4,4,4,4,4,4,4,4,4,4,4,4,4,4,4,4,4,4
.long 0x30ed,0x76,0x8540e5,0x20510e5,0xe,0x6050,0x6110,0x1e,0x61d0,0x6290,4,4,4,4,4,4,4,4,4,4,4,4,4,4,4,4,4,4,4,4,4,4
.long 0x40ed,0x3276,0x20430e5,0xe6,0x40,0xa0,0x100,0x160,0x1c0,0x220,0x280,0x2e0,0x340,0x3a0,4,4,4,4,4,4,4,4,4,4,4,4,4,4,4,4,4,4
.long 0x50ed,0x1054,0x18420e5,0xe6,0,0x60,0xc0,0x120,0x180,0x1e0,0x240,0x2a0,0x300,0x360,0x3c0,4,4,4,4,4,4,4,4,4,4,4,4,4,4,4,4,4
.long 0x60ed,0x76543210,0x1e,0x6310,0x6350,0x6390,0x63d0,4,4,4,4,4,4,4,4,4,4,4,4,4,4,4,4,4,4,4,4,4,4,4,4,4
.long 0xfd,0x10,0x10470f5,0xe,0x7030,0x70f0,0x1e,0x71b0,0x7270,4,4,4,4,4,4,4,4,4,4,4,4,4,4,4,4,4,4,4,4,4,4,4
.long 0x10fd,0x32,0x8460f5,0xf6,0x20,0x80,0xe0,0x140,0x1a0,0x200,0x260,0x2c0,0x320,0x380,0x3e0,4,4,4,4,4,4,4,4,4,4,4,4,4,4,4,4,4
.long 0x20fd,0x54,0x10550f5,0x18500f5,0xe,0x7040,0x7100,0x1e,0x71c0,0x7280,4,4,4,4,4,4,4,4,4,4,4,4,4,4,4,4,4,4,4,4,4,4
.long 0x30fd,0x76,0x8540f5,0x20510f5,0xe,0x7050,0x7110,0x1e,0x71d0,0x7290,4,4,4,4,4,4,4,4,4,4,4,4,4,4,4,4,4,4,4,4,4,4
.long 0x40fd,0x3276,0x20430f5,0xf6,0x40,0xa0,0x100,0x160,0x1c0,0x220,0x280,0x2e0,0x340,0x3a0,4,4,4,4,4,4,4,4,4,4,4,4,4,4,4,4,4,4
.long 0x50fd,0x1054,0x18420f5,0xf6,0,0x60,0xc0,0x120,0x180,0x1e0,0x240,0x2a0,0x300,0x360,0x3c0,4,4,4,4,4,4,4,4,4,4,4,4,4,4,4,4,4
.long 0x60fd,0x76543210,0x1e,0x7310,0x7350,0x7390,0x73d0,4,4,4,4,4,4,4,4,4,4,4,4,4,4,4,4,4,4,4,4,4,4,4,4,4
.long 0x10d,0x10,0x1047105,0xe,0x60,0x120,0x1e,0x1e0,0x2a0,4,4,4,4,4,4,4,4,4,4,4,4,4,4,4,4,4,4,4,4,4,4,4
.long 0x110d,0x32,0x846105,6,0x30,0x90,0xf0,0x150,0x1b0,0x210,0x270,0x2d0,0x330,0x390,0x3f0,4,4,4,4,4,4,4,4,4,4,4,4,4,4,4,4,4
.long 0x210d,0x54,0x1055105,0x1850105,0xe,0x70,0x130,0x1e,0x1f0,0x2b0,4,4,4,4,4,4,4,4,4,4,4,4,4,4,4,4,4,4,4,4,4,4
.long 0x310d,0x76,0x854105,0x2051105,0xe,0x80,0x140,0x1e,0x200,0x2c0,4,4,4,4,4,4,4,4,4,4,4,4,4,4,4,4,4,4,4,4,4,4
.long 0x410d,0x3276,0x2043105,6,0x50,0xb0,0x110,0x170,0x1d0,0x230,0x290,0x2f0,0x350,0x3b0,4,4,4,4,4,4,4,4,4,4,4,4,4,4,4,4,4,4
.long 0x510d,0x1054,0x1842105,6,0x10,0x70,0xd0,0x130,0x190,0x1f0,0x250,0x2b0,0x310,0x370,0x3d0,4,4,4,4,4,4,4,4,4,4,4,4,4,4,4,4,4
.long 0x610d,0x76543210,0x1e,0x320,0x360,0x3a0,0x3e0,4,4,4,4,4,4,4,4,4,4,4,4,4,4,4,4,4,4,4,4,4,4,4,4,4
.long 0x11d,0x10,0x1047115,0xe,0x1060,0x1120,0x1e,0x11e0,0x12a0,4,4,4,4,4,4,4,4,4,4,4,4,4,4,4,4,4,4,4,4,4,4,4
.long 0x111d,0x32,0x846115,0x16,0x30,0x90,0xf0,0x150,0x1b0,0x210,0x270,0x2d0,0x330,0x390,0x3f0,4,4,4,4,4,4,4,4,4,4,4,4,4,4,4,4,4
.long 0x211d,0x54,0x1055115,0x1850115,0xe,0x1070,0x1130,0x1e,0x11f0,0x12b0,4,4,4,4,4,4,4,4,4,4,4,4,4,4,4,4,4,4,4,4,4,4
.long 0x311d,0x76,0x854115,0x2051115,0xe,0x1080,0x1140,0x1e,0x1200,0x12c0,4,4,4,4,4,4,4,4,4,4,4,4,4,4,4,4,4,4,4,4,4,4
.long 0x411d,0x3276,0x2043115,0x16,0x50,0xb0,0x110,0x170,0x1d0,0x230,0x290,0x2f0,0x350,0x3b0,4,4,4,4,4,4,4,4,4,4,4,4,4,4,4,4,4,4
.long 0x511d,0x1054,0x1842115,0x16,0x10,0x70,0xd0,0x130,0x190,0x1f0,0x250,0x2b0,0x310,0x370,0x3d0,4,4,4,4,4,4,4,4,4,4,4,4,4,4,4,4,4
.long 0x611d,0x76543210,0x1e,0x1320,0x1360,0x13a0,0x13e0,4,4,4,4,4,4,4,4,4,4,4,4,4,4,4,4,4,4,4,4,4,4,4,4,4
.long 0x12d,0x10,0x1047125,0xe,0x2060,0x2120,0x1e,0x21e0,0x22a0,4,4,4,4,4,4,4,4,4,4,4,4,4,4,4,4,4,4,4,4,4,4,4
.long 0x112d,0x32,0x846125,0x26,0x30,0x90,0xf0,0x150,0x1b0,0x210,0x270,0x2d0,0x330,0x390,0x3f0,4,4,4,4,4,4,4,4,4,4,4,4,4,4,4,4,4
.long 0x212d,0x54,0x1055125,0x1850125,0xe,0x2070,0x2130,0x1e,0x21f0,0x22b0,4,4,4,4,4,4,4,4,4,4,4,4,4,4,4,4,4,4,4,4,4,4
.long 0x312d,0x76,0x854125,0x2051125,0xe,0x2080,0x2140,0x1e,0x2200,0x22c0,4,4,4,4,4,4,4,4,4,4,4,4,4,4,4,4,4,4,4,4,4,4
.long 0x412d,0x3276,0x2043125,0x26,0x50,0xb0,0x110,0x170,0x1d0,0x230,0x290,0x2f0,0x350,0x3b0,4,4,4,4,4,4,4,4,4,4,4,4,4,4,4,4,4,4
.long 0x512d,0x1054,0x1842125,0x26,0x10,0x70,0xd0,0x130,0x190,0x1f0,0x250,0x2b0,0x310,0x370,0x3d0,4,4,4,4,4,4,4,4,4,4,4,4,4,4,4,4,4
.long 0x612d,0x76543210,0x1e,0x2320,0x2360,0x23a0,0x23e0,4,4,4,4,4,4,4,4,4,4,4,4,4,4,4,4,4,4,4,4,4,4,4,4,4
.long 0x13d,0x10,0x1047135,0xe,0x3060,0x3120,0x1e,0x31e0,0x32a0,4,4,4,4,4,4,4,4,4,4,4,4,4,4,4,4,4,4,4,4,4,4,4
.long 0x113d,0x32,0x846135,0x36,0x30,0x90,0xf0,0x150,0x1b0,0x210,0x270,0x2d0,0x330,0x390,0x3f0,4,4,4,4,4,4,4,4,4,4,4,4,4,4,4,4,4
.long 0x213d,0x54,0x1055135,0x1850135,0xe,0x3070,0x3130,0x1e,0x31f0,0x32b0,4,4,4,4,4,4,4,4,4,4,4,4,4,4,4,4,4,4,4,4,4,4
.long 0x313d,0x76,0x854135,0x2051135,0xe,0x3080,0x3140,0x1e,0x3200,0x32c0,4,4,4,4,4,4,4,4,4,4,4,4,4,4,4,4,4,4,4,4,4,4
.long 0x413d,0x3276,0x2043135,0x36,0x50,0xb0,0x110,0x170,0x1d0,0x230,0x290,0x2f0,0x350,0x3b0,4,4,4,4,4,4,4,4,4,4,4,4,4,4,4,4,4,4
.long 0x513d,0x1054,0x1842135,0x36,0x10,0x70,0xd0,0x130,0x190,0x1f0,0x250,0x2b0,0x310,0x370,0x3d0,4,4,4,4,4,4,4,4,4,4,4,4,4,4,4,4,4
.long 0x613d,0x76543210,0x1e,0x3320,0x3360,0x33a0,0x33e0,4,4,4,4,4,4,4,4,4,4,4,4,4,4,4,4,4,4,4,4,4,4,4,4,4
.long 0x14d,0x10,0x1047145,0xe,0x4060,0x4120,0x1e,0x41e0,0x42a0,4,4,4,4,4,4,4,4,4,4,4,4,4,4,4,4,4,4,4,4,4,4,4
.long 0x114d,0x32,0x846145,0x46,0x30,0x90,0xf0,0x150,0x1b0,0x210,0x270,0x2d0,0x330,0x390,0x3f0,4,4,4,4,4,4,4,4,4,4,4,4,4,4,4,4,4
.long 0x214d,0x54,0x1055145,0x1850145,0xe,0x4070,0x4130,0x1e,0x41f0,0x42b0,4,4,4,4,4,4,4,4,4,4,4,4,4,4,4,4,4,4,4,4,4,4
.long 0x314d,0x76,0x854145,0x2051145,0xe,0x4080,0x4140,0x1e,0x4200,0x42c0,4,4,4,4,4,4,4,4,4,4,4,4,4,4,4,4,4,4,4,4,4,4
.long 0x414d,0x3276,0x2043145,0x46,0x50,0xb0,0x110,0x170,0x1d0,0x230,0x290,0x2f0,0x350,0x3b0,4,4,4,4,4,4,4,4,4,4,4,4,4,4,4,4,4,4
.long 0x514d,0x1054,0x1842145,0x46,0x10,0x70,0xd0,0x130,0x190,0x1f0,0x250,0x2b0,0x310,0x370,0x3d0,4,4,4,4,4,4,4,4,4,4,4,4,4,4,4,4,4
.long 0x614d,0x76543210,0x1e,0x4320,0x4360,0x43a0,0x43e0,4,4,4,4,4,4,4,4,4,4,4,4,4,4,4,4,4,4,4,4,4,4,4,4,4
.long 0x15d,0x10,0x1047155,0xe,0x5060,0x5120,0x1e,0x51e0,0x52a0,4,4,4,4,4,4,4,4,4,4,4,4,4,4,4,4,4,4,4,4,4,4,4
.long 0x115d,0x32,0x846155,0x56,0x30,0x90,0xf0,0x150,0x1b0,0x210,0x270,0x2d0,0x330,0x390,0x3f0,4,4,4,4,4,4,4,4,4,4,4,4,4,4,4,4,4
.long 0x215d,0x54,0x1055155,0x1850155,0xe,0x5070,0x5130,0x1e,0x51f0,0x52b0,4,4,4,4,4,4,4,4,4,4,4,4,4,4,4,4,4,4,4,4,4,4
.long 0x315d,0x76,0x854155,0x2051155,0xe,0x5080,0x5140,0x1e,0x5200,0x52c0,4,4,4,4,4,4,4,4,4,4,4,4,4,4,4,4,4,4,4,4,4,4
.long 0x415d,0x3276,0x2043155,0x56,0x50,0xb0,0x110,0x170,0x1d0,0x230,0x290,0x2f0,0x350,0x3b0,4,4,4,4,4,4,4,4,4,4,4,4,4,4,4,4,4,4
.long 0x515d,0x1054,0x1842155,0x56,0x10,0x70,0xd0,0x130,0x190,0x1f0,0x250,0x2b0,0x310,0x370,0x3d0,4,4,4,4,4,4,4,4,4,4,4,4,4,4,4,4,4
.long 0x615d,0x76543210,0x1e,0x5320,0x5360,0x53a0,0x53e0,4,4,4,4,4,4,4,4,4,4,4,4,4,4,4,4,4,4,4,4,4,4,4,4,4
.long 0x16d,0x10,0x1047165,0xe,0x6060,0x6120,0x1e,0x61e0,0x62a0,4,4,4,4,4,4,4,4,4,4,4,4,4,4,4,4,4,4,4,4,4,4,4
.long 0x116d,0x32,0x846165,0x66,0x30,0x90,0xf0,0x150,0x1b0,0x210,0x270,0x2d0,0x330,0x390,0x3f0,4,4,4,4,4,4,4,4,4,4,4,4,4,4,4,4,4
.long 0x216d,0x54,0x1055165,0x1850165,0xe,0x6070,0x6130,0x1e,0x61f0,0x62b0,4,4,4,4,4,4,4,4,4,4,4,4,4,4,4,4,4,4,4,4,4,4
.long 0x316d,0x76,0x854165,0x2051165,0xe,0x6080,0x6140,0x1e,0x6200,0x62c0,4,4,4,4,4,4,4,4,4,4,4,4,4,4,4,4,4,4,4,4,4,4
.long 0x416d,0x3276,0x2043165,0x66,0x50,0xb0,0x110,0x170,0x1d0,0x230,0x290,0x2f0,0x350,0x3b0,4,4,4,4,4,4,4,4,4,4,4,4,4,4,4,4,4,4
.long 0x516d,0x1054,0x1842165,0x66,0x10,0x70,0xd0,0x130,0x190,0x1f0,0x250,0x2b0,0x310,0x370,0x3d0,4,4,4,4,4,4,4,4,4,4,4,4,4,4,4,4,4
.long 0x616d,0x76543210,0x1e,0x6320,0x6360,0x63a0,0x63e0,4,4,4,4,4,4,4,4,4,4,4,4,4,4,4,4,4,4,4,4,4,4,4,4,4
.long 0x17d,0x10,0x1047175,0xe,0x7060,0x7120,0x1e,0x71e0,0x72a0,4,4,4,4,4,4,4,4,4,4,4,4,4,4,4,4,4,4,4,4,4,4,4
.long 0x117d,0x32,0x846175,0x76,0x30,0x90,0xf0,0x150,0x1b0,0x210,0x270,0x2d0,0x330,0x390,0x3f0,4,4,4,4,4,4,4,4,4,4,4,4,4,4,4,4,4
.long 0x217d,0x54,0x1055175,0x1850175,0xe,0x7070,0x7130,0x1e,0x71f0,0x72b0,4,4,4,4,4,4,4,4,4,4,4,4,4,4,4,4,4,4,4,4,4,4
.long 0x317d,0x76,0x854175,0x2051175,0xe,0x7080,0x7140,0x1e,0x7200,0x72c0,4,4,4,4,4,4,4,4,4,4,4,4,4,4,4,4,4,4,4,4,4,4
.long 0x417d,0x3276,0x2043175,0x76,0x50,0xb0,0x110,0x170,0x1d0,0x230,0x290,0x2f0,0x350,0x3b0,4,4,4,4,4,4,4,4,4,4,4,4,4,4,4,4,4,4
.long 0x517d,0x1054,0x1842175,0x76,0x10,0x70,0xd0,0x130,0x190,0x1f0,0x250,0x2b0,0x310,0x370,0x3d0,4,4,4,4,4,4,4,4,4,4,4,4,4,4,4,4,4
.long 0x617d,0x76543210,0x1e,0x7320,0x7360,0x73a0,0x73e0,4,4,4,4,4,4,4,4,4,4,4,4,4,4,4,4,4,4,4,4,4,4,4,4,4
.long 0x18d,0x10,0x1047185,0xe,0x90,0x150,0x1e,0x210,0x2d0,4,4,4,4,4,4,4,4,4,4,4,4,4,4,4,4,4,4,4,4,4,4,4
.long 0x118d,0x32,0x846185,0x86,0x30,0x90,0xf0,0x150,0x1b0,0x210,0x270,0x2d0,0x330,0x390,0x3f0,4,4,4,4,4,4,4,4,4,4,4,4,4,4,4,4,4
.long 0x218d,0x54,0x1055185,0x1850185,0xe,0xa0,0x160,0x1e,0x220,0x2e0,4,4,4,4,4,4,4,4,4,4,4,4,4,4,4,4,4,4,4,4,4,4
.long 0x318d,0x76,0x854185,0x2051185,0xe,0xb0,0x170,0x1e,0x230,0x2f0,4,4,4,4,4,4,4,4,4,4,4,4,4,4,4,4,4,4,4,4,4,4
.long 0x418d,0x3276,0x2043185,0x86,0x50,0xb0,0x110,0x170,0x1d0,0x230,0x290,0x2f0,0x350,0x3b0,4,4,4,4,4,4,4,4,4,4,4,4,4,4,4,4,4,4
.long 0x518d,0x1054,0x1842185,0x86,0x10,0x70,0xd0,0x130,0x190,0x1f0,0x250,0x2b0,0x310,0x370,0x3d0,4,4,4,4,4,4,4,4,4,4,4,4,4,4,4,4,4
.long 0x618d,0x76543210,0x1e,0x330,0x370,0x3b0,0x3f0,4,4,4,4,4,4,4,4,4,4,4,4,4,4,4,4,4,4,4,4,4,4,4,4,4
.long 0x19d,0x10,0x1047195,0xe,0x1090,0x1150,0x1e,0x1210,0x12d0,4,4,4,4,4,4,4,4,4,4,4,4,4,4,4,4,4,4,4,4,4,4,4
.long 0x119d,0x32,0x846195,0x96,0x30,0x90,0xf0,0x150,0x1b0,0x210,0x270,0x2d0,0x330,0x390,0x3f0,4,4,4,4,4,4,4,4,4,4,4,4,4,4,4,4,4
.long 0x219d,0x54,0x1055195,0x1850195,0xe,0x10a0,0x1160,0x1e,0x1220,0x12e0,4,4,4,4,4,4,4,4,4,4,4,4,4,4,4,4,4,4,4,4,4,4
.long 0x319d,0x76,0x854195,0x2051195,0xe,0x10b0,0x1170,0x1e,0x1230,0x12f0,4,4,4,4,4,4,4,4,4,4,4,4,4,4,4,4,4,4,4,4,4,4
.long 0x419d,0x3276,0x2043195,0x96,0x50,0xb0,0x110,0x170,0x1d0,0x230,0x290,0x2f0,0x350,0x3b0,4,4,4,4,4,4,4,4,4,4,4,4,4,4,4,4,4,4
.long 0x519d,0x1054,0x1842195,0x96,0x10,0x70,0xd0,0x130,0x190,0x1f0,0x250,0x2b0,0x310,0x370,0x3d0,4,4,4,4,4,4,4,4,4,4,4,4,4,4,4,4,4
.long 0x619d,0x76543210,0x1e,0x1330,0x1370,0x13b0,0x13f0,4,4,4,4,4,4,4,4,4,4,4,4,4,4,4,4,4,4,4,4,4,4,4,4,4
.long 0x1ad,0x10,0x10471a5,0xe,0x2090,0x2150,0x1e,0x2210,0x22d0,4,4,4,4,4,4,4,4,4,4,4,4,4,4,4,4,4,4,4,4,4,4,4
.long 0x11ad,0x32,0x8461a5,0xa6,0x30,0x90,0xf0,0x150,0x1b0,0x210,0x270,0x2d0,0x330,0x390,0x3f0,4,4,4,4,4,4,4,4,4,4,4,4,4,4,4,4,4
.long 0x21ad,0x54,0x10551a5,0x18501a5,0xe,0x20a0,0x2160,0x1e,0x2220,0x22e0,4,4,4,4,4,4,4,4,4,4,4,4,4,4,4,4,4,4,4,4,4,4
.long 0x31ad,0x76,0x8541a5,0x20511a5,0xe,0x20b0,0x2170,0x1e,0x2230,0x22f0,4,4,4,4,4,4,4,4,4,4,4,4,4,4,4,4,4,4,4,4,4,4
.long 0x41ad,0x3276,0x20431a5,0xa6,0x50,0xb0,0x110,0x170,0x1d0,0x230,0x290,0x2f0,0x350,0x3b0,4,4,4,4,4,4,4,4,4,4,4,4,4,4,4,4,4,4
.long 0x51ad,0x1054,0x18421a5,0xa6,0x10,0x70,0xd0,0x130,0x190,0x1f0,0x250,0x2b0,0x310,0x370,0x3d0,4,4,4,4,4,4,4,4,4,4,4,4,4,4,4,4,4
.long 0x61ad,0x76543210,0x1e,0x2330,0x2370,0x23b0,0x23f0,4,4,4,4,4,4,4,4,4,4,4,4,4,4,4,4,4,4,4,4,4,4,4,4,4
.long 0x1bd,0x10,0x10471b5,0xe,0x3090,0x3150,0x1e,0x3210,0x32d0,4,4,4,4,4,4,4,4,4,4,4,4,4,4,4,4,4,4,4,4,4,4,4
.long 0x11bd,0x32,0x8461b5,0xb6,0x30,0x90,0xf0,0x150,0x1b0,0x210,0x270,0x2d0,0x330,0x390,0x3f0,4,4,4,4,4,4,4,4,4,4,4,4,4,4,4,4,4
.long 0x21bd,0x54,0x10551b5,0x18501b5,0xe,0x30a0,0x3160,0x1e,0x3220,0x32e0,4,4,4,4,4,4,4,4,4,4,4,4,4,4,4,4,4,4,4,4,4,4
.long 0x31bd,0x76,0x8541b5,0x20511b5,0xe,0x30b0,0x3170,0x1e,0x3230,0x32f0,4,4,4,4,4,4,4,4,4,4,4,4,4,4,4,4,4,4,4,4,4,4
.long 0x41bd,0x3276,0x20431b5,0xb6,0x50,0xb0,0x110,0x170,0x1d0,0x230,0x290,0x2f0,0x350,0x3b0,4,4,4,4,4,4,4,4,4,4,4,4,4,4,4,4,4,4
.long 0x51bd,0x1054,0x18421b5,0xb6,0x10,0x70,0xd0,0x130,0x190,0x1f0,0x250,0x2b0,0x310,0x370,0x3d0,4,4,4,4,4,4,4,4,4,4,4,4,4,4,4,4,4
.long 0x61bd,0x76543210,0x1e,0x3330,0x3370,0x33b0,0x33f0,4,4,4,4,4,4,4,4,4,4,4,4,4,4,4,4,4,4,4,4,4,4,4,4,4
.long 0x1cd,0x10,0x10471c5,0xe,0x4090,0x4150,0x1e,0x4210,0x42d0,4,4,4,4,4,4,4,4,4,4,4,4,4,4,4,4,4,4,4,4,4,4,4
.long 0x11cd,0x32,0x8461c5,0xc6,0x30,0x90,0xf0,0x150,0x1b0,0x210,0x270,0x2d0,0x330,0x390,0x3f0,4,4,4,4,4,4,4,4,4,4,4,4,4,4,4,4,4
.long 0x21cd,0x54,0x10551c5,0x18501c5,0xe,0x40a0,0x4160,0x1e,0x4220,0x42e0,4,4,4,4,4,4,4,4,4,4,4,4,4,4,4,4,4,4,4,4,4,4
.long 0x31cd,0x76,0x8541c5,0x20511c5,0xe,0x40b0,0x4170,0x1e,0x4230,0x42f0,4,4,4,4,4,4,4,4,4,4,4,4,4,4,4,4,4,4,4,4,4,4
.long 0x41cd,0x3276,0x20431c5,0xc6,0x50,0xb0,0x110,0x170,0x1d0,0x230,0x290,0x2f0,0x350,0x3b0,4,4,4,4,4,4,4,4,4,4,4,4,4,4,4,4,4,4
.long 0x51cd,0x1054,0x18421c5,0xc6,0x10,0x70,0xd0,0x130,0x190,0x1f0,0x250,0x2b0,0x310,0x370,0x3d0,4,4,4,4,4,4,4,4,4,4,4,4,4,4,4,4,4
.long 0x61cd,0x76543210,0x1e,0x4330,0x4370,0x43b0,0x43f0,4,4,4,4,4,4,4,4,4,4,4,4,4,4,4,4,4,4,4,4,4,4,4,4,4
.long 0x1dd,0x10,0x10471d5,0xe,0x5090,0x5150,0x1e,0x5210,0x52d0,4,4,4,4,4,4,4,4,4,4,4,4,4,4,4,4,4,4,4,4,4,4,4
.long 0x11dd,0x32,0x8461d5,0xd6,0x30,0x90,0xf0,0x150,0x1b0,0x210,0x270,0x2d0,0x330,0x390,0x3f0,4,4,4,4,4,4,4,4,4,4,4,4,4,4,4,4,4
.long 0x21dd,0x54,0x10551d5,0x18501d5,0xe,0x50a0,0x5160,0x1e,0x5220,0x52e0,4,4,4,4,4,4,4,4,4,4,4,4,4,4,4,4,4,4,4,4,4,4
.long 0x31dd,0x76,0x8541d5,0x20511d5,0xe,0x50b0,0x5170,0x1e,0x5230,0x52f0,4,4,4,4,4,4,4,4,4,4,4,4,4,4,4,4,4,4,4,4,4,4
.long 0x41dd,0x3276,0x20431d5,0xd6,0x50,0xb0,0x110,0x170,0x1d0,0x230,0x290,0x2f0,0x350,0x3b0,4,4,4,4,4,4,4,4,4,4,4,4,4,4,4,4,4,4
.long 0x51dd,0x1054,0x18421d5,0xd6,0x10,0x70,0xd0,0x130,0x190,0x1f0,0x250,0x2b0,0x310,0x370,0x3d0,4,4,4,4,4,4,4,4,4,4,4,4,4,4,4,4,4
.long 0x61dd,0x76543210,0x1e,0x5330,0x5370,0x53b0,0x53f0,4,4,4,4,4,4,4,4,4,4,4,4,4,4,4,4,4,4,4,4,4,4,4,4,4
.long 0x1ed,0x10,0x10471e5,0xe,0x6090,0x6150,0x1e,0x6210,0x62d0,4,4,4,4,4,4,4,4,4,4,4,4,4,4,4,4,4,4,4,4,4,4,4
.long 0x11ed,0x32,0x8461e5,0xe6,0x30,0x90,0xf0,0x150,0x1b0,0x210,0x270,0x2d0,0x330,0x390,0x3f0,4,4,4,4,4,4,4,4,4,4,4,4,4,4,4,4,4
.long 0x21ed,0x54,0x10551e5,0x18501e5,0xe,0x60a0,0x6160,0x1e,0x6220,0x62e0,4,4,4,4,4,4,4,4,4,4,4,4,4,4,4,4,4,4,4,4,4,4
.long 0x31ed,0x76,0x8541e5,0x20511e5,0xe,0x60b0,0x6170,0x1e,0x6230,0x62f0,4,4,4,4,4,4,4,4,4,4,4,4,4,4,4,4,4,4,4,4,4,4
.long 0x41ed,0x3276,0x20431e5,0xe6,0x50,0xb0,0x110,0x170,0x1d0,0x230,0x290,0x2f0,0x350,0x3b0,4,4,4,4,4,4,4,4,4,4,4,4,4,4,4,4,4,4
.long 0x51ed,0x1054,0x18421e5,0xe6,0x10,0x70,0xd0,0x130,0x190,0x1f0,0x250,0x2b0,0x310,0x370,0x3d0,4,4,4,4,4,4,4,4,4,4,4,4,4,4,4,4,4
.long 0x61ed,0x76543210,0x1e,0x6330,0x6370,0x63b0,0x63f0,4,4,4,4,4,4,4,4,4,4,4,4,4,4,4,4,4,4,4,4,4,4,4,4,4
.long 0x1fd,0x10,0x10471f5,0xe,0x7090,0x7150,0x1e,0x7210,0x72d0,4,4,4,4,4,4,4,4,4,4,4,4,4,4,4,4,4,4,4,4,4,4,4
.long 0x11fd,0x32,0x8461f5,0xf6,0x30,0x90,0xf0,0x150,0x1b0,0x210,0x270,0x2d0,0x330,0x390,0x3f0,4,4,4,4,4,4,4,4,4,4,4,4,4,4,4,4,4
.long 0x21fd,0x54,0x10551f5,0x18501f5,0xe,0x70a0,0x7160,0x1e,0x7220,0x72e0,4,4,4,4,4,4,4,4,4,4,4,4,4,4,4,4,4,4,4,4,4,4
.long 0x31fd,0x76,0x8541f5,0x20511f5,0xe,0x70b0,0x7170,0x1e,0x7230,0x72f0,4,4,4,4,4,4,4,4,4,4,4,4,4,4,4,4,4,4,4,4,4,4
.long 0x41fd,0x3276,0x20431f5,0xf6,0x50,0xb0,0x110,0x170,0x1d0,0x230,0x290,0x2f0,0x350,0x3b0,4,4,4,4,4,4,4,4,4,4,4,4,4,4,4,4,4,4
.long 0x51fd,0x1054,0x18421f5,0xf6,0x10,0x70,0xd0,0x130,0x190,0x1f0,0x250,0x2b0,0x310,0x370,0x3d0,4,4,4,4,4,4,4,4,4,4,4,4,4,4,4,4,4
.long 0x61fd,0x76543210,0x1e,0x7330,0x7370,0x73b0,0x73f0,4,4,4,4,4,4,4,4,4,4,4,4,4,4,4,4,4,4,4,4,4,4,4,4,4
.section .rodata,"a"
.p2align 6
.amdhsa_kernel gated_mix__compressed_kv_cla__memory_aug_recurrent_mem_tr__prompt_kernel
  .amdhsa_next_free_vgpr 512
  .amdhsa_next_free_sgpr 102
  .amdhsa_accum_offset 256
  .amdhsa_group_segment_fixed_size 0
  .amdhsa_kernarg_size 136
  .amdhsa_user_sgpr_count 2
  .amdhsa_user_sgpr_kernarg_segment_ptr 1
  .amdhsa_system_sgpr_workgroup_id_x 1
  .amdhsa_float_denorm_mode_32 3
.end_amdhsa_kernel
```

```asm
; @launch grid=(256,1,1) block=(256,1,1) lds=163840
.amdgcn_target "amdgcn-amd-amdhsa--gfx950"
.text
.globl gated_mix__compressed_kv_cla__memory_aug_recurrent_mem_tr__prompt_kernel
.p2align 8
.type gated_mix__compressed_kv_cla__memory_aug_recurrent_mem_tr__prompt_kernel,@function
gated_mix__compressed_kv_cla__memory_aug_recurrent_mem_tr__prompt_kernel:
  s_cmp_ge_u32 s2, 256
  s_cbranch_scc1 L_exit
  s_load_dwordx16 s[8:23], s[0:1], 0
  s_load_dwordx16 s[24:39], s[0:1], 64
  s_load_dwordx2 s[40:41], s[0:1], 128
  s_and_b32 s47, s2, 7
  s_lshr_b32 s45, s2, 3
  s_max_u32 s3, s47, 1
  s_sub_u32 s3, s3, 1
  s_lshl_b32 s3, s3, 5
  s_add_u32 s94, s3, s45
  s_getpc_b64 s[4:5]
L_pc0:
  s_add_u32 s4, s4, L_ptab-L_pc0
  s_addc_u32 s5, s5, 0
  s_lshl_b32 s3, s94, 7
  v_and_b32 v2, 31, v0
  v_lshl_add_u32 v2, v2, 2, s3
  global_load_dword v1, v2, s[4:5]
  s_getreg_b32 s46, hwreg(HW_REG_XCC_ID, 0, 4)
  v_lshrrev_b32 v3, 6, v0
  v_and_b32 v0, 63, v0
  v_readfirstlane_b32 s44, v3
  s_sub_u32 s4, s4, L_ptab-L_pc0
  s_subb_u32 s5, s5, 0
  s_and_b32 s3, s45, 15
  s_lshl_b32 s3, s3, 13
  v_lshl_add_u32 v2, v0, 7, s3
  v_min_u32 v2, L_ptab-L_pc0, v2
  s_cmp_lg_u32 s44, 3
  s_cbranch_scc1 L_nocodepf
  global_load_dword v31, v2, s[4:5]
L_nocodepf:
  s_and_b32 s46, s46, 7
  s_waitcnt lgkmcnt(0)
  s_add_u32 s40, s40, 0x0
  s_addc_u32 s41, s41, 0
  s_and_b32 s41, s41, 0xffff
  s_mov_b32 s42, 0x10000000
  s_mov_b32 s43, 0x20000
  s_cmp_eq_u32 s47, 0
  s_cbranch_scc1 L_team
  s_lshl2_add_u32 s3, s94, s44
  v_lshlrev_b32 v2, 7, v0
  s_mov_b32 s95, 0
  s_mov_b32 s50, 0x200000
  s_mov_b32 s51, 0x20000
  s_add_u32 s4, s3, 0
  s_lshr_b32 s5, s4, 8
  s_and_b32 s4, s4, 255
  s_lshl_b32 s4, s4, 13
  s_mov_b64 s[48:49], s[8:9]
  s_mov_b32 s6, 0
  s_cmp_eq_u32 s5, 0
  s_cselect_b64 s[48:49], s[8:9], s[48:49]
  s_cselect_b32 s6, 0x0, s6
  s_cmp_eq_u32 s5, 1
  s_cselect_b64 s[48:49], s[10:11], s[48:49]
  s_cselect_b32 s6, 0x0, s6
  s_add_u32 s48, s48, s6
  s_addc_u32 s49, s49, 0
  s_and_b32 s49, s49, 0xffff
  s_cmp_lt_u32 s5, 2
  s_cselect_b32 s4, s4, 0x40000000
  buffer_load_dword v31, v2, s[48:51], s4 offen
  s_waitcnt vmcnt(1)
L_next:
  v_readlane_b32 s3, v1, s95
  s_add_u32 s95, s95, 1
  s_nop 0
  s_and_b32 s4, s3, 3
  s_cmp_eq_u32 s4, 0
  s_cbranch_scc1 L_after_p
  s_cmp_eq_u32 s4, 2
  s_cbranch_scc1 L_go_outx
L_go_att:
  s_bfe_u32 s56, s3, 0x50004
  s_bfe_u32 s57, s3, 0x3000c
  s_bitcmp1_b32 s3, 3
  s_cbranch_scc1 L_feed
L_att:
  v_lshlrev_b32 v2, 4, v0
  s_lshl_b32 s65, s44, 11
  v_add_u32 v3, s65, v2
  s_mov_b32 s74, 0
  v_and_b32 v6, 7, v0
  s_lshl3_add_u32 s67, s57, 8
  v_lshlrev_b32 v7, 4, v6
  v_sub_u32 v7, s67, v7
  v_med3_i32 v7, v7, 0, 16
  s_lshl_b32 s66, s56, 7
  s_add_u32 s66, s66, 0xd080000
  v_lshl_add_u32 v6, v6, 2, s66
  s_bfe_u32 m0, s3, 0x30010
  s_bfe_u32 s67, s3, 0x60014
  s_nop 0
  v_writelane_b32 v7, s67, m0
  s_lshl_b32 s66, s57, 7
  s_add_u32 s66, s66, 0xd086400
  v_writelane_b32 v6, s66, 63
  v_writelane_b32 v7, 16, 63
  buffer_load_dword v24, v6, s[40:43], 0 offen sc1
  v_mov_b64 v[128:129], 0
  v_mov_b64 v[130:131], 0
  v_mov_b64 v[132:133], 0
  v_mov_b64 v[134:135], 0
  v_mov_b64 v[136:137], 0
  v_mov_b64 v[138:139], 0
  v_mov_b64 v[140:141], 0
  v_mov_b64 v[142:143], 0
  v_mov_b64 v[144:145], 0
  v_mov_b64 v[146:147], 0
  v_mov_b64 v[148:149], 0
  v_mov_b64 v[150:151], 0
  v_mov_b64 v[152:153], 0
  v_mov_b64 v[154:155], 0
  v_mov_b64 v[156:157], 0
  v_mov_b64 v[158:159], 0
  v_mov_b64 v[160:161], 0
  v_mov_b64 v[162:163], 0
  v_mov_b64 v[164:165], 0
  v_mov_b64 v[166:167], 0
  v_mov_b64 v[168:169], 0
  v_mov_b64 v[170:171], 0
  v_mov_b64 v[172:173], 0
  v_mov_b64 v[174:175], 0
  v_mov_b64 v[176:177], 0
  v_mov_b64 v[178:179], 0
  v_mov_b64 v[180:181], 0
  v_mov_b64 v[182:183], 0
  v_mov_b64 v[184:185], 0
  v_mov_b64 v[186:187], 0
  v_mov_b64 v[188:189], 0
  v_mov_b64 v[190:191], 0
  v_mov_b64 v[192:193], 0
  v_mov_b64 v[194:195], 0
  v_mov_b64 v[196:197], 0
  v_mov_b64 v[198:199], 0
  v_mov_b64 v[200:201], 0
  v_mov_b64 v[202:203], 0
  v_mov_b64 v[204:205], 0
  v_mov_b64 v[206:207], 0
  v_mov_b64 v[208:209], 0
  v_mov_b64 v[210:211], 0
  v_mov_b64 v[212:213], 0
  v_mov_b64 v[214:215], 0
  v_mov_b64 v[216:217], 0
  v_mov_b64 v[218:219], 0
  v_mov_b64 v[220:221], 0
  v_mov_b64 v[222:223], 0
  v_mov_b64 v[224:225], 0
  v_mov_b64 v[226:227], 0
  v_mov_b64 v[228:229], 0
  v_mov_b64 v[230:231], 0
  v_mov_b64 v[232:233], 0
  v_mov_b64 v[234:235], 0
  v_mov_b64 v[236:237], 0
  v_mov_b64 v[238:239], 0
  v_mov_b64 v[240:241], 0
  v_mov_b64 v[242:243], 0
  v_mov_b64 v[244:245], 0
  v_mov_b64 v[246:247], 0
  v_mov_b64 v[248:249], 0
  v_mov_b64 v[250:251], 0
  v_mov_b64 v[252:253], 0
  v_mov_b64 v[254:255], 0
  v_mov_b64 v[96:97], 0
  v_accvgpr_write_b32 a128, 0
  v_mov_b64 v[98:99], 0
  v_accvgpr_write_b32 a129, 0
  v_mov_b64 v[100:101], 0
  v_accvgpr_write_b32 a130, 0
  v_mov_b64 v[102:103], 0
  v_accvgpr_write_b32 a131, 0
  v_mov_b64 v[104:105], 0
  v_accvgpr_write_b32 a132, 0
  v_mov_b64 v[106:107], 0
  v_accvgpr_write_b32 a133, 0
  v_mov_b64 v[108:109], 0
  v_accvgpr_write_b32 a134, 0
  v_mov_b64 v[110:111], 0
  v_accvgpr_write_b32 a135, 0
  v_mov_b64 v[112:113], 0
  v_accvgpr_write_b32 a136, 0
  v_mov_b64 v[114:115], 0
  v_accvgpr_write_b32 a137, 0
  v_mov_b64 v[116:117], 0
  v_accvgpr_write_b32 a138, 0
  v_mov_b64 v[118:119], 0
  v_accvgpr_write_b32 a139, 0
  v_mov_b64 v[120:121], 0
  v_accvgpr_write_b32 a140, 0
  v_mov_b64 v[122:123], 0
  v_accvgpr_write_b32 a141, 0
  v_mov_b64 v[124:125], 0
  v_accvgpr_write_b32 a142, 0
  v_mov_b64 v[126:127], 0
  v_accvgpr_write_b32 a143, 0
  v_mov_b32 v16, 0x3f803f80
  v_mov_b32 v17, 0x3f803f80
  v_mov_b32 v18, 0x3f803f80
  v_mov_b32 v19, 0x3f803f80
  s_mov_b32 s48, s18
  s_and_b32 s49, s19, 0xffff
  s_mov_b32 s50, 0x400000
  s_mov_b32 s51, 0x20000
  s_lshl_b32 s66, s56, 19
  s_add_u32 s60, s66, 0x1000000
  s_add_u32 s61, s66, 0x2000000
  s_lshl_b32 s59, s57, 3
  s_lshr_b32 s67, s44, 1
  s_add_u32 s67, s67, s59
  s_lshl_b32 s68, s67, 13
  s_add_u32 s68, s68, s66
  s_and_b32 s67, s44, 1
  s_lshl_b32 s67, s67, 10
  s_add_u32 s68, s68, s67
  s_lshl4_add_u32 s69, s57, s44
  s_add_u32 s63, s59, 7
  s_lshl_b32 s63, s63, 13
  s_add_u32 s63, s63, s60
  s_sub_u32 s59, s59, 1
  s_add_u32 s62, s60, 0x4000
  s_mov_b32 s64, 0
  s_mov_b32 s70, 0x40004000
  s_lshl_b32 s73, s44, 12
  s_lshl_b32 s72, s56, 17
  s_lshl_b32 s67, s44, 15
  s_add_u32 s72, s72, s67
  v_lshrrev_b32 v8, 4, v0
  v_and_b32 v9, 15, v0
  s_lshl_b32 s67, s44, 4
  v_add_u32 v25, s67, v9
  v_lshlrev_b32 v10, 2, v8
  v_sub_u32 v25, v25, v10
  v_lshlrev_b32 v8, 1, v8
  v_and_b32 v10, 7, v0
  v_xor_b32 v8, v8, v10
  v_lshlrev_b32 v8, 4, v8
  v_lshrrev_b32 v10, 3, v0
  v_lshl_add_u32 v26, v10, 10, v8
  v_lshlrev_b32 v9, 2, v9
  v_add_u32 v4, 122880, v2
L_a_wait:
  s_waitcnt vmcnt(0)
  v_cmp_gt_u32 vcc, v7, v24
  s_cbranch_vccz L_a_go
  s_sleep 4
  buffer_load_dword v24, v6, s[40:43], 0 offen sc1
  s_add_u32 s74, s74, 1
  s_cmp_gt_u32 s74, 1048576
  s_cbranch_scc1 L_exit
  s_branch L_a_wait
L_a_go:
  s_add_u32 m0, s65, 131072
  s_add_u32 s66, s60, 0x2000
  buffer_load_dwordx4 v3, s[40:43], s60 offen sc1 lds
  buffer_load_dwordx4 v3, s[40:43], s60 offen offset:1024 sc1 lds
  s_add_u32 m0, s65, 139264
  s_lshl_b32 s67, s69, 6
  buffer_load_dwordx4 v3, s[40:43], s66 offen sc1 lds
  buffer_load_dwordx4 v3, s[40:43], s66 offen offset:1024 sc1 lds
  s_add_u32 s67, s67, 0xd0c0000
  s_add_u32 s58, s68, 0x1000
  buffer_load_dwordx4 a[0:3], v2, s[40:43], s68 offen offset:0 sc1
  buffer_load_dwordx4 a[4:7], v2, s[40:43], s68 offen offset:2048 sc1
  buffer_load_dwordx4 a[8:11], v2, s[40:43], s58 offen offset:0 sc1
  buffer_load_dwordx4 a[12:15], v2, s[40:43], s58 offen offset:2048 sc1
  s_add_u32 s68, s68, 0x4000
  s_add_u32 s58, s68, 0x1000
  buffer_load_dwordx4 a[16:19], v2, s[40:43], s68 offen offset:0 sc1
  buffer_load_dwordx4 a[20:23], v2, s[40:43], s68 offen offset:2048 sc1
  buffer_load_dwordx4 a[24:27], v2, s[40:43], s58 offen offset:0 sc1
  buffer_load_dwordx4 a[28:31], v2, s[40:43], s58 offen offset:2048 sc1
  s_add_u32 s68, s68, 0x4000
  s_add_u32 s58, s68, 0x1000
  buffer_load_dwordx4 a[32:35], v2, s[40:43], s68 offen offset:0 sc1
  buffer_load_dwordx4 a[36:39], v2, s[40:43], s68 offen offset:2048 sc1
  buffer_load_dwordx4 a[40:43], v2, s[40:43], s58 offen offset:0 sc1
  buffer_load_dwordx4 a[44:47], v2, s[40:43], s58 offen offset:2048 sc1
  s_add_u32 s68, s68, 0x4000
  s_add_u32 s58, s68, 0x1000
  buffer_load_dwordx4 a[48:51], v2, s[40:43], s68 offen offset:0 sc1
  buffer_load_dwordx4 a[52:55], v2, s[40:43], s68 offen offset:2048 sc1
  buffer_load_dwordx4 a[56:59], v2, s[40:43], s58 offen offset:0 sc1
  buffer_load_dwordx4 a[60:63], v2, s[40:43], s58 offen offset:2048 sc1
  s_add_u32 s68, s68, 0x4000
  buffer_load_dword v20, v9, s[40:43], s67 offen offset:0 sc1
  buffer_load_dword v21, v9, s[40:43], s67 offen offset:256 sc1
  buffer_load_dword v22, v9, s[40:43], s67 offen offset:512 sc1
  buffer_load_dword v23, v9, s[40:43], s67 offen offset:768 sc1
  s_add_u32 m0, s64, s65
  s_nop 0
  buffer_load_dwordx4 v3, s[40:43], s61 offen sc1 lds
  s_min_u32 s66, s62, s63
  s_nop 0
  buffer_load_dwordx4 v3, s[40:43], s61 offen offset:1024 sc1 lds
  s_add_u32 m0, m0, 0x2000
  s_nop 0
  buffer_load_dwordx4 v3, s[40:43], s66 offen sc1 lds
  s_add_u32 s61, s61, 0x2000
  s_nop 0
  buffer_load_dwordx4 v3, s[40:43], s66 offen offset:1024 sc1 lds
  s_add_u32 s62, s62, 0x2000
  s_add_u32 s64, s64, 0x4000
  s_and_b32 s64, s64, 0x1ffff
  s_add_u32 m0, s64, s65
  s_nop 0
  buffer_load_dwordx4 v3, s[40:43], s61 offen sc1 lds
  s_min_u32 s66, s62, s63
  s_nop 0
  buffer_load_dwordx4 v3, s[40:43], s61 offen offset:1024 sc1 lds
  s_add_u32 m0, m0, 0x2000
  s_nop 0
  buffer_load_dwordx4 v3, s[40:43], s66 offen sc1 lds
  s_add_u32 s61, s61, 0x2000
  s_nop 0
  buffer_load_dwordx4 v3, s[40:43], s66 offen offset:1024 sc1 lds
  s_add_u32 s62, s62, 0x2000
  s_add_u32 s64, s64, 0x4000
  s_and_b32 s64, s64, 0x1ffff
  s_mul_i32 s69, s69, 786432
  s_lshl_b32 s67, s56, 14
  s_add_u32 s69, s69, s67
  s_add_u32 s76, s69, 0x6000000
  s_add_u32 s77, s69, 0x6300000
  s_add_u32 s78, s69, 0x6600000
  s_add_u32 s79, s69, 0x6900000
  v_mov_b32 v24, 0xff800000
  s_cmp_lg_u32 s57, 0
  s_cbranch_scc1 L_a_nomask0
  v_cmp_gt_i32 s[80:81], 0, v25
  v_cmp_gt_i32 s[82:83], 1, v25
  v_cmp_gt_i32 s[84:85], 2, v25
  v_cmp_gt_i32 s[86:87], 3, v25
  v_cndmask_b32 v96, v96, v24, s[80:81]
  v_cndmask_b32 v97, v97, v24, s[82:83]
  v_cndmask_b32 v98, v98, v24, s[84:85]
  v_cndmask_b32 v99, v99, v24, s[86:87]
  v_cmp_gt_i32 s[80:81], 16, v25
  v_cmp_gt_i32 s[82:83], 17, v25
  v_cmp_gt_i32 s[84:85], 18, v25
  v_cmp_gt_i32 s[86:87], 19, v25
  v_cndmask_b32 v100, v100, v24, s[80:81]
  v_cndmask_b32 v101, v101, v24, s[82:83]
  v_cndmask_b32 v102, v102, v24, s[84:85]
  v_cndmask_b32 v103, v103, v24, s[86:87]
L_a_nomask0:
  s_waitcnt vmcnt(28)
  s_barrier
  ds_read_b128 a[64:67], v4 offset:8192
  ds_read_b128 a[68:71], v4 offset:9216
  ds_read_b128 a[72:75], v4 offset:10240
  ds_read_b128 a[76:79], v4 offset:11264
  ds_read_b128 a[80:83], v4 offset:12288
  ds_read_b128 a[84:87], v4 offset:13312
  ds_read_b128 a[88:91], v4 offset:14336
  ds_read_b128 a[92:95], v4 offset:15360
  v_add_u32 v4, 0x2000, v4
  s_waitcnt vmcnt(24) lgkmcnt(0)
  v_mfma_f32_16x16x32_bf16 v[32:35], a[64:67], a[0:3], v[96:99]
  v_mfma_f32_16x16x32_bf16 v[32:35], a[72:75], a[4:7], v[32:35]
  v_mfma_f32_16x16x32_bf16 v[32:35], a[80:83], a[8:11], v[32:35]
  v_mfma_f32_16x16x32_bf16 v[32:35], a[88:91], a[12:15], v[32:35]
  v_mfma_f32_16x16x32_bf16 v[36:39], a[68:71], a[0:3], v[100:103]
  v_mfma_f32_16x16x32_bf16 v[36:39], a[76:79], a[4:7], v[36:39]
  v_mfma_f32_16x16x32_bf16 v[36:39], a[84:87], a[8:11], v[36:39]
  v_mfma_f32_16x16x32_bf16 v[36:39], a[92:95], a[12:15], v[36:39]
  s_waitcnt vmcnt(20) lgkmcnt(0)
  v_mfma_f32_16x16x32_bf16 v[40:43], a[64:67], a[16:19], v[104:107]
  v_mfma_f32_16x16x32_bf16 v[40:43], a[72:75], a[20:23], v[40:43]
  v_mfma_f32_16x16x32_bf16 v[40:43], a[80:83], a[24:27], v[40:43]
  v_mfma_f32_16x16x32_bf16 v[40:43], a[88:91], a[28:31], v[40:43]
  v_mfma_f32_16x16x32_bf16 v[44:47], a[68:71], a[16:19], v[108:111]
  v_mfma_f32_16x16x32_bf16 v[44:47], a[76:79], a[20:23], v[44:47]
  v_mfma_f32_16x16x32_bf16 v[44:47], a[84:87], a[24:27], v[44:47]
  v_mfma_f32_16x16x32_bf16 v[44:47], a[92:95], a[28:31], v[44:47]
  s_waitcnt vmcnt(16) lgkmcnt(0)
  v_mfma_f32_16x16x32_bf16 v[48:51], a[64:67], a[32:35], v[112:115]
  v_mfma_f32_16x16x32_bf16 v[48:51], a[72:75], a[36:39], v[48:51]
  v_mfma_f32_16x16x32_bf16 v[48:51], a[80:83], a[40:43], v[48:51]
  v_mfma_f32_16x16x32_bf16 v[48:51], a[88:91], a[44:47], v[48:51]
  v_mfma_f32_16x16x32_bf16 v[52:55], a[68:71], a[32:35], v[116:119]
  v_mfma_f32_16x16x32_bf16 v[52:55], a[76:79], a[36:39], v[52:55]
  v_mfma_f32_16x16x32_bf16 v[52:55], a[84:87], a[40:43], v[52:55]
  v_mfma_f32_16x16x32_bf16 v[52:55], a[92:95], a[44:47], v[52:55]
  s_waitcnt vmcnt(12) lgkmcnt(0)
  v_mfma_f32_16x16x32_bf16 v[56:59], a[64:67], a[48:51], v[120:123]
  v_mfma_f32_16x16x32_bf16 v[56:59], a[72:75], a[52:55], v[56:59]
  v_mfma_f32_16x16x32_bf16 v[56:59], a[80:83], a[56:59], v[56:59]
  v_mfma_f32_16x16x32_bf16 v[56:59], a[88:91], a[60:63], v[56:59]
  v_mfma_f32_16x16x32_bf16 v[60:63], a[68:71], a[48:51], v[124:127]
  v_mfma_f32_16x16x32_bf16 v[60:63], a[76:79], a[52:55], v[60:63]
  v_mfma_f32_16x16x32_bf16 v[60:63], a[84:87], a[56:59], v[60:63]
  v_mfma_f32_16x16x32_bf16 v[60:63], a[92:95], a[60:63], v[60:63]
  ds_read_b128 a[64:67], v4 offset:8192
  ds_read_b128 a[68:71], v4 offset:9216
  ds_read_b128 a[72:75], v4 offset:10240
  ds_read_b128 a[76:79], v4 offset:11264
  ds_read_b128 a[80:83], v4 offset:12288
  ds_read_b128 a[84:87], v4 offset:13312
  ds_read_b128 a[88:91], v4 offset:14336
  ds_read_b128 a[92:95], v4 offset:15360
  v_mov_b32 v4, v2
  s_add_u32 m0, s64, s65
  s_nop 0
  buffer_load_dwordx4 v3, s[40:43], s61 offen sc1 lds
  s_min_u32 s66, s62, s63
  s_nop 0
  buffer_load_dwordx4 v3, s[40:43], s61 offen offset:1024 sc1 lds
  s_add_u32 m0, m0, 0x2000
  s_nop 0
  buffer_load_dwordx4 v3, s[40:43], s66 offen sc1 lds
  s_add_u32 s61, s61, 0x2000
  s_nop 0
  buffer_load_dwordx4 v3, s[40:43], s66 offen offset:1024 sc1 lds
  s_add_u32 s62, s62, 0x2000
  s_add_u32 s64, s64, 0x4000
  s_and_b32 s64, s64, 0x1ffff
  v_max3_f32 v6, v32, v33, v34
  v_max3_f32 v7, v35, v36, v37
  v_max3_f32 v6, v6, v38, v39
  v_max_f32 v6, v6, v7
  v_mov_b32 v7, v6
  s_nop 1
  v_permlane32_swap_b32 v7, v6
  v_max_f32 v6, v6, v7
  v_mov_b32 v7, v6
  s_nop 1
  v_permlane16_swap_b32 v7, v6
  v_max_f32 v6, v6, v7
  v_add_f32 v6, 0x41800000, v6
  v_sub_f32 v96, v96, v6
  v_sub_f32 v97, v97, v6
  v_sub_f32 v98, v98, v6
  v_sub_f32 v99, v99, v6
  v_sub_f32 v100, v100, v6
  v_sub_f32 v101, v101, v6
  v_sub_f32 v102, v102, v6
  v_sub_f32 v103, v103, v6
  v_sub_f32 v8, v32, v6
  v_sub_f32 v9, v33, v6
  v_sub_f32 v10, v34, v6
  v_sub_f32 v11, v35, v6
  v_sub_f32 v12, v36, v6
  v_sub_f32 v13, v37, v6
  v_sub_f32 v14, v38, v6
  v_sub_f32 v15, v39, v6
  v_exp_f32 v8, v8
  v_exp_f32 v9, v9
  v_exp_f32 v10, v10
  v_exp_f32 v11, v11
  v_exp_f32 v12, v12
  v_exp_f32 v13, v13
  v_exp_f32 v14, v14
  v_exp_f32 v15, v15
  v_cvt_pk_bf16_f32 v64, v8, v9
  v_cvt_pk_bf16_f32 v65, v10, v11
  v_cvt_pk_bf16_f32 v66, v12, v13
  v_cvt_pk_bf16_f32 v67, v14, v15
  s_add_u32 m0, s64, s65
  s_nop 0
  buffer_load_dwordx4 v3, s[40:43], s61 offen sc1 lds
  s_min_u32 s66, s62, s63
  s_nop 0
  buffer_load_dwordx4 v3, s[40:43], s61 offen offset:1024 sc1 lds
  s_add_u32 m0, m0, 0x2000
  s_nop 0
  buffer_load_dwordx4 v3, s[40:43], s66 offen sc1 lds
  s_add_u32 s61, s61, 0x2000
  s_nop 0
  buffer_load_dwordx4 v3, s[40:43], s66 offen offset:1024 sc1 lds
  s_add_u32 s62, s62, 0x2000
  s_add_u32 s64, s64, 0x4000
  s_and_b32 s64, s64, 0x1ffff
  v_max3_f32 v6, v40, v41, v42
  v_max3_f32 v7, v43, v44, v45
  v_max3_f32 v6, v6, v46, v47
  v_max_f32 v6, v6, v7
  v_mov_b32 v7, v6
  s_nop 1
  v_permlane32_swap_b32 v7, v6
  v_max_f32 v6, v6, v7
  v_mov_b32 v7, v6
  s_nop 1
  v_permlane16_swap_b32 v7, v6
  v_max_f32 v6, v6, v7
  v_add_f32 v6, 0x41800000, v6
  v_sub_f32 v104, v104, v6
  v_sub_f32 v105, v105, v6
  v_sub_f32 v106, v106, v6
  v_sub_f32 v107, v107, v6
  v_sub_f32 v108, v108, v6
  v_sub_f32 v109, v109, v6
  v_sub_f32 v110, v110, v6
  v_sub_f32 v111, v111, v6
  v_sub_f32 v8, v40, v6
  v_sub_f32 v9, v41, v6
  v_sub_f32 v10, v42, v6
  v_sub_f32 v11, v43, v6
  v_sub_f32 v12, v44, v6
  v_sub_f32 v13, v45, v6
  v_sub_f32 v14, v46, v6
  v_sub_f32 v15, v47, v6
  v_exp_f32 v8, v8
  v_exp_f32 v9, v9
  v_exp_f32 v10, v10
  v_exp_f32 v11, v11
  v_exp_f32 v12, v12
  v_exp_f32 v13, v13
  v_exp_f32 v14, v14
  v_exp_f32 v15, v15
  v_cvt_pk_bf16_f32 v68, v8, v9
  v_cvt_pk_bf16_f32 v69, v10, v11
  v_cvt_pk_bf16_f32 v70, v12, v13
  v_cvt_pk_bf16_f32 v71, v14, v15
  s_add_u32 m0, s64, s65
  s_nop 0
  buffer_load_dwordx4 v3, s[40:43], s61 offen sc1 lds
  s_min_u32 s66, s62, s63
  s_nop 0
  buffer_load_dwordx4 v3, s[40:43], s61 offen offset:1024 sc1 lds
  s_add_u32 m0, m0, 0x2000
  s_nop 0
  buffer_load_dwordx4 v3, s[40:43], s66 offen sc1 lds
  s_add_u32 s61, s61, 0x2000
  s_nop 0
  buffer_load_dwordx4 v3, s[40:43], s66 offen offset:1024 sc1 lds
  s_add_u32 s62, s62, 0x2000
  s_add_u32 s64, s64, 0x4000
  s_and_b32 s64, s64, 0x1ffff
  v_max3_f32 v6, v48, v49, v50
  v_max3_f32 v7, v51, v52, v53
  v_max3_f32 v6, v6, v54, v55
  v_max_f32 v6, v6, v7
  v_mov_b32 v7, v6
  s_nop 1
  v_permlane32_swap_b32 v7, v6
  v_max_f32 v6, v6, v7
  v_mov_b32 v7, v6
  s_nop 1
  v_permlane16_swap_b32 v7, v6
  v_max_f32 v6, v6, v7
  v_add_f32 v6, 0x41800000, v6
  v_sub_f32 v112, v112, v6
  v_sub_f32 v113, v113, v6
  v_sub_f32 v114, v114, v6
  v_sub_f32 v115, v115, v6
  v_sub_f32 v116, v116, v6
  v_sub_f32 v117, v117, v6
  v_sub_f32 v118, v118, v6
  v_sub_f32 v119, v119, v6
  v_sub_f32 v8, v48, v6
  v_sub_f32 v9, v49, v6
  v_sub_f32 v10, v50, v6
  v_sub_f32 v11, v51, v6
  v_sub_f32 v12, v52, v6
  v_sub_f32 v13, v53, v6
  v_sub_f32 v14, v54, v6
  v_sub_f32 v15, v55, v6
  v_exp_f32 v8, v8
  v_exp_f32 v9, v9
  v_exp_f32 v10, v10
  v_exp_f32 v11, v11
  v_exp_f32 v12, v12
  v_exp_f32 v13, v13
  v_exp_f32 v14, v14
  v_exp_f32 v15, v15
  v_cvt_pk_bf16_f32 v72, v8, v9
  v_cvt_pk_bf16_f32 v73, v10, v11
  v_cvt_pk_bf16_f32 v74, v12, v13
  v_cvt_pk_bf16_f32 v75, v14, v15
  s_add_u32 m0, s64, s65
  s_nop 0
  buffer_load_dwordx4 v3, s[40:43], s61 offen sc1 lds
  s_min_u32 s66, s62, s63
  s_nop 0
  buffer_load_dwordx4 v3, s[40:43], s61 offen offset:1024 sc1 lds
  s_add_u32 m0, m0, 0x2000
  s_nop 0
  buffer_load_dwordx4 v3, s[40:43], s66 offen sc1 lds
  s_add_u32 s61, s61, 0x2000
  s_nop 0
  buffer_load_dwordx4 v3, s[40:43], s66 offen offset:1024 sc1 lds
  s_add_u32 s62, s62, 0x2000
  s_add_u32 s64, s64, 0x4000
  s_and_b32 s64, s64, 0x1ffff
  v_max3_f32 v6, v56, v57, v58
  v_max3_f32 v7, v59, v60, v61
  v_max3_f32 v6, v6, v62, v63
  v_max_f32 v6, v6, v7
  v_mov_b32 v7, v6
  s_nop 1
  v_permlane32_swap_b32 v7, v6
  v_max_f32 v6, v6, v7
  v_mov_b32 v7, v6
  s_nop 1
  v_permlane16_swap_b32 v7, v6
  v_max_f32 v6, v6, v7
  v_add_f32 v6, 0x41800000, v6
  v_sub_f32 v120, v120, v6
  v_sub_f32 v121, v121, v6
  v_sub_f32 v122, v122, v6
  v_sub_f32 v123, v123, v6
  v_sub_f32 v124, v124, v6
  v_sub_f32 v125, v125, v6
  v_sub_f32 v126, v126, v6
  v_sub_f32 v127, v127, v6
  v_sub_f32 v8, v56, v6
  v_sub_f32 v9, v57, v6
  v_sub_f32 v10, v58, v6
  v_sub_f32 v11, v59, v6
  v_sub_f32 v12, v60, v6
  v_sub_f32 v13, v61, v6
  v_sub_f32 v14, v62, v6
  v_sub_f32 v15, v63, v6
  v_exp_f32 v8, v8
  v_exp_f32 v9, v9
  v_exp_f32 v10, v10
  v_exp_f32 v11, v11
  v_exp_f32 v12, v12
  v_exp_f32 v13, v13
  v_exp_f32 v14, v14
  v_exp_f32 v15, v15
  v_cvt_pk_bf16_f32 v76, v8, v9
  v_cvt_pk_bf16_f32 v77, v10, v11
  v_cvt_pk_bf16_f32 v78, v12, v13
  v_cvt_pk_bf16_f32 v79, v14, v15
  s_add_u32 m0, s64, s65
  s_nop 0
  buffer_load_dwordx4 v3, s[40:43], s61 offen sc1 lds
  s_min_u32 s66, s62, s63
  s_nop 0
  buffer_load_dwordx4 v3, s[40:43], s61 offen offset:1024 sc1 lds
  s_add_u32 m0, m0, 0x2000
  s_nop 0
  buffer_load_dwordx4 v3, s[40:43], s66 offen sc1 lds
  s_add_u32 s61, s61, 0x2000
  s_nop 0
  buffer_load_dwordx4 v3, s[40:43], s66 offen offset:1024 sc1 lds
  s_add_u32 s62, s62, 0x2000
  s_add_u32 s64, s64, 0x4000
  s_and_b32 s64, s64, 0x1ffff
  s_mov_b32 s58, 0
  s_cmp_lg_u32 s57, 0
  s_cbranch_scc1 L_a_s0
  v_cmp_gt_i32 s[80:81], 32, v25
  v_cmp_gt_i32 s[82:83], 33, v25
  v_cmp_gt_i32 s[84:85], 34, v25
  v_cmp_gt_i32 s[86:87], 35, v25
  v_cndmask_b32 v96, v96, v24, s[80:81]
  v_cndmask_b32 v97, v97, v24, s[82:83]
  v_cndmask_b32 v98, v98, v24, s[84:85]
  v_cndmask_b32 v99, v99, v24, s[86:87]
  v_cmp_gt_i32 s[80:81], 48, v25
  v_cmp_gt_i32 s[82:83], 49, v25
  v_cmp_gt_i32 s[84:85], 50, v25
  v_cmp_gt_i32 s[86:87], 51, v25
  v_cndmask_b32 v100, v100, v24, s[80:81]
  v_cndmask_b32 v101, v101, v24, s[82:83]
  v_cndmask_b32 v102, v102, v24, s[84:85]
  v_cndmask_b32 v103, v103, v24, s[86:87]
  s_branch L_a_d1
L_a_s1:
  s_waitcnt vmcnt(24) lgkmcnt(0)
  v_mfma_f32_16x16x32_bf16 v[32:35], a[64:67], a[0:3], v[96:99]
  s_barrier
  ds_read_b128 a[96:99], v4 offset:0
  v_mfma_f32_16x16x32_bf16 v[32:35], a[72:75], a[4:7], v[32:35]
  s_nop 0
  ds_read_b128 a[100:103], v4 offset:1024
  v_mfma_f32_16x16x32_bf16 v[32:35], a[80:83], a[8:11], v[32:35]
  s_nop 0
  ds_read_b128 a[104:107], v4 offset:2048
  v_mfma_f32_16x16x32_bf16 v[32:35], a[88:91], a[12:15], v[32:35]
  s_nop 0
  ds_read_b128 a[108:111], v4 offset:3072
  v_mfma_f32_16x16x32_bf16 v[36:39], a[68:71], a[0:3], v[100:103]
  s_nop 0
  ds_read_b128 a[112:115], v4 offset:4096
  v_mfma_f32_16x16x32_bf16 v[36:39], a[76:79], a[4:7], v[36:39]
  s_nop 0
  ds_read_b128 a[116:119], v4 offset:5120
  v_mfma_f32_16x16x32_bf16 v[36:39], a[84:87], a[8:11], v[36:39]
  s_nop 0
  ds_read_b128 a[120:123], v4 offset:6144
  v_mfma_f32_16x16x32_bf16 v[36:39], a[92:95], a[12:15], v[36:39]
  s_nop 0
  ds_read_b128 a[124:127], v4 offset:7168
  v_mfma_f32_16x16x32_bf16 v[40:43], a[64:67], a[16:19], v[104:107]
  s_nop 0
  v_exp_f32 v8, v32
  v_mfma_f32_16x16x32_bf16 v[40:43], a[72:75], a[20:23], v[40:43]
  s_nop 0
  v_exp_f32 v9, v33
  v_mfma_f32_16x16x32_bf16 v[40:43], a[80:83], a[24:27], v[40:43]
  s_nop 0
  v_exp_f32 v10, v34
  v_mfma_f32_16x16x32_bf16 v[40:43], a[88:91], a[28:31], v[40:43]
  s_nop 0
  v_exp_f32 v11, v35
  v_mfma_f32_16x16x32_bf16 v[44:47], a[68:71], a[16:19], v[108:111]
  s_nop 0
  v_cvt_pk_bf16_f32 v64, v8, v9
  v_cvt_pk_bf16_f32 v65, v10, v11
  v_mfma_f32_16x16x32_bf16 v[44:47], a[76:79], a[20:23], v[44:47]
  s_nop 0
  v_or_b32 v5, v64, v65
  v_mfma_f32_16x16x32_bf16 v[44:47], a[84:87], a[24:27], v[44:47]
  s_nop 0
  v_exp_f32 v12, v36
  v_mfma_f32_16x16x32_bf16 v[44:47], a[92:95], a[28:31], v[44:47]
  s_nop 0
  v_exp_f32 v13, v37
  v_mfma_f32_16x16x32_bf16 v[48:51], a[64:67], a[32:35], v[112:115]
  s_nop 0
  v_exp_f32 v14, v38
  v_mfma_f32_16x16x32_bf16 v[48:51], a[72:75], a[36:39], v[48:51]
  s_nop 0
  v_exp_f32 v15, v39
  v_mfma_f32_16x16x32_bf16 v[48:51], a[80:83], a[40:43], v[48:51]
  s_nop 0
  v_cvt_pk_bf16_f32 v66, v12, v13
  v_cvt_pk_bf16_f32 v67, v14, v15
  v_mfma_f32_16x16x32_bf16 v[48:51], a[88:91], a[44:47], v[48:51]
  s_add_u32 m0, s64, s65
  s_nop 0
  buffer_load_dwordx4 v3, s[40:43], s61 offen sc1 lds
  v_or3_b32 v5, v5, v66, v67
  v_mfma_f32_16x16x32_bf16 v[52:55], a[68:71], a[32:35], v[116:119]
  s_nop 0
  v_exp_f32 v8, v40
  v_mfma_f32_16x16x32_bf16 v[52:55], a[76:79], a[36:39], v[52:55]
  s_nop 0
  v_exp_f32 v9, v41
  v_mfma_f32_16x16x32_bf16 v[52:55], a[84:87], a[40:43], v[52:55]
  s_min_u32 s66, s62, s63
  buffer_load_dwordx4 v3, s[40:43], s61 offen offset:1024 sc1 lds
  v_mfma_f32_16x16x32_bf16 v[52:55], a[92:95], a[44:47], v[52:55]
  s_nop 0
  v_exp_f32 v10, v42
  v_mfma_f32_16x16x32_bf16 v[56:59], a[64:67], a[48:51], v[120:123]
  s_nop 0
  v_exp_f32 v11, v43
  v_mfma_f32_16x16x32_bf16 v[56:59], a[72:75], a[52:55], v[56:59]
  s_add_u32 m0, m0, 0x2000
  s_nop 0
  buffer_load_dwordx4 v3, s[40:43], s66 offen sc1 lds
  v_cvt_pk_bf16_f32 v68, v8, v9
  v_mfma_f32_16x16x32_bf16 v[56:59], a[80:83], a[56:59], v[56:59]
  s_nop 0
  v_cvt_pk_bf16_f32 v69, v10, v11
  v_or3_b32 v5, v5, v68, v69
  v_mfma_f32_16x16x32_bf16 v[56:59], a[88:91], a[60:63], v[56:59]
  s_nop 0
  v_exp_f32 v12, v44
  v_mfma_f32_16x16x32_bf16 v[60:63], a[68:71], a[48:51], v[124:127]
  s_add_u32 s61, s61, 0x2000
  buffer_load_dwordx4 v3, s[40:43], s66 offen offset:1024 sc1 lds
  v_mfma_f32_16x16x32_bf16 v[60:63], a[76:79], a[52:55], v[60:63]
  s_add_u32 s62, s62, 0x2000
  v_exp_f32 v13, v45
  v_mfma_f32_16x16x32_bf16 v[60:63], a[84:87], a[56:59], v[60:63]
  s_add_u32 s64, s64, 0x4000
  v_exp_f32 v14, v46
  v_mfma_f32_16x16x32_bf16 v[60:63], a[92:95], a[60:63], v[60:63]
  s_and_b32 s64, s64, 0x1ffff
  v_exp_f32 v15, v47
  v_mfma_f32_16x16x32_bf16 a[128:131], v[16:19], v[80:83], a[128:131]
  s_add_u32 s58, s58, 1
  v_cvt_pk_bf16_f32 v70, v12, v13
  v_cvt_pk_bf16_f32 v71, v14, v15
  v_mfma_f32_16x16x32_bf16 a[132:135], v[16:19], v[84:87], a[132:135]
  s_nop 0
  ds_read_b128 a[64:67], v4 offset:8192
  v_or3_b32 v5, v5, v70, v71
  v_mfma_f32_16x16x32_bf16 a[136:139], v[16:19], v[88:91], a[136:139]
  s_nop 0
  v_exp_f32 v8, v48
  v_mfma_f32_16x16x32_bf16 a[140:143], v[16:19], v[92:95], a[140:143]
  s_nop 0
  v_exp_f32 v9, v49
  s_waitcnt lgkmcnt(1)
  v_mfma_f32_16x16x32_bf16 v[128:131], a[96:99], v[80:83], v[128:131]
  ds_read_b128 a[68:71], v4 offset:9216
  v_mfma_f32_16x16x32_bf16 v[160:163], a[96:99], v[84:87], v[160:163]
  v_exp_f32 v10, v50
  v_mfma_f32_16x16x32_bf16 v[192:195], a[96:99], v[88:91], v[192:195]
  v_exp_f32 v11, v51
  v_mfma_f32_16x16x32_bf16 v[224:227], a[96:99], v[92:95], v[224:227]
  ds_read_b128 a[72:75], v4 offset:10240
  v_cvt_pk_bf16_f32 v72, v8, v9
  v_mfma_f32_16x16x32_bf16 v[132:135], a[100:103], v[80:83], v[132:135]
  v_cvt_pk_bf16_f32 v73, v10, v11
  v_or3_b32 v5, v5, v72, v73
  v_mfma_f32_16x16x32_bf16 v[164:167], a[100:103], v[84:87], v[164:167]
  v_exp_f32 v12, v52
  v_mfma_f32_16x16x32_bf16 v[196:199], a[100:103], v[88:91], v[196:199]
  ds_read_b128 a[76:79], v4 offset:11264
  v_mfma_f32_16x16x32_bf16 v[228:231], a[100:103], v[92:95], v[228:231]
  v_exp_f32 v13, v53
  v_mfma_f32_16x16x32_bf16 v[136:139], a[104:107], v[80:83], v[136:139]
  v_exp_f32 v14, v54
  v_mfma_f32_16x16x32_bf16 v[168:171], a[104:107], v[84:87], v[168:171]
  ds_read_b128 a[80:83], v4 offset:12288
  v_mfma_f32_16x16x32_bf16 v[200:203], a[104:107], v[88:91], v[200:203]
  v_exp_f32 v15, v55
  v_mfma_f32_16x16x32_bf16 v[232:235], a[104:107], v[92:95], v[232:235]
  v_cvt_pk_bf16_f32 v74, v12, v13
  v_cvt_pk_bf16_f32 v75, v14, v15
  v_mfma_f32_16x16x32_bf16 v[140:143], a[108:111], v[80:83], v[140:143]
  ds_read_b128 a[84:87], v4 offset:13312
  v_or3_b32 v5, v5, v74, v75
  v_mfma_f32_16x16x32_bf16 v[172:175], a[108:111], v[84:87], v[172:175]
  v_exp_f32 v8, v56
  v_mfma_f32_16x16x32_bf16 v[204:207], a[108:111], v[88:91], v[204:207]
  v_exp_f32 v9, v57
  v_mfma_f32_16x16x32_bf16 v[236:239], a[108:111], v[92:95], v[236:239]
  ds_read_b128 a[88:91], v4 offset:14336
  v_mfma_f32_16x16x32_bf16 v[144:147], a[112:115], v[80:83], v[144:147]
  v_exp_f32 v10, v58
  v_mfma_f32_16x16x32_bf16 v[176:179], a[112:115], v[84:87], v[176:179]
  v_exp_f32 v11, v59
  v_mfma_f32_16x16x32_bf16 v[208:211], a[112:115], v[88:91], v[208:211]
  ds_read_b128 a[92:95], v4 offset:15360
  v_cvt_pk_bf16_f32 v76, v8, v9
  v_mfma_f32_16x16x32_bf16 v[240:243], a[112:115], v[92:95], v[240:243]
  v_cvt_pk_bf16_f32 v77, v10, v11
  v_or3_b32 v5, v5, v76, v77
  v_mfma_f32_16x16x32_bf16 v[148:151], a[116:119], v[80:83], v[148:151]
  v_exp_f32 v12, v60
  v_mfma_f32_16x16x32_bf16 v[180:183], a[116:119], v[84:87], v[180:183]
  v_exp_f32 v13, v61
  v_mfma_f32_16x16x32_bf16 v[212:215], a[116:119], v[88:91], v[212:215]
  v_exp_f32 v14, v62
  v_mfma_f32_16x16x32_bf16 v[244:247], a[116:119], v[92:95], v[244:247]
  v_exp_f32 v15, v63
  v_mfma_f32_16x16x32_bf16 v[152:155], a[120:123], v[80:83], v[152:155]
  v_cvt_pk_bf16_f32 v78, v12, v13
  v_cvt_pk_bf16_f32 v79, v14, v15
  v_mfma_f32_16x16x32_bf16 v[184:187], a[120:123], v[84:87], v[184:187]
  v_or3_b32 v5, v5, v78, v79
  v_and_b32 v5, s70, v5
  v_mfma_f32_16x16x32_bf16 v[216:219], a[120:123], v[88:91], v[216:219]
  v_cmp_ne_u32 vcc, 0, v5
  v_add_u32 v4, 0x4000, v4
  v_mfma_f32_16x16x32_bf16 v[248:251], a[120:123], v[92:95], v[248:251]
  v_and_b32 v4, 0x1ffff, v4
  v_mfma_f32_16x16x32_bf16 v[156:159], a[124:127], v[80:83], v[156:159]
  v_mfma_f32_16x16x32_bf16 v[188:191], a[124:127], v[84:87], v[188:191]
  v_mfma_f32_16x16x32_bf16 v[220:223], a[124:127], v[88:91], v[220:223]
  v_mfma_f32_16x16x32_bf16 v[252:255], a[124:127], v[92:95], v[252:255]
  s_cbranch_vccnz L_a_s1_t
L_a_s1_r:
L_a_s0:
  s_waitcnt vmcnt(24) lgkmcnt(0)
  v_mfma_f32_16x16x32_bf16 v[32:35], a[64:67], a[0:3], v[96:99]
  s_barrier
  ds_read_b128 a[96:99], v4 offset:0
  v_mfma_f32_16x16x32_bf16 v[32:35], a[72:75], a[4:7], v[32:35]
  s_nop 0
  ds_read_b128 a[100:103], v4 offset:1024
  v_mfma_f32_16x16x32_bf16 v[32:35], a[80:83], a[8:11], v[32:35]
  s_nop 0
  ds_read_b128 a[104:107], v4 offset:2048
  v_mfma_f32_16x16x32_bf16 v[32:35], a[88:91], a[12:15], v[32:35]
  s_nop 0
  ds_read_b128 a[108:111], v4 offset:3072
  v_mfma_f32_16x16x32_bf16 v[36:39], a[68:71], a[0:3], v[100:103]
  s_nop 0
  ds_read_b128 a[112:115], v4 offset:4096
  v_mfma_f32_16x16x32_bf16 v[36:39], a[76:79], a[4:7], v[36:39]
  s_nop 0
  ds_read_b128 a[116:119], v4 offset:5120
  v_mfma_f32_16x16x32_bf16 v[36:39], a[84:87], a[8:11], v[36:39]
  s_nop 0
  ds_read_b128 a[120:123], v4 offset:6144
  v_mfma_f32_16x16x32_bf16 v[36:39], a[92:95], a[12:15], v[36:39]
  s_nop 0
  ds_read_b128 a[124:127], v4 offset:7168
  v_mfma_f32_16x16x32_bf16 v[40:43], a[64:67], a[16:19], v[104:107]
  s_nop 0
  v_exp_f32 v8, v32
  v_mfma_f32_16x16x32_bf16 v[40:43], a[72:75], a[20:23], v[40:43]
  s_nop 0
  v_exp_f32 v9, v33
  v_mfma_f32_16x16x32_bf16 v[40:43], a[80:83], a[24:27], v[40:43]
  s_nop 0
  v_exp_f32 v10, v34
  v_mfma_f32_16x16x32_bf16 v[40:43], a[88:91], a[28:31], v[40:43]
  s_nop 0
  v_exp_f32 v11, v35
  v_mfma_f32_16x16x32_bf16 v[44:47], a[68:71], a[16:19], v[108:111]
  s_nop 0
  v_cvt_pk_bf16_f32 v80, v8, v9
  v_cvt_pk_bf16_f32 v81, v10, v11
  v_mfma_f32_16x16x32_bf16 v[44:47], a[76:79], a[20:23], v[44:47]
  s_nop 0
  v_or_b32 v5, v80, v81
  v_mfma_f32_16x16x32_bf16 v[44:47], a[84:87], a[24:27], v[44:47]
  s_nop 0
  v_exp_f32 v12, v36
  v_mfma_f32_16x16x32_bf16 v[44:47], a[92:95], a[28:31], v[44:47]
  s_nop 0
  v_exp_f32 v13, v37
  v_mfma_f32_16x16x32_bf16 v[48:51], a[64:67], a[32:35], v[112:115]
  s_nop 0
  v_exp_f32 v14, v38
  v_mfma_f32_16x16x32_bf16 v[48:51], a[72:75], a[36:39], v[48:51]
  s_nop 0
  v_exp_f32 v15, v39
  v_mfma_f32_16x16x32_bf16 v[48:51], a[80:83], a[40:43], v[48:51]
  s_nop 0
  v_cvt_pk_bf16_f32 v82, v12, v13
  v_cvt_pk_bf16_f32 v83, v14, v15
  v_mfma_f32_16x16x32_bf16 v[48:51], a[88:91], a[44:47], v[48:51]
  s_add_u32 m0, s64, s65
  s_nop 0
  buffer_load_dwordx4 v3, s[40:43], s61 offen sc1 lds
  v_or3_b32 v5, v5, v82, v83
  v_mfma_f32_16x16x32_bf16 v[52:55], a[68:71], a[32:35], v[116:119]
  s_nop 0
  v_exp_f32 v8, v40
  v_mfma_f32_16x16x32_bf16 v[52:55], a[76:79], a[36:39], v[52:55]
  s_nop 0
  v_exp_f32 v9, v41
  v_mfma_f32_16x16x32_bf16 v[52:55], a[84:87], a[40:43], v[52:55]
  s_min_u32 s66, s62, s63
  buffer_load_dwordx4 v3, s[40:43], s61 offen offset:1024 sc1 lds
  v_mfma_f32_16x16x32_bf16 v[52:55], a[92:95], a[44:47], v[52:55]
  s_nop 0
  v_exp_f32 v10, v42
  v_mfma_f32_16x16x32_bf16 v[56:59], a[64:67], a[48:51], v[120:123]
  s_nop 0
  v_exp_f32 v11, v43
  v_mfma_f32_16x16x32_bf16 v[56:59], a[72:75], a[52:55], v[56:59]
  s_add_u32 m0, m0, 0x2000
  s_nop 0
  buffer_load_dwordx4 v3, s[40:43], s66 offen sc1 lds
  v_cvt_pk_bf16_f32 v84, v8, v9
  v_mfma_f32_16x16x32_bf16 v[56:59], a[80:83], a[56:59], v[56:59]
  s_nop 0
  v_cvt_pk_bf16_f32 v85, v10, v11
  v_or3_b32 v5, v5, v84, v85
  v_mfma_f32_16x16x32_bf16 v[56:59], a[88:91], a[60:63], v[56:59]
  s_nop 0
  v_exp_f32 v12, v44
  v_mfma_f32_16x16x32_bf16 v[60:63], a[68:71], a[48:51], v[124:127]
  s_add_u32 s61, s61, 0x2000
  buffer_load_dwordx4 v3, s[40:43], s66 offen offset:1024 sc1 lds
  v_mfma_f32_16x16x32_bf16 v[60:63], a[76:79], a[52:55], v[60:63]
  s_add_u32 s62, s62, 0x2000
  v_exp_f32 v13, v45
  v_mfma_f32_16x16x32_bf16 v[60:63], a[84:87], a[56:59], v[60:63]
  s_add_u32 s64, s64, 0x4000
  v_exp_f32 v14, v46
  v_mfma_f32_16x16x32_bf16 v[60:63], a[92:95], a[60:63], v[60:63]
  s_and_b32 s64, s64, 0x1ffff
  v_exp_f32 v15, v47
  v_mfma_f32_16x16x32_bf16 a[128:131], v[16:19], v[64:67], a[128:131]
  s_add_u32 s58, s58, 1
  v_cvt_pk_bf16_f32 v86, v12, v13
  v_cvt_pk_bf16_f32 v87, v14, v15
  v_mfma_f32_16x16x32_bf16 a[132:135], v[16:19], v[68:71], a[132:135]
  s_nop 0
  ds_read_b128 a[64:67], v4 offset:8192
  v_or3_b32 v5, v5, v86, v87
  v_mfma_f32_16x16x32_bf16 a[136:139], v[16:19], v[72:75], a[136:139]
  s_nop 0
  v_exp_f32 v8, v48
  v_mfma_f32_16x16x32_bf16 a[140:143], v[16:19], v[76:79], a[140:143]
  s_nop 0
  v_exp_f32 v9, v49
  s_waitcnt lgkmcnt(1)
  v_mfma_f32_16x16x32_bf16 v[128:131], a[96:99], v[64:67], v[128:131]
  ds_read_b128 a[68:71], v4 offset:9216
  v_mfma_f32_16x16x32_bf16 v[160:163], a[96:99], v[68:71], v[160:163]
  v_exp_f32 v10, v50
  v_mfma_f32_16x16x32_bf16 v[192:195], a[96:99], v[72:75], v[192:195]
  v_exp_f32 v11, v51
  v_mfma_f32_16x16x32_bf16 v[224:227], a[96:99], v[76:79], v[224:227]
  ds_read_b128 a[72:75], v4 offset:10240
  v_cvt_pk_bf16_f32 v88, v8, v9
  v_mfma_f32_16x16x32_bf16 v[132:135], a[100:103], v[64:67], v[132:135]
  v_cvt_pk_bf16_f32 v89, v10, v11
  v_or3_b32 v5, v5, v88, v89
  v_mfma_f32_16x16x32_bf16 v[164:167], a[100:103], v[68:71], v[164:167]
  v_exp_f32 v12, v52
  v_mfma_f32_16x16x32_bf16 v[196:199], a[100:103], v[72:75], v[196:199]
  ds_read_b128 a[76:79], v4 offset:11264
  v_mfma_f32_16x16x32_bf16 v[228:231], a[100:103], v[76:79], v[228:231]
  v_exp_f32 v13, v53
  v_mfma_f32_16x16x32_bf16 v[136:139], a[104:107], v[64:67], v[136:139]
  v_exp_f32 v14, v54
  v_mfma_f32_16x16x32_bf16 v[168:171], a[104:107], v[68:71], v[168:171]
  ds_read_b128 a[80:83], v4 offset:12288
  v_mfma_f32_16x16x32_bf16 v[200:203], a[104:107], v[72:75], v[200:203]
  v_exp_f32 v15, v55
  v_mfma_f32_16x16x32_bf16 v[232:235], a[104:107], v[76:79], v[232:235]
  v_cvt_pk_bf16_f32 v90, v12, v13
  v_cvt_pk_bf16_f32 v91, v14, v15
  v_mfma_f32_16x16x32_bf16 v[140:143], a[108:111], v[64:67], v[140:143]
  ds_read_b128 a[84:87], v4 offset:13312
  v_or3_b32 v5, v5, v90, v91
  v_mfma_f32_16x16x32_bf16 v[172:175], a[108:111], v[68:71], v[172:175]
  v_exp_f32 v8, v56
  v_mfma_f32_16x16x32_bf16 v[204:207], a[108:111], v[72:75], v[204:207]
  v_exp_f32 v9, v57
  v_mfma_f32_16x16x32_bf16 v[236:239], a[108:111], v[76:79], v[236:239]
  ds_read_b128 a[88:91], v4 offset:14336
  v_mfma_f32_16x16x32_bf16 v[144:147], a[112:115], v[64:67], v[144:147]
  v_exp_f32 v10, v58
  v_mfma_f32_16x16x32_bf16 v[176:179], a[112:115], v[68:71], v[176:179]
  v_exp_f32 v11, v59
  v_mfma_f32_16x16x32_bf16 v[208:211], a[112:115], v[72:75], v[208:211]
  ds_read_b128 a[92:95], v4 offset:15360
  v_cvt_pk_bf16_f32 v92, v8, v9
  v_mfma_f32_16x16x32_bf16 v[240:243], a[112:115], v[76:79], v[240:243]
  v_cvt_pk_bf16_f32 v93, v10, v11
  v_or3_b32 v5, v5, v92, v93
  v_mfma_f32_16x16x32_bf16 v[148:151], a[116:119], v[64:67], v[148:151]
  v_exp_f32 v12, v60
  v_mfma_f32_16x16x32_bf16 v[180:183], a[116:119], v[68:71], v[180:183]
  v_exp_f32 v13, v61
  v_mfma_f32_16x16x32_bf16 v[212:215], a[116:119], v[72:75], v[212:215]
  v_exp_f32 v14, v62
  v_mfma_f32_16x16x32_bf16 v[244:247], a[116:119], v[76:79], v[244:247]
  v_exp_f32 v15, v63
  v_mfma_f32_16x16x32_bf16 v[152:155], a[120:123], v[64:67], v[152:155]
  v_cvt_pk_bf16_f32 v94, v12, v13
  v_cvt_pk_bf16_f32 v95, v14, v15
  v_mfma_f32_16x16x32_bf16 v[184:187], a[120:123], v[68:71], v[184:187]
  v_or3_b32 v5, v5, v94, v95
  v_and_b32 v5, s70, v5
  v_mfma_f32_16x16x32_bf16 v[216:219], a[120:123], v[72:75], v[216:219]
  v_cmp_ne_u32 vcc, 0, v5
  v_add_u32 v4, 0x4000, v4
  v_mfma_f32_16x16x32_bf16 v[248:251], a[120:123], v[76:79], v[248:251]
  v_and_b32 v4, 0x1ffff, v4
  v_mfma_f32_16x16x32_bf16 v[156:159], a[124:127], v[64:67], v[156:159]
  v_mfma_f32_16x16x32_bf16 v[188:191], a[124:127], v[68:71], v[188:191]
  v_mfma_f32_16x16x32_bf16 v[220:223], a[124:127], v[72:75], v[220:223]
  v_mfma_f32_16x16x32_bf16 v[252:255], a[124:127], v[76:79], v[252:255]
  s_cbranch_vccnz L_a_s0_t
L_a_s0_r:
  s_cmp_eq_u32 s58, s59
  s_cbranch_scc0 L_a_s1
  v_cmp_gt_i32 s[80:81], 0, v25
  v_cmp_gt_i32 s[82:83], 1, v25
  v_cmp_gt_i32 s[84:85], 2, v25
  v_cmp_gt_i32 s[86:87], 3, v25
  v_cndmask_b32 v96, v96, v24, s[80:81]
  v_cndmask_b32 v97, v97, v24, s[82:83]
  v_cndmask_b32 v98, v98, v24, s[84:85]
  v_cndmask_b32 v99, v99, v24, s[86:87]
  v_cmp_gt_i32 s[80:81], 16, v25
  v_cmp_gt_i32 s[82:83], 17, v25
  v_cmp_gt_i32 s[84:85], 18, v25
  v_cmp_gt_i32 s[86:87], 19, v25
  v_cndmask_b32 v100, v100, v24, s[80:81]
  v_cndmask_b32 v101, v101, v24, s[82:83]
  v_cndmask_b32 v102, v102, v24, s[84:85]
  v_cndmask_b32 v103, v103, v24, s[86:87]
  s_nop 0
L_a_d0:
  s_waitcnt vmcnt(24) lgkmcnt(0)
  v_mfma_f32_16x16x32_bf16 v[32:35], a[64:67], a[0:3], v[96:99]
  s_barrier
  ds_read_b128 a[96:99], v4 offset:0
  v_mfma_f32_16x16x32_bf16 v[32:35], a[72:75], a[4:7], v[32:35]
  s_nop 0
  ds_read_b128 a[100:103], v4 offset:1024
  v_mfma_f32_16x16x32_bf16 v[32:35], a[80:83], a[8:11], v[32:35]
  s_nop 0
  ds_read_b128 a[104:107], v4 offset:2048
  v_mfma_f32_16x16x32_bf16 v[32:35], a[88:91], a[12:15], v[32:35]
  s_nop 0
  ds_read_b128 a[108:111], v4 offset:3072
  v_mfma_f32_16x16x32_bf16 v[36:39], a[68:71], a[0:3], v[100:103]
  s_nop 0
  ds_read_b128 a[112:115], v4 offset:4096
  v_mfma_f32_16x16x32_bf16 v[36:39], a[76:79], a[4:7], v[36:39]
  s_nop 0
  ds_read_b128 a[116:119], v4 offset:5120
  v_mfma_f32_16x16x32_bf16 v[36:39], a[84:87], a[8:11], v[36:39]
  s_nop 0
  ds_read_b128 a[120:123], v4 offset:6144
  v_mfma_f32_16x16x32_bf16 v[36:39], a[92:95], a[12:15], v[36:39]
  s_nop 0
  ds_read_b128 a[124:127], v4 offset:7168
  v_mfma_f32_16x16x32_bf16 v[40:43], a[64:67], a[16:19], v[104:107]
  s_nop 0
  v_exp_f32 v8, v32
  v_mfma_f32_16x16x32_bf16 v[40:43], a[72:75], a[20:23], v[40:43]
  s_nop 0
  v_exp_f32 v9, v33
  v_mfma_f32_16x16x32_bf16 v[40:43], a[80:83], a[24:27], v[40:43]
  s_nop 0
  v_exp_f32 v10, v34
  v_mfma_f32_16x16x32_bf16 v[40:43], a[88:91], a[28:31], v[40:43]
  s_nop 0
  v_exp_f32 v11, v35
  v_mfma_f32_16x16x32_bf16 v[44:47], a[68:71], a[16:19], v[108:111]
  s_nop 0
  v_cvt_pk_bf16_f32 v64, v8, v9
  v_cvt_pk_bf16_f32 v65, v10, v11
  v_mfma_f32_16x16x32_bf16 v[44:47], a[76:79], a[20:23], v[44:47]
  s_nop 0
  v_or_b32 v5, v64, v65
  v_mfma_f32_16x16x32_bf16 v[44:47], a[84:87], a[24:27], v[44:47]
  s_nop 0
  v_exp_f32 v12, v36
  v_mfma_f32_16x16x32_bf16 v[44:47], a[92:95], a[28:31], v[44:47]
  s_nop 0
  v_exp_f32 v13, v37
  v_mfma_f32_16x16x32_bf16 v[48:51], a[64:67], a[32:35], v[112:115]
  s_nop 0
  v_exp_f32 v14, v38
  v_mfma_f32_16x16x32_bf16 v[48:51], a[72:75], a[36:39], v[48:51]
  s_nop 0
  v_exp_f32 v15, v39
  v_mfma_f32_16x16x32_bf16 v[48:51], a[80:83], a[40:43], v[48:51]
  s_nop 0
  v_cvt_pk_bf16_f32 v66, v12, v13
  v_cvt_pk_bf16_f32 v67, v14, v15
  v_mfma_f32_16x16x32_bf16 v[48:51], a[88:91], a[44:47], v[48:51]
  s_add_u32 m0, s64, s65
  s_nop 0
  buffer_load_dwordx4 v3, s[40:43], s61 offen sc1 lds
  v_or3_b32 v5, v5, v66, v67
  v_mfma_f32_16x16x32_bf16 v[52:55], a[68:71], a[32:35], v[116:119]
  s_nop 0
  v_exp_f32 v8, v40
  v_mfma_f32_16x16x32_bf16 v[52:55], a[76:79], a[36:39], v[52:55]
  s_nop 0
  v_exp_f32 v9, v41
  v_mfma_f32_16x16x32_bf16 v[52:55], a[84:87], a[40:43], v[52:55]
  s_min_u32 s66, s62, s63
  buffer_load_dwordx4 v3, s[40:43], s61 offen offset:1024 sc1 lds
  v_mfma_f32_16x16x32_bf16 v[52:55], a[92:95], a[44:47], v[52:55]
  s_nop 0
  v_exp_f32 v10, v42
  v_mfma_f32_16x16x32_bf16 v[56:59], a[64:67], a[48:51], v[120:123]
  s_nop 0
  v_exp_f32 v11, v43
  v_mfma_f32_16x16x32_bf16 v[56:59], a[72:75], a[52:55], v[56:59]
  s_add_u32 m0, m0, 0x2000
  s_nop 0
  buffer_load_dwordx4 v3, s[40:43], s66 offen sc1 lds
  v_cvt_pk_bf16_f32 v68, v8, v9
  v_mfma_f32_16x16x32_bf16 v[56:59], a[80:83], a[56:59], v[56:59]
  s_nop 0
  v_cvt_pk_bf16_f32 v69, v10, v11
  v_or3_b32 v5, v5, v68, v69
  v_mfma_f32_16x16x32_bf16 v[56:59], a[88:91], a[60:63], v[56:59]
  s_nop 0
  v_exp_f32 v12, v44
  v_mfma_f32_16x16x32_bf16 v[60:63], a[68:71], a[48:51], v[124:127]
  s_add_u32 s61, s61, 0x2000
  buffer_load_dwordx4 v3, s[40:43], s66 offen offset:1024 sc1 lds
  v_mfma_f32_16x16x32_bf16 v[60:63], a[76:79], a[52:55], v[60:63]
  s_add_u32 s62, s62, 0x2000
  v_exp_f32 v13, v45
  v_mfma_f32_16x16x32_bf16 v[60:63], a[84:87], a[56:59], v[60:63]
  s_add_u32 s64, s64, 0x4000
  v_exp_f32 v14, v46
  v_mfma_f32_16x16x32_bf16 v[60:63], a[92:95], a[60:63], v[60:63]
  s_and_b32 s64, s64, 0x1ffff
  v_exp_f32 v15, v47
  v_mfma_f32_16x16x32_bf16 a[128:131], v[16:19], v[80:83], a[128:131]
  s_add_u32 s58, s58, 1
  v_cvt_pk_bf16_f32 v70, v12, v13
  v_cvt_pk_bf16_f32 v71, v14, v15
  v_mfma_f32_16x16x32_bf16 a[132:135], v[16:19], v[84:87], a[132:135]
  s_nop 0
  ds_read_b128 a[64:67], v4 offset:8192
  v_or3_b32 v5, v5, v70, v71
  v_mfma_f32_16x16x32_bf16 a[136:139], v[16:19], v[88:91], a[136:139]
  s_nop 0
  v_exp_f32 v8, v48
  v_mfma_f32_16x16x32_bf16 a[140:143], v[16:19], v[92:95], a[140:143]
  s_nop 0
  v_exp_f32 v9, v49
  s_waitcnt lgkmcnt(1)
  v_mfma_f32_16x16x32_bf16 v[128:131], a[96:99], v[80:83], v[128:131]
  ds_read_b128 a[68:71], v4 offset:9216
  v_mfma_f32_16x16x32_bf16 v[160:163], a[96:99], v[84:87], v[160:163]
  v_exp_f32 v10, v50
  v_mfma_f32_16x16x32_bf16 v[192:195], a[96:99], v[88:91], v[192:195]
  v_exp_f32 v11, v51
  v_mfma_f32_16x16x32_bf16 v[224:227], a[96:99], v[92:95], v[224:227]
  ds_read_b128 a[72:75], v4 offset:10240
  v_cvt_pk_bf16_f32 v72, v8, v9
  v_mfma_f32_16x16x32_bf16 v[132:135], a[100:103], v[80:83], v[132:135]
  v_cvt_pk_bf16_f32 v73, v10, v11
  v_or3_b32 v5, v5, v72, v73
  v_mfma_f32_16x16x32_bf16 v[164:167], a[100:103], v[84:87], v[164:167]
  v_exp_f32 v12, v52
  v_mfma_f32_16x16x32_bf16 v[196:199], a[100:103], v[88:91], v[196:199]
  ds_read_b128 a[76:79], v4 offset:11264
  v_mfma_f32_16x16x32_bf16 v[228:231], a[100:103], v[92:95], v[228:231]
  v_exp_f32 v13, v53
  v_mfma_f32_16x16x32_bf16 v[136:139], a[104:107], v[80:83], v[136:139]
  v_exp_f32 v14, v54
  v_mfma_f32_16x16x32_bf16 v[168:171], a[104:107], v[84:87], v[168:171]
  ds_read_b128 a[80:83], v4 offset:12288
  v_mfma_f32_16x16x32_bf16 v[200:203], a[104:107], v[88:91], v[200:203]
  v_exp_f32 v15, v55
  v_mfma_f32_16x16x32_bf16 v[232:235], a[104:107], v[92:95], v[232:235]
  v_cvt_pk_bf16_f32 v74, v12, v13
  v_cvt_pk_bf16_f32 v75, v14, v15
  v_mfma_f32_16x16x32_bf16 v[140:143], a[108:111], v[80:83], v[140:143]
  ds_read_b128 a[84:87], v4 offset:13312
  v_or3_b32 v5, v5, v74, v75
  v_mfma_f32_16x16x32_bf16 v[172:175], a[108:111], v[84:87], v[172:175]
  v_exp_f32 v8, v56
  v_mfma_f32_16x16x32_bf16 v[204:207], a[108:111], v[88:91], v[204:207]
  v_exp_f32 v9, v57
  v_mfma_f32_16x16x32_bf16 v[236:239], a[108:111], v[92:95], v[236:239]
  ds_read_b128 a[88:91], v4 offset:14336
  v_mfma_f32_16x16x32_bf16 v[144:147], a[112:115], v[80:83], v[144:147]
  v_exp_f32 v10, v58
  v_mfma_f32_16x16x32_bf16 v[176:179], a[112:115], v[84:87], v[176:179]
  v_exp_f32 v11, v59
  v_mfma_f32_16x16x32_bf16 v[208:211], a[112:115], v[88:91], v[208:211]
  ds_read_b128 a[92:95], v4 offset:15360
  v_cvt_pk_bf16_f32 v76, v8, v9
  v_mfma_f32_16x16x32_bf16 v[240:243], a[112:115], v[92:95], v[240:243]
  v_cvt_pk_bf16_f32 v77, v10, v11
  v_or3_b32 v5, v5, v76, v77
  v_mfma_f32_16x16x32_bf16 v[148:151], a[116:119], v[80:83], v[148:151]
  v_exp_f32 v12, v60
  v_mfma_f32_16x16x32_bf16 v[180:183], a[116:119], v[84:87], v[180:183]
  v_exp_f32 v13, v61
  v_mfma_f32_16x16x32_bf16 v[212:215], a[116:119], v[88:91], v[212:215]
  v_exp_f32 v14, v62
  v_mfma_f32_16x16x32_bf16 v[244:247], a[116:119], v[92:95], v[244:247]
  v_exp_f32 v15, v63
  v_mfma_f32_16x16x32_bf16 v[152:155], a[120:123], v[80:83], v[152:155]
  v_cvt_pk_bf16_f32 v78, v12, v13
  v_cvt_pk_bf16_f32 v79, v14, v15
  v_mfma_f32_16x16x32_bf16 v[184:187], a[120:123], v[84:87], v[184:187]
  v_or3_b32 v5, v5, v78, v79
  v_and_b32 v5, s70, v5
  v_mfma_f32_16x16x32_bf16 v[216:219], a[120:123], v[88:91], v[216:219]
  v_cmp_ne_u32 vcc, 0, v5
  v_cmp_gt_i32 s[80:81], 32, v25
  v_mfma_f32_16x16x32_bf16 v[248:251], a[120:123], v[92:95], v[248:251]
  v_cmp_gt_i32 s[82:83], 33, v25
  v_cmp_gt_i32 s[84:85], 34, v25
  v_mfma_f32_16x16x32_bf16 v[156:159], a[124:127], v[80:83], v[156:159]
  v_cmp_gt_i32 s[86:87], 35, v25
  v_cndmask_b32 v96, v96, v24, s[80:81]
  v_mfma_f32_16x16x32_bf16 v[188:191], a[124:127], v[84:87], v[188:191]
  v_cndmask_b32 v97, v97, v24, s[82:83]
  v_cndmask_b32 v98, v98, v24, s[84:85]
  v_mfma_f32_16x16x32_bf16 v[220:223], a[124:127], v[88:91], v[220:223]
  v_cndmask_b32 v99, v99, v24, s[86:87]
  v_cmp_gt_i32 s[80:81], 48, v25
  v_mfma_f32_16x16x32_bf16 v[252:255], a[124:127], v[92:95], v[252:255]
  v_cmp_gt_i32 s[82:83], 49, v25
  v_cmp_gt_i32 s[84:85], 50, v25
  v_cmp_gt_i32 s[86:87], 51, v25
  v_cndmask_b32 v100, v100, v24, s[80:81]
  v_cndmask_b32 v101, v101, v24, s[82:83]
  v_cndmask_b32 v102, v102, v24, s[84:85]
  v_cndmask_b32 v103, v103, v24, s[86:87]
  v_add_u32 v4, 0x4000, v4
  v_and_b32 v4, 0x1ffff, v4
  s_cbranch_vccnz L_a_d0_t
L_a_d0_r:
L_a_d1:
  s_waitcnt vmcnt(24) lgkmcnt(0)
  v_mfma_f32_16x16x32_bf16 v[32:35], a[64:67], a[0:3], v[96:99]
  s_barrier
  ds_read_b128 a[96:99], v4 offset:0
  v_mfma_f32_16x16x32_bf16 v[32:35], a[72:75], a[4:7], v[32:35]
  s_nop 0
  ds_read_b128 a[100:103], v4 offset:1024
  v_mfma_f32_16x16x32_bf16 v[32:35], a[80:83], a[8:11], v[32:35]
  s_nop 0
  ds_read_b128 a[104:107], v4 offset:2048
  v_mfma_f32_16x16x32_bf16 v[32:35], a[88:91], a[12:15], v[32:35]
  s_nop 0
  ds_read_b128 a[108:111], v4 offset:3072
  v_mfma_f32_16x16x32_bf16 v[36:39], a[68:71], a[0:3], v[100:103]
  s_nop 0
  ds_read_b128 a[112:115], v4 offset:4096
  v_mfma_f32_16x16x32_bf16 v[36:39], a[76:79], a[4:7], v[36:39]
  s_nop 0
  ds_read_b128 a[116:119], v4 offset:5120
  v_mfma_f32_16x16x32_bf16 v[36:39], a[84:87], a[8:11], v[36:39]
  s_nop 0
  ds_read_b128 a[120:123], v4 offset:6144
  v_mfma_f32_16x16x32_bf16 v[36:39], a[92:95], a[12:15], v[36:39]
  s_nop 0
  ds_read_b128 a[124:127], v4 offset:7168
  v_mfma_f32_16x16x32_bf16 v[40:43], a[64:67], a[16:19], v[104:107]
  s_nop 0
  v_exp_f32 v8, v32
  v_mfma_f32_16x16x32_bf16 v[40:43], a[72:75], a[20:23], v[40:43]
  s_nop 0
  v_exp_f32 v9, v33
  v_mfma_f32_16x16x32_bf16 v[40:43], a[80:83], a[24:27], v[40:43]
  s_nop 0
  v_exp_f32 v10, v34
  v_mfma_f32_16x16x32_bf16 v[40:43], a[88:91], a[28:31], v[40:43]
  s_nop 0
  v_exp_f32 v11, v35
  v_mfma_f32_16x16x32_bf16 v[44:47], a[68:71], a[16:19], v[108:111]
  s_nop 0
  v_cvt_pk_bf16_f32 v80, v8, v9
  v_cvt_pk_bf16_f32 v81, v10, v11
  v_mfma_f32_16x16x32_bf16 v[44:47], a[76:79], a[20:23], v[44:47]
  s_nop 0
  v_or_b32 v5, v80, v81
  v_mfma_f32_16x16x32_bf16 v[44:47], a[84:87], a[24:27], v[44:47]
  s_nop 0
  v_exp_f32 v12, v36
  v_mfma_f32_16x16x32_bf16 v[44:47], a[92:95], a[28:31], v[44:47]
  s_nop 0
  v_exp_f32 v13, v37
  v_mfma_f32_16x16x32_bf16 v[48:51], a[64:67], a[32:35], v[112:115]
  s_nop 0
  v_exp_f32 v14, v38
  v_mfma_f32_16x16x32_bf16 v[48:51], a[72:75], a[36:39], v[48:51]
  s_nop 0
  v_exp_f32 v15, v39
  v_mfma_f32_16x16x32_bf16 v[48:51], a[80:83], a[40:43], v[48:51]
  s_nop 0
  v_cvt_pk_bf16_f32 v82, v12, v13
  v_cvt_pk_bf16_f32 v83, v14, v15
  v_mfma_f32_16x16x32_bf16 v[48:51], a[88:91], a[44:47], v[48:51]
  s_add_u32 m0, s64, s65
  s_nop 0
  buffer_load_dwordx4 v3, s[40:43], s61 offen sc1 lds
  v_or3_b32 v5, v5, v82, v83
  v_mfma_f32_16x16x32_bf16 v[52:55], a[68:71], a[32:35], v[116:119]
  s_nop 0
  v_exp_f32 v8, v40
  v_mfma_f32_16x16x32_bf16 v[52:55], a[76:79], a[36:39], v[52:55]
  s_nop 0
  v_exp_f32 v9, v41
  v_mfma_f32_16x16x32_bf16 v[52:55], a[84:87], a[40:43], v[52:55]
  s_min_u32 s66, s62, s63
  buffer_load_dwordx4 v3, s[40:43], s61 offen offset:1024 sc1 lds
  v_mfma_f32_16x16x32_bf16 v[52:55], a[92:95], a[44:47], v[52:55]
  s_nop 0
  v_exp_f32 v10, v42
  v_mfma_f32_16x16x32_bf16 v[56:59], a[64:67], a[48:51], v[120:123]
  s_nop 0
  v_exp_f32 v11, v43
  v_mfma_f32_16x16x32_bf16 v[56:59], a[72:75], a[52:55], v[56:59]
  s_add_u32 m0, m0, 0x2000
  s_nop 0
  buffer_load_dwordx4 v3, s[40:43], s66 offen sc1 lds
  v_cvt_pk_bf16_f32 v84, v8, v9
  v_mfma_f32_16x16x32_bf16 v[56:59], a[80:83], a[56:59], v[56:59]
  s_nop 0
  v_cvt_pk_bf16_f32 v85, v10, v11
  v_or3_b32 v5, v5, v84, v85
  v_mfma_f32_16x16x32_bf16 v[56:59], a[88:91], a[60:63], v[56:59]
  s_nop 0
  v_exp_f32 v12, v44
  v_mfma_f32_16x16x32_bf16 v[60:63], a[68:71], a[48:51], v[124:127]
  s_add_u32 s61, s61, 0x2000
  buffer_load_dwordx4 v3, s[40:43], s66 offen offset:1024 sc1 lds
  v_mfma_f32_16x16x32_bf16 v[60:63], a[76:79], a[52:55], v[60:63]
  s_add_u32 s62, s62, 0x2000
  v_exp_f32 v13, v45
  v_mfma_f32_16x16x32_bf16 v[60:63], a[84:87], a[56:59], v[60:63]
  s_add_u32 s64, s64, 0x4000
  v_exp_f32 v14, v46
  v_mfma_f32_16x16x32_bf16 v[60:63], a[92:95], a[60:63], v[60:63]
  s_and_b32 s64, s64, 0x1ffff
  v_exp_f32 v15, v47
  v_mfma_f32_16x16x32_bf16 a[128:131], v[16:19], v[64:67], a[128:131]
  s_add_u32 s58, s58, 1
  v_cvt_pk_bf16_f32 v86, v12, v13
  v_cvt_pk_bf16_f32 v87, v14, v15
  v_mfma_f32_16x16x32_bf16 a[132:135], v[16:19], v[68:71], a[132:135]
  s_nop 0
  ds_read_b128 a[64:67], v4 offset:8192
  v_or3_b32 v5, v5, v86, v87
  v_mfma_f32_16x16x32_bf16 a[136:139], v[16:19], v[72:75], a[136:139]
  s_nop 0
  v_exp_f32 v8, v48
  v_mfma_f32_16x16x32_bf16 a[140:143], v[16:19], v[76:79], a[140:143]
  s_nop 0
  v_exp_f32 v9, v49
  s_waitcnt lgkmcnt(1)
  v_mfma_f32_16x16x32_bf16 v[128:131], a[96:99], v[64:67], v[128:131]
  ds_read_b128 a[68:71], v4 offset:9216
  v_mfma_f32_16x16x32_bf16 v[160:163], a[96:99], v[68:71], v[160:163]
  v_exp_f32 v10, v50
  v_mfma_f32_16x16x32_bf16 v[192:195], a[96:99], v[72:75], v[192:195]
  v_exp_f32 v11, v51
  v_mfma_f32_16x16x32_bf16 v[224:227], a[96:99], v[76:79], v[224:227]
  ds_read_b128 a[72:75], v4 offset:10240
  v_cvt_pk_bf16_f32 v88, v8, v9
  v_mfma_f32_16x16x32_bf16 v[132:135], a[100:103], v[64:67], v[132:135]
  v_cvt_pk_bf16_f32 v89, v10, v11
  v_or3_b32 v5, v5, v88, v89
  v_mfma_f32_16x16x32_bf16 v[164:167], a[100:103], v[68:71], v[164:167]
  v_exp_f32 v12, v52
  v_mfma_f32_16x16x32_bf16 v[196:199], a[100:103], v[72:75], v[196:199]
  ds_read_b128 a[76:79], v4 offset:11264
  v_mfma_f32_16x16x32_bf16 v[228:231], a[100:103], v[76:79], v[228:231]
  v_exp_f32 v13, v53
  v_mfma_f32_16x16x32_bf16 v[136:139], a[104:107], v[64:67], v[136:139]
  v_exp_f32 v14, v54
  v_mfma_f32_16x16x32_bf16 v[168:171], a[104:107], v[68:71], v[168:171]
  ds_read_b128 a[80:83], v4 offset:12288
  v_mfma_f32_16x16x32_bf16 v[200:203], a[104:107], v[72:75], v[200:203]
  v_exp_f32 v15, v55
  v_mfma_f32_16x16x32_bf16 v[232:235], a[104:107], v[76:79], v[232:235]
  v_cvt_pk_bf16_f32 v90, v12, v13
  v_cvt_pk_bf16_f32 v91, v14, v15
  v_mfma_f32_16x16x32_bf16 v[140:143], a[108:111], v[64:67], v[140:143]
  ds_read_b128 a[84:87], v4 offset:13312
  v_or3_b32 v5, v5, v90, v91
  v_mfma_f32_16x16x32_bf16 v[172:175], a[108:111], v[68:71], v[172:175]
  v_exp_f32 v8, v56
  v_mfma_f32_16x16x32_bf16 v[204:207], a[108:111], v[72:75], v[204:207]
  v_exp_f32 v9, v57
  v_mfma_f32_16x16x32_bf16 v[236:239], a[108:111], v[76:79], v[236:239]
  ds_read_b128 a[88:91], v4 offset:14336
  v_mfma_f32_16x16x32_bf16 v[144:147], a[112:115], v[64:67], v[144:147]
  v_exp_f32 v10, v58
  v_mfma_f32_16x16x32_bf16 v[176:179], a[112:115], v[68:71], v[176:179]
  v_exp_f32 v11, v59
  v_mfma_f32_16x16x32_bf16 v[208:211], a[112:115], v[72:75], v[208:211]
  ds_read_b128 a[92:95], v4 offset:15360
  v_cvt_pk_bf16_f32 v92, v8, v9
  v_mfma_f32_16x16x32_bf16 v[240:243], a[112:115], v[76:79], v[240:243]
  v_cvt_pk_bf16_f32 v93, v10, v11
  v_or3_b32 v5, v5, v92, v93
  v_mfma_f32_16x16x32_bf16 v[148:151], a[116:119], v[64:67], v[148:151]
  v_exp_f32 v12, v60
  v_mfma_f32_16x16x32_bf16 v[180:183], a[116:119], v[68:71], v[180:183]
  v_exp_f32 v13, v61
  v_mfma_f32_16x16x32_bf16 v[212:215], a[116:119], v[72:75], v[212:215]
  v_exp_f32 v14, v62
  v_mfma_f32_16x16x32_bf16 v[244:247], a[116:119], v[76:79], v[244:247]
  v_exp_f32 v15, v63
  v_mfma_f32_16x16x32_bf16 v[152:155], a[120:123], v[64:67], v[152:155]
  v_cvt_pk_bf16_f32 v94, v12, v13
  v_cvt_pk_bf16_f32 v95, v14, v15
  v_mfma_f32_16x16x32_bf16 v[184:187], a[120:123], v[68:71], v[184:187]
  v_or3_b32 v5, v5, v94, v95
  v_and_b32 v5, s70, v5
  v_mfma_f32_16x16x32_bf16 v[216:219], a[120:123], v[72:75], v[216:219]
  v_cmp_ne_u32 vcc, 0, v5
  v_cmp_gt_i32 s[80:81], 0, v25
  v_mfma_f32_16x16x32_bf16 v[248:251], a[120:123], v[76:79], v[248:251]
  v_cmp_gt_i32 s[82:83], 1, v25
  v_cmp_gt_i32 s[84:85], 2, v25
  v_mfma_f32_16x16x32_bf16 v[156:159], a[124:127], v[64:67], v[156:159]
  v_cmp_gt_i32 s[86:87], 3, v25
  v_cndmask_b32 v104, v104, v24, s[80:81]
  v_mfma_f32_16x16x32_bf16 v[188:191], a[124:127], v[68:71], v[188:191]
  v_cndmask_b32 v105, v105, v24, s[82:83]
  v_cndmask_b32 v106, v106, v24, s[84:85]
  v_mfma_f32_16x16x32_bf16 v[220:223], a[124:127], v[72:75], v[220:223]
  v_cndmask_b32 v107, v107, v24, s[86:87]
  v_cmp_gt_i32 s[80:81], 16, v25
  v_mfma_f32_16x16x32_bf16 v[252:255], a[124:127], v[76:79], v[252:255]
  v_cmp_gt_i32 s[82:83], 17, v25
  v_cmp_gt_i32 s[84:85], 18, v25
  v_cmp_gt_i32 s[86:87], 19, v25
  v_cndmask_b32 v108, v108, v24, s[80:81]
  v_cndmask_b32 v109, v109, v24, s[82:83]
  v_cndmask_b32 v110, v110, v24, s[84:85]
  v_cndmask_b32 v111, v111, v24, s[86:87]
  v_add_u32 v4, 0x4000, v4
  v_and_b32 v4, 0x1ffff, v4
  s_cbranch_vccnz L_a_d1_t
L_a_d1_r:
L_a_d2:
  s_waitcnt vmcnt(24) lgkmcnt(0)
  v_mfma_f32_16x16x32_bf16 v[40:43], a[64:67], a[16:19], v[104:107]
  s_barrier
  ds_read_b128 a[96:99], v4 offset:0
  v_mfma_f32_16x16x32_bf16 v[40:43], a[72:75], a[20:23], v[40:43]
  s_nop 0
  ds_read_b128 a[100:103], v4 offset:1024
  v_mfma_f32_16x16x32_bf16 v[40:43], a[80:83], a[24:27], v[40:43]
  s_nop 0
  ds_read_b128 a[104:107], v4 offset:2048
  v_mfma_f32_16x16x32_bf16 v[40:43], a[88:91], a[28:31], v[40:43]
  s_nop 0
  ds_read_b128 a[108:111], v4 offset:3072
  v_mfma_f32_16x16x32_bf16 v[44:47], a[68:71], a[16:19], v[108:111]
  s_nop 0
  ds_read_b128 a[112:115], v4 offset:4096
  v_mfma_f32_16x16x32_bf16 v[44:47], a[76:79], a[20:23], v[44:47]
  s_nop 0
  ds_read_b128 a[116:119], v4 offset:5120
  v_mfma_f32_16x16x32_bf16 v[44:47], a[84:87], a[24:27], v[44:47]
  s_nop 0
  ds_read_b128 a[120:123], v4 offset:6144
  v_mfma_f32_16x16x32_bf16 v[44:47], a[92:95], a[28:31], v[44:47]
  s_nop 0
  ds_read_b128 a[124:127], v4 offset:7168
  v_mfma_f32_16x16x32_bf16 v[48:51], a[64:67], a[32:35], v[112:115]
  s_add_u32 m0, s73, 0
  s_add_u32 s66, s72, 0
  buffer_load_dwordx4 v26, s[48:51], s66 offen lds
  v_mfma_f32_16x16x32_bf16 v[48:51], a[72:75], a[36:39], v[48:51]
  s_add_u32 m0, s73, 1024
  s_add_u32 s66, s72, 8192
  buffer_load_dwordx4 v26, s[48:51], s66 offen lds
  v_mfma_f32_16x16x32_bf16 v[48:51], a[80:83], a[40:43], v[48:51]
  s_add_u32 m0, s73, 2048
  s_add_u32 s66, s72, 16384
  buffer_load_dwordx4 v26, s[48:51], s66 offen lds
  v_mfma_f32_16x16x32_bf16 v[48:51], a[88:91], a[44:47], v[48:51]
  s_add_u32 m0, s73, 3072
  s_add_u32 s66, s72, 24576
  buffer_load_dwordx4 v26, s[48:51], s66 offen lds
  v_mfma_f32_16x16x32_bf16 v[52:55], a[68:71], a[32:35], v[116:119]
  s_add_u32 s58, s58, 1
  v_exp_f32 v8, v40
  v_mfma_f32_16x16x32_bf16 v[52:55], a[76:79], a[36:39], v[52:55]
  s_nop 0
  v_exp_f32 v9, v41
  v_mfma_f32_16x16x32_bf16 v[52:55], a[84:87], a[40:43], v[52:55]
  s_nop 0
  v_exp_f32 v10, v42
  v_mfma_f32_16x16x32_bf16 v[52:55], a[92:95], a[44:47], v[52:55]
  s_nop 0
  v_exp_f32 v11, v43
  v_mfma_f32_16x16x32_bf16 v[56:59], a[64:67], a[48:51], v[120:123]
  s_nop 0
  v_cvt_pk_bf16_f32 v68, v8, v9
  v_cvt_pk_bf16_f32 v69, v10, v11
  v_mfma_f32_16x16x32_bf16 v[56:59], a[72:75], a[52:55], v[56:59]
  s_nop 0
  v_or_b32 v5, v68, v69
  v_mfma_f32_16x16x32_bf16 v[56:59], a[80:83], a[56:59], v[56:59]
  s_nop 0
  v_exp_f32 v12, v44
  v_mfma_f32_16x16x32_bf16 v[56:59], a[88:91], a[60:63], v[56:59]
  s_nop 0
  v_exp_f32 v13, v45
  v_mfma_f32_16x16x32_bf16 v[60:63], a[68:71], a[48:51], v[124:127]
  s_nop 0
  v_exp_f32 v14, v46
  v_mfma_f32_16x16x32_bf16 v[60:63], a[76:79], a[52:55], v[60:63]
  s_nop 0
  v_exp_f32 v15, v47
  v_mfma_f32_16x16x32_bf16 v[60:63], a[84:87], a[56:59], v[60:63]
  s_nop 0
  v_cvt_pk_bf16_f32 v70, v12, v13
  v_cvt_pk_bf16_f32 v71, v14, v15
  v_mfma_f32_16x16x32_bf16 v[60:63], a[92:95], a[60:63], v[60:63]
  s_nop 0
  v_or3_b32 v5, v5, v70, v71
  v_mfma_f32_16x16x32_bf16 a[128:131], v[16:19], v[80:83], a[128:131]
  s_nop 0
  v_exp_f32 v8, v48
  v_mfma_f32_16x16x32_bf16 a[132:135], v[16:19], v[84:87], a[132:135]
  s_nop 0
  ds_read_b128 a[64:67], v4 offset:8192
  v_mfma_f32_16x16x32_bf16 a[136:139], v[16:19], v[88:91], a[136:139]
  s_nop 0
  v_exp_f32 v9, v49
  v_mfma_f32_16x16x32_bf16 a[140:143], v[16:19], v[92:95], a[140:143]
  s_nop 0
  v_exp_f32 v10, v50
  s_waitcnt lgkmcnt(1)
  v_mfma_f32_16x16x32_bf16 v[128:131], a[96:99], v[80:83], v[128:131]
  ds_read_b128 a[68:71], v4 offset:9216
  v_mfma_f32_16x16x32_bf16 v[160:163], a[96:99], v[84:87], v[160:163]
  v_exp_f32 v11, v51
  v_mfma_f32_16x16x32_bf16 v[192:195], a[96:99], v[88:91], v[192:195]
  v_cvt_pk_bf16_f32 v72, v8, v9
  v_cvt_pk_bf16_f32 v73, v10, v11
  v_mfma_f32_16x16x32_bf16 v[224:227], a[96:99], v[92:95], v[224:227]
  ds_read_b128 a[72:75], v4 offset:10240
  v_or3_b32 v5, v5, v72, v73
  v_mfma_f32_16x16x32_bf16 v[132:135], a[100:103], v[80:83], v[132:135]
  v_exp_f32 v12, v52
  v_mfma_f32_16x16x32_bf16 v[164:167], a[100:103], v[84:87], v[164:167]
  v_exp_f32 v13, v53
  v_mfma_f32_16x16x32_bf16 v[196:199], a[100:103], v[88:91], v[196:199]
  ds_read_b128 a[76:79], v4 offset:11264
  v_mfma_f32_16x16x32_bf16 v[228:231], a[100:103], v[92:95], v[228:231]
  v_exp_f32 v14, v54
  v_mfma_f32_16x16x32_bf16 v[136:139], a[104:107], v[80:83], v[136:139]
  v_exp_f32 v15, v55
  v_mfma_f32_16x16x32_bf16 v[168:171], a[104:107], v[84:87], v[168:171]
  ds_read_b128 a[80:83], v4 offset:12288
  v_cvt_pk_bf16_f32 v74, v12, v13
  v_mfma_f32_16x16x32_bf16 v[200:203], a[104:107], v[88:91], v[200:203]
  v_cvt_pk_bf16_f32 v75, v14, v15
  v_or3_b32 v5, v5, v74, v75
  v_mfma_f32_16x16x32_bf16 v[232:235], a[104:107], v[92:95], v[232:235]
  v_exp_f32 v8, v56
  v_mfma_f32_16x16x32_bf16 v[140:143], a[108:111], v[80:83], v[140:143]
  ds_read_b128 a[84:87], v4 offset:13312
  v_mfma_f32_16x16x32_bf16 v[172:175], a[108:111], v[84:87], v[172:175]
  v_exp_f32 v9, v57
  v_mfma_f32_16x16x32_bf16 v[204:207], a[108:111], v[88:91], v[204:207]
  v_exp_f32 v10, v58
  v_mfma_f32_16x16x32_bf16 v[236:239], a[108:111], v[92:95], v[236:239]
  ds_read_b128 a[88:91], v4 offset:14336
  v_mfma_f32_16x16x32_bf16 v[144:147], a[112:115], v[80:83], v[144:147]
  v_exp_f32 v11, v59
  v_mfma_f32_16x16x32_bf16 v[176:179], a[112:115], v[84:87], v[176:179]
  v_cvt_pk_bf16_f32 v76, v8, v9
  v_cvt_pk_bf16_f32 v77, v10, v11
  v_mfma_f32_16x16x32_bf16 v[208:211], a[112:115], v[88:91], v[208:211]
  ds_read_b128 a[92:95], v4 offset:15360
  v_or3_b32 v5, v5, v76, v77
  v_mfma_f32_16x16x32_bf16 v[240:243], a[112:115], v[92:95], v[240:243]
  v_exp_f32 v12, v60
  v_mfma_f32_16x16x32_bf16 v[148:151], a[116:119], v[80:83], v[148:151]
  v_exp_f32 v13, v61
  v_mfma_f32_16x16x32_bf16 v[180:183], a[116:119], v[84:87], v[180:183]
  v_exp_f32 v14, v62
  v_mfma_f32_16x16x32_bf16 v[212:215], a[116:119], v[88:91], v[212:215]
  v_exp_f32 v15, v63
  v_mfma_f32_16x16x32_bf16 v[244:247], a[116:119], v[92:95], v[244:247]
  v_cvt_pk_bf16_f32 v78, v12, v13
  v_cvt_pk_bf16_f32 v79, v14, v15
  v_mfma_f32_16x16x32_bf16 v[152:155], a[120:123], v[80:83], v[152:155]
  v_or3_b32 v5, v5, v78, v79
  v_and_b32 v5, s70, v5
  v_mfma_f32_16x16x32_bf16 v[184:187], a[120:123], v[84:87], v[184:187]
  v_cmp_ne_u32 vcc, 0, v5
  v_cmp_gt_i32 s[80:81], 32, v25
  v_mfma_f32_16x16x32_bf16 v[216:219], a[120:123], v[88:91], v[216:219]
  v_cmp_gt_i32 s[82:83], 33, v25
  v_cmp_gt_i32 s[84:85], 34, v25
  v_mfma_f32_16x16x32_bf16 v[248:251], a[120:123], v[92:95], v[248:251]
  v_cmp_gt_i32 s[86:87], 35, v25
  v_cndmask_b32 v104, v104, v24, s[80:81]
  v_mfma_f32_16x16x32_bf16 v[156:159], a[124:127], v[80:83], v[156:159]
  v_cndmask_b32 v105, v105, v24, s[82:83]
  v_cndmask_b32 v106, v106, v24, s[84:85]
  v_mfma_f32_16x16x32_bf16 v[188:191], a[124:127], v[84:87], v[188:191]
  v_cndmask_b32 v107, v107, v24, s[86:87]
  v_cmp_gt_i32 s[80:81], 48, v25
  v_mfma_f32_16x16x32_bf16 v[220:223], a[124:127], v[88:91], v[220:223]
  v_cmp_gt_i32 s[82:83], 49, v25
  v_cmp_gt_i32 s[84:85], 50, v25
  v_mfma_f32_16x16x32_bf16 v[252:255], a[124:127], v[92:95], v[252:255]
  v_cmp_gt_i32 s[86:87], 51, v25
  v_cndmask_b32 v108, v108, v24, s[80:81]
  v_cndmask_b32 v109, v109, v24, s[82:83]
  v_cndmask_b32 v110, v110, v24, s[84:85]
  v_cndmask_b32 v111, v111, v24, s[86:87]
  v_add_u32 v4, 0x4000, v4
  v_and_b32 v4, 0x1ffff, v4
  s_cbranch_vccnz L_a_d2_t
L_a_d2_r:
L_a_d3:
  s_waitcnt vmcnt(24) lgkmcnt(0)
  v_mfma_f32_16x16x32_bf16 v[40:43], a[64:67], a[16:19], v[104:107]
  s_barrier
  ds_read_b128 a[96:99], v4 offset:0
  v_mfma_f32_16x16x32_bf16 v[40:43], a[72:75], a[20:23], v[40:43]
  s_nop 0
  ds_read_b128 a[100:103], v4 offset:1024
  v_mfma_f32_16x16x32_bf16 v[40:43], a[80:83], a[24:27], v[40:43]
  s_nop 0
  ds_read_b128 a[104:107], v4 offset:2048
  v_mfma_f32_16x16x32_bf16 v[40:43], a[88:91], a[28:31], v[40:43]
  s_nop 0
  ds_read_b128 a[108:111], v4 offset:3072
  v_mfma_f32_16x16x32_bf16 v[44:47], a[68:71], a[16:19], v[108:111]
  s_nop 0
  ds_read_b128 a[112:115], v4 offset:4096
  v_mfma_f32_16x16x32_bf16 v[44:47], a[76:79], a[20:23], v[44:47]
  s_nop 0
  ds_read_b128 a[116:119], v4 offset:5120
  v_mfma_f32_16x16x32_bf16 v[44:47], a[84:87], a[24:27], v[44:47]
  s_nop 0
  ds_read_b128 a[120:123], v4 offset:6144
  v_mfma_f32_16x16x32_bf16 v[44:47], a[92:95], a[28:31], v[44:47]
  s_nop 0
  ds_read_b128 a[124:127], v4 offset:7168
  v_mfma_f32_16x16x32_bf16 v[48:51], a[64:67], a[32:35], v[112:115]
  s_add_u32 m0, s73, 16384
  s_add_u32 s66, s72, 128
  buffer_load_dwordx4 v26, s[48:51], s66 offen lds
  v_mfma_f32_16x16x32_bf16 v[48:51], a[72:75], a[36:39], v[48:51]
  s_add_u32 m0, s73, 17408
  s_add_u32 s66, s72, 8320
  buffer_load_dwordx4 v26, s[48:51], s66 offen lds
  v_mfma_f32_16x16x32_bf16 v[48:51], a[80:83], a[40:43], v[48:51]
  s_add_u32 m0, s73, 18432
  s_add_u32 s66, s72, 16512
  buffer_load_dwordx4 v26, s[48:51], s66 offen lds
  v_mfma_f32_16x16x32_bf16 v[48:51], a[88:91], a[44:47], v[48:51]
  s_add_u32 m0, s73, 19456
  s_add_u32 s66, s72, 24704
  buffer_load_dwordx4 v26, s[48:51], s66 offen lds
  v_mfma_f32_16x16x32_bf16 v[52:55], a[68:71], a[32:35], v[116:119]
  s_add_u32 s58, s58, 1
  v_exp_f32 v8, v40
  v_mfma_f32_16x16x32_bf16 v[52:55], a[76:79], a[36:39], v[52:55]
  s_nop 0
  v_exp_f32 v9, v41
  v_mfma_f32_16x16x32_bf16 v[52:55], a[84:87], a[40:43], v[52:55]
  s_nop 0
  v_exp_f32 v10, v42
  v_mfma_f32_16x16x32_bf16 v[52:55], a[92:95], a[44:47], v[52:55]
  s_nop 0
  v_exp_f32 v11, v43
  v_mfma_f32_16x16x32_bf16 v[56:59], a[64:67], a[48:51], v[120:123]
  s_nop 0
  v_cvt_pk_bf16_f32 v84, v8, v9
  v_cvt_pk_bf16_f32 v85, v10, v11
  v_mfma_f32_16x16x32_bf16 v[56:59], a[72:75], a[52:55], v[56:59]
  s_nop 0
  v_or_b32 v5, v84, v85
  v_mfma_f32_16x16x32_bf16 v[56:59], a[80:83], a[56:59], v[56:59]
  s_nop 0
  v_exp_f32 v12, v44
  v_mfma_f32_16x16x32_bf16 v[56:59], a[88:91], a[60:63], v[56:59]
  s_nop 0
  v_exp_f32 v13, v45
  v_mfma_f32_16x16x32_bf16 v[60:63], a[68:71], a[48:51], v[124:127]
  s_nop 0
  v_exp_f32 v14, v46
  v_mfma_f32_16x16x32_bf16 v[60:63], a[76:79], a[52:55], v[60:63]
  s_nop 0
  v_exp_f32 v15, v47
  v_mfma_f32_16x16x32_bf16 v[60:63], a[84:87], a[56:59], v[60:63]
  s_nop 0
  v_cvt_pk_bf16_f32 v86, v12, v13
  v_cvt_pk_bf16_f32 v87, v14, v15
  v_mfma_f32_16x16x32_bf16 v[60:63], a[92:95], a[60:63], v[60:63]
  s_nop 0
  v_or3_b32 v5, v5, v86, v87
  v_mfma_f32_16x16x32_bf16 a[132:135], v[16:19], v[68:71], a[132:135]
  s_nop 0
  ds_read_b128 a[64:67], v4 offset:8192
  v_mfma_f32_16x16x32_bf16 a[136:139], v[16:19], v[72:75], a[136:139]
  s_nop 0
  ds_read_b128 a[68:71], v4 offset:9216
  v_mfma_f32_16x16x32_bf16 a[140:143], v[16:19], v[76:79], a[140:143]
  s_nop 0
  ds_read_b128 a[72:75], v4 offset:10240
  s_waitcnt lgkmcnt(3)
  v_mfma_f32_16x16x32_bf16 v[160:163], a[96:99], v[68:71], v[160:163]
  s_nop 0
  ds_read_b128 a[76:79], v4 offset:11264
  v_mfma_f32_16x16x32_bf16 v[192:195], a[96:99], v[72:75], v[192:195]
  ds_read_b128 a[80:83], v4 offset:12288
  v_mfma_f32_16x16x32_bf16 v[224:227], a[96:99], v[76:79], v[224:227]
  ds_read_b128 a[84:87], v4 offset:13312
  v_mfma_f32_16x16x32_bf16 v[164:167], a[100:103], v[68:71], v[164:167]
  ds_read_b128 a[88:91], v4 offset:14336
  v_mfma_f32_16x16x32_bf16 v[196:199], a[100:103], v[72:75], v[196:199]
  ds_read_b128 a[92:95], v4 offset:15360
  v_mfma_f32_16x16x32_bf16 v[228:231], a[100:103], v[76:79], v[228:231]
  v_exp_f32 v8, v48
  v_mfma_f32_16x16x32_bf16 v[168:171], a[104:107], v[68:71], v[168:171]
  v_exp_f32 v9, v49
  v_mfma_f32_16x16x32_bf16 v[200:203], a[104:107], v[72:75], v[200:203]
  v_exp_f32 v10, v50
  v_mfma_f32_16x16x32_bf16 v[232:235], a[104:107], v[76:79], v[232:235]
  v_exp_f32 v11, v51
  v_mfma_f32_16x16x32_bf16 v[172:175], a[108:111], v[68:71], v[172:175]
  v_cvt_pk_bf16_f32 v88, v8, v9
  v_cvt_pk_bf16_f32 v89, v10, v11
  v_mfma_f32_16x16x32_bf16 v[204:207], a[108:111], v[72:75], v[204:207]
  v_or3_b32 v5, v5, v88, v89
  v_mfma_f32_16x16x32_bf16 v[236:239], a[108:111], v[76:79], v[236:239]
  v_exp_f32 v12, v52
  v_mfma_f32_16x16x32_bf16 v[176:179], a[112:115], v[68:71], v[176:179]
  v_exp_f32 v13, v53
  v_mfma_f32_16x16x32_bf16 v[208:211], a[112:115], v[72:75], v[208:211]
  v_exp_f32 v14, v54
  v_mfma_f32_16x16x32_bf16 v[240:243], a[112:115], v[76:79], v[240:243]
  v_exp_f32 v15, v55
  v_mfma_f32_16x16x32_bf16 v[180:183], a[116:119], v[68:71], v[180:183]
  v_cvt_pk_bf16_f32 v90, v12, v13
  v_cvt_pk_bf16_f32 v91, v14, v15
  v_mfma_f32_16x16x32_bf16 v[212:215], a[116:119], v[72:75], v[212:215]
  v_or3_b32 v5, v5, v90, v91
  v_mfma_f32_16x16x32_bf16 v[244:247], a[116:119], v[76:79], v[244:247]
  v_exp_f32 v8, v56
  v_mfma_f32_16x16x32_bf16 v[184:187], a[120:123], v[68:71], v[184:187]
  v_exp_f32 v9, v57
  v_mfma_f32_16x16x32_bf16 v[216:219], a[120:123], v[72:75], v[216:219]
  v_exp_f32 v10, v58
  v_mfma_f32_16x16x32_bf16 v[248:251], a[120:123], v[76:79], v[248:251]
  v_exp_f32 v11, v59
  v_mfma_f32_16x16x32_bf16 v[188:191], a[124:127], v[68:71], v[188:191]
  v_cvt_pk_bf16_f32 v92, v8, v9
  v_cvt_pk_bf16_f32 v93, v10, v11
  v_mfma_f32_16x16x32_bf16 v[220:223], a[124:127], v[72:75], v[220:223]
  v_or3_b32 v5, v5, v92, v93
  v_mfma_f32_16x16x32_bf16 v[252:255], a[124:127], v[76:79], v[252:255]
  v_exp_f32 v12, v60
  v_exp_f32 v13, v61
  v_exp_f32 v14, v62
  v_exp_f32 v15, v63
  s_nop 0
  v_cvt_pk_bf16_f32 v94, v12, v13
  v_cvt_pk_bf16_f32 v95, v14, v15
  v_or3_b32 v5, v5, v94, v95
  v_and_b32 v5, s70, v5
  v_cmp_ne_u32 vcc, 0, v5
  v_cmp_gt_i32 s[80:81], 0, v25
  v_cmp_gt_i32 s[82:83], 1, v25
  v_cmp_gt_i32 s[84:85], 2, v25
  v_cmp_gt_i32 s[86:87], 3, v25
  v_cndmask_b32 v112, v112, v24, s[80:81]
  v_cndmask_b32 v113, v113, v24, s[82:83]
  v_cndmask_b32 v114, v114, v24, s[84:85]
  v_cndmask_b32 v115, v115, v24, s[86:87]
  v_cmp_gt_i32 s[80:81], 16, v25
  v_cmp_gt_i32 s[82:83], 17, v25
  v_cmp_gt_i32 s[84:85], 18, v25
  v_cmp_gt_i32 s[86:87], 19, v25
  v_cndmask_b32 v116, v116, v24, s[80:81]
  v_cndmask_b32 v117, v117, v24, s[82:83]
  v_cndmask_b32 v118, v118, v24, s[84:85]
  v_cndmask_b32 v119, v119, v24, s[86:87]
  v_add_u32 v4, 0x4000, v4
  v_and_b32 v4, 0x1ffff, v4
  s_cbranch_vccnz L_a_d3_t
L_a_d3_r:
L_a_d4:
  s_waitcnt vmcnt(24) lgkmcnt(0)
  v_mfma_f32_16x16x32_bf16 v[48:51], a[64:67], a[32:35], v[112:115]
  s_barrier
  ds_read_b128 a[96:99], v4 offset:0
  v_mfma_f32_16x16x32_bf16 v[48:51], a[72:75], a[36:39], v[48:51]
  s_nop 0
  ds_read_b128 a[100:103], v4 offset:1024
  v_mfma_f32_16x16x32_bf16 v[48:51], a[80:83], a[40:43], v[48:51]
  s_nop 0
  ds_read_b128 a[104:107], v4 offset:2048
  v_mfma_f32_16x16x32_bf16 v[48:51], a[88:91], a[44:47], v[48:51]
  s_nop 0
  ds_read_b128 a[108:111], v4 offset:3072
  v_mfma_f32_16x16x32_bf16 v[52:55], a[68:71], a[32:35], v[116:119]
  s_nop 0
  ds_read_b128 a[112:115], v4 offset:4096
  v_mfma_f32_16x16x32_bf16 v[52:55], a[76:79], a[36:39], v[52:55]
  s_nop 0
  ds_read_b128 a[116:119], v4 offset:5120
  v_mfma_f32_16x16x32_bf16 v[52:55], a[84:87], a[40:43], v[52:55]
  s_nop 0
  ds_read_b128 a[120:123], v4 offset:6144
  v_mfma_f32_16x16x32_bf16 v[52:55], a[92:95], a[44:47], v[52:55]
  s_nop 0
  ds_read_b128 a[124:127], v4 offset:7168
  v_mfma_f32_16x16x32_bf16 v[56:59], a[64:67], a[48:51], v[120:123]
  s_add_u32 m0, s73, 32768
  s_add_u32 s66, s72, 256
  buffer_load_dwordx4 v26, s[48:51], s66 offen lds
  v_mfma_f32_16x16x32_bf16 v[56:59], a[72:75], a[52:55], v[56:59]
  s_add_u32 m0, s73, 33792
  s_add_u32 s66, s72, 8448
  buffer_load_dwordx4 v26, s[48:51], s66 offen lds
  v_mfma_f32_16x16x32_bf16 v[56:59], a[80:83], a[56:59], v[56:59]
  s_add_u32 m0, s73, 34816
  s_add_u32 s66, s72, 16640
  buffer_load_dwordx4 v26, s[48:51], s66 offen lds
  v_mfma_f32_16x16x32_bf16 v[56:59], a[88:91], a[60:63], v[56:59]
  s_add_u32 m0, s73, 35840
  s_add_u32 s66, s72, 24832
  buffer_load_dwordx4 v26, s[48:51], s66 offen lds
  v_mfma_f32_16x16x32_bf16 v[60:63], a[68:71], a[48:51], v[124:127]
  s_add_u32 s58, s58, 1
  v_exp_f32 v8, v48
  v_mfma_f32_16x16x32_bf16 v[60:63], a[76:79], a[52:55], v[60:63]
  s_nop 0
  v_exp_f32 v9, v49
  v_mfma_f32_16x16x32_bf16 v[60:63], a[84:87], a[56:59], v[60:63]
  s_nop 0
  v_exp_f32 v10, v50
  v_mfma_f32_16x16x32_bf16 v[60:63], a[92:95], a[60:63], v[60:63]
  s_nop 0
  v_exp_f32 v11, v51
  v_mfma_f32_16x16x32_bf16 a[132:135], v[16:19], v[84:87], a[132:135]
  s_nop 0
  ds_read_b128 a[64:67], v4 offset:8192
  v_cvt_pk_bf16_f32 v72, v8, v9
  v_mfma_f32_16x16x32_bf16 a[136:139], v[16:19], v[88:91], a[136:139]
  s_nop 0
  ds_read_b128 a[68:71], v4 offset:9216
  v_cvt_pk_bf16_f32 v73, v10, v11
  v_mfma_f32_16x16x32_bf16 a[140:143], v[16:19], v[92:95], a[140:143]
  s_nop 0
  ds_read_b128 a[72:75], v4 offset:10240
  v_or_b32 v5, v72, v73
  s_waitcnt lgkmcnt(3)
  v_mfma_f32_16x16x32_bf16 v[160:163], a[96:99], v[84:87], v[160:163]
  s_nop 0
  ds_read_b128 a[76:79], v4 offset:11264
  v_mfma_f32_16x16x32_bf16 v[192:195], a[96:99], v[88:91], v[192:195]
  ds_read_b128 a[80:83], v4 offset:12288
  v_mfma_f32_16x16x32_bf16 v[224:227], a[96:99], v[92:95], v[224:227]
  ds_read_b128 a[84:87], v4 offset:13312
  v_mfma_f32_16x16x32_bf16 v[164:167], a[100:103], v[84:87], v[164:167]
  ds_read_b128 a[88:91], v4 offset:14336
  v_mfma_f32_16x16x32_bf16 v[196:199], a[100:103], v[88:91], v[196:199]
  ds_read_b128 a[92:95], v4 offset:15360
  v_mfma_f32_16x16x32_bf16 v[228:231], a[100:103], v[92:95], v[228:231]
  v_exp_f32 v12, v52
  v_mfma_f32_16x16x32_bf16 v[168:171], a[104:107], v[84:87], v[168:171]
  v_exp_f32 v13, v53
  v_mfma_f32_16x16x32_bf16 v[200:203], a[104:107], v[88:91], v[200:203]
  v_exp_f32 v14, v54
  v_mfma_f32_16x16x32_bf16 v[232:235], a[104:107], v[92:95], v[232:235]
  v_exp_f32 v15, v55
  v_mfma_f32_16x16x32_bf16 v[172:175], a[108:111], v[84:87], v[172:175]
  v_cvt_pk_bf16_f32 v74, v12, v13
  v_cvt_pk_bf16_f32 v75, v14, v15
  v_mfma_f32_16x16x32_bf16 v[204:207], a[108:111], v[88:91], v[204:207]
  v_or3_b32 v5, v5, v74, v75
  v_mfma_f32_16x16x32_bf16 v[236:239], a[108:111], v[92:95], v[236:239]
  v_exp_f32 v8, v56
  v_mfma_f32_16x16x32_bf16 v[176:179], a[112:115], v[84:87], v[176:179]
  v_exp_f32 v9, v57
  v_mfma_f32_16x16x32_bf16 v[208:211], a[112:115], v[88:91], v[208:211]
  v_exp_f32 v10, v58
  v_mfma_f32_16x16x32_bf16 v[240:243], a[112:115], v[92:95], v[240:243]
  v_exp_f32 v11, v59
  v_mfma_f32_16x16x32_bf16 v[180:183], a[116:119], v[84:87], v[180:183]
  v_cvt_pk_bf16_f32 v76, v8, v9
  v_cvt_pk_bf16_f32 v77, v10, v11
  v_mfma_f32_16x16x32_bf16 v[212:215], a[116:119], v[88:91], v[212:215]
  v_or3_b32 v5, v5, v76, v77
  v_mfma_f32_16x16x32_bf16 v[244:247], a[116:119], v[92:95], v[244:247]
  v_exp_f32 v12, v60
  v_mfma_f32_16x16x32_bf16 v[184:187], a[120:123], v[84:87], v[184:187]
  v_exp_f32 v13, v61
  v_mfma_f32_16x16x32_bf16 v[216:219], a[120:123], v[88:91], v[216:219]
  v_exp_f32 v14, v62
  v_mfma_f32_16x16x32_bf16 v[248:251], a[120:123], v[92:95], v[248:251]
  v_exp_f32 v15, v63
  v_mfma_f32_16x16x32_bf16 v[188:191], a[124:127], v[84:87], v[188:191]
  v_cvt_pk_bf16_f32 v78, v12, v13
  v_cvt_pk_bf16_f32 v79, v14, v15
  v_mfma_f32_16x16x32_bf16 v[220:223], a[124:127], v[88:91], v[220:223]
  v_or3_b32 v5, v5, v78, v79
  v_and_b32 v5, s70, v5
  v_mfma_f32_16x16x32_bf16 v[252:255], a[124:127], v[92:95], v[252:255]
  v_cmp_ne_u32 vcc, 0, v5
  v_cmp_gt_i32 s[80:81], 32, v25
  v_cmp_gt_i32 s[82:83], 33, v25
  v_cmp_gt_i32 s[84:85], 34, v25
  v_cmp_gt_i32 s[86:87], 35, v25
  v_cndmask_b32 v112, v112, v24, s[80:81]
  v_cndmask_b32 v113, v113, v24, s[82:83]
  v_cndmask_b32 v114, v114, v24, s[84:85]
  v_cndmask_b32 v115, v115, v24, s[86:87]
  v_cmp_gt_i32 s[80:81], 48, v25
  v_cmp_gt_i32 s[82:83], 49, v25
  v_cmp_gt_i32 s[84:85], 50, v25
  v_cmp_gt_i32 s[86:87], 51, v25
  v_cndmask_b32 v116, v116, v24, s[80:81]
  v_cndmask_b32 v117, v117, v24, s[82:83]
  v_cndmask_b32 v118, v118, v24, s[84:85]
  v_cndmask_b32 v119, v119, v24, s[86:87]
  v_add_u32 v4, 0x4000, v4
  v_and_b32 v4, 0x1ffff, v4
  s_cbranch_vccnz L_a_d4_t
L_a_d4_r:
L_a_d5:
  s_waitcnt vmcnt(24) lgkmcnt(0)
  v_mfma_f32_16x16x32_bf16 v[48:51], a[64:67], a[32:35], v[112:115]
  s_barrier
  ds_read_b128 a[96:99], v4 offset:0
  v_mfma_f32_16x16x32_bf16 v[48:51], a[72:75], a[36:39], v[48:51]
  s_nop 0
  ds_read_b128 a[100:103], v4 offset:1024
  v_mfma_f32_16x16x32_bf16 v[48:51], a[80:83], a[40:43], v[48:51]
  s_nop 0
  ds_read_b128 a[104:107], v4 offset:2048
  v_mfma_f32_16x16x32_bf16 v[48:51], a[88:91], a[44:47], v[48:51]
  s_nop 0
  ds_read_b128 a[108:111], v4 offset:3072
  v_mfma_f32_16x16x32_bf16 v[52:55], a[68:71], a[32:35], v[116:119]
  s_nop 0
  ds_read_b128 a[112:115], v4 offset:4096
  v_mfma_f32_16x16x32_bf16 v[52:55], a[76:79], a[36:39], v[52:55]
  s_nop 0
  ds_read_b128 a[116:119], v4 offset:5120
  v_mfma_f32_16x16x32_bf16 v[52:55], a[84:87], a[40:43], v[52:55]
  s_nop 0
  ds_read_b128 a[120:123], v4 offset:6144
  v_mfma_f32_16x16x32_bf16 v[52:55], a[92:95], a[44:47], v[52:55]
  s_nop 0
  ds_read_b128 a[124:127], v4 offset:7168
  v_mfma_f32_16x16x32_bf16 v[56:59], a[64:67], a[48:51], v[120:123]
  s_add_u32 m0, s73, 49152
  s_add_u32 s66, s72, 384
  buffer_load_dwordx4 v26, s[48:51], s66 offen lds
  v_mfma_f32_16x16x32_bf16 v[56:59], a[72:75], a[52:55], v[56:59]
  s_add_u32 m0, s73, 50176
  s_add_u32 s66, s72, 8576
  buffer_load_dwordx4 v26, s[48:51], s66 offen lds
  v_mfma_f32_16x16x32_bf16 v[56:59], a[80:83], a[56:59], v[56:59]
  s_add_u32 m0, s73, 51200
  s_add_u32 s66, s72, 16768
  buffer_load_dwordx4 v26, s[48:51], s66 offen lds
  v_mfma_f32_16x16x32_bf16 v[56:59], a[88:91], a[60:63], v[56:59]
  s_add_u32 m0, s73, 52224
  s_add_u32 s66, s72, 24960
  buffer_load_dwordx4 v26, s[48:51], s66 offen lds
  v_mfma_f32_16x16x32_bf16 v[60:63], a[68:71], a[48:51], v[124:127]
  s_add_u32 s58, s58, 1
  v_exp_f32 v8, v48
  v_mfma_f32_16x16x32_bf16 v[60:63], a[76:79], a[52:55], v[60:63]
  s_nop 0
  v_exp_f32 v9, v49
  v_mfma_f32_16x16x32_bf16 v[60:63], a[84:87], a[56:59], v[60:63]
  s_nop 0
  v_exp_f32 v10, v50
  v_mfma_f32_16x16x32_bf16 v[60:63], a[92:95], a[60:63], v[60:63]
  s_nop 0
  v_exp_f32 v11, v51
  v_mfma_f32_16x16x32_bf16 a[136:139], v[16:19], v[72:75], a[136:139]
  s_nop 0
  ds_read_b128 a[64:67], v4 offset:8192
  v_cvt_pk_bf16_f32 v88, v8, v9
  v_mfma_f32_16x16x32_bf16 a[140:143], v[16:19], v[76:79], a[140:143]
  s_nop 0
  ds_read_b128 a[68:71], v4 offset:9216
  v_cvt_pk_bf16_f32 v89, v10, v11
  s_waitcnt lgkmcnt(2)
  v_mfma_f32_16x16x32_bf16 v[192:195], a[96:99], v[72:75], v[192:195]
  s_nop 0
  ds_read_b128 a[72:75], v4 offset:10240
  v_or_b32 v5, v88, v89
  v_mfma_f32_16x16x32_bf16 v[224:227], a[96:99], v[76:79], v[224:227]
  s_nop 0
  ds_read_b128 a[76:79], v4 offset:11264
  v_mfma_f32_16x16x32_bf16 v[196:199], a[100:103], v[72:75], v[196:199]
  ds_read_b128 a[80:83], v4 offset:12288
  v_mfma_f32_16x16x32_bf16 v[228:231], a[100:103], v[76:79], v[228:231]
  ds_read_b128 a[84:87], v4 offset:13312
  v_mfma_f32_16x16x32_bf16 v[200:203], a[104:107], v[72:75], v[200:203]
  ds_read_b128 a[88:91], v4 offset:14336
  v_mfma_f32_16x16x32_bf16 v[232:235], a[104:107], v[76:79], v[232:235]
  ds_read_b128 a[92:95], v4 offset:15360
  v_mfma_f32_16x16x32_bf16 v[204:207], a[108:111], v[72:75], v[204:207]
  v_exp_f32 v12, v52
  v_mfma_f32_16x16x32_bf16 v[236:239], a[108:111], v[76:79], v[236:239]
  v_exp_f32 v13, v53
  v_mfma_f32_16x16x32_bf16 v[208:211], a[112:115], v[72:75], v[208:211]
  v_exp_f32 v14, v54
  v_mfma_f32_16x16x32_bf16 v[240:243], a[112:115], v[76:79], v[240:243]
  v_exp_f32 v15, v55
  v_mfma_f32_16x16x32_bf16 v[212:215], a[116:119], v[72:75], v[212:215]
  v_cvt_pk_bf16_f32 v90, v12, v13
  v_cvt_pk_bf16_f32 v91, v14, v15
  v_mfma_f32_16x16x32_bf16 v[244:247], a[116:119], v[76:79], v[244:247]
  v_or3_b32 v5, v5, v90, v91
  v_mfma_f32_16x16x32_bf16 v[216:219], a[120:123], v[72:75], v[216:219]
  v_exp_f32 v8, v56
  v_mfma_f32_16x16x32_bf16 v[248:251], a[120:123], v[76:79], v[248:251]
  v_exp_f32 v9, v57
  v_mfma_f32_16x16x32_bf16 v[220:223], a[124:127], v[72:75], v[220:223]
  v_exp_f32 v10, v58
  v_mfma_f32_16x16x32_bf16 v[252:255], a[124:127], v[76:79], v[252:255]
  v_exp_f32 v11, v59
  s_nop 0
  v_cvt_pk_bf16_f32 v92, v8, v9
  v_cvt_pk_bf16_f32 v93, v10, v11
  v_or3_b32 v5, v5, v92, v93
  v_exp_f32 v12, v60
  v_exp_f32 v13, v61
  v_exp_f32 v14, v62
  v_exp_f32 v15, v63
  s_nop 0
  v_cvt_pk_bf16_f32 v94, v12, v13
  v_cvt_pk_bf16_f32 v95, v14, v15
  v_or3_b32 v5, v5, v94, v95
  v_and_b32 v5, s70, v5
  v_cmp_ne_u32 vcc, 0, v5
  v_cmp_gt_i32 s[80:81], 0, v25
  v_cmp_gt_i32 s[82:83], 1, v25
  v_cmp_gt_i32 s[84:85], 2, v25
  v_cmp_gt_i32 s[86:87], 3, v25
  v_cndmask_b32 v120, v120, v24, s[80:81]
  v_cndmask_b32 v121, v121, v24, s[82:83]
  v_cndmask_b32 v122, v122, v24, s[84:85]
  v_cndmask_b32 v123, v123, v24, s[86:87]
  v_cmp_gt_i32 s[80:81], 16, v25
  v_cmp_gt_i32 s[82:83], 17, v25
  v_cmp_gt_i32 s[84:85], 18, v25
  v_cmp_gt_i32 s[86:87], 19, v25
  v_cndmask_b32 v124, v124, v24, s[80:81]
  v_cndmask_b32 v125, v125, v24, s[82:83]
  v_cndmask_b32 v126, v126, v24, s[84:85]
  v_cndmask_b32 v127, v127, v24, s[86:87]
  v_add_u32 v4, 0x4000, v4
  v_and_b32 v4, 0x1ffff, v4
  s_cbranch_vccnz L_a_d5_t
L_a_d5_r:
L_a_d6:
  s_waitcnt vmcnt(24) lgkmcnt(0)
  v_mfma_f32_16x16x32_bf16 v[56:59], a[64:67], a[48:51], v[120:123]
  s_barrier
  ds_read_b128 a[96:99], v4 offset:0
  v_mfma_f32_16x16x32_bf16 v[56:59], a[72:75], a[52:55], v[56:59]
  s_nop 0
  ds_read_b128 a[100:103], v4 offset:1024
  v_mfma_f32_16x16x32_bf16 v[56:59], a[80:83], a[56:59], v[56:59]
  s_nop 0
  ds_read_b128 a[104:107], v4 offset:2048
  v_mfma_f32_16x16x32_bf16 v[56:59], a[88:91], a[60:63], v[56:59]
  s_nop 0
  ds_read_b128 a[108:111], v4 offset:3072
  v_mfma_f32_16x16x32_bf16 v[60:63], a[68:71], a[48:51], v[124:127]
  s_nop 0
  ds_read_b128 a[112:115], v4 offset:4096
  v_mfma_f32_16x16x32_bf16 v[60:63], a[76:79], a[52:55], v[60:63]
  s_nop 0
  ds_read_b128 a[116:119], v4 offset:5120
  v_mfma_f32_16x16x32_bf16 v[60:63], a[84:87], a[56:59], v[60:63]
  s_nop 0
  ds_read_b128 a[120:123], v4 offset:6144
  v_mfma_f32_16x16x32_bf16 v[60:63], a[92:95], a[60:63], v[60:63]
  s_nop 0
  ds_read_b128 a[124:127], v4 offset:7168
  v_mfma_f32_16x16x32_bf16 a[136:139], v[16:19], v[88:91], a[136:139]
  s_add_u32 m0, s73, 65536
  s_add_u32 s66, s72, 512
  buffer_load_dwordx4 v26, s[48:51], s66 offen lds
  v_mfma_f32_16x16x32_bf16 a[140:143], v[16:19], v[92:95], a[140:143]
  s_add_u32 m0, s73, 66560
  s_add_u32 s66, s72, 8704
  buffer_load_dwordx4 v26, s[48:51], s66 offen lds
  s_waitcnt lgkmcnt(0)
  v_mfma_f32_16x16x32_bf16 v[192:195], a[96:99], v[88:91], v[192:195]
  s_add_u32 m0, s73, 67584
  s_add_u32 s66, s72, 16896
  buffer_load_dwordx4 v26, s[48:51], s66 offen lds
  v_mfma_f32_16x16x32_bf16 v[224:227], a[96:99], v[92:95], v[224:227]
  s_add_u32 m0, s73, 68608
  s_add_u32 s66, s72, 25088
  buffer_load_dwordx4 v26, s[48:51], s66 offen lds
  v_mfma_f32_16x16x32_bf16 v[196:199], a[100:103], v[88:91], v[196:199]
  s_add_u32 s58, s58, 1
  ds_read_b128 a[64:67], v4 offset:8192
  v_mfma_f32_16x16x32_bf16 v[228:231], a[100:103], v[92:95], v[228:231]
  ds_read_b128 a[68:71], v4 offset:9216
  v_mfma_f32_16x16x32_bf16 v[200:203], a[104:107], v[88:91], v[200:203]
  ds_read_b128 a[72:75], v4 offset:10240
  v_mfma_f32_16x16x32_bf16 v[232:235], a[104:107], v[92:95], v[232:235]
  ds_read_b128 a[76:79], v4 offset:11264
  v_mfma_f32_16x16x32_bf16 v[204:207], a[108:111], v[88:91], v[204:207]
  ds_read_b128 a[80:83], v4 offset:12288
  v_mfma_f32_16x16x32_bf16 v[236:239], a[108:111], v[92:95], v[236:239]
  ds_read_b128 a[84:87], v4 offset:13312
  v_mfma_f32_16x16x32_bf16 v[208:211], a[112:115], v[88:91], v[208:211]
  ds_read_b128 a[88:91], v4 offset:14336
  v_mfma_f32_16x16x32_bf16 v[240:243], a[112:115], v[92:95], v[240:243]
  ds_read_b128 a[92:95], v4 offset:15360
  v_mfma_f32_16x16x32_bf16 v[212:215], a[116:119], v[88:91], v[212:215]
  v_exp_f32 v8, v56
  v_mfma_f32_16x16x32_bf16 v[244:247], a[116:119], v[92:95], v[244:247]
  v_exp_f32 v9, v57
  v_mfma_f32_16x16x32_bf16 v[216:219], a[120:123], v[88:91], v[216:219]
  v_exp_f32 v10, v58
  v_mfma_f32_16x16x32_bf16 v[248:251], a[120:123], v[92:95], v[248:251]
  v_exp_f32 v11, v59
  v_mfma_f32_16x16x32_bf16 v[220:223], a[124:127], v[88:91], v[220:223]
  v_cvt_pk_bf16_f32 v76, v8, v9
  v_cvt_pk_bf16_f32 v77, v10, v11
  v_mfma_f32_16x16x32_bf16 v[252:255], a[124:127], v[92:95], v[252:255]
  v_or_b32 v5, v76, v77
  v_exp_f32 v12, v60
  v_exp_f32 v13, v61
  v_exp_f32 v14, v62
  v_exp_f32 v15, v63
  s_nop 0
  v_cvt_pk_bf16_f32 v78, v12, v13
  v_cvt_pk_bf16_f32 v79, v14, v15
  v_or3_b32 v5, v5, v78, v79
  v_and_b32 v5, s70, v5
  v_cmp_ne_u32 vcc, 0, v5
  v_cmp_gt_i32 s[80:81], 32, v25
  v_cmp_gt_i32 s[82:83], 33, v25
  v_cmp_gt_i32 s[84:85], 34, v25
  v_cmp_gt_i32 s[86:87], 35, v25
  v_cndmask_b32 v120, v120, v24, s[80:81]
  v_cndmask_b32 v121, v121, v24, s[82:83]
  v_cndmask_b32 v122, v122, v24, s[84:85]
  v_cndmask_b32 v123, v123, v24, s[86:87]
  v_cmp_gt_i32 s[80:81], 48, v25
  v_cmp_gt_i32 s[82:83], 49, v25
  v_cmp_gt_i32 s[84:85], 50, v25
  v_cmp_gt_i32 s[86:87], 51, v25
  v_cndmask_b32 v124, v124, v24, s[80:81]
  v_cndmask_b32 v125, v125, v24, s[82:83]
  v_cndmask_b32 v126, v126, v24, s[84:85]
  v_cndmask_b32 v127, v127, v24, s[86:87]
  v_add_u32 v4, 0x4000, v4
  v_and_b32 v4, 0x1ffff, v4
  s_cbranch_vccnz L_a_d6_t
L_a_d6_r:
L_a_d7:
  s_waitcnt vmcnt(24) lgkmcnt(0)
  v_mfma_f32_16x16x32_bf16 v[56:59], a[64:67], a[48:51], v[120:123]
  s_barrier
  ds_read_b128 a[96:99], v4 offset:0
  v_mfma_f32_16x16x32_bf16 v[56:59], a[72:75], a[52:55], v[56:59]
  s_nop 0
  ds_read_b128 a[100:103], v4 offset:1024
  v_mfma_f32_16x16x32_bf16 v[56:59], a[80:83], a[56:59], v[56:59]
  s_nop 0
  ds_read_b128 a[104:107], v4 offset:2048
  v_mfma_f32_16x16x32_bf16 v[56:59], a[88:91], a[60:63], v[56:59]
  s_nop 0
  ds_read_b128 a[108:111], v4 offset:3072
  v_mfma_f32_16x16x32_bf16 v[60:63], a[68:71], a[48:51], v[124:127]
  s_nop 0
  ds_read_b128 a[112:115], v4 offset:4096
  v_mfma_f32_16x16x32_bf16 v[60:63], a[76:79], a[52:55], v[60:63]
  s_nop 0
  ds_read_b128 a[116:119], v4 offset:5120
  v_mfma_f32_16x16x32_bf16 v[60:63], a[84:87], a[56:59], v[60:63]
  s_nop 0
  ds_read_b128 a[120:123], v4 offset:6144
  v_mfma_f32_16x16x32_bf16 v[60:63], a[92:95], a[60:63], v[60:63]
  s_nop 0
  ds_read_b128 a[124:127], v4 offset:7168
  v_mfma_f32_16x16x32_bf16 a[140:143], v[16:19], v[76:79], a[140:143]
  s_add_u32 m0, s73, 81920
  s_add_u32 s66, s72, 640
  buffer_load_dwordx4 v26, s[48:51], s66 offen lds
  s_waitcnt lgkmcnt(0)
  v_mfma_f32_16x16x32_bf16 v[224:227], a[96:99], v[76:79], v[224:227]
  s_add_u32 m0, s73, 82944
  s_add_u32 s66, s72, 8832
  buffer_load_dwordx4 v26, s[48:51], s66 offen lds
  v_mfma_f32_16x16x32_bf16 v[228:231], a[100:103], v[76:79], v[228:231]
  s_add_u32 m0, s73, 83968
  s_add_u32 s66, s72, 17024
  buffer_load_dwordx4 v26, s[48:51], s66 offen lds
  v_mfma_f32_16x16x32_bf16 v[232:235], a[104:107], v[76:79], v[232:235]
  s_add_u32 m0, s73, 84992
  s_add_u32 s66, s72, 25216
  buffer_load_dwordx4 v26, s[48:51], s66 offen lds
  v_mfma_f32_16x16x32_bf16 v[236:239], a[108:111], v[76:79], v[236:239]
  s_add_u32 s58, s58, 1
  v_exp_f32 v8, v56
  v_mfma_f32_16x16x32_bf16 v[240:243], a[112:115], v[76:79], v[240:243]
  v_exp_f32 v9, v57
  v_mfma_f32_16x16x32_bf16 v[244:247], a[116:119], v[76:79], v[244:247]
  v_exp_f32 v10, v58
  v_mfma_f32_16x16x32_bf16 v[248:251], a[120:123], v[76:79], v[248:251]
  v_exp_f32 v11, v59
  v_mfma_f32_16x16x32_bf16 v[252:255], a[124:127], v[76:79], v[252:255]
  v_cvt_pk_bf16_f32 v92, v8, v9
  v_cvt_pk_bf16_f32 v93, v10, v11
  v_or_b32 v5, v92, v93
  v_exp_f32 v12, v60
  v_exp_f32 v13, v61
  v_exp_f32 v14, v62
  v_exp_f32 v15, v63
  s_nop 0
  v_cvt_pk_bf16_f32 v94, v12, v13
  v_cvt_pk_bf16_f32 v95, v14, v15
  v_or3_b32 v5, v5, v94, v95
  v_and_b32 v5, s70, v5
  v_cmp_ne_u32 vcc, 0, v5
  v_add_u32 v4, 0x4000, v4
  v_and_b32 v4, 0x1ffff, v4
  s_cbranch_vccnz L_a_d7_t
L_a_d7_r:
  s_waitcnt vmcnt(24)
  s_barrier
  ds_read_b128 a[96:99], v4 offset:0
  ds_read_b128 a[100:103], v4 offset:1024
  ds_read_b128 a[104:107], v4 offset:2048
  ds_read_b128 a[108:111], v4 offset:3072
  ds_read_b128 a[112:115], v4 offset:4096
  ds_read_b128 a[116:119], v4 offset:5120
  ds_read_b128 a[120:123], v4 offset:6144
  ds_read_b128 a[124:127], v4 offset:7168
  s_add_u32 m0, s73, 98304
  s_add_u32 s66, s72, 768
  buffer_load_dwordx4 v26, s[48:51], s66 offen lds
  s_add_u32 m0, s73, 99328
  s_add_u32 s66, s72, 8960
  buffer_load_dwordx4 v26, s[48:51], s66 offen lds
  s_add_u32 m0, s73, 100352
  s_add_u32 s66, s72, 17152
  buffer_load_dwordx4 v26, s[48:51], s66 offen lds
  s_add_u32 m0, s73, 101376
  s_add_u32 s66, s72, 25344
  buffer_load_dwordx4 v26, s[48:51], s66 offen lds
  v_mfma_f32_16x16x32_bf16 a[140:143], v[16:19], v[92:95], a[140:143]
  s_waitcnt lgkmcnt(7)
  v_mfma_f32_16x16x32_bf16 v[224:227], a[96:99], v[92:95], v[224:227]
  s_waitcnt lgkmcnt(6)
  v_mfma_f32_16x16x32_bf16 v[228:231], a[100:103], v[92:95], v[228:231]
  s_waitcnt lgkmcnt(5)
  v_mfma_f32_16x16x32_bf16 v[232:235], a[104:107], v[92:95], v[232:235]
  s_waitcnt lgkmcnt(4)
  v_mfma_f32_16x16x32_bf16 v[236:239], a[108:111], v[92:95], v[236:239]
  s_waitcnt lgkmcnt(3)
  v_mfma_f32_16x16x32_bf16 v[240:243], a[112:115], v[92:95], v[240:243]
  s_waitcnt lgkmcnt(2)
  v_mfma_f32_16x16x32_bf16 v[244:247], a[116:119], v[92:95], v[244:247]
  s_waitcnt lgkmcnt(1)
  v_mfma_f32_16x16x32_bf16 v[248:251], a[120:123], v[92:95], v[248:251]
  s_waitcnt lgkmcnt(0)
  v_mfma_f32_16x16x32_bf16 v[252:255], a[124:127], v[92:95], v[252:255]
  s_barrier
  s_add_u32 m0, s73, 114688
  s_add_u32 s66, s72, 896
  buffer_load_dwordx4 v26, s[48:51], s66 offen lds
  s_add_u32 m0, s73, 115712
  s_add_u32 s66, s72, 9088
  buffer_load_dwordx4 v26, s[48:51], s66 offen lds
  s_add_u32 m0, s73, 116736
  s_add_u32 s66, s72, 17280
  buffer_load_dwordx4 v26, s[48:51], s66 offen lds
  s_add_u32 m0, s73, 117760
  s_add_u32 s66, s72, 25472
  buffer_load_dwordx4 v26, s[48:51], s66 offen lds
  v_accvgpr_read_b32 v6, a128
  v_rcp_f32 v6, v6
  s_nop 0
  v_mul_f32 v20, v20, v6
  v_accvgpr_read_b32 v6, a132
  v_rcp_f32 v6, v6
  s_nop 0
  v_mul_f32 v21, v21, v6
  v_accvgpr_read_b32 v6, a136
  v_rcp_f32 v6, v6
  s_nop 0
  v_mul_f32 v22, v22, v6
  v_accvgpr_read_b32 v6, a140
  v_rcp_f32 v6, v6
  s_nop 0
  v_mul_f32 v23, v23, v6
  v_mul_f32 v128, v128, v20
  v_mul_f32 v129, v129, v20
  v_mul_f32 v130, v130, v20
  v_mul_f32 v131, v131, v20
  v_mul_f32 v132, v132, v20
  v_mul_f32 v133, v133, v20
  v_mul_f32 v134, v134, v20
  v_mul_f32 v135, v135, v20
  v_cvt_pk_bf16_f32 v32, v128, v129
  v_cvt_pk_bf16_f32 v33, v130, v131
  v_cvt_pk_bf16_f32 v34, v132, v133
  v_cvt_pk_bf16_f32 v35, v134, v135
  v_mul_f32 v136, v136, v20
  v_mul_f32 v137, v137, v20
  v_mul_f32 v138, v138, v20
  v_mul_f32 v139, v139, v20
  v_mul_f32 v140, v140, v20
  v_mul_f32 v141, v141, v20
  v_mul_f32 v142, v142, v20
  v_mul_f32 v143, v143, v20
  v_cvt_pk_bf16_f32 v36, v136, v137
  v_cvt_pk_bf16_f32 v37, v138, v139
  v_cvt_pk_bf16_f32 v38, v140, v141
  v_cvt_pk_bf16_f32 v39, v142, v143
  v_mul_f32 v144, v144, v20
  v_mul_f32 v145, v145, v20
  v_mul_f32 v146, v146, v20
  v_mul_f32 v147, v147, v20
  v_mul_f32 v148, v148, v20
  v_mul_f32 v149, v149, v20
  v_mul_f32 v150, v150, v20
  v_mul_f32 v151, v151, v20
  v_cvt_pk_bf16_f32 v40, v144, v145
  v_cvt_pk_bf16_f32 v41, v146, v147
  v_cvt_pk_bf16_f32 v42, v148, v149
  v_cvt_pk_bf16_f32 v43, v150, v151
  v_mul_f32 v152, v152, v20
  v_mul_f32 v153, v153, v20
  v_mul_f32 v154, v154, v20
  v_mul_f32 v155, v155, v20
  v_mul_f32 v156, v156, v20
  v_mul_f32 v157, v157, v20
  v_mul_f32 v158, v158, v20
  v_mul_f32 v159, v159, v20
  v_cvt_pk_bf16_f32 v44, v152, v153
  v_cvt_pk_bf16_f32 v45, v154, v155
  v_cvt_pk_bf16_f32 v46, v156, v157
  v_cvt_pk_bf16_f32 v47, v158, v159
  v_mul_f32 v160, v160, v21
  v_mul_f32 v161, v161, v21
  v_mul_f32 v162, v162, v21
  v_mul_f32 v163, v163, v21
  v_mul_f32 v164, v164, v21
  v_mul_f32 v165, v165, v21
  v_mul_f32 v166, v166, v21
  v_mul_f32 v167, v167, v21
  v_cvt_pk_bf16_f32 v48, v160, v161
  v_cvt_pk_bf16_f32 v49, v162, v163
  v_cvt_pk_bf16_f32 v50, v164, v165
  v_cvt_pk_bf16_f32 v51, v166, v167
  v_mul_f32 v168, v168, v21
  v_mul_f32 v169, v169, v21
  v_mul_f32 v170, v170, v21
  v_mul_f32 v171, v171, v21
  v_mul_f32 v172, v172, v21
  v_mul_f32 v173, v173, v21
  v_mul_f32 v174, v174, v21
  v_mul_f32 v175, v175, v21
  v_cvt_pk_bf16_f32 v52, v168, v169
  v_cvt_pk_bf16_f32 v53, v170, v171
  v_cvt_pk_bf16_f32 v54, v172, v173
  v_cvt_pk_bf16_f32 v55, v174, v175
  v_mul_f32 v176, v176, v21
  v_mul_f32 v177, v177, v21
  v_mul_f32 v178, v178, v21
  v_mul_f32 v179, v179, v21
  v_mul_f32 v180, v180, v21
  v_mul_f32 v181, v181, v21
  v_mul_f32 v182, v182, v21
  v_mul_f32 v183, v183, v21
  v_cvt_pk_bf16_f32 v56, v176, v177
  v_cvt_pk_bf16_f32 v57, v178, v179
  v_cvt_pk_bf16_f32 v58, v180, v181
  v_cvt_pk_bf16_f32 v59, v182, v183
  v_mul_f32 v184, v184, v21
  v_mul_f32 v185, v185, v21
  v_mul_f32 v186, v186, v21
  v_mul_f32 v187, v187, v21
  v_mul_f32 v188, v188, v21
  v_mul_f32 v189, v189, v21
  v_mul_f32 v190, v190, v21
  v_mul_f32 v191, v191, v21
  v_cvt_pk_bf16_f32 v60, v184, v185
  v_cvt_pk_bf16_f32 v61, v186, v187
  v_cvt_pk_bf16_f32 v62, v188, v189
  v_cvt_pk_bf16_f32 v63, v190, v191
  v_mul_f32 v192, v192, v22
  v_mul_f32 v193, v193, v22
  v_mul_f32 v194, v194, v22
  v_mul_f32 v195, v195, v22
  v_mul_f32 v196, v196, v22
  v_mul_f32 v197, v197, v22
  v_mul_f32 v198, v198, v22
  v_mul_f32 v199, v199, v22
  v_cvt_pk_bf16_f32 v64, v192, v193
  v_cvt_pk_bf16_f32 v65, v194, v195
  v_cvt_pk_bf16_f32 v66, v196, v197
  v_cvt_pk_bf16_f32 v67, v198, v199
  v_mul_f32 v200, v200, v22
  v_mul_f32 v201, v201, v22
  v_mul_f32 v202, v202, v22
  v_mul_f32 v203, v203, v22
  v_mul_f32 v204, v204, v22
  v_mul_f32 v205, v205, v22
  v_mul_f32 v206, v206, v22
  v_mul_f32 v207, v207, v22
  v_cvt_pk_bf16_f32 v68, v200, v201
  v_cvt_pk_bf16_f32 v69, v202, v203
  v_cvt_pk_bf16_f32 v70, v204, v205
  v_cvt_pk_bf16_f32 v71, v206, v207
  v_mul_f32 v208, v208, v22
  v_mul_f32 v209, v209, v22
  v_mul_f32 v210, v210, v22
  v_mul_f32 v211, v211, v22
  v_mul_f32 v212, v212, v22
  v_mul_f32 v213, v213, v22
  v_mul_f32 v214, v214, v22
  v_mul_f32 v215, v215, v22
  v_cvt_pk_bf16_f32 v72, v208, v209
  v_cvt_pk_bf16_f32 v73, v210, v211
  v_cvt_pk_bf16_f32 v74, v212, v213
  v_cvt_pk_bf16_f32 v75, v214, v215
  v_mul_f32 v216, v216, v22
  v_mul_f32 v217, v217, v22
  v_mul_f32 v218, v218, v22
  v_mul_f32 v219, v219, v22
  v_mul_f32 v220, v220, v22
  v_mul_f32 v221, v221, v22
  v_mul_f32 v222, v222, v22
  v_mul_f32 v223, v223, v22
  v_cvt_pk_bf16_f32 v76, v216, v217
  v_cvt_pk_bf16_f32 v77, v218, v219
  v_cvt_pk_bf16_f32 v78, v220, v221
  v_cvt_pk_bf16_f32 v79, v222, v223
  v_mul_f32 v224, v224, v23
  v_mul_f32 v225, v225, v23
  v_mul_f32 v226, v226, v23
  v_mul_f32 v227, v227, v23
  v_mul_f32 v228, v228, v23
  v_mul_f32 v229, v229, v23
  v_mul_f32 v230, v230, v23
  v_mul_f32 v231, v231, v23
  v_cvt_pk_bf16_f32 v80, v224, v225
  v_cvt_pk_bf16_f32 v81, v226, v227
  v_cvt_pk_bf16_f32 v82, v228, v229
  v_cvt_pk_bf16_f32 v83, v230, v231
  v_mul_f32 v232, v232, v23
  v_mul_f32 v233, v233, v23
  v_mul_f32 v234, v234, v23
  v_mul_f32 v235, v235, v23
  v_mul_f32 v236, v236, v23
  v_mul_f32 v237, v237, v23
  v_mul_f32 v238, v238, v23
  v_mul_f32 v239, v239, v23
  v_cvt_pk_bf16_f32 v84, v232, v233
  v_cvt_pk_bf16_f32 v85, v234, v235
  v_cvt_pk_bf16_f32 v86, v236, v237
  v_cvt_pk_bf16_f32 v87, v238, v239
  v_mul_f32 v240, v240, v23
  v_mul_f32 v241, v241, v23
  v_mul_f32 v242, v242, v23
  v_mul_f32 v243, v243, v23
  v_mul_f32 v244, v244, v23
  v_mul_f32 v245, v245, v23
  v_mul_f32 v246, v246, v23
  v_mul_f32 v247, v247, v23
  v_cvt_pk_bf16_f32 v88, v240, v241
  v_cvt_pk_bf16_f32 v89, v242, v243
  v_cvt_pk_bf16_f32 v90, v244, v245
  v_cvt_pk_bf16_f32 v91, v246, v247
  v_mul_f32 v248, v248, v23
  v_mul_f32 v249, v249, v23
  v_mul_f32 v250, v250, v23
  v_mul_f32 v251, v251, v23
  v_mul_f32 v252, v252, v23
  v_mul_f32 v253, v253, v23
  v_mul_f32 v254, v254, v23
  v_mul_f32 v255, v255, v23
  v_cvt_pk_bf16_f32 v92, v248, v249
  v_cvt_pk_bf16_f32 v93, v250, v251
  v_cvt_pk_bf16_f32 v94, v252, v253
  v_cvt_pk_bf16_f32 v95, v254, v255
  v_lshrrev_b32 v6, 2, v0
  v_lshlrev_b32 v8, 7, v6
  v_bfe_u32 v6, v0, 3, 2
  v_lshl_add_u32 v8, v6, 5, v8
  v_and_b32 v6, 3, v0
  v_lshl_add_u32 v8, v6, 3, v8
  v_xor_b32 v9, 32, v8
  v_xor_b32 v10, 64, v8
  v_xor_b32 v11, 96, v8
  v_add_u32 v12, 0x10000, v8
  v_add_u32 v13, 0x10000, v9
  v_add_u32 v14, 0x10000, v10
  v_add_u32 v15, 0x10000, v11
  s_waitcnt vmcnt(4)
  s_barrier
  ds_read_b64_tr_b16 a[64:65], v8 offset:0
  ds_read_b64_tr_b16 a[66:67], v8 offset:2048
  ds_read_b64_tr_b16 a[68:69], v8 offset:4096
  ds_read_b64_tr_b16 a[70:71], v8 offset:6144
  ds_read_b64_tr_b16 a[72:73], v8 offset:8192
  ds_read_b64_tr_b16 a[74:75], v8 offset:10240
  ds_read_b64_tr_b16 a[76:77], v8 offset:12288
  ds_read_b64_tr_b16 a[78:79], v8 offset:14336
  ds_read_b64_tr_b16 a[80:81], v9 offset:0
  ds_read_b64_tr_b16 a[82:83], v9 offset:2048
  ds_read_b64_tr_b16 a[84:85], v9 offset:4096
  ds_read_b64_tr_b16 a[86:87], v9 offset:6144
  ds_read_b64_tr_b16 a[88:89], v9 offset:8192
  ds_read_b64_tr_b16 a[90:91], v9 offset:10240
  ds_read_b64_tr_b16 a[92:93], v9 offset:12288
  ds_read_b64_tr_b16 a[94:95], v9 offset:14336
  s_waitcnt lgkmcnt(8)
  v_mfma_f32_16x16x32_bf16 v[128:131], a[64:67], v[32:35], 0
  ds_read_b64_tr_b16 a[96:97], v10 offset:0
  v_mfma_f32_16x16x32_bf16 v[128:131], a[68:71], v[36:39], v[128:131]
  v_mfma_f32_16x16x32_bf16 v[128:131], a[72:75], v[40:43], v[128:131]
  ds_read_b64_tr_b16 a[98:99], v10 offset:2048
  v_mfma_f32_16x16x32_bf16 v[128:131], a[76:79], v[44:47], v[128:131]
  v_mfma_f32_16x16x32_bf16 v[136:139], a[64:67], v[48:51], 0
  ds_read_b64_tr_b16 a[100:101], v10 offset:4096
  v_mfma_f32_16x16x32_bf16 v[136:139], a[68:71], v[52:55], v[136:139]
  v_mfma_f32_16x16x32_bf16 v[136:139], a[72:75], v[56:59], v[136:139]
  ds_read_b64_tr_b16 a[102:103], v10 offset:6144
  v_mfma_f32_16x16x32_bf16 v[136:139], a[76:79], v[60:63], v[136:139]
  v_mfma_f32_16x16x32_bf16 v[144:147], a[64:67], v[64:67], 0
  ds_read_b64_tr_b16 a[104:105], v10 offset:8192
  v_mfma_f32_16x16x32_bf16 v[144:147], a[68:71], v[68:71], v[144:147]
  v_mfma_f32_16x16x32_bf16 v[144:147], a[72:75], v[72:75], v[144:147]
  ds_read_b64_tr_b16 a[106:107], v10 offset:10240
  v_mfma_f32_16x16x32_bf16 v[144:147], a[76:79], v[76:79], v[144:147]
  v_mfma_f32_16x16x32_bf16 v[152:155], a[64:67], v[80:83], 0
  ds_read_b64_tr_b16 a[108:109], v10 offset:12288
  v_mfma_f32_16x16x32_bf16 v[152:155], a[68:71], v[84:87], v[152:155]
  v_mfma_f32_16x16x32_bf16 v[152:155], a[72:75], v[88:91], v[152:155]
  ds_read_b64_tr_b16 a[110:111], v10 offset:14336
  v_mfma_f32_16x16x32_bf16 v[152:155], a[76:79], v[92:95], v[152:155]
  s_waitcnt lgkmcnt(8)
  v_mfma_f32_16x16x32_bf16 v[132:135], a[80:83], v[32:35], 0
  ds_read_b64_tr_b16 a[112:113], v11 offset:0
  v_mfma_f32_16x16x32_bf16 v[132:135], a[84:87], v[36:39], v[132:135]
  v_mfma_f32_16x16x32_bf16 v[132:135], a[88:91], v[40:43], v[132:135]
  ds_read_b64_tr_b16 a[114:115], v11 offset:2048
  v_mfma_f32_16x16x32_bf16 v[132:135], a[92:95], v[44:47], v[132:135]
  v_mfma_f32_16x16x32_bf16 v[140:143], a[80:83], v[48:51], 0
  ds_read_b64_tr_b16 a[116:117], v11 offset:4096
  v_mfma_f32_16x16x32_bf16 v[140:143], a[84:87], v[52:55], v[140:143]
  v_mfma_f32_16x16x32_bf16 v[140:143], a[88:91], v[56:59], v[140:143]
  ds_read_b64_tr_b16 a[118:119], v11 offset:6144
  v_mfma_f32_16x16x32_bf16 v[140:143], a[92:95], v[60:63], v[140:143]
  v_mfma_f32_16x16x32_bf16 v[148:151], a[80:83], v[64:67], 0
  ds_read_b64_tr_b16 a[120:121], v11 offset:8192
  v_mfma_f32_16x16x32_bf16 v[148:151], a[84:87], v[68:71], v[148:151]
  v_mfma_f32_16x16x32_bf16 v[148:151], a[88:91], v[72:75], v[148:151]
  ds_read_b64_tr_b16 a[122:123], v11 offset:10240
  v_mfma_f32_16x16x32_bf16 v[148:151], a[92:95], v[76:79], v[148:151]
  v_mfma_f32_16x16x32_bf16 v[156:159], a[80:83], v[80:83], 0
  ds_read_b64_tr_b16 a[124:125], v11 offset:12288
  v_mfma_f32_16x16x32_bf16 v[156:159], a[84:87], v[84:87], v[156:159]
  v_mfma_f32_16x16x32_bf16 v[156:159], a[88:91], v[88:91], v[156:159]
  ds_read_b64_tr_b16 a[126:127], v11 offset:14336
  v_mfma_f32_16x16x32_bf16 v[156:159], a[92:95], v[92:95], v[156:159]
  s_waitcnt lgkmcnt(8)
  v_mfma_f32_16x16x32_bf16 v[160:163], a[96:99], v[32:35], 0
  ds_read_b64_tr_b16 a[64:65], v8 offset:16384
  v_mfma_f32_16x16x32_bf16 v[160:163], a[100:103], v[36:39], v[160:163]
  s_nop 1
  v_mfma_f32_16x16x32_bf16 v[160:163], a[104:107], v[40:43], v[160:163]
  ds_read_b64_tr_b16 a[66:67], v8 offset:18432
  v_mfma_f32_16x16x32_bf16 v[160:163], a[108:111], v[44:47], v[160:163]
  v_cvt_pk_bf16_f32 v96, v128, v129
  v_cvt_pk_bf16_f32 v97, v130, v131
  v_mfma_f32_16x16x32_bf16 v[168:171], a[96:99], v[48:51], 0
  ds_read_b64_tr_b16 a[68:69], v8 offset:20480
  v_mfma_f32_16x16x32_bf16 v[168:171], a[100:103], v[52:55], v[168:171]
  v_cvt_pk_bf16_f32 v98, v132, v133
  v_cvt_pk_bf16_f32 v99, v134, v135
  v_mfma_f32_16x16x32_bf16 v[168:171], a[104:107], v[56:59], v[168:171]
  ds_read_b64_tr_b16 a[70:71], v8 offset:22528
  v_mfma_f32_16x16x32_bf16 v[168:171], a[108:111], v[60:63], v[168:171]
  buffer_store_dwordx4 v[96:99], v2, s[40:43], s76 offen offset:0 sc1
  v_mfma_f32_16x16x32_bf16 v[176:179], a[96:99], v[64:67], 0
  ds_read_b64_tr_b16 a[72:73], v8 offset:24576
  v_mfma_f32_16x16x32_bf16 v[176:179], a[100:103], v[68:71], v[176:179]
  v_cvt_pk_bf16_f32 v100, v136, v137
  v_cvt_pk_bf16_f32 v101, v138, v139
  v_mfma_f32_16x16x32_bf16 v[176:179], a[104:107], v[72:75], v[176:179]
  ds_read_b64_tr_b16 a[74:75], v8 offset:26624
  v_mfma_f32_16x16x32_bf16 v[176:179], a[108:111], v[76:79], v[176:179]
  v_cvt_pk_bf16_f32 v102, v140, v141
  v_cvt_pk_bf16_f32 v103, v142, v143
  v_mfma_f32_16x16x32_bf16 v[184:187], a[96:99], v[80:83], 0
  ds_read_b64_tr_b16 a[76:77], v8 offset:28672
  v_mfma_f32_16x16x32_bf16 v[184:187], a[100:103], v[84:87], v[184:187]
  buffer_store_dwordx4 v[100:103], v2, s[40:43], s77 offen offset:0 sc1
  v_mfma_f32_16x16x32_bf16 v[184:187], a[104:107], v[88:91], v[184:187]
  ds_read_b64_tr_b16 a[78:79], v8 offset:30720
  v_mfma_f32_16x16x32_bf16 v[184:187], a[108:111], v[92:95], v[184:187]
  s_waitcnt lgkmcnt(8)
  v_cvt_pk_bf16_f32 v104, v144, v145
  v_cvt_pk_bf16_f32 v105, v146, v147
  v_mfma_f32_16x16x32_bf16 v[164:167], a[112:115], v[32:35], 0
  ds_read_b64_tr_b16 a[80:81], v9 offset:16384
  v_mfma_f32_16x16x32_bf16 v[164:167], a[116:119], v[36:39], v[164:167]
  v_cvt_pk_bf16_f32 v106, v148, v149
  v_cvt_pk_bf16_f32 v107, v150, v151
  v_mfma_f32_16x16x32_bf16 v[164:167], a[120:123], v[40:43], v[164:167]
  ds_read_b64_tr_b16 a[82:83], v9 offset:18432
  v_mfma_f32_16x16x32_bf16 v[164:167], a[124:127], v[44:47], v[164:167]
  buffer_store_dwordx4 v[104:107], v2, s[40:43], s78 offen offset:0 sc1
  v_mfma_f32_16x16x32_bf16 v[172:175], a[112:115], v[48:51], 0
  ds_read_b64_tr_b16 a[84:85], v9 offset:20480
  v_mfma_f32_16x16x32_bf16 v[172:175], a[116:119], v[52:55], v[172:175]
  v_cvt_pk_bf16_f32 v108, v152, v153
  v_cvt_pk_bf16_f32 v109, v154, v155
  v_mfma_f32_16x16x32_bf16 v[172:175], a[120:123], v[56:59], v[172:175]
  ds_read_b64_tr_b16 a[86:87], v9 offset:22528
  v_mfma_f32_16x16x32_bf16 v[172:175], a[124:127], v[60:63], v[172:175]
  v_cvt_pk_bf16_f32 v110, v156, v157
  v_cvt_pk_bf16_f32 v111, v158, v159
  v_mfma_f32_16x16x32_bf16 v[180:183], a[112:115], v[64:67], 0
  ds_read_b64_tr_b16 a[88:89], v9 offset:24576
  v_mfma_f32_16x16x32_bf16 v[180:183], a[116:119], v[68:71], v[180:183]
  buffer_store_dwordx4 v[108:111], v2, s[40:43], s79 offen offset:0 sc1
  v_mfma_f32_16x16x32_bf16 v[180:183], a[120:123], v[72:75], v[180:183]
  ds_read_b64_tr_b16 a[90:91], v9 offset:26624
  v_mfma_f32_16x16x32_bf16 v[180:183], a[124:127], v[76:79], v[180:183]
  v_mfma_f32_16x16x32_bf16 v[188:191], a[112:115], v[80:83], 0
  ds_read_b64_tr_b16 a[92:93], v9 offset:28672
  v_mfma_f32_16x16x32_bf16 v[188:191], a[116:119], v[84:87], v[188:191]
  v_mfma_f32_16x16x32_bf16 v[188:191], a[120:123], v[88:91], v[188:191]
  ds_read_b64_tr_b16 a[94:95], v9 offset:30720
  v_mfma_f32_16x16x32_bf16 v[188:191], a[124:127], v[92:95], v[188:191]
  s_waitcnt lgkmcnt(8)
  v_mfma_f32_16x16x32_bf16 v[128:131], a[64:67], v[32:35], 0
  ds_read_b64_tr_b16 a[96:97], v10 offset:16384
  v_mfma_f32_16x16x32_bf16 v[128:131], a[68:71], v[36:39], v[128:131]
  s_nop 1
  v_mfma_f32_16x16x32_bf16 v[128:131], a[72:75], v[40:43], v[128:131]
  ds_read_b64_tr_b16 a[98:99], v10 offset:18432
  v_mfma_f32_16x16x32_bf16 v[128:131], a[76:79], v[44:47], v[128:131]
  v_cvt_pk_bf16_f32 v112, v160, v161
  v_cvt_pk_bf16_f32 v113, v162, v163
  v_mfma_f32_16x16x32_bf16 v[136:139], a[64:67], v[48:51], 0
  ds_read_b64_tr_b16 a[100:101], v10 offset:20480
  v_mfma_f32_16x16x32_bf16 v[136:139], a[68:71], v[52:55], v[136:139]
  v_cvt_pk_bf16_f32 v114, v164, v165
  v_cvt_pk_bf16_f32 v115, v166, v167
  v_mfma_f32_16x16x32_bf16 v[136:139], a[72:75], v[56:59], v[136:139]
  ds_read_b64_tr_b16 a[102:103], v10 offset:22528
  v_mfma_f32_16x16x32_bf16 v[136:139], a[76:79], v[60:63], v[136:139]
  buffer_store_dwordx4 v[112:115], v2, s[40:43], s76 offen offset:1024 sc1
  v_mfma_f32_16x16x32_bf16 v[144:147], a[64:67], v[64:67], 0
  ds_read_b64_tr_b16 a[104:105], v10 offset:24576
  v_mfma_f32_16x16x32_bf16 v[144:147], a[68:71], v[68:71], v[144:147]
  v_cvt_pk_bf16_f32 v116, v168, v169
  v_cvt_pk_bf16_f32 v117, v170, v171
  v_mfma_f32_16x16x32_bf16 v[144:147], a[72:75], v[72:75], v[144:147]
  ds_read_b64_tr_b16 a[106:107], v10 offset:26624
  v_mfma_f32_16x16x32_bf16 v[144:147], a[76:79], v[76:79], v[144:147]
  v_cvt_pk_bf16_f32 v118, v172, v173
  v_cvt_pk_bf16_f32 v119, v174, v175
  v_mfma_f32_16x16x32_bf16 v[152:155], a[64:67], v[80:83], 0
  ds_read_b64_tr_b16 a[108:109], v10 offset:28672
  v_mfma_f32_16x16x32_bf16 v[152:155], a[68:71], v[84:87], v[152:155]
  buffer_store_dwordx4 v[116:119], v2, s[40:43], s77 offen offset:1024 sc1
  v_mfma_f32_16x16x32_bf16 v[152:155], a[72:75], v[88:91], v[152:155]
  ds_read_b64_tr_b16 a[110:111], v10 offset:30720
  v_mfma_f32_16x16x32_bf16 v[152:155], a[76:79], v[92:95], v[152:155]
  s_waitcnt lgkmcnt(8)
  v_cvt_pk_bf16_f32 v120, v176, v177
  v_cvt_pk_bf16_f32 v121, v178, v179
  v_mfma_f32_16x16x32_bf16 v[132:135], a[80:83], v[32:35], 0
  ds_read_b64_tr_b16 a[112:113], v11 offset:16384
  v_mfma_f32_16x16x32_bf16 v[132:135], a[84:87], v[36:39], v[132:135]
  v_cvt_pk_bf16_f32 v122, v180, v181
  v_cvt_pk_bf16_f32 v123, v182, v183
  v_mfma_f32_16x16x32_bf16 v[132:135], a[88:91], v[40:43], v[132:135]
  ds_read_b64_tr_b16 a[114:115], v11 offset:18432
  v_mfma_f32_16x16x32_bf16 v[132:135], a[92:95], v[44:47], v[132:135]
  buffer_store_dwordx4 v[120:123], v2, s[40:43], s78 offen offset:1024 sc1
  v_mfma_f32_16x16x32_bf16 v[140:143], a[80:83], v[48:51], 0
  ds_read_b64_tr_b16 a[116:117], v11 offset:20480
  v_mfma_f32_16x16x32_bf16 v[140:143], a[84:87], v[52:55], v[140:143]
  v_cvt_pk_bf16_f32 v124, v184, v185
  v_cvt_pk_bf16_f32 v125, v186, v187
  v_mfma_f32_16x16x32_bf16 v[140:143], a[88:91], v[56:59], v[140:143]
  ds_read_b64_tr_b16 a[118:119], v11 offset:22528
  v_mfma_f32_16x16x32_bf16 v[140:143], a[92:95], v[60:63], v[140:143]
  v_cvt_pk_bf16_f32 v126, v188, v189
  v_cvt_pk_bf16_f32 v127, v190, v191
  v_mfma_f32_16x16x32_bf16 v[148:151], a[80:83], v[64:67], 0
  ds_read_b64_tr_b16 a[120:121], v11 offset:24576
  v_mfma_f32_16x16x32_bf16 v[148:151], a[84:87], v[68:71], v[148:151]
  buffer_store_dwordx4 v[124:127], v2, s[40:43], s79 offen offset:1024 sc1
  v_mfma_f32_16x16x32_bf16 v[148:151], a[88:91], v[72:75], v[148:151]
  ds_read_b64_tr_b16 a[122:123], v11 offset:26624
  v_mfma_f32_16x16x32_bf16 v[148:151], a[92:95], v[76:79], v[148:151]
  v_mfma_f32_16x16x32_bf16 v[156:159], a[80:83], v[80:83], 0
  ds_read_b64_tr_b16 a[124:125], v11 offset:28672
  v_mfma_f32_16x16x32_bf16 v[156:159], a[84:87], v[84:87], v[156:159]
  v_mfma_f32_16x16x32_bf16 v[156:159], a[88:91], v[88:91], v[156:159]
  ds_read_b64_tr_b16 a[126:127], v11 offset:30720
  v_mfma_f32_16x16x32_bf16 v[156:159], a[92:95], v[92:95], v[156:159]
  s_waitcnt lgkmcnt(8)
  v_mfma_f32_16x16x32_bf16 v[160:163], a[96:99], v[32:35], 0
  ds_read_b64_tr_b16 a[64:65], v8 offset:32768
  v_mfma_f32_16x16x32_bf16 v[160:163], a[100:103], v[36:39], v[160:163]
  s_nop 1
  v_mfma_f32_16x16x32_bf16 v[160:163], a[104:107], v[40:43], v[160:163]
  ds_read_b64_tr_b16 a[66:67], v8 offset:34816
  v_mfma_f32_16x16x32_bf16 v[160:163], a[108:111], v[44:47], v[160:163]
  v_cvt_pk_bf16_f32 v96, v128, v129
  v_cvt_pk_bf16_f32 v97, v130, v131
  v_mfma_f32_16x16x32_bf16 v[168:171], a[96:99], v[48:51], 0
  ds_read_b64_tr_b16 a[68:69], v8 offset:36864
  v_mfma_f32_16x16x32_bf16 v[168:171], a[100:103], v[52:55], v[168:171]
  v_cvt_pk_bf16_f32 v98, v132, v133
  v_cvt_pk_bf16_f32 v99, v134, v135
  v_mfma_f32_16x16x32_bf16 v[168:171], a[104:107], v[56:59], v[168:171]
  ds_read_b64_tr_b16 a[70:71], v8 offset:38912
  v_mfma_f32_16x16x32_bf16 v[168:171], a[108:111], v[60:63], v[168:171]
  buffer_store_dwordx4 v[96:99], v2, s[40:43], s76 offen offset:2048 sc1
  v_mfma_f32_16x16x32_bf16 v[176:179], a[96:99], v[64:67], 0
  ds_read_b64_tr_b16 a[72:73], v8 offset:40960
  v_mfma_f32_16x16x32_bf16 v[176:179], a[100:103], v[68:71], v[176:179]
  v_cvt_pk_bf16_f32 v100, v136, v137
  v_cvt_pk_bf16_f32 v101, v138, v139
  v_mfma_f32_16x16x32_bf16 v[176:179], a[104:107], v[72:75], v[176:179]
  ds_read_b64_tr_b16 a[74:75], v8 offset:43008
  v_mfma_f32_16x16x32_bf16 v[176:179], a[108:111], v[76:79], v[176:179]
  v_cvt_pk_bf16_f32 v102, v140, v141
  v_cvt_pk_bf16_f32 v103, v142, v143
  v_mfma_f32_16x16x32_bf16 v[184:187], a[96:99], v[80:83], 0
  ds_read_b64_tr_b16 a[76:77], v8 offset:45056
  v_mfma_f32_16x16x32_bf16 v[184:187], a[100:103], v[84:87], v[184:187]
  buffer_store_dwordx4 v[100:103], v2, s[40:43], s77 offen offset:2048 sc1
  v_mfma_f32_16x16x32_bf16 v[184:187], a[104:107], v[88:91], v[184:187]
  ds_read_b64_tr_b16 a[78:79], v8 offset:47104
  v_mfma_f32_16x16x32_bf16 v[184:187], a[108:111], v[92:95], v[184:187]
  s_waitcnt lgkmcnt(8)
  v_cvt_pk_bf16_f32 v104, v144, v145
  v_cvt_pk_bf16_f32 v105, v146, v147
  v_mfma_f32_16x16x32_bf16 v[164:167], a[112:115], v[32:35], 0
  ds_read_b64_tr_b16 a[80:81], v9 offset:32768
  v_mfma_f32_16x16x32_bf16 v[164:167], a[116:119], v[36:39], v[164:167]
  v_cvt_pk_bf16_f32 v106, v148, v149
  v_cvt_pk_bf16_f32 v107, v150, v151
  v_mfma_f32_16x16x32_bf16 v[164:167], a[120:123], v[40:43], v[164:167]
  ds_read_b64_tr_b16 a[82:83], v9 offset:34816
  v_mfma_f32_16x16x32_bf16 v[164:167], a[124:127], v[44:47], v[164:167]
  buffer_store_dwordx4 v[104:107], v2, s[40:43], s78 offen offset:2048 sc1
  v_mfma_f32_16x16x32_bf16 v[172:175], a[112:115], v[48:51], 0
  ds_read_b64_tr_b16 a[84:85], v9 offset:36864
  v_mfma_f32_16x16x32_bf16 v[172:175], a[116:119], v[52:55], v[172:175]
  v_cvt_pk_bf16_f32 v108, v152, v153
  v_cvt_pk_bf16_f32 v109, v154, v155
  v_mfma_f32_16x16x32_bf16 v[172:175], a[120:123], v[56:59], v[172:175]
  ds_read_b64_tr_b16 a[86:87], v9 offset:38912
  v_mfma_f32_16x16x32_bf16 v[172:175], a[124:127], v[60:63], v[172:175]
  v_cvt_pk_bf16_f32 v110, v156, v157
  v_cvt_pk_bf16_f32 v111, v158, v159
  v_mfma_f32_16x16x32_bf16 v[180:183], a[112:115], v[64:67], 0
  ds_read_b64_tr_b16 a[88:89], v9 offset:40960
  v_mfma_f32_16x16x32_bf16 v[180:183], a[116:119], v[68:71], v[180:183]
  buffer_store_dwordx4 v[108:111], v2, s[40:43], s79 offen offset:2048 sc1
  v_mfma_f32_16x16x32_bf16 v[180:183], a[120:123], v[72:75], v[180:183]
  ds_read_b64_tr_b16 a[90:91], v9 offset:43008
  v_mfma_f32_16x16x32_bf16 v[180:183], a[124:127], v[76:79], v[180:183]
  v_mfma_f32_16x16x32_bf16 v[188:191], a[112:115], v[80:83], 0
  ds_read_b64_tr_b16 a[92:93], v9 offset:45056
  v_mfma_f32_16x16x32_bf16 v[188:191], a[116:119], v[84:87], v[188:191]
  v_mfma_f32_16x16x32_bf16 v[188:191], a[120:123], v[88:91], v[188:191]
  ds_read_b64_tr_b16 a[94:95], v9 offset:47104
  v_mfma_f32_16x16x32_bf16 v[188:191], a[124:127], v[92:95], v[188:191]
  s_waitcnt lgkmcnt(8)
  v_mfma_f32_16x16x32_bf16 v[128:131], a[64:67], v[32:35], 0
  ds_read_b64_tr_b16 a[96:97], v10 offset:32768
  v_mfma_f32_16x16x32_bf16 v[128:131], a[68:71], v[36:39], v[128:131]
  s_nop 1
  v_mfma_f32_16x16x32_bf16 v[128:131], a[72:75], v[40:43], v[128:131]
  ds_read_b64_tr_b16 a[98:99], v10 offset:34816
  v_mfma_f32_16x16x32_bf16 v[128:131], a[76:79], v[44:47], v[128:131]
  v_cvt_pk_bf16_f32 v112, v160, v161
  v_cvt_pk_bf16_f32 v113, v162, v163
  v_mfma_f32_16x16x32_bf16 v[136:139], a[64:67], v[48:51], 0
  ds_read_b64_tr_b16 a[100:101], v10 offset:36864
  v_mfma_f32_16x16x32_bf16 v[136:139], a[68:71], v[52:55], v[136:139]
  v_cvt_pk_bf16_f32 v114, v164, v165
  v_cvt_pk_bf16_f32 v115, v166, v167
  v_mfma_f32_16x16x32_bf16 v[136:139], a[72:75], v[56:59], v[136:139]
  ds_read_b64_tr_b16 a[102:103], v10 offset:38912
  v_mfma_f32_16x16x32_bf16 v[136:139], a[76:79], v[60:63], v[136:139]
  buffer_store_dwordx4 v[112:115], v2, s[40:43], s76 offen offset:3072 sc1
  v_mfma_f32_16x16x32_bf16 v[144:147], a[64:67], v[64:67], 0
  ds_read_b64_tr_b16 a[104:105], v10 offset:40960
  v_mfma_f32_16x16x32_bf16 v[144:147], a[68:71], v[68:71], v[144:147]
  v_cvt_pk_bf16_f32 v116, v168, v169
  v_cvt_pk_bf16_f32 v117, v170, v171
  v_mfma_f32_16x16x32_bf16 v[144:147], a[72:75], v[72:75], v[144:147]
  ds_read_b64_tr_b16 a[106:107], v10 offset:43008
  v_mfma_f32_16x16x32_bf16 v[144:147], a[76:79], v[76:79], v[144:147]
  v_cvt_pk_bf16_f32 v118, v172, v173
  v_cvt_pk_bf16_f32 v119, v174, v175
  v_mfma_f32_16x16x32_bf16 v[152:155], a[64:67], v[80:83], 0
  ds_read_b64_tr_b16 a[108:109], v10 offset:45056
  v_mfma_f32_16x16x32_bf16 v[152:155], a[68:71], v[84:87], v[152:155]
  buffer_store_dwordx4 v[116:119], v2, s[40:43], s77 offen offset:3072 sc1
  v_mfma_f32_16x16x32_bf16 v[152:155], a[72:75], v[88:91], v[152:155]
  ds_read_b64_tr_b16 a[110:111], v10 offset:47104
  v_mfma_f32_16x16x32_bf16 v[152:155], a[76:79], v[92:95], v[152:155]
  s_waitcnt lgkmcnt(8)
  v_cvt_pk_bf16_f32 v120, v176, v177
  v_cvt_pk_bf16_f32 v121, v178, v179
  v_mfma_f32_16x16x32_bf16 v[132:135], a[80:83], v[32:35], 0
  ds_read_b64_tr_b16 a[112:113], v11 offset:32768
  v_mfma_f32_16x16x32_bf16 v[132:135], a[84:87], v[36:39], v[132:135]
  v_cvt_pk_bf16_f32 v122, v180, v181
  v_cvt_pk_bf16_f32 v123, v182, v183
  v_mfma_f32_16x16x32_bf16 v[132:135], a[88:91], v[40:43], v[132:135]
  ds_read_b64_tr_b16 a[114:115], v11 offset:34816
  v_mfma_f32_16x16x32_bf16 v[132:135], a[92:95], v[44:47], v[132:135]
  buffer_store_dwordx4 v[120:123], v2, s[40:43], s78 offen offset:3072 sc1
  v_mfma_f32_16x16x32_bf16 v[140:143], a[80:83], v[48:51], 0
  ds_read_b64_tr_b16 a[116:117], v11 offset:36864
  v_mfma_f32_16x16x32_bf16 v[140:143], a[84:87], v[52:55], v[140:143]
  v_cvt_pk_bf16_f32 v124, v184, v185
  v_cvt_pk_bf16_f32 v125, v186, v187
  v_mfma_f32_16x16x32_bf16 v[140:143], a[88:91], v[56:59], v[140:143]
  ds_read_b64_tr_b16 a[118:119], v11 offset:38912
  v_mfma_f32_16x16x32_bf16 v[140:143], a[92:95], v[60:63], v[140:143]
  v_cvt_pk_bf16_f32 v126, v188, v189
  v_cvt_pk_bf16_f32 v127, v190, v191
  v_mfma_f32_16x16x32_bf16 v[148:151], a[80:83], v[64:67], 0
  ds_read_b64_tr_b16 a[120:121], v11 offset:40960
  v_mfma_f32_16x16x32_bf16 v[148:151], a[84:87], v[68:71], v[148:151]
  buffer_store_dwordx4 v[124:127], v2, s[40:43], s79 offen offset:3072 sc1
  v_mfma_f32_16x16x32_bf16 v[148:151], a[88:91], v[72:75], v[148:151]
  ds_read_b64_tr_b16 a[122:123], v11 offset:43008
  v_mfma_f32_16x16x32_bf16 v[148:151], a[92:95], v[76:79], v[148:151]
  v_mfma_f32_16x16x32_bf16 v[156:159], a[80:83], v[80:83], 0
  ds_read_b64_tr_b16 a[124:125], v11 offset:45056
  v_mfma_f32_16x16x32_bf16 v[156:159], a[84:87], v[84:87], v[156:159]
  v_mfma_f32_16x16x32_bf16 v[156:159], a[88:91], v[88:91], v[156:159]
  ds_read_b64_tr_b16 a[126:127], v11 offset:47104
  v_mfma_f32_16x16x32_bf16 v[156:159], a[92:95], v[92:95], v[156:159]
  s_waitcnt lgkmcnt(8)
  v_mfma_f32_16x16x32_bf16 v[160:163], a[96:99], v[32:35], 0
  ds_read_b64_tr_b16 a[64:65], v8 offset:49152
  v_mfma_f32_16x16x32_bf16 v[160:163], a[100:103], v[36:39], v[160:163]
  s_add_u32 s76, s76, 0x1000
  s_add_u32 s77, s77, 0x1000
  s_add_u32 s78, s78, 0x1000
  s_add_u32 s79, s79, 0x1000
  v_mfma_f32_16x16x32_bf16 v[160:163], a[104:107], v[40:43], v[160:163]
  ds_read_b64_tr_b16 a[66:67], v8 offset:51200
  v_mfma_f32_16x16x32_bf16 v[160:163], a[108:111], v[44:47], v[160:163]
  v_cvt_pk_bf16_f32 v96, v128, v129
  v_cvt_pk_bf16_f32 v97, v130, v131
  v_mfma_f32_16x16x32_bf16 v[168:171], a[96:99], v[48:51], 0
  ds_read_b64_tr_b16 a[68:69], v8 offset:53248
  v_mfma_f32_16x16x32_bf16 v[168:171], a[100:103], v[52:55], v[168:171]
  v_cvt_pk_bf16_f32 v98, v132, v133
  v_cvt_pk_bf16_f32 v99, v134, v135
  v_mfma_f32_16x16x32_bf16 v[168:171], a[104:107], v[56:59], v[168:171]
  ds_read_b64_tr_b16 a[70:71], v8 offset:55296
  v_mfma_f32_16x16x32_bf16 v[168:171], a[108:111], v[60:63], v[168:171]
  buffer_store_dwordx4 v[96:99], v2, s[40:43], s76 offen offset:0 sc1
  v_mfma_f32_16x16x32_bf16 v[176:179], a[96:99], v[64:67], 0
  ds_read_b64_tr_b16 a[72:73], v8 offset:57344
  v_mfma_f32_16x16x32_bf16 v[176:179], a[100:103], v[68:71], v[176:179]
  v_cvt_pk_bf16_f32 v100, v136, v137
  v_cvt_pk_bf16_f32 v101, v138, v139
  v_mfma_f32_16x16x32_bf16 v[176:179], a[104:107], v[72:75], v[176:179]
  ds_read_b64_tr_b16 a[74:75], v8 offset:59392
  v_mfma_f32_16x16x32_bf16 v[176:179], a[108:111], v[76:79], v[176:179]
  v_cvt_pk_bf16_f32 v102, v140, v141
  v_cvt_pk_bf16_f32 v103, v142, v143
  v_mfma_f32_16x16x32_bf16 v[184:187], a[96:99], v[80:83], 0
  ds_read_b64_tr_b16 a[76:77], v8 offset:61440
  v_mfma_f32_16x16x32_bf16 v[184:187], a[100:103], v[84:87], v[184:187]
  buffer_store_dwordx4 v[100:103], v2, s[40:43], s77 offen offset:0 sc1
  v_mfma_f32_16x16x32_bf16 v[184:187], a[104:107], v[88:91], v[184:187]
  ds_read_b64_tr_b16 a[78:79], v8 offset:63488
  v_mfma_f32_16x16x32_bf16 v[184:187], a[108:111], v[92:95], v[184:187]
  s_waitcnt lgkmcnt(8)
  v_cvt_pk_bf16_f32 v104, v144, v145
  v_cvt_pk_bf16_f32 v105, v146, v147
  v_mfma_f32_16x16x32_bf16 v[164:167], a[112:115], v[32:35], 0
  ds_read_b64_tr_b16 a[80:81], v9 offset:49152
  v_mfma_f32_16x16x32_bf16 v[164:167], a[116:119], v[36:39], v[164:167]
  v_cvt_pk_bf16_f32 v106, v148, v149
  v_cvt_pk_bf16_f32 v107, v150, v151
  v_mfma_f32_16x16x32_bf16 v[164:167], a[120:123], v[40:43], v[164:167]
  ds_read_b64_tr_b16 a[82:83], v9 offset:51200
  v_mfma_f32_16x16x32_bf16 v[164:167], a[124:127], v[44:47], v[164:167]
  buffer_store_dwordx4 v[104:107], v2, s[40:43], s78 offen offset:0 sc1
  v_mfma_f32_16x16x32_bf16 v[172:175], a[112:115], v[48:51], 0
  ds_read_b64_tr_b16 a[84:85], v9 offset:53248
  v_mfma_f32_16x16x32_bf16 v[172:175], a[116:119], v[52:55], v[172:175]
  v_cvt_pk_bf16_f32 v108, v152, v153
  v_cvt_pk_bf16_f32 v109, v154, v155
  v_mfma_f32_16x16x32_bf16 v[172:175], a[120:123], v[56:59], v[172:175]
  ds_read_b64_tr_b16 a[86:87], v9 offset:55296
  v_mfma_f32_16x16x32_bf16 v[172:175], a[124:127], v[60:63], v[172:175]
  v_cvt_pk_bf16_f32 v110, v156, v157
  v_cvt_pk_bf16_f32 v111, v158, v159
  v_mfma_f32_16x16x32_bf16 v[180:183], a[112:115], v[64:67], 0
  ds_read_b64_tr_b16 a[88:89], v9 offset:57344
  v_mfma_f32_16x16x32_bf16 v[180:183], a[116:119], v[68:71], v[180:183]
  buffer_store_dwordx4 v[108:111], v2, s[40:43], s79 offen offset:0 sc1
  v_mfma_f32_16x16x32_bf16 v[180:183], a[120:123], v[72:75], v[180:183]
  ds_read_b64_tr_b16 a[90:91], v9 offset:59392
  v_mfma_f32_16x16x32_bf16 v[180:183], a[124:127], v[76:79], v[180:183]
  v_mfma_f32_16x16x32_bf16 v[188:191], a[112:115], v[80:83], 0
  ds_read_b64_tr_b16 a[92:93], v9 offset:61440
  v_mfma_f32_16x16x32_bf16 v[188:191], a[116:119], v[84:87], v[188:191]
  v_mfma_f32_16x16x32_bf16 v[188:191], a[120:123], v[88:91], v[188:191]
  ds_read_b64_tr_b16 a[94:95], v9 offset:63488
  v_mfma_f32_16x16x32_bf16 v[188:191], a[124:127], v[92:95], v[188:191]
  s_waitcnt lgkmcnt(8)
  v_mfma_f32_16x16x32_bf16 v[128:131], a[64:67], v[32:35], 0
  ds_read_b64_tr_b16 a[96:97], v10 offset:49152
  v_mfma_f32_16x16x32_bf16 v[128:131], a[68:71], v[36:39], v[128:131]
  s_nop 1
  v_mfma_f32_16x16x32_bf16 v[128:131], a[72:75], v[40:43], v[128:131]
  ds_read_b64_tr_b16 a[98:99], v10 offset:51200
  v_mfma_f32_16x16x32_bf16 v[128:131], a[76:79], v[44:47], v[128:131]
  v_cvt_pk_bf16_f32 v112, v160, v161
  v_cvt_pk_bf16_f32 v113, v162, v163
  v_mfma_f32_16x16x32_bf16 v[136:139], a[64:67], v[48:51], 0
  ds_read_b64_tr_b16 a[100:101], v10 offset:53248
  v_mfma_f32_16x16x32_bf16 v[136:139], a[68:71], v[52:55], v[136:139]
  v_cvt_pk_bf16_f32 v114, v164, v165
  v_cvt_pk_bf16_f32 v115, v166, v167
  v_mfma_f32_16x16x32_bf16 v[136:139], a[72:75], v[56:59], v[136:139]
  ds_read_b64_tr_b16 a[102:103], v10 offset:55296
  v_mfma_f32_16x16x32_bf16 v[136:139], a[76:79], v[60:63], v[136:139]
  buffer_store_dwordx4 v[112:115], v2, s[40:43], s76 offen offset:1024 sc1
  v_mfma_f32_16x16x32_bf16 v[144:147], a[64:67], v[64:67], 0
  ds_read_b64_tr_b16 a[104:105], v10 offset:57344
  v_mfma_f32_16x16x32_bf16 v[144:147], a[68:71], v[68:71], v[144:147]
  v_cvt_pk_bf16_f32 v116, v168, v169
  v_cvt_pk_bf16_f32 v117, v170, v171
  v_mfma_f32_16x16x32_bf16 v[144:147], a[72:75], v[72:75], v[144:147]
  ds_read_b64_tr_b16 a[106:107], v10 offset:59392
  v_mfma_f32_16x16x32_bf16 v[144:147], a[76:79], v[76:79], v[144:147]
  v_cvt_pk_bf16_f32 v118, v172, v173
  v_cvt_pk_bf16_f32 v119, v174, v175
  v_mfma_f32_16x16x32_bf16 v[152:155], a[64:67], v[80:83], 0
  ds_read_b64_tr_b16 a[108:109], v10 offset:61440
  v_mfma_f32_16x16x32_bf16 v[152:155], a[68:71], v[84:87], v[152:155]
  buffer_store_dwordx4 v[116:119], v2, s[40:43], s77 offen offset:1024 sc1
  v_mfma_f32_16x16x32_bf16 v[152:155], a[72:75], v[88:91], v[152:155]
  ds_read_b64_tr_b16 a[110:111], v10 offset:63488
  v_mfma_f32_16x16x32_bf16 v[152:155], a[76:79], v[92:95], v[152:155]
  s_waitcnt lgkmcnt(8)
  v_cvt_pk_bf16_f32 v120, v176, v177
  v_cvt_pk_bf16_f32 v121, v178, v179
  v_mfma_f32_16x16x32_bf16 v[132:135], a[80:83], v[32:35], 0
  ds_read_b64_tr_b16 a[112:113], v11 offset:49152
  v_mfma_f32_16x16x32_bf16 v[132:135], a[84:87], v[36:39], v[132:135]
  v_cvt_pk_bf16_f32 v122, v180, v181
  v_cvt_pk_bf16_f32 v123, v182, v183
  v_mfma_f32_16x16x32_bf16 v[132:135], a[88:91], v[40:43], v[132:135]
  ds_read_b64_tr_b16 a[114:115], v11 offset:51200
  v_mfma_f32_16x16x32_bf16 v[132:135], a[92:95], v[44:47], v[132:135]
  buffer_store_dwordx4 v[120:123], v2, s[40:43], s78 offen offset:1024 sc1
  v_mfma_f32_16x16x32_bf16 v[140:143], a[80:83], v[48:51], 0
  ds_read_b64_tr_b16 a[116:117], v11 offset:53248
  v_mfma_f32_16x16x32_bf16 v[140:143], a[84:87], v[52:55], v[140:143]
  v_cvt_pk_bf16_f32 v124, v184, v185
  v_cvt_pk_bf16_f32 v125, v186, v187
  v_mfma_f32_16x16x32_bf16 v[140:143], a[88:91], v[56:59], v[140:143]
  ds_read_b64_tr_b16 a[118:119], v11 offset:55296
  v_mfma_f32_16x16x32_bf16 v[140:143], a[92:95], v[60:63], v[140:143]
  v_cvt_pk_bf16_f32 v126, v188, v189
  v_cvt_pk_bf16_f32 v127, v190, v191
  v_mfma_f32_16x16x32_bf16 v[148:151], a[80:83], v[64:67], 0
  ds_read_b64_tr_b16 a[120:121], v11 offset:57344
  v_mfma_f32_16x16x32_bf16 v[148:151], a[84:87], v[68:71], v[148:151]
  buffer_store_dwordx4 v[124:127], v2, s[40:43], s79 offen offset:1024 sc1
  v_mfma_f32_16x16x32_bf16 v[148:151], a[88:91], v[72:75], v[148:151]
  ds_read_b64_tr_b16 a[122:123], v11 offset:59392
  v_mfma_f32_16x16x32_bf16 v[148:151], a[92:95], v[76:79], v[148:151]
  v_mfma_f32_16x16x32_bf16 v[156:159], a[80:83], v[80:83], 0
  ds_read_b64_tr_b16 a[124:125], v11 offset:61440
  v_mfma_f32_16x16x32_bf16 v[156:159], a[84:87], v[84:87], v[156:159]
  v_mfma_f32_16x16x32_bf16 v[156:159], a[88:91], v[88:91], v[156:159]
  ds_read_b64_tr_b16 a[126:127], v11 offset:63488
  v_mfma_f32_16x16x32_bf16 v[156:159], a[92:95], v[92:95], v[156:159]
  s_waitcnt lgkmcnt(8)
  v_mfma_f32_16x16x32_bf16 v[160:163], a[96:99], v[32:35], 0
  ds_read_b64_tr_b16 a[64:65], v12 offset:0
  v_mfma_f32_16x16x32_bf16 v[160:163], a[100:103], v[36:39], v[160:163]
  s_nop 1
  v_mfma_f32_16x16x32_bf16 v[160:163], a[104:107], v[40:43], v[160:163]
  ds_read_b64_tr_b16 a[66:67], v12 offset:2048
  v_mfma_f32_16x16x32_bf16 v[160:163], a[108:111], v[44:47], v[160:163]
  v_cvt_pk_bf16_f32 v96, v128, v129
  v_cvt_pk_bf16_f32 v97, v130, v131
  v_mfma_f32_16x16x32_bf16 v[168:171], a[96:99], v[48:51], 0
  ds_read_b64_tr_b16 a[68:69], v12 offset:4096
  v_mfma_f32_16x16x32_bf16 v[168:171], a[100:103], v[52:55], v[168:171]
  v_cvt_pk_bf16_f32 v98, v132, v133
  v_cvt_pk_bf16_f32 v99, v134, v135
  v_mfma_f32_16x16x32_bf16 v[168:171], a[104:107], v[56:59], v[168:171]
  ds_read_b64_tr_b16 a[70:71], v12 offset:6144
  v_mfma_f32_16x16x32_bf16 v[168:171], a[108:111], v[60:63], v[168:171]
  buffer_store_dwordx4 v[96:99], v2, s[40:43], s76 offen offset:2048 sc1
  v_mfma_f32_16x16x32_bf16 v[176:179], a[96:99], v[64:67], 0
  ds_read_b64_tr_b16 a[72:73], v12 offset:8192
  v_mfma_f32_16x16x32_bf16 v[176:179], a[100:103], v[68:71], v[176:179]
  v_cvt_pk_bf16_f32 v100, v136, v137
  v_cvt_pk_bf16_f32 v101, v138, v139
  v_mfma_f32_16x16x32_bf16 v[176:179], a[104:107], v[72:75], v[176:179]
  ds_read_b64_tr_b16 a[74:75], v12 offset:10240
  v_mfma_f32_16x16x32_bf16 v[176:179], a[108:111], v[76:79], v[176:179]
  v_cvt_pk_bf16_f32 v102, v140, v141
  v_cvt_pk_bf16_f32 v103, v142, v143
  v_mfma_f32_16x16x32_bf16 v[184:187], a[96:99], v[80:83], 0
  ds_read_b64_tr_b16 a[76:77], v12 offset:12288
  v_mfma_f32_16x16x32_bf16 v[184:187], a[100:103], v[84:87], v[184:187]
  buffer_store_dwordx4 v[100:103], v2, s[40:43], s77 offen offset:2048 sc1
  v_mfma_f32_16x16x32_bf16 v[184:187], a[104:107], v[88:91], v[184:187]
  ds_read_b64_tr_b16 a[78:79], v12 offset:14336
  v_mfma_f32_16x16x32_bf16 v[184:187], a[108:111], v[92:95], v[184:187]
  s_waitcnt lgkmcnt(8)
  v_cvt_pk_bf16_f32 v104, v144, v145
  v_cvt_pk_bf16_f32 v105, v146, v147
  v_mfma_f32_16x16x32_bf16 v[164:167], a[112:115], v[32:35], 0
  ds_read_b64_tr_b16 a[80:81], v13 offset:0
  v_mfma_f32_16x16x32_bf16 v[164:167], a[116:119], v[36:39], v[164:167]
  v_cvt_pk_bf16_f32 v106, v148, v149
  v_cvt_pk_bf16_f32 v107, v150, v151
  v_mfma_f32_16x16x32_bf16 v[164:167], a[120:123], v[40:43], v[164:167]
  ds_read_b64_tr_b16 a[82:83], v13 offset:2048
  v_mfma_f32_16x16x32_bf16 v[164:167], a[124:127], v[44:47], v[164:167]
  buffer_store_dwordx4 v[104:107], v2, s[40:43], s78 offen offset:2048 sc1
  v_mfma_f32_16x16x32_bf16 v[172:175], a[112:115], v[48:51], 0
  ds_read_b64_tr_b16 a[84:85], v13 offset:4096
  v_mfma_f32_16x16x32_bf16 v[172:175], a[116:119], v[52:55], v[172:175]
  v_cvt_pk_bf16_f32 v108, v152, v153
  v_cvt_pk_bf16_f32 v109, v154, v155
  v_mfma_f32_16x16x32_bf16 v[172:175], a[120:123], v[56:59], v[172:175]
  ds_read_b64_tr_b16 a[86:87], v13 offset:6144
  v_mfma_f32_16x16x32_bf16 v[172:175], a[124:127], v[60:63], v[172:175]
  v_cvt_pk_bf16_f32 v110, v156, v157
  v_cvt_pk_bf16_f32 v111, v158, v159
  v_mfma_f32_16x16x32_bf16 v[180:183], a[112:115], v[64:67], 0
  ds_read_b64_tr_b16 a[88:89], v13 offset:8192
  v_mfma_f32_16x16x32_bf16 v[180:183], a[116:119], v[68:71], v[180:183]
  buffer_store_dwordx4 v[108:111], v2, s[40:43], s79 offen offset:2048 sc1
  v_mfma_f32_16x16x32_bf16 v[180:183], a[120:123], v[72:75], v[180:183]
  ds_read_b64_tr_b16 a[90:91], v13 offset:10240
  v_mfma_f32_16x16x32_bf16 v[180:183], a[124:127], v[76:79], v[180:183]
  v_mfma_f32_16x16x32_bf16 v[188:191], a[112:115], v[80:83], 0
  ds_read_b64_tr_b16 a[92:93], v13 offset:12288
  v_mfma_f32_16x16x32_bf16 v[188:191], a[116:119], v[84:87], v[188:191]
  v_mfma_f32_16x16x32_bf16 v[188:191], a[120:123], v[88:91], v[188:191]
  ds_read_b64_tr_b16 a[94:95], v13 offset:14336
  v_mfma_f32_16x16x32_bf16 v[188:191], a[124:127], v[92:95], v[188:191]
  s_waitcnt lgkmcnt(8)
  v_mfma_f32_16x16x32_bf16 v[128:131], a[64:67], v[32:35], 0
  ds_read_b64_tr_b16 a[96:97], v14 offset:0
  v_mfma_f32_16x16x32_bf16 v[128:131], a[68:71], v[36:39], v[128:131]
  s_nop 1
  v_mfma_f32_16x16x32_bf16 v[128:131], a[72:75], v[40:43], v[128:131]
  ds_read_b64_tr_b16 a[98:99], v14 offset:2048
  v_mfma_f32_16x16x32_bf16 v[128:131], a[76:79], v[44:47], v[128:131]
  v_cvt_pk_bf16_f32 v112, v160, v161
  v_cvt_pk_bf16_f32 v113, v162, v163
  v_mfma_f32_16x16x32_bf16 v[136:139], a[64:67], v[48:51], 0
  ds_read_b64_tr_b16 a[100:101], v14 offset:4096
  v_mfma_f32_16x16x32_bf16 v[136:139], a[68:71], v[52:55], v[136:139]
  v_cvt_pk_bf16_f32 v114, v164, v165
  v_cvt_pk_bf16_f32 v115, v166, v167
  v_mfma_f32_16x16x32_bf16 v[136:139], a[72:75], v[56:59], v[136:139]
  ds_read_b64_tr_b16 a[102:103], v14 offset:6144
  v_mfma_f32_16x16x32_bf16 v[136:139], a[76:79], v[60:63], v[136:139]
  buffer_store_dwordx4 v[112:115], v2, s[40:43], s76 offen offset:3072 sc1
  v_mfma_f32_16x16x32_bf16 v[144:147], a[64:67], v[64:67], 0
  ds_read_b64_tr_b16 a[104:105], v14 offset:8192
  v_mfma_f32_16x16x32_bf16 v[144:147], a[68:71], v[68:71], v[144:147]
  v_cvt_pk_bf16_f32 v116, v168, v169
  v_cvt_pk_bf16_f32 v117, v170, v171
  v_mfma_f32_16x16x32_bf16 v[144:147], a[72:75], v[72:75], v[144:147]
  ds_read_b64_tr_b16 a[106:107], v14 offset:10240
  v_mfma_f32_16x16x32_bf16 v[144:147], a[76:79], v[76:79], v[144:147]
  v_cvt_pk_bf16_f32 v118, v172, v173
  v_cvt_pk_bf16_f32 v119, v174, v175
  v_mfma_f32_16x16x32_bf16 v[152:155], a[64:67], v[80:83], 0
  ds_read_b64_tr_b16 a[108:109], v14 offset:12288
  v_mfma_f32_16x16x32_bf16 v[152:155], a[68:71], v[84:87], v[152:155]
  buffer_store_dwordx4 v[116:119], v2, s[40:43], s77 offen offset:3072 sc1
  v_mfma_f32_16x16x32_bf16 v[152:155], a[72:75], v[88:91], v[152:155]
  ds_read_b64_tr_b16 a[110:111], v14 offset:14336
  v_mfma_f32_16x16x32_bf16 v[152:155], a[76:79], v[92:95], v[152:155]
  s_waitcnt lgkmcnt(8)
  v_cvt_pk_bf16_f32 v120, v176, v177
  v_cvt_pk_bf16_f32 v121, v178, v179
  v_mfma_f32_16x16x32_bf16 v[132:135], a[80:83], v[32:35], 0
  ds_read_b64_tr_b16 a[112:113], v15 offset:0
  v_mfma_f32_16x16x32_bf16 v[132:135], a[84:87], v[36:39], v[132:135]
  v_cvt_pk_bf16_f32 v122, v180, v181
  v_cvt_pk_bf16_f32 v123, v182, v183
  v_mfma_f32_16x16x32_bf16 v[132:135], a[88:91], v[40:43], v[132:135]
  ds_read_b64_tr_b16 a[114:115], v15 offset:2048
  v_mfma_f32_16x16x32_bf16 v[132:135], a[92:95], v[44:47], v[132:135]
  buffer_store_dwordx4 v[120:123], v2, s[40:43], s78 offen offset:3072 sc1
  v_mfma_f32_16x16x32_bf16 v[140:143], a[80:83], v[48:51], 0
  ds_read_b64_tr_b16 a[116:117], v15 offset:4096
  v_mfma_f32_16x16x32_bf16 v[140:143], a[84:87], v[52:55], v[140:143]
  v_cvt_pk_bf16_f32 v124, v184, v185
  v_cvt_pk_bf16_f32 v125, v186, v187
  v_mfma_f32_16x16x32_bf16 v[140:143], a[88:91], v[56:59], v[140:143]
  ds_read_b64_tr_b16 a[118:119], v15 offset:6144
  v_mfma_f32_16x16x32_bf16 v[140:143], a[92:95], v[60:63], v[140:143]
  v_cvt_pk_bf16_f32 v126, v188, v189
  v_cvt_pk_bf16_f32 v127, v190, v191
  v_mfma_f32_16x16x32_bf16 v[148:151], a[80:83], v[64:67], 0
  ds_read_b64_tr_b16 a[120:121], v15 offset:8192
  v_mfma_f32_16x16x32_bf16 v[148:151], a[84:87], v[68:71], v[148:151]
  buffer_store_dwordx4 v[124:127], v2, s[40:43], s79 offen offset:3072 sc1
  v_mfma_f32_16x16x32_bf16 v[148:151], a[88:91], v[72:75], v[148:151]
  ds_read_b64_tr_b16 a[122:123], v15 offset:10240
  v_mfma_f32_16x16x32_bf16 v[148:151], a[92:95], v[76:79], v[148:151]
  v_mfma_f32_16x16x32_bf16 v[156:159], a[80:83], v[80:83], 0
  ds_read_b64_tr_b16 a[124:125], v15 offset:12288
  v_mfma_f32_16x16x32_bf16 v[156:159], a[84:87], v[84:87], v[156:159]
  v_mfma_f32_16x16x32_bf16 v[156:159], a[88:91], v[88:91], v[156:159]
  ds_read_b64_tr_b16 a[126:127], v15 offset:14336
  v_mfma_f32_16x16x32_bf16 v[156:159], a[92:95], v[92:95], v[156:159]
  s_waitcnt lgkmcnt(8)
  v_mfma_f32_16x16x32_bf16 v[160:163], a[96:99], v[32:35], 0
  ds_read_b64_tr_b16 a[64:65], v12 offset:16384
  v_mfma_f32_16x16x32_bf16 v[160:163], a[100:103], v[36:39], v[160:163]
  s_add_u32 s76, s76, 0x1000
  s_add_u32 s77, s77, 0x1000
  s_add_u32 s78, s78, 0x1000
  s_add_u32 s79, s79, 0x1000
  v_mfma_f32_16x16x32_bf16 v[160:163], a[104:107], v[40:43], v[160:163]
  ds_read_b64_tr_b16 a[66:67], v12 offset:18432
  v_mfma_f32_16x16x32_bf16 v[160:163], a[108:111], v[44:47], v[160:163]
  v_cvt_pk_bf16_f32 v96, v128, v129
  v_cvt_pk_bf16_f32 v97, v130, v131
  v_mfma_f32_16x16x32_bf16 v[168:171], a[96:99], v[48:51], 0
  ds_read_b64_tr_b16 a[68:69], v12 offset:20480
  v_mfma_f32_16x16x32_bf16 v[168:171], a[100:103], v[52:55], v[168:171]
  v_cvt_pk_bf16_f32 v98, v132, v133
  v_cvt_pk_bf16_f32 v99, v134, v135
  v_mfma_f32_16x16x32_bf16 v[168:171], a[104:107], v[56:59], v[168:171]
  ds_read_b64_tr_b16 a[70:71], v12 offset:22528
  v_mfma_f32_16x16x32_bf16 v[168:171], a[108:111], v[60:63], v[168:171]
  buffer_store_dwordx4 v[96:99], v2, s[40:43], s76 offen offset:0 sc1
  v_mfma_f32_16x16x32_bf16 v[176:179], a[96:99], v[64:67], 0
  ds_read_b64_tr_b16 a[72:73], v12 offset:24576
  v_mfma_f32_16x16x32_bf16 v[176:179], a[100:103], v[68:71], v[176:179]
  v_cvt_pk_bf16_f32 v100, v136, v137
  v_cvt_pk_bf16_f32 v101, v138, v139
  v_mfma_f32_16x16x32_bf16 v[176:179], a[104:107], v[72:75], v[176:179]
  ds_read_b64_tr_b16 a[74:75], v12 offset:26624
  v_mfma_f32_16x16x32_bf16 v[176:179], a[108:111], v[76:79], v[176:179]
  v_cvt_pk_bf16_f32 v102, v140, v141
  v_cvt_pk_bf16_f32 v103, v142, v143
  v_mfma_f32_16x16x32_bf16 v[184:187], a[96:99], v[80:83], 0
  ds_read_b64_tr_b16 a[76:77], v12 offset:28672
  v_mfma_f32_16x16x32_bf16 v[184:187], a[100:103], v[84:87], v[184:187]
  buffer_store_dwordx4 v[100:103], v2, s[40:43], s77 offen offset:0 sc1
  v_mfma_f32_16x16x32_bf16 v[184:187], a[104:107], v[88:91], v[184:187]
  ds_read_b64_tr_b16 a[78:79], v12 offset:30720
  v_mfma_f32_16x16x32_bf16 v[184:187], a[108:111], v[92:95], v[184:187]
  s_waitcnt lgkmcnt(8)
  v_cvt_pk_bf16_f32 v104, v144, v145
  v_cvt_pk_bf16_f32 v105, v146, v147
  v_mfma_f32_16x16x32_bf16 v[164:167], a[112:115], v[32:35], 0
  ds_read_b64_tr_b16 a[80:81], v13 offset:16384
  v_mfma_f32_16x16x32_bf16 v[164:167], a[116:119], v[36:39], v[164:167]
  v_cvt_pk_bf16_f32 v106, v148, v149
  v_cvt_pk_bf16_f32 v107, v150, v151
  v_mfma_f32_16x16x32_bf16 v[164:167], a[120:123], v[40:43], v[164:167]
  ds_read_b64_tr_b16 a[82:83], v13 offset:18432
  v_mfma_f32_16x16x32_bf16 v[164:167], a[124:127], v[44:47], v[164:167]
  buffer_store_dwordx4 v[104:107], v2, s[40:43], s78 offen offset:0 sc1
  v_mfma_f32_16x16x32_bf16 v[172:175], a[112:115], v[48:51], 0
  ds_read_b64_tr_b16 a[84:85], v13 offset:20480
  v_mfma_f32_16x16x32_bf16 v[172:175], a[116:119], v[52:55], v[172:175]
  v_cvt_pk_bf16_f32 v108, v152, v153
  v_cvt_pk_bf16_f32 v109, v154, v155
  v_mfma_f32_16x16x32_bf16 v[172:175], a[120:123], v[56:59], v[172:175]
  ds_read_b64_tr_b16 a[86:87], v13 offset:22528
  v_mfma_f32_16x16x32_bf16 v[172:175], a[124:127], v[60:63], v[172:175]
  v_cvt_pk_bf16_f32 v110, v156, v157
  v_cvt_pk_bf16_f32 v111, v158, v159
  v_mfma_f32_16x16x32_bf16 v[180:183], a[112:115], v[64:67], 0
  ds_read_b64_tr_b16 a[88:89], v13 offset:24576
  v_mfma_f32_16x16x32_bf16 v[180:183], a[116:119], v[68:71], v[180:183]
  buffer_store_dwordx4 v[108:111], v2, s[40:43], s79 offen offset:0 sc1
  v_mfma_f32_16x16x32_bf16 v[180:183], a[120:123], v[72:75], v[180:183]
  ds_read_b64_tr_b16 a[90:91], v13 offset:26624
  v_mfma_f32_16x16x32_bf16 v[180:183], a[124:127], v[76:79], v[180:183]
  v_mfma_f32_16x16x32_bf16 v[188:191], a[112:115], v[80:83], 0
  ds_read_b64_tr_b16 a[92:93], v13 offset:28672
  v_mfma_f32_16x16x32_bf16 v[188:191], a[116:119], v[84:87], v[188:191]
  v_mfma_f32_16x16x32_bf16 v[188:191], a[120:123], v[88:91], v[188:191]
  ds_read_b64_tr_b16 a[94:95], v13 offset:30720
  v_mfma_f32_16x16x32_bf16 v[188:191], a[124:127], v[92:95], v[188:191]
  s_waitcnt lgkmcnt(8)
  v_mfma_f32_16x16x32_bf16 v[128:131], a[64:67], v[32:35], 0
  ds_read_b64_tr_b16 a[96:97], v14 offset:16384
  v_mfma_f32_16x16x32_bf16 v[128:131], a[68:71], v[36:39], v[128:131]
  s_nop 1
  v_mfma_f32_16x16x32_bf16 v[128:131], a[72:75], v[40:43], v[128:131]
  ds_read_b64_tr_b16 a[98:99], v14 offset:18432
  v_mfma_f32_16x16x32_bf16 v[128:131], a[76:79], v[44:47], v[128:131]
  v_cvt_pk_bf16_f32 v112, v160, v161
  v_cvt_pk_bf16_f32 v113, v162, v163
  v_mfma_f32_16x16x32_bf16 v[136:139], a[64:67], v[48:51], 0
  ds_read_b64_tr_b16 a[100:101], v14 offset:20480
  v_mfma_f32_16x16x32_bf16 v[136:139], a[68:71], v[52:55], v[136:139]
  v_cvt_pk_bf16_f32 v114, v164, v165
  v_cvt_pk_bf16_f32 v115, v166, v167
  v_mfma_f32_16x16x32_bf16 v[136:139], a[72:75], v[56:59], v[136:139]
  ds_read_b64_tr_b16 a[102:103], v14 offset:22528
  v_mfma_f32_16x16x32_bf16 v[136:139], a[76:79], v[60:63], v[136:139]
  buffer_store_dwordx4 v[112:115], v2, s[40:43], s76 offen offset:1024 sc1
  v_mfma_f32_16x16x32_bf16 v[144:147], a[64:67], v[64:67], 0
  ds_read_b64_tr_b16 a[104:105], v14 offset:24576
  v_mfma_f32_16x16x32_bf16 v[144:147], a[68:71], v[68:71], v[144:147]
  v_cvt_pk_bf16_f32 v116, v168, v169
  v_cvt_pk_bf16_f32 v117, v170, v171
  v_mfma_f32_16x16x32_bf16 v[144:147], a[72:75], v[72:75], v[144:147]
  ds_read_b64_tr_b16 a[106:107], v14 offset:26624
  v_mfma_f32_16x16x32_bf16 v[144:147], a[76:79], v[76:79], v[144:147]
  v_cvt_pk_bf16_f32 v118, v172, v173
  v_cvt_pk_bf16_f32 v119, v174, v175
  v_mfma_f32_16x16x32_bf16 v[152:155], a[64:67], v[80:83], 0
  ds_read_b64_tr_b16 a[108:109], v14 offset:28672
  v_mfma_f32_16x16x32_bf16 v[152:155], a[68:71], v[84:87], v[152:155]
  buffer_store_dwordx4 v[116:119], v2, s[40:43], s77 offen offset:1024 sc1
  v_mfma_f32_16x16x32_bf16 v[152:155], a[72:75], v[88:91], v[152:155]
  ds_read_b64_tr_b16 a[110:111], v14 offset:30720
  v_mfma_f32_16x16x32_bf16 v[152:155], a[76:79], v[92:95], v[152:155]
  s_waitcnt lgkmcnt(8)
  v_cvt_pk_bf16_f32 v120, v176, v177
  v_cvt_pk_bf16_f32 v121, v178, v179
  v_mfma_f32_16x16x32_bf16 v[132:135], a[80:83], v[32:35], 0
  ds_read_b64_tr_b16 a[112:113], v15 offset:16384
  v_mfma_f32_16x16x32_bf16 v[132:135], a[84:87], v[36:39], v[132:135]
  v_cvt_pk_bf16_f32 v122, v180, v181
  v_cvt_pk_bf16_f32 v123, v182, v183
  v_mfma_f32_16x16x32_bf16 v[132:135], a[88:91], v[40:43], v[132:135]
  ds_read_b64_tr_b16 a[114:115], v15 offset:18432
  v_mfma_f32_16x16x32_bf16 v[132:135], a[92:95], v[44:47], v[132:135]
  buffer_store_dwordx4 v[120:123], v2, s[40:43], s78 offen offset:1024 sc1
  v_mfma_f32_16x16x32_bf16 v[140:143], a[80:83], v[48:51], 0
  ds_read_b64_tr_b16 a[116:117], v15 offset:20480
  v_mfma_f32_16x16x32_bf16 v[140:143], a[84:87], v[52:55], v[140:143]
  v_cvt_pk_bf16_f32 v124, v184, v185
  v_cvt_pk_bf16_f32 v125, v186, v187
  v_mfma_f32_16x16x32_bf16 v[140:143], a[88:91], v[56:59], v[140:143]
  ds_read_b64_tr_b16 a[118:119], v15 offset:22528
  v_mfma_f32_16x16x32_bf16 v[140:143], a[92:95], v[60:63], v[140:143]
  v_cvt_pk_bf16_f32 v126, v188, v189
  v_cvt_pk_bf16_f32 v127, v190, v191
  v_mfma_f32_16x16x32_bf16 v[148:151], a[80:83], v[64:67], 0
  ds_read_b64_tr_b16 a[120:121], v15 offset:24576
  v_mfma_f32_16x16x32_bf16 v[148:151], a[84:87], v[68:71], v[148:151]
  buffer_store_dwordx4 v[124:127], v2, s[40:43], s79 offen offset:1024 sc1
  v_mfma_f32_16x16x32_bf16 v[148:151], a[88:91], v[72:75], v[148:151]
  ds_read_b64_tr_b16 a[122:123], v15 offset:26624
  v_mfma_f32_16x16x32_bf16 v[148:151], a[92:95], v[76:79], v[148:151]
  v_mfma_f32_16x16x32_bf16 v[156:159], a[80:83], v[80:83], 0
  ds_read_b64_tr_b16 a[124:125], v15 offset:28672
  v_mfma_f32_16x16x32_bf16 v[156:159], a[84:87], v[84:87], v[156:159]
  v_mfma_f32_16x16x32_bf16 v[156:159], a[88:91], v[88:91], v[156:159]
  ds_read_b64_tr_b16 a[126:127], v15 offset:30720
  v_mfma_f32_16x16x32_bf16 v[156:159], a[92:95], v[92:95], v[156:159]
  s_waitcnt lgkmcnt(8)
  v_mfma_f32_16x16x32_bf16 v[160:163], a[96:99], v[32:35], 0
  ds_read_b64_tr_b16 a[64:65], v12 offset:32768
  v_mfma_f32_16x16x32_bf16 v[160:163], a[100:103], v[36:39], v[160:163]
  s_nop 1
  v_mfma_f32_16x16x32_bf16 v[160:163], a[104:107], v[40:43], v[160:163]
  ds_read_b64_tr_b16 a[66:67], v12 offset:34816
  v_mfma_f32_16x16x32_bf16 v[160:163], a[108:111], v[44:47], v[160:163]
  v_cvt_pk_bf16_f32 v96, v128, v129
  v_cvt_pk_bf16_f32 v97, v130, v131
  v_mfma_f32_16x16x32_bf16 v[168:171], a[96:99], v[48:51], 0
  ds_read_b64_tr_b16 a[68:69], v12 offset:36864
  v_mfma_f32_16x16x32_bf16 v[168:171], a[100:103], v[52:55], v[168:171]
  v_cvt_pk_bf16_f32 v98, v132, v133
  v_cvt_pk_bf16_f32 v99, v134, v135
  v_mfma_f32_16x16x32_bf16 v[168:171], a[104:107], v[56:59], v[168:171]
  ds_read_b64_tr_b16 a[70:71], v12 offset:38912
  v_mfma_f32_16x16x32_bf16 v[168:171], a[108:111], v[60:63], v[168:171]
  buffer_store_dwordx4 v[96:99], v2, s[40:43], s76 offen offset:2048 sc1
  v_mfma_f32_16x16x32_bf16 v[176:179], a[96:99], v[64:67], 0
  ds_read_b64_tr_b16 a[72:73], v12 offset:40960
  v_mfma_f32_16x16x32_bf16 v[176:179], a[100:103], v[68:71], v[176:179]
  v_cvt_pk_bf16_f32 v100, v136, v137
  v_cvt_pk_bf16_f32 v101, v138, v139
  v_mfma_f32_16x16x32_bf16 v[176:179], a[104:107], v[72:75], v[176:179]
  ds_read_b64_tr_b16 a[74:75], v12 offset:43008
  v_mfma_f32_16x16x32_bf16 v[176:179], a[108:111], v[76:79], v[176:179]
  v_cvt_pk_bf16_f32 v102, v140, v141
  v_cvt_pk_bf16_f32 v103, v142, v143
  v_mfma_f32_16x16x32_bf16 v[184:187], a[96:99], v[80:83], 0
  ds_read_b64_tr_b16 a[76:77], v12 offset:45056
  v_mfma_f32_16x16x32_bf16 v[184:187], a[100:103], v[84:87], v[184:187]
  buffer_store_dwordx4 v[100:103], v2, s[40:43], s77 offen offset:2048 sc1
  v_mfma_f32_16x16x32_bf16 v[184:187], a[104:107], v[88:91], v[184:187]
  ds_read_b64_tr_b16 a[78:79], v12 offset:47104
  v_mfma_f32_16x16x32_bf16 v[184:187], a[108:111], v[92:95], v[184:187]
  s_waitcnt lgkmcnt(8)
  v_cvt_pk_bf16_f32 v104, v144, v145
  v_cvt_pk_bf16_f32 v105, v146, v147
  v_mfma_f32_16x16x32_bf16 v[164:167], a[112:115], v[32:35], 0
  ds_read_b64_tr_b16 a[80:81], v13 offset:32768
  v_mfma_f32_16x16x32_bf16 v[164:167], a[116:119], v[36:39], v[164:167]
  v_cvt_pk_bf16_f32 v106, v148, v149
  v_cvt_pk_bf16_f32 v107, v150, v151
  v_mfma_f32_16x16x32_bf16 v[164:167], a[120:123], v[40:43], v[164:167]
  ds_read_b64_tr_b16 a[82:83], v13 offset:34816
  v_mfma_f32_16x16x32_bf16 v[164:167], a[124:127], v[44:47], v[164:167]
  buffer_store_dwordx4 v[104:107], v2, s[40:43], s78 offen offset:2048 sc1
  v_mfma_f32_16x16x32_bf16 v[172:175], a[112:115], v[48:51], 0
  ds_read_b64_tr_b16 a[84:85], v13 offset:36864
  v_mfma_f32_16x16x32_bf16 v[172:175], a[116:119], v[52:55], v[172:175]
  v_cvt_pk_bf16_f32 v108, v152, v153
  v_cvt_pk_bf16_f32 v109, v154, v155
  v_mfma_f32_16x16x32_bf16 v[172:175], a[120:123], v[56:59], v[172:175]
  ds_read_b64_tr_b16 a[86:87], v13 offset:38912
  v_mfma_f32_16x16x32_bf16 v[172:175], a[124:127], v[60:63], v[172:175]
  v_cvt_pk_bf16_f32 v110, v156, v157
  v_cvt_pk_bf16_f32 v111, v158, v159
  v_mfma_f32_16x16x32_bf16 v[180:183], a[112:115], v[64:67], 0
  ds_read_b64_tr_b16 a[88:89], v13 offset:40960
  v_mfma_f32_16x16x32_bf16 v[180:183], a[116:119], v[68:71], v[180:183]
  buffer_store_dwordx4 v[108:111], v2, s[40:43], s79 offen offset:2048 sc1
  v_mfma_f32_16x16x32_bf16 v[180:183], a[120:123], v[72:75], v[180:183]
  ds_read_b64_tr_b16 a[90:91], v13 offset:43008
  v_mfma_f32_16x16x32_bf16 v[180:183], a[124:127], v[76:79], v[180:183]
  v_mfma_f32_16x16x32_bf16 v[188:191], a[112:115], v[80:83], 0
  ds_read_b64_tr_b16 a[92:93], v13 offset:45056
  v_mfma_f32_16x16x32_bf16 v[188:191], a[116:119], v[84:87], v[188:191]
  v_mfma_f32_16x16x32_bf16 v[188:191], a[120:123], v[88:91], v[188:191]
  ds_read_b64_tr_b16 a[94:95], v13 offset:47104
  v_mfma_f32_16x16x32_bf16 v[188:191], a[124:127], v[92:95], v[188:191]
  s_waitcnt lgkmcnt(8)
  v_mfma_f32_16x16x32_bf16 v[128:131], a[64:67], v[32:35], 0
  ds_read_b64_tr_b16 a[96:97], v14 offset:32768
  v_mfma_f32_16x16x32_bf16 v[128:131], a[68:71], v[36:39], v[128:131]
  s_nop 1
  v_mfma_f32_16x16x32_bf16 v[128:131], a[72:75], v[40:43], v[128:131]
  ds_read_b64_tr_b16 a[98:99], v14 offset:34816
  v_mfma_f32_16x16x32_bf16 v[128:131], a[76:79], v[44:47], v[128:131]
  v_cvt_pk_bf16_f32 v112, v160, v161
  v_cvt_pk_bf16_f32 v113, v162, v163
  v_mfma_f32_16x16x32_bf16 v[136:139], a[64:67], v[48:51], 0
  ds_read_b64_tr_b16 a[100:101], v14 offset:36864
  v_mfma_f32_16x16x32_bf16 v[136:139], a[68:71], v[52:55], v[136:139]
  v_cvt_pk_bf16_f32 v114, v164, v165
  v_cvt_pk_bf16_f32 v115, v166, v167
  v_mfma_f32_16x16x32_bf16 v[136:139], a[72:75], v[56:59], v[136:139]
  ds_read_b64_tr_b16 a[102:103], v14 offset:38912
  v_mfma_f32_16x16x32_bf16 v[136:139], a[76:79], v[60:63], v[136:139]
  buffer_store_dwordx4 v[112:115], v2, s[40:43], s76 offen offset:3072 sc1
  v_mfma_f32_16x16x32_bf16 v[144:147], a[64:67], v[64:67], 0
  ds_read_b64_tr_b16 a[104:105], v14 offset:40960
  v_mfma_f32_16x16x32_bf16 v[144:147], a[68:71], v[68:71], v[144:147]
  v_cvt_pk_bf16_f32 v116, v168, v169
  v_cvt_pk_bf16_f32 v117, v170, v171
  v_mfma_f32_16x16x32_bf16 v[144:147], a[72:75], v[72:75], v[144:147]
  ds_read_b64_tr_b16 a[106:107], v14 offset:43008
  v_mfma_f32_16x16x32_bf16 v[144:147], a[76:79], v[76:79], v[144:147]
  v_cvt_pk_bf16_f32 v118, v172, v173
  v_cvt_pk_bf16_f32 v119, v174, v175
  v_mfma_f32_16x16x32_bf16 v[152:155], a[64:67], v[80:83], 0
  ds_read_b64_tr_b16 a[108:109], v14 offset:45056
  v_mfma_f32_16x16x32_bf16 v[152:155], a[68:71], v[84:87], v[152:155]
  buffer_store_dwordx4 v[116:119], v2, s[40:43], s77 offen offset:3072 sc1
  v_mfma_f32_16x16x32_bf16 v[152:155], a[72:75], v[88:91], v[152:155]
  ds_read_b64_tr_b16 a[110:111], v14 offset:47104
  v_mfma_f32_16x16x32_bf16 v[152:155], a[76:79], v[92:95], v[152:155]
  s_waitcnt lgkmcnt(8)
  v_cvt_pk_bf16_f32 v120, v176, v177
  v_cvt_pk_bf16_f32 v121, v178, v179
  v_mfma_f32_16x16x32_bf16 v[132:135], a[80:83], v[32:35], 0
  ds_read_b64_tr_b16 a[112:113], v15 offset:32768
  v_mfma_f32_16x16x32_bf16 v[132:135], a[84:87], v[36:39], v[132:135]
  v_cvt_pk_bf16_f32 v122, v180, v181
  v_cvt_pk_bf16_f32 v123, v182, v183
  v_mfma_f32_16x16x32_bf16 v[132:135], a[88:91], v[40:43], v[132:135]
  ds_read_b64_tr_b16 a[114:115], v15 offset:34816
  v_mfma_f32_16x16x32_bf16 v[132:135], a[92:95], v[44:47], v[132:135]
  buffer_store_dwordx4 v[120:123], v2, s[40:43], s78 offen offset:3072 sc1
  v_mfma_f32_16x16x32_bf16 v[140:143], a[80:83], v[48:51], 0
  ds_read_b64_tr_b16 a[116:117], v15 offset:36864
  v_mfma_f32_16x16x32_bf16 v[140:143], a[84:87], v[52:55], v[140:143]
  v_cvt_pk_bf16_f32 v124, v184, v185
  v_cvt_pk_bf16_f32 v125, v186, v187
  v_mfma_f32_16x16x32_bf16 v[140:143], a[88:91], v[56:59], v[140:143]
  ds_read_b64_tr_b16 a[118:119], v15 offset:38912
  v_mfma_f32_16x16x32_bf16 v[140:143], a[92:95], v[60:63], v[140:143]
  v_cvt_pk_bf16_f32 v126, v188, v189
  v_cvt_pk_bf16_f32 v127, v190, v191
  v_mfma_f32_16x16x32_bf16 v[148:151], a[80:83], v[64:67], 0
  ds_read_b64_tr_b16 a[120:121], v15 offset:40960
  v_mfma_f32_16x16x32_bf16 v[148:151], a[84:87], v[68:71], v[148:151]
  buffer_store_dwordx4 v[124:127], v2, s[40:43], s79 offen offset:3072 sc1
  v_mfma_f32_16x16x32_bf16 v[148:151], a[88:91], v[72:75], v[148:151]
  ds_read_b64_tr_b16 a[122:123], v15 offset:43008
  v_mfma_f32_16x16x32_bf16 v[148:151], a[92:95], v[76:79], v[148:151]
  v_mfma_f32_16x16x32_bf16 v[156:159], a[80:83], v[80:83], 0
  ds_read_b64_tr_b16 a[124:125], v15 offset:45056
  v_mfma_f32_16x16x32_bf16 v[156:159], a[84:87], v[84:87], v[156:159]
  v_mfma_f32_16x16x32_bf16 v[156:159], a[88:91], v[88:91], v[156:159]
  s_waitcnt vmcnt(32)
  s_barrier
  ds_read_b64_tr_b16 a[126:127], v15 offset:47104
  v_mfma_f32_16x16x32_bf16 v[156:159], a[92:95], v[92:95], v[156:159]
  s_waitcnt lgkmcnt(8)
  v_mfma_f32_16x16x32_bf16 v[160:163], a[96:99], v[32:35], 0
  ds_read_b64_tr_b16 a[64:65], v12 offset:49152
  v_mfma_f32_16x16x32_bf16 v[160:163], a[100:103], v[36:39], v[160:163]
  s_add_u32 s76, s76, 0x1000
  s_add_u32 s77, s77, 0x1000
  s_add_u32 s78, s78, 0x1000
  s_add_u32 s79, s79, 0x1000
  v_mfma_f32_16x16x32_bf16 v[160:163], a[104:107], v[40:43], v[160:163]
  ds_read_b64_tr_b16 a[66:67], v12 offset:51200
  v_mfma_f32_16x16x32_bf16 v[160:163], a[108:111], v[44:47], v[160:163]
  v_cvt_pk_bf16_f32 v96, v128, v129
  v_cvt_pk_bf16_f32 v97, v130, v131
  v_mfma_f32_16x16x32_bf16 v[168:171], a[96:99], v[48:51], 0
  ds_read_b64_tr_b16 a[68:69], v12 offset:53248
  v_mfma_f32_16x16x32_bf16 v[168:171], a[100:103], v[52:55], v[168:171]
  v_cvt_pk_bf16_f32 v98, v132, v133
  v_cvt_pk_bf16_f32 v99, v134, v135
  v_mfma_f32_16x16x32_bf16 v[168:171], a[104:107], v[56:59], v[168:171]
  ds_read_b64_tr_b16 a[70:71], v12 offset:55296
  v_mfma_f32_16x16x32_bf16 v[168:171], a[108:111], v[60:63], v[168:171]
  buffer_store_dwordx4 v[96:99], v2, s[40:43], s76 offen offset:0 sc1
  v_mfma_f32_16x16x32_bf16 v[176:179], a[96:99], v[64:67], 0
  ds_read_b64_tr_b16 a[72:73], v12 offset:57344
  v_mfma_f32_16x16x32_bf16 v[176:179], a[100:103], v[68:71], v[176:179]
  v_cvt_pk_bf16_f32 v100, v136, v137
  v_cvt_pk_bf16_f32 v101, v138, v139
  v_mfma_f32_16x16x32_bf16 v[176:179], a[104:107], v[72:75], v[176:179]
  ds_read_b64_tr_b16 a[74:75], v12 offset:59392
  v_mfma_f32_16x16x32_bf16 v[176:179], a[108:111], v[76:79], v[176:179]
  v_cvt_pk_bf16_f32 v102, v140, v141
  v_cvt_pk_bf16_f32 v103, v142, v143
  v_mfma_f32_16x16x32_bf16 v[184:187], a[96:99], v[80:83], 0
  ds_read_b64_tr_b16 a[76:77], v12 offset:61440
  v_mfma_f32_16x16x32_bf16 v[184:187], a[100:103], v[84:87], v[184:187]
  buffer_store_dwordx4 v[100:103], v2, s[40:43], s77 offen offset:0 sc1
  v_mfma_f32_16x16x32_bf16 v[184:187], a[104:107], v[88:91], v[184:187]
  ds_read_b64_tr_b16 a[78:79], v12 offset:63488
  v_mfma_f32_16x16x32_bf16 v[184:187], a[108:111], v[92:95], v[184:187]
  s_waitcnt lgkmcnt(8)
  v_cvt_pk_bf16_f32 v104, v144, v145
  v_cvt_pk_bf16_f32 v105, v146, v147
  v_mfma_f32_16x16x32_bf16 v[164:167], a[112:115], v[32:35], 0
  ds_read_b64_tr_b16 a[80:81], v13 offset:49152
  v_mfma_f32_16x16x32_bf16 v[164:167], a[116:119], v[36:39], v[164:167]
  v_cvt_pk_bf16_f32 v106, v148, v149
  v_cvt_pk_bf16_f32 v107, v150, v151
  v_mfma_f32_16x16x32_bf16 v[164:167], a[120:123], v[40:43], v[164:167]
  ds_read_b64_tr_b16 a[82:83], v13 offset:51200
  v_mfma_f32_16x16x32_bf16 v[164:167], a[124:127], v[44:47], v[164:167]
  buffer_store_dwordx4 v[104:107], v2, s[40:43], s78 offen offset:0 sc1
  v_mfma_f32_16x16x32_bf16 v[172:175], a[112:115], v[48:51], 0
  ds_read_b64_tr_b16 a[84:85], v13 offset:53248
  v_mfma_f32_16x16x32_bf16 v[172:175], a[116:119], v[52:55], v[172:175]
  v_cvt_pk_bf16_f32 v108, v152, v153
  v_cvt_pk_bf16_f32 v109, v154, v155
  v_mfma_f32_16x16x32_bf16 v[172:175], a[120:123], v[56:59], v[172:175]
  ds_read_b64_tr_b16 a[86:87], v13 offset:55296
  v_mfma_f32_16x16x32_bf16 v[172:175], a[124:127], v[60:63], v[172:175]
  v_cvt_pk_bf16_f32 v110, v156, v157
  v_cvt_pk_bf16_f32 v111, v158, v159
  v_mfma_f32_16x16x32_bf16 v[180:183], a[112:115], v[64:67], 0
  ds_read_b64_tr_b16 a[88:89], v13 offset:57344
  v_mfma_f32_16x16x32_bf16 v[180:183], a[116:119], v[68:71], v[180:183]
  buffer_store_dwordx4 v[108:111], v2, s[40:43], s79 offen offset:0 sc1
  v_mfma_f32_16x16x32_bf16 v[180:183], a[120:123], v[72:75], v[180:183]
  ds_read_b64_tr_b16 a[90:91], v13 offset:59392
  v_mfma_f32_16x16x32_bf16 v[180:183], a[124:127], v[76:79], v[180:183]
  v_mfma_f32_16x16x32_bf16 v[188:191], a[112:115], v[80:83], 0
  ds_read_b64_tr_b16 a[92:93], v13 offset:61440
  v_mfma_f32_16x16x32_bf16 v[188:191], a[116:119], v[84:87], v[188:191]
  v_mfma_f32_16x16x32_bf16 v[188:191], a[120:123], v[88:91], v[188:191]
  ds_read_b64_tr_b16 a[94:95], v13 offset:63488
  v_mfma_f32_16x16x32_bf16 v[188:191], a[124:127], v[92:95], v[188:191]
  s_waitcnt lgkmcnt(8)
  v_mfma_f32_16x16x32_bf16 v[128:131], a[64:67], v[32:35], 0
  ds_read_b64_tr_b16 a[96:97], v14 offset:49152
  v_mfma_f32_16x16x32_bf16 v[128:131], a[68:71], v[36:39], v[128:131]
  s_nop 1
  v_mfma_f32_16x16x32_bf16 v[128:131], a[72:75], v[40:43], v[128:131]
  ds_read_b64_tr_b16 a[98:99], v14 offset:51200
  v_mfma_f32_16x16x32_bf16 v[128:131], a[76:79], v[44:47], v[128:131]
  v_cvt_pk_bf16_f32 v112, v160, v161
  v_cvt_pk_bf16_f32 v113, v162, v163
  v_mfma_f32_16x16x32_bf16 v[136:139], a[64:67], v[48:51], 0
  ds_read_b64_tr_b16 a[100:101], v14 offset:53248
  v_mfma_f32_16x16x32_bf16 v[136:139], a[68:71], v[52:55], v[136:139]
  v_cvt_pk_bf16_f32 v114, v164, v165
  v_cvt_pk_bf16_f32 v115, v166, v167
  v_mfma_f32_16x16x32_bf16 v[136:139], a[72:75], v[56:59], v[136:139]
  ds_read_b64_tr_b16 a[102:103], v14 offset:55296
  v_mfma_f32_16x16x32_bf16 v[136:139], a[76:79], v[60:63], v[136:139]
  buffer_store_dwordx4 v[112:115], v2, s[40:43], s76 offen offset:1024 sc1
  v_mfma_f32_16x16x32_bf16 v[144:147], a[64:67], v[64:67], 0
  ds_read_b64_tr_b16 a[104:105], v14 offset:57344
  v_mfma_f32_16x16x32_bf16 v[144:147], a[68:71], v[68:71], v[144:147]
  v_cvt_pk_bf16_f32 v116, v168, v169
  v_cvt_pk_bf16_f32 v117, v170, v171
  v_mfma_f32_16x16x32_bf16 v[144:147], a[72:75], v[72:75], v[144:147]
  ds_read_b64_tr_b16 a[106:107], v14 offset:59392
  v_mfma_f32_16x16x32_bf16 v[144:147], a[76:79], v[76:79], v[144:147]
  v_cvt_pk_bf16_f32 v118, v172, v173
  v_cvt_pk_bf16_f32 v119, v174, v175
  v_mfma_f32_16x16x32_bf16 v[152:155], a[64:67], v[80:83], 0
  ds_read_b64_tr_b16 a[108:109], v14 offset:61440
  v_mfma_f32_16x16x32_bf16 v[152:155], a[68:71], v[84:87], v[152:155]
  buffer_store_dwordx4 v[116:119], v2, s[40:43], s77 offen offset:1024 sc1
  v_mfma_f32_16x16x32_bf16 v[152:155], a[72:75], v[88:91], v[152:155]
  ds_read_b64_tr_b16 a[110:111], v14 offset:63488
  v_mfma_f32_16x16x32_bf16 v[152:155], a[76:79], v[92:95], v[152:155]
  s_waitcnt lgkmcnt(8)
  v_cvt_pk_bf16_f32 v120, v176, v177
  v_cvt_pk_bf16_f32 v121, v178, v179
  v_mfma_f32_16x16x32_bf16 v[132:135], a[80:83], v[32:35], 0
  ds_read_b64_tr_b16 a[112:113], v15 offset:49152
  v_mfma_f32_16x16x32_bf16 v[132:135], a[84:87], v[36:39], v[132:135]
  v_cvt_pk_bf16_f32 v122, v180, v181
  v_cvt_pk_bf16_f32 v123, v182, v183
  v_mfma_f32_16x16x32_bf16 v[132:135], a[88:91], v[40:43], v[132:135]
  ds_read_b64_tr_b16 a[114:115], v15 offset:51200
  v_mfma_f32_16x16x32_bf16 v[132:135], a[92:95], v[44:47], v[132:135]
  buffer_store_dwordx4 v[120:123], v2, s[40:43], s78 offen offset:1024 sc1
  v_mfma_f32_16x16x32_bf16 v[140:143], a[80:83], v[48:51], 0
  ds_read_b64_tr_b16 a[116:117], v15 offset:53248
  v_mfma_f32_16x16x32_bf16 v[140:143], a[84:87], v[52:55], v[140:143]
  v_cvt_pk_bf16_f32 v124, v184, v185
  v_cvt_pk_bf16_f32 v125, v186, v187
  v_mfma_f32_16x16x32_bf16 v[140:143], a[88:91], v[56:59], v[140:143]
  ds_read_b64_tr_b16 a[118:119], v15 offset:55296
  v_mfma_f32_16x16x32_bf16 v[140:143], a[92:95], v[60:63], v[140:143]
  v_cvt_pk_bf16_f32 v126, v188, v189
  v_cvt_pk_bf16_f32 v127, v190, v191
  v_mfma_f32_16x16x32_bf16 v[148:151], a[80:83], v[64:67], 0
  ds_read_b64_tr_b16 a[120:121], v15 offset:57344
  v_mfma_f32_16x16x32_bf16 v[148:151], a[84:87], v[68:71], v[148:151]
  buffer_store_dwordx4 v[124:127], v2, s[40:43], s79 offen offset:1024 sc1
  v_mfma_f32_16x16x32_bf16 v[148:151], a[88:91], v[72:75], v[148:151]
  ds_read_b64_tr_b16 a[122:123], v15 offset:59392
  v_mfma_f32_16x16x32_bf16 v[148:151], a[92:95], v[76:79], v[148:151]
  v_mfma_f32_16x16x32_bf16 v[156:159], a[80:83], v[80:83], 0
  ds_read_b64_tr_b16 a[124:125], v15 offset:61440
  v_mfma_f32_16x16x32_bf16 v[156:159], a[84:87], v[84:87], v[156:159]
  v_mfma_f32_16x16x32_bf16 v[156:159], a[88:91], v[88:91], v[156:159]
  ds_read_b64_tr_b16 a[126:127], v15 offset:63488
  v_mfma_f32_16x16x32_bf16 v[156:159], a[92:95], v[92:95], v[156:159]
  s_waitcnt lgkmcnt(8)
  v_mfma_f32_16x16x32_bf16 v[160:163], a[96:99], v[32:35], 0
  v_mfma_f32_16x16x32_bf16 v[160:163], a[100:103], v[36:39], v[160:163]
  s_nop 1
  v_mfma_f32_16x16x32_bf16 v[160:163], a[104:107], v[40:43], v[160:163]
  v_mfma_f32_16x16x32_bf16 v[160:163], a[108:111], v[44:47], v[160:163]
  v_cvt_pk_bf16_f32 v96, v128, v129
  v_cvt_pk_bf16_f32 v97, v130, v131
  v_mfma_f32_16x16x32_bf16 v[168:171], a[96:99], v[48:51], 0
  v_mfma_f32_16x16x32_bf16 v[168:171], a[100:103], v[52:55], v[168:171]
  v_cvt_pk_bf16_f32 v98, v132, v133
  v_cvt_pk_bf16_f32 v99, v134, v135
  v_mfma_f32_16x16x32_bf16 v[168:171], a[104:107], v[56:59], v[168:171]
  v_mfma_f32_16x16x32_bf16 v[168:171], a[108:111], v[60:63], v[168:171]
  buffer_store_dwordx4 v[96:99], v2, s[40:43], s76 offen offset:2048 sc1
  v_mfma_f32_16x16x32_bf16 v[176:179], a[96:99], v[64:67], 0
  v_mfma_f32_16x16x32_bf16 v[176:179], a[100:103], v[68:71], v[176:179]
  v_cvt_pk_bf16_f32 v100, v136, v137
  v_cvt_pk_bf16_f32 v101, v138, v139
  v_mfma_f32_16x16x32_bf16 v[176:179], a[104:107], v[72:75], v[176:179]
  v_mfma_f32_16x16x32_bf16 v[176:179], a[108:111], v[76:79], v[176:179]
  v_cvt_pk_bf16_f32 v102, v140, v141
  v_cvt_pk_bf16_f32 v103, v142, v143
  v_mfma_f32_16x16x32_bf16 v[184:187], a[96:99], v[80:83], 0
  v_mfma_f32_16x16x32_bf16 v[184:187], a[100:103], v[84:87], v[184:187]
  buffer_store_dwordx4 v[100:103], v2, s[40:43], s77 offen offset:2048 sc1
  v_mfma_f32_16x16x32_bf16 v[184:187], a[104:107], v[88:91], v[184:187]
  v_mfma_f32_16x16x32_bf16 v[184:187], a[108:111], v[92:95], v[184:187]
  s_waitcnt lgkmcnt(0)
  v_cvt_pk_bf16_f32 v104, v144, v145
  v_cvt_pk_bf16_f32 v105, v146, v147
  v_mfma_f32_16x16x32_bf16 v[164:167], a[112:115], v[32:35], 0
  v_mfma_f32_16x16x32_bf16 v[164:167], a[116:119], v[36:39], v[164:167]
  v_cvt_pk_bf16_f32 v106, v148, v149
  v_cvt_pk_bf16_f32 v107, v150, v151
  v_mfma_f32_16x16x32_bf16 v[164:167], a[120:123], v[40:43], v[164:167]
  v_mfma_f32_16x16x32_bf16 v[164:167], a[124:127], v[44:47], v[164:167]
  buffer_store_dwordx4 v[104:107], v2, s[40:43], s78 offen offset:2048 sc1
  v_mfma_f32_16x16x32_bf16 v[172:175], a[112:115], v[48:51], 0
  v_mfma_f32_16x16x32_bf16 v[172:175], a[116:119], v[52:55], v[172:175]
  v_cvt_pk_bf16_f32 v108, v152, v153
  v_cvt_pk_bf16_f32 v109, v154, v155
  v_mfma_f32_16x16x32_bf16 v[172:175], a[120:123], v[56:59], v[172:175]
  v_mfma_f32_16x16x32_bf16 v[172:175], a[124:127], v[60:63], v[172:175]
  v_cvt_pk_bf16_f32 v110, v156, v157
  v_cvt_pk_bf16_f32 v111, v158, v159
  v_mfma_f32_16x16x32_bf16 v[180:183], a[112:115], v[64:67], 0
  v_mfma_f32_16x16x32_bf16 v[180:183], a[116:119], v[68:71], v[180:183]
  buffer_store_dwordx4 v[108:111], v2, s[40:43], s79 offen offset:2048 sc1
  v_mfma_f32_16x16x32_bf16 v[180:183], a[120:123], v[72:75], v[180:183]
  v_mfma_f32_16x16x32_bf16 v[180:183], a[124:127], v[76:79], v[180:183]
  v_mfma_f32_16x16x32_bf16 v[188:191], a[112:115], v[80:83], 0
  v_mfma_f32_16x16x32_bf16 v[188:191], a[116:119], v[84:87], v[188:191]
  v_mfma_f32_16x16x32_bf16 v[188:191], a[120:123], v[88:91], v[188:191]
  v_mfma_f32_16x16x32_bf16 v[188:191], a[124:127], v[92:95], v[188:191]
  s_nop 7
  v_cvt_pk_bf16_f32 v112, v160, v161
  v_cvt_pk_bf16_f32 v113, v162, v163
  v_cvt_pk_bf16_f32 v114, v164, v165
  v_cvt_pk_bf16_f32 v115, v166, v167
  buffer_store_dwordx4 v[112:115], v2, s[40:43], s76 offen offset:3072 sc1
  v_cvt_pk_bf16_f32 v116, v168, v169
  v_cvt_pk_bf16_f32 v117, v170, v171
  v_cvt_pk_bf16_f32 v118, v172, v173
  v_cvt_pk_bf16_f32 v119, v174, v175
  buffer_store_dwordx4 v[116:119], v2, s[40:43], s77 offen offset:3072 sc1
  v_cvt_pk_bf16_f32 v120, v176, v177
  v_cvt_pk_bf16_f32 v121, v178, v179
  v_cvt_pk_bf16_f32 v122, v180, v181
  v_cvt_pk_bf16_f32 v123, v182, v183
  buffer_store_dwordx4 v[120:123], v2, s[40:43], s78 offen offset:3072 sc1
  v_cvt_pk_bf16_f32 v124, v184, v185
  v_cvt_pk_bf16_f32 v125, v186, v187
  v_cvt_pk_bf16_f32 v126, v188, v189
  v_cvt_pk_bf16_f32 v127, v190, v191
  buffer_store_dwordx4 v[124:127], v2, s[40:43], s79 offen offset:3072 sc1
  s_lshl_b32 s66, s57, 7
  s_add_u32 s66, s66, 0xd086000
  s_cmp_eq_u32 s44, 0
  s_cselect_b32 s66, s66, 0x40000000
  v_mov_b32 v6, 1
  s_waitcnt vmcnt(0)
  s_barrier
  s_mov_b64 exec, 1
  buffer_atomic_add v6, v2, s[40:43], s66 offen
  s_mov_b64 exec, -1
  s_branch L_att_end
L_a_s1_t:
  s_mov_b32 s71, 0
  s_nop 6
  s_branch L_a_slow0_0
L_a_s0_t:
  s_mov_b32 s71, 1
  s_nop 6
  s_branch L_a_slow1_0
L_a_d0_t:
  s_mov_b32 s71, 2
  s_nop 6
  s_branch L_a_slow0_0
L_a_d1_t:
  s_mov_b32 s71, 3
  s_nop 6
  s_branch L_a_slow1_0
L_a_d2_t:
  s_mov_b32 s71, 4
  s_nop 6
  s_branch L_a_slow0_1
L_a_d3_t:
  s_mov_b32 s71, 5
  s_nop 6
  s_branch L_a_slow1_1
L_a_d4_t:
  s_mov_b32 s71, 6
  s_nop 6
  s_branch L_a_slow0_2
L_a_d5_t:
  s_mov_b32 s71, 7
  s_nop 6
  s_branch L_a_slow1_2
L_a_d6_t:
  s_mov_b32 s71, 8
  s_nop 6
  s_branch L_a_slow0_3
L_a_d7_t:
  s_mov_b32 s71, 9
  s_nop 6
  s_branch L_a_slow1_3
L_a_slow0_0:
  v_max3_f32 v6, v32, v33, v34
  v_max3_f32 v7, v35, v36, v37
  v_max3_f32 v6, v6, v38, v39
  v_max_f32 v6, v6, v7
  v_mov_b32 v7, v6
  s_nop 1
  v_permlane32_swap_b32 v7, v6
  v_max_f32 v6, v6, v7
  v_mov_b32 v7, v6
  s_nop 1
  v_permlane16_swap_b32 v7, v6
  v_max_f32 v6, v6, v7
  v_add_f32 v6, 0x41800000, v6
  v_max_f32 v6, 0, v6
  v_exp_f32 v7, -v6
  v_sub_f32 v96, v96, v6
  v_sub_f32 v97, v97, v6
  v_sub_f32 v98, v98, v6
  v_sub_f32 v99, v99, v6
  v_sub_f32 v100, v100, v6
  v_sub_f32 v101, v101, v6
  v_sub_f32 v102, v102, v6
  v_sub_f32 v103, v103, v6
  v_mul_f32 v128, v128, v7
  v_mul_f32 v129, v129, v7
  v_mul_f32 v130, v130, v7
  v_mul_f32 v131, v131, v7
  v_mul_f32 v132, v132, v7
  v_mul_f32 v133, v133, v7
  v_mul_f32 v134, v134, v7
  v_mul_f32 v135, v135, v7
  v_mul_f32 v136, v136, v7
  v_mul_f32 v137, v137, v7
  v_mul_f32 v138, v138, v7
  v_mul_f32 v139, v139, v7
  v_mul_f32 v140, v140, v7
  v_mul_f32 v141, v141, v7
  v_mul_f32 v142, v142, v7
  v_mul_f32 v143, v143, v7
  v_mul_f32 v144, v144, v7
  v_mul_f32 v145, v145, v7
  v_mul_f32 v146, v146, v7
  v_mul_f32 v147, v147, v7
  v_mul_f32 v148, v148, v7
  v_mul_f32 v149, v149, v7
  v_mul_f32 v150, v150, v7
  v_mul_f32 v151, v151, v7
  v_mul_f32 v152, v152, v7
  v_mul_f32 v153, v153, v7
  v_mul_f32 v154, v154, v7
  v_mul_f32 v155, v155, v7
  v_mul_f32 v156, v156, v7
  v_mul_f32 v157, v157, v7
  v_mul_f32 v158, v158, v7
  v_mul_f32 v159, v159, v7
  v_accvgpr_read_b32 v8, a128
  v_mul_f32 v8, v8, v7
  v_accvgpr_write_b32 a128, v8
  v_accvgpr_read_b32 v8, a129
  v_mul_f32 v8, v8, v7
  v_accvgpr_write_b32 a129, v8
  v_accvgpr_read_b32 v8, a130
  v_mul_f32 v8, v8, v7
  v_accvgpr_write_b32 a130, v8
  v_accvgpr_read_b32 v8, a131
  v_mul_f32 v8, v8, v7
  v_accvgpr_write_b32 a131, v8
  v_sub_f32 v8, v32, v6
  v_sub_f32 v9, v33, v6
  v_sub_f32 v10, v34, v6
  v_sub_f32 v11, v35, v6
  v_sub_f32 v12, v36, v6
  v_sub_f32 v13, v37, v6
  v_sub_f32 v14, v38, v6
  v_sub_f32 v15, v39, v6
  v_exp_f32 v8, v8
  v_exp_f32 v9, v9
  v_exp_f32 v10, v10
  v_exp_f32 v11, v11
  v_exp_f32 v12, v12
  v_exp_f32 v13, v13
  v_exp_f32 v14, v14
  v_exp_f32 v15, v15
  v_cvt_pk_bf16_f32 v64, v8, v9
  v_cvt_pk_bf16_f32 v65, v10, v11
  v_cvt_pk_bf16_f32 v66, v12, v13
  v_cvt_pk_bf16_f32 v67, v14, v15
L_a_slow0_1:
  v_max3_f32 v6, v40, v41, v42
  v_max3_f32 v7, v43, v44, v45
  v_max3_f32 v6, v6, v46, v47
  v_max_f32 v6, v6, v7
  v_mov_b32 v7, v6
  s_nop 1
  v_permlane32_swap_b32 v7, v6
  v_max_f32 v6, v6, v7
  v_mov_b32 v7, v6
  s_nop 1
  v_permlane16_swap_b32 v7, v6
  v_max_f32 v6, v6, v7
  v_add_f32 v6, 0x41800000, v6
  v_max_f32 v6, 0, v6
  v_exp_f32 v7, -v6
  v_sub_f32 v104, v104, v6
  v_sub_f32 v105, v105, v6
  v_sub_f32 v106, v106, v6
  v_sub_f32 v107, v107, v6
  v_sub_f32 v108, v108, v6
  v_sub_f32 v109, v109, v6
  v_sub_f32 v110, v110, v6
  v_sub_f32 v111, v111, v6
  v_mul_f32 v160, v160, v7
  v_mul_f32 v161, v161, v7
  v_mul_f32 v162, v162, v7
  v_mul_f32 v163, v163, v7
  v_mul_f32 v164, v164, v7
  v_mul_f32 v165, v165, v7
  v_mul_f32 v166, v166, v7
  v_mul_f32 v167, v167, v7
  v_mul_f32 v168, v168, v7
  v_mul_f32 v169, v169, v7
  v_mul_f32 v170, v170, v7
  v_mul_f32 v171, v171, v7
  v_mul_f32 v172, v172, v7
  v_mul_f32 v173, v173, v7
  v_mul_f32 v174, v174, v7
  v_mul_f32 v175, v175, v7
  v_mul_f32 v176, v176, v7
  v_mul_f32 v177, v177, v7
  v_mul_f32 v178, v178, v7
  v_mul_f32 v179, v179, v7
  v_mul_f32 v180, v180, v7
  v_mul_f32 v181, v181, v7
  v_mul_f32 v182, v182, v7
  v_mul_f32 v183, v183, v7
  v_mul_f32 v184, v184, v7
  v_mul_f32 v185, v185, v7
  v_mul_f32 v186, v186, v7
  v_mul_f32 v187, v187, v7
  v_mul_f32 v188, v188, v7
  v_mul_f32 v189, v189, v7
  v_mul_f32 v190, v190, v7
  v_mul_f32 v191, v191, v7
  v_accvgpr_read_b32 v8, a132
  v_mul_f32 v8, v8, v7
  v_accvgpr_write_b32 a132, v8
  v_accvgpr_read_b32 v8, a133
  v_mul_f32 v8, v8, v7
  v_accvgpr_write_b32 a133, v8
  v_accvgpr_read_b32 v8, a134
  v_mul_f32 v8, v8, v7
  v_accvgpr_write_b32 a134, v8
  v_accvgpr_read_b32 v8, a135
  v_mul_f32 v8, v8, v7
  v_accvgpr_write_b32 a135, v8
  v_sub_f32 v8, v40, v6
  v_sub_f32 v9, v41, v6
  v_sub_f32 v10, v42, v6
  v_sub_f32 v11, v43, v6
  v_sub_f32 v12, v44, v6
  v_sub_f32 v13, v45, v6
  v_sub_f32 v14, v46, v6
  v_sub_f32 v15, v47, v6
  v_exp_f32 v8, v8
  v_exp_f32 v9, v9
  v_exp_f32 v10, v10
  v_exp_f32 v11, v11
  v_exp_f32 v12, v12
  v_exp_f32 v13, v13
  v_exp_f32 v14, v14
  v_exp_f32 v15, v15
  v_cvt_pk_bf16_f32 v68, v8, v9
  v_cvt_pk_bf16_f32 v69, v10, v11
  v_cvt_pk_bf16_f32 v70, v12, v13
  v_cvt_pk_bf16_f32 v71, v14, v15
L_a_slow0_2:
  v_max3_f32 v6, v48, v49, v50
  v_max3_f32 v7, v51, v52, v53
  v_max3_f32 v6, v6, v54, v55
  v_max_f32 v6, v6, v7
  v_mov_b32 v7, v6
  s_nop 1
  v_permlane32_swap_b32 v7, v6
  v_max_f32 v6, v6, v7
  v_mov_b32 v7, v6
  s_nop 1
  v_permlane16_swap_b32 v7, v6
  v_max_f32 v6, v6, v7
  v_add_f32 v6, 0x41800000, v6
  v_max_f32 v6, 0, v6
  v_exp_f32 v7, -v6
  v_sub_f32 v112, v112, v6
  v_sub_f32 v113, v113, v6
  v_sub_f32 v114, v114, v6
  v_sub_f32 v115, v115, v6
  v_sub_f32 v116, v116, v6
  v_sub_f32 v117, v117, v6
  v_sub_f32 v118, v118, v6
  v_sub_f32 v119, v119, v6
  v_mul_f32 v192, v192, v7
  v_mul_f32 v193, v193, v7
  v_mul_f32 v194, v194, v7
  v_mul_f32 v195, v195, v7
  v_mul_f32 v196, v196, v7
  v_mul_f32 v197, v197, v7
  v_mul_f32 v198, v198, v7
  v_mul_f32 v199, v199, v7
  v_mul_f32 v200, v200, v7
  v_mul_f32 v201, v201, v7
  v_mul_f32 v202, v202, v7
  v_mul_f32 v203, v203, v7
  v_mul_f32 v204, v204, v7
  v_mul_f32 v205, v205, v7
  v_mul_f32 v206, v206, v7
  v_mul_f32 v207, v207, v7
  v_mul_f32 v208, v208, v7
  v_mul_f32 v209, v209, v7
  v_mul_f32 v210, v210, v7
  v_mul_f32 v211, v211, v7
  v_mul_f32 v212, v212, v7
  v_mul_f32 v213, v213, v7
  v_mul_f32 v214, v214, v7
  v_mul_f32 v215, v215, v7
  v_mul_f32 v216, v216, v7
  v_mul_f32 v217, v217, v7
  v_mul_f32 v218, v218, v7
  v_mul_f32 v219, v219, v7
  v_mul_f32 v220, v220, v7
  v_mul_f32 v221, v221, v7
  v_mul_f32 v222, v222, v7
  v_mul_f32 v223, v223, v7
  v_accvgpr_read_b32 v8, a136
  v_mul_f32 v8, v8, v7
  v_accvgpr_write_b32 a136, v8
  v_accvgpr_read_b32 v8, a137
  v_mul_f32 v8, v8, v7
  v_accvgpr_write_b32 a137, v8
  v_accvgpr_read_b32 v8, a138
  v_mul_f32 v8, v8, v7
  v_accvgpr_write_b32 a138, v8
  v_accvgpr_read_b32 v8, a139
  v_mul_f32 v8, v8, v7
  v_accvgpr_write_b32 a139, v8
  v_sub_f32 v8, v48, v6
  v_sub_f32 v9, v49, v6
  v_sub_f32 v10, v50, v6
  v_sub_f32 v11, v51, v6
  v_sub_f32 v12, v52, v6
  v_sub_f32 v13, v53, v6
  v_sub_f32 v14, v54, v6
  v_sub_f32 v15, v55, v6
  v_exp_f32 v8, v8
  v_exp_f32 v9, v9
  v_exp_f32 v10, v10
  v_exp_f32 v11, v11
  v_exp_f32 v12, v12
  v_exp_f32 v13, v13
  v_exp_f32 v14, v14
  v_exp_f32 v15, v15
  v_cvt_pk_bf16_f32 v72, v8, v9
  v_cvt_pk_bf16_f32 v73, v10, v11
  v_cvt_pk_bf16_f32 v74, v12, v13
  v_cvt_pk_bf16_f32 v75, v14, v15
L_a_slow0_3:
  v_max3_f32 v6, v56, v57, v58
  v_max3_f32 v7, v59, v60, v61
  v_max3_f32 v6, v6, v62, v63
  v_max_f32 v6, v6, v7
  v_mov_b32 v7, v6
  s_nop 1
  v_permlane32_swap_b32 v7, v6
  v_max_f32 v6, v6, v7
  v_mov_b32 v7, v6
  s_nop 1
  v_permlane16_swap_b32 v7, v6
  v_max_f32 v6, v6, v7
  v_add_f32 v6, 0x41800000, v6
  v_max_f32 v6, 0, v6
  v_exp_f32 v7, -v6
  v_sub_f32 v120, v120, v6
  v_sub_f32 v121, v121, v6
  v_sub_f32 v122, v122, v6
  v_sub_f32 v123, v123, v6
  v_sub_f32 v124, v124, v6
  v_sub_f32 v125, v125, v6
  v_sub_f32 v126, v126, v6
  v_sub_f32 v127, v127, v6
  v_mul_f32 v224, v224, v7
  v_mul_f32 v225, v225, v7
  v_mul_f32 v226, v226, v7
  v_mul_f32 v227, v227, v7
  v_mul_f32 v228, v228, v7
  v_mul_f32 v229, v229, v7
  v_mul_f32 v230, v230, v7
  v_mul_f32 v231, v231, v7
  v_mul_f32 v232, v232, v7
  v_mul_f32 v233, v233, v7
  v_mul_f32 v234, v234, v7
  v_mul_f32 v235, v235, v7
  v_mul_f32 v236, v236, v7
  v_mul_f32 v237, v237, v7
  v_mul_f32 v238, v238, v7
  v_mul_f32 v239, v239, v7
  v_mul_f32 v240, v240, v7
  v_mul_f32 v241, v241, v7
  v_mul_f32 v242, v242, v7
  v_mul_f32 v243, v243, v7
  v_mul_f32 v244, v244, v7
  v_mul_f32 v245, v245, v7
  v_mul_f32 v246, v246, v7
  v_mul_f32 v247, v247, v7
  v_mul_f32 v248, v248, v7
  v_mul_f32 v249, v249, v7
  v_mul_f32 v250, v250, v7
  v_mul_f32 v251, v251, v7
  v_mul_f32 v252, v252, v7
  v_mul_f32 v253, v253, v7
  v_mul_f32 v254, v254, v7
  v_mul_f32 v255, v255, v7
  v_accvgpr_read_b32 v8, a140
  v_mul_f32 v8, v8, v7
  v_accvgpr_write_b32 a140, v8
  v_accvgpr_read_b32 v8, a141
  v_mul_f32 v8, v8, v7
  v_accvgpr_write_b32 a141, v8
  v_accvgpr_read_b32 v8, a142
  v_mul_f32 v8, v8, v7
  v_accvgpr_write_b32 a142, v8
  v_accvgpr_read_b32 v8, a143
  v_mul_f32 v8, v8, v7
  v_accvgpr_write_b32 a143, v8
  v_sub_f32 v8, v56, v6
  v_sub_f32 v9, v57, v6
  v_sub_f32 v10, v58, v6
  v_sub_f32 v11, v59, v6
  v_sub_f32 v12, v60, v6
  v_sub_f32 v13, v61, v6
  v_sub_f32 v14, v62, v6
  v_sub_f32 v15, v63, v6
  v_exp_f32 v8, v8
  v_exp_f32 v9, v9
  v_exp_f32 v10, v10
  v_exp_f32 v11, v11
  v_exp_f32 v12, v12
  v_exp_f32 v13, v13
  v_exp_f32 v14, v14
  v_exp_f32 v15, v15
  v_cvt_pk_bf16_f32 v76, v8, v9
  v_cvt_pk_bf16_f32 v77, v10, v11
  v_cvt_pk_bf16_f32 v78, v12, v13
  v_cvt_pk_bf16_f32 v79, v14, v15
  s_cmp_eq_u32 s71, 0
  s_cbranch_scc1 L_a_s1_r
  s_cmp_eq_u32 s71, 2
  s_cbranch_scc1 L_a_d0_r
  s_cmp_eq_u32 s71, 4
  s_cbranch_scc1 L_a_d2_r
  s_cmp_eq_u32 s71, 6
  s_cbranch_scc1 L_a_d4_r
  s_branch L_a_d6_r
L_a_slow1_0:
  v_max3_f32 v6, v32, v33, v34
  v_max3_f32 v7, v35, v36, v37
  v_max3_f32 v6, v6, v38, v39
  v_max_f32 v6, v6, v7
  v_mov_b32 v7, v6
  s_nop 1
  v_permlane32_swap_b32 v7, v6
  v_max_f32 v6, v6, v7
  v_mov_b32 v7, v6
  s_nop 1
  v_permlane16_swap_b32 v7, v6
  v_max_f32 v6, v6, v7
  v_add_f32 v6, 0x41800000, v6
  v_max_f32 v6, 0, v6
  v_exp_f32 v7, -v6
  v_sub_f32 v96, v96, v6
  v_sub_f32 v97, v97, v6
  v_sub_f32 v98, v98, v6
  v_sub_f32 v99, v99, v6
  v_sub_f32 v100, v100, v6
  v_sub_f32 v101, v101, v6
  v_sub_f32 v102, v102, v6
  v_sub_f32 v103, v103, v6
  v_mul_f32 v128, v128, v7
  v_mul_f32 v129, v129, v7
  v_mul_f32 v130, v130, v7
  v_mul_f32 v131, v131, v7
  v_mul_f32 v132, v132, v7
  v_mul_f32 v133, v133, v7
  v_mul_f32 v134, v134, v7
  v_mul_f32 v135, v135, v7
  v_mul_f32 v136, v136, v7
  v_mul_f32 v137, v137, v7
  v_mul_f32 v138, v138, v7
  v_mul_f32 v139, v139, v7
  v_mul_f32 v140, v140, v7
  v_mul_f32 v141, v141, v7
  v_mul_f32 v142, v142, v7
  v_mul_f32 v143, v143, v7
  v_mul_f32 v144, v144, v7
  v_mul_f32 v145, v145, v7
  v_mul_f32 v146, v146, v7
  v_mul_f32 v147, v147, v7
  v_mul_f32 v148, v148, v7
  v_mul_f32 v149, v149, v7
  v_mul_f32 v150, v150, v7
  v_mul_f32 v151, v151, v7
  v_mul_f32 v152, v152, v7
  v_mul_f32 v153, v153, v7
  v_mul_f32 v154, v154, v7
  v_mul_f32 v155, v155, v7
  v_mul_f32 v156, v156, v7
  v_mul_f32 v157, v157, v7
  v_mul_f32 v158, v158, v7
  v_mul_f32 v159, v159, v7
  v_accvgpr_read_b32 v8, a128
  v_mul_f32 v8, v8, v7
  v_accvgpr_write_b32 a128, v8
  v_accvgpr_read_b32 v8, a129
  v_mul_f32 v8, v8, v7
  v_accvgpr_write_b32 a129, v8
  v_accvgpr_read_b32 v8, a130
  v_mul_f32 v8, v8, v7
  v_accvgpr_write_b32 a130, v8
  v_accvgpr_read_b32 v8, a131
  v_mul_f32 v8, v8, v7
  v_accvgpr_write_b32 a131, v8
  v_sub_f32 v8, v32, v6
  v_sub_f32 v9, v33, v6
  v_sub_f32 v10, v34, v6
  v_sub_f32 v11, v35, v6
  v_sub_f32 v12, v36, v6
  v_sub_f32 v13, v37, v6
  v_sub_f32 v14, v38, v6
  v_sub_f32 v15, v39, v6
  v_exp_f32 v8, v8
  v_exp_f32 v9, v9
  v_exp_f32 v10, v10
  v_exp_f32 v11, v11
  v_exp_f32 v12, v12
  v_exp_f32 v13, v13
  v_exp_f32 v14, v14
  v_exp_f32 v15, v15
  v_cvt_pk_bf16_f32 v80, v8, v9
  v_cvt_pk_bf16_f32 v81, v10, v11
  v_cvt_pk_bf16_f32 v82, v12, v13
  v_cvt_pk_bf16_f32 v83, v14, v15
L_a_slow1_1:
  v_max3_f32 v6, v40, v41, v42
  v_max3_f32 v7, v43, v44, v45
  v_max3_f32 v6, v6, v46, v47
  v_max_f32 v6, v6, v7
  v_mov_b32 v7, v6
  s_nop 1
  v_permlane32_swap_b32 v7, v6
  v_max_f32 v6, v6, v7
  v_mov_b32 v7, v6
  s_nop 1
  v_permlane16_swap_b32 v7, v6
  v_max_f32 v6, v6, v7
  v_add_f32 v6, 0x41800000, v6
  v_max_f32 v6, 0, v6
  v_exp_f32 v7, -v6
  v_sub_f32 v104, v104, v6
  v_sub_f32 v105, v105, v6
  v_sub_f32 v106, v106, v6
  v_sub_f32 v107, v107, v6
  v_sub_f32 v108, v108, v6
  v_sub_f32 v109, v109, v6
  v_sub_f32 v110, v110, v6
  v_sub_f32 v111, v111, v6
  v_mul_f32 v160, v160, v7
  v_mul_f32 v161, v161, v7
  v_mul_f32 v162, v162, v7
  v_mul_f32 v163, v163, v7
  v_mul_f32 v164, v164, v7
  v_mul_f32 v165, v165, v7
  v_mul_f32 v166, v166, v7
  v_mul_f32 v167, v167, v7
  v_mul_f32 v168, v168, v7
  v_mul_f32 v169, v169, v7
  v_mul_f32 v170, v170, v7
  v_mul_f32 v171, v171, v7
  v_mul_f32 v172, v172, v7
  v_mul_f32 v173, v173, v7
  v_mul_f32 v174, v174, v7
  v_mul_f32 v175, v175, v7
  v_mul_f32 v176, v176, v7
  v_mul_f32 v177, v177, v7
  v_mul_f32 v178, v178, v7
  v_mul_f32 v179, v179, v7
  v_mul_f32 v180, v180, v7
  v_mul_f32 v181, v181, v7
  v_mul_f32 v182, v182, v7
  v_mul_f32 v183, v183, v7
  v_mul_f32 v184, v184, v7
  v_mul_f32 v185, v185, v7
  v_mul_f32 v186, v186, v7
  v_mul_f32 v187, v187, v7
  v_mul_f32 v188, v188, v7
  v_mul_f32 v189, v189, v7
  v_mul_f32 v190, v190, v7
  v_mul_f32 v191, v191, v7
  v_accvgpr_read_b32 v8, a132
  v_mul_f32 v8, v8, v7
  v_accvgpr_write_b32 a132, v8
  v_accvgpr_read_b32 v8, a133
  v_mul_f32 v8, v8, v7
  v_accvgpr_write_b32 a133, v8
  v_accvgpr_read_b32 v8, a134
  v_mul_f32 v8, v8, v7
  v_accvgpr_write_b32 a134, v8
  v_accvgpr_read_b32 v8, a135
  v_mul_f32 v8, v8, v7
  v_accvgpr_write_b32 a135, v8
  v_sub_f32 v8, v40, v6
  v_sub_f32 v9, v41, v6
  v_sub_f32 v10, v42, v6
  v_sub_f32 v11, v43, v6
  v_sub_f32 v12, v44, v6
  v_sub_f32 v13, v45, v6
  v_sub_f32 v14, v46, v6
  v_sub_f32 v15, v47, v6
  v_exp_f32 v8, v8
  v_exp_f32 v9, v9
  v_exp_f32 v10, v10
  v_exp_f32 v11, v11
  v_exp_f32 v12, v12
  v_exp_f32 v13, v13
  v_exp_f32 v14, v14
  v_exp_f32 v15, v15
  v_cvt_pk_bf16_f32 v84, v8, v9
  v_cvt_pk_bf16_f32 v85, v10, v11
  v_cvt_pk_bf16_f32 v86, v12, v13
  v_cvt_pk_bf16_f32 v87, v14, v15
L_a_slow1_2:
  v_max3_f32 v6, v48, v49, v50
  v_max3_f32 v7, v51, v52, v53
  v_max3_f32 v6, v6, v54, v55
  v_max_f32 v6, v6, v7
  v_mov_b32 v7, v6
  s_nop 1
  v_permlane32_swap_b32 v7, v6
  v_max_f32 v6, v6, v7
  v_mov_b32 v7, v6
  s_nop 1
  v_permlane16_swap_b32 v7, v6
  v_max_f32 v6, v6, v7
  v_add_f32 v6, 0x41800000, v6
  v_max_f32 v6, 0, v6
  v_exp_f32 v7, -v6
  v_sub_f32 v112, v112, v6
  v_sub_f32 v113, v113, v6
  v_sub_f32 v114, v114, v6
  v_sub_f32 v115, v115, v6
  v_sub_f32 v116, v116, v6
  v_sub_f32 v117, v117, v6
  v_sub_f32 v118, v118, v6
  v_sub_f32 v119, v119, v6
  v_mul_f32 v192, v192, v7
  v_mul_f32 v193, v193, v7
  v_mul_f32 v194, v194, v7
  v_mul_f32 v195, v195, v7
  v_mul_f32 v196, v196, v7
  v_mul_f32 v197, v197, v7
  v_mul_f32 v198, v198, v7
  v_mul_f32 v199, v199, v7
  v_mul_f32 v200, v200, v7
  v_mul_f32 v201, v201, v7
  v_mul_f32 v202, v202, v7
  v_mul_f32 v203, v203, v7
  v_mul_f32 v204, v204, v7
  v_mul_f32 v205, v205, v7
  v_mul_f32 v206, v206, v7
  v_mul_f32 v207, v207, v7
  v_mul_f32 v208, v208, v7
  v_mul_f32 v209, v209, v7
  v_mul_f32 v210, v210, v7
  v_mul_f32 v211, v211, v7
  v_mul_f32 v212, v212, v7
  v_mul_f32 v213, v213, v7
  v_mul_f32 v214, v214, v7
  v_mul_f32 v215, v215, v7
  v_mul_f32 v216, v216, v7
  v_mul_f32 v217, v217, v7
  v_mul_f32 v218, v218, v7
  v_mul_f32 v219, v219, v7
  v_mul_f32 v220, v220, v7
  v_mul_f32 v221, v221, v7
  v_mul_f32 v222, v222, v7
  v_mul_f32 v223, v223, v7
  v_accvgpr_read_b32 v8, a136
  v_mul_f32 v8, v8, v7
  v_accvgpr_write_b32 a136, v8
  v_accvgpr_read_b32 v8, a137
  v_mul_f32 v8, v8, v7
  v_accvgpr_write_b32 a137, v8
  v_accvgpr_read_b32 v8, a138
  v_mul_f32 v8, v8, v7
  v_accvgpr_write_b32 a138, v8
  v_accvgpr_read_b32 v8, a139
  v_mul_f32 v8, v8, v7
  v_accvgpr_write_b32 a139, v8
  v_sub_f32 v8, v48, v6
  v_sub_f32 v9, v49, v6
  v_sub_f32 v10, v50, v6
  v_sub_f32 v11, v51, v6
  v_sub_f32 v12, v52, v6
  v_sub_f32 v13, v53, v6
  v_sub_f32 v14, v54, v6
  v_sub_f32 v15, v55, v6
  v_exp_f32 v8, v8
  v_exp_f32 v9, v9
  v_exp_f32 v10, v10
  v_exp_f32 v11, v11
  v_exp_f32 v12, v12
  v_exp_f32 v13, v13
  v_exp_f32 v14, v14
  v_exp_f32 v15, v15
  v_cvt_pk_bf16_f32 v88, v8, v9
  v_cvt_pk_bf16_f32 v89, v10, v11
  v_cvt_pk_bf16_f32 v90, v12, v13
  v_cvt_pk_bf16_f32 v91, v14, v15
L_a_slow1_3:
  v_max3_f32 v6, v56, v57, v58
  v_max3_f32 v7, v59, v60, v61
  v_max3_f32 v6, v6, v62, v63
  v_max_f32 v6, v6, v7
  v_mov_b32 v7, v6
  s_nop 1
  v_permlane32_swap_b32 v7, v6
  v_max_f32 v6, v6, v7
  v_mov_b32 v7, v6
  s_nop 1
  v_permlane16_swap_b32 v7, v6
  v_max_f32 v6, v6, v7
  v_add_f32 v6, 0x41800000, v6
  v_max_f32 v6, 0, v6
  v_exp_f32 v7, -v6
  v_sub_f32 v120, v120, v6
  v_sub_f32 v121, v121, v6
  v_sub_f32 v122, v122, v6
  v_sub_f32 v123, v123, v6
  v_sub_f32 v124, v124, v6
  v_sub_f32 v125, v125, v6
  v_sub_f32 v126, v126, v6
  v_sub_f32 v127, v127, v6
  v_mul_f32 v224, v224, v7
  v_mul_f32 v225, v225, v7
  v_mul_f32 v226, v226, v7
  v_mul_f32 v227, v227, v7
  v_mul_f32 v228, v228, v7
  v_mul_f32 v229, v229, v7
  v_mul_f32 v230, v230, v7
  v_mul_f32 v231, v231, v7
  v_mul_f32 v232, v232, v7
  v_mul_f32 v233, v233, v7
  v_mul_f32 v234, v234, v7
  v_mul_f32 v235, v235, v7
  v_mul_f32 v236, v236, v7
  v_mul_f32 v237, v237, v7
  v_mul_f32 v238, v238, v7
  v_mul_f32 v239, v239, v7
  v_mul_f32 v240, v240, v7
  v_mul_f32 v241, v241, v7
  v_mul_f32 v242, v242, v7
  v_mul_f32 v243, v243, v7
  v_mul_f32 v244, v244, v7
  v_mul_f32 v245, v245, v7
  v_mul_f32 v246, v246, v7
  v_mul_f32 v247, v247, v7
  v_mul_f32 v248, v248, v7
  v_mul_f32 v249, v249, v7
  v_mul_f32 v250, v250, v7
  v_mul_f32 v251, v251, v7
  v_mul_f32 v252, v252, v7
  v_mul_f32 v253, v253, v7
  v_mul_f32 v254, v254, v7
  v_mul_f32 v255, v255, v7
  v_accvgpr_read_b32 v8, a140
  v_mul_f32 v8, v8, v7
  v_accvgpr_write_b32 a140, v8
  v_accvgpr_read_b32 v8, a141
  v_mul_f32 v8, v8, v7
  v_accvgpr_write_b32 a141, v8
  v_accvgpr_read_b32 v8, a142
  v_mul_f32 v8, v8, v7
  v_accvgpr_write_b32 a142, v8
  v_accvgpr_read_b32 v8, a143
  v_mul_f32 v8, v8, v7
  v_accvgpr_write_b32 a143, v8
  v_sub_f32 v8, v56, v6
  v_sub_f32 v9, v57, v6
  v_sub_f32 v10, v58, v6
  v_sub_f32 v11, v59, v6
  v_sub_f32 v12, v60, v6
  v_sub_f32 v13, v61, v6
  v_sub_f32 v14, v62, v6
  v_sub_f32 v15, v63, v6
  v_exp_f32 v8, v8
  v_exp_f32 v9, v9
  v_exp_f32 v10, v10
  v_exp_f32 v11, v11
  v_exp_f32 v12, v12
  v_exp_f32 v13, v13
  v_exp_f32 v14, v14
  v_exp_f32 v15, v15
  v_cvt_pk_bf16_f32 v92, v8, v9
  v_cvt_pk_bf16_f32 v93, v10, v11
  v_cvt_pk_bf16_f32 v94, v12, v13
  v_cvt_pk_bf16_f32 v95, v14, v15
  s_cmp_eq_u32 s71, 1
  s_cbranch_scc1 L_a_s0_r
  s_cmp_eq_u32 s71, 3
  s_cbranch_scc1 L_a_d1_r
  s_cmp_eq_u32 s71, 5
  s_cbranch_scc1 L_a_d3_r
  s_cmp_eq_u32 s71, 7
  s_cbranch_scc1 L_a_d5_r
  s_branch L_a_d7_r
L_att_end:
  s_branch L_next
L_go_outx:
  s_bfe_u32 s56, s3, 0x40004
  s_bfe_u32 s62, s3, 0x10004
  s_bitcmp1_b32 s3, 3
  s_cbranch_scc1 L_red
L_barr:
  s_mov_b32 s48, s30
  s_and_b32 s49, s31, 0xffff
  s_mov_b32 s50, 0x400000
  s_mov_b32 s51, 0x20000
  v_lshlrev_b32 v2, 4, v0
  v_mov_b32 v7, 0
  s_mov_b32 s57, 0
  v_lshrrev_b32 v3, 4, v0
  v_and_b32 v4, 15, v0
  v_lshlrev_b32 v5, 1, v3
  v_xor_b32 v5, v5, v4
  v_lshlrev_b32 v5, 4, v5
  v_lshl_add_u32 v80, v3, 10, v5
  v_xor_b32 v81, 128, v80
  s_lshl_b32 s66, s44, 15
  s_lshl_b32 s60, s56, 18
  s_lshl_b32 s58, s44, 8
  s_add_u32 s60, s60, s58
  s_add_u32 m0, s66, 0
  s_add_u32 s58, s60, 0
  buffer_load_dwordx4 v80, s[48:51], s58 offen lds
  s_add_u32 m0, s66, 1024
  s_add_u32 s58, s60, 4096
  buffer_load_dwordx4 v81, s[48:51], s58 offen lds
  s_add_u32 m0, s66, 2048
  s_add_u32 s58, s60, 8192
  buffer_load_dwordx4 v80, s[48:51], s58 offen lds
  s_add_u32 m0, s66, 3072
  s_add_u32 s58, s60, 12288
  buffer_load_dwordx4 v81, s[48:51], s58 offen lds
  s_add_u32 m0, s66, 4096
  s_add_u32 s58, s60, 16384
  buffer_load_dwordx4 v80, s[48:51], s58 offen lds
  s_add_u32 m0, s66, 5120
  s_add_u32 s58, s60, 20480
  buffer_load_dwordx4 v81, s[48:51], s58 offen lds
  s_add_u32 m0, s66, 6144
  s_add_u32 s58, s60, 24576
  buffer_load_dwordx4 v80, s[48:51], s58 offen lds
  s_add_u32 m0, s66, 7168
  s_add_u32 s58, s60, 28672
  buffer_load_dwordx4 v81, s[48:51], s58 offen lds
  s_add_u32 m0, s66, 8192
  s_add_u32 s58, s60, 32768
  buffer_load_dwordx4 v80, s[48:51], s58 offen lds
  s_add_u32 m0, s66, 9216
  s_add_u32 s58, s60, 36864
  buffer_load_dwordx4 v81, s[48:51], s58 offen lds
  s_add_u32 m0, s66, 10240
  s_add_u32 s58, s60, 40960
  buffer_load_dwordx4 v80, s[48:51], s58 offen lds
  s_add_u32 m0, s66, 11264
  s_add_u32 s58, s60, 45056
  buffer_load_dwordx4 v81, s[48:51], s58 offen lds
  s_add_u32 m0, s66, 12288
  s_add_u32 s58, s60, 49152
  buffer_load_dwordx4 v80, s[48:51], s58 offen lds
  s_add_u32 m0, s66, 13312
  s_add_u32 s58, s60, 53248
  buffer_load_dwordx4 v81, s[48:51], s58 offen lds
  s_add_u32 m0, s66, 14336
  s_add_u32 s58, s60, 57344
  buffer_load_dwordx4 v80, s[48:51], s58 offen lds
  s_add_u32 m0, s66, 15360
  s_add_u32 s58, s60, 61440
  buffer_load_dwordx4 v81, s[48:51], s58 offen lds
  s_add_u32 m0, s66, 16384
  s_add_u32 s58, s60, 65536
  buffer_load_dwordx4 v80, s[48:51], s58 offen lds
  s_add_u32 m0, s66, 17408
  s_add_u32 s58, s60, 69632
  buffer_load_dwordx4 v81, s[48:51], s58 offen lds
  s_add_u32 m0, s66, 18432
  s_add_u32 s58, s60, 73728
  buffer_load_dwordx4 v80, s[48:51], s58 offen lds
  s_add_u32 m0, s66, 19456
  s_add_u32 s58, s60, 77824
  buffer_load_dwordx4 v81, s[48:51], s58 offen lds
  s_add_u32 m0, s66, 20480
  s_add_u32 s58, s60, 81920
  buffer_load_dwordx4 v80, s[48:51], s58 offen lds
  s_add_u32 m0, s66, 21504
  s_add_u32 s58, s60, 86016
  buffer_load_dwordx4 v81, s[48:51], s58 offen lds
  s_add_u32 m0, s66, 22528
  s_add_u32 s58, s60, 90112
  buffer_load_dwordx4 v80, s[48:51], s58 offen lds
  s_add_u32 m0, s66, 23552
  s_add_u32 s58, s60, 94208
  buffer_load_dwordx4 v81, s[48:51], s58 offen lds
  s_add_u32 m0, s66, 24576
  s_add_u32 s58, s60, 98304
  buffer_load_dwordx4 v80, s[48:51], s58 offen lds
  s_add_u32 m0, s66, 25600
  s_add_u32 s58, s60, 102400
  buffer_load_dwordx4 v81, s[48:51], s58 offen lds
  s_add_u32 m0, s66, 26624
  s_add_u32 s58, s60, 106496
  buffer_load_dwordx4 v80, s[48:51], s58 offen lds
  s_add_u32 m0, s66, 27648
  s_add_u32 s58, s60, 110592
  buffer_load_dwordx4 v81, s[48:51], s58 offen lds
  s_add_u32 m0, s66, 28672
  s_add_u32 s58, s60, 114688
  buffer_load_dwordx4 v80, s[48:51], s58 offen lds
  s_add_u32 m0, s66, 29696
  s_add_u32 s58, s60, 118784
  buffer_load_dwordx4 v81, s[48:51], s58 offen lds
  s_add_u32 m0, s66, 30720
  s_add_u32 s58, s60, 122880
  buffer_load_dwordx4 v80, s[48:51], s58 offen lds
  s_add_u32 m0, s66, 31744
  s_add_u32 s58, s60, 126976
  buffer_load_dwordx4 v81, s[48:51], s58 offen lds
  v_lshrrev_b32 v5, 2, v0
  v_lshl_add_u32 v112, v5, 8, s66
  v_and_b32 v5, 7, v5
  v_lshl_add_u32 v112, v5, 5, v112
  v_and_b32 v5, 3, v0
  v_lshl_add_u32 v112, v5, 3, v112
  v_xor_b32 v113, 32, v112
  v_xor_b32 v114, 64, v112
  v_xor_b32 v115, 96, v112
  v_xor_b32 v116, 128, v112
  v_xor_b32 v117, 160, v112
  v_xor_b32 v118, 192, v112
  v_xor_b32 v119, 224, v112
  s_waitcnt vmcnt(24)
  ds_read_b64_tr_b16 a[0:1], v112 offset:0
  ds_read_b64_tr_b16 a[2:3], v112 offset:4096
  ds_read_b64_tr_b16 a[32:33], v113 offset:0
  ds_read_b64_tr_b16 a[34:35], v113 offset:4096
  ds_read_b64_tr_b16 a[64:65], v114 offset:0
  ds_read_b64_tr_b16 a[66:67], v114 offset:4096
  ds_read_b64_tr_b16 a[96:97], v115 offset:0
  ds_read_b64_tr_b16 a[98:99], v115 offset:4096
  ds_read_b64_tr_b16 a[128:129], v116 offset:0
  ds_read_b64_tr_b16 a[130:131], v116 offset:4096
  ds_read_b64_tr_b16 a[160:161], v117 offset:0
  ds_read_b64_tr_b16 a[162:163], v117 offset:4096
  ds_read_b64_tr_b16 a[192:193], v118 offset:0
  ds_read_b64_tr_b16 a[194:195], v118 offset:4096
  ds_read_b64_tr_b16 a[224:225], v119 offset:0
  ds_read_b64_tr_b16 a[226:227], v119 offset:4096
  s_waitcnt vmcnt(16)
  ds_read_b64_tr_b16 a[4:5], v112 offset:8192
  ds_read_b64_tr_b16 a[6:7], v112 offset:12288
  ds_read_b64_tr_b16 a[36:37], v113 offset:8192
  ds_read_b64_tr_b16 a[38:39], v113 offset:12288
  ds_read_b64_tr_b16 a[68:69], v114 offset:8192
  ds_read_b64_tr_b16 a[70:71], v114 offset:12288
  ds_read_b64_tr_b16 a[100:101], v115 offset:8192
  ds_read_b64_tr_b16 a[102:103], v115 offset:12288
  ds_read_b64_tr_b16 a[132:133], v116 offset:8192
  ds_read_b64_tr_b16 a[134:135], v116 offset:12288
  ds_read_b64_tr_b16 a[164:165], v117 offset:8192
  ds_read_b64_tr_b16 a[166:167], v117 offset:12288
  ds_read_b64_tr_b16 a[196:197], v118 offset:8192
  ds_read_b64_tr_b16 a[198:199], v118 offset:12288
  ds_read_b64_tr_b16 a[228:229], v119 offset:8192
  ds_read_b64_tr_b16 a[230:231], v119 offset:12288
  s_waitcnt vmcnt(8)
  ds_read_b64_tr_b16 a[8:9], v112 offset:16384
  ds_read_b64_tr_b16 a[10:11], v112 offset:20480
  ds_read_b64_tr_b16 a[40:41], v113 offset:16384
  ds_read_b64_tr_b16 a[42:43], v113 offset:20480
  ds_read_b64_tr_b16 a[72:73], v114 offset:16384
  ds_read_b64_tr_b16 a[74:75], v114 offset:20480
  ds_read_b64_tr_b16 a[104:105], v115 offset:16384
  ds_read_b64_tr_b16 a[106:107], v115 offset:20480
  ds_read_b64_tr_b16 a[136:137], v116 offset:16384
  ds_read_b64_tr_b16 a[138:139], v116 offset:20480
  ds_read_b64_tr_b16 a[168:169], v117 offset:16384
  ds_read_b64_tr_b16 a[170:171], v117 offset:20480
  ds_read_b64_tr_b16 a[200:201], v118 offset:16384
  ds_read_b64_tr_b16 a[202:203], v118 offset:20480
  ds_read_b64_tr_b16 a[232:233], v119 offset:16384
  ds_read_b64_tr_b16 a[234:235], v119 offset:20480
  s_waitcnt vmcnt(0)
  ds_read_b64_tr_b16 a[12:13], v112 offset:24576
  ds_read_b64_tr_b16 a[14:15], v112 offset:28672
  ds_read_b64_tr_b16 a[44:45], v113 offset:24576
  ds_read_b64_tr_b16 a[46:47], v113 offset:28672
  ds_read_b64_tr_b16 a[76:77], v114 offset:24576
  ds_read_b64_tr_b16 a[78:79], v114 offset:28672
  ds_read_b64_tr_b16 a[108:109], v115 offset:24576
  ds_read_b64_tr_b16 a[110:111], v115 offset:28672
  ds_read_b64_tr_b16 a[140:141], v116 offset:24576
  ds_read_b64_tr_b16 a[142:143], v116 offset:28672
  ds_read_b64_tr_b16 a[172:173], v117 offset:24576
  ds_read_b64_tr_b16 a[174:175], v117 offset:28672
  ds_read_b64_tr_b16 a[204:205], v118 offset:24576
  ds_read_b64_tr_b16 a[206:207], v118 offset:28672
  ds_read_b64_tr_b16 a[236:237], v119 offset:24576
  ds_read_b64_tr_b16 a[238:239], v119 offset:28672
  s_waitcnt lgkmcnt(0)
  s_add_u32 m0, s66, 0
  s_add_u32 s58, s60, 131072
  buffer_load_dwordx4 v80, s[48:51], s58 offen lds
  s_add_u32 m0, s66, 1024
  s_add_u32 s58, s60, 135168
  buffer_load_dwordx4 v81, s[48:51], s58 offen lds
  s_add_u32 m0, s66, 2048
  s_add_u32 s58, s60, 139264
  buffer_load_dwordx4 v80, s[48:51], s58 offen lds
  s_add_u32 m0, s66, 3072
  s_add_u32 s58, s60, 143360
  buffer_load_dwordx4 v81, s[48:51], s58 offen lds
  s_add_u32 m0, s66, 4096
  s_add_u32 s58, s60, 147456
  buffer_load_dwordx4 v80, s[48:51], s58 offen lds
  s_add_u32 m0, s66, 5120
  s_add_u32 s58, s60, 151552
  buffer_load_dwordx4 v81, s[48:51], s58 offen lds
  s_add_u32 m0, s66, 6144
  s_add_u32 s58, s60, 155648
  buffer_load_dwordx4 v80, s[48:51], s58 offen lds
  s_add_u32 m0, s66, 7168
  s_add_u32 s58, s60, 159744
  buffer_load_dwordx4 v81, s[48:51], s58 offen lds
  s_add_u32 m0, s66, 8192
  s_add_u32 s58, s60, 163840
  buffer_load_dwordx4 v80, s[48:51], s58 offen lds
  s_add_u32 m0, s66, 9216
  s_add_u32 s58, s60, 167936
  buffer_load_dwordx4 v81, s[48:51], s58 offen lds
  s_add_u32 m0, s66, 10240
  s_add_u32 s58, s60, 172032
  buffer_load_dwordx4 v80, s[48:51], s58 offen lds
  s_add_u32 m0, s66, 11264
  s_add_u32 s58, s60, 176128
  buffer_load_dwordx4 v81, s[48:51], s58 offen lds
  s_add_u32 m0, s66, 12288
  s_add_u32 s58, s60, 180224
  buffer_load_dwordx4 v80, s[48:51], s58 offen lds
  s_add_u32 m0, s66, 13312
  s_add_u32 s58, s60, 184320
  buffer_load_dwordx4 v81, s[48:51], s58 offen lds
  s_add_u32 m0, s66, 14336
  s_add_u32 s58, s60, 188416
  buffer_load_dwordx4 v80, s[48:51], s58 offen lds
  s_add_u32 m0, s66, 15360
  s_add_u32 s58, s60, 192512
  buffer_load_dwordx4 v81, s[48:51], s58 offen lds
  s_add_u32 m0, s66, 16384
  s_add_u32 s58, s60, 196608
  buffer_load_dwordx4 v80, s[48:51], s58 offen lds
  s_add_u32 m0, s66, 17408
  s_add_u32 s58, s60, 200704
  buffer_load_dwordx4 v81, s[48:51], s58 offen lds
  s_add_u32 m0, s66, 18432
  s_add_u32 s58, s60, 204800
  buffer_load_dwordx4 v80, s[48:51], s58 offen lds
  s_add_u32 m0, s66, 19456
  s_add_u32 s58, s60, 208896
  buffer_load_dwordx4 v81, s[48:51], s58 offen lds
  s_add_u32 m0, s66, 20480
  s_add_u32 s58, s60, 212992
  buffer_load_dwordx4 v80, s[48:51], s58 offen lds
  s_add_u32 m0, s66, 21504
  s_add_u32 s58, s60, 217088
  buffer_load_dwordx4 v81, s[48:51], s58 offen lds
  s_add_u32 m0, s66, 22528
  s_add_u32 s58, s60, 221184
  buffer_load_dwordx4 v80, s[48:51], s58 offen lds
  s_add_u32 m0, s66, 23552
  s_add_u32 s58, s60, 225280
  buffer_load_dwordx4 v81, s[48:51], s58 offen lds
  s_add_u32 m0, s66, 24576
  s_add_u32 s58, s60, 229376
  buffer_load_dwordx4 v80, s[48:51], s58 offen lds
  s_add_u32 m0, s66, 25600
  s_add_u32 s58, s60, 233472
  buffer_load_dwordx4 v81, s[48:51], s58 offen lds
  s_add_u32 m0, s66, 26624
  s_add_u32 s58, s60, 237568
  buffer_load_dwordx4 v80, s[48:51], s58 offen lds
  s_add_u32 m0, s66, 27648
  s_add_u32 s58, s60, 241664
  buffer_load_dwordx4 v81, s[48:51], s58 offen lds
  s_add_u32 m0, s66, 28672
  s_add_u32 s58, s60, 245760
  buffer_load_dwordx4 v80, s[48:51], s58 offen lds
  s_add_u32 m0, s66, 29696
  s_add_u32 s58, s60, 249856
  buffer_load_dwordx4 v81, s[48:51], s58 offen lds
  s_add_u32 m0, s66, 30720
  s_add_u32 s58, s60, 253952
  buffer_load_dwordx4 v80, s[48:51], s58 offen lds
  s_add_u32 m0, s66, 31744
  s_add_u32 s58, s60, 258048
  buffer_load_dwordx4 v81, s[48:51], s58 offen lds
  s_lshr_b32 s58, s44, 1
  s_lshl1_add_u32 s61, s56, s58
  s_and_b32 s59, s44, 1
  s_lshl_b32 s60, s44, 12
  s_add_u32 s60, s60, 131072
  v_bfe_u32 v6, v0, 3, 1
  v_lshl_add_u32 v8, v6, 8, s60
  v_lshl_add_u32 v8, v3, 6, v8
  v_and_b32 v6, 7, v0
  v_lshl_add_u32 v8, v6, 3, v8
  v_lshrrev_b32 v6, 5, v0
  v_lshl_add_u32 v9, v6, 8, s60
  v_and_b32 v6, 3, v0
  v_lshl_add_u32 v9, v6, 6, v9
  v_bfe_u32 v6, v0, 2, 3
  v_lshl_add_u32 v9, v6, 3, v9
  s_mul_i32 s60, s58, 24576
  v_add_u32 v12, s60, v2
  s_lshl_b32 s66, s59, 10
  v_add_u32 v15, s66, v12
  s_lshl_b32 s66, s59, 12
  s_lshl_b32 s67, s61, 19
  s_add_u32 s67, s67, s66
  s_add_u32 s67, s67, 0x3000000
  s_add_u32 s66, s66, s60
  s_lshl1_add_u32 s60, s59, s58
  s_lshl_b32 s60, s60, 12
  s_add_u32 s60, s60, 98304
  v_add_u32 v13, s60, v2
  v_add_u32 v14, 98304, v2
  s_lshl_b32 s60, s59, 4
  v_add_u32 v4, s60, v4
  v_lshlrev_b32 v31, 2, v4
  v_add_u32 v31, 0xd0c0000, v31
  v_lshlrev_b32 v3, 2, v3
  v_sub_u32 v4, v4, v3
  v_mov_b32 v6, 0xff800000
  s_lshl_b32 s73, s61, 7
  s_add_u32 s73, s73, 0xd081000
  s_lshl_b32 s69, s61, 12
  s_add_u32 s69, s69, 0xc020000
  s_lshl2_add_u32 s70, s56, s44
  s_lshl_b32 s70, s70, 12
  s_add_u32 s70, s70, 0x6080000
  v_mov_b32 v241, 1
  v_lshlrev_b32 v5, 2, v0
  v_add_u32 v5, 147456, v5
  ds_write_b32 v5, v7
  v_cmp_gt_i32 vcc, 0, v4
  v_mov_b32 v16, 0x3f803f80
  s_nop 0
  v_cndmask_b32 v20, 0, v6, vcc
  v_cmp_gt_i32 vcc, 1, v4
  v_mov_b32 v17, 0x3f803f80
  s_nop 0
  v_cndmask_b32 v21, 0, v6, vcc
  v_cmp_gt_i32 vcc, 2, v4
  v_mov_b32 v18, 0x3f803f80
  s_nop 0
  v_cndmask_b32 v22, 0, v6, vcc
  v_cmp_gt_i32 vcc, 3, v4
  v_mov_b32 v19, 0x3f803f80
  s_nop 0
  v_cndmask_b32 v23, 0, v6, vcc
  v_cmp_gt_i32 vcc, 16, v4
  v_mov_b32 v16, 0x3f803f80
  s_nop 0
  v_cndmask_b32 v24, 0, v6, vcc
  v_cmp_gt_i32 vcc, 17, v4
  v_mov_b32 v17, 0x3f803f80
  s_nop 0
  v_cndmask_b32 v25, 0, v6, vcc
  v_cmp_gt_i32 vcc, 18, v4
  v_mov_b32 v18, 0x3f803f80
  s_nop 0
  v_cndmask_b32 v26, 0, v6, vcc
  v_cmp_gt_i32 vcc, 19, v4
  v_mov_b32 v19, 0x3f803f80
  s_nop 0
  v_cndmask_b32 v27, 0, v6, vcc
  v_mov_b32 v33, 0
  v_mov_b32 v34, 0
  s_waitcnt vmcnt(24)
  ds_read_b64_tr_b16 a[16:17], v112 offset:0
  ds_read_b64_tr_b16 a[18:19], v112 offset:4096
  ds_read_b64_tr_b16 a[48:49], v113 offset:0
  ds_read_b64_tr_b16 a[50:51], v113 offset:4096
  ds_read_b64_tr_b16 a[80:81], v114 offset:0
  ds_read_b64_tr_b16 a[82:83], v114 offset:4096
  ds_read_b64_tr_b16 a[112:113], v115 offset:0
  ds_read_b64_tr_b16 a[114:115], v115 offset:4096
  ds_read_b64_tr_b16 a[144:145], v116 offset:0
  ds_read_b64_tr_b16 a[146:147], v116 offset:4096
  ds_read_b64_tr_b16 a[176:177], v117 offset:0
  ds_read_b64_tr_b16 a[178:179], v117 offset:4096
  ds_read_b64_tr_b16 a[208:209], v118 offset:0
  ds_read_b64_tr_b16 a[210:211], v118 offset:4096
  ds_read_b64_tr_b16 a[240:241], v119 offset:0
  ds_read_b64_tr_b16 a[242:243], v119 offset:4096
  s_waitcnt vmcnt(16)
  ds_read_b64_tr_b16 a[20:21], v112 offset:8192
  ds_read_b64_tr_b16 a[22:23], v112 offset:12288
  ds_read_b64_tr_b16 a[52:53], v113 offset:8192
  ds_read_b64_tr_b16 a[54:55], v113 offset:12288
  ds_read_b64_tr_b16 a[84:85], v114 offset:8192
  ds_read_b64_tr_b16 a[86:87], v114 offset:12288
  ds_read_b64_tr_b16 a[116:117], v115 offset:8192
  ds_read_b64_tr_b16 a[118:119], v115 offset:12288
  ds_read_b64_tr_b16 a[148:149], v116 offset:8192
  ds_read_b64_tr_b16 a[150:151], v116 offset:12288
  ds_read_b64_tr_b16 a[180:181], v117 offset:8192
  ds_read_b64_tr_b16 a[182:183], v117 offset:12288
  ds_read_b64_tr_b16 a[212:213], v118 offset:8192
  ds_read_b64_tr_b16 a[214:215], v118 offset:12288
  ds_read_b64_tr_b16 a[244:245], v119 offset:8192
  ds_read_b64_tr_b16 a[246:247], v119 offset:12288
  s_waitcnt vmcnt(8)
  ds_read_b64_tr_b16 a[24:25], v112 offset:16384
  ds_read_b64_tr_b16 a[26:27], v112 offset:20480
  ds_read_b64_tr_b16 a[56:57], v113 offset:16384
  ds_read_b64_tr_b16 a[58:59], v113 offset:20480
  ds_read_b64_tr_b16 a[88:89], v114 offset:16384
  ds_read_b64_tr_b16 a[90:91], v114 offset:20480
  ds_read_b64_tr_b16 a[120:121], v115 offset:16384
  ds_read_b64_tr_b16 a[122:123], v115 offset:20480
  ds_read_b64_tr_b16 a[152:153], v116 offset:16384
  ds_read_b64_tr_b16 a[154:155], v116 offset:20480
  ds_read_b64_tr_b16 a[184:185], v117 offset:16384
  ds_read_b64_tr_b16 a[186:187], v117 offset:20480
  ds_read_b64_tr_b16 a[216:217], v118 offset:16384
  ds_read_b64_tr_b16 a[218:219], v118 offset:20480
  ds_read_b64_tr_b16 a[248:249], v119 offset:16384
  ds_read_b64_tr_b16 a[250:251], v119 offset:20480
  s_waitcnt vmcnt(0)
  ds_read_b64_tr_b16 a[28:29], v112 offset:24576
  ds_read_b64_tr_b16 a[30:31], v112 offset:28672
  ds_read_b64_tr_b16 a[60:61], v113 offset:24576
  ds_read_b64_tr_b16 a[62:63], v113 offset:28672
  ds_read_b64_tr_b16 a[92:93], v114 offset:24576
  ds_read_b64_tr_b16 a[94:95], v114 offset:28672
  ds_read_b64_tr_b16 a[124:125], v115 offset:24576
  ds_read_b64_tr_b16 a[126:127], v115 offset:28672
  ds_read_b64_tr_b16 a[156:157], v116 offset:24576
  ds_read_b64_tr_b16 a[158:159], v116 offset:28672
  ds_read_b64_tr_b16 a[188:189], v117 offset:24576
  ds_read_b64_tr_b16 a[190:191], v117 offset:28672
  ds_read_b64_tr_b16 a[220:221], v118 offset:24576
  ds_read_b64_tr_b16 a[222:223], v118 offset:28672
  ds_read_b64_tr_b16 a[252:253], v119 offset:24576
  ds_read_b64_tr_b16 a[254:255], v119 offset:28672
  s_waitcnt lgkmcnt(0)
  s_lshl_b32 s58, s61, 7
  s_add_u32 s58, s58, 0xd080010
  v_lshl_add_u32 v3, v0, 2, s58
  v_and_b32 v4, 7, v0
  v_lshlrev_b32 v4, 7, v4
  v_add_u32 v4, 0xd086400, v4
  v_cmp_gt_u32 vcc, 2, v0
  v_mov_b32 v240, 0
  s_nop 0
  v_cndmask_b32 v3, v4, v3, vcc
  v_cndmask_b32 v4, 16, 32, vcc
L_b_w0:
  buffer_load_dword v5, v3, s[40:43], 0 offen sc1
  s_add_u32 s57, s57, 1
  s_cmp_gt_u32 s57, 1048576
  s_cbranch_scc1 L_exit
  s_waitcnt vmcnt(0)
  v_cmp_ne_u32 vcc, v4, v5
  s_cbranch_vccnz L_b_w0
  v_readlane_b32 s63, v1, s95
  s_add_u32 s95, s95, 1
  s_mov_b32 s64, 4
  v_readlane_b32 s65, v1, s95
  s_barrier
  s_lshr_b32 s59, s63, 4
  s_lshl_b32 s68, s63, 9
  s_add_u32 s68, s68, s67
  s_lshl_b32 s74, s63, 3
  s_bitcmp1_b32 s63, 2
  s_cselect_b32 s68, 0x40000000, s68
  s_cselect_b32 s74, 0x40000000, s74
  s_cselect_b32 s59, -1, s59
L_b_ff_1c:
  v_cmp_lt_i32 vcc, s59, v240
  s_cbranch_vccz L_b_ff_1
  s_add_u32 m0, s66, 0
  s_add_u32 s59, s68, 0x0
  buffer_load_dwordx4 v2, s[40:43], s59 offen offset:0 sc1 lds
  buffer_load_dwordx4 v2, s[40:43], s59 offen offset:1024 sc1 lds
  buffer_load_dwordx4 v2, s[40:43], s59 offen offset:2048 sc1 lds
  buffer_load_dwordx4 v2, s[40:43], s59 offen offset:3072 sc1 lds
  s_add_u32 m0, s66, 8192
  s_add_u32 s59, s68, 0x1000000
  buffer_load_dwordx4 v2, s[40:43], s59 offen offset:0 sc1 lds
  buffer_load_dwordx4 v2, s[40:43], s59 offen offset:1024 sc1 lds
  buffer_load_dwordx4 v2, s[40:43], s59 offen offset:2048 sc1 lds
  buffer_load_dwordx4 v2, s[40:43], s59 offen offset:3072 sc1 lds
  s_add_u32 m0, s66, 16384
  s_add_u32 s59, s68, 0x2000000
  buffer_load_dwordx4 v2, s[40:43], s59 offen offset:0 sc1 lds
  buffer_load_dwordx4 v2, s[40:43], s59 offen offset:1024 sc1 lds
  buffer_load_dwordx4 v2, s[40:43], s59 offen offset:2048 sc1 lds
  buffer_load_dwordx4 v2, s[40:43], s59 offen offset:3072 sc1 lds
  buffer_load_dword v11, v31, s[40:43], s74 offen sc1
  buffer_load_dword v240, v7, s[40:43], s73 offen sc1
  s_lshl_b32 s58, s63, 13
  s_add_u32 s58, s58, s69
  buffer_load_dwordx4 v[56:59], v2, s[40:43], s58 offen offset:0 sc1
  buffer_load_dwordx4 v[60:63], v2, s[40:43], s58 offen offset:1024 sc1
  buffer_load_dwordx4 v[64:67], v2, s[40:43], s58 offen offset:2048 sc1
  buffer_load_dwordx4 v[68:71], v2, s[40:43], s58 offen offset:3072 sc1
  s_cmp_ge_u32 s66, 49152
  s_mov_b32 s60, 49152
  s_cmov_b32 s60, -49152
  s_add_u32 s66, s66, s60
  s_waitcnt vmcnt(0)
  s_barrier
  v_sub_f32 v10, 1.0, v11
  s_lshr_b32 s59, s65, 4
  s_lshl_b32 s68, s65, 9
  s_add_u32 s68, s68, s67
  s_lshl_b32 s74, s65, 3
  s_bitcmp1_b32 s65, 2
  s_cselect_b32 s68, 0x40000000, s68
  s_cselect_b32 s74, 0x40000000, s74
  s_cselect_b32 s59, -1, s59
L_b_ff_2c:
  v_cmp_lt_i32 vcc, s59, v240
  s_cbranch_vccz L_b_ff_2
  s_add_u32 m0, s66, 0
  s_add_u32 s59, s68, 0x0
  buffer_load_dwordx4 v2, s[40:43], s59 offen offset:0 sc1 lds
  buffer_load_dwordx4 v2, s[40:43], s59 offen offset:1024 sc1 lds
  buffer_load_dwordx4 v2, s[40:43], s59 offen offset:2048 sc1 lds
  buffer_load_dwordx4 v2, s[40:43], s59 offen offset:3072 sc1 lds
  s_add_u32 m0, s66, 8192
  s_add_u32 s59, s68, 0x1000000
  buffer_load_dwordx4 v2, s[40:43], s59 offen offset:0 sc1 lds
  buffer_load_dwordx4 v2, s[40:43], s59 offen offset:1024 sc1 lds
  buffer_load_dwordx4 v2, s[40:43], s59 offen offset:2048 sc1 lds
  buffer_load_dwordx4 v2, s[40:43], s59 offen offset:3072 sc1 lds
  s_add_u32 m0, s66, 16384
  s_add_u32 s59, s68, 0x2000000
  buffer_load_dwordx4 v2, s[40:43], s59 offen offset:0 sc1 lds
  buffer_load_dwordx4 v2, s[40:43], s59 offen offset:1024 sc1 lds
  buffer_load_dwordx4 v2, s[40:43], s59 offen offset:2048 sc1 lds
  buffer_load_dwordx4 v2, s[40:43], s59 offen offset:3072 sc1 lds
  buffer_load_dword v11, v31, s[40:43], s74 offen sc1
  buffer_load_dword v240, v7, s[40:43], s73 offen sc1
  s_cmp_ge_u32 s66, 49152
  s_mov_b32 s60, 49152
  s_cmov_b32 s60, -49152
  s_add_u32 s66, s66, s60
L_b_chk:
  v_max3_u32 v3, v56, v60, v64
  v_max_u32 v3, v3, v68
  v_cmp_eq_u32 vcc, -1, v3
  s_cbranch_vccnz L_b_late
  ds_write2st64_b32 v8, v56, v57 offset0:0 offset1:8
  ds_write2st64_b32 v8, v60, v61 offset0:2 offset1:10
  ds_write2st64_b32 v8, v64, v65 offset0:4 offset1:12
  ds_write2st64_b32 v8, v68, v69 offset0:6 offset1:14
  ds_read_b128 v[80:83], v15 offset:0
  ds_read_b128 v[112:115], v12 offset:8192
  ds_read_b128 v[116:119], v12 offset:9216
  ds_read_b128 v[84:87], v15 offset:2048
  ds_read_b128 v[120:123], v12 offset:10240
  ds_read_b128 v[124:127], v12 offset:11264
  ds_read_b128 v[88:91], v15 offset:4096
  ds_read_b128 v[128:131], v12 offset:12288
  ds_read_b128 v[132:135], v12 offset:13312
  ds_read_b128 v[92:95], v15 offset:6144
  ds_read_b128 v[136:139], v12 offset:14336
  ds_read_b128 v[140:143], v12 offset:15360
  v_mov_b64 v[72:73], v[58:59]
  v_mov_b64 v[74:75], v[62:63]
  v_mov_b64 v[76:77], v[66:67]
  v_mov_b64 v[78:79], v[70:71]
  s_waitcnt lgkmcnt(12)
  s_lshl_b32 s58, s65, 13
  s_add_u32 s58, s58, s69
  buffer_load_dwordx4 v[56:59], v2, s[40:43], s58 offen offset:0 sc1
  buffer_load_dwordx4 v[60:63], v2, s[40:43], s58 offen offset:1024 sc1
  buffer_load_dwordx4 v[64:67], v2, s[40:43], s58 offen offset:2048 sc1
  buffer_load_dwordx4 v[68:71], v2, s[40:43], s58 offen offset:3072 sc1
  s_waitcnt lgkmcnt(9)
  v_mfma_f32_16x16x32_bf16 v[40:43], v[112:115], v[80:83], v[20:23]
  ds_read_b64_tr_b16 v[96:97], v9 offset:0
  v_mfma_f32_16x16x32_bf16 v[44:47], v[116:119], v[80:83], v[24:27]
  ds_read_b64_tr_b16 v[98:99], v9 offset:2048
  s_waitcnt lgkmcnt(8)
  v_mfma_f32_16x16x32_bf16 v[40:43], v[120:123], v[84:87], v[40:43]
  ds_read_b64_tr_b16 v[100:101], v9 offset:512
  v_mfma_f32_16x16x32_bf16 v[44:47], v[124:127], v[84:87], v[44:47]
  ds_read_b64_tr_b16 v[102:103], v9 offset:2560
  s_waitcnt lgkmcnt(7)
  v_mfma_f32_16x16x32_bf16 v[40:43], v[128:131], v[88:91], v[40:43]
  ds_read_b64_tr_b16 v[104:105], v9 offset:1024
  v_mfma_f32_16x16x32_bf16 v[44:47], v[132:135], v[88:91], v[44:47]
  ds_read_b64_tr_b16 v[106:107], v9 offset:3072
  s_waitcnt lgkmcnt(6)
  v_mfma_f32_16x16x32_bf16 v[40:43], v[136:139], v[92:95], v[40:43]
  ds_read_b64_tr_b16 v[108:109], v9 offset:1536
  v_mfma_f32_16x16x32_bf16 v[44:47], v[140:143], v[92:95], v[44:47]
  ds_read_b64_tr_b16 v[110:111], v9 offset:3584
  ds_read_b128 v[112:115], v12 offset:16384
  ds_read_b128 v[116:119], v12 offset:17408
  ds_read_b128 v[120:123], v12 offset:18432
  ds_read_b128 v[124:127], v12 offset:19456
  s_waitcnt lgkmcnt(4)
  v_mfma_f32_16x16x32_bf16 v[48:51], v[96:99], v[80:83], 0
  ds_read_b128 v[128:131], v12 offset:20480
  v_mfma_f32_16x16x32_bf16 v[48:51], v[100:103], v[84:87], v[48:51]
  ds_read_b128 v[132:135], v12 offset:21504
  v_mfma_f32_16x16x32_bf16 v[48:51], v[104:107], v[88:91], v[48:51]
  ds_read_b128 v[136:139], v12 offset:22528
  v_mfma_f32_16x16x32_bf16 v[48:51], v[108:111], v[92:95], v[48:51]
  ds_read_b128 v[140:143], v12 offset:23552
  v_subrev_u32 v12, s60, v12
  v_subrev_u32 v15, s60, v15
  v_max_f32 v3, v40, v41
  v_max3_f32 v3, v3, v42, v43
  v_max3_f32 v3, v3, v44, v45
  v_max3_f32 v3, v3, v46, v47
  s_nop 0
  v_max3_f32 v3, v3, v48, v49
  v_mov_b32 v4, v3
  s_nop 1
  v_permlane32_swap_b32 v4, v3
  v_max_f32 v3, v3, v4
  v_mov_b32 v4, v3
  s_nop 1
  v_permlane16_swap_b32 v4, v3
  v_max_f32 v3, v3, v4
  v_sub_f32 v40, v40, v3
  v_sub_f32 v41, v41, v3
  v_sub_f32 v42, v42, v3
  v_sub_f32 v43, v43, v3
  v_sub_f32 v44, v44, v3
  v_sub_f32 v45, v45, v3
  v_sub_f32 v46, v46, v3
  v_sub_f32 v47, v47, v3
  v_sub_f32 v48, v48, v3
  v_sub_f32 v49, v49, v3
  v_exp_f32 v40, v40
  v_exp_f32 v41, v41
  v_exp_f32 v42, v42
  v_exp_f32 v43, v43
  v_exp_f32 v44, v44
  v_exp_f32 v45, v45
  v_exp_f32 v46, v46
  v_exp_f32 v47, v47
  v_exp_f32 v48, v48
  v_exp_f32 v49, v49
  v_cvt_pk_bf16_f32 v36, v40, v41
  v_cvt_pk_bf16_f32 v37, v42, v43
  v_cvt_pk_bf16_f32 v38, v44, v45
  v_cvt_pk_bf16_f32 v39, v46, v47
  v_cvt_pk_bf16_f32 v32, v48, v49
  v_cvt_pk_bf16_f32 v35, v48, v49
  s_waitcnt lgkmcnt(0)
  v_mfma_f32_16x16x32_bf16 v[52:55], v[16:19], v[36:39], 0
  v_mfma_f32_16x16x32_bf16 v[80:83], v[112:115], v[36:39], 0
  v_mfma_f32_16x16x32_bf16 v[84:87], v[116:119], v[36:39], 0
  v_mfma_f32_16x16x32_bf16 v[88:91], v[120:123], v[36:39], 0
  v_mfma_f32_16x16x32_bf16 v[92:95], v[124:127], v[36:39], 0
  v_mfma_f32_16x16x32_bf16 v[96:99], v[128:131], v[36:39], 0
  v_mfma_f32_16x16x32_bf16 v[100:103], v[132:135], v[36:39], 0
  v_mfma_f32_16x16x16_bf16 v[52:55], v[16:17], v[32:33], v[52:55]
  v_mfma_f32_16x16x32_bf16 v[104:107], v[136:139], v[36:39], 0
  v_mfma_f32_16x16x32_bf16 v[108:111], v[140:143], v[36:39], 0
  v_mfma_f32_16x16x16_bf16 v[80:83], v[72:73], v[32:33], v[80:83]
  v_mfma_f32_16x16x16_bf16 v[84:87], v[72:73], v[34:35], v[84:87]
  v_mfma_f32_16x16x16_bf16 v[88:91], v[74:75], v[32:33], v[88:91]
  v_mfma_f32_16x16x16_bf16 v[92:95], v[74:75], v[34:35], v[92:95]
  v_mfma_f32_16x16x16_bf16 v[96:99], v[76:77], v[32:33], v[96:99]
  v_mfma_f32_16x16x16_bf16 v[100:103], v[76:77], v[34:35], v[100:103]
  v_rcp_f32 v3, v52
  v_mfma_f32_16x16x16_bf16 v[104:107], v[78:79], v[32:33], v[104:107]
  v_mul_f32 v3, v3, v10
  v_mfma_f32_16x16x16_bf16 v[108:111], v[78:79], v[34:35], v[108:111]
  v_mul_f32 v80, v80, v3
  v_mul_f32 v81, v81, v3
  v_mul_f32 v82, v82, v3
  v_mul_f32 v83, v83, v3
  v_mul_f32 v84, v84, v3
  v_mul_f32 v85, v85, v3
  v_mul_f32 v86, v86, v3
  v_mul_f32 v87, v87, v3
  v_cvt_pk_bf16_f32 v144, v80, v81
  v_cvt_pk_bf16_f32 v145, v82, v83
  v_cvt_pk_bf16_f32 v146, v84, v85
  v_cvt_pk_bf16_f32 v147, v86, v87
  ds_write_b128 v13, v[144:147] offset:0
  v_mul_f32 v88, v88, v3
  v_mul_f32 v89, v89, v3
  v_mul_f32 v90, v90, v3
  v_mul_f32 v91, v91, v3
  v_mul_f32 v92, v92, v3
  v_mul_f32 v93, v93, v3
  v_mul_f32 v94, v94, v3
  v_mul_f32 v95, v95, v3
  v_cvt_pk_bf16_f32 v148, v88, v89
  v_cvt_pk_bf16_f32 v149, v90, v91
  v_cvt_pk_bf16_f32 v150, v92, v93
  v_cvt_pk_bf16_f32 v151, v94, v95
  ds_write_b128 v13, v[148:151] offset:1024
  v_mul_f32 v96, v96, v3
  v_mul_f32 v97, v97, v3
  v_mul_f32 v98, v98, v3
  v_mul_f32 v99, v99, v3
  v_mul_f32 v100, v100, v3
  v_mul_f32 v101, v101, v3
  v_mul_f32 v102, v102, v3
  v_mul_f32 v103, v103, v3
  s_waitcnt lgkmcnt(1)
  v_cvt_pk_bf16_f32 v144, v96, v97
  v_cvt_pk_bf16_f32 v145, v98, v99
  v_cvt_pk_bf16_f32 v146, v100, v101
  v_cvt_pk_bf16_f32 v147, v102, v103
  ds_write_b128 v13, v[144:147] offset:2048
  v_mul_f32 v104, v104, v3
  v_mul_f32 v105, v105, v3
  v_mul_f32 v106, v106, v3
  v_mul_f32 v107, v107, v3
  v_mul_f32 v108, v108, v3
  v_mul_f32 v109, v109, v3
  v_mul_f32 v110, v110, v3
  v_mul_f32 v111, v111, v3
  s_waitcnt lgkmcnt(1)
  v_cvt_pk_bf16_f32 v148, v104, v105
  v_cvt_pk_bf16_f32 v149, v106, v107
  v_cvt_pk_bf16_f32 v150, v108, v109
  v_cvt_pk_bf16_f32 v151, v110, v111
  ds_write_b128 v13, v[148:151] offset:3072
  v_xor_b32 v13, 0x4000, v13
  s_waitcnt vmcnt(0)
L_b_join:
  s_mov_b32 s62, s63
  s_mov_b32 s63, s65
  s_bitcmp1_b32 s63, 2
  s_cselect_b32 s58, 0, 1
  s_add_u32 s95, s95, s58
  v_sub_f32 v10, 1.0, v11
  v_readlane_b32 s65, v1, s95
  s_mul_i32 s71, s62, 98304
  s_add_u32 s71, s71, s70
  s_lshr_b32 s59, s65, 4
  s_lshl_b32 s68, s65, 9
  s_add_u32 s68, s68, s67
  s_lshl_b32 s74, s65, 3
  s_bitcmp1_b32 s65, 2
  s_cselect_b32 s68, 0x40000000, s68
  s_cselect_b32 s74, 0x40000000, s74
  s_cselect_b32 s59, -1, s59
L_b_ff_3c:
  v_cmp_lt_i32 vcc, s59, v240
  s_cbranch_vccz L_b_ff_3
  v_max3_u32 v3, v56, v60, v64
  v_max_u32 v3, v3, v68
  v_cmp_eq_u32 vcc, -1, v3
  s_bitcmp1_b32 s63, 2
  s_waitcnt lgkmcnt(0)
  s_barrier
  s_cbranch_scc1 L_b_alone
  s_cbranch_vccnz L_b_alone
  s_sub_u32 s60, 0, s60
  ds_read_b128 v[152:155], v14 offset:0
  ds_read_b128 v[156:159], v14 offset:1024
  ds_read_b128 v[160:163], v14 offset:2048
  ds_read_b128 v[164:167], v14 offset:3072
  ds_read_b128 v[168:171], v14 offset:4096
  ds_read_b128 v[172:175], v14 offset:5120
  ds_read_b128 v[176:179], v14 offset:6144
  ds_read_b128 v[180:183], v14 offset:7168
  s_waitcnt lgkmcnt(7)
  v_mfma_f32_16x16x32_bf16 v[216:219], a[0:3], v[152:155], 0
  s_waitcnt lgkmcnt(6)
  v_mfma_f32_16x16x32_bf16 v[216:219], a[4:7], v[156:159], v[216:219]
  s_waitcnt lgkmcnt(5)
  v_mfma_f32_16x16x32_bf16 v[216:219], a[8:11], v[160:163], v[216:219]
  s_waitcnt lgkmcnt(4)
  v_mfma_f32_16x16x32_bf16 v[216:219], a[12:15], v[164:167], v[216:219]
  s_waitcnt lgkmcnt(3)
  ds_write2st64_b32 v8, v56, v57 offset0:0 offset1:8
  ds_write2st64_b32 v8, v60, v61 offset0:2 offset1:10
  v_mfma_f32_16x16x32_bf16 v[216:219], a[16:19], v[168:171], v[216:219]
  s_waitcnt lgkmcnt(4)
  ds_write2st64_b32 v8, v64, v65 offset0:4 offset1:12
  ds_write2st64_b32 v8, v68, v69 offset0:6 offset1:14
  v_mfma_f32_16x16x32_bf16 v[216:219], a[20:23], v[172:175], v[216:219]
  s_waitcnt lgkmcnt(5)
  ds_read_b128 v[80:83], v15 offset:0
  ds_read_b128 v[112:115], v12 offset:8192
  v_mfma_f32_16x16x32_bf16 v[216:219], a[24:27], v[176:179], v[216:219]
  s_waitcnt lgkmcnt(6)
  ds_read_b128 v[116:119], v12 offset:9216
  ds_read_b128 v[84:87], v15 offset:2048
  v_mfma_f32_16x16x32_bf16 v[216:219], a[28:31], v[180:183], v[216:219]
  s_nop 0
  ds_read_b128 v[120:123], v12 offset:10240
  ds_read_b128 v[124:127], v12 offset:11264
  v_mfma_f32_16x16x32_bf16 v[220:223], a[32:35], v[152:155], 0
  s_nop 0
  ds_read_b128 v[88:91], v15 offset:4096
  ds_read_b128 v[128:131], v12 offset:12288
  v_mfma_f32_16x16x32_bf16 v[220:223], a[36:39], v[156:159], v[220:223]
  s_nop 0
  ds_read_b128 v[132:135], v12 offset:13312
  ds_read_b128 v[92:95], v15 offset:6144
  v_mfma_f32_16x16x32_bf16 v[220:223], a[40:43], v[160:163], v[220:223]
  s_nop 0
  ds_read_b128 v[136:139], v12 offset:14336
  ds_read_b128 v[140:143], v12 offset:15360
  v_mfma_f32_16x16x32_bf16 v[220:223], a[44:47], v[164:167], v[220:223]
  s_nop 0
  v_mov_b64 v[72:73], v[58:59]
  v_mov_b64 v[74:75], v[62:63]
  v_mfma_f32_16x16x32_bf16 v[220:223], a[48:51], v[168:171], v[220:223]
  s_nop 0
  v_mov_b64 v[76:77], v[66:67]
  v_mov_b64 v[78:79], v[70:71]
  v_mfma_f32_16x16x32_bf16 v[220:223], a[52:55], v[172:175], v[220:223]
  s_waitcnt lgkmcnt(12)
  s_lshl_b32 s58, s65, 13
  s_add_u32 s58, s58, s69
  buffer_load_dwordx4 v[56:59], v2, s[40:43], s58 offen offset:0 sc1
  v_mfma_f32_16x16x32_bf16 v[220:223], a[56:59], v[176:179], v[220:223]
  s_nop 0
  buffer_load_dwordx4 v[60:63], v2, s[40:43], s58 offen offset:1024 sc1
  v_mfma_f32_16x16x32_bf16 v[220:223], a[60:63], v[180:183], v[220:223]
  s_nop 0
  buffer_load_dwordx4 v[64:67], v2, s[40:43], s58 offen offset:2048 sc1
  v_mfma_f32_16x16x32_bf16 v[224:227], a[64:67], v[152:155], 0
  s_nop 0
  buffer_load_dwordx4 v[68:71], v2, s[40:43], s58 offen offset:3072 sc1
  v_mfma_f32_16x16x32_bf16 v[224:227], a[68:71], v[156:159], v[224:227]
  s_waitcnt lgkmcnt(9)
  v_mfma_f32_16x16x32_bf16 v[40:43], v[112:115], v[80:83], v[20:23]
  s_nop 0
  ds_read_b64_tr_b16 v[96:97], v9 offset:0
  v_mfma_f32_16x16x32_bf16 v[44:47], v[116:119], v[80:83], v[24:27]
  s_nop 0
  ds_read_b64_tr_b16 v[98:99], v9 offset:2048
  v_mfma_f32_16x16x32_bf16 v[224:227], a[72:75], v[160:163], v[224:227]
  s_waitcnt lgkmcnt(8)
  v_mfma_f32_16x16x32_bf16 v[40:43], v[120:123], v[84:87], v[40:43]
  s_nop 0
  ds_read_b64_tr_b16 v[100:101], v9 offset:512
  v_mfma_f32_16x16x32_bf16 v[44:47], v[124:127], v[84:87], v[44:47]
  s_nop 0
  ds_read_b64_tr_b16 v[102:103], v9 offset:2560
  v_mfma_f32_16x16x32_bf16 v[224:227], a[76:79], v[164:167], v[224:227]
  s_waitcnt lgkmcnt(7)
  v_mfma_f32_16x16x32_bf16 v[40:43], v[128:131], v[88:91], v[40:43]
  s_nop 0
  ds_read_b64_tr_b16 v[104:105], v9 offset:1024
  v_mfma_f32_16x16x32_bf16 v[44:47], v[132:135], v[88:91], v[44:47]
  s_nop 0
  ds_read_b64_tr_b16 v[106:107], v9 offset:3072
  v_mfma_f32_16x16x32_bf16 v[224:227], a[80:83], v[168:171], v[224:227]
  s_waitcnt lgkmcnt(6)
  v_mfma_f32_16x16x32_bf16 v[40:43], v[136:139], v[92:95], v[40:43]
  s_nop 0
  ds_read_b64_tr_b16 v[108:109], v9 offset:1536
  v_mfma_f32_16x16x32_bf16 v[44:47], v[140:143], v[92:95], v[44:47]
  s_nop 0
  ds_read_b64_tr_b16 v[110:111], v9 offset:3584
  ds_read_b128 v[112:115], v12 offset:16384
  v_mfma_f32_16x16x32_bf16 v[224:227], a[84:87], v[172:175], v[224:227]
  s_nop 0
  ds_read_b128 v[116:119], v12 offset:17408
  ds_read_b128 v[120:123], v12 offset:18432
  v_mfma_f32_16x16x32_bf16 v[224:227], a[88:91], v[176:179], v[224:227]
  s_nop 0
  ds_read_b128 v[124:127], v12 offset:19456
  v_mfma_f32_16x16x32_bf16 v[224:227], a[92:95], v[180:183], v[224:227]
  s_nop 0
  v_cvt_pk_bf16_f32 v232, v216, v217
  v_cvt_pk_bf16_f32 v233, v218, v219
  v_mfma_f32_16x16x32_bf16 v[228:231], a[96:99], v[152:155], 0
  s_nop 0
  v_cvt_pk_bf16_f32 v234, v220, v221
  v_cvt_pk_bf16_f32 v235, v222, v223
  v_mfma_f32_16x16x32_bf16 v[228:231], a[100:103], v[156:159], v[228:231]
  s_nop 0
  buffer_store_dwordx4 v[232:235], v2, s[40:43], s71 offen offset:0 sc1
  v_mfma_f32_16x16x32_bf16 v[228:231], a[104:107], v[160:163], v[228:231]
  s_waitcnt lgkmcnt(4)
  v_mfma_f32_16x16x32_bf16 v[48:51], v[96:99], v[80:83], 0
  s_nop 0
  ds_read_b128 v[128:131], v12 offset:20480
  v_mfma_f32_16x16x32_bf16 v[48:51], v[100:103], v[84:87], v[48:51]
  s_nop 0
  ds_read_b128 v[132:135], v12 offset:21504
  v_mfma_f32_16x16x32_bf16 v[48:51], v[104:107], v[88:91], v[48:51]
  s_nop 0
  ds_read_b128 v[136:139], v12 offset:22528
  v_mfma_f32_16x16x32_bf16 v[48:51], v[108:111], v[92:95], v[48:51]
  s_nop 0
  ds_read_b128 v[140:143], v12 offset:23552
  v_subrev_u32 v12, s60, v12
  v_mfma_f32_16x16x32_bf16 v[228:231], a[108:111], v[164:167], v[228:231]
  s_add_u32 m0, s66, 0
  s_add_u32 s59, s68, 0x0
  buffer_load_dwordx4 v2, s[40:43], s59 offen offset:0 sc1 lds
  v_subrev_u32 v15, s60, v15
  v_mfma_f32_16x16x32_bf16 v[228:231], a[112:115], v[168:171], v[228:231]
  s_nop 0
  v_max_f32 v3, v40, v41
  v_max3_f32 v3, v3, v42, v43
  v_mfma_f32_16x16x32_bf16 v[228:231], a[116:119], v[172:175], v[228:231]
  s_nop 0
  v_max3_f32 v3, v3, v44, v45
  v_max3_f32 v3, v3, v46, v47
  v_mfma_f32_16x16x32_bf16 v[228:231], a[120:123], v[176:179], v[228:231]
  s_nop 0
  buffer_load_dwordx4 v2, s[40:43], s59 offen offset:1024 sc1 lds
  v_max3_f32 v3, v3, v48, v49
  v_mfma_f32_16x16x32_bf16 v[228:231], a[124:127], v[180:183], v[228:231]
  s_nop 0
  v_mov_b32 v4, v3
  v_mfma_f32_16x16x32_bf16 v[216:219], a[128:131], v[152:155], 0
  s_nop 0
  v_permlane32_swap_b32 v4, v3
  v_mfma_f32_16x16x32_bf16 v[216:219], a[132:135], v[156:159], v[216:219]
  s_nop 0
  buffer_load_dwordx4 v2, s[40:43], s59 offen offset:2048 sc1 lds
  v_max_f32 v3, v3, v4
  v_mfma_f32_16x16x32_bf16 v[216:219], a[136:139], v[160:163], v[216:219]
  s_nop 0
  v_mov_b32 v4, v3
  v_mfma_f32_16x16x32_bf16 v[216:219], a[140:143], v[164:167], v[216:219]
  s_nop 0
  v_permlane16_swap_b32 v4, v3
  v_mfma_f32_16x16x32_bf16 v[216:219], a[144:147], v[168:171], v[216:219]
  s_nop 0
  buffer_load_dwordx4 v2, s[40:43], s59 offen offset:3072 sc1 lds
  v_max_f32 v3, v3, v4
  v_mfma_f32_16x16x32_bf16 v[216:219], a[148:151], v[172:175], v[216:219]
  s_nop 0
  v_sub_f32 v40, v40, v3
  v_sub_f32 v41, v41, v3
  v_mfma_f32_16x16x32_bf16 v[216:219], a[152:155], v[176:179], v[216:219]
  s_nop 0
  v_sub_f32 v42, v42, v3
  v_sub_f32 v43, v43, v3
  v_mfma_f32_16x16x32_bf16 v[216:219], a[156:159], v[180:183], v[216:219]
  s_nop 0
  v_cvt_pk_bf16_f32 v236, v224, v225
  v_cvt_pk_bf16_f32 v237, v226, v227
  v_mfma_f32_16x16x32_bf16 v[220:223], a[160:163], v[152:155], 0
  s_nop 0
  ds_read_b128 v[184:187], v14 offset:8192
  v_cvt_pk_bf16_f32 v238, v228, v229
  v_cvt_pk_bf16_f32 v239, v230, v231
  v_mfma_f32_16x16x32_bf16 v[220:223], a[164:167], v[156:159], v[220:223]
  s_nop 0
  buffer_store_dwordx4 v[236:239], v2, s[40:43], s71 offen offset:1024 sc1
  v_sub_f32 v44, v44, v3
  v_mfma_f32_16x16x32_bf16 v[220:223], a[168:171], v[160:163], v[220:223]
  s_nop 0
  ds_read_b128 v[188:191], v14 offset:9216
  v_sub_f32 v45, v45, v3
  v_mfma_f32_16x16x32_bf16 v[220:223], a[172:175], v[164:167], v[220:223]
  s_add_u32 m0, s66, 8192
  s_add_u32 s59, s68, 0x1000000
  buffer_load_dwordx4 v2, s[40:43], s59 offen offset:0 sc1 lds
  v_sub_f32 v46, v46, v3
  v_mfma_f32_16x16x32_bf16 v[220:223], a[176:179], v[168:171], v[220:223]
  s_nop 0
  ds_read_b128 v[192:195], v14 offset:10240
  v_sub_f32 v47, v47, v3
  v_mfma_f32_16x16x32_bf16 v[220:223], a[180:183], v[172:175], v[220:223]
  s_nop 0
  v_sub_f32 v48, v48, v3
  v_sub_f32 v49, v49, v3
  v_mfma_f32_16x16x32_bf16 v[220:223], a[184:187], v[176:179], v[220:223]
  s_nop 0
  ds_read_b128 v[196:199], v14 offset:11264
  v_mfma_f32_16x16x32_bf16 v[220:223], a[188:191], v[180:183], v[220:223]
  s_nop 0
  buffer_load_dwordx4 v2, s[40:43], s59 offen offset:1024 sc1 lds
  v_mfma_f32_16x16x32_bf16 v[224:227], a[192:195], v[152:155], 0
  s_nop 0
  ds_read_b128 v[200:203], v14 offset:12288
  v_mfma_f32_16x16x32_bf16 v[224:227], a[196:199], v[156:159], v[224:227]
  s_nop 0
  v_exp_f32 v40, v40
  v_mfma_f32_16x16x32_bf16 v[224:227], a[200:203], v[160:163], v[224:227]
  s_nop 0
  ds_read_b128 v[204:207], v14 offset:13312
  v_mfma_f32_16x16x32_bf16 v[224:227], a[204:207], v[164:167], v[224:227]
  s_nop 0
  buffer_load_dwordx4 v2, s[40:43], s59 offen offset:2048 sc1 lds
  v_mfma_f32_16x16x32_bf16 v[224:227], a[208:211], v[168:171], v[224:227]
  s_nop 0
  ds_read_b128 v[208:211], v14 offset:14336
  v_mfma_f32_16x16x32_bf16 v[224:227], a[212:215], v[172:175], v[224:227]
  s_nop 0
  v_exp_f32 v41, v41
  v_mfma_f32_16x16x32_bf16 v[224:227], a[216:219], v[176:179], v[224:227]
  s_nop 0
  ds_read_b128 v[212:215], v14 offset:15360
  v_mfma_f32_16x16x32_bf16 v[224:227], a[220:223], v[180:183], v[224:227]
  s_nop 0
  v_cvt_pk_bf16_f32 v232, v216, v217
  v_cvt_pk_bf16_f32 v233, v218, v219
  v_mfma_f32_16x16x32_bf16 v[228:231], a[224:227], v[152:155], 0
  s_nop 0
  v_cvt_pk_bf16_f32 v234, v220, v221
  v_cvt_pk_bf16_f32 v235, v222, v223
  v_mfma_f32_16x16x32_bf16 v[228:231], a[228:231], v[156:159], v[228:231]
  s_nop 0
  buffer_store_dwordx4 v[232:235], v2, s[40:43], s71 offen offset:2048 sc1
  v_mfma_f32_16x16x32_bf16 v[228:231], a[232:235], v[160:163], v[228:231]
  s_nop 0
  buffer_load_dwordx4 v2, s[40:43], s59 offen offset:3072 sc1 lds
  v_mfma_f32_16x16x32_bf16 v[228:231], a[236:239], v[164:167], v[228:231]
  s_nop 0
  v_exp_f32 v42, v42
  v_mfma_f32_16x16x32_bf16 v[228:231], a[240:243], v[168:171], v[228:231]
  s_nop 0
  v_exp_f32 v43, v43
  v_mfma_f32_16x16x32_bf16 v[228:231], a[244:247], v[172:175], v[228:231]
  s_add_u32 m0, s66, 16384
  s_add_u32 s59, s68, 0x2000000
  buffer_load_dwordx4 v2, s[40:43], s59 offen offset:0 sc1 lds
  v_mfma_f32_16x16x32_bf16 v[228:231], a[248:251], v[176:179], v[228:231]
  s_nop 0
  v_exp_f32 v44, v44
  v_mfma_f32_16x16x32_bf16 v[228:231], a[252:255], v[180:183], v[228:231]
  s_waitcnt lgkmcnt(0)
  v_exp_f32 v45, v45
  v_mfma_f32_16x16x32_bf16 v[216:219], a[0:3], v[184:187], 0
  s_nop 0
  buffer_load_dwordx4 v2, s[40:43], s59 offen offset:1024 sc1 lds
  v_mfma_f32_16x16x32_bf16 v[216:219], a[4:7], v[188:191], v[216:219]
  s_nop 0
  v_exp_f32 v46, v46
  v_mfma_f32_16x16x32_bf16 v[216:219], a[8:11], v[192:195], v[216:219]
  s_nop 0
  v_xor_b32 v14, 0x4000, v14
  v_mfma_f32_16x16x32_bf16 v[216:219], a[12:15], v[196:199], v[216:219]
  s_nop 0
  buffer_load_dwordx4 v2, s[40:43], s59 offen offset:2048 sc1 lds
  v_mfma_f32_16x16x32_bf16 v[216:219], a[16:19], v[200:203], v[216:219]
  s_nop 0
  v_exp_f32 v47, v47
  v_mfma_f32_16x16x32_bf16 v[216:219], a[20:23], v[204:207], v[216:219]
  s_nop 0
  v_exp_f32 v48, v48
  v_mfma_f32_16x16x32_bf16 v[216:219], a[24:27], v[208:211], v[216:219]
  s_nop 0
  buffer_load_dwordx4 v2, s[40:43], s59 offen offset:3072 sc1 lds
  v_mfma_f32_16x16x32_bf16 v[216:219], a[28:31], v[212:215], v[216:219]
  s_nop 0
  v_cvt_pk_bf16_f32 v236, v224, v225
  v_cvt_pk_bf16_f32 v237, v226, v227
  v_mfma_f32_16x16x32_bf16 v[220:223], a[32:35], v[184:187], 0
  s_nop 0
  v_cvt_pk_bf16_f32 v238, v228, v229
  v_cvt_pk_bf16_f32 v239, v230, v231
  v_mfma_f32_16x16x32_bf16 v[220:223], a[36:39], v[188:191], v[220:223]
  s_nop 0
  buffer_store_dwordx4 v[236:239], v2, s[40:43], s71 offen offset:3072 sc1
  v_mfma_f32_16x16x32_bf16 v[220:223], a[40:43], v[192:195], v[220:223]
  s_nop 0
  buffer_load_dword v11, v31, s[40:43], s74 offen sc1
  v_mfma_f32_16x16x32_bf16 v[220:223], a[44:47], v[196:199], v[220:223]
  s_nop 0
  v_exp_f32 v49, v49
  v_mfma_f32_16x16x32_bf16 v[220:223], a[48:51], v[200:203], v[220:223]
  s_nop 0
  v_cvt_pk_bf16_f32 v36, v40, v41
  v_cvt_pk_bf16_f32 v37, v42, v43
  v_mfma_f32_16x16x32_bf16 v[220:223], a[52:55], v[204:207], v[220:223]
  s_nop 0
  buffer_load_dword v240, v7, s[40:43], s73 offen sc1
  v_cvt_pk_bf16_f32 v38, v44, v45
  v_mfma_f32_16x16x32_bf16 v[220:223], a[56:59], v[208:211], v[220:223]
  s_nop 0
  v_cvt_pk_bf16_f32 v39, v46, v47
  v_cvt_pk_bf16_f32 v32, v48, v49
  v_mfma_f32_16x16x32_bf16 v[220:223], a[60:63], v[212:215], v[220:223]
  s_nop 0
  v_cvt_pk_bf16_f32 v35, v48, v49
  v_mfma_f32_16x16x32_bf16 v[224:227], a[64:67], v[184:187], 0
  s_nop 0
  v_mfma_f32_16x16x32_bf16 v[52:55], v[16:19], v[36:39], 0
  s_nop 0
  v_mfma_f32_16x16x32_bf16 v[80:83], v[112:115], v[36:39], 0
  s_nop 0
  v_mfma_f32_16x16x32_bf16 v[84:87], v[116:119], v[36:39], 0
  s_nop 0
  v_mfma_f32_16x16x32_bf16 v[88:91], v[120:123], v[36:39], 0
  s_nop 0
  v_mfma_f32_16x16x32_bf16 v[92:95], v[124:127], v[36:39], 0
  s_nop 0
  v_mfma_f32_16x16x32_bf16 v[96:99], v[128:131], v[36:39], 0
  s_nop 0
  v_mfma_f32_16x16x32_bf16 v[100:103], v[132:135], v[36:39], 0
  s_nop 0
  v_mfma_f32_16x16x16_bf16 v[52:55], v[16:17], v[32:33], v[52:55]
  s_nop 0
  v_mfma_f32_16x16x32_bf16 v[104:107], v[136:139], v[36:39], 0
  s_nop 0
  v_mfma_f32_16x16x32_bf16 v[108:111], v[140:143], v[36:39], 0
  s_nop 0
  v_mfma_f32_16x16x16_bf16 v[80:83], v[72:73], v[32:33], v[80:83]
  s_nop 0
  v_mfma_f32_16x16x16_bf16 v[84:87], v[72:73], v[34:35], v[84:87]
  s_nop 0
  v_mfma_f32_16x16x16_bf16 v[88:91], v[74:75], v[32:33], v[88:91]
  s_nop 0
  v_mfma_f32_16x16x16_bf16 v[92:95], v[74:75], v[34:35], v[92:95]
  s_nop 0
  v_mfma_f32_16x16x16_bf16 v[96:99], v[76:77], v[32:33], v[96:99]
  s_nop 0
  v_mfma_f32_16x16x16_bf16 v[100:103], v[76:77], v[34:35], v[100:103]
  s_nop 0
  v_rcp_f32 v3, v52
  v_mfma_f32_16x16x16_bf16 v[104:107], v[78:79], v[32:33], v[104:107]
  s_nop 0
  v_mul_f32 v3, v3, v10
  v_mfma_f32_16x16x16_bf16 v[108:111], v[78:79], v[34:35], v[108:111]
  s_nop 0
  v_mul_f32 v80, v80, v3
  v_mul_f32 v81, v81, v3
  v_mfma_f32_16x16x32_bf16 v[224:227], a[68:71], v[188:191], v[224:227]
  s_nop 0
  v_mul_f32 v82, v82, v3
  v_mul_f32 v83, v83, v3
  v_mfma_f32_16x16x32_bf16 v[224:227], a[72:75], v[192:195], v[224:227]
  s_nop 0
  v_mul_f32 v84, v84, v3
  v_mul_f32 v85, v85, v3
  v_mfma_f32_16x16x32_bf16 v[224:227], a[76:79], v[196:199], v[224:227]
  s_nop 0
  v_mul_f32 v86, v86, v3
  v_mul_f32 v87, v87, v3
  v_mfma_f32_16x16x32_bf16 v[224:227], a[80:83], v[200:203], v[224:227]
  s_nop 0
  v_cvt_pk_bf16_f32 v144, v80, v81
  v_cvt_pk_bf16_f32 v145, v82, v83
  v_mfma_f32_16x16x32_bf16 v[224:227], a[84:87], v[204:207], v[224:227]
  s_nop 0
  v_cvt_pk_bf16_f32 v146, v84, v85
  v_cvt_pk_bf16_f32 v147, v86, v87
  v_mfma_f32_16x16x32_bf16 v[224:227], a[88:91], v[208:211], v[224:227]
  s_add_u32 s71, s71, 786432
  ds_write_b128 v13, v[144:147] offset:0
  v_mul_f32 v88, v88, v3
  v_mfma_f32_16x16x32_bf16 v[224:227], a[92:95], v[212:215], v[224:227]
  s_nop 0
  v_cvt_pk_bf16_f32 v232, v216, v217
  v_cvt_pk_bf16_f32 v233, v218, v219
  v_mfma_f32_16x16x32_bf16 v[228:231], a[96:99], v[184:187], 0
  s_nop 0
  v_cvt_pk_bf16_f32 v234, v220, v221
  v_cvt_pk_bf16_f32 v235, v222, v223
  v_mfma_f32_16x16x32_bf16 v[228:231], a[100:103], v[188:191], v[228:231]
  s_nop 0
  buffer_store_dwordx4 v[232:235], v2, s[40:43], s71 offen offset:0 sc1
  v_mul_f32 v89, v89, v3
  v_mfma_f32_16x16x32_bf16 v[228:231], a[104:107], v[192:195], v[228:231]
  s_nop 0
  v_mul_f32 v90, v90, v3
  v_mul_f32 v91, v91, v3
  v_mfma_f32_16x16x32_bf16 v[228:231], a[108:111], v[196:199], v[228:231]
  s_nop 0
  v_mul_f32 v92, v92, v3
  v_mul_f32 v93, v93, v3
  v_mfma_f32_16x16x32_bf16 v[228:231], a[112:115], v[200:203], v[228:231]
  s_nop 0
  v_mul_f32 v94, v94, v3
  v_mul_f32 v95, v95, v3
  v_mfma_f32_16x16x32_bf16 v[228:231], a[116:119], v[204:207], v[228:231]
  s_nop 0
  v_cvt_pk_bf16_f32 v148, v88, v89
  v_cvt_pk_bf16_f32 v149, v90, v91
  v_mfma_f32_16x16x32_bf16 v[228:231], a[120:123], v[208:211], v[228:231]
  s_nop 0
  v_cvt_pk_bf16_f32 v150, v92, v93
  v_cvt_pk_bf16_f32 v151, v94, v95
  v_mfma_f32_16x16x32_bf16 v[228:231], a[124:127], v[212:215], v[228:231]
  s_nop 0
  ds_write_b128 v13, v[148:151] offset:1024
  v_mul_f32 v96, v96, v3
  v_mfma_f32_16x16x32_bf16 v[216:219], a[128:131], v[184:187], 0
  s_nop 0
  v_mul_f32 v97, v97, v3
  v_mul_f32 v98, v98, v3
  v_mfma_f32_16x16x32_bf16 v[216:219], a[132:135], v[188:191], v[216:219]
  s_nop 0
  v_mul_f32 v99, v99, v3
  v_mul_f32 v100, v100, v3
  v_mfma_f32_16x16x32_bf16 v[216:219], a[136:139], v[192:195], v[216:219]
  s_nop 0
  v_mul_f32 v101, v101, v3
  v_mul_f32 v102, v102, v3
  v_mfma_f32_16x16x32_bf16 v[216:219], a[140:143], v[196:199], v[216:219]
  s_nop 0
  v_mul_f32 v103, v103, v3
  v_mfma_f32_16x16x32_bf16 v[216:219], a[144:147], v[200:203], v[216:219]
  s_waitcnt lgkmcnt(1)
  v_cvt_pk_bf16_f32 v144, v96, v97
  v_cvt_pk_bf16_f32 v145, v98, v99
  v_mfma_f32_16x16x32_bf16 v[216:219], a[148:151], v[204:207], v[216:219]
  s_nop 0
  v_cvt_pk_bf16_f32 v146, v100, v101
  v_cvt_pk_bf16_f32 v147, v102, v103
  v_mfma_f32_16x16x32_bf16 v[216:219], a[152:155], v[208:211], v[216:219]
  s_nop 0
  ds_write_b128 v13, v[144:147] offset:2048
  v_mul_f32 v104, v104, v3
  v_mfma_f32_16x16x32_bf16 v[216:219], a[156:159], v[212:215], v[216:219]
  s_nop 0
  v_cvt_pk_bf16_f32 v236, v224, v225
  v_cvt_pk_bf16_f32 v237, v226, v227
  v_mfma_f32_16x16x32_bf16 v[220:223], a[160:163], v[184:187], 0
  s_nop 0
  v_cvt_pk_bf16_f32 v238, v228, v229
  v_cvt_pk_bf16_f32 v239, v230, v231
  v_mfma_f32_16x16x32_bf16 v[220:223], a[164:167], v[188:191], v[220:223]
  s_nop 0
  buffer_store_dwordx4 v[236:239], v2, s[40:43], s71 offen offset:1024 sc1
  v_mul_f32 v105, v105, v3
  v_mfma_f32_16x16x32_bf16 v[220:223], a[168:171], v[192:195], v[220:223]
  s_nop 0
  v_mul_f32 v106, v106, v3
  v_mul_f32 v107, v107, v3
  v_mfma_f32_16x16x32_bf16 v[220:223], a[172:175], v[196:199], v[220:223]
  s_nop 0
  v_mul_f32 v108, v108, v3
  v_mul_f32 v109, v109, v3
  v_mfma_f32_16x16x32_bf16 v[220:223], a[176:179], v[200:203], v[220:223]
  s_nop 0
  v_mul_f32 v110, v110, v3
  v_mul_f32 v111, v111, v3
  v_mfma_f32_16x16x32_bf16 v[220:223], a[180:183], v[204:207], v[220:223]
  s_waitcnt lgkmcnt(1)
  v_cvt_pk_bf16_f32 v148, v104, v105
  v_cvt_pk_bf16_f32 v149, v106, v107
  v_mfma_f32_16x16x32_bf16 v[220:223], a[184:187], v[208:211], v[220:223]
  s_nop 0
  v_cvt_pk_bf16_f32 v150, v108, v109
  v_cvt_pk_bf16_f32 v151, v110, v111
  v_mfma_f32_16x16x32_bf16 v[220:223], a[188:191], v[212:215], v[220:223]
  s_nop 0
  ds_write_b128 v13, v[148:151] offset:3072
  v_xor_b32 v13, 0x4000, v13
  v_mfma_f32_16x16x32_bf16 v[224:227], a[192:195], v[184:187], 0
  s_nop 0
  v_mfma_f32_16x16x32_bf16 v[224:227], a[196:199], v[188:191], v[224:227]
  s_nop 0
  v_mfma_f32_16x16x32_bf16 v[224:227], a[200:203], v[192:195], v[224:227]
  s_nop 0
  v_mfma_f32_16x16x32_bf16 v[224:227], a[204:207], v[196:199], v[224:227]
  s_nop 0
  v_mfma_f32_16x16x32_bf16 v[224:227], a[208:211], v[200:203], v[224:227]
  s_nop 0
  v_mfma_f32_16x16x32_bf16 v[224:227], a[212:215], v[204:207], v[224:227]
  s_nop 0
  v_mfma_f32_16x16x32_bf16 v[224:227], a[216:219], v[208:211], v[224:227]
  s_nop 0
  v_mfma_f32_16x16x32_bf16 v[224:227], a[220:223], v[212:215], v[224:227]
  s_nop 0
  v_cvt_pk_bf16_f32 v232, v216, v217
  v_cvt_pk_bf16_f32 v233, v218, v219
  v_mfma_f32_16x16x32_bf16 v[228:231], a[224:227], v[184:187], 0
  s_nop 0
  v_cvt_pk_bf16_f32 v234, v220, v221
  v_cvt_pk_bf16_f32 v235, v222, v223
  v_mfma_f32_16x16x32_bf16 v[228:231], a[228:231], v[188:191], v[228:231]
  s_nop 0
  buffer_store_dwordx4 v[232:235], v2, s[40:43], s71 offen offset:2048 sc1
  v_mfma_f32_16x16x32_bf16 v[228:231], a[232:235], v[192:195], v[228:231]
  s_nop 0
  v_mfma_f32_16x16x32_bf16 v[228:231], a[236:239], v[196:199], v[228:231]
  s_nop 0
  v_mfma_f32_16x16x32_bf16 v[228:231], a[240:243], v[200:203], v[228:231]
  s_nop 0
  v_mfma_f32_16x16x32_bf16 v[228:231], a[244:247], v[204:207], v[228:231]
  s_nop 0
  v_mfma_f32_16x16x32_bf16 v[228:231], a[248:251], v[208:211], v[228:231]
  s_nop 0
  v_mfma_f32_16x16x32_bf16 v[228:231], a[252:255], v[212:215], v[228:231]
  s_nop 0
  s_nop 6
  v_cvt_pk_bf16_f32 v236, v224, v225
  v_cvt_pk_bf16_f32 v237, v226, v227
  v_cvt_pk_bf16_f32 v238, v228, v229
  v_cvt_pk_bf16_f32 v239, v230, v231
  buffer_store_dwordx4 v[236:239], v2, s[40:43], s71 offen offset:3072 sc1
  s_cmp_ge_u32 s66, 49152
  s_mov_b32 s60, 49152
  s_cmov_b32 s60, -49152
  s_add_u32 s66, s66, s60
  s_waitcnt vmcnt(4)
  s_bitcmp1_b32 s64, 2
  s_cbranch_scc1 L_b_sig_4
  s_lshr_b32 s58, s64, 2
  s_add_u32 s58, s58, 147456
  v_mov_b32 v3, s58
  s_mov_b64 exec, 1
  ds_add_rtn_u32 v3, v3, v241
  s_lshl_b32 s58, s64, 3
  s_add_u32 s58, s58, 0xd087000
  s_waitcnt lgkmcnt(0)
  v_cmp_eq_u32 vcc, 3, v3
  s_cbranch_vccz L_b_sig_4x
  buffer_atomic_add v241, v7, s[40:43], s58 offen
L_b_sig_4x:
  s_mov_b64 exec, -1
L_b_sig_4:
  s_mov_b32 s64, s62
  s_branch L_b_join
L_b_alone:
  ds_read_b128 v[152:155], v14 offset:0
  ds_read_b128 v[156:159], v14 offset:1024
  ds_read_b128 v[160:163], v14 offset:2048
  ds_read_b128 v[164:167], v14 offset:3072
  ds_read_b128 v[168:171], v14 offset:4096
  ds_read_b128 v[172:175], v14 offset:5120
  ds_read_b128 v[176:179], v14 offset:6144
  ds_read_b128 v[180:183], v14 offset:7168
  s_waitcnt lgkmcnt(7)
  v_mfma_f32_16x16x32_bf16 v[216:219], a[0:3], v[152:155], 0
  s_waitcnt lgkmcnt(6)
  v_mfma_f32_16x16x32_bf16 v[216:219], a[4:7], v[156:159], v[216:219]
  s_waitcnt lgkmcnt(5)
  v_mfma_f32_16x16x32_bf16 v[216:219], a[8:11], v[160:163], v[216:219]
  s_waitcnt lgkmcnt(4)
  v_mfma_f32_16x16x32_bf16 v[216:219], a[12:15], v[164:167], v[216:219]
  s_waitcnt lgkmcnt(3)
  v_mfma_f32_16x16x32_bf16 v[216:219], a[16:19], v[168:171], v[216:219]
  s_waitcnt lgkmcnt(2)
  v_mfma_f32_16x16x32_bf16 v[216:219], a[20:23], v[172:175], v[216:219]
  s_waitcnt lgkmcnt(1)
  v_mfma_f32_16x16x32_bf16 v[216:219], a[24:27], v[176:179], v[216:219]
  s_waitcnt lgkmcnt(0)
  v_mfma_f32_16x16x32_bf16 v[216:219], a[28:31], v[180:183], v[216:219]
  s_nop 0
  v_mfma_f32_16x16x32_bf16 v[220:223], a[32:35], v[152:155], 0
  s_add_u32 m0, s66, 0
  s_add_u32 s59, s68, 0x0
  buffer_load_dwordx4 v2, s[40:43], s59 offen offset:0 sc1 lds
  v_mfma_f32_16x16x32_bf16 v[220:223], a[36:39], v[156:159], v[220:223]
  s_nop 0
  v_mfma_f32_16x16x32_bf16 v[220:223], a[40:43], v[160:163], v[220:223]
  s_nop 0
  buffer_load_dwordx4 v2, s[40:43], s59 offen offset:1024 sc1 lds
  v_mfma_f32_16x16x32_bf16 v[220:223], a[44:47], v[164:167], v[220:223]
  s_nop 0
  v_mfma_f32_16x16x32_bf16 v[220:223], a[48:51], v[168:171], v[220:223]
  s_nop 0
  buffer_load_dwordx4 v2, s[40:43], s59 offen offset:2048 sc1 lds
  v_mfma_f32_16x16x32_bf16 v[220:223], a[52:55], v[172:175], v[220:223]
  s_nop 0
  v_mfma_f32_16x16x32_bf16 v[220:223], a[56:59], v[176:179], v[220:223]
  s_nop 0
  buffer_load_dwordx4 v2, s[40:43], s59 offen offset:3072 sc1 lds
  v_mfma_f32_16x16x32_bf16 v[220:223], a[60:63], v[180:183], v[220:223]
  s_nop 0
  v_mfma_f32_16x16x32_bf16 v[224:227], a[64:67], v[152:155], 0
  s_add_u32 m0, s66, 8192
  s_add_u32 s59, s68, 0x1000000
  buffer_load_dwordx4 v2, s[40:43], s59 offen offset:0 sc1 lds
  v_mfma_f32_16x16x32_bf16 v[224:227], a[68:71], v[156:159], v[224:227]
  s_nop 0
  v_mfma_f32_16x16x32_bf16 v[224:227], a[72:75], v[160:163], v[224:227]
  s_nop 0
  buffer_load_dwordx4 v2, s[40:43], s59 offen offset:1024 sc1 lds
  v_mfma_f32_16x16x32_bf16 v[224:227], a[76:79], v[164:167], v[224:227]
  s_nop 0
  v_mfma_f32_16x16x32_bf16 v[224:227], a[80:83], v[168:171], v[224:227]
  s_nop 0
  buffer_load_dwordx4 v2, s[40:43], s59 offen offset:2048 sc1 lds
  v_mfma_f32_16x16x32_bf16 v[224:227], a[84:87], v[172:175], v[224:227]
  s_nop 0
  v_mfma_f32_16x16x32_bf16 v[224:227], a[88:91], v[176:179], v[224:227]
  s_nop 0
  buffer_load_dwordx4 v2, s[40:43], s59 offen offset:3072 sc1 lds
  v_mfma_f32_16x16x32_bf16 v[224:227], a[92:95], v[180:183], v[224:227]
  s_nop 0
  v_cvt_pk_bf16_f32 v232, v216, v217
  v_cvt_pk_bf16_f32 v233, v218, v219
  v_mfma_f32_16x16x32_bf16 v[228:231], a[96:99], v[152:155], 0
  s_nop 0
  v_cvt_pk_bf16_f32 v234, v220, v221
  v_cvt_pk_bf16_f32 v235, v222, v223
  v_mfma_f32_16x16x32_bf16 v[228:231], a[100:103], v[156:159], v[228:231]
  s_nop 0
  buffer_store_dwordx4 v[232:235], v2, s[40:43], s71 offen offset:0 sc1
  v_mfma_f32_16x16x32_bf16 v[228:231], a[104:107], v[160:163], v[228:231]
  s_add_u32 m0, s66, 16384
  s_add_u32 s59, s68, 0x2000000
  buffer_load_dwordx4 v2, s[40:43], s59 offen offset:0 sc1 lds
  v_mfma_f32_16x16x32_bf16 v[228:231], a[108:111], v[164:167], v[228:231]
  s_nop 0
  v_mfma_f32_16x16x32_bf16 v[228:231], a[112:115], v[168:171], v[228:231]
  s_nop 0
  buffer_load_dwordx4 v2, s[40:43], s59 offen offset:1024 sc1 lds
  v_mfma_f32_16x16x32_bf16 v[228:231], a[116:119], v[172:175], v[228:231]
  s_nop 0
  v_mfma_f32_16x16x32_bf16 v[228:231], a[120:123], v[176:179], v[228:231]
  s_nop 0
  buffer_load_dwordx4 v2, s[40:43], s59 offen offset:2048 sc1 lds
  v_mfma_f32_16x16x32_bf16 v[228:231], a[124:127], v[180:183], v[228:231]
  s_nop 0
  v_mfma_f32_16x16x32_bf16 v[216:219], a[128:131], v[152:155], 0
  s_nop 0
  buffer_load_dwordx4 v2, s[40:43], s59 offen offset:3072 sc1 lds
  v_mfma_f32_16x16x32_bf16 v[216:219], a[132:135], v[156:159], v[216:219]
  s_nop 0
  v_mfma_f32_16x16x32_bf16 v[216:219], a[136:139], v[160:163], v[216:219]
  s_nop 0
  buffer_load_dword v11, v31, s[40:43], s74 offen sc1
  v_mfma_f32_16x16x32_bf16 v[216:219], a[140:143], v[164:167], v[216:219]
  s_nop 0
  v_mfma_f32_16x16x32_bf16 v[216:219], a[144:147], v[168:171], v[216:219]
  s_nop 0
  buffer_load_dword v240, v7, s[40:43], s73 offen sc1
  v_mfma_f32_16x16x32_bf16 v[216:219], a[148:151], v[172:175], v[216:219]
  s_nop 0
  v_mfma_f32_16x16x32_bf16 v[216:219], a[152:155], v[176:179], v[216:219]
  s_nop 0
  v_mfma_f32_16x16x32_bf16 v[216:219], a[156:159], v[180:183], v[216:219]
  s_nop 0
  v_cvt_pk_bf16_f32 v236, v224, v225
  v_cvt_pk_bf16_f32 v237, v226, v227
  v_mfma_f32_16x16x32_bf16 v[220:223], a[160:163], v[152:155], 0
  s_nop 0
  ds_read_b128 v[184:187], v14 offset:8192
  v_cvt_pk_bf16_f32 v238, v228, v229
  v_cvt_pk_bf16_f32 v239, v230, v231
  v_mfma_f32_16x16x32_bf16 v[220:223], a[164:167], v[156:159], v[220:223]
  s_nop 0
  buffer_store_dwordx4 v[236:239], v2, s[40:43], s71 offen offset:1024 sc1
  v_mfma_f32_16x16x32_bf16 v[220:223], a[168:171], v[160:163], v[220:223]
  s_nop 0
  ds_read_b128 v[188:191], v14 offset:9216
  v_mfma_f32_16x16x32_bf16 v[220:223], a[172:175], v[164:167], v[220:223]
  s_nop 0
  v_mfma_f32_16x16x32_bf16 v[220:223], a[176:179], v[168:171], v[220:223]
  s_nop 0
  ds_read_b128 v[192:195], v14 offset:10240
  v_mfma_f32_16x16x32_bf16 v[220:223], a[180:183], v[172:175], v[220:223]
  s_nop 0
  v_mfma_f32_16x16x32_bf16 v[220:223], a[184:187], v[176:179], v[220:223]
  s_nop 0
  ds_read_b128 v[196:199], v14 offset:11264
  v_mfma_f32_16x16x32_bf16 v[220:223], a[188:191], v[180:183], v[220:223]
  s_nop 0
  v_mfma_f32_16x16x32_bf16 v[224:227], a[192:195], v[152:155], 0
  s_nop 0
  ds_read_b128 v[200:203], v14 offset:12288
  v_mfma_f32_16x16x32_bf16 v[224:227], a[196:199], v[156:159], v[224:227]
  s_nop 0
  v_mfma_f32_16x16x32_bf16 v[224:227], a[200:203], v[160:163], v[224:227]
  s_nop 0
  ds_read_b128 v[204:207], v14 offset:13312
  v_mfma_f32_16x16x32_bf16 v[224:227], a[204:207], v[164:167], v[224:227]
  s_nop 0
  v_mfma_f32_16x16x32_bf16 v[224:227], a[208:211], v[168:171], v[224:227]
  s_nop 0
  ds_read_b128 v[208:211], v14 offset:14336
  v_mfma_f32_16x16x32_bf16 v[224:227], a[212:215], v[172:175], v[224:227]
  s_nop 0
  v_mfma_f32_16x16x32_bf16 v[224:227], a[216:219], v[176:179], v[224:227]
  s_nop 0
  ds_read_b128 v[212:215], v14 offset:15360
  v_mfma_f32_16x16x32_bf16 v[224:227], a[220:223], v[180:183], v[224:227]
  s_nop 0
  v_cvt_pk_bf16_f32 v232, v216, v217
  v_cvt_pk_bf16_f32 v233, v218, v219
  v_mfma_f32_16x16x32_bf16 v[228:231], a[224:227], v[152:155], 0
  s_nop 0
  v_cvt_pk_bf16_f32 v234, v220, v221
  v_cvt_pk_bf16_f32 v235, v222, v223
  v_mfma_f32_16x16x32_bf16 v[228:231], a[228:231], v[156:159], v[228:231]
  s_nop 0
  buffer_store_dwordx4 v[232:235], v2, s[40:43], s71 offen offset:2048 sc1
  v_mfma_f32_16x16x32_bf16 v[228:231], a[232:235], v[160:163], v[228:231]
  s_nop 0
  v_mfma_f32_16x16x32_bf16 v[228:231], a[236:239], v[164:167], v[228:231]
  s_nop 0
  v_mfma_f32_16x16x32_bf16 v[228:231], a[240:243], v[168:171], v[228:231]
  s_nop 0
  v_mfma_f32_16x16x32_bf16 v[228:231], a[244:247], v[172:175], v[228:231]
  s_nop 0
  v_mfma_f32_16x16x32_bf16 v[228:231], a[248:251], v[176:179], v[228:231]
  s_nop 0
  v_mfma_f32_16x16x32_bf16 v[228:231], a[252:255], v[180:183], v[228:231]
  s_waitcnt lgkmcnt(0)
  v_mfma_f32_16x16x32_bf16 v[216:219], a[0:3], v[184:187], 0
  s_nop 0
  v_mfma_f32_16x16x32_bf16 v[216:219], a[4:7], v[188:191], v[216:219]
  s_nop 0
  v_mfma_f32_16x16x32_bf16 v[216:219], a[8:11], v[192:195], v[216:219]
  s_nop 0
  v_xor_b32 v14, 0x4000, v14
  v_mfma_f32_16x16x32_bf16 v[216:219], a[12:15], v[196:199], v[216:219]
  s_nop 0
  v_mfma_f32_16x16x32_bf16 v[216:219], a[16:19], v[200:203], v[216:219]
  s_nop 0
  v_mfma_f32_16x16x32_bf16 v[216:219], a[20:23], v[204:207], v[216:219]
  s_nop 0
  v_mfma_f32_16x16x32_bf16 v[216:219], a[24:27], v[208:211], v[216:219]
  s_nop 0
  v_mfma_f32_16x16x32_bf16 v[216:219], a[28:31], v[212:215], v[216:219]
  s_nop 0
  v_cvt_pk_bf16_f32 v236, v224, v225
  v_cvt_pk_bf16_f32 v237, v226, v227
  v_mfma_f32_16x16x32_bf16 v[220:223], a[32:35], v[184:187], 0
  s_nop 0
  v_cvt_pk_bf16_f32 v238, v228, v229
  v_cvt_pk_bf16_f32 v239, v230, v231
  v_mfma_f32_16x16x32_bf16 v[220:223], a[36:39], v[188:191], v[220:223]
  s_nop 0
  buffer_store_dwordx4 v[236:239], v2, s[40:43], s71 offen offset:3072 sc1
  v_mfma_f32_16x16x32_bf16 v[220:223], a[40:43], v[192:195], v[220:223]
  s_nop 0
  v_mfma_f32_16x16x32_bf16 v[220:223], a[44:47], v[196:199], v[220:223]
  s_nop 0
  v_mfma_f32_16x16x32_bf16 v[220:223], a[48:51], v[200:203], v[220:223]
  s_nop 0
  v_mfma_f32_16x16x32_bf16 v[220:223], a[52:55], v[204:207], v[220:223]
  s_nop 0
  v_mfma_f32_16x16x32_bf16 v[220:223], a[56:59], v[208:211], v[220:223]
  s_nop 0
  v_mfma_f32_16x16x32_bf16 v[220:223], a[60:63], v[212:215], v[220:223]
  s_nop 0
  v_mfma_f32_16x16x32_bf16 v[224:227], a[64:67], v[184:187], 0
  s_nop 0
  v_mfma_f32_16x16x32_bf16 v[224:227], a[68:71], v[188:191], v[224:227]
  s_nop 0
  v_mfma_f32_16x16x32_bf16 v[224:227], a[72:75], v[192:195], v[224:227]
  s_nop 0
  v_mfma_f32_16x16x32_bf16 v[224:227], a[76:79], v[196:199], v[224:227]
  s_nop 0
  v_mfma_f32_16x16x32_bf16 v[224:227], a[80:83], v[200:203], v[224:227]
  s_nop 0
  v_mfma_f32_16x16x32_bf16 v[224:227], a[84:87], v[204:207], v[224:227]
  s_nop 0
  v_mfma_f32_16x16x32_bf16 v[224:227], a[88:91], v[208:211], v[224:227]
  s_add_u32 s71, s71, 786432
  v_mfma_f32_16x16x32_bf16 v[224:227], a[92:95], v[212:215], v[224:227]
  s_nop 0
  v_cvt_pk_bf16_f32 v232, v216, v217
  v_cvt_pk_bf16_f32 v233, v218, v219
  v_mfma_f32_16x16x32_bf16 v[228:231], a[96:99], v[184:187], 0
  s_nop 0
  v_cvt_pk_bf16_f32 v234, v220, v221
  v_cvt_pk_bf16_f32 v235, v222, v223
  v_mfma_f32_16x16x32_bf16 v[228:231], a[100:103], v[188:191], v[228:231]
  s_nop 0
  buffer_store_dwordx4 v[232:235], v2, s[40:43], s71 offen offset:0 sc1
  v_mfma_f32_16x16x32_bf16 v[228:231], a[104:107], v[192:195], v[228:231]
  s_nop 0
  v_mfma_f32_16x16x32_bf16 v[228:231], a[108:111], v[196:199], v[228:231]
  s_nop 0
  v_mfma_f32_16x16x32_bf16 v[228:231], a[112:115], v[200:203], v[228:231]
  s_nop 0
  v_mfma_f32_16x16x32_bf16 v[228:231], a[116:119], v[204:207], v[228:231]
  s_nop 0
  v_mfma_f32_16x16x32_bf16 v[228:231], a[120:123], v[208:211], v[228:231]
  s_nop 0
  v_mfma_f32_16x16x32_bf16 v[228:231], a[124:127], v[212:215], v[228:231]
  s_nop 0
  v_mfma_f32_16x16x32_bf16 v[216:219], a[128:131], v[184:187], 0
  s_nop 0
  v_mfma_f32_16x16x32_bf16 v[216:219], a[132:135], v[188:191], v[216:219]
  s_nop 0
  v_mfma_f32_16x16x32_bf16 v[216:219], a[136:139], v[192:195], v[216:219]
  s_nop 0
  v_mfma_f32_16x16x32_bf16 v[216:219], a[140:143], v[196:199], v[216:219]
  s_nop 0
  v_mfma_f32_16x16x32_bf16 v[216:219], a[144:147], v[200:203], v[216:219]
  s_nop 0
  v_mfma_f32_16x16x32_bf16 v[216:219], a[148:151], v[204:207], v[216:219]
  s_nop 0
  v_mfma_f32_16x16x32_bf16 v[216:219], a[152:155], v[208:211], v[216:219]
  s_nop 0
  v_mfma_f32_16x16x32_bf16 v[216:219], a[156:159], v[212:215], v[216:219]
  s_nop 0
  v_cvt_pk_bf16_f32 v236, v224, v225
  v_cvt_pk_bf16_f32 v237, v226, v227
  v_mfma_f32_16x16x32_bf16 v[220:223], a[160:163], v[184:187], 0
  s_nop 0
  v_cvt_pk_bf16_f32 v238, v228, v229
  v_cvt_pk_bf16_f32 v239, v230, v231
  v_mfma_f32_16x16x32_bf16 v[220:223], a[164:167], v[188:191], v[220:223]
  s_nop 0
  buffer_store_dwordx4 v[236:239], v2, s[40:43], s71 offen offset:1024 sc1
  v_mfma_f32_16x16x32_bf16 v[220:223], a[168:171], v[192:195], v[220:223]
  s_nop 0
  v_mfma_f32_16x16x32_bf16 v[220:223], a[172:175], v[196:199], v[220:223]
  s_nop 0
  v_mfma_f32_16x16x32_bf16 v[220:223], a[176:179], v[200:203], v[220:223]
  s_nop 0
  v_mfma_f32_16x16x32_bf16 v[220:223], a[180:183], v[204:207], v[220:223]
  s_nop 0
  v_mfma_f32_16x16x32_bf16 v[220:223], a[184:187], v[208:211], v[220:223]
  s_nop 0
  v_mfma_f32_16x16x32_bf16 v[220:223], a[188:191], v[212:215], v[220:223]
  s_nop 0
  v_mfma_f32_16x16x32_bf16 v[224:227], a[192:195], v[184:187], 0
  s_nop 0
  v_mfma_f32_16x16x32_bf16 v[224:227], a[196:199], v[188:191], v[224:227]
  s_nop 0
  v_mfma_f32_16x16x32_bf16 v[224:227], a[200:203], v[192:195], v[224:227]
  s_nop 0
  v_mfma_f32_16x16x32_bf16 v[224:227], a[204:207], v[196:199], v[224:227]
  s_nop 0
  v_mfma_f32_16x16x32_bf16 v[224:227], a[208:211], v[200:203], v[224:227]
  s_nop 0
  v_mfma_f32_16x16x32_bf16 v[224:227], a[212:215], v[204:207], v[224:227]
  s_nop 0
  v_mfma_f32_16x16x32_bf16 v[224:227], a[216:219], v[208:211], v[224:227]
  s_nop 0
  v_mfma_f32_16x16x32_bf16 v[224:227], a[220:223], v[212:215], v[224:227]
  s_nop 0
  v_cvt_pk_bf16_f32 v232, v216, v217
  v_cvt_pk_bf16_f32 v233, v218, v219
  v_mfma_f32_16x16x32_bf16 v[228:231], a[224:227], v[184:187], 0
  s_nop 0
  v_cvt_pk_bf16_f32 v234, v220, v221
  v_cvt_pk_bf16_f32 v235, v222, v223
  v_mfma_f32_16x16x32_bf16 v[228:231], a[228:231], v[188:191], v[228:231]
  s_nop 0
  buffer_store_dwordx4 v[232:235], v2, s[40:43], s71 offen offset:2048 sc1
  v_mfma_f32_16x16x32_bf16 v[228:231], a[232:235], v[192:195], v[228:231]
  s_nop 0
  v_mfma_f32_16x16x32_bf16 v[228:231], a[236:239], v[196:199], v[228:231]
  s_nop 0
  v_mfma_f32_16x16x32_bf16 v[228:231], a[240:243], v[200:203], v[228:231]
  s_nop 0
  v_mfma_f32_16x16x32_bf16 v[228:231], a[244:247], v[204:207], v[228:231]
  s_nop 0
  v_mfma_f32_16x16x32_bf16 v[228:231], a[248:251], v[208:211], v[228:231]
  s_nop 0
  v_mfma_f32_16x16x32_bf16 v[228:231], a[252:255], v[212:215], v[228:231]
  s_nop 0
  s_nop 6
  v_cvt_pk_bf16_f32 v236, v224, v225
  v_cvt_pk_bf16_f32 v237, v226, v227
  v_cvt_pk_bf16_f32 v238, v228, v229
  v_cvt_pk_bf16_f32 v239, v230, v231
  buffer_store_dwordx4 v[236:239], v2, s[40:43], s71 offen offset:3072 sc1
  s_cmp_ge_u32 s66, 49152
  s_mov_b32 s60, 49152
  s_cmov_b32 s60, -49152
  s_add_u32 s66, s66, s60
  s_waitcnt vmcnt(0)
  s_bitcmp1_b32 s62, 2
  s_cbranch_scc1 L_b_sig_5
  s_lshr_b32 s58, s62, 2
  s_add_u32 s58, s58, 147456
  v_mov_b32 v3, s58
  s_mov_b64 exec, 1
  ds_add_rtn_u32 v3, v3, v241
  s_lshl_b32 s58, s62, 3
  s_add_u32 s58, s58, 0xd087000
  s_waitcnt lgkmcnt(0)
  v_cmp_eq_u32 vcc, 3, v3
  s_cbranch_vccz L_b_sig_5x
  buffer_atomic_add v241, v7, s[40:43], s58 offen
L_b_sig_5x:
  s_mov_b64 exec, -1
L_b_sig_5:
  s_bitcmp1_b32 s64, 2
  s_cbranch_scc1 L_b_sig_6
  s_lshr_b32 s58, s64, 2
  s_add_u32 s58, s58, 147456
  v_mov_b32 v3, s58
  s_mov_b64 exec, 1
  ds_add_rtn_u32 v3, v3, v241
  s_lshl_b32 s58, s64, 3
  s_add_u32 s58, s58, 0xd087000
  s_waitcnt lgkmcnt(0)
  v_cmp_eq_u32 vcc, 3, v3
  s_cbranch_vccz L_b_sig_6x
  buffer_atomic_add v241, v7, s[40:43], s58 offen
L_b_sig_6x:
  s_mov_b64 exec, -1
L_b_sig_6:
  s_mov_b32 s64, 4
  s_bitcmp1_b32 s63, 2
  s_cbranch_scc0 L_b_chk
  s_barrier
  s_branch L_next
L_b_late:
  s_sleep 2
  s_lshl_b32 s58, s63, 13
  s_add_u32 s58, s58, s69
  buffer_load_dwordx4 v[56:59], v2, s[40:43], s58 offen offset:0 sc1
  buffer_load_dwordx4 v[60:63], v2, s[40:43], s58 offen offset:1024 sc1
  buffer_load_dwordx4 v[64:67], v2, s[40:43], s58 offen offset:2048 sc1
  buffer_load_dwordx4 v[68:71], v2, s[40:43], s58 offen offset:3072 sc1
  s_add_u32 s57, s57, 1
  s_cmp_gt_u32 s57, 1048576
  s_cbranch_scc1 L_exit
  s_waitcnt vmcnt(0)
  s_branch L_b_chk
L_b_ff_1:
  buffer_load_dword v240, v7, s[40:43], s73 offen sc1
  s_add_u32 s57, s57, 1
  s_cmp_gt_u32 s57, 1048576
  s_cbranch_scc1 L_exit
  s_waitcnt vmcnt(0)
  s_branch L_b_ff_1c
L_b_ff_2:
  buffer_load_dword v240, v7, s[40:43], s73 offen sc1
  s_add_u32 s57, s57, 1
  s_cmp_gt_u32 s57, 1048576
  s_cbranch_scc1 L_exit
  s_waitcnt vmcnt(0)
  s_branch L_b_ff_2c
L_b_ff_3:
  buffer_load_dword v240, v7, s[40:43], s73 offen sc1
  s_add_u32 s57, s57, 1
  s_cmp_gt_u32 s57, 1048576
  s_cbranch_scc1 L_exit
  s_waitcnt vmcnt(0)
  s_branch L_b_ff_3c
L_red:
  s_mov_b32 s48, s36
  s_and_b32 s49, s37, 0xffff
  s_mov_b32 s50, 0x200000
  s_mov_b32 s51, 0x20000
  v_lshlrev_b32 v2, 4, v0
  v_mov_b32 v7, 0
  s_mov_b32 s57, 0
  v_and_b32 v3, 4, v1
  v_cmp_ne_u32 vcc, 0, v3
  v_bfe_u32 v3, v1, 4, 6
  v_lshrrev_b32 v4, 3, v3
  s_lshr_b32 s58, vcc_lo, s95
  s_ff1_i32_b32 s58, s58
  s_bfm_b32 s58, s58, s95
  s_cmp_eq_u32 s62, 0
  s_cselect_b32 s59, s58, 0
  v_lshlrev_b32 v4, 7, v4
  v_add_u32 v4, 0xd086000, v4
  v_lshlrev_b32 v3, 7, v3
  v_add_u32 v3, 0xd087000, v3
  v_cmp_gt_u32 vcc, 32, v0
  v_and_b32 v5, 15, v0
  v_lshrrev_b32 v6, 4, v0
  v_cndmask_b32 v3, v3, v4, vcc
  v_cndmask_b32 v4, 16, 32, vcc
  buffer_load_dword v16, v3, s[40:43], 0 offen sc1
  v_lshlrev_b32 v24, 10, v5
  v_lshl_add_u32 v24, v6, 4, v24
  v_bfe_u32 v17, v0, 2, 1
  v_lshlrev_b32 v17, 1, v17
  v_sub_u32 v17, v6, v17
  v_bfe_u32 v18, v0, 3, 1
  v_bfe_u32 v19, v0, 1, 1
  v_lshl_add_u32 v18, v18, 1, v19
  v_lshl_add_u32 v17, v17, 2, v18
  v_and_b32 v18, 1, v0
  v_lshlrev_b32 v18, 4, v18
  v_mov_b32 v19, 0x3f80
  v_lshlrev_b32 v18, v18, v19
  v_cmp_eq_u32 vcc, 0, v17
  s_nop 1
  v_cndmask_b32 v8, 0, v18, vcc
  v_cmp_eq_u32 vcc, 1, v17
  s_nop 1
  v_cndmask_b32 v9, 0, v18, vcc
  v_cmp_eq_u32 vcc, 2, v17
  s_nop 1
  v_cndmask_b32 v10, 0, v18, vcc
  v_cmp_eq_u32 vcc, 3, v17
  s_nop 1
  v_cndmask_b32 v11, 0, v18, vcc
  v_cmp_eq_u32 vcc, 4, v17
  s_nop 1
  v_cndmask_b32 v12, 0, v18, vcc
  v_cmp_eq_u32 vcc, 5, v17
  s_nop 1
  v_cndmask_b32 v13, 0, v18, vcc
  v_cmp_eq_u32 vcc, 6, v17
  s_nop 1
  v_cndmask_b32 v14, 0, v18, vcc
  v_cmp_eq_u32 vcc, 7, v17
  s_nop 1
  v_cndmask_b32 v15, 0, v18, vcc
  v_readlane_b32 s63, v1, s95
L_r_wait:
  s_waitcnt vmcnt(0)
  v_cmp_gt_u32 vcc, v4, v16
  s_nop 0
  s_and_b64 vcc, vcc, s[58:59]
  s_cbranch_scc0 L_r_go
  s_sleep 4
  buffer_load_dword v16, v3, s[40:43], 0 offen sc1
  s_add_u32 s57, s57, 1
  s_cmp_gt_u32 s57, 1048576
  s_cbranch_scc1 L_exit
  s_branch L_r_wait
L_r_go:
  s_bfe_u32 s58, s63, 0x60004
  s_bfe_u32 s59, s63, 0x1000e
  s_lshl1_add_u32 s58, s58, s59
  s_mul_i32 s64, s58, 786432
  s_bfe_u32 s59, s63, 0x2000c
  s_lshl2_add_u32 s59, s59, s44
  s_lshl_b32 s58, s58, 14
  s_lshl_b32 s71, s59, 6
  s_add_u32 s71, s71, s58
  s_lshl_b32 s59, s59, 10
  s_add_u32 s64, s64, s59
  s_add_u32 s64, s64, 0x6000000
  s_bitcmp1_b32 s63, 2
  s_cselect_b32 s64, 0x40000000, s64
  buffer_load_dwordx4 v[64:67], v2, s[40:43], s64 offen sc1
  s_add_u32 s64, s64, 0x4000
  buffer_load_dwordx4 v[68:71], v2, s[40:43], s64 offen sc1
  s_add_u32 s64, s64, 0x4000
  buffer_load_dwordx4 v[72:75], v2, s[40:43], s64 offen sc1
  s_add_u32 s64, s64, 0x4000
  buffer_load_dwordx4 v[76:79], v2, s[40:43], s64 offen sc1
  s_add_u32 s64, s64, 0x4000
  buffer_load_dwordx4 v[80:83], v2, s[40:43], s64 offen sc1
  s_add_u32 s64, s64, 0x4000
  buffer_load_dwordx4 v[84:87], v2, s[40:43], s64 offen sc1
  s_add_u32 s64, s64, 0x4000
  buffer_load_dwordx4 v[88:91], v2, s[40:43], s64 offen sc1
  s_add_u32 s64, s64, 0x4000
  buffer_load_dwordx4 v[92:95], v2, s[40:43], s64 offen sc1
  s_add_u32 s64, s64, 0x4000
  buffer_load_dwordx4 v[96:99], v2, s[40:43], s64 offen sc1
  s_add_u32 s64, s64, 0x4000
  buffer_load_dwordx4 v[100:103], v2, s[40:43], s64 offen sc1
  s_add_u32 s64, s64, 0x4000
  buffer_load_dwordx4 v[104:107], v2, s[40:43], s64 offen sc1
  s_add_u32 s64, s64, 0x4000
  buffer_load_dwordx4 v[108:111], v2, s[40:43], s64 offen sc1
  s_add_u32 s64, s64, 0x4000
  buffer_load_dwordx4 v[112:115], v2, s[40:43], s64 offen sc1
  s_add_u32 s64, s64, 0x4000
  buffer_load_dwordx4 v[116:119], v2, s[40:43], s64 offen sc1
  s_add_u32 s64, s64, 0x4000
  buffer_load_dwordx4 v[120:123], v2, s[40:43], s64 offen sc1
  s_add_u32 s64, s64, 0x4000
L_r_loop:
  s_mov_b32 s61, s63
  s_mov_b32 s65, s71
  s_add_u32 s95, s95, 1
  s_nop 0
  v_readlane_b32 s63, v1, s95
  buffer_load_dwordx4 v[124:127], v2, s[40:43], s64 offen sc1
  s_add_u32 s64, s64, 0x4000
  s_waitcnt vmcnt(15)
  v_mfma_f32_16x16x32_bf16 v[16:19], v[8:11], v[64:67], 0
  v_mfma_f32_16x16x32_bf16 v[20:23], v[12:15], v[64:67], 0
  buffer_load_dwordx4 v[64:67], v2, s[40:43], s64 offen sc1
  s_add_u32 s64, s64, 0x4000
  s_waitcnt vmcnt(15)
  v_mfma_f32_16x16x32_bf16 v[16:19], v[8:11], v[68:71], v[16:19]
  v_mfma_f32_16x16x32_bf16 v[20:23], v[12:15], v[68:71], v[20:23]
  buffer_load_dwordx4 v[68:71], v2, s[40:43], s64 offen sc1
  s_add_u32 s64, s64, 0x4000
  s_waitcnt vmcnt(15)
  v_mfma_f32_16x16x32_bf16 v[16:19], v[8:11], v[72:75], v[16:19]
  v_mfma_f32_16x16x32_bf16 v[20:23], v[12:15], v[72:75], v[20:23]
  buffer_load_dwordx4 v[72:75], v2, s[40:43], s64 offen sc1
  s_add_u32 s64, s64, 0x4000
  s_waitcnt vmcnt(15)
  v_mfma_f32_16x16x32_bf16 v[16:19], v[8:11], v[76:79], v[16:19]
  v_mfma_f32_16x16x32_bf16 v[20:23], v[12:15], v[76:79], v[20:23]
  buffer_load_dwordx4 v[76:79], v2, s[40:43], s64 offen sc1
  s_add_u32 s64, s64, 0x4000
  s_waitcnt vmcnt(15)
  v_mfma_f32_16x16x32_bf16 v[16:19], v[8:11], v[80:83], v[16:19]
  v_mfma_f32_16x16x32_bf16 v[20:23], v[12:15], v[80:83], v[20:23]
  buffer_load_dwordx4 v[80:83], v2, s[40:43], s64 offen sc1
  s_add_u32 s64, s64, 0x4000
  s_waitcnt vmcnt(15)
  v_mfma_f32_16x16x32_bf16 v[16:19], v[8:11], v[84:87], v[16:19]
  v_mfma_f32_16x16x32_bf16 v[20:23], v[12:15], v[84:87], v[20:23]
  buffer_load_dwordx4 v[84:87], v2, s[40:43], s64 offen sc1
  s_add_u32 s64, s64, 0x4000
  s_waitcnt vmcnt(15)
  v_mfma_f32_16x16x32_bf16 v[16:19], v[8:11], v[88:91], v[16:19]
  v_mfma_f32_16x16x32_bf16 v[20:23], v[12:15], v[88:91], v[20:23]
  buffer_load_dwordx4 v[88:91], v2, s[40:43], s64 offen sc1
  s_add_u32 s64, s64, 0x4000
  s_waitcnt vmcnt(15)
  v_mfma_f32_16x16x32_bf16 v[16:19], v[8:11], v[92:95], v[16:19]
  v_mfma_f32_16x16x32_bf16 v[20:23], v[12:15], v[92:95], v[20:23]
  buffer_load_dwordx4 v[92:95], v2, s[40:43], s64 offen sc1
  s_add_u32 s64, s64, 0x4000
  s_waitcnt vmcnt(15)
  v_mfma_f32_16x16x32_bf16 v[16:19], v[8:11], v[96:99], v[16:19]
  v_mfma_f32_16x16x32_bf16 v[20:23], v[12:15], v[96:99], v[20:23]
  buffer_load_dwordx4 v[96:99], v2, s[40:43], s64 offen sc1
  s_add_u32 s64, s64, 0x4000
  s_waitcnt vmcnt(15)
  v_mfma_f32_16x16x32_bf16 v[16:19], v[8:11], v[100:103], v[16:19]
  v_mfma_f32_16x16x32_bf16 v[20:23], v[12:15], v[100:103], v[20:23]
  buffer_load_dwordx4 v[100:103], v2, s[40:43], s64 offen sc1
  s_add_u32 s64, s64, 0x4000
  s_waitcnt vmcnt(15)
  v_mfma_f32_16x16x32_bf16 v[16:19], v[8:11], v[104:107], v[16:19]
  v_mfma_f32_16x16x32_bf16 v[20:23], v[12:15], v[104:107], v[20:23]
  buffer_load_dwordx4 v[104:107], v2, s[40:43], s64 offen sc1
  s_add_u32 s64, s64, 0x4000
  s_waitcnt vmcnt(15)
  v_mfma_f32_16x16x32_bf16 v[16:19], v[8:11], v[108:111], v[16:19]
  v_mfma_f32_16x16x32_bf16 v[20:23], v[12:15], v[108:111], v[20:23]
  buffer_load_dwordx4 v[108:111], v2, s[40:43], s64 offen sc1
  s_add_u32 s64, s64, 0x4000
  s_waitcnt vmcnt(15)
  v_mfma_f32_16x16x32_bf16 v[16:19], v[8:11], v[112:115], v[16:19]
  v_mfma_f32_16x16x32_bf16 v[20:23], v[12:15], v[112:115], v[20:23]
  buffer_load_dwordx4 v[112:115], v2, s[40:43], s64 offen sc1
  s_add_u32 s64, s64, 0x4000
  s_waitcnt vmcnt(15)
  v_mfma_f32_16x16x32_bf16 v[16:19], v[8:11], v[116:119], v[16:19]
  v_mfma_f32_16x16x32_bf16 v[20:23], v[12:15], v[116:119], v[20:23]
  buffer_load_dwordx4 v[116:119], v2, s[40:43], s64 offen sc1
  s_add_u32 s64, s64, 0x4000
  s_waitcnt vmcnt(15)
  v_mfma_f32_16x16x32_bf16 v[16:19], v[8:11], v[120:123], v[16:19]
  v_mfma_f32_16x16x32_bf16 v[20:23], v[12:15], v[120:123], v[20:23]
  buffer_load_dwordx4 v[120:123], v2, s[40:43], s64 offen sc1
  s_add_u32 s64, s64, 0x4000
  s_waitcnt vmcnt(15)
  v_mfma_f32_16x16x32_bf16 v[16:19], v[8:11], v[124:127], v[16:19]
  v_mfma_f32_16x16x32_bf16 v[20:23], v[12:15], v[124:127], v[20:23]
  buffer_load_dwordx4 v[124:127], v2, s[40:43], s64 offen sc1
  s_add_u32 s64, s64, 0x4000
  s_waitcnt vmcnt(15)
  v_mfma_f32_16x16x32_bf16 v[16:19], v[8:11], v[64:67], v[16:19]
  v_mfma_f32_16x16x32_bf16 v[20:23], v[12:15], v[64:67], v[20:23]
  s_cmp_lg_u32 s62, 0
  s_cbranch_scc1 L_r_stage
L_r_stageback:
  buffer_load_dwordx4 v[64:67], v2, s[40:43], s64 offen sc1
  s_add_u32 s64, s64, 0x4000
  s_waitcnt vmcnt(15)
  v_mfma_f32_16x16x32_bf16 v[16:19], v[8:11], v[68:71], v[16:19]
  v_mfma_f32_16x16x32_bf16 v[20:23], v[12:15], v[68:71], v[20:23]
  buffer_load_dwordx4 v[68:71], v2, s[40:43], s64 offen sc1
  s_add_u32 s64, s64, 0x4000
  s_waitcnt vmcnt(15)
  v_mfma_f32_16x16x32_bf16 v[16:19], v[8:11], v[72:75], v[16:19]
  v_mfma_f32_16x16x32_bf16 v[20:23], v[12:15], v[72:75], v[20:23]
  buffer_load_dwordx4 v[72:75], v2, s[40:43], s64 offen sc1
  s_add_u32 s64, s64, 0x4000
  s_waitcnt vmcnt(15)
  v_mfma_f32_16x16x32_bf16 v[16:19], v[8:11], v[76:79], v[16:19]
  v_mfma_f32_16x16x32_bf16 v[20:23], v[12:15], v[76:79], v[20:23]
  buffer_load_dwordx4 v[76:79], v2, s[40:43], s64 offen sc1
  s_add_u32 s64, s64, 0x4000
  s_waitcnt vmcnt(15)
  v_mfma_f32_16x16x32_bf16 v[16:19], v[8:11], v[80:83], v[16:19]
  v_mfma_f32_16x16x32_bf16 v[20:23], v[12:15], v[80:83], v[20:23]
  buffer_load_dwordx4 v[80:83], v2, s[40:43], s64 offen sc1
  s_add_u32 s64, s64, 0x4000
  s_waitcnt vmcnt(15)
  v_mfma_f32_16x16x32_bf16 v[16:19], v[8:11], v[84:87], v[16:19]
  v_mfma_f32_16x16x32_bf16 v[20:23], v[12:15], v[84:87], v[20:23]
  buffer_load_dwordx4 v[84:87], v2, s[40:43], s64 offen sc1
  s_add_u32 s64, s64, 0x4000
  s_waitcnt vmcnt(15)
  v_mfma_f32_16x16x32_bf16 v[16:19], v[8:11], v[88:91], v[16:19]
  v_mfma_f32_16x16x32_bf16 v[20:23], v[12:15], v[88:91], v[20:23]
  buffer_load_dwordx4 v[88:91], v2, s[40:43], s64 offen sc1
  s_add_u32 s64, s64, 0x4000
  s_waitcnt vmcnt(15)
  v_mfma_f32_16x16x32_bf16 v[16:19], v[8:11], v[92:95], v[16:19]
  v_mfma_f32_16x16x32_bf16 v[20:23], v[12:15], v[92:95], v[20:23]
  buffer_load_dwordx4 v[92:95], v2, s[40:43], s64 offen sc1
  s_add_u32 s64, s64, 0x4000
  s_waitcnt vmcnt(15)
  v_mfma_f32_16x16x32_bf16 v[16:19], v[8:11], v[96:99], v[16:19]
  v_mfma_f32_16x16x32_bf16 v[20:23], v[12:15], v[96:99], v[20:23]
  buffer_load_dwordx4 v[96:99], v2, s[40:43], s64 offen sc1
  s_add_u32 s64, s64, 0x4000
  s_waitcnt vmcnt(15)
  v_mfma_f32_16x16x32_bf16 v[16:19], v[8:11], v[100:103], v[16:19]
  v_mfma_f32_16x16x32_bf16 v[20:23], v[12:15], v[100:103], v[20:23]
  buffer_load_dwordx4 v[100:103], v2, s[40:43], s64 offen sc1
  s_add_u32 s64, s64, 0x4000
  s_waitcnt vmcnt(15)
  v_mfma_f32_16x16x32_bf16 v[16:19], v[8:11], v[104:107], v[16:19]
  v_mfma_f32_16x16x32_bf16 v[20:23], v[12:15], v[104:107], v[20:23]
  buffer_load_dwordx4 v[104:107], v2, s[40:43], s64 offen sc1
  s_add_u32 s64, s64, 0x4000
  s_waitcnt vmcnt(15)
  v_mfma_f32_16x16x32_bf16 v[16:19], v[8:11], v[108:111], v[16:19]
  v_mfma_f32_16x16x32_bf16 v[20:23], v[12:15], v[108:111], v[20:23]
  buffer_load_dwordx4 v[108:111], v2, s[40:43], s64 offen sc1
  s_add_u32 s64, s64, 0x4000
  s_waitcnt vmcnt(15)
  v_mfma_f32_16x16x32_bf16 v[16:19], v[8:11], v[112:115], v[16:19]
  v_mfma_f32_16x16x32_bf16 v[20:23], v[12:15], v[112:115], v[20:23]
  buffer_load_dwordx4 v[112:115], v2, s[40:43], s64 offen sc1
  s_add_u32 s64, s64, 0x4000
  s_waitcnt vmcnt(15)
  v_mfma_f32_16x16x32_bf16 v[16:19], v[8:11], v[116:119], v[16:19]
  v_mfma_f32_16x16x32_bf16 v[20:23], v[12:15], v[116:119], v[20:23]
  buffer_load_dwordx4 v[116:119], v2, s[40:43], s64 offen sc1
  s_add_u32 s64, s64, 0x4000
  s_waitcnt vmcnt(15)
  v_mfma_f32_16x16x32_bf16 v[16:19], v[8:11], v[120:123], v[16:19]
  v_mfma_f32_16x16x32_bf16 v[20:23], v[12:15], v[120:123], v[20:23]
  buffer_load_dwordx4 v[120:123], v2, s[40:43], s64 offen sc1
  s_add_u32 s64, s64, 0x4000
  s_waitcnt vmcnt(15)
  v_mfma_f32_16x16x32_bf16 v[16:19], v[8:11], v[124:127], v[16:19]
  v_mfma_f32_16x16x32_bf16 v[20:23], v[12:15], v[124:127], v[20:23]
  buffer_load_dwordx4 v[124:127], v2, s[40:43], s64 offen sc1
  s_add_u32 s64, s64, 0x4000
  s_waitcnt vmcnt(15)
  v_mfma_f32_16x16x32_bf16 v[16:19], v[8:11], v[64:67], v[16:19]
  v_mfma_f32_16x16x32_bf16 v[20:23], v[12:15], v[64:67], v[20:23]
  s_bfe_u32 s58, s63, 0x60004
  s_bfe_u32 s59, s63, 0x1000e
  s_lshl1_add_u32 s58, s58, s59
  s_mul_i32 s64, s58, 786432
  s_bfe_u32 s59, s63, 0x2000c
  s_lshl2_add_u32 s59, s59, s44
  s_lshl_b32 s58, s58, 14
  s_lshl_b32 s71, s59, 6
  s_add_u32 s71, s71, s58
  s_lshl_b32 s59, s59, 10
  s_add_u32 s64, s64, s59
  s_add_u32 s64, s64, 0x6000000
  s_bitcmp1_b32 s63, 2
  s_cselect_b32 s64, 0x40000000, s64
  buffer_load_dwordx4 v[64:67], v2, s[40:43], s64 offen sc1
  s_add_u32 s64, s64, 0x4000
  s_waitcnt vmcnt(15)
  v_mfma_f32_16x16x32_bf16 v[16:19], v[8:11], v[68:71], v[16:19]
  v_mfma_f32_16x16x32_bf16 v[20:23], v[12:15], v[68:71], v[20:23]
  buffer_load_dwordx4 v[68:71], v2, s[40:43], s64 offen sc1
  s_add_u32 s64, s64, 0x4000
  s_waitcnt vmcnt(15)
  v_mfma_f32_16x16x32_bf16 v[16:19], v[8:11], v[72:75], v[16:19]
  v_mfma_f32_16x16x32_bf16 v[20:23], v[12:15], v[72:75], v[20:23]
  buffer_load_dwordx4 v[72:75], v2, s[40:43], s64 offen sc1
  s_add_u32 s64, s64, 0x4000
  s_waitcnt vmcnt(15)
  v_mfma_f32_16x16x32_bf16 v[16:19], v[8:11], v[76:79], v[16:19]
  v_mfma_f32_16x16x32_bf16 v[20:23], v[12:15], v[76:79], v[20:23]
  buffer_load_dwordx4 v[76:79], v2, s[40:43], s64 offen sc1
  s_add_u32 s64, s64, 0x4000
  s_waitcnt vmcnt(15)
  v_mfma_f32_16x16x32_bf16 v[16:19], v[8:11], v[80:83], v[16:19]
  v_mfma_f32_16x16x32_bf16 v[20:23], v[12:15], v[80:83], v[20:23]
  buffer_load_dwordx4 v[80:83], v2, s[40:43], s64 offen sc1
  s_add_u32 s64, s64, 0x4000
  s_waitcnt vmcnt(15)
  v_mfma_f32_16x16x32_bf16 v[16:19], v[8:11], v[84:87], v[16:19]
  v_mfma_f32_16x16x32_bf16 v[20:23], v[12:15], v[84:87], v[20:23]
  buffer_load_dwordx4 v[84:87], v2, s[40:43], s64 offen sc1
  s_add_u32 s64, s64, 0x4000
  s_waitcnt vmcnt(15)
  v_mfma_f32_16x16x32_bf16 v[16:19], v[8:11], v[88:91], v[16:19]
  v_mfma_f32_16x16x32_bf16 v[20:23], v[12:15], v[88:91], v[20:23]
  buffer_load_dwordx4 v[88:91], v2, s[40:43], s64 offen sc1
  s_add_u32 s64, s64, 0x4000
  s_waitcnt vmcnt(15)
  v_mfma_f32_16x16x32_bf16 v[16:19], v[8:11], v[92:95], v[16:19]
  v_mfma_f32_16x16x32_bf16 v[20:23], v[12:15], v[92:95], v[20:23]
  buffer_load_dwordx4 v[92:95], v2, s[40:43], s64 offen sc1
  s_add_u32 s64, s64, 0x4000
  s_waitcnt vmcnt(15)
  v_mfma_f32_16x16x32_bf16 v[16:19], v[8:11], v[96:99], v[16:19]
  v_mfma_f32_16x16x32_bf16 v[20:23], v[12:15], v[96:99], v[20:23]
  buffer_load_dwordx4 v[96:99], v2, s[40:43], s64 offen sc1
  s_add_u32 s64, s64, 0x4000
  s_waitcnt vmcnt(15)
  v_mfma_f32_16x16x32_bf16 v[16:19], v[8:11], v[100:103], v[16:19]
  v_mfma_f32_16x16x32_bf16 v[20:23], v[12:15], v[100:103], v[20:23]
  buffer_load_dwordx4 v[100:103], v2, s[40:43], s64 offen sc1
  s_add_u32 s64, s64, 0x4000
  s_waitcnt vmcnt(15)
  v_mfma_f32_16x16x32_bf16 v[16:19], v[8:11], v[104:107], v[16:19]
  v_mfma_f32_16x16x32_bf16 v[20:23], v[12:15], v[104:107], v[20:23]
  buffer_load_dwordx4 v[104:107], v2, s[40:43], s64 offen sc1
  s_add_u32 s64, s64, 0x4000
  s_waitcnt vmcnt(15)
  v_mfma_f32_16x16x32_bf16 v[16:19], v[8:11], v[108:111], v[16:19]
  v_mfma_f32_16x16x32_bf16 v[20:23], v[12:15], v[108:111], v[20:23]
  buffer_load_dwordx4 v[108:111], v2, s[40:43], s64 offen sc1
  s_add_u32 s64, s64, 0x4000
  s_waitcnt vmcnt(15)
  v_mfma_f32_16x16x32_bf16 v[16:19], v[8:11], v[112:115], v[16:19]
  v_mfma_f32_16x16x32_bf16 v[20:23], v[12:15], v[112:115], v[20:23]
  buffer_load_dwordx4 v[112:115], v2, s[40:43], s64 offen sc1
  s_add_u32 s64, s64, 0x4000
  s_waitcnt vmcnt(15)
  v_mfma_f32_16x16x32_bf16 v[16:19], v[8:11], v[116:119], v[16:19]
  v_mfma_f32_16x16x32_bf16 v[20:23], v[12:15], v[116:119], v[20:23]
  buffer_load_dwordx4 v[116:119], v2, s[40:43], s64 offen sc1
  s_add_u32 s64, s64, 0x4000
  s_waitcnt vmcnt(15)
  v_mfma_f32_16x16x32_bf16 v[16:19], v[8:11], v[120:123], v[16:19]
  v_mfma_f32_16x16x32_bf16 v[20:23], v[12:15], v[120:123], v[20:23]
  buffer_load_dwordx4 v[120:123], v2, s[40:43], s64 offen sc1
  s_add_u32 s64, s64, 0x4000
  s_waitcnt vmcnt(15)
  v_mfma_f32_16x16x32_bf16 v[16:19], v[8:11], v[124:127], v[16:19]
  v_mfma_f32_16x16x32_bf16 v[20:23], v[12:15], v[124:127], v[20:23]
  s_nop 6
  v_cvt_pk_bf16_f32 v32, v16, v17
  v_cvt_pk_bf16_f32 v33, v18, v19
  v_cvt_pk_bf16_f32 v34, v20, v21
  v_cvt_pk_bf16_f32 v35, v22, v23
  buffer_store_dwordx4 v[32:35], v24, s[48:51], s65 offen
  s_bitcmp1_b32 s63, 2
  s_cbranch_scc0 L_r_loop
  s_waitcnt vmcnt(1)
  s_branch L_next
L_r_stage:
  s_bfe_u32 s66, s61, 0x60004
  s_lshl_b32 s66, s66, 7
  s_add_u32 s66, s66, 0xd087000
L_r_st2:
  buffer_load_dword v3, v7, s[40:43], s66 offen sc1
  s_add_u32 s57, s57, 1
  s_cmp_gt_u32 s57, 1048576
  s_cbranch_scc1 L_exit
  s_waitcnt vmcnt(0)
  v_cmp_gt_u32 vcc, 16, v3
  s_cbranch_vccz L_r_stageback
  s_sleep 4
  s_branch L_r_st2
L_feed:
  s_cmp_lt_u32 s57, 4
  s_cselect_b64 s[52:53], s[10:11], s[8:9]
  s_cselect_b64 s[48:49], s[14:15], s[12:13]
  s_cselect_b64 s[4:5], s[16:17], s[24:25]
  s_cselect_b32 s72, 0x21, 0x30
  s_cselect_b32 s67, 16, 32
  s_cselect_b32 s69, 1.0, 0x3e0293ee
  s_cselect_b32 s74, 2, 4
  s_cmp_eq_u32 s57, 6
  s_cselect_b64 s[48:49], s[26:27], s[48:49]
  s_cselect_b64 s[4:5], s[28:29], s[4:5]
  s_cselect_b32 s72, 0x54, s72
  s_cselect_b32 s67, 64, s67
  s_cselect_b32 s80, 4, 0
  s_cselect_b32 s69, 1.0, s69
  s_cselect_b32 s74, 2, s74
  v_readlane_b32 s73, v1, s95
  s_add_u32 s95, s95, 1
  s_and_b32 s53, s53, 0xffff
  s_mov_b32 s54, 0x200000
  s_mov_b32 s55, 0x20000
  s_cmp_lt_u32 s44, 2
  s_cselect_b64 s[48:49], s[48:49], s[4:5]
  s_cselect_b32 s58, 0, 4
  s_lshr_b32 s72, s72, s58
  s_and_b32 s72, s72, 15
  s_and_b32 s49, s49, 0xffff
  s_mov_b32 s50, 0x400000
  s_mov_b32 s51, 0x20000
  v_lshlrev_b32 v2, 4, v0
  v_mov_b32 v6, 0
  v_lshrrev_b32 v3, 3, v0
  v_lshlrev_b32 v20, 13, v3
  v_and_b32 v3, 2, v3
  v_and_b32 v4, 7, v0
  v_xor_b32 v3, v3, v4
  v_lshl_add_u32 v20, v3, 4, v20
  v_xor_b32 v21, 64, v20
  s_lshl_b32 s60, s44, 14
  s_add_u32 s60, s60, 0x18000
  s_and_b32 s59, s44, 1
  s_lshl1_add_u32 s75, s56, s59
  s_lshl_b32 s75, s75, 7
  s_lshl_b32 s58, s57, 2
  s_lshr_b32 s78, 0, s58
  s_and_b32 s78, s78, 15
  s_lshl_b32 s58, s78, 20
  s_or_b32 s75, s75, s58
  s_cmp_lt_u32 s72, 3
  s_cbranch_scc1 L_f_w_7
  s_add_u32 m0, s60, 0
  s_xor_b32 s58, s75, 0
  buffer_load_dwordx4 v20, s[48:51], s58 offen  lds
  s_add_u32 m0, s60, 1024
  s_xor_b32 s58, s75, 65536
  buffer_load_dwordx4 v21, s[48:51], s58 offen  lds
  s_add_u32 m0, s60, 2048
  s_xor_b32 s58, s75, 131072
  buffer_load_dwordx4 v20, s[48:51], s58 offen  lds
  s_add_u32 m0, s60, 3072
  s_xor_b32 s58, s75, 196608
  buffer_load_dwordx4 v21, s[48:51], s58 offen  lds
  s_branch L_f_w_7e
L_f_w_7:
  s_add_u32 m0, s60, 0
  s_xor_b32 s58, s75, 0
  buffer_load_dwordx4 v20, s[48:51], s58 offen nt lds
  s_add_u32 m0, s60, 1024
  s_xor_b32 s58, s75, 65536
  buffer_load_dwordx4 v21, s[48:51], s58 offen nt lds
  s_add_u32 m0, s60, 2048
  s_xor_b32 s58, s75, 131072
  buffer_load_dwordx4 v20, s[48:51], s58 offen nt lds
  s_add_u32 m0, s60, 3072
  s_xor_b32 s58, s75, 196608
  buffer_load_dwordx4 v21, s[48:51], s58 offen nt lds
L_f_w_7e:
  s_cmp_lt_u32 s72, 3
  s_cbranch_scc1 L_f_w_8
  s_add_u32 m0, s60, 4096
  s_xor_b32 s58, s75, 262144
  buffer_load_dwordx4 v20, s[48:51], s58 offen  lds
  s_add_u32 m0, s60, 5120
  s_xor_b32 s58, s75, 327680
  buffer_load_dwordx4 v21, s[48:51], s58 offen  lds
  s_add_u32 m0, s60, 6144
  s_xor_b32 s58, s75, 393216
  buffer_load_dwordx4 v20, s[48:51], s58 offen  lds
  s_add_u32 m0, s60, 7168
  s_xor_b32 s58, s75, 458752
  buffer_load_dwordx4 v21, s[48:51], s58 offen  lds
  s_branch L_f_w_8e
L_f_w_8:
  s_add_u32 m0, s60, 4096
  s_xor_b32 s58, s75, 262144
  buffer_load_dwordx4 v20, s[48:51], s58 offen nt lds
  s_add_u32 m0, s60, 5120
  s_xor_b32 s58, s75, 327680
  buffer_load_dwordx4 v21, s[48:51], s58 offen nt lds
  s_add_u32 m0, s60, 6144
  s_xor_b32 s58, s75, 393216
  buffer_load_dwordx4 v20, s[48:51], s58 offen nt lds
  s_add_u32 m0, s60, 7168
  s_xor_b32 s58, s75, 458752
  buffer_load_dwordx4 v21, s[48:51], s58 offen nt lds
L_f_w_8e:
  s_cmp_lt_u32 s72, 3
  s_cbranch_scc1 L_f_w_9
  s_add_u32 m0, s60, 8192
  s_xor_b32 s58, s75, 524288
  buffer_load_dwordx4 v20, s[48:51], s58 offen  lds
  s_add_u32 m0, s60, 9216
  s_xor_b32 s58, s75, 589824
  buffer_load_dwordx4 v21, s[48:51], s58 offen  lds
  s_add_u32 m0, s60, 10240
  s_xor_b32 s58, s75, 655360
  buffer_load_dwordx4 v20, s[48:51], s58 offen  lds
  s_add_u32 m0, s60, 11264
  s_xor_b32 s58, s75, 720896
  buffer_load_dwordx4 v21, s[48:51], s58 offen  lds
  s_branch L_f_w_9e
L_f_w_9:
  s_add_u32 m0, s60, 8192
  s_xor_b32 s58, s75, 524288
  buffer_load_dwordx4 v20, s[48:51], s58 offen nt lds
  s_add_u32 m0, s60, 9216
  s_xor_b32 s58, s75, 589824
  buffer_load_dwordx4 v21, s[48:51], s58 offen nt lds
  s_add_u32 m0, s60, 10240
  s_xor_b32 s58, s75, 655360
  buffer_load_dwordx4 v20, s[48:51], s58 offen nt lds
  s_add_u32 m0, s60, 11264
  s_xor_b32 s58, s75, 720896
  buffer_load_dwordx4 v21, s[48:51], s58 offen nt lds
L_f_w_9e:
  s_cmp_lt_u32 s72, 3
  s_cbranch_scc1 L_f_w_10
  s_add_u32 m0, s60, 12288
  s_xor_b32 s58, s75, 786432
  buffer_load_dwordx4 v20, s[48:51], s58 offen  lds
  s_add_u32 m0, s60, 13312
  s_xor_b32 s58, s75, 851968
  buffer_load_dwordx4 v21, s[48:51], s58 offen  lds
  s_add_u32 m0, s60, 14336
  s_xor_b32 s58, s75, 917504
  buffer_load_dwordx4 v20, s[48:51], s58 offen  lds
  s_add_u32 m0, s60, 15360
  s_xor_b32 s58, s75, 983040
  buffer_load_dwordx4 v21, s[48:51], s58 offen  lds
  s_branch L_f_w_10e
L_f_w_10:
  s_add_u32 m0, s60, 12288
  s_xor_b32 s58, s75, 786432
  buffer_load_dwordx4 v20, s[48:51], s58 offen nt lds
  s_add_u32 m0, s60, 13312
  s_xor_b32 s58, s75, 851968
  buffer_load_dwordx4 v21, s[48:51], s58 offen nt lds
  s_add_u32 m0, s60, 14336
  s_xor_b32 s58, s75, 917504
  buffer_load_dwordx4 v20, s[48:51], s58 offen nt lds
  s_add_u32 m0, s60, 15360
  s_xor_b32 s58, s75, 983040
  buffer_load_dwordx4 v21, s[48:51], s58 offen nt lds
L_f_w_10e:
  s_mov_b32 s76, 0x40000000
  v_and_b32 v32, 15, v0
  v_mov_b32 v33, 1
  s_lshl2_add_u32 s58, s44, s57
  s_cmp_ge_u32 s58, 4
  s_cbranch_scc1 L_f_nogate
  s_mov_b64 s[4:5], s[8:9]
  s_mov_b64 s[6:7], s[34:35]
  v_lshrrev_b32 v4, 4, v0
  v_lshlrev_b32 v4, 4, v4
  v_lshl_add_u32 v5, v32, 10, v4
  s_lshl2_add_u32 s77, s56, s57
  s_lshl_b32 s58, s77, 14
  v_add_u32 v5, s58, v5
  global_load_dwordx4 v[64:67], v5, s[4:5] offset:0
  global_load_dwordx4 v[128:131], v4, s[6:7] offset:0
  global_load_dwordx4 v[68:71], v5, s[4:5] offset:64
  global_load_dwordx4 v[132:135], v4, s[6:7] offset:64
  global_load_dwordx4 v[72:75], v5, s[4:5] offset:128
  global_load_dwordx4 v[136:139], v4, s[6:7] offset:128
  global_load_dwordx4 v[76:79], v5, s[4:5] offset:192
  global_load_dwordx4 v[140:143], v4, s[6:7] offset:192
  global_load_dwordx4 v[80:83], v5, s[4:5] offset:256
  global_load_dwordx4 v[144:147], v4, s[6:7] offset:256
  global_load_dwordx4 v[84:87], v5, s[4:5] offset:320
  global_load_dwordx4 v[148:151], v4, s[6:7] offset:320
  global_load_dwordx4 v[88:91], v5, s[4:5] offset:384
  global_load_dwordx4 v[152:155], v4, s[6:7] offset:384
  global_load_dwordx4 v[92:95], v5, s[4:5] offset:448
  global_load_dwordx4 v[156:159], v4, s[6:7] offset:448
  global_load_dwordx4 v[96:99], v5, s[4:5] offset:512
  global_load_dwordx4 v[160:163], v4, s[6:7] offset:512
  global_load_dwordx4 v[100:103], v5, s[4:5] offset:576
  global_load_dwordx4 v[164:167], v4, s[6:7] offset:576
  global_load_dwordx4 v[104:107], v5, s[4:5] offset:640
  global_load_dwordx4 v[168:171], v4, s[6:7] offset:640
  global_load_dwordx4 v[108:111], v5, s[4:5] offset:704
  global_load_dwordx4 v[172:175], v4, s[6:7] offset:704
  global_load_dwordx4 v[112:115], v5, s[4:5] offset:768
  global_load_dwordx4 v[176:179], v4, s[6:7] offset:768
  global_load_dwordx4 v[116:119], v5, s[4:5] offset:832
  global_load_dwordx4 v[180:183], v4, s[6:7] offset:832
  global_load_dwordx4 v[120:123], v5, s[4:5] offset:896
  global_load_dwordx4 v[184:187], v4, s[6:7] offset:896
  global_load_dwordx4 v[124:127], v5, s[4:5] offset:960
  global_load_dwordx4 v[188:191], v4, s[6:7] offset:960
  v_lshlrev_b32 v32, 2, v32
  s_lshl_b32 s77, s77, 6
  s_add_u32 s77, s77, 0xd0c0000
  s_lshr_b32 s76, s56, 2
  s_lshl_b32 s76, s76, 7
  s_add_u32 s76, s76, 0xd086400
L_f_nogate:
  v_lshrrev_b32 v3, 4, v0
  v_lshl_add_u32 v24, v3, 10, s60
  v_bfe_u32 v4, v0, 2, 2
  v_lshl_add_u32 v24, v4, 7, v24
  v_bfe_u32 v4, v0, 3, 2
  v_lshl_add_u32 v24, v4, 5, v24
  v_and_b32 v4, 3, v0
  v_lshl_add_u32 v24, v4, 3, v24
  v_and_b32 v4, 15, v0
  v_xor_b32 v3, v3, v4
  v_lshlrev_b32 v3, 4, v3
  v_lshl_add_u32 v16, v4, 10, v3
  s_lshl1_add_u32 s58, s78, s59
  s_lshl_b32 s58, s58, 7
  v_xor_b32 v8, s58, v2
  s_lshl_b32 s62, s72, 24
  s_lshl_b32 s58, s56, 19
  s_add_u32 s62, s62, s58
  s_lshl_b32 s58, s59, 12
  s_add_u32 s62, s62, s58
  s_add_u32 s65, s62, 0x0
  s_mov_b32 s62, 0x40000000
  s_lshl_b32 s58, s57, 2
  s_cmp_eq_u32 s57, 6
  s_cselect_b32 s58, 0x1000, s58
  s_lshl_b32 s64, s56, 7
  s_add_u32 s64, s64, s58
  s_add_u32 s64, s64, 0xd080000
  s_cmp_eq_u32 s44, 0
  s_cselect_b32 s64, s64, 0x40000000
  v_xor_b32 v25, 32, v24
  v_xor_b32 v17, 64, v16
  v_xor_b32 v26, 64, v24
  v_xor_b32 v18, 128, v16
  v_xor_b32 v27, 96, v24
  v_xor_b32 v19, 192, v16
  v_xor_b32 v9, 16, v8
  v_xor_b32 v10, 32, v8
  v_xor_b32 v11, 48, v8
  v_xor_b32 v12, 64, v8
  v_xor_b32 v13, 80, v8
  v_xor_b32 v14, 96, v8
  v_xor_b32 v15, 112, v8
  s_lshl_b32 s66, s44, 13
  s_mov_b32 s71, s66
  s_and_b32 s61, s73, 7
  s_lshl_b32 s61, s61, 18
  s_add_u32 s61, s61, s71
  s_mov_b32 s70, 0
  s_mov_b32 s63, 0
  s_mov_b32 s68, 0
  s_lshl2_add_u32 s79, s56, s44
  s_lshl_b32 s79, s79, 10
  s_add_u32 s79, s79, 0xc020000
  v_mov_b64 v[36:37], -1
  v_mov_b64 v[38:39], -1
  s_waitcnt vmcnt(12)
  ds_read_b64_tr_b16 a[0:1], v24 offset:0
  ds_read_b64_tr_b16 a[2:3], v24 offset:512
  ds_read_b64_tr_b16 a[64:65], v25 offset:0
  ds_read_b64_tr_b16 a[66:67], v25 offset:512
  ds_read_b64_tr_b16 a[128:129], v26 offset:0
  ds_read_b64_tr_b16 a[130:131], v26 offset:512
  ds_read_b64_tr_b16 a[192:193], v27 offset:0
  ds_read_b64_tr_b16 a[194:195], v27 offset:512
  s_waitcnt lgkmcnt(0)
  s_cmp_lt_u32 s72, 3
  s_cbranch_scc1 L_f_w_11
  s_add_u32 m0, s60, 0
  s_xor_b32 s58, s75, 1048576
  buffer_load_dwordx4 v20, s[48:51], s58 offen  lds
  s_add_u32 m0, s60, 1024
  s_xor_b32 s58, s75, 1114112
  buffer_load_dwordx4 v21, s[48:51], s58 offen  lds
  s_add_u32 m0, s60, 2048
  s_xor_b32 s58, s75, 1179648
  buffer_load_dwordx4 v20, s[48:51], s58 offen  lds
  s_add_u32 m0, s60, 3072
  s_xor_b32 s58, s75, 1245184
  buffer_load_dwordx4 v21, s[48:51], s58 offen  lds
  s_branch L_f_w_11e
L_f_w_11:
  s_add_u32 m0, s60, 0
  s_xor_b32 s58, s75, 1048576
  buffer_load_dwordx4 v20, s[48:51], s58 offen nt lds
  s_add_u32 m0, s60, 1024
  s_xor_b32 s58, s75, 1114112
  buffer_load_dwordx4 v21, s[48:51], s58 offen nt lds
  s_add_u32 m0, s60, 2048
  s_xor_b32 s58, s75, 1179648
  buffer_load_dwordx4 v20, s[48:51], s58 offen nt lds
  s_add_u32 m0, s60, 3072
  s_xor_b32 s58, s75, 1245184
  buffer_load_dwordx4 v21, s[48:51], s58 offen nt lds
L_f_w_11e:
  s_waitcnt vmcnt(12)
  ds_read_b64_tr_b16 a[4:5], v24 offset:4096
  ds_read_b64_tr_b16 a[6:7], v24 offset:4608
  ds_read_b64_tr_b16 a[68:69], v25 offset:4096
  ds_read_b64_tr_b16 a[70:71], v25 offset:4608
  ds_read_b64_tr_b16 a[132:133], v26 offset:4096
  ds_read_b64_tr_b16 a[134:135], v26 offset:4608
  ds_read_b64_tr_b16 a[196:197], v27 offset:4096
  ds_read_b64_tr_b16 a[198:199], v27 offset:4608
  s_waitcnt lgkmcnt(0)
  s_cmp_lt_u32 s72, 3
  s_cbranch_scc1 L_f_w_12
  s_add_u32 m0, s60, 4096
  s_xor_b32 s58, s75, 1310720
  buffer_load_dwordx4 v20, s[48:51], s58 offen  lds
  s_add_u32 m0, s60, 5120
  s_xor_b32 s58, s75, 1376256
  buffer_load_dwordx4 v21, s[48:51], s58 offen  lds
  s_add_u32 m0, s60, 6144
  s_xor_b32 s58, s75, 1441792
  buffer_load_dwordx4 v20, s[48:51], s58 offen  lds
  s_add_u32 m0, s60, 7168
  s_xor_b32 s58, s75, 1507328
  buffer_load_dwordx4 v21, s[48:51], s58 offen  lds
  s_branch L_f_w_12e
L_f_w_12:
  s_add_u32 m0, s60, 4096
  s_xor_b32 s58, s75, 1310720
  buffer_load_dwordx4 v20, s[48:51], s58 offen nt lds
  s_add_u32 m0, s60, 5120
  s_xor_b32 s58, s75, 1376256
  buffer_load_dwordx4 v21, s[48:51], s58 offen nt lds
  s_add_u32 m0, s60, 6144
  s_xor_b32 s58, s75, 1441792
  buffer_load_dwordx4 v20, s[48:51], s58 offen nt lds
  s_add_u32 m0, s60, 7168
  s_xor_b32 s58, s75, 1507328
  buffer_load_dwordx4 v21, s[48:51], s58 offen nt lds
L_f_w_12e:
  s_waitcnt vmcnt(12)
  ds_read_b64_tr_b16 a[8:9], v24 offset:8192
  ds_read_b64_tr_b16 a[10:11], v24 offset:8704
  ds_read_b64_tr_b16 a[72:73], v25 offset:8192
  ds_read_b64_tr_b16 a[74:75], v25 offset:8704
  ds_read_b64_tr_b16 a[136:137], v26 offset:8192
  ds_read_b64_tr_b16 a[138:139], v26 offset:8704
  ds_read_b64_tr_b16 a[200:201], v27 offset:8192
  ds_read_b64_tr_b16 a[202:203], v27 offset:8704
  s_waitcnt lgkmcnt(0)
  s_cmp_lt_u32 s72, 3
  s_cbranch_scc1 L_f_w_13
  s_add_u32 m0, s60, 8192
  s_xor_b32 s58, s75, 1572864
  buffer_load_dwordx4 v20, s[48:51], s58 offen  lds
  s_add_u32 m0, s60, 9216
  s_xor_b32 s58, s75, 1638400
  buffer_load_dwordx4 v21, s[48:51], s58 offen  lds
  s_add_u32 m0, s60, 10240
  s_xor_b32 s58, s75, 1703936
  buffer_load_dwordx4 v20, s[48:51], s58 offen  lds
  s_add_u32 m0, s60, 11264
  s_xor_b32 s58, s75, 1769472
  buffer_load_dwordx4 v21, s[48:51], s58 offen  lds
  s_branch L_f_w_13e
L_f_w_13:
  s_add_u32 m0, s60, 8192
  s_xor_b32 s58, s75, 1572864
  buffer_load_dwordx4 v20, s[48:51], s58 offen nt lds
  s_add_u32 m0, s60, 9216
  s_xor_b32 s58, s75, 1638400
  buffer_load_dwordx4 v21, s[48:51], s58 offen nt lds
  s_add_u32 m0, s60, 10240
  s_xor_b32 s58, s75, 1703936
  buffer_load_dwordx4 v20, s[48:51], s58 offen nt lds
  s_add_u32 m0, s60, 11264
  s_xor_b32 s58, s75, 1769472
  buffer_load_dwordx4 v21, s[48:51], s58 offen nt lds
L_f_w_13e:
  s_waitcnt vmcnt(12)
  ds_read_b64_tr_b16 a[12:13], v24 offset:12288
  ds_read_b64_tr_b16 a[14:15], v24 offset:12800
  ds_read_b64_tr_b16 a[76:77], v25 offset:12288
  ds_read_b64_tr_b16 a[78:79], v25 offset:12800
  ds_read_b64_tr_b16 a[140:141], v26 offset:12288
  ds_read_b64_tr_b16 a[142:143], v26 offset:12800
  ds_read_b64_tr_b16 a[204:205], v27 offset:12288
  ds_read_b64_tr_b16 a[206:207], v27 offset:12800
  s_waitcnt lgkmcnt(0)
  s_cmp_lt_u32 s72, 3
  s_cbranch_scc1 L_f_w_14
  s_add_u32 m0, s60, 12288
  s_xor_b32 s58, s75, 1835008
  buffer_load_dwordx4 v20, s[48:51], s58 offen  lds
  s_add_u32 m0, s60, 13312
  s_xor_b32 s58, s75, 1900544
  buffer_load_dwordx4 v21, s[48:51], s58 offen  lds
  s_add_u32 m0, s60, 14336
  s_xor_b32 s58, s75, 1966080
  buffer_load_dwordx4 v20, s[48:51], s58 offen  lds
  s_add_u32 m0, s60, 15360
  s_xor_b32 s58, s75, 2031616
  buffer_load_dwordx4 v21, s[48:51], s58 offen  lds
  s_branch L_f_w_14e
L_f_w_14:
  s_add_u32 m0, s60, 12288
  s_xor_b32 s58, s75, 1835008
  buffer_load_dwordx4 v20, s[48:51], s58 offen nt lds
  s_add_u32 m0, s60, 13312
  s_xor_b32 s58, s75, 1900544
  buffer_load_dwordx4 v21, s[48:51], s58 offen nt lds
  s_add_u32 m0, s60, 14336
  s_xor_b32 s58, s75, 1966080
  buffer_load_dwordx4 v20, s[48:51], s58 offen nt lds
  s_add_u32 m0, s60, 15360
  s_xor_b32 s58, s75, 2031616
  buffer_load_dwordx4 v21, s[48:51], s58 offen nt lds
L_f_w_14e:
  s_waitcnt vmcnt(12)
  ds_read_b64_tr_b16 a[16:17], v24 offset:0
  ds_read_b64_tr_b16 a[18:19], v24 offset:512
  ds_read_b64_tr_b16 a[80:81], v25 offset:0
  ds_read_b64_tr_b16 a[82:83], v25 offset:512
  ds_read_b64_tr_b16 a[144:145], v26 offset:0
  ds_read_b64_tr_b16 a[146:147], v26 offset:512
  ds_read_b64_tr_b16 a[208:209], v27 offset:0
  ds_read_b64_tr_b16 a[210:211], v27 offset:512
  s_waitcnt lgkmcnt(0)
  s_cmp_lt_u32 s72, 3
  s_cbranch_scc1 L_f_w_15
  s_add_u32 m0, s60, 0
  s_xor_b32 s58, s75, 2097152
  buffer_load_dwordx4 v20, s[48:51], s58 offen  lds
  s_add_u32 m0, s60, 1024
  s_xor_b32 s58, s75, 2162688
  buffer_load_dwordx4 v21, s[48:51], s58 offen  lds
  s_add_u32 m0, s60, 2048
  s_xor_b32 s58, s75, 2228224
  buffer_load_dwordx4 v20, s[48:51], s58 offen  lds
  s_add_u32 m0, s60, 3072
  s_xor_b32 s58, s75, 2293760
  buffer_load_dwordx4 v21, s[48:51], s58 offen  lds
  s_branch L_f_w_15e
L_f_w_15:
  s_add_u32 m0, s60, 0
  s_xor_b32 s58, s75, 2097152
  buffer_load_dwordx4 v20, s[48:51], s58 offen nt lds
  s_add_u32 m0, s60, 1024
  s_xor_b32 s58, s75, 2162688
  buffer_load_dwordx4 v21, s[48:51], s58 offen nt lds
  s_add_u32 m0, s60, 2048
  s_xor_b32 s58, s75, 2228224
  buffer_load_dwordx4 v20, s[48:51], s58 offen nt lds
  s_add_u32 m0, s60, 3072
  s_xor_b32 s58, s75, 2293760
  buffer_load_dwordx4 v21, s[48:51], s58 offen nt lds
L_f_w_15e:
  s_waitcnt vmcnt(12)
  ds_read_b64_tr_b16 a[20:21], v24 offset:4096
  ds_read_b64_tr_b16 a[22:23], v24 offset:4608
  ds_read_b64_tr_b16 a[84:85], v25 offset:4096
  ds_read_b64_tr_b16 a[86:87], v25 offset:4608
  ds_read_b64_tr_b16 a[148:149], v26 offset:4096
  ds_read_b64_tr_b16 a[150:151], v26 offset:4608
  ds_read_b64_tr_b16 a[212:213], v27 offset:4096
  ds_read_b64_tr_b16 a[214:215], v27 offset:4608
  s_waitcnt lgkmcnt(0)
  s_cmp_lt_u32 s72, 3
  s_cbranch_scc1 L_f_w_16
  s_add_u32 m0, s60, 4096
  s_xor_b32 s58, s75, 2359296
  buffer_load_dwordx4 v20, s[48:51], s58 offen  lds
  s_add_u32 m0, s60, 5120
  s_xor_b32 s58, s75, 2424832
  buffer_load_dwordx4 v21, s[48:51], s58 offen  lds
  s_add_u32 m0, s60, 6144
  s_xor_b32 s58, s75, 2490368
  buffer_load_dwordx4 v20, s[48:51], s58 offen  lds
  s_add_u32 m0, s60, 7168
  s_xor_b32 s58, s75, 2555904
  buffer_load_dwordx4 v21, s[48:51], s58 offen  lds
  s_branch L_f_w_16e
L_f_w_16:
  s_add_u32 m0, s60, 4096
  s_xor_b32 s58, s75, 2359296
  buffer_load_dwordx4 v20, s[48:51], s58 offen nt lds
  s_add_u32 m0, s60, 5120
  s_xor_b32 s58, s75, 2424832
  buffer_load_dwordx4 v21, s[48:51], s58 offen nt lds
  s_add_u32 m0, s60, 6144
  s_xor_b32 s58, s75, 2490368
  buffer_load_dwordx4 v20, s[48:51], s58 offen nt lds
  s_add_u32 m0, s60, 7168
  s_xor_b32 s58, s75, 2555904
  buffer_load_dwordx4 v21, s[48:51], s58 offen nt lds
L_f_w_16e:
  s_cmp_eq_u32 s76, 0x40000000
  s_cbranch_scc1 L_f_nogate2
  v_mfma_f32_16x16x32_bf16 v[192:195], v[128:131], v[64:67], 0
  v_mfma_f32_16x16x32_bf16 v[192:195], v[132:135], v[68:71], v[192:195]
  v_mfma_f32_16x16x32_bf16 v[192:195], v[136:139], v[72:75], v[192:195]
  v_mfma_f32_16x16x32_bf16 v[192:195], v[140:143], v[76:79], v[192:195]
  v_mfma_f32_16x16x32_bf16 v[192:195], v[144:147], v[80:83], v[192:195]
  v_mfma_f32_16x16x32_bf16 v[192:195], v[148:151], v[84:87], v[192:195]
  v_mfma_f32_16x16x32_bf16 v[192:195], v[152:155], v[88:91], v[192:195]
  v_mfma_f32_16x16x32_bf16 v[192:195], v[156:159], v[92:95], v[192:195]
  v_mfma_f32_16x16x32_bf16 v[192:195], v[160:163], v[96:99], v[192:195]
  v_mfma_f32_16x16x32_bf16 v[192:195], v[164:167], v[100:103], v[192:195]
  v_mfma_f32_16x16x32_bf16 v[192:195], v[168:171], v[104:107], v[192:195]
  v_mfma_f32_16x16x32_bf16 v[192:195], v[172:175], v[108:111], v[192:195]
  v_mfma_f32_16x16x32_bf16 v[192:195], v[176:179], v[112:115], v[192:195]
  v_mfma_f32_16x16x32_bf16 v[192:195], v[180:183], v[116:119], v[192:195]
  v_mfma_f32_16x16x32_bf16 v[192:195], v[184:187], v[120:123], v[192:195]
  v_mfma_f32_16x16x32_bf16 v[192:195], v[188:191], v[124:127], v[192:195]
  s_nop 7
  v_mul_f32 v192, 0xbfb8aa3b, v192
  v_exp_f32 v192, v192
  s_nop 0
  v_add_f32 v192, 1.0, v192
  v_rcp_f32 v192, v192
  s_nop 0
  buffer_store_dword v192, v32, s[40:43], s77 offen sc1
L_f_nogate2:
  s_waitcnt vmcnt(12)
  ds_read_b64_tr_b16 a[24:25], v24 offset:8192
  ds_read_b64_tr_b16 a[26:27], v24 offset:8704
  ds_read_b64_tr_b16 a[88:89], v25 offset:8192
  ds_read_b64_tr_b16 a[90:91], v25 offset:8704
  ds_read_b64_tr_b16 a[152:153], v26 offset:8192
  ds_read_b64_tr_b16 a[154:155], v26 offset:8704
  ds_read_b64_tr_b16 a[216:217], v27 offset:8192
  ds_read_b64_tr_b16 a[218:219], v27 offset:8704
  s_waitcnt lgkmcnt(0)
  s_cmp_lt_u32 s72, 3
  s_cbranch_scc1 L_f_w_17
  s_add_u32 m0, s60, 8192
  s_xor_b32 s58, s75, 2621440
  buffer_load_dwordx4 v20, s[48:51], s58 offen  lds
  s_add_u32 m0, s60, 9216
  s_xor_b32 s58, s75, 2686976
  buffer_load_dwordx4 v21, s[48:51], s58 offen  lds
  s_add_u32 m0, s60, 10240
  s_xor_b32 s58, s75, 2752512
  buffer_load_dwordx4 v20, s[48:51], s58 offen  lds
  s_add_u32 m0, s60, 11264
  s_xor_b32 s58, s75, 2818048
  buffer_load_dwordx4 v21, s[48:51], s58 offen  lds
  s_branch L_f_w_17e
L_f_w_17:
  s_add_u32 m0, s60, 8192
  s_xor_b32 s58, s75, 2621440
  buffer_load_dwordx4 v20, s[48:51], s58 offen nt lds
  s_add_u32 m0, s60, 9216
  s_xor_b32 s58, s75, 2686976
  buffer_load_dwordx4 v21, s[48:51], s58 offen nt lds
  s_add_u32 m0, s60, 10240
  s_xor_b32 s58, s75, 2752512
  buffer_load_dwordx4 v20, s[48:51], s58 offen nt lds
  s_add_u32 m0, s60, 11264
  s_xor_b32 s58, s75, 2818048
  buffer_load_dwordx4 v21, s[48:51], s58 offen nt lds
L_f_w_17e:
  s_waitcnt vmcnt(12)
  ds_read_b64_tr_b16 a[28:29], v24 offset:12288
  ds_read_b64_tr_b16 a[30:31], v24 offset:12800
  ds_read_b64_tr_b16 a[92:93], v25 offset:12288
  ds_read_b64_tr_b16 a[94:95], v25 offset:12800
  ds_read_b64_tr_b16 a[156:157], v26 offset:12288
  ds_read_b64_tr_b16 a[158:159], v26 offset:12800
  ds_read_b64_tr_b16 a[220:221], v27 offset:12288
  ds_read_b64_tr_b16 a[222:223], v27 offset:12800
  s_waitcnt lgkmcnt(0)
  s_cmp_lt_u32 s72, 3
  s_cbranch_scc1 L_f_w_18
  s_add_u32 m0, s60, 12288
  s_xor_b32 s58, s75, 2883584
  buffer_load_dwordx4 v20, s[48:51], s58 offen  lds
  s_add_u32 m0, s60, 13312
  s_xor_b32 s58, s75, 2949120
  buffer_load_dwordx4 v21, s[48:51], s58 offen  lds
  s_add_u32 m0, s60, 14336
  s_xor_b32 s58, s75, 3014656
  buffer_load_dwordx4 v20, s[48:51], s58 offen  lds
  s_add_u32 m0, s60, 15360
  s_xor_b32 s58, s75, 3080192
  buffer_load_dwordx4 v21, s[48:51], s58 offen  lds
  s_branch L_f_w_18e
L_f_w_18:
  s_add_u32 m0, s60, 12288
  s_xor_b32 s58, s75, 2883584
  buffer_load_dwordx4 v20, s[48:51], s58 offen nt lds
  s_add_u32 m0, s60, 13312
  s_xor_b32 s58, s75, 2949120
  buffer_load_dwordx4 v21, s[48:51], s58 offen nt lds
  s_add_u32 m0, s60, 14336
  s_xor_b32 s58, s75, 3014656
  buffer_load_dwordx4 v20, s[48:51], s58 offen nt lds
  s_add_u32 m0, s60, 15360
  s_xor_b32 s58, s75, 3080192
  buffer_load_dwordx4 v21, s[48:51], s58 offen nt lds
L_f_w_18e:
  s_waitcnt vmcnt(12)
  ds_read_b64_tr_b16 a[32:33], v24 offset:0
  ds_read_b64_tr_b16 a[34:35], v24 offset:512
  ds_read_b64_tr_b16 a[96:97], v25 offset:0
  ds_read_b64_tr_b16 a[98:99], v25 offset:512
  ds_read_b64_tr_b16 a[160:161], v26 offset:0
  ds_read_b64_tr_b16 a[162:163], v26 offset:512
  ds_read_b64_tr_b16 a[224:225], v27 offset:0
  ds_read_b64_tr_b16 a[226:227], v27 offset:512
  s_waitcnt lgkmcnt(0)
  s_cmp_lt_u32 s72, 3
  s_cbranch_scc1 L_f_w_19
  s_add_u32 m0, s60, 0
  s_xor_b32 s58, s75, 3145728
  buffer_load_dwordx4 v20, s[48:51], s58 offen  lds
  s_add_u32 m0, s60, 1024
  s_xor_b32 s58, s75, 3211264
  buffer_load_dwordx4 v21, s[48:51], s58 offen  lds
  s_add_u32 m0, s60, 2048
  s_xor_b32 s58, s75, 3276800
  buffer_load_dwordx4 v20, s[48:51], s58 offen  lds
  s_add_u32 m0, s60, 3072
  s_xor_b32 s58, s75, 3342336
  buffer_load_dwordx4 v21, s[48:51], s58 offen  lds
  s_branch L_f_w_19e
L_f_w_19:
  s_add_u32 m0, s60, 0
  s_xor_b32 s58, s75, 3145728
  buffer_load_dwordx4 v20, s[48:51], s58 offen nt lds
  s_add_u32 m0, s60, 1024
  s_xor_b32 s58, s75, 3211264
  buffer_load_dwordx4 v21, s[48:51], s58 offen nt lds
  s_add_u32 m0, s60, 2048
  s_xor_b32 s58, s75, 3276800
  buffer_load_dwordx4 v20, s[48:51], s58 offen nt lds
  s_add_u32 m0, s60, 3072
  s_xor_b32 s58, s75, 3342336
  buffer_load_dwordx4 v21, s[48:51], s58 offen nt lds
L_f_w_19e:
  s_waitcnt vmcnt(12)
  ds_read_b64_tr_b16 a[36:37], v24 offset:4096
  ds_read_b64_tr_b16 a[38:39], v24 offset:4608
  ds_read_b64_tr_b16 a[100:101], v25 offset:4096
  ds_read_b64_tr_b16 a[102:103], v25 offset:4608
  ds_read_b64_tr_b16 a[164:165], v26 offset:4096
  ds_read_b64_tr_b16 a[166:167], v26 offset:4608
  ds_read_b64_tr_b16 a[228:229], v27 offset:4096
  ds_read_b64_tr_b16 a[230:231], v27 offset:4608
  s_waitcnt lgkmcnt(0)
  s_cmp_lt_u32 s72, 3
  s_cbranch_scc1 L_f_w_20
  s_add_u32 m0, s60, 4096
  s_xor_b32 s58, s75, 3407872
  buffer_load_dwordx4 v20, s[48:51], s58 offen  lds
  s_add_u32 m0, s60, 5120
  s_xor_b32 s58, s75, 3473408
  buffer_load_dwordx4 v21, s[48:51], s58 offen  lds
  s_add_u32 m0, s60, 6144
  s_xor_b32 s58, s75, 3538944
  buffer_load_dwordx4 v20, s[48:51], s58 offen  lds
  s_add_u32 m0, s60, 7168
  s_xor_b32 s58, s75, 3604480
  buffer_load_dwordx4 v21, s[48:51], s58 offen  lds
  s_branch L_f_w_20e
L_f_w_20:
  s_add_u32 m0, s60, 4096
  s_xor_b32 s58, s75, 3407872
  buffer_load_dwordx4 v20, s[48:51], s58 offen nt lds
  s_add_u32 m0, s60, 5120
  s_xor_b32 s58, s75, 3473408
  buffer_load_dwordx4 v21, s[48:51], s58 offen nt lds
  s_add_u32 m0, s60, 6144
  s_xor_b32 s58, s75, 3538944
  buffer_load_dwordx4 v20, s[48:51], s58 offen nt lds
  s_add_u32 m0, s60, 7168
  s_xor_b32 s58, s75, 3604480
  buffer_load_dwordx4 v21, s[48:51], s58 offen nt lds
L_f_w_20e:
  s_waitcnt vmcnt(12)
  ds_read_b64_tr_b16 a[40:41], v24 offset:8192
  ds_read_b64_tr_b16 a[42:43], v24 offset:8704
  ds_read_b64_tr_b16 a[104:105], v25 offset:8192
  ds_read_b64_tr_b16 a[106:107], v25 offset:8704
  ds_read_b64_tr_b16 a[168:169], v26 offset:8192
  ds_read_b64_tr_b16 a[170:171], v26 offset:8704
  ds_read_b64_tr_b16 a[232:233], v27 offset:8192
  ds_read_b64_tr_b16 a[234:235], v27 offset:8704
  s_waitcnt lgkmcnt(0)
  s_cmp_lt_u32 s72, 3
  s_cbranch_scc1 L_f_w_21
  s_add_u32 m0, s60, 8192
  s_xor_b32 s58, s75, 3670016
  buffer_load_dwordx4 v20, s[48:51], s58 offen  lds
  s_add_u32 m0, s60, 9216
  s_xor_b32 s58, s75, 3735552
  buffer_load_dwordx4 v21, s[48:51], s58 offen  lds
  s_add_u32 m0, s60, 10240
  s_xor_b32 s58, s75, 3801088
  buffer_load_dwordx4 v20, s[48:51], s58 offen  lds
  s_add_u32 m0, s60, 11264
  s_xor_b32 s58, s75, 3866624
  buffer_load_dwordx4 v21, s[48:51], s58 offen  lds
  s_branch L_f_w_21e
L_f_w_21:
  s_add_u32 m0, s60, 8192
  s_xor_b32 s58, s75, 3670016
  buffer_load_dwordx4 v20, s[48:51], s58 offen nt lds
  s_add_u32 m0, s60, 9216
  s_xor_b32 s58, s75, 3735552
  buffer_load_dwordx4 v21, s[48:51], s58 offen nt lds
  s_add_u32 m0, s60, 10240
  s_xor_b32 s58, s75, 3801088
  buffer_load_dwordx4 v20, s[48:51], s58 offen nt lds
  s_add_u32 m0, s60, 11264
  s_xor_b32 s58, s75, 3866624
  buffer_load_dwordx4 v21, s[48:51], s58 offen nt lds
L_f_w_21e:
  s_waitcnt vmcnt(12)
  ds_read_b64_tr_b16 a[44:45], v24 offset:12288
  ds_read_b64_tr_b16 a[46:47], v24 offset:12800
  ds_read_b64_tr_b16 a[108:109], v25 offset:12288
  ds_read_b64_tr_b16 a[110:111], v25 offset:12800
  ds_read_b64_tr_b16 a[172:173], v26 offset:12288
  ds_read_b64_tr_b16 a[174:175], v26 offset:12800
  ds_read_b64_tr_b16 a[236:237], v27 offset:12288
  ds_read_b64_tr_b16 a[238:239], v27 offset:12800
  s_waitcnt lgkmcnt(0)
  s_cmp_lt_u32 s72, 3
  s_cbranch_scc1 L_f_w_22
  s_add_u32 m0, s60, 12288
  s_xor_b32 s58, s75, 3932160
  buffer_load_dwordx4 v20, s[48:51], s58 offen  lds
  s_add_u32 m0, s60, 13312
  s_xor_b32 s58, s75, 3997696
  buffer_load_dwordx4 v21, s[48:51], s58 offen  lds
  s_add_u32 m0, s60, 14336
  s_xor_b32 s58, s75, 4063232
  buffer_load_dwordx4 v20, s[48:51], s58 offen  lds
  s_add_u32 m0, s60, 15360
  s_xor_b32 s58, s75, 4128768
  buffer_load_dwordx4 v21, s[48:51], s58 offen  lds
  s_branch L_f_w_22e
L_f_w_22:
  s_add_u32 m0, s60, 12288
  s_xor_b32 s58, s75, 3932160
  buffer_load_dwordx4 v20, s[48:51], s58 offen nt lds
  s_add_u32 m0, s60, 13312
  s_xor_b32 s58, s75, 3997696
  buffer_load_dwordx4 v21, s[48:51], s58 offen nt lds
  s_add_u32 m0, s60, 14336
  s_xor_b32 s58, s75, 4063232
  buffer_load_dwordx4 v20, s[48:51], s58 offen nt lds
  s_add_u32 m0, s60, 15360
  s_xor_b32 s58, s75, 4128768
  buffer_load_dwordx4 v21, s[48:51], s58 offen nt lds
L_f_w_22e:
  s_waitcnt vmcnt(12)
  ds_read_b64_tr_b16 a[48:49], v24 offset:0
  ds_read_b64_tr_b16 a[50:51], v24 offset:512
  ds_read_b64_tr_b16 a[112:113], v25 offset:0
  ds_read_b64_tr_b16 a[114:115], v25 offset:512
  ds_read_b64_tr_b16 a[176:177], v26 offset:0
  ds_read_b64_tr_b16 a[178:179], v26 offset:512
  ds_read_b64_tr_b16 a[240:241], v27 offset:0
  ds_read_b64_tr_b16 a[242:243], v27 offset:512
  s_mov_b32 s48, s38
  s_and_b32 s49, s39, 0xffff
  s_mov_b32 s50, 0x100
  s_mov_b32 s51, 0x20000
  buffer_load_dwordx2 v[4:5], v6, s[48:51], 0 offen sc1
  s_add_u32 m0, s66, 0
  s_add_u32 s58, s61, 0
  buffer_load_dwordx4 v8, s[52:55], s58 offen lds
  s_add_u32 m0, s66, 1024
  s_add_u32 s58, s61, 1024
  buffer_load_dwordx4 v9, s[52:55], s58 offen lds
  s_add_u32 m0, s66, 2048
  s_add_u32 s58, s61, 2048
  buffer_load_dwordx4 v10, s[52:55], s58 offen lds
  s_add_u32 m0, s66, 3072
  s_add_u32 s58, s61, 3072
  buffer_load_dwordx4 v11, s[52:55], s58 offen lds
  s_add_u32 m0, s66, 4096
  s_add_u32 s58, s61, 4096
  buffer_load_dwordx4 v12, s[52:55], s58 offen lds
  s_add_u32 m0, s66, 5120
  s_add_u32 s58, s61, 5120
  buffer_load_dwordx4 v13, s[52:55], s58 offen lds
  s_add_u32 m0, s66, 6144
  s_add_u32 s58, s61, 6144
  buffer_load_dwordx4 v14, s[52:55], s58 offen lds
  s_add_u32 m0, s66, 7168
  s_add_u32 s58, s61, 7168
  buffer_load_dwordx4 v15, s[52:55], s58 offen lds
  s_add_u32 s70, s70, 1
  s_lshr_b32 s61, s70, 3
  s_lshl_b32 s61, s61, 2
  s_lshr_b32 s61, s73, s61
  s_and_b32 s61, s61, 7
  s_and_b32 s59, s70, 7
  s_lshl3_add_u32 s61, s61, s59
  s_lshl_b32 s61, s61, 15
  s_add_u32 s61, s61, s71
  s_add_u32 s66, s66, 0x8000
  s_and_b32 s66, s66, 0x1ffff
  s_waitcnt vmcnt(17)
  ds_read_b64_tr_b16 a[52:53], v24 offset:4096
  ds_read_b64_tr_b16 a[54:55], v24 offset:4608
  ds_read_b64_tr_b16 a[116:117], v25 offset:4096
  ds_read_b64_tr_b16 a[118:119], v25 offset:4608
  ds_read_b64_tr_b16 a[180:181], v26 offset:4096
  ds_read_b64_tr_b16 a[182:183], v26 offset:4608
  ds_read_b64_tr_b16 a[244:245], v27 offset:4096
  ds_read_b64_tr_b16 a[246:247], v27 offset:4608
  s_waitcnt vmcnt(13)
  ds_read_b64_tr_b16 a[56:57], v24 offset:8192
  ds_read_b64_tr_b16 a[58:59], v24 offset:8704
  ds_read_b64_tr_b16 a[120:121], v25 offset:8192
  ds_read_b64_tr_b16 a[122:123], v25 offset:8704
  ds_read_b64_tr_b16 a[184:185], v26 offset:8192
  ds_read_b64_tr_b16 a[186:187], v26 offset:8704
  ds_read_b64_tr_b16 a[248:249], v27 offset:8192
  ds_read_b64_tr_b16 a[250:251], v27 offset:8704
  s_waitcnt vmcnt(9)
  ds_read_b64_tr_b16 a[60:61], v24 offset:12288
  ds_read_b64_tr_b16 a[62:63], v24 offset:12800
  ds_read_b64_tr_b16 a[124:125], v25 offset:12288
  ds_read_b64_tr_b16 a[126:127], v25 offset:12800
  ds_read_b64_tr_b16 a[188:189], v26 offset:12288
  ds_read_b64_tr_b16 a[190:191], v26 offset:12800
  ds_read_b64_tr_b16 a[252:253], v27 offset:12288
  ds_read_b64_tr_b16 a[254:255], v27 offset:12800
  s_waitcnt vmcnt(0) lgkmcnt(0)
L_f_init:
  v_sad_u8 v3, v4, 0, 0
  v_sad_u8 v3, v5, 0, v3
  v_cmp_gt_u32 vcc, 32, v3
  s_cbranch_vccz L_f_go
  buffer_load_dwordx2 v[4:5], v6, s[48:51], 0 offen sc1
  s_add_u32 s68, s68, 1
  s_cmp_gt_u32 s68, 1048576
  s_cbranch_scc1 L_exit
  s_waitcnt vmcnt(0)
  s_branch L_f_init
L_f_go:
  s_barrier
  ds_read_b128 v[64:67], v16 offset:0
  ds_read_b128 v[68:71], v16 offset:16384
  ds_read_b128 v[72:75], v17 offset:0
  ds_read_b128 v[76:79], v17 offset:16384
  ds_read_b128 v[80:83], v18 offset:0
  ds_read_b128 v[84:87], v18 offset:16384
  ds_read_b128 v[88:91], v19 offset:0
  ds_read_b128 v[92:95], v19 offset:16384
  s_cmp_lt_u32 s44, s74
  s_waitcnt lgkmcnt(0)
  s_cbranch_scc0 L_f_10f
L_f_00f:
  v_mfma_f32_16x16x32_bf16 v[128:131], a[0:3], v[64:67], 0
  v_mfma_f32_16x16x32_bf16 v[128:131], a[4:7], v[72:75], v[128:131]
  v_mfma_f32_16x16x32_bf16 v[128:131], a[8:11], v[80:83], v[128:131]
  ds_read_b128 v[96:99], v16 offset:256
  v_mfma_f32_16x16x32_bf16 v[128:131], a[12:15], v[88:91], v[128:131]
  s_cmp_lg_u32 s57, 6
  s_cbranch_scc1 L_f_pw_23
  buffer_store_dwordx4 v[36:39], v2, s[40:43], s79 offen sc1
  s_add_u32 s79, s79, 0x20000
L_f_pw_23:
  v_mfma_f32_16x16x32_bf16 v[136:139], a[0:3], v[68:71], 0
  ds_read_b128 v[100:103], v16 offset:16640
  v_mfma_f32_16x16x32_bf16 v[136:139], a[4:7], v[76:79], v[136:139]
  s_add_u32 m0, s66, 0
  s_add_u32 s58, s61, 0
  buffer_load_dwordx4 v8, s[52:55], s58 offen lds
  v_mfma_f32_16x16x32_bf16 v[136:139], a[8:11], v[84:87], v[136:139]
  ds_read_b128 v[104:107], v17 offset:256
  v_mfma_f32_16x16x32_bf16 v[136:139], a[12:15], v[92:95], v[136:139]
  s_add_u32 m0, s66, 1024
  s_add_u32 s58, s61, 1024
  buffer_load_dwordx4 v9, s[52:55], s58 offen lds
  v_mfma_f32_16x16x32_bf16 v[132:135], a[64:67], v[64:67], 0
  ds_read_b128 v[108:111], v17 offset:16640
  v_mfma_f32_16x16x32_bf16 v[132:135], a[68:71], v[72:75], v[132:135]
  s_add_u32 m0, s66, 2048
  s_add_u32 s58, s61, 2048
  buffer_load_dwordx4 v10, s[52:55], s58 offen lds
  v_mfma_f32_16x16x32_bf16 v[132:135], a[72:75], v[80:83], v[132:135]
  ds_read_b128 v[112:115], v18 offset:256
  v_mfma_f32_16x16x32_bf16 v[132:135], a[76:79], v[88:91], v[132:135]
  s_add_u32 m0, s66, 3072
  s_add_u32 s58, s61, 3072
  buffer_load_dwordx4 v11, s[52:55], s58 offen lds
  v_mfma_f32_16x16x32_bf16 v[140:143], a[64:67], v[68:71], 0
  ds_read_b128 v[116:119], v18 offset:16640
  v_mfma_f32_16x16x32_bf16 v[140:143], a[68:71], v[76:79], v[140:143]
  s_add_u32 m0, s66, 4096
  s_add_u32 s58, s61, 4096
  buffer_load_dwordx4 v12, s[52:55], s58 offen lds
  v_mfma_f32_16x16x32_bf16 v[140:143], a[72:75], v[84:87], v[140:143]
  ds_read_b128 v[120:123], v19 offset:256
  v_mfma_f32_16x16x32_bf16 v[140:143], a[76:79], v[92:95], v[140:143]
  s_add_u32 m0, s66, 5120
  s_add_u32 s58, s61, 5120
  buffer_load_dwordx4 v13, s[52:55], s58 offen lds
  v_mfma_f32_16x16x32_bf16 v[144:147], a[128:131], v[64:67], 0
  ds_read_b128 v[124:127], v19 offset:16640
  v_mfma_f32_16x16x32_bf16 v[144:147], a[132:135], v[72:75], v[144:147]
  s_add_u32 m0, s66, 6144
  s_add_u32 s58, s61, 6144
  buffer_load_dwordx4 v14, s[52:55], s58 offen lds
  v_mfma_f32_16x16x32_bf16 v[144:147], a[136:139], v[80:83], v[144:147]
  v_mfma_f32_16x16x32_bf16 v[144:147], a[140:143], v[88:91], v[144:147]
  s_add_u32 m0, s66, 7168
  s_add_u32 s58, s61, 7168
  buffer_load_dwordx4 v15, s[52:55], s58 offen lds
  v_mfma_f32_16x16x32_bf16 v[152:155], a[128:131], v[68:71], 0
  v_mfma_f32_16x16x32_bf16 v[152:155], a[132:135], v[76:79], v[152:155]
  s_add_u32 s70, s70, 1
  s_lshr_b32 s61, s70, 3
  v_mfma_f32_16x16x32_bf16 v[152:155], a[136:139], v[84:87], v[152:155]
  s_lshl_b32 s61, s61, 2
  s_lshr_b32 s61, s73, s61
  v_mfma_f32_16x16x32_bf16 v[152:155], a[140:143], v[92:95], v[152:155]
  s_and_b32 s61, s61, 7
  s_and_b32 s59, s70, 7
  v_mfma_f32_16x16x32_bf16 v[148:151], a[192:195], v[64:67], 0
  s_lshl3_add_u32 s61, s61, s59
  s_lshl_b32 s61, s61, 15
  v_mfma_f32_16x16x32_bf16 v[148:151], a[196:199], v[72:75], v[148:151]
  s_add_u32 s61, s61, s71
  s_add_u32 s66, s66, 0x8000
  v_mfma_f32_16x16x32_bf16 v[148:151], a[200:203], v[80:83], v[148:151]
  s_and_b32 s66, s66, 0x1ffff
  v_mfma_f32_16x16x32_bf16 v[148:151], a[204:207], v[88:91], v[148:151]
  v_mfma_f32_16x16x32_bf16 v[156:159], a[192:195], v[68:71], 0
  s_add_u32 m0, s66, 0
  s_add_u32 s58, s61, 0
  buffer_load_dwordx4 v8, s[52:55], s58 offen lds
  v_mfma_f32_16x16x32_bf16 v[156:159], a[196:199], v[76:79], v[156:159]
  v_mfma_f32_16x16x32_bf16 v[156:159], a[200:203], v[84:87], v[156:159]
  s_add_u32 m0, s66, 1024
  s_add_u32 s58, s61, 1024
  buffer_load_dwordx4 v9, s[52:55], s58 offen lds
  v_mfma_f32_16x16x32_bf16 v[156:159], a[204:207], v[92:95], v[156:159]
  s_waitcnt lgkmcnt(0)
  v_mfma_f32_16x16x32_bf16 v[128:131], a[16:19], v[96:99], v[128:131]
  s_add_u32 m0, s66, 2048
  s_add_u32 s58, s61, 2048
  buffer_load_dwordx4 v10, s[52:55], s58 offen lds
  v_mfma_f32_16x16x32_bf16 v[128:131], a[20:23], v[104:107], v[128:131]
  s_add_u32 m0, s66, 3072
  s_add_u32 s58, s61, 3072
  buffer_load_dwordx4 v11, s[52:55], s58 offen lds
  v_mfma_f32_16x16x32_bf16 v[128:131], a[24:27], v[112:115], v[128:131]
  ds_read_b128 v[64:67], v16 offset:512
  v_mfma_f32_16x16x32_bf16 v[128:131], a[28:31], v[120:123], v[128:131]
  s_add_u32 m0, s66, 4096
  s_add_u32 s58, s61, 4096
  buffer_load_dwordx4 v12, s[52:55], s58 offen lds
  v_mfma_f32_16x16x32_bf16 v[136:139], a[16:19], v[100:103], v[136:139]
  ds_read_b128 v[68:71], v16 offset:16896
  v_mfma_f32_16x16x32_bf16 v[136:139], a[20:23], v[108:111], v[136:139]
  s_add_u32 m0, s66, 5120
  s_add_u32 s58, s61, 5120
  buffer_load_dwordx4 v13, s[52:55], s58 offen lds
  v_mfma_f32_16x16x32_bf16 v[136:139], a[24:27], v[116:119], v[136:139]
  ds_read_b128 v[72:75], v17 offset:512
  v_mfma_f32_16x16x32_bf16 v[136:139], a[28:31], v[124:127], v[136:139]
  s_add_u32 m0, s66, 6144
  s_add_u32 s58, s61, 6144
  buffer_load_dwordx4 v14, s[52:55], s58 offen lds
  v_mfma_f32_16x16x32_bf16 v[132:135], a[80:83], v[96:99], v[132:135]
  ds_read_b128 v[76:79], v17 offset:16896
  v_mfma_f32_16x16x32_bf16 v[132:135], a[84:87], v[104:107], v[132:135]
  s_add_u32 m0, s66, 7168
  s_add_u32 s58, s61, 7168
  buffer_load_dwordx4 v15, s[52:55], s58 offen lds
  v_mfma_f32_16x16x32_bf16 v[132:135], a[88:91], v[112:115], v[132:135]
  ds_read_b128 v[80:83], v18 offset:512
  v_mfma_f32_16x16x32_bf16 v[132:135], a[92:95], v[120:123], v[132:135]
  v_mfma_f32_16x16x32_bf16 v[140:143], a[80:83], v[100:103], v[140:143]
  ds_read_b128 v[84:87], v18 offset:16896
  s_add_u32 s70, s70, 1
  s_lshr_b32 s61, s70, 3
  v_mfma_f32_16x16x32_bf16 v[140:143], a[84:87], v[108:111], v[140:143]
  s_lshl_b32 s61, s61, 2
  s_lshr_b32 s61, s73, s61
  v_mfma_f32_16x16x32_bf16 v[140:143], a[88:91], v[116:119], v[140:143]
  ds_read_b128 v[88:91], v19 offset:512
  s_and_b32 s61, s61, 7
  s_and_b32 s59, s70, 7
  v_mfma_f32_16x16x32_bf16 v[140:143], a[92:95], v[124:127], v[140:143]
  s_lshl3_add_u32 s61, s61, s59
  s_lshl_b32 s61, s61, 15
  v_mfma_f32_16x16x32_bf16 v[144:147], a[144:147], v[96:99], v[144:147]
  ds_read_b128 v[92:95], v19 offset:16896
  s_add_u32 s61, s61, s71
  s_add_u32 s66, s66, 0x8000
  v_mfma_f32_16x16x32_bf16 v[144:147], a[148:151], v[104:107], v[144:147]
  s_and_b32 s66, s66, 0x1ffff
  v_mfma_f32_16x16x32_bf16 v[144:147], a[152:155], v[112:115], v[144:147]
  v_mfma_f32_16x16x32_bf16 v[144:147], a[156:159], v[120:123], v[144:147]
  s_add_u32 m0, s66, 0
  s_add_u32 s58, s61, 0
  v_mfma_f32_16x16x32_bf16 v[152:155], a[144:147], v[100:103], v[152:155]
  v_mfma_f32_16x16x32_bf16 v[152:155], a[148:151], v[108:111], v[152:155]
  buffer_load_dwordx4 v8, s[52:55], s58 offen lds
  v_mfma_f32_16x16x32_bf16 v[152:155], a[152:155], v[116:119], v[152:155]
  v_mfma_f32_16x16x32_bf16 v[152:155], a[156:159], v[124:127], v[152:155]
  s_add_u32 m0, s66, 1024
  s_add_u32 s58, s61, 1024
  v_mfma_f32_16x16x32_bf16 v[148:151], a[208:211], v[96:99], v[148:151]
  v_mfma_f32_16x16x32_bf16 v[148:151], a[212:215], v[104:107], v[148:151]
  buffer_load_dwordx4 v9, s[52:55], s58 offen lds
  v_mfma_f32_16x16x32_bf16 v[148:151], a[216:219], v[112:115], v[148:151]
  v_mfma_f32_16x16x32_bf16 v[148:151], a[220:223], v[120:123], v[148:151]
  s_add_u32 m0, s66, 2048
  s_add_u32 s58, s61, 2048
  v_mfma_f32_16x16x32_bf16 v[156:159], a[208:211], v[100:103], v[156:159]
  v_mfma_f32_16x16x32_bf16 v[156:159], a[212:215], v[108:111], v[156:159]
  buffer_load_dwordx4 v10, s[52:55], s58 offen lds
  v_mfma_f32_16x16x32_bf16 v[156:159], a[216:219], v[116:119], v[156:159]
  v_mfma_f32_16x16x32_bf16 v[156:159], a[220:223], v[124:127], v[156:159]
  s_waitcnt lgkmcnt(0)
  s_add_u32 m0, s66, 3072
  s_add_u32 s58, s61, 3072
  v_mfma_f32_16x16x32_bf16 v[128:131], a[32:35], v[64:67], v[128:131]
  v_mfma_f32_16x16x32_bf16 v[128:131], a[36:39], v[72:75], v[128:131]
  buffer_load_dwordx4 v11, s[52:55], s58 offen lds
  v_mfma_f32_16x16x32_bf16 v[128:131], a[40:43], v[80:83], v[128:131]
  ds_read_b128 v[96:99], v16 offset:768
  v_mfma_f32_16x16x32_bf16 v[128:131], a[44:47], v[88:91], v[128:131]
  s_add_u32 m0, s66, 4096
  s_add_u32 s58, s61, 4096
  v_mfma_f32_16x16x32_bf16 v[136:139], a[32:35], v[68:71], v[136:139]
  ds_read_b128 v[100:103], v16 offset:17152
  v_mfma_f32_16x16x32_bf16 v[136:139], a[36:39], v[76:79], v[136:139]
  buffer_load_dwordx4 v12, s[52:55], s58 offen lds
  v_mfma_f32_16x16x32_bf16 v[136:139], a[40:43], v[84:87], v[136:139]
  ds_read_b128 v[104:107], v17 offset:768
  v_mfma_f32_16x16x32_bf16 v[136:139], a[44:47], v[92:95], v[136:139]
  s_add_u32 m0, s66, 5120
  s_add_u32 s58, s61, 5120
  v_mfma_f32_16x16x32_bf16 v[132:135], a[96:99], v[64:67], v[132:135]
  ds_read_b128 v[108:111], v17 offset:17152
  v_mfma_f32_16x16x32_bf16 v[132:135], a[100:103], v[72:75], v[132:135]
  buffer_load_dwordx4 v13, s[52:55], s58 offen lds
  v_mfma_f32_16x16x32_bf16 v[132:135], a[104:107], v[80:83], v[132:135]
  ds_read_b128 v[112:115], v18 offset:768
  v_mfma_f32_16x16x32_bf16 v[132:135], a[108:111], v[88:91], v[132:135]
  s_add_u32 m0, s66, 6144
  s_add_u32 s58, s61, 6144
  v_mfma_f32_16x16x32_bf16 v[140:143], a[96:99], v[68:71], v[140:143]
  ds_read_b128 v[116:119], v18 offset:17152
  v_mfma_f32_16x16x32_bf16 v[140:143], a[100:103], v[76:79], v[140:143]
  buffer_load_dwordx4 v14, s[52:55], s58 offen lds
  v_mfma_f32_16x16x32_bf16 v[140:143], a[104:107], v[84:87], v[140:143]
  ds_read_b128 v[120:123], v19 offset:768
  v_mfma_f32_16x16x32_bf16 v[140:143], a[108:111], v[92:95], v[140:143]
  s_add_u32 m0, s66, 7168
  s_add_u32 s58, s61, 7168
  v_mfma_f32_16x16x32_bf16 v[144:147], a[160:163], v[64:67], v[144:147]
  ds_read_b128 v[124:127], v19 offset:17152
  v_mfma_f32_16x16x32_bf16 v[144:147], a[164:167], v[72:75], v[144:147]
  buffer_load_dwordx4 v15, s[52:55], s58 offen lds
  v_mfma_f32_16x16x32_bf16 v[144:147], a[168:171], v[80:83], v[144:147]
  v_mfma_f32_16x16x32_bf16 v[144:147], a[172:175], v[88:91], v[144:147]
  v_mfma_f32_16x16x32_bf16 v[152:155], a[160:163], v[68:71], v[152:155]
  v_add_u32 v16, 0x8000, v16
  v_mfma_f32_16x16x32_bf16 v[152:155], a[164:167], v[76:79], v[152:155]
  v_and_b32 v16, 0x1ffff, v16
  v_mfma_f32_16x16x32_bf16 v[152:155], a[168:171], v[84:87], v[152:155]
  v_add_u32 v17, 0x8000, v17
  v_mfma_f32_16x16x32_bf16 v[152:155], a[172:175], v[92:95], v[152:155]
  v_and_b32 v17, 0x1ffff, v17
  v_mfma_f32_16x16x32_bf16 v[148:151], a[224:227], v[64:67], v[148:151]
  v_add_u32 v18, 0x8000, v18
  v_mfma_f32_16x16x32_bf16 v[148:151], a[228:231], v[72:75], v[148:151]
  v_and_b32 v18, 0x1ffff, v18
  v_mfma_f32_16x16x32_bf16 v[148:151], a[232:235], v[80:83], v[148:151]
  v_add_u32 v19, 0x8000, v19
  v_mfma_f32_16x16x32_bf16 v[148:151], a[236:239], v[88:91], v[148:151]
  v_and_b32 v19, 0x1ffff, v19
  v_mfma_f32_16x16x32_bf16 v[156:159], a[224:227], v[68:71], v[156:159]
  s_sub_u32 s59, s63, 1
  s_max_i32 s59, s59, 0
  v_mfma_f32_16x16x32_bf16 v[156:159], a[228:231], v[76:79], v[156:159]
  v_mov_b32 v7, s59
  v_mfma_f32_16x16x32_bf16 v[156:159], a[232:235], v[84:87], v[156:159]
  s_cmp_lt_u32 s63, s80
  v_mfma_f32_16x16x32_bf16 v[156:159], a[236:239], v[92:95], v[156:159]
  s_waitcnt lgkmcnt(0)
  v_mfma_f32_16x16x32_bf16 v[128:131], a[48:51], v[96:99], v[128:131]
  s_waitcnt vmcnt(16)
  v_mfma_f32_16x16x32_bf16 v[128:131], a[52:55], v[104:107], v[128:131]
  s_barrier
  v_mfma_f32_16x16x32_bf16 v[128:131], a[56:59], v[112:115], v[128:131]
  ds_read_b128 v[64:67], v16 offset:0
  v_mfma_f32_16x16x32_bf16 v[128:131], a[60:63], v[120:123], v[128:131]
  buffer_store_dword v7, v6, s[40:43], s64 offen sc1
  v_mfma_f32_16x16x32_bf16 v[136:139], a[48:51], v[100:103], v[136:139]
  s_lshr_b32 s62, s63, 3
  ds_read_b128 v[68:71], v16 offset:16384
  v_mfma_f32_16x16x32_bf16 v[136:139], a[52:55], v[108:111], v[136:139]
  s_lshl_b32 s62, s62, 2
  v_mfma_f32_16x16x32_bf16 v[136:139], a[56:59], v[116:119], v[136:139]
  s_lshr_b32 s62, s73, s62
  ds_read_b128 v[72:75], v17 offset:0
  v_mfma_f32_16x16x32_bf16 v[136:139], a[60:63], v[124:127], v[136:139]
  s_and_b32 s62, s62, 7
  v_mfma_f32_16x16x32_bf16 v[132:135], a[112:115], v[96:99], v[132:135]
  s_and_b32 s59, s63, 7
  ds_read_b128 v[76:79], v17 offset:16384
  v_mfma_f32_16x16x32_bf16 v[132:135], a[116:119], v[104:107], v[132:135]
  s_lshl3_add_u32 s62, s62, s59
  v_mfma_f32_16x16x32_bf16 v[132:135], a[120:123], v[112:115], v[132:135]
  s_lshl_b32 s62, s62, 13
  ds_read_b128 v[80:83], v18 offset:0
  v_mfma_f32_16x16x32_bf16 v[132:135], a[124:127], v[120:123], v[132:135]
  s_add_u32 s62, s62, s65
  v_mfma_f32_16x16x32_bf16 v[140:143], a[112:115], v[100:103], v[140:143]
  s_add_u32 s70, s70, 1
  ds_read_b128 v[84:87], v18 offset:16384
  v_mfma_f32_16x16x32_bf16 v[140:143], a[116:119], v[108:111], v[140:143]
  s_lshr_b32 s61, s70, 3
  v_mfma_f32_16x16x32_bf16 v[140:143], a[120:123], v[116:119], v[140:143]
  s_lshl_b32 s61, s61, 2
  ds_read_b128 v[88:91], v19 offset:0
  v_mfma_f32_16x16x32_bf16 v[140:143], a[124:127], v[124:127], v[140:143]
  s_lshr_b32 s61, s73, s61
  v_mfma_f32_16x16x32_bf16 v[144:147], a[176:179], v[96:99], v[144:147]
  s_and_b32 s61, s61, 7
  ds_read_b128 v[92:95], v19 offset:16384
  v_mfma_f32_16x16x32_bf16 v[144:147], a[180:183], v[104:107], v[144:147]
  s_and_b32 s59, s70, 7
  v_mfma_f32_16x16x32_bf16 v[144:147], a[184:187], v[112:115], v[144:147]
  s_lshl3_add_u32 s61, s61, s59
  v_mfma_f32_16x16x32_bf16 v[144:147], a[188:191], v[120:123], v[144:147]
  s_lshl_b32 s61, s61, 15
  v_mfma_f32_16x16x32_bf16 v[152:155], a[176:179], v[100:103], v[152:155]
  s_add_u32 s61, s61, s71
  v_mfma_f32_16x16x32_bf16 v[152:155], a[180:183], v[108:111], v[152:155]
  s_add_u32 s66, s66, 0x8000
  v_mfma_f32_16x16x32_bf16 v[152:155], a[184:187], v[116:119], v[152:155]
  s_and_b32 s66, s66, 0x1ffff
  v_mfma_f32_16x16x32_bf16 v[152:155], a[188:191], v[124:127], v[152:155]
  v_mfma_f32_16x16x32_bf16 v[148:151], a[240:243], v[96:99], v[148:151]
  s_add_u32 s63, s63, 1
  v_mfma_f32_16x16x32_bf16 v[148:151], a[244:247], v[104:107], v[148:151]
  v_mfma_f32_16x16x32_bf16 v[148:151], a[248:251], v[112:115], v[148:151]
  v_mfma_f32_16x16x32_bf16 v[148:151], a[252:255], v[120:123], v[148:151]
  v_mfma_f32_16x16x32_bf16 v[156:159], a[240:243], v[100:103], v[156:159]
  v_mfma_f32_16x16x32_bf16 v[156:159], a[244:247], v[108:111], v[156:159]
  v_mfma_f32_16x16x32_bf16 v[156:159], a[248:251], v[116:119], v[156:159]
  s_cmp_lt_u32 s63, s67
  v_mfma_f32_16x16x32_bf16 v[156:159], a[252:255], v[124:127], v[156:159]
  s_waitcnt lgkmcnt(0)
  s_branch L_f_01
L_f_10f:
  v_mfma_f32_16x16x32_bf16 v[128:131], v[64:67], a[0:3], 0
  v_mfma_f32_16x16x32_bf16 v[128:131], v[72:75], a[4:7], v[128:131]
  v_mfma_f32_16x16x32_bf16 v[128:131], v[80:83], a[8:11], v[128:131]
  ds_read_b128 v[96:99], v16 offset:256
  v_mfma_f32_16x16x32_bf16 v[128:131], v[88:91], a[12:15], v[128:131]
  s_cmp_lg_u32 s57, 6
  s_cbranch_scc1 L_f_pw_24
  buffer_store_dwordx4 v[36:39], v2, s[40:43], s79 offen sc1
  s_add_u32 s79, s79, 0x20000
L_f_pw_24:
  v_mfma_f32_16x16x32_bf16 v[132:135], v[68:71], a[0:3], 0
  ds_read_b128 v[100:103], v16 offset:16640
  v_mfma_f32_16x16x32_bf16 v[132:135], v[76:79], a[4:7], v[132:135]
  s_add_u32 m0, s66, 0
  s_add_u32 s58, s61, 0
  buffer_load_dwordx4 v8, s[52:55], s58 offen lds
  v_mfma_f32_16x16x32_bf16 v[132:135], v[84:87], a[8:11], v[132:135]
  ds_read_b128 v[104:107], v17 offset:256
  v_mfma_f32_16x16x32_bf16 v[132:135], v[92:95], a[12:15], v[132:135]
  s_add_u32 m0, s66, 1024
  s_add_u32 s58, s61, 1024
  buffer_load_dwordx4 v9, s[52:55], s58 offen lds
  v_mfma_f32_16x16x32_bf16 v[136:139], v[64:67], a[64:67], 0
  ds_read_b128 v[108:111], v17 offset:16640
  v_mfma_f32_16x16x32_bf16 v[136:139], v[72:75], a[68:71], v[136:139]
  s_add_u32 m0, s66, 2048
  s_add_u32 s58, s61, 2048
  buffer_load_dwordx4 v10, s[52:55], s58 offen lds
  v_mfma_f32_16x16x32_bf16 v[136:139], v[80:83], a[72:75], v[136:139]
  ds_read_b128 v[112:115], v18 offset:256
  v_mfma_f32_16x16x32_bf16 v[136:139], v[88:91], a[76:79], v[136:139]
  s_add_u32 m0, s66, 3072
  s_add_u32 s58, s61, 3072
  buffer_load_dwordx4 v11, s[52:55], s58 offen lds
  v_mfma_f32_16x16x32_bf16 v[140:143], v[68:71], a[64:67], 0
  ds_read_b128 v[116:119], v18 offset:16640
  v_mfma_f32_16x16x32_bf16 v[140:143], v[76:79], a[68:71], v[140:143]
  s_add_u32 m0, s66, 4096
  s_add_u32 s58, s61, 4096
  buffer_load_dwordx4 v12, s[52:55], s58 offen lds
  v_mfma_f32_16x16x32_bf16 v[140:143], v[84:87], a[72:75], v[140:143]
  ds_read_b128 v[120:123], v19 offset:256
  v_mfma_f32_16x16x32_bf16 v[140:143], v[92:95], a[76:79], v[140:143]
  s_add_u32 m0, s66, 5120
  s_add_u32 s58, s61, 5120
  buffer_load_dwordx4 v13, s[52:55], s58 offen lds
  v_mfma_f32_16x16x32_bf16 v[144:147], v[64:67], a[128:131], 0
  ds_read_b128 v[124:127], v19 offset:16640
  v_mfma_f32_16x16x32_bf16 v[144:147], v[72:75], a[132:135], v[144:147]
  s_add_u32 m0, s66, 6144
  s_add_u32 s58, s61, 6144
  buffer_load_dwordx4 v14, s[52:55], s58 offen lds
  v_mfma_f32_16x16x32_bf16 v[144:147], v[80:83], a[136:139], v[144:147]
  v_mfma_f32_16x16x32_bf16 v[144:147], v[88:91], a[140:143], v[144:147]
  s_add_u32 m0, s66, 7168
  s_add_u32 s58, s61, 7168
  buffer_load_dwordx4 v15, s[52:55], s58 offen lds
  v_mfma_f32_16x16x32_bf16 v[148:151], v[68:71], a[128:131], 0
  v_mfma_f32_16x16x32_bf16 v[148:151], v[76:79], a[132:135], v[148:151]
  s_add_u32 s70, s70, 1
  s_lshr_b32 s61, s70, 3
  v_mfma_f32_16x16x32_bf16 v[148:151], v[84:87], a[136:139], v[148:151]
  s_lshl_b32 s61, s61, 2
  s_lshr_b32 s61, s73, s61
  v_mfma_f32_16x16x32_bf16 v[148:151], v[92:95], a[140:143], v[148:151]
  s_and_b32 s61, s61, 7
  s_and_b32 s59, s70, 7
  v_mfma_f32_16x16x32_bf16 v[152:155], v[64:67], a[192:195], 0
  s_lshl3_add_u32 s61, s61, s59
  s_lshl_b32 s61, s61, 15
  v_mfma_f32_16x16x32_bf16 v[152:155], v[72:75], a[196:199], v[152:155]
  s_add_u32 s61, s61, s71
  s_add_u32 s66, s66, 0x8000
  v_mfma_f32_16x16x32_bf16 v[152:155], v[80:83], a[200:203], v[152:155]
  s_and_b32 s66, s66, 0x1ffff
  v_mfma_f32_16x16x32_bf16 v[152:155], v[88:91], a[204:207], v[152:155]
  v_mfma_f32_16x16x32_bf16 v[156:159], v[68:71], a[192:195], 0
  s_add_u32 m0, s66, 0
  s_add_u32 s58, s61, 0
  buffer_load_dwordx4 v8, s[52:55], s58 offen lds
  v_mfma_f32_16x16x32_bf16 v[156:159], v[76:79], a[196:199], v[156:159]
  v_mfma_f32_16x16x32_bf16 v[156:159], v[84:87], a[200:203], v[156:159]
  s_add_u32 m0, s66, 1024
  s_add_u32 s58, s61, 1024
  buffer_load_dwordx4 v9, s[52:55], s58 offen lds
  v_mfma_f32_16x16x32_bf16 v[156:159], v[92:95], a[204:207], v[156:159]
  s_waitcnt lgkmcnt(0)
  v_mfma_f32_16x16x32_bf16 v[128:131], v[96:99], a[16:19], v[128:131]
  s_add_u32 m0, s66, 2048
  s_add_u32 s58, s61, 2048
  buffer_load_dwordx4 v10, s[52:55], s58 offen lds
  v_mfma_f32_16x16x32_bf16 v[128:131], v[104:107], a[20:23], v[128:131]
  s_add_u32 m0, s66, 3072
  s_add_u32 s58, s61, 3072
  buffer_load_dwordx4 v11, s[52:55], s58 offen lds
  v_mfma_f32_16x16x32_bf16 v[128:131], v[112:115], a[24:27], v[128:131]
  ds_read_b128 v[64:67], v16 offset:512
  v_mfma_f32_16x16x32_bf16 v[128:131], v[120:123], a[28:31], v[128:131]
  s_add_u32 m0, s66, 4096
  s_add_u32 s58, s61, 4096
  buffer_load_dwordx4 v12, s[52:55], s58 offen lds
  v_mfma_f32_16x16x32_bf16 v[132:135], v[100:103], a[16:19], v[132:135]
  ds_read_b128 v[68:71], v16 offset:16896
  v_mfma_f32_16x16x32_bf16 v[132:135], v[108:111], a[20:23], v[132:135]
  s_add_u32 m0, s66, 5120
  s_add_u32 s58, s61, 5120
  buffer_load_dwordx4 v13, s[52:55], s58 offen lds
  v_mfma_f32_16x16x32_bf16 v[132:135], v[116:119], a[24:27], v[132:135]
  ds_read_b128 v[72:75], v17 offset:512
  v_mfma_f32_16x16x32_bf16 v[132:135], v[124:127], a[28:31], v[132:135]
  s_add_u32 m0, s66, 6144
  s_add_u32 s58, s61, 6144
  buffer_load_dwordx4 v14, s[52:55], s58 offen lds
  v_mfma_f32_16x16x32_bf16 v[136:139], v[96:99], a[80:83], v[136:139]
  ds_read_b128 v[76:79], v17 offset:16896
  v_mfma_f32_16x16x32_bf16 v[136:139], v[104:107], a[84:87], v[136:139]
  s_add_u32 m0, s66, 7168
  s_add_u32 s58, s61, 7168
  buffer_load_dwordx4 v15, s[52:55], s58 offen lds
  v_mfma_f32_16x16x32_bf16 v[136:139], v[112:115], a[88:91], v[136:139]
  ds_read_b128 v[80:83], v18 offset:512
  v_mfma_f32_16x16x32_bf16 v[136:139], v[120:123], a[92:95], v[136:139]
  v_mfma_f32_16x16x32_bf16 v[140:143], v[100:103], a[80:83], v[140:143]
  ds_read_b128 v[84:87], v18 offset:16896
  s_add_u32 s70, s70, 1
  s_lshr_b32 s61, s70, 3
  v_mfma_f32_16x16x32_bf16 v[140:143], v[108:111], a[84:87], v[140:143]
  s_lshl_b32 s61, s61, 2
  s_lshr_b32 s61, s73, s61
  v_mfma_f32_16x16x32_bf16 v[140:143], v[116:119], a[88:91], v[140:143]
  ds_read_b128 v[88:91], v19 offset:512
  s_and_b32 s61, s61, 7
  s_and_b32 s59, s70, 7
  v_mfma_f32_16x16x32_bf16 v[140:143], v[124:127], a[92:95], v[140:143]
  s_lshl3_add_u32 s61, s61, s59
  s_lshl_b32 s61, s61, 15
  v_mfma_f32_16x16x32_bf16 v[144:147], v[96:99], a[144:147], v[144:147]
  ds_read_b128 v[92:95], v19 offset:16896
  s_add_u32 s61, s61, s71
  s_add_u32 s66, s66, 0x8000
  v_mfma_f32_16x16x32_bf16 v[144:147], v[104:107], a[148:151], v[144:147]
  s_and_b32 s66, s66, 0x1ffff
  v_mfma_f32_16x16x32_bf16 v[144:147], v[112:115], a[152:155], v[144:147]
  v_mfma_f32_16x16x32_bf16 v[144:147], v[120:123], a[156:159], v[144:147]
  s_add_u32 m0, s66, 0
  s_add_u32 s58, s61, 0
  v_mfma_f32_16x16x32_bf16 v[148:151], v[100:103], a[144:147], v[148:151]
  v_mfma_f32_16x16x32_bf16 v[148:151], v[108:111], a[148:151], v[148:151]
  buffer_load_dwordx4 v8, s[52:55], s58 offen lds
  v_mfma_f32_16x16x32_bf16 v[148:151], v[116:119], a[152:155], v[148:151]
  v_mfma_f32_16x16x32_bf16 v[148:151], v[124:127], a[156:159], v[148:151]
  s_add_u32 m0, s66, 1024
  s_add_u32 s58, s61, 1024
  v_mfma_f32_16x16x32_bf16 v[152:155], v[96:99], a[208:211], v[152:155]
  v_mfma_f32_16x16x32_bf16 v[152:155], v[104:107], a[212:215], v[152:155]
  buffer_load_dwordx4 v9, s[52:55], s58 offen lds
  v_mfma_f32_16x16x32_bf16 v[152:155], v[112:115], a[216:219], v[152:155]
  v_mfma_f32_16x16x32_bf16 v[152:155], v[120:123], a[220:223], v[152:155]
  s_add_u32 m0, s66, 2048
  s_add_u32 s58, s61, 2048
  v_mfma_f32_16x16x32_bf16 v[156:159], v[100:103], a[208:211], v[156:159]
  v_mfma_f32_16x16x32_bf16 v[156:159], v[108:111], a[212:215], v[156:159]
  buffer_load_dwordx4 v10, s[52:55], s58 offen lds
  v_mfma_f32_16x16x32_bf16 v[156:159], v[116:119], a[216:219], v[156:159]
  v_mfma_f32_16x16x32_bf16 v[156:159], v[124:127], a[220:223], v[156:159]
  s_waitcnt lgkmcnt(0)
  s_add_u32 m0, s66, 3072
  s_add_u32 s58, s61, 3072
  v_mfma_f32_16x16x32_bf16 v[128:131], v[64:67], a[32:35], v[128:131]
  v_mfma_f32_16x16x32_bf16 v[128:131], v[72:75], a[36:39], v[128:131]
  buffer_load_dwordx4 v11, s[52:55], s58 offen lds
  v_mfma_f32_16x16x32_bf16 v[128:131], v[80:83], a[40:43], v[128:131]
  ds_read_b128 v[96:99], v16 offset:768
  v_mfma_f32_16x16x32_bf16 v[128:131], v[88:91], a[44:47], v[128:131]
  s_add_u32 m0, s66, 4096
  s_add_u32 s58, s61, 4096
  v_mfma_f32_16x16x32_bf16 v[132:135], v[68:71], a[32:35], v[132:135]
  ds_read_b128 v[100:103], v16 offset:17152
  v_mfma_f32_16x16x32_bf16 v[132:135], v[76:79], a[36:39], v[132:135]
  buffer_load_dwordx4 v12, s[52:55], s58 offen lds
  v_mfma_f32_16x16x32_bf16 v[132:135], v[84:87], a[40:43], v[132:135]
  ds_read_b128 v[104:107], v17 offset:768
  v_mfma_f32_16x16x32_bf16 v[132:135], v[92:95], a[44:47], v[132:135]
  s_add_u32 m0, s66, 5120
  s_add_u32 s58, s61, 5120
  v_mfma_f32_16x16x32_bf16 v[136:139], v[64:67], a[96:99], v[136:139]
  ds_read_b128 v[108:111], v17 offset:17152
  v_mfma_f32_16x16x32_bf16 v[136:139], v[72:75], a[100:103], v[136:139]
  buffer_load_dwordx4 v13, s[52:55], s58 offen lds
  v_mfma_f32_16x16x32_bf16 v[136:139], v[80:83], a[104:107], v[136:139]
  ds_read_b128 v[112:115], v18 offset:768
  v_mfma_f32_16x16x32_bf16 v[136:139], v[88:91], a[108:111], v[136:139]
  s_add_u32 m0, s66, 6144
  s_add_u32 s58, s61, 6144
  v_mfma_f32_16x16x32_bf16 v[140:143], v[68:71], a[96:99], v[140:143]
  ds_read_b128 v[116:119], v18 offset:17152
  v_mfma_f32_16x16x32_bf16 v[140:143], v[76:79], a[100:103], v[140:143]
  buffer_load_dwordx4 v14, s[52:55], s58 offen lds
  v_mfma_f32_16x16x32_bf16 v[140:143], v[84:87], a[104:107], v[140:143]
  ds_read_b128 v[120:123], v19 offset:768
  v_mfma_f32_16x16x32_bf16 v[140:143], v[92:95], a[108:111], v[140:143]
  s_add_u32 m0, s66, 7168
  s_add_u32 s58, s61, 7168
  v_mfma_f32_16x16x32_bf16 v[144:147], v[64:67], a[160:163], v[144:147]
  ds_read_b128 v[124:127], v19 offset:17152
  v_mfma_f32_16x16x32_bf16 v[144:147], v[72:75], a[164:167], v[144:147]
  buffer_load_dwordx4 v15, s[52:55], s58 offen lds
  v_mfma_f32_16x16x32_bf16 v[144:147], v[80:83], a[168:171], v[144:147]
  v_mfma_f32_16x16x32_bf16 v[144:147], v[88:91], a[172:175], v[144:147]
  v_mfma_f32_16x16x32_bf16 v[148:151], v[68:71], a[160:163], v[148:151]
  v_add_u32 v16, 0x8000, v16
  v_mfma_f32_16x16x32_bf16 v[148:151], v[76:79], a[164:167], v[148:151]
  v_and_b32 v16, 0x1ffff, v16
  v_mfma_f32_16x16x32_bf16 v[148:151], v[84:87], a[168:171], v[148:151]
  v_add_u32 v17, 0x8000, v17
  v_mfma_f32_16x16x32_bf16 v[148:151], v[92:95], a[172:175], v[148:151]
  v_and_b32 v17, 0x1ffff, v17
  v_mfma_f32_16x16x32_bf16 v[152:155], v[64:67], a[224:227], v[152:155]
  v_add_u32 v18, 0x8000, v18
  v_mfma_f32_16x16x32_bf16 v[152:155], v[72:75], a[228:231], v[152:155]
  v_and_b32 v18, 0x1ffff, v18
  v_mfma_f32_16x16x32_bf16 v[152:155], v[80:83], a[232:235], v[152:155]
  v_add_u32 v19, 0x8000, v19
  v_mfma_f32_16x16x32_bf16 v[152:155], v[88:91], a[236:239], v[152:155]
  v_and_b32 v19, 0x1ffff, v19
  v_mfma_f32_16x16x32_bf16 v[156:159], v[68:71], a[224:227], v[156:159]
  s_sub_u32 s59, s63, 1
  s_max_i32 s59, s59, 0
  v_mfma_f32_16x16x32_bf16 v[156:159], v[76:79], a[228:231], v[156:159]
  v_mov_b32 v7, s59
  v_mfma_f32_16x16x32_bf16 v[156:159], v[84:87], a[232:235], v[156:159]
  s_cmp_lt_u32 s63, s80
  v_mfma_f32_16x16x32_bf16 v[156:159], v[92:95], a[236:239], v[156:159]
  s_waitcnt lgkmcnt(0)
  v_mfma_f32_16x16x32_bf16 v[128:131], v[96:99], a[48:51], v[128:131]
  s_waitcnt vmcnt(16)
  v_mfma_f32_16x16x32_bf16 v[128:131], v[104:107], a[52:55], v[128:131]
  s_barrier
  v_mfma_f32_16x16x32_bf16 v[128:131], v[112:115], a[56:59], v[128:131]
  ds_read_b128 v[64:67], v16 offset:0
  v_mfma_f32_16x16x32_bf16 v[128:131], v[120:123], a[60:63], v[128:131]
  buffer_store_dword v7, v6, s[40:43], s64 offen sc1
  v_mfma_f32_16x16x32_bf16 v[132:135], v[100:103], a[48:51], v[132:135]
  s_lshr_b32 s62, s63, 3
  ds_read_b128 v[68:71], v16 offset:16384
  v_mfma_f32_16x16x32_bf16 v[132:135], v[108:111], a[52:55], v[132:135]
  s_lshl_b32 s62, s62, 2
  v_mfma_f32_16x16x32_bf16 v[132:135], v[116:119], a[56:59], v[132:135]
  s_lshr_b32 s62, s73, s62
  ds_read_b128 v[72:75], v17 offset:0
  v_mfma_f32_16x16x32_bf16 v[132:135], v[124:127], a[60:63], v[132:135]
  s_and_b32 s62, s62, 7
  v_mfma_f32_16x16x32_bf16 v[136:139], v[96:99], a[112:115], v[136:139]
  s_and_b32 s59, s63, 7
  ds_read_b128 v[76:79], v17 offset:16384
  v_mfma_f32_16x16x32_bf16 v[136:139], v[104:107], a[116:119], v[136:139]
  s_lshl3_add_u32 s62, s62, s59
  v_mfma_f32_16x16x32_bf16 v[136:139], v[112:115], a[120:123], v[136:139]
  s_lshl_b32 s62, s62, 13
  ds_read_b128 v[80:83], v18 offset:0
  v_mfma_f32_16x16x32_bf16 v[136:139], v[120:123], a[124:127], v[136:139]
  s_add_u32 s62, s62, s65
  v_mfma_f32_16x16x32_bf16 v[140:143], v[100:103], a[112:115], v[140:143]
  s_add_u32 s70, s70, 1
  ds_read_b128 v[84:87], v18 offset:16384
  v_mfma_f32_16x16x32_bf16 v[140:143], v[108:111], a[116:119], v[140:143]
  s_lshr_b32 s61, s70, 3
  v_mfma_f32_16x16x32_bf16 v[140:143], v[116:119], a[120:123], v[140:143]
  s_lshl_b32 s61, s61, 2
  ds_read_b128 v[88:91], v19 offset:0
  v_mfma_f32_16x16x32_bf16 v[140:143], v[124:127], a[124:127], v[140:143]
  s_lshr_b32 s61, s73, s61
  v_mfma_f32_16x16x32_bf16 v[144:147], v[96:99], a[176:179], v[144:147]
  s_and_b32 s61, s61, 7
  ds_read_b128 v[92:95], v19 offset:16384
  v_mfma_f32_16x16x32_bf16 v[144:147], v[104:107], a[180:183], v[144:147]
  s_and_b32 s59, s70, 7
  v_mfma_f32_16x16x32_bf16 v[144:147], v[112:115], a[184:187], v[144:147]
  s_lshl3_add_u32 s61, s61, s59
  v_mfma_f32_16x16x32_bf16 v[144:147], v[120:123], a[188:191], v[144:147]
  s_lshl_b32 s61, s61, 15
  v_mfma_f32_16x16x32_bf16 v[148:151], v[100:103], a[176:179], v[148:151]
  s_add_u32 s61, s61, s71
  v_mfma_f32_16x16x32_bf16 v[148:151], v[108:111], a[180:183], v[148:151]
  s_add_u32 s66, s66, 0x8000
  v_mfma_f32_16x16x32_bf16 v[148:151], v[116:119], a[184:187], v[148:151]
  s_and_b32 s66, s66, 0x1ffff
  v_mfma_f32_16x16x32_bf16 v[148:151], v[124:127], a[188:191], v[148:151]
  v_mfma_f32_16x16x32_bf16 v[152:155], v[96:99], a[240:243], v[152:155]
  s_add_u32 s63, s63, 1
  v_mfma_f32_16x16x32_bf16 v[152:155], v[104:107], a[244:247], v[152:155]
  v_mfma_f32_16x16x32_bf16 v[152:155], v[112:115], a[248:251], v[152:155]
  v_mfma_f32_16x16x32_bf16 v[152:155], v[120:123], a[252:255], v[152:155]
  v_mfma_f32_16x16x32_bf16 v[156:159], v[100:103], a[240:243], v[156:159]
  v_mfma_f32_16x16x32_bf16 v[156:159], v[108:111], a[244:247], v[156:159]
  v_mfma_f32_16x16x32_bf16 v[156:159], v[116:119], a[248:251], v[156:159]
  s_cmp_lt_u32 s63, s67
  v_mfma_f32_16x16x32_bf16 v[156:159], v[124:127], a[252:255], v[156:159]
  s_waitcnt lgkmcnt(0)
  s_branch L_f_11
L_f_00:
  v_mfma_f32_16x16x32_bf16 v[128:131], a[0:3], v[64:67], 0
  v_mfma_f32_16x16x32_bf16 v[128:131], a[4:7], v[72:75], v[128:131]
  v_mfma_f32_16x16x32_bf16 v[128:131], a[8:11], v[80:83], v[128:131]
  ds_read_b128 v[96:99], v16 offset:256
  v_mfma_f32_16x16x32_bf16 v[128:131], a[12:15], v[88:91], v[128:131]
  s_cmp_lg_u32 s57, 6
  s_cbranch_scc1 L_f_pw_26
  buffer_store_dwordx4 v[36:39], v2, s[40:43], s79 offen sc1
  s_add_u32 s79, s79, 0x20000
L_f_pw_26:
  v_mfma_f32_16x16x32_bf16 v[136:139], a[0:3], v[68:71], 0
  ds_read_b128 v[100:103], v16 offset:16640
  v_mfma_f32_16x16x32_bf16 v[136:139], a[4:7], v[76:79], v[136:139]
  v_mfma_f32_16x16x32_bf16 v[136:139], a[8:11], v[84:87], v[136:139]
  ds_read_b128 v[104:107], v17 offset:256
  v_mfma_f32_16x16x32_bf16 v[136:139], a[12:15], v[92:95], v[136:139]
  v_mfma_f32_16x16x32_bf16 v[132:135], a[64:67], v[64:67], 0
  ds_read_b128 v[108:111], v17 offset:16640
  v_mfma_f32_16x16x32_bf16 v[132:135], a[68:71], v[72:75], v[132:135]
  v_mul_f32 v160, s69, v160
  v_mul_f32 v161, s69, v161
  v_mfma_f32_16x16x32_bf16 v[132:135], a[72:75], v[80:83], v[132:135]
  ds_read_b128 v[112:115], v18 offset:256
  v_mul_f32 v162, s69, v162
  v_mfma_f32_16x16x32_bf16 v[132:135], a[76:79], v[88:91], v[132:135]
  v_mul_f32 v163, s69, v163
  v_mul_f32 v164, s69, v164
  v_mfma_f32_16x16x32_bf16 v[140:143], a[64:67], v[68:71], 0
  ds_read_b128 v[116:119], v18 offset:16640
  v_mul_f32 v165, s69, v165
  v_mfma_f32_16x16x32_bf16 v[140:143], a[68:71], v[76:79], v[140:143]
  v_mul_f32 v166, s69, v166
  v_mul_f32 v167, s69, v167
  v_mfma_f32_16x16x32_bf16 v[140:143], a[72:75], v[84:87], v[140:143]
  ds_read_b128 v[120:123], v19 offset:256
  v_cvt_pk_bf16_f32 v192, v160, v161
  v_mfma_f32_16x16x32_bf16 v[140:143], a[76:79], v[92:95], v[140:143]
  v_cvt_pk_bf16_f32 v193, v162, v163
  v_cvt_pk_bf16_f32 v194, v164, v165
  v_mfma_f32_16x16x32_bf16 v[144:147], a[128:131], v[64:67], 0
  ds_read_b128 v[124:127], v19 offset:16640
  v_cvt_pk_bf16_f32 v195, v166, v167
  v_mfma_f32_16x16x32_bf16 v[144:147], a[132:135], v[72:75], v[144:147]
  buffer_store_dwordx4 v[192:195], v2, s[40:43], s62 offen offset:0 sc1
  v_mfma_f32_16x16x32_bf16 v[144:147], a[136:139], v[80:83], v[144:147]
  v_mul_f32 v168, s69, v168
  v_mul_f32 v169, s69, v169
  v_mfma_f32_16x16x32_bf16 v[144:147], a[140:143], v[88:91], v[144:147]
  v_mul_f32 v170, s69, v170
  v_mul_f32 v171, s69, v171
  v_mfma_f32_16x16x32_bf16 v[152:155], a[128:131], v[68:71], 0
  v_mul_f32 v172, s69, v172
  v_mul_f32 v173, s69, v173
  v_mfma_f32_16x16x32_bf16 v[152:155], a[132:135], v[76:79], v[152:155]
  v_mul_f32 v174, s69, v174
  v_mul_f32 v175, s69, v175
  v_mfma_f32_16x16x32_bf16 v[152:155], a[136:139], v[84:87], v[152:155]
  v_cvt_pk_bf16_f32 v196, v168, v169
  v_cvt_pk_bf16_f32 v197, v170, v171
  v_mfma_f32_16x16x32_bf16 v[152:155], a[140:143], v[92:95], v[152:155]
  v_cvt_pk_bf16_f32 v198, v172, v173
  v_cvt_pk_bf16_f32 v199, v174, v175
  v_mfma_f32_16x16x32_bf16 v[148:151], a[192:195], v[64:67], 0
  buffer_store_dwordx4 v[196:199], v2, s[40:43], s62 offen offset:1024 sc1
  v_mfma_f32_16x16x32_bf16 v[148:151], a[196:199], v[72:75], v[148:151]
  v_mul_f32 v176, s69, v176
  v_mul_f32 v177, s69, v177
  v_mfma_f32_16x16x32_bf16 v[148:151], a[200:203], v[80:83], v[148:151]
  v_mul_f32 v178, s69, v178
  v_mul_f32 v179, s69, v179
  v_mfma_f32_16x16x32_bf16 v[148:151], a[204:207], v[88:91], v[148:151]
  v_mul_f32 v180, s69, v180
  v_mul_f32 v181, s69, v181
  v_mfma_f32_16x16x32_bf16 v[156:159], a[192:195], v[68:71], 0
  v_mul_f32 v182, s69, v182
  v_mul_f32 v183, s69, v183
  v_mfma_f32_16x16x32_bf16 v[156:159], a[196:199], v[76:79], v[156:159]
  v_cvt_pk_bf16_f32 v200, v176, v177
  v_cvt_pk_bf16_f32 v201, v178, v179
  v_mfma_f32_16x16x32_bf16 v[156:159], a[200:203], v[84:87], v[156:159]
  v_cvt_pk_bf16_f32 v202, v180, v181
  v_cvt_pk_bf16_f32 v203, v182, v183
  v_mfma_f32_16x16x32_bf16 v[156:159], a[204:207], v[92:95], v[156:159]
  s_waitcnt lgkmcnt(0)
  buffer_store_dwordx4 v[200:203], v2, s[40:43], s62 offen offset:2048 sc1
  v_mfma_f32_16x16x32_bf16 v[128:131], a[16:19], v[96:99], v[128:131]
  v_mul_f32 v184, s69, v184
  v_mul_f32 v185, s69, v185
  v_mfma_f32_16x16x32_bf16 v[128:131], a[20:23], v[104:107], v[128:131]
  v_mul_f32 v186, s69, v186
  v_mul_f32 v187, s69, v187
  v_mfma_f32_16x16x32_bf16 v[128:131], a[24:27], v[112:115], v[128:131]
  ds_read_b128 v[64:67], v16 offset:512
  v_mul_f32 v188, s69, v188
  v_mfma_f32_16x16x32_bf16 v[128:131], a[28:31], v[120:123], v[128:131]
  v_mul_f32 v189, s69, v189
  v_mul_f32 v190, s69, v190
  v_mfma_f32_16x16x32_bf16 v[136:139], a[16:19], v[100:103], v[136:139]
  ds_read_b128 v[68:71], v16 offset:16896
  v_mul_f32 v191, s69, v191
  v_mfma_f32_16x16x32_bf16 v[136:139], a[20:23], v[108:111], v[136:139]
  v_cvt_pk_bf16_f32 v204, v184, v185
  v_cvt_pk_bf16_f32 v205, v186, v187
  v_mfma_f32_16x16x32_bf16 v[136:139], a[24:27], v[116:119], v[136:139]
  ds_read_b128 v[72:75], v17 offset:512
  v_cvt_pk_bf16_f32 v206, v188, v189
  v_mfma_f32_16x16x32_bf16 v[136:139], a[28:31], v[124:127], v[136:139]
  v_cvt_pk_bf16_f32 v207, v190, v191
  v_mfma_f32_16x16x32_bf16 v[132:135], a[80:83], v[96:99], v[132:135]
  ds_read_b128 v[76:79], v17 offset:16896
  v_mfma_f32_16x16x32_bf16 v[132:135], a[84:87], v[104:107], v[132:135]
  buffer_store_dwordx4 v[204:207], v2, s[40:43], s62 offen offset:3072 sc1
  v_mfma_f32_16x16x32_bf16 v[132:135], a[88:91], v[112:115], v[132:135]
  ds_read_b128 v[80:83], v18 offset:512
  v_mfma_f32_16x16x32_bf16 v[132:135], a[92:95], v[120:123], v[132:135]
  v_mfma_f32_16x16x32_bf16 v[140:143], a[80:83], v[100:103], v[140:143]
  ds_read_b128 v[84:87], v18 offset:16896
  v_mfma_f32_16x16x32_bf16 v[140:143], a[84:87], v[108:111], v[140:143]
  v_mfma_f32_16x16x32_bf16 v[140:143], a[88:91], v[116:119], v[140:143]
  ds_read_b128 v[88:91], v19 offset:512
  v_mfma_f32_16x16x32_bf16 v[140:143], a[92:95], v[124:127], v[140:143]
  v_mfma_f32_16x16x32_bf16 v[144:147], a[144:147], v[96:99], v[144:147]
  ds_read_b128 v[92:95], v19 offset:16896
  v_mfma_f32_16x16x32_bf16 v[144:147], a[148:151], v[104:107], v[144:147]
  v_mfma_f32_16x16x32_bf16 v[144:147], a[152:155], v[112:115], v[144:147]
  v_mfma_f32_16x16x32_bf16 v[144:147], a[156:159], v[120:123], v[144:147]
  s_add_u32 m0, s66, 0
  s_add_u32 s58, s61, 0
  v_mfma_f32_16x16x32_bf16 v[152:155], a[144:147], v[100:103], v[152:155]
  v_mfma_f32_16x16x32_bf16 v[152:155], a[148:151], v[108:111], v[152:155]
  buffer_load_dwordx4 v8, s[52:55], s58 offen lds
  v_mfma_f32_16x16x32_bf16 v[152:155], a[152:155], v[116:119], v[152:155]
  v_mfma_f32_16x16x32_bf16 v[152:155], a[156:159], v[124:127], v[152:155]
  s_add_u32 m0, s66, 1024
  s_add_u32 s58, s61, 1024
  v_mfma_f32_16x16x32_bf16 v[148:151], a[208:211], v[96:99], v[148:151]
  v_mfma_f32_16x16x32_bf16 v[148:151], a[212:215], v[104:107], v[148:151]
  buffer_load_dwordx4 v9, s[52:55], s58 offen lds
  v_mfma_f32_16x16x32_bf16 v[148:151], a[216:219], v[112:115], v[148:151]
  v_mfma_f32_16x16x32_bf16 v[148:151], a[220:223], v[120:123], v[148:151]
  s_add_u32 m0, s66, 2048
  s_add_u32 s58, s61, 2048
  v_mfma_f32_16x16x32_bf16 v[156:159], a[208:211], v[100:103], v[156:159]
  v_mfma_f32_16x16x32_bf16 v[156:159], a[212:215], v[108:111], v[156:159]
  buffer_load_dwordx4 v10, s[52:55], s58 offen lds
  v_mfma_f32_16x16x32_bf16 v[156:159], a[216:219], v[116:119], v[156:159]
  v_mfma_f32_16x16x32_bf16 v[156:159], a[220:223], v[124:127], v[156:159]
  s_waitcnt lgkmcnt(0)
  s_add_u32 m0, s66, 3072
  s_add_u32 s58, s61, 3072
  v_mfma_f32_16x16x32_bf16 v[128:131], a[32:35], v[64:67], v[128:131]
  v_mfma_f32_16x16x32_bf16 v[128:131], a[36:39], v[72:75], v[128:131]
  buffer_load_dwordx4 v11, s[52:55], s58 offen lds
  v_mfma_f32_16x16x32_bf16 v[128:131], a[40:43], v[80:83], v[128:131]
  ds_read_b128 v[96:99], v16 offset:768
  v_mfma_f32_16x16x32_bf16 v[128:131], a[44:47], v[88:91], v[128:131]
  s_add_u32 m0, s66, 4096
  s_add_u32 s58, s61, 4096
  v_mfma_f32_16x16x32_bf16 v[136:139], a[32:35], v[68:71], v[136:139]
  ds_read_b128 v[100:103], v16 offset:17152
  v_mfma_f32_16x16x32_bf16 v[136:139], a[36:39], v[76:79], v[136:139]
  buffer_load_dwordx4 v12, s[52:55], s58 offen lds
  v_mfma_f32_16x16x32_bf16 v[136:139], a[40:43], v[84:87], v[136:139]
  ds_read_b128 v[104:107], v17 offset:768
  v_mfma_f32_16x16x32_bf16 v[136:139], a[44:47], v[92:95], v[136:139]
  s_add_u32 m0, s66, 5120
  s_add_u32 s58, s61, 5120
  v_mfma_f32_16x16x32_bf16 v[132:135], a[96:99], v[64:67], v[132:135]
  ds_read_b128 v[108:111], v17 offset:17152
  v_mfma_f32_16x16x32_bf16 v[132:135], a[100:103], v[72:75], v[132:135]
  buffer_load_dwordx4 v13, s[52:55], s58 offen lds
  v_mfma_f32_16x16x32_bf16 v[132:135], a[104:107], v[80:83], v[132:135]
  ds_read_b128 v[112:115], v18 offset:768
  v_mfma_f32_16x16x32_bf16 v[132:135], a[108:111], v[88:91], v[132:135]
  s_add_u32 m0, s66, 6144
  s_add_u32 s58, s61, 6144
  v_mfma_f32_16x16x32_bf16 v[140:143], a[96:99], v[68:71], v[140:143]
  ds_read_b128 v[116:119], v18 offset:17152
  v_mfma_f32_16x16x32_bf16 v[140:143], a[100:103], v[76:79], v[140:143]
  buffer_load_dwordx4 v14, s[52:55], s58 offen lds
  v_mfma_f32_16x16x32_bf16 v[140:143], a[104:107], v[84:87], v[140:143]
  ds_read_b128 v[120:123], v19 offset:768
  v_mfma_f32_16x16x32_bf16 v[140:143], a[108:111], v[92:95], v[140:143]
  s_add_u32 m0, s66, 7168
  s_add_u32 s58, s61, 7168
  v_mfma_f32_16x16x32_bf16 v[144:147], a[160:163], v[64:67], v[144:147]
  ds_read_b128 v[124:127], v19 offset:17152
  v_mfma_f32_16x16x32_bf16 v[144:147], a[164:167], v[72:75], v[144:147]
  buffer_load_dwordx4 v15, s[52:55], s58 offen lds
  v_mfma_f32_16x16x32_bf16 v[144:147], a[168:171], v[80:83], v[144:147]
  v_mfma_f32_16x16x32_bf16 v[144:147], a[172:175], v[88:91], v[144:147]
  v_mfma_f32_16x16x32_bf16 v[152:155], a[160:163], v[68:71], v[152:155]
  v_add_u32 v16, 0x8000, v16
  v_mfma_f32_16x16x32_bf16 v[152:155], a[164:167], v[76:79], v[152:155]
  v_and_b32 v16, 0x1ffff, v16
  v_mfma_f32_16x16x32_bf16 v[152:155], a[168:171], v[84:87], v[152:155]
  v_add_u32 v17, 0x8000, v17
  v_mfma_f32_16x16x32_bf16 v[152:155], a[172:175], v[92:95], v[152:155]
  v_and_b32 v17, 0x1ffff, v17
  v_mfma_f32_16x16x32_bf16 v[148:151], a[224:227], v[64:67], v[148:151]
  v_add_u32 v18, 0x8000, v18
  v_mfma_f32_16x16x32_bf16 v[148:151], a[228:231], v[72:75], v[148:151]
  v_and_b32 v18, 0x1ffff, v18
  v_mfma_f32_16x16x32_bf16 v[148:151], a[232:235], v[80:83], v[148:151]
  v_add_u32 v19, 0x8000, v19
  v_mfma_f32_16x16x32_bf16 v[148:151], a[236:239], v[88:91], v[148:151]
  v_and_b32 v19, 0x1ffff, v19
  v_mfma_f32_16x16x32_bf16 v[156:159], a[224:227], v[68:71], v[156:159]
  s_sub_u32 s59, s63, 1
  s_max_i32 s59, s59, 0
  v_mfma_f32_16x16x32_bf16 v[156:159], a[228:231], v[76:79], v[156:159]
  v_mov_b32 v7, s59
  v_mfma_f32_16x16x32_bf16 v[156:159], a[232:235], v[84:87], v[156:159]
  s_cmp_lt_u32 s63, s80
  v_mfma_f32_16x16x32_bf16 v[156:159], a[236:239], v[92:95], v[156:159]
  s_waitcnt lgkmcnt(0)
  v_mfma_f32_16x16x32_bf16 v[128:131], a[48:51], v[96:99], v[128:131]
  s_waitcnt vmcnt(20)
  s_cbranch_scc1 L_f_e_25
L_f_e_25b:
  v_mfma_f32_16x16x32_bf16 v[128:131], a[52:55], v[104:107], v[128:131]
  s_barrier
  v_mfma_f32_16x16x32_bf16 v[128:131], a[56:59], v[112:115], v[128:131]
  ds_read_b128 v[64:67], v16 offset:0
  v_mfma_f32_16x16x32_bf16 v[128:131], a[60:63], v[120:123], v[128:131]
  buffer_store_dword v7, v6, s[40:43], s64 offen sc1
  v_mfma_f32_16x16x32_bf16 v[136:139], a[48:51], v[100:103], v[136:139]
  s_lshr_b32 s62, s63, 3
  ds_read_b128 v[68:71], v16 offset:16384
  v_mfma_f32_16x16x32_bf16 v[136:139], a[52:55], v[108:111], v[136:139]
  s_lshl_b32 s62, s62, 2
  v_mfma_f32_16x16x32_bf16 v[136:139], a[56:59], v[116:119], v[136:139]
  s_lshr_b32 s62, s73, s62
  ds_read_b128 v[72:75], v17 offset:0
  v_mfma_f32_16x16x32_bf16 v[136:139], a[60:63], v[124:127], v[136:139]
  s_and_b32 s62, s62, 7
  v_mfma_f32_16x16x32_bf16 v[132:135], a[112:115], v[96:99], v[132:135]
  s_and_b32 s59, s63, 7
  ds_read_b128 v[76:79], v17 offset:16384
  v_mfma_f32_16x16x32_bf16 v[132:135], a[116:119], v[104:107], v[132:135]
  s_lshl3_add_u32 s62, s62, s59
  v_mfma_f32_16x16x32_bf16 v[132:135], a[120:123], v[112:115], v[132:135]
  s_lshl_b32 s62, s62, 13
  ds_read_b128 v[80:83], v18 offset:0
  v_mfma_f32_16x16x32_bf16 v[132:135], a[124:127], v[120:123], v[132:135]
  s_add_u32 s62, s62, s65
  v_mfma_f32_16x16x32_bf16 v[140:143], a[112:115], v[100:103], v[140:143]
  s_add_u32 s70, s70, 1
  ds_read_b128 v[84:87], v18 offset:16384
  v_mfma_f32_16x16x32_bf16 v[140:143], a[116:119], v[108:111], v[140:143]
  s_lshr_b32 s61, s70, 3
  v_mfma_f32_16x16x32_bf16 v[140:143], a[120:123], v[116:119], v[140:143]
  s_lshl_b32 s61, s61, 2
  ds_read_b128 v[88:91], v19 offset:0
  v_mfma_f32_16x16x32_bf16 v[140:143], a[124:127], v[124:127], v[140:143]
  s_lshr_b32 s61, s73, s61
  v_mfma_f32_16x16x32_bf16 v[144:147], a[176:179], v[96:99], v[144:147]
  s_and_b32 s61, s61, 7
  ds_read_b128 v[92:95], v19 offset:16384
  v_mfma_f32_16x16x32_bf16 v[144:147], a[180:183], v[104:107], v[144:147]
  s_and_b32 s59, s70, 7
  v_mfma_f32_16x16x32_bf16 v[144:147], a[184:187], v[112:115], v[144:147]
  s_lshl3_add_u32 s61, s61, s59
  v_mfma_f32_16x16x32_bf16 v[144:147], a[188:191], v[120:123], v[144:147]
  s_lshl_b32 s61, s61, 15
  v_mfma_f32_16x16x32_bf16 v[152:155], a[176:179], v[100:103], v[152:155]
  s_add_u32 s61, s61, s71
  v_mfma_f32_16x16x32_bf16 v[152:155], a[180:183], v[108:111], v[152:155]
  s_add_u32 s66, s66, 0x8000
  v_mfma_f32_16x16x32_bf16 v[152:155], a[184:187], v[116:119], v[152:155]
  s_and_b32 s66, s66, 0x1ffff
  v_mfma_f32_16x16x32_bf16 v[152:155], a[188:191], v[124:127], v[152:155]
  v_mfma_f32_16x16x32_bf16 v[148:151], a[240:243], v[96:99], v[148:151]
  s_add_u32 s63, s63, 1
  v_mfma_f32_16x16x32_bf16 v[148:151], a[244:247], v[104:107], v[148:151]
  v_mfma_f32_16x16x32_bf16 v[148:151], a[248:251], v[112:115], v[148:151]
  v_mfma_f32_16x16x32_bf16 v[148:151], a[252:255], v[120:123], v[148:151]
  v_mfma_f32_16x16x32_bf16 v[156:159], a[240:243], v[100:103], v[156:159]
  v_mfma_f32_16x16x32_bf16 v[156:159], a[244:247], v[108:111], v[156:159]
  v_mfma_f32_16x16x32_bf16 v[156:159], a[248:251], v[116:119], v[156:159]
  s_cmp_lt_u32 s63, s67
  v_mfma_f32_16x16x32_bf16 v[156:159], a[252:255], v[124:127], v[156:159]
  s_waitcnt lgkmcnt(0)
L_f_01:
  v_mfma_f32_16x16x32_bf16 v[160:163], a[0:3], v[64:67], 0
  v_mfma_f32_16x16x32_bf16 v[160:163], a[4:7], v[72:75], v[160:163]
  v_mfma_f32_16x16x32_bf16 v[160:163], a[8:11], v[80:83], v[160:163]
  ds_read_b128 v[96:99], v16 offset:256
  v_mfma_f32_16x16x32_bf16 v[160:163], a[12:15], v[88:91], v[160:163]
  s_cmp_lg_u32 s57, 6
  s_cbranch_scc1 L_f_pw_28
  buffer_store_dwordx4 v[36:39], v2, s[40:43], s79 offen sc1
  s_add_u32 s79, s79, 0x20000
L_f_pw_28:
  v_mfma_f32_16x16x32_bf16 v[168:171], a[0:3], v[68:71], 0
  ds_read_b128 v[100:103], v16 offset:16640
  v_mfma_f32_16x16x32_bf16 v[168:171], a[4:7], v[76:79], v[168:171]
  v_mfma_f32_16x16x32_bf16 v[168:171], a[8:11], v[84:87], v[168:171]
  ds_read_b128 v[104:107], v17 offset:256
  v_mfma_f32_16x16x32_bf16 v[168:171], a[12:15], v[92:95], v[168:171]
  v_mfma_f32_16x16x32_bf16 v[164:167], a[64:67], v[64:67], 0
  ds_read_b128 v[108:111], v17 offset:16640
  v_mfma_f32_16x16x32_bf16 v[164:167], a[68:71], v[72:75], v[164:167]
  v_mul_f32 v128, s69, v128
  v_mul_f32 v129, s69, v129
  v_mfma_f32_16x16x32_bf16 v[164:167], a[72:75], v[80:83], v[164:167]
  ds_read_b128 v[112:115], v18 offset:256
  v_mul_f32 v130, s69, v130
  v_mfma_f32_16x16x32_bf16 v[164:167], a[76:79], v[88:91], v[164:167]
  v_mul_f32 v131, s69, v131
  v_mul_f32 v132, s69, v132
  v_mfma_f32_16x16x32_bf16 v[172:175], a[64:67], v[68:71], 0
  ds_read_b128 v[116:119], v18 offset:16640
  v_mul_f32 v133, s69, v133
  v_mfma_f32_16x16x32_bf16 v[172:175], a[68:71], v[76:79], v[172:175]
  v_mul_f32 v134, s69, v134
  v_mul_f32 v135, s69, v135
  v_mfma_f32_16x16x32_bf16 v[172:175], a[72:75], v[84:87], v[172:175]
  ds_read_b128 v[120:123], v19 offset:256
  v_cvt_pk_bf16_f32 v192, v128, v129
  v_mfma_f32_16x16x32_bf16 v[172:175], a[76:79], v[92:95], v[172:175]
  v_cvt_pk_bf16_f32 v193, v130, v131
  v_cvt_pk_bf16_f32 v194, v132, v133
  v_mfma_f32_16x16x32_bf16 v[176:179], a[128:131], v[64:67], 0
  ds_read_b128 v[124:127], v19 offset:16640
  v_cvt_pk_bf16_f32 v195, v134, v135
  v_mfma_f32_16x16x32_bf16 v[176:179], a[132:135], v[72:75], v[176:179]
  buffer_store_dwordx4 v[192:195], v2, s[40:43], s62 offen offset:0 sc1
  v_mfma_f32_16x16x32_bf16 v[176:179], a[136:139], v[80:83], v[176:179]
  v_mul_f32 v136, s69, v136
  v_mul_f32 v137, s69, v137
  v_mfma_f32_16x16x32_bf16 v[176:179], a[140:143], v[88:91], v[176:179]
  v_mul_f32 v138, s69, v138
  v_mul_f32 v139, s69, v139
  v_mfma_f32_16x16x32_bf16 v[184:187], a[128:131], v[68:71], 0
  v_mul_f32 v140, s69, v140
  v_mul_f32 v141, s69, v141
  v_mfma_f32_16x16x32_bf16 v[184:187], a[132:135], v[76:79], v[184:187]
  v_mul_f32 v142, s69, v142
  v_mul_f32 v143, s69, v143
  v_mfma_f32_16x16x32_bf16 v[184:187], a[136:139], v[84:87], v[184:187]
  v_cvt_pk_bf16_f32 v196, v136, v137
  v_cvt_pk_bf16_f32 v197, v138, v139
  v_mfma_f32_16x16x32_bf16 v[184:187], a[140:143], v[92:95], v[184:187]
  v_cvt_pk_bf16_f32 v198, v140, v141
  v_cvt_pk_bf16_f32 v199, v142, v143
  v_mfma_f32_16x16x32_bf16 v[180:183], a[192:195], v[64:67], 0
  buffer_store_dwordx4 v[196:199], v2, s[40:43], s62 offen offset:1024 sc1
  v_mfma_f32_16x16x32_bf16 v[180:183], a[196:199], v[72:75], v[180:183]
  v_mul_f32 v144, s69, v144
  v_mul_f32 v145, s69, v145
  v_mfma_f32_16x16x32_bf16 v[180:183], a[200:203], v[80:83], v[180:183]
  v_mul_f32 v146, s69, v146
  v_mul_f32 v147, s69, v147
  v_mfma_f32_16x16x32_bf16 v[180:183], a[204:207], v[88:91], v[180:183]
  v_mul_f32 v148, s69, v148
  v_mul_f32 v149, s69, v149
  v_mfma_f32_16x16x32_bf16 v[188:191], a[192:195], v[68:71], 0
  v_mul_f32 v150, s69, v150
  v_mul_f32 v151, s69, v151
  v_mfma_f32_16x16x32_bf16 v[188:191], a[196:199], v[76:79], v[188:191]
  v_cvt_pk_bf16_f32 v200, v144, v145
  v_cvt_pk_bf16_f32 v201, v146, v147
  v_mfma_f32_16x16x32_bf16 v[188:191], a[200:203], v[84:87], v[188:191]
  v_cvt_pk_bf16_f32 v202, v148, v149
  v_cvt_pk_bf16_f32 v203, v150, v151
  v_mfma_f32_16x16x32_bf16 v[188:191], a[204:207], v[92:95], v[188:191]
  s_waitcnt lgkmcnt(0)
  buffer_store_dwordx4 v[200:203], v2, s[40:43], s62 offen offset:2048 sc1
  v_mfma_f32_16x16x32_bf16 v[160:163], a[16:19], v[96:99], v[160:163]
  v_mul_f32 v152, s69, v152
  v_mul_f32 v153, s69, v153
  v_mfma_f32_16x16x32_bf16 v[160:163], a[20:23], v[104:107], v[160:163]
  v_mul_f32 v154, s69, v154
  v_mul_f32 v155, s69, v155
  v_mfma_f32_16x16x32_bf16 v[160:163], a[24:27], v[112:115], v[160:163]
  ds_read_b128 v[64:67], v16 offset:512
  v_mul_f32 v156, s69, v156
  v_mfma_f32_16x16x32_bf16 v[160:163], a[28:31], v[120:123], v[160:163]
  v_mul_f32 v157, s69, v157
  v_mul_f32 v158, s69, v158
  v_mfma_f32_16x16x32_bf16 v[168:171], a[16:19], v[100:103], v[168:171]
  ds_read_b128 v[68:71], v16 offset:16896
  v_mul_f32 v159, s69, v159
  v_mfma_f32_16x16x32_bf16 v[168:171], a[20:23], v[108:111], v[168:171]
  v_cvt_pk_bf16_f32 v204, v152, v153
  v_cvt_pk_bf16_f32 v205, v154, v155
  v_mfma_f32_16x16x32_bf16 v[168:171], a[24:27], v[116:119], v[168:171]
  ds_read_b128 v[72:75], v17 offset:512
  v_cvt_pk_bf16_f32 v206, v156, v157
  v_mfma_f32_16x16x32_bf16 v[168:171], a[28:31], v[124:127], v[168:171]
  v_cvt_pk_bf16_f32 v207, v158, v159
  v_mfma_f32_16x16x32_bf16 v[164:167], a[80:83], v[96:99], v[164:167]
  ds_read_b128 v[76:79], v17 offset:16896
  v_mfma_f32_16x16x32_bf16 v[164:167], a[84:87], v[104:107], v[164:167]
  buffer_store_dwordx4 v[204:207], v2, s[40:43], s62 offen offset:3072 sc1
  v_mfma_f32_16x16x32_bf16 v[164:167], a[88:91], v[112:115], v[164:167]
  ds_read_b128 v[80:83], v18 offset:512
  v_mfma_f32_16x16x32_bf16 v[164:167], a[92:95], v[120:123], v[164:167]
  v_mfma_f32_16x16x32_bf16 v[172:175], a[80:83], v[100:103], v[172:175]
  ds_read_b128 v[84:87], v18 offset:16896
  v_mfma_f32_16x16x32_bf16 v[172:175], a[84:87], v[108:111], v[172:175]
  v_mfma_f32_16x16x32_bf16 v[172:175], a[88:91], v[116:119], v[172:175]
  ds_read_b128 v[88:91], v19 offset:512
  v_mfma_f32_16x16x32_bf16 v[172:175], a[92:95], v[124:127], v[172:175]
  v_mfma_f32_16x16x32_bf16 v[176:179], a[144:147], v[96:99], v[176:179]
  ds_read_b128 v[92:95], v19 offset:16896
  v_mfma_f32_16x16x32_bf16 v[176:179], a[148:151], v[104:107], v[176:179]
  v_mfma_f32_16x16x32_bf16 v[176:179], a[152:155], v[112:115], v[176:179]
  v_mfma_f32_16x16x32_bf16 v[176:179], a[156:159], v[120:123], v[176:179]
  s_add_u32 m0, s66, 0
  s_add_u32 s58, s61, 0
  v_mfma_f32_16x16x32_bf16 v[184:187], a[144:147], v[100:103], v[184:187]
  v_mfma_f32_16x16x32_bf16 v[184:187], a[148:151], v[108:111], v[184:187]
  buffer_load_dwordx4 v8, s[52:55], s58 offen lds
  v_mfma_f32_16x16x32_bf16 v[184:187], a[152:155], v[116:119], v[184:187]
  v_mfma_f32_16x16x32_bf16 v[184:187], a[156:159], v[124:127], v[184:187]
  s_add_u32 m0, s66, 1024
  s_add_u32 s58, s61, 1024
  v_mfma_f32_16x16x32_bf16 v[180:183], a[208:211], v[96:99], v[180:183]
  v_mfma_f32_16x16x32_bf16 v[180:183], a[212:215], v[104:107], v[180:183]
  buffer_load_dwordx4 v9, s[52:55], s58 offen lds
  v_mfma_f32_16x16x32_bf16 v[180:183], a[216:219], v[112:115], v[180:183]
  v_mfma_f32_16x16x32_bf16 v[180:183], a[220:223], v[120:123], v[180:183]
  s_add_u32 m0, s66, 2048
  s_add_u32 s58, s61, 2048
  v_mfma_f32_16x16x32_bf16 v[188:191], a[208:211], v[100:103], v[188:191]
  v_mfma_f32_16x16x32_bf16 v[188:191], a[212:215], v[108:111], v[188:191]
  buffer_load_dwordx4 v10, s[52:55], s58 offen lds
  v_mfma_f32_16x16x32_bf16 v[188:191], a[216:219], v[116:119], v[188:191]
  v_mfma_f32_16x16x32_bf16 v[188:191], a[220:223], v[124:127], v[188:191]
  s_waitcnt lgkmcnt(0)
  s_add_u32 m0, s66, 3072
  s_add_u32 s58, s61, 3072
  v_mfma_f32_16x16x32_bf16 v[160:163], a[32:35], v[64:67], v[160:163]
  v_mfma_f32_16x16x32_bf16 v[160:163], a[36:39], v[72:75], v[160:163]
  buffer_load_dwordx4 v11, s[52:55], s58 offen lds
  v_mfma_f32_16x16x32_bf16 v[160:163], a[40:43], v[80:83], v[160:163]
  ds_read_b128 v[96:99], v16 offset:768
  v_mfma_f32_16x16x32_bf16 v[160:163], a[44:47], v[88:91], v[160:163]
  s_add_u32 m0, s66, 4096
  s_add_u32 s58, s61, 4096
  v_mfma_f32_16x16x32_bf16 v[168:171], a[32:35], v[68:71], v[168:171]
  ds_read_b128 v[100:103], v16 offset:17152
  v_mfma_f32_16x16x32_bf16 v[168:171], a[36:39], v[76:79], v[168:171]
  buffer_load_dwordx4 v12, s[52:55], s58 offen lds
  v_mfma_f32_16x16x32_bf16 v[168:171], a[40:43], v[84:87], v[168:171]
  ds_read_b128 v[104:107], v17 offset:768
  v_mfma_f32_16x16x32_bf16 v[168:171], a[44:47], v[92:95], v[168:171]
  s_add_u32 m0, s66, 5120
  s_add_u32 s58, s61, 5120
  v_mfma_f32_16x16x32_bf16 v[164:167], a[96:99], v[64:67], v[164:167]
  ds_read_b128 v[108:111], v17 offset:17152
  v_mfma_f32_16x16x32_bf16 v[164:167], a[100:103], v[72:75], v[164:167]
  buffer_load_dwordx4 v13, s[52:55], s58 offen lds
  v_mfma_f32_16x16x32_bf16 v[164:167], a[104:107], v[80:83], v[164:167]
  ds_read_b128 v[112:115], v18 offset:768
  v_mfma_f32_16x16x32_bf16 v[164:167], a[108:111], v[88:91], v[164:167]
  s_add_u32 m0, s66, 6144
  s_add_u32 s58, s61, 6144
  v_mfma_f32_16x16x32_bf16 v[172:175], a[96:99], v[68:71], v[172:175]
  ds_read_b128 v[116:119], v18 offset:17152
  v_mfma_f32_16x16x32_bf16 v[172:175], a[100:103], v[76:79], v[172:175]
  buffer_load_dwordx4 v14, s[52:55], s58 offen lds
  v_mfma_f32_16x16x32_bf16 v[172:175], a[104:107], v[84:87], v[172:175]
  ds_read_b128 v[120:123], v19 offset:768
  v_mfma_f32_16x16x32_bf16 v[172:175], a[108:111], v[92:95], v[172:175]
  s_add_u32 m0, s66, 7168
  s_add_u32 s58, s61, 7168
  v_mfma_f32_16x16x32_bf16 v[176:179], a[160:163], v[64:67], v[176:179]
  ds_read_b128 v[124:127], v19 offset:17152
  v_mfma_f32_16x16x32_bf16 v[176:179], a[164:167], v[72:75], v[176:179]
  buffer_load_dwordx4 v15, s[52:55], s58 offen lds
  v_mfma_f32_16x16x32_bf16 v[176:179], a[168:171], v[80:83], v[176:179]
  v_mfma_f32_16x16x32_bf16 v[176:179], a[172:175], v[88:91], v[176:179]
  v_mfma_f32_16x16x32_bf16 v[184:187], a[160:163], v[68:71], v[184:187]
  v_add_u32 v16, 0x8000, v16
  v_mfma_f32_16x16x32_bf16 v[184:187], a[164:167], v[76:79], v[184:187]
  v_and_b32 v16, 0x1ffff, v16
  v_mfma_f32_16x16x32_bf16 v[184:187], a[168:171], v[84:87], v[184:187]
  v_add_u32 v17, 0x8000, v17
  v_mfma_f32_16x16x32_bf16 v[184:187], a[172:175], v[92:95], v[184:187]
  v_and_b32 v17, 0x1ffff, v17
  v_mfma_f32_16x16x32_bf16 v[180:183], a[224:227], v[64:67], v[180:183]
  v_add_u32 v18, 0x8000, v18
  v_mfma_f32_16x16x32_bf16 v[180:183], a[228:231], v[72:75], v[180:183]
  v_and_b32 v18, 0x1ffff, v18
  v_mfma_f32_16x16x32_bf16 v[180:183], a[232:235], v[80:83], v[180:183]
  v_add_u32 v19, 0x8000, v19
  v_mfma_f32_16x16x32_bf16 v[180:183], a[236:239], v[88:91], v[180:183]
  v_and_b32 v19, 0x1ffff, v19
  v_mfma_f32_16x16x32_bf16 v[188:191], a[224:227], v[68:71], v[188:191]
  s_sub_u32 s59, s63, 1
  s_max_i32 s59, s59, 0
  v_mfma_f32_16x16x32_bf16 v[188:191], a[228:231], v[76:79], v[188:191]
  v_mov_b32 v7, s59
  v_mfma_f32_16x16x32_bf16 v[188:191], a[232:235], v[84:87], v[188:191]
  s_cmp_lt_u32 s63, s80
  v_mfma_f32_16x16x32_bf16 v[188:191], a[236:239], v[92:95], v[188:191]
  s_waitcnt lgkmcnt(0)
  v_mfma_f32_16x16x32_bf16 v[160:163], a[48:51], v[96:99], v[160:163]
  s_waitcnt vmcnt(20)
  s_cbranch_scc1 L_f_e_27
L_f_e_27b:
  v_mfma_f32_16x16x32_bf16 v[160:163], a[52:55], v[104:107], v[160:163]
  s_barrier
  v_mfma_f32_16x16x32_bf16 v[160:163], a[56:59], v[112:115], v[160:163]
  ds_read_b128 v[64:67], v16 offset:0
  v_mfma_f32_16x16x32_bf16 v[160:163], a[60:63], v[120:123], v[160:163]
  buffer_store_dword v7, v6, s[40:43], s64 offen sc1
  v_mfma_f32_16x16x32_bf16 v[168:171], a[48:51], v[100:103], v[168:171]
  s_lshr_b32 s62, s63, 3
  ds_read_b128 v[68:71], v16 offset:16384
  v_mfma_f32_16x16x32_bf16 v[168:171], a[52:55], v[108:111], v[168:171]
  s_lshl_b32 s62, s62, 2
  v_mfma_f32_16x16x32_bf16 v[168:171], a[56:59], v[116:119], v[168:171]
  s_lshr_b32 s62, s73, s62
  ds_read_b128 v[72:75], v17 offset:0
  v_mfma_f32_16x16x32_bf16 v[168:171], a[60:63], v[124:127], v[168:171]
  s_and_b32 s62, s62, 7
  v_mfma_f32_16x16x32_bf16 v[164:167], a[112:115], v[96:99], v[164:167]
  s_and_b32 s59, s63, 7
  ds_read_b128 v[76:79], v17 offset:16384
  v_mfma_f32_16x16x32_bf16 v[164:167], a[116:119], v[104:107], v[164:167]
  s_lshl3_add_u32 s62, s62, s59
  v_mfma_f32_16x16x32_bf16 v[164:167], a[120:123], v[112:115], v[164:167]
  s_lshl_b32 s62, s62, 13
  ds_read_b128 v[80:83], v18 offset:0
  v_mfma_f32_16x16x32_bf16 v[164:167], a[124:127], v[120:123], v[164:167]
  s_add_u32 s62, s62, s65
  v_mfma_f32_16x16x32_bf16 v[172:175], a[112:115], v[100:103], v[172:175]
  s_add_u32 s70, s70, 1
  ds_read_b128 v[84:87], v18 offset:16384
  v_mfma_f32_16x16x32_bf16 v[172:175], a[116:119], v[108:111], v[172:175]
  s_lshr_b32 s61, s70, 3
  v_mfma_f32_16x16x32_bf16 v[172:175], a[120:123], v[116:119], v[172:175]
  s_lshl_b32 s61, s61, 2
  ds_read_b128 v[88:91], v19 offset:0
  v_mfma_f32_16x16x32_bf16 v[172:175], a[124:127], v[124:127], v[172:175]
  s_lshr_b32 s61, s73, s61
  v_mfma_f32_16x16x32_bf16 v[176:179], a[176:179], v[96:99], v[176:179]
  s_and_b32 s61, s61, 7
  ds_read_b128 v[92:95], v19 offset:16384
  v_mfma_f32_16x16x32_bf16 v[176:179], a[180:183], v[104:107], v[176:179]
  s_and_b32 s59, s70, 7
  v_mfma_f32_16x16x32_bf16 v[176:179], a[184:187], v[112:115], v[176:179]
  s_lshl3_add_u32 s61, s61, s59
  v_mfma_f32_16x16x32_bf16 v[176:179], a[188:191], v[120:123], v[176:179]
  s_lshl_b32 s61, s61, 15
  v_mfma_f32_16x16x32_bf16 v[184:187], a[176:179], v[100:103], v[184:187]
  s_add_u32 s61, s61, s71
  v_mfma_f32_16x16x32_bf16 v[184:187], a[180:183], v[108:111], v[184:187]
  s_add_u32 s66, s66, 0x8000
  v_mfma_f32_16x16x32_bf16 v[184:187], a[184:187], v[116:119], v[184:187]
  s_and_b32 s66, s66, 0x1ffff
  v_mfma_f32_16x16x32_bf16 v[184:187], a[188:191], v[124:127], v[184:187]
  v_mfma_f32_16x16x32_bf16 v[180:183], a[240:243], v[96:99], v[180:183]
  s_add_u32 s63, s63, 1
  v_mfma_f32_16x16x32_bf16 v[180:183], a[244:247], v[104:107], v[180:183]
  s_mov_b64 exec, 1
  buffer_atomic_add v33, v6, s[40:43], s76 offen
  s_mov_b64 exec, -1
  v_mfma_f32_16x16x32_bf16 v[180:183], a[248:251], v[112:115], v[180:183]
  s_mov_b32 s76, 0x40000000
  v_mfma_f32_16x16x32_bf16 v[180:183], a[252:255], v[120:123], v[180:183]
  v_mfma_f32_16x16x32_bf16 v[188:191], a[240:243], v[100:103], v[188:191]
  v_mfma_f32_16x16x32_bf16 v[188:191], a[244:247], v[108:111], v[188:191]
  v_mfma_f32_16x16x32_bf16 v[188:191], a[248:251], v[116:119], v[188:191]
  s_cmp_lt_u32 s63, s67
  v_mfma_f32_16x16x32_bf16 v[188:191], a[252:255], v[124:127], v[188:191]
  s_waitcnt lgkmcnt(0)
  s_cbranch_scc1 L_f_00
  s_branch L_f_done
L_f_10:
  v_mfma_f32_16x16x32_bf16 v[128:131], v[64:67], a[0:3], 0
  v_mfma_f32_16x16x32_bf16 v[128:131], v[72:75], a[4:7], v[128:131]
  v_mfma_f32_16x16x32_bf16 v[128:131], v[80:83], a[8:11], v[128:131]
  ds_read_b128 v[96:99], v16 offset:256
  v_mfma_f32_16x16x32_bf16 v[128:131], v[88:91], a[12:15], v[128:131]
  s_cmp_lg_u32 s57, 6
  s_cbranch_scc1 L_f_pw_30
  buffer_store_dwordx4 v[36:39], v2, s[40:43], s79 offen sc1
  s_add_u32 s79, s79, 0x20000
L_f_pw_30:
  v_mfma_f32_16x16x32_bf16 v[132:135], v[68:71], a[0:3], 0
  ds_read_b128 v[100:103], v16 offset:16640
  v_mfma_f32_16x16x32_bf16 v[132:135], v[76:79], a[4:7], v[132:135]
  v_mfma_f32_16x16x32_bf16 v[132:135], v[84:87], a[8:11], v[132:135]
  ds_read_b128 v[104:107], v17 offset:256
  v_mfma_f32_16x16x32_bf16 v[132:135], v[92:95], a[12:15], v[132:135]
  v_mfma_f32_16x16x32_bf16 v[136:139], v[64:67], a[64:67], 0
  ds_read_b128 v[108:111], v17 offset:16640
  v_mfma_f32_16x16x32_bf16 v[136:139], v[72:75], a[68:71], v[136:139]
  v_cvt_pk_bf16_f32 v192, v160, v161
  v_cvt_pk_bf16_f32 v193, v162, v163
  v_mfma_f32_16x16x32_bf16 v[136:139], v[80:83], a[72:75], v[136:139]
  ds_read_b128 v[112:115], v18 offset:256
  v_cvt_pk_bf16_f32 v194, v164, v165
  v_mfma_f32_16x16x32_bf16 v[136:139], v[88:91], a[76:79], v[136:139]
  v_cvt_pk_bf16_f32 v195, v166, v167
  v_mfma_f32_16x16x32_bf16 v[140:143], v[68:71], a[64:67], 0
  ds_read_b128 v[116:119], v18 offset:16640
  v_mfma_f32_16x16x32_bf16 v[140:143], v[76:79], a[68:71], v[140:143]
  buffer_store_dwordx4 v[192:195], v2, s[40:43], s62 offen offset:0 sc1
  v_mfma_f32_16x16x32_bf16 v[140:143], v[84:87], a[72:75], v[140:143]
  ds_read_b128 v[120:123], v19 offset:256
  v_cvt_pk_bf16_f32 v196, v168, v169
  v_mfma_f32_16x16x32_bf16 v[140:143], v[92:95], a[76:79], v[140:143]
  v_cvt_pk_bf16_f32 v197, v170, v171
  v_cvt_pk_bf16_f32 v198, v172, v173
  v_mfma_f32_16x16x32_bf16 v[144:147], v[64:67], a[128:131], 0
  ds_read_b128 v[124:127], v19 offset:16640
  v_cvt_pk_bf16_f32 v199, v174, v175
  v_mfma_f32_16x16x32_bf16 v[144:147], v[72:75], a[132:135], v[144:147]
  buffer_store_dwordx4 v[196:199], v2, s[40:43], s62 offen offset:1024 sc1
  v_mfma_f32_16x16x32_bf16 v[144:147], v[80:83], a[136:139], v[144:147]
  v_cvt_pk_bf16_f32 v200, v176, v177
  v_cvt_pk_bf16_f32 v201, v178, v179
  v_mfma_f32_16x16x32_bf16 v[144:147], v[88:91], a[140:143], v[144:147]
  v_cvt_pk_bf16_f32 v202, v180, v181
  v_cvt_pk_bf16_f32 v203, v182, v183
  v_mfma_f32_16x16x32_bf16 v[148:151], v[68:71], a[128:131], 0
  buffer_store_dwordx4 v[200:203], v2, s[40:43], s62 offen offset:2048 sc1
  v_mfma_f32_16x16x32_bf16 v[148:151], v[76:79], a[132:135], v[148:151]
  v_cvt_pk_bf16_f32 v204, v184, v185
  v_cvt_pk_bf16_f32 v205, v186, v187
  v_mfma_f32_16x16x32_bf16 v[148:151], v[84:87], a[136:139], v[148:151]
  v_cvt_pk_bf16_f32 v206, v188, v189
  v_cvt_pk_bf16_f32 v207, v190, v191
  v_mfma_f32_16x16x32_bf16 v[148:151], v[92:95], a[140:143], v[148:151]
  buffer_store_dwordx4 v[204:207], v2, s[40:43], s62 offen offset:3072 sc1
  v_mfma_f32_16x16x32_bf16 v[152:155], v[64:67], a[192:195], 0
  v_mfma_f32_16x16x32_bf16 v[152:155], v[72:75], a[196:199], v[152:155]
  v_mfma_f32_16x16x32_bf16 v[152:155], v[80:83], a[200:203], v[152:155]
  v_mfma_f32_16x16x32_bf16 v[152:155], v[88:91], a[204:207], v[152:155]
  v_mfma_f32_16x16x32_bf16 v[156:159], v[68:71], a[192:195], 0
  v_mfma_f32_16x16x32_bf16 v[156:159], v[76:79], a[196:199], v[156:159]
  v_mfma_f32_16x16x32_bf16 v[156:159], v[84:87], a[200:203], v[156:159]
  v_mfma_f32_16x16x32_bf16 v[156:159], v[92:95], a[204:207], v[156:159]
  s_waitcnt lgkmcnt(0)
  v_mfma_f32_16x16x32_bf16 v[128:131], v[96:99], a[16:19], v[128:131]
  v_mfma_f32_16x16x32_bf16 v[128:131], v[104:107], a[20:23], v[128:131]
  v_mfma_f32_16x16x32_bf16 v[128:131], v[112:115], a[24:27], v[128:131]
  ds_read_b128 v[64:67], v16 offset:512
  v_mfma_f32_16x16x32_bf16 v[128:131], v[120:123], a[28:31], v[128:131]
  v_mfma_f32_16x16x32_bf16 v[132:135], v[100:103], a[16:19], v[132:135]
  ds_read_b128 v[68:71], v16 offset:16896
  v_mfma_f32_16x16x32_bf16 v[132:135], v[108:111], a[20:23], v[132:135]
  v_mfma_f32_16x16x32_bf16 v[132:135], v[116:119], a[24:27], v[132:135]
  ds_read_b128 v[72:75], v17 offset:512
  v_mfma_f32_16x16x32_bf16 v[132:135], v[124:127], a[28:31], v[132:135]
  v_mfma_f32_16x16x32_bf16 v[136:139], v[96:99], a[80:83], v[136:139]
  ds_read_b128 v[76:79], v17 offset:16896
  v_mfma_f32_16x16x32_bf16 v[136:139], v[104:107], a[84:87], v[136:139]
  v_mfma_f32_16x16x32_bf16 v[136:139], v[112:115], a[88:91], v[136:139]
  ds_read_b128 v[80:83], v18 offset:512
  v_mfma_f32_16x16x32_bf16 v[136:139], v[120:123], a[92:95], v[136:139]
  v_mfma_f32_16x16x32_bf16 v[140:143], v[100:103], a[80:83], v[140:143]
  ds_read_b128 v[84:87], v18 offset:16896
  v_mfma_f32_16x16x32_bf16 v[140:143], v[108:111], a[84:87], v[140:143]
  v_mfma_f32_16x16x32_bf16 v[140:143], v[116:119], a[88:91], v[140:143]
  ds_read_b128 v[88:91], v19 offset:512
  v_mfma_f32_16x16x32_bf16 v[140:143], v[124:127], a[92:95], v[140:143]
  v_mfma_f32_16x16x32_bf16 v[144:147], v[96:99], a[144:147], v[144:147]
  ds_read_b128 v[92:95], v19 offset:16896
  v_mfma_f32_16x16x32_bf16 v[144:147], v[104:107], a[148:151], v[144:147]
  v_mfma_f32_16x16x32_bf16 v[144:147], v[112:115], a[152:155], v[144:147]
  v_mfma_f32_16x16x32_bf16 v[144:147], v[120:123], a[156:159], v[144:147]
  s_add_u32 m0, s66, 0
  s_add_u32 s58, s61, 0
  v_mfma_f32_16x16x32_bf16 v[148:151], v[100:103], a[144:147], v[148:151]
  v_mfma_f32_16x16x32_bf16 v[148:151], v[108:111], a[148:151], v[148:151]
  buffer_load_dwordx4 v8, s[52:55], s58 offen lds
  v_mfma_f32_16x16x32_bf16 v[148:151], v[116:119], a[152:155], v[148:151]
  v_mfma_f32_16x16x32_bf16 v[148:151], v[124:127], a[156:159], v[148:151]
  s_add_u32 m0, s66, 1024
  s_add_u32 s58, s61, 1024
  v_mfma_f32_16x16x32_bf16 v[152:155], v[96:99], a[208:211], v[152:155]
  v_mfma_f32_16x16x32_bf16 v[152:155], v[104:107], a[212:215], v[152:155]
  buffer_load_dwordx4 v9, s[52:55], s58 offen lds
  v_mfma_f32_16x16x32_bf16 v[152:155], v[112:115], a[216:219], v[152:155]
  v_mfma_f32_16x16x32_bf16 v[152:155], v[120:123], a[220:223], v[152:155]
  s_add_u32 m0, s66, 2048
  s_add_u32 s58, s61, 2048
  v_mfma_f32_16x16x32_bf16 v[156:159], v[100:103], a[208:211], v[156:159]
  v_mfma_f32_16x16x32_bf16 v[156:159], v[108:111], a[212:215], v[156:159]
  buffer_load_dwordx4 v10, s[52:55], s58 offen lds
  v_mfma_f32_16x16x32_bf16 v[156:159], v[116:119], a[216:219], v[156:159]
  v_mfma_f32_16x16x32_bf16 v[156:159], v[124:127], a[220:223], v[156:159]
  s_waitcnt lgkmcnt(0)
  s_add_u32 m0, s66, 3072
  s_add_u32 s58, s61, 3072
  v_mfma_f32_16x16x32_bf16 v[128:131], v[64:67], a[32:35], v[128:131]
  v_mfma_f32_16x16x32_bf16 v[128:131], v[72:75], a[36:39], v[128:131]
  buffer_load_dwordx4 v11, s[52:55], s58 offen lds
  v_mfma_f32_16x16x32_bf16 v[128:131], v[80:83], a[40:43], v[128:131]
  ds_read_b128 v[96:99], v16 offset:768
  v_mfma_f32_16x16x32_bf16 v[128:131], v[88:91], a[44:47], v[128:131]
  s_add_u32 m0, s66, 4096
  s_add_u32 s58, s61, 4096
  v_mfma_f32_16x16x32_bf16 v[132:135], v[68:71], a[32:35], v[132:135]
  ds_read_b128 v[100:103], v16 offset:17152
  v_mfma_f32_16x16x32_bf16 v[132:135], v[76:79], a[36:39], v[132:135]
  buffer_load_dwordx4 v12, s[52:55], s58 offen lds
  v_mfma_f32_16x16x32_bf16 v[132:135], v[84:87], a[40:43], v[132:135]
  ds_read_b128 v[104:107], v17 offset:768
  v_mfma_f32_16x16x32_bf16 v[132:135], v[92:95], a[44:47], v[132:135]
  s_add_u32 m0, s66, 5120
  s_add_u32 s58, s61, 5120
  v_mfma_f32_16x16x32_bf16 v[136:139], v[64:67], a[96:99], v[136:139]
  ds_read_b128 v[108:111], v17 offset:17152
  v_mfma_f32_16x16x32_bf16 v[136:139], v[72:75], a[100:103], v[136:139]
  buffer_load_dwordx4 v13, s[52:55], s58 offen lds
  v_mfma_f32_16x16x32_bf16 v[136:139], v[80:83], a[104:107], v[136:139]
  ds_read_b128 v[112:115], v18 offset:768
  v_mfma_f32_16x16x32_bf16 v[136:139], v[88:91], a[108:111], v[136:139]
  s_add_u32 m0, s66, 6144
  s_add_u32 s58, s61, 6144
  v_mfma_f32_16x16x32_bf16 v[140:143], v[68:71], a[96:99], v[140:143]
  ds_read_b128 v[116:119], v18 offset:17152
  v_mfma_f32_16x16x32_bf16 v[140:143], v[76:79], a[100:103], v[140:143]
  buffer_load_dwordx4 v14, s[52:55], s58 offen lds
  v_mfma_f32_16x16x32_bf16 v[140:143], v[84:87], a[104:107], v[140:143]
  ds_read_b128 v[120:123], v19 offset:768
  v_mfma_f32_16x16x32_bf16 v[140:143], v[92:95], a[108:111], v[140:143]
  s_add_u32 m0, s66, 7168
  s_add_u32 s58, s61, 7168
  v_mfma_f32_16x16x32_bf16 v[144:147], v[64:67], a[160:163], v[144:147]
  ds_read_b128 v[124:127], v19 offset:17152
  v_mfma_f32_16x16x32_bf16 v[144:147], v[72:75], a[164:167], v[144:147]
  buffer_load_dwordx4 v15, s[52:55], s58 offen lds
  v_mfma_f32_16x16x32_bf16 v[144:147], v[80:83], a[168:171], v[144:147]
  v_mfma_f32_16x16x32_bf16 v[144:147], v[88:91], a[172:175], v[144:147]
  v_mfma_f32_16x16x32_bf16 v[148:151], v[68:71], a[160:163], v[148:151]
  v_add_u32 v16, 0x8000, v16
  v_mfma_f32_16x16x32_bf16 v[148:151], v[76:79], a[164:167], v[148:151]
  v_and_b32 v16, 0x1ffff, v16
  v_mfma_f32_16x16x32_bf16 v[148:151], v[84:87], a[168:171], v[148:151]
  v_add_u32 v17, 0x8000, v17
  v_mfma_f32_16x16x32_bf16 v[148:151], v[92:95], a[172:175], v[148:151]
  v_and_b32 v17, 0x1ffff, v17
  v_mfma_f32_16x16x32_bf16 v[152:155], v[64:67], a[224:227], v[152:155]
  v_add_u32 v18, 0x8000, v18
  v_mfma_f32_16x16x32_bf16 v[152:155], v[72:75], a[228:231], v[152:155]
  v_and_b32 v18, 0x1ffff, v18
  v_mfma_f32_16x16x32_bf16 v[152:155], v[80:83], a[232:235], v[152:155]
  v_add_u32 v19, 0x8000, v19
  v_mfma_f32_16x16x32_bf16 v[152:155], v[88:91], a[236:239], v[152:155]
  v_and_b32 v19, 0x1ffff, v19
  v_mfma_f32_16x16x32_bf16 v[156:159], v[68:71], a[224:227], v[156:159]
  s_sub_u32 s59, s63, 1
  s_max_i32 s59, s59, 0
  v_mfma_f32_16x16x32_bf16 v[156:159], v[76:79], a[228:231], v[156:159]
  v_mov_b32 v7, s59
  v_mfma_f32_16x16x32_bf16 v[156:159], v[84:87], a[232:235], v[156:159]
  s_cmp_lt_u32 s63, s80
  v_mfma_f32_16x16x32_bf16 v[156:159], v[92:95], a[236:239], v[156:159]
  s_waitcnt lgkmcnt(0)
  v_mfma_f32_16x16x32_bf16 v[128:131], v[96:99], a[48:51], v[128:131]
  s_waitcnt vmcnt(20)
  s_cbranch_scc1 L_f_e_29
L_f_e_29b:
  v_mfma_f32_16x16x32_bf16 v[128:131], v[104:107], a[52:55], v[128:131]
  s_barrier
  v_mfma_f32_16x16x32_bf16 v[128:131], v[112:115], a[56:59], v[128:131]
  ds_read_b128 v[64:67], v16 offset:0
  v_mfma_f32_16x16x32_bf16 v[128:131], v[120:123], a[60:63], v[128:131]
  buffer_store_dword v7, v6, s[40:43], s64 offen sc1
  v_mfma_f32_16x16x32_bf16 v[132:135], v[100:103], a[48:51], v[132:135]
  s_lshr_b32 s62, s63, 3
  ds_read_b128 v[68:71], v16 offset:16384
  v_mfma_f32_16x16x32_bf16 v[132:135], v[108:111], a[52:55], v[132:135]
  s_lshl_b32 s62, s62, 2
  v_mfma_f32_16x16x32_bf16 v[132:135], v[116:119], a[56:59], v[132:135]
  s_lshr_b32 s62, s73, s62
  ds_read_b128 v[72:75], v17 offset:0
  v_mfma_f32_16x16x32_bf16 v[132:135], v[124:127], a[60:63], v[132:135]
  s_and_b32 s62, s62, 7
  v_mfma_f32_16x16x32_bf16 v[136:139], v[96:99], a[112:115], v[136:139]
  s_and_b32 s59, s63, 7
  ds_read_b128 v[76:79], v17 offset:16384
  v_mfma_f32_16x16x32_bf16 v[136:139], v[104:107], a[116:119], v[136:139]
  s_lshl3_add_u32 s62, s62, s59
  v_mfma_f32_16x16x32_bf16 v[136:139], v[112:115], a[120:123], v[136:139]
  s_lshl_b32 s62, s62, 13
  ds_read_b128 v[80:83], v18 offset:0
  v_mfma_f32_16x16x32_bf16 v[136:139], v[120:123], a[124:127], v[136:139]
  s_add_u32 s62, s62, s65
  v_mfma_f32_16x16x32_bf16 v[140:143], v[100:103], a[112:115], v[140:143]
  s_add_u32 s70, s70, 1
  ds_read_b128 v[84:87], v18 offset:16384
  v_mfma_f32_16x16x32_bf16 v[140:143], v[108:111], a[116:119], v[140:143]
  s_lshr_b32 s61, s70, 3
  v_mfma_f32_16x16x32_bf16 v[140:143], v[116:119], a[120:123], v[140:143]
  s_lshl_b32 s61, s61, 2
  ds_read_b128 v[88:91], v19 offset:0
  v_mfma_f32_16x16x32_bf16 v[140:143], v[124:127], a[124:127], v[140:143]
  s_lshr_b32 s61, s73, s61
  v_mfma_f32_16x16x32_bf16 v[144:147], v[96:99], a[176:179], v[144:147]
  s_and_b32 s61, s61, 7
  ds_read_b128 v[92:95], v19 offset:16384
  v_mfma_f32_16x16x32_bf16 v[144:147], v[104:107], a[180:183], v[144:147]
  s_and_b32 s59, s70, 7
  v_mfma_f32_16x16x32_bf16 v[144:147], v[112:115], a[184:187], v[144:147]
  s_lshl3_add_u32 s61, s61, s59
  v_mfma_f32_16x16x32_bf16 v[144:147], v[120:123], a[188:191], v[144:147]
  s_lshl_b32 s61, s61, 15
  v_mfma_f32_16x16x32_bf16 v[148:151], v[100:103], a[176:179], v[148:151]
  s_add_u32 s61, s61, s71
  v_mfma_f32_16x16x32_bf16 v[148:151], v[108:111], a[180:183], v[148:151]
  s_add_u32 s66, s66, 0x8000
  v_mfma_f32_16x16x32_bf16 v[148:151], v[116:119], a[184:187], v[148:151]
  s_and_b32 s66, s66, 0x1ffff
  v_mfma_f32_16x16x32_bf16 v[148:151], v[124:127], a[188:191], v[148:151]
  v_mfma_f32_16x16x32_bf16 v[152:155], v[96:99], a[240:243], v[152:155]
  s_add_u32 s63, s63, 1
  v_mfma_f32_16x16x32_bf16 v[152:155], v[104:107], a[244:247], v[152:155]
  v_mfma_f32_16x16x32_bf16 v[152:155], v[112:115], a[248:251], v[152:155]
  v_mfma_f32_16x16x32_bf16 v[152:155], v[120:123], a[252:255], v[152:155]
  v_mfma_f32_16x16x32_bf16 v[156:159], v[100:103], a[240:243], v[156:159]
  v_mfma_f32_16x16x32_bf16 v[156:159], v[108:111], a[244:247], v[156:159]
  v_mfma_f32_16x16x32_bf16 v[156:159], v[116:119], a[248:251], v[156:159]
  s_cmp_lt_u32 s63, s67
  v_mfma_f32_16x16x32_bf16 v[156:159], v[124:127], a[252:255], v[156:159]
  s_waitcnt lgkmcnt(0)
L_f_11:
  v_mfma_f32_16x16x32_bf16 v[160:163], v[64:67], a[0:3], 0
  v_mfma_f32_16x16x32_bf16 v[160:163], v[72:75], a[4:7], v[160:163]
  v_mfma_f32_16x16x32_bf16 v[160:163], v[80:83], a[8:11], v[160:163]
  ds_read_b128 v[96:99], v16 offset:256
  v_mfma_f32_16x16x32_bf16 v[160:163], v[88:91], a[12:15], v[160:163]
  s_cmp_lg_u32 s57, 6
  s_cbranch_scc1 L_f_pw_32
  buffer_store_dwordx4 v[36:39], v2, s[40:43], s79 offen sc1
  s_add_u32 s79, s79, 0x20000
L_f_pw_32:
  v_mfma_f32_16x16x32_bf16 v[164:167], v[68:71], a[0:3], 0
  ds_read_b128 v[100:103], v16 offset:16640
  v_mfma_f32_16x16x32_bf16 v[164:167], v[76:79], a[4:7], v[164:167]
  v_mfma_f32_16x16x32_bf16 v[164:167], v[84:87], a[8:11], v[164:167]
  ds_read_b128 v[104:107], v17 offset:256
  v_mfma_f32_16x16x32_bf16 v[164:167], v[92:95], a[12:15], v[164:167]
  v_mfma_f32_16x16x32_bf16 v[168:171], v[64:67], a[64:67], 0
  ds_read_b128 v[108:111], v17 offset:16640
  v_mfma_f32_16x16x32_bf16 v[168:171], v[72:75], a[68:71], v[168:171]
  v_cvt_pk_bf16_f32 v192, v128, v129
  v_cvt_pk_bf16_f32 v193, v130, v131
  v_mfma_f32_16x16x32_bf16 v[168:171], v[80:83], a[72:75], v[168:171]
  ds_read_b128 v[112:115], v18 offset:256
  v_cvt_pk_bf16_f32 v194, v132, v133
  v_mfma_f32_16x16x32_bf16 v[168:171], v[88:91], a[76:79], v[168:171]
  v_cvt_pk_bf16_f32 v195, v134, v135
  v_mfma_f32_16x16x32_bf16 v[172:175], v[68:71], a[64:67], 0
  ds_read_b128 v[116:119], v18 offset:16640
  v_mfma_f32_16x16x32_bf16 v[172:175], v[76:79], a[68:71], v[172:175]
  buffer_store_dwordx4 v[192:195], v2, s[40:43], s62 offen offset:0 sc1
  v_mfma_f32_16x16x32_bf16 v[172:175], v[84:87], a[72:75], v[172:175]
  ds_read_b128 v[120:123], v19 offset:256
  v_cvt_pk_bf16_f32 v196, v136, v137
  v_mfma_f32_16x16x32_bf16 v[172:175], v[92:95], a[76:79], v[172:175]
  v_cvt_pk_bf16_f32 v197, v138, v139
  v_cvt_pk_bf16_f32 v198, v140, v141
  v_mfma_f32_16x16x32_bf16 v[176:179], v[64:67], a[128:131], 0
  ds_read_b128 v[124:127], v19 offset:16640
  v_cvt_pk_bf16_f32 v199, v142, v143
  v_mfma_f32_16x16x32_bf16 v[176:179], v[72:75], a[132:135], v[176:179]
  buffer_store_dwordx4 v[196:199], v2, s[40:43], s62 offen offset:1024 sc1
  v_mfma_f32_16x16x32_bf16 v[176:179], v[80:83], a[136:139], v[176:179]
  v_cvt_pk_bf16_f32 v200, v144, v145
  v_cvt_pk_bf16_f32 v201, v146, v147
  v_mfma_f32_16x16x32_bf16 v[176:179], v[88:91], a[140:143], v[176:179]
  v_cvt_pk_bf16_f32 v202, v148, v149
  v_cvt_pk_bf16_f32 v203, v150, v151
  v_mfma_f32_16x16x32_bf16 v[180:183], v[68:71], a[128:131], 0
  buffer_store_dwordx4 v[200:203], v2, s[40:43], s62 offen offset:2048 sc1
  v_mfma_f32_16x16x32_bf16 v[180:183], v[76:79], a[132:135], v[180:183]
  v_cvt_pk_bf16_f32 v204, v152, v153
  v_cvt_pk_bf16_f32 v205, v154, v155
  v_mfma_f32_16x16x32_bf16 v[180:183], v[84:87], a[136:139], v[180:183]
  v_cvt_pk_bf16_f32 v206, v156, v157
  v_cvt_pk_bf16_f32 v207, v158, v159
  v_mfma_f32_16x16x32_bf16 v[180:183], v[92:95], a[140:143], v[180:183]
  buffer_store_dwordx4 v[204:207], v2, s[40:43], s62 offen offset:3072 sc1
  v_mfma_f32_16x16x32_bf16 v[184:187], v[64:67], a[192:195], 0
  v_mfma_f32_16x16x32_bf16 v[184:187], v[72:75], a[196:199], v[184:187]
  v_mfma_f32_16x16x32_bf16 v[184:187], v[80:83], a[200:203], v[184:187]
  v_mfma_f32_16x16x32_bf16 v[184:187], v[88:91], a[204:207], v[184:187]
  v_mfma_f32_16x16x32_bf16 v[188:191], v[68:71], a[192:195], 0
  v_mfma_f32_16x16x32_bf16 v[188:191], v[76:79], a[196:199], v[188:191]
  v_mfma_f32_16x16x32_bf16 v[188:191], v[84:87], a[200:203], v[188:191]
  v_mfma_f32_16x16x32_bf16 v[188:191], v[92:95], a[204:207], v[188:191]
  s_waitcnt lgkmcnt(0)
  v_mfma_f32_16x16x32_bf16 v[160:163], v[96:99], a[16:19], v[160:163]
  v_mfma_f32_16x16x32_bf16 v[160:163], v[104:107], a[20:23], v[160:163]
  v_mfma_f32_16x16x32_bf16 v[160:163], v[112:115], a[24:27], v[160:163]
  ds_read_b128 v[64:67], v16 offset:512
  v_mfma_f32_16x16x32_bf16 v[160:163], v[120:123], a[28:31], v[160:163]
  v_mfma_f32_16x16x32_bf16 v[164:167], v[100:103], a[16:19], v[164:167]
  ds_read_b128 v[68:71], v16 offset:16896
  v_mfma_f32_16x16x32_bf16 v[164:167], v[108:111], a[20:23], v[164:167]
  v_mfma_f32_16x16x32_bf16 v[164:167], v[116:119], a[24:27], v[164:167]
  ds_read_b128 v[72:75], v17 offset:512
  v_mfma_f32_16x16x32_bf16 v[164:167], v[124:127], a[28:31], v[164:167]
  v_mfma_f32_16x16x32_bf16 v[168:171], v[96:99], a[80:83], v[168:171]
  ds_read_b128 v[76:79], v17 offset:16896
  v_mfma_f32_16x16x32_bf16 v[168:171], v[104:107], a[84:87], v[168:171]
  v_mfma_f32_16x16x32_bf16 v[168:171], v[112:115], a[88:91], v[168:171]
  ds_read_b128 v[80:83], v18 offset:512
  v_mfma_f32_16x16x32_bf16 v[168:171], v[120:123], a[92:95], v[168:171]
  v_mfma_f32_16x16x32_bf16 v[172:175], v[100:103], a[80:83], v[172:175]
  ds_read_b128 v[84:87], v18 offset:16896
  v_mfma_f32_16x16x32_bf16 v[172:175], v[108:111], a[84:87], v[172:175]
  v_mfma_f32_16x16x32_bf16 v[172:175], v[116:119], a[88:91], v[172:175]
  ds_read_b128 v[88:91], v19 offset:512
  v_mfma_f32_16x16x32_bf16 v[172:175], v[124:127], a[92:95], v[172:175]
  v_mfma_f32_16x16x32_bf16 v[176:179], v[96:99], a[144:147], v[176:179]
  ds_read_b128 v[92:95], v19 offset:16896
  v_mfma_f32_16x16x32_bf16 v[176:179], v[104:107], a[148:151], v[176:179]
  v_mfma_f32_16x16x32_bf16 v[176:179], v[112:115], a[152:155], v[176:179]
  v_mfma_f32_16x16x32_bf16 v[176:179], v[120:123], a[156:159], v[176:179]
  s_add_u32 m0, s66, 0
  s_add_u32 s58, s61, 0
  v_mfma_f32_16x16x32_bf16 v[180:183], v[100:103], a[144:147], v[180:183]
  v_mfma_f32_16x16x32_bf16 v[180:183], v[108:111], a[148:151], v[180:183]
  buffer_load_dwordx4 v8, s[52:55], s58 offen lds
  v_mfma_f32_16x16x32_bf16 v[180:183], v[116:119], a[152:155], v[180:183]
  v_mfma_f32_16x16x32_bf16 v[180:183], v[124:127], a[156:159], v[180:183]
  s_add_u32 m0, s66, 1024
  s_add_u32 s58, s61, 1024
  v_mfma_f32_16x16x32_bf16 v[184:187], v[96:99], a[208:211], v[184:187]
  v_mfma_f32_16x16x32_bf16 v[184:187], v[104:107], a[212:215], v[184:187]
  buffer_load_dwordx4 v9, s[52:55], s58 offen lds
  v_mfma_f32_16x16x32_bf16 v[184:187], v[112:115], a[216:219], v[184:187]
  v_mfma_f32_16x16x32_bf16 v[184:187], v[120:123], a[220:223], v[184:187]
  s_add_u32 m0, s66, 2048
  s_add_u32 s58, s61, 2048
  v_mfma_f32_16x16x32_bf16 v[188:191], v[100:103], a[208:211], v[188:191]
  v_mfma_f32_16x16x32_bf16 v[188:191], v[108:111], a[212:215], v[188:191]
  buffer_load_dwordx4 v10, s[52:55], s58 offen lds
  v_mfma_f32_16x16x32_bf16 v[188:191], v[116:119], a[216:219], v[188:191]
  v_mfma_f32_16x16x32_bf16 v[188:191], v[124:127], a[220:223], v[188:191]
  s_waitcnt lgkmcnt(0)
  s_add_u32 m0, s66, 3072
  s_add_u32 s58, s61, 3072
  v_mfma_f32_16x16x32_bf16 v[160:163], v[64:67], a[32:35], v[160:163]
  v_mfma_f32_16x16x32_bf16 v[160:163], v[72:75], a[36:39], v[160:163]
  buffer_load_dwordx4 v11, s[52:55], s58 offen lds
  v_mfma_f32_16x16x32_bf16 v[160:163], v[80:83], a[40:43], v[160:163]
  ds_read_b128 v[96:99], v16 offset:768
  v_mfma_f32_16x16x32_bf16 v[160:163], v[88:91], a[44:47], v[160:163]
  s_add_u32 m0, s66, 4096
  s_add_u32 s58, s61, 4096
  v_mfma_f32_16x16x32_bf16 v[164:167], v[68:71], a[32:35], v[164:167]
  ds_read_b128 v[100:103], v16 offset:17152
  v_mfma_f32_16x16x32_bf16 v[164:167], v[76:79], a[36:39], v[164:167]
  buffer_load_dwordx4 v12, s[52:55], s58 offen lds
  v_mfma_f32_16x16x32_bf16 v[164:167], v[84:87], a[40:43], v[164:167]
  ds_read_b128 v[104:107], v17 offset:768
  v_mfma_f32_16x16x32_bf16 v[164:167], v[92:95], a[44:47], v[164:167]
  s_add_u32 m0, s66, 5120
  s_add_u32 s58, s61, 5120
  v_mfma_f32_16x16x32_bf16 v[168:171], v[64:67], a[96:99], v[168:171]
  ds_read_b128 v[108:111], v17 offset:17152
  v_mfma_f32_16x16x32_bf16 v[168:171], v[72:75], a[100:103], v[168:171]
  buffer_load_dwordx4 v13, s[52:55], s58 offen lds
  v_mfma_f32_16x16x32_bf16 v[168:171], v[80:83], a[104:107], v[168:171]
  ds_read_b128 v[112:115], v18 offset:768
  v_mfma_f32_16x16x32_bf16 v[168:171], v[88:91], a[108:111], v[168:171]
  s_add_u32 m0, s66, 6144
  s_add_u32 s58, s61, 6144
  v_mfma_f32_16x16x32_bf16 v[172:175], v[68:71], a[96:99], v[172:175]
  ds_read_b128 v[116:119], v18 offset:17152
  v_mfma_f32_16x16x32_bf16 v[172:175], v[76:79], a[100:103], v[172:175]
  buffer_load_dwordx4 v14, s[52:55], s58 offen lds
  v_mfma_f32_16x16x32_bf16 v[172:175], v[84:87], a[104:107], v[172:175]
  ds_read_b128 v[120:123], v19 offset:768
  v_mfma_f32_16x16x32_bf16 v[172:175], v[92:95], a[108:111], v[172:175]
  s_add_u32 m0, s66, 7168
  s_add_u32 s58, s61, 7168
  v_mfma_f32_16x16x32_bf16 v[176:179], v[64:67], a[160:163], v[176:179]
  ds_read_b128 v[124:127], v19 offset:17152
  v_mfma_f32_16x16x32_bf16 v[176:179], v[72:75], a[164:167], v[176:179]
  buffer_load_dwordx4 v15, s[52:55], s58 offen lds
  v_mfma_f32_16x16x32_bf16 v[176:179], v[80:83], a[168:171], v[176:179]
  v_mfma_f32_16x16x32_bf16 v[176:179], v[88:91], a[172:175], v[176:179]
  v_mfma_f32_16x16x32_bf16 v[180:183], v[68:71], a[160:163], v[180:183]
  v_add_u32 v16, 0x8000, v16
  v_mfma_f32_16x16x32_bf16 v[180:183], v[76:79], a[164:167], v[180:183]
  v_and_b32 v16, 0x1ffff, v16
  v_mfma_f32_16x16x32_bf16 v[180:183], v[84:87], a[168:171], v[180:183]
  v_add_u32 v17, 0x8000, v17
  v_mfma_f32_16x16x32_bf16 v[180:183], v[92:95], a[172:175], v[180:183]
  v_and_b32 v17, 0x1ffff, v17
  v_mfma_f32_16x16x32_bf16 v[184:187], v[64:67], a[224:227], v[184:187]
  v_add_u32 v18, 0x8000, v18
  v_mfma_f32_16x16x32_bf16 v[184:187], v[72:75], a[228:231], v[184:187]
  v_and_b32 v18, 0x1ffff, v18
  v_mfma_f32_16x16x32_bf16 v[184:187], v[80:83], a[232:235], v[184:187]
  v_add_u32 v19, 0x8000, v19
  v_mfma_f32_16x16x32_bf16 v[184:187], v[88:91], a[236:239], v[184:187]
  v_and_b32 v19, 0x1ffff, v19
  v_mfma_f32_16x16x32_bf16 v[188:191], v[68:71], a[224:227], v[188:191]
  s_sub_u32 s59, s63, 1
  s_max_i32 s59, s59, 0
  v_mfma_f32_16x16x32_bf16 v[188:191], v[76:79], a[228:231], v[188:191]
  v_mov_b32 v7, s59
  v_mfma_f32_16x16x32_bf16 v[188:191], v[84:87], a[232:235], v[188:191]
  s_cmp_lt_u32 s63, s80
  v_mfma_f32_16x16x32_bf16 v[188:191], v[92:95], a[236:239], v[188:191]
  s_waitcnt lgkmcnt(0)
  v_mfma_f32_16x16x32_bf16 v[160:163], v[96:99], a[48:51], v[160:163]
  s_waitcnt vmcnt(20)
  s_cbranch_scc1 L_f_e_31
L_f_e_31b:
  v_mfma_f32_16x16x32_bf16 v[160:163], v[104:107], a[52:55], v[160:163]
  s_barrier
  v_mfma_f32_16x16x32_bf16 v[160:163], v[112:115], a[56:59], v[160:163]
  ds_read_b128 v[64:67], v16 offset:0
  v_mfma_f32_16x16x32_bf16 v[160:163], v[120:123], a[60:63], v[160:163]
  buffer_store_dword v7, v6, s[40:43], s64 offen sc1
  v_mfma_f32_16x16x32_bf16 v[164:167], v[100:103], a[48:51], v[164:167]
  s_lshr_b32 s62, s63, 3
  ds_read_b128 v[68:71], v16 offset:16384
  v_mfma_f32_16x16x32_bf16 v[164:167], v[108:111], a[52:55], v[164:167]
  s_lshl_b32 s62, s62, 2
  v_mfma_f32_16x16x32_bf16 v[164:167], v[116:119], a[56:59], v[164:167]
  s_lshr_b32 s62, s73, s62
  ds_read_b128 v[72:75], v17 offset:0
  v_mfma_f32_16x16x32_bf16 v[164:167], v[124:127], a[60:63], v[164:167]
  s_and_b32 s62, s62, 7
  v_mfma_f32_16x16x32_bf16 v[168:171], v[96:99], a[112:115], v[168:171]
  s_and_b32 s59, s63, 7
  ds_read_b128 v[76:79], v17 offset:16384
  v_mfma_f32_16x16x32_bf16 v[168:171], v[104:107], a[116:119], v[168:171]
  s_lshl3_add_u32 s62, s62, s59
  v_mfma_f32_16x16x32_bf16 v[168:171], v[112:115], a[120:123], v[168:171]
  s_lshl_b32 s62, s62, 13
  ds_read_b128 v[80:83], v18 offset:0
  v_mfma_f32_16x16x32_bf16 v[168:171], v[120:123], a[124:127], v[168:171]
  s_add_u32 s62, s62, s65
  v_mfma_f32_16x16x32_bf16 v[172:175], v[100:103], a[112:115], v[172:175]
  s_add_u32 s70, s70, 1
  ds_read_b128 v[84:87], v18 offset:16384
  v_mfma_f32_16x16x32_bf16 v[172:175], v[108:111], a[116:119], v[172:175]
  s_lshr_b32 s61, s70, 3
  v_mfma_f32_16x16x32_bf16 v[172:175], v[116:119], a[120:123], v[172:175]
  s_lshl_b32 s61, s61, 2
  ds_read_b128 v[88:91], v19 offset:0
  v_mfma_f32_16x16x32_bf16 v[172:175], v[124:127], a[124:127], v[172:175]
  s_lshr_b32 s61, s73, s61
  v_mfma_f32_16x16x32_bf16 v[176:179], v[96:99], a[176:179], v[176:179]
  s_and_b32 s61, s61, 7
  ds_read_b128 v[92:95], v19 offset:16384
  v_mfma_f32_16x16x32_bf16 v[176:179], v[104:107], a[180:183], v[176:179]
  s_and_b32 s59, s70, 7
  v_mfma_f32_16x16x32_bf16 v[176:179], v[112:115], a[184:187], v[176:179]
  s_lshl3_add_u32 s61, s61, s59
  v_mfma_f32_16x16x32_bf16 v[176:179], v[120:123], a[188:191], v[176:179]
  s_lshl_b32 s61, s61, 15
  v_mfma_f32_16x16x32_bf16 v[180:183], v[100:103], a[176:179], v[180:183]
  s_add_u32 s61, s61, s71
  v_mfma_f32_16x16x32_bf16 v[180:183], v[108:111], a[180:183], v[180:183]
  s_add_u32 s66, s66, 0x8000
  v_mfma_f32_16x16x32_bf16 v[180:183], v[116:119], a[184:187], v[180:183]
  s_and_b32 s66, s66, 0x1ffff
  v_mfma_f32_16x16x32_bf16 v[180:183], v[124:127], a[188:191], v[180:183]
  v_mfma_f32_16x16x32_bf16 v[184:187], v[96:99], a[240:243], v[184:187]
  s_add_u32 s63, s63, 1
  v_mfma_f32_16x16x32_bf16 v[184:187], v[104:107], a[244:247], v[184:187]
  v_mfma_f32_16x16x32_bf16 v[184:187], v[112:115], a[248:251], v[184:187]
  v_mfma_f32_16x16x32_bf16 v[184:187], v[120:123], a[252:255], v[184:187]
  v_mfma_f32_16x16x32_bf16 v[188:191], v[100:103], a[240:243], v[188:191]
  v_mfma_f32_16x16x32_bf16 v[188:191], v[108:111], a[244:247], v[188:191]
  v_mfma_f32_16x16x32_bf16 v[188:191], v[116:119], a[248:251], v[188:191]
  s_cmp_lt_u32 s63, s67
  v_mfma_f32_16x16x32_bf16 v[188:191], v[124:127], a[252:255], v[188:191]
  s_waitcnt lgkmcnt(0)
  s_cbranch_scc1 L_f_10
  s_branch L_f_done
L_f_e_25:
  v_mov_b32 v7, s63
  s_waitcnt vmcnt(8)
  s_branch L_f_e_25b
L_f_e_27:
  v_mov_b32 v7, s63
  s_waitcnt vmcnt(8)
  s_branch L_f_e_27b
L_f_e_29:
  v_mov_b32 v7, s63
  s_waitcnt vmcnt(8)
  s_branch L_f_e_29b
L_f_e_31:
  v_mov_b32 v7, s63
  s_waitcnt vmcnt(8)
  s_branch L_f_e_31b
L_f_done:
  s_nop 7
  v_mul_f32 v160, s69, v160
  v_mul_f32 v161, s69, v161
  v_mul_f32 v162, s69, v162
  v_mul_f32 v163, s69, v163
  v_mul_f32 v164, s69, v164
  v_mul_f32 v165, s69, v165
  v_mul_f32 v166, s69, v166
  v_mul_f32 v167, s69, v167
  v_cvt_pk_bf16_f32 v192, v160, v161
  v_cvt_pk_bf16_f32 v193, v162, v163
  v_cvt_pk_bf16_f32 v194, v164, v165
  v_cvt_pk_bf16_f32 v195, v166, v167
  buffer_store_dwordx4 v[192:195], v2, s[40:43], s62 offen offset:0 sc1
  v_mul_f32 v168, s69, v168
  v_mul_f32 v169, s69, v169
  v_mul_f32 v170, s69, v170
  v_mul_f32 v171, s69, v171
  v_mul_f32 v172, s69, v172
  v_mul_f32 v173, s69, v173
  v_mul_f32 v174, s69, v174
  v_mul_f32 v175, s69, v175
  v_cvt_pk_bf16_f32 v196, v168, v169
  v_cvt_pk_bf16_f32 v197, v170, v171
  v_cvt_pk_bf16_f32 v198, v172, v173
  v_cvt_pk_bf16_f32 v199, v174, v175
  buffer_store_dwordx4 v[196:199], v2, s[40:43], s62 offen offset:1024 sc1
  v_mul_f32 v176, s69, v176
  v_mul_f32 v177, s69, v177
  v_mul_f32 v178, s69, v178
  v_mul_f32 v179, s69, v179
  v_mul_f32 v180, s69, v180
  v_mul_f32 v181, s69, v181
  v_mul_f32 v182, s69, v182
  v_mul_f32 v183, s69, v183
  v_cvt_pk_bf16_f32 v200, v176, v177
  v_cvt_pk_bf16_f32 v201, v178, v179
  v_cvt_pk_bf16_f32 v202, v180, v181
  v_cvt_pk_bf16_f32 v203, v182, v183
  buffer_store_dwordx4 v[200:203], v2, s[40:43], s62 offen offset:2048 sc1
  v_mul_f32 v184, s69, v184
  v_mul_f32 v185, s69, v185
  v_mul_f32 v186, s69, v186
  v_mul_f32 v187, s69, v187
  v_mul_f32 v188, s69, v188
  v_mul_f32 v189, s69, v189
  v_mul_f32 v190, s69, v190
  v_mul_f32 v191, s69, v191
  v_cvt_pk_bf16_f32 v204, v184, v185
  v_cvt_pk_bf16_f32 v205, v186, v187
  v_cvt_pk_bf16_f32 v206, v188, v189
  v_cvt_pk_bf16_f32 v207, v190, v191
  buffer_store_dwordx4 v[204:207], v2, s[40:43], s62 offen offset:3072 sc1
  v_mov_b32 v7, s67
  s_waitcnt vmcnt(0) lgkmcnt(0)
  s_barrier
  buffer_store_dword v7, v6, s[40:43], s64 offen sc1
  s_branch L_next
L_after_p:
  s_waitcnt vmcnt(0)
  s_endpgm
L_team:
  s_mov_b32 s67, 0
  v_lshrrev_b32 v20, 4, v0
  v_and_b32 v21, 15, v0
  v_bfe_u32 v22, v0, 4, 1
  v_lshrrev_b32 v23, 5, v0
  s_lshl_b32 s68, s44, 1
  v_or_b32 v24, s68, v22
  v_lshlrev_b32 v24, 1, v24
  v_xor_b32 v24, v24, v21
  v_lshlrev_b32 v24, 4, v24
  v_lshl_add_u32 v25, v22, 4, v23
  v_add_u32 v25, s68, v25
  v_lshl_add_u32 v44, v25, 13, v24
  s_lshl_b32 s69, s45, 8
  v_add_u32 v44, s69, v44
  s_lshl_b32 s68, s44, 4
  v_add_u32 v25, s68, v20
  v_lshl_add_u32 v45, v25, 10, v24
  s_lshl_b32 s69, s45, 17
  v_add_u32 v45, s69, v45
  s_mov_b32 s50, 0x400000
  s_mov_b32 s51, 0x20000
  s_lshl_b32 s56, s44, 10
  s_mov_b32 s48, s30
  s_and_b32 s49, s31, 0xffff
  s_add_u32 m0, s56, 0
  s_mov_b32 s68, 0
  buffer_load_dwordx4 v45, s[48:51], s68 offen  lds
  s_add_u32 m0, s56, 4096
  s_mov_b32 s68, 4096
  buffer_load_dwordx4 v45, s[48:51], s68 offen  lds
  s_add_u32 m0, s56, 8192
  s_mov_b32 s68, 8192
  buffer_load_dwordx4 v45, s[48:51], s68 offen  lds
  s_add_u32 m0, s56, 12288
  s_mov_b32 s68, 12288
  buffer_load_dwordx4 v45, s[48:51], s68 offen  lds
  s_add_u32 m0, s56, 16384
  s_mov_b32 s68, 65536
  buffer_load_dwordx4 v45, s[48:51], s68 offen  lds
  s_add_u32 m0, s56, 20480
  s_mov_b32 s68, 69632
  buffer_load_dwordx4 v45, s[48:51], s68 offen  lds
  s_add_u32 m0, s56, 24576
  s_mov_b32 s68, 73728
  buffer_load_dwordx4 v45, s[48:51], s68 offen  lds
  s_add_u32 m0, s56, 28672
  s_mov_b32 s68, 77824
  buffer_load_dwordx4 v45, s[48:51], s68 offen  lds
  s_lshl_b32 s68, s44, 11
  s_add_u32 s68, s68, 131072
  v_lshl_add_u32 v2, v0, 4, s68
  s_add_u32 s73, s68, 8192
  s_lshl_b32 s68, s44, 12
  v_lshl_add_u32 v3, v0, 4, s68
  s_lshl_b32 s68, s44, 9
  s_add_u32 s68, s68, 131072
  v_bfe_u32 v22, v0, 3, 1
  v_lshl_add_u32 v5, v22, 8, s68
  v_lshl_add_u32 v5, v20, 6, v5
  v_and_b32 v22, 7, v0
  v_lshl_add_u32 v5, v22, 3, v5
  v_lshrrev_b32 v22, 5, v0
  v_lshlrev_b32 v6, 8, v22
  v_and_b32 v22, 3, v0
  v_lshl_add_u32 v6, v22, 6, v6
  v_bfe_u32 v22, v0, 2, 3
  v_lshl_add_u32 v6, v22, 3, v6
  v_add_u32 v6, 131072, v6
  s_lshl_b32 s68, s44, 9
  s_add_u32 s68, s68, 147456
  v_lshrrev_b32 v22, 1, v0
  v_lshl_add_u32 v7, v22, 4, s68
  s_lshl_b32 s68, s44, 14
  s_lshl_b32 s69, s45, 6
  s_add_u32 s68, s68, s69
  v_lshrrev_b32 v22, 3, v0
  v_lshl_add_u32 v8, v22, 11, s68
  v_and_b32 v22, 7, v0
  v_lshl_add_u32 v8, v22, 3, v8
  v_lshlrev_b32 v9, 8, v20
  v_bfe_u32 v22, v0, 2, 1
  v_lshl_add_u32 v9, v22, 7, v9
  v_and_b32 v22, 1, v0
  v_lshl_add_u32 v9, v22, 6, v9
  v_bfe_u32 v22, v0, 3, 1
  v_lshl_add_u32 v9, v22, 5, v9
  v_bfe_u32 v22, v0, 1, 1
  v_lshl_add_u32 v9, v22, 4, v9
  s_lshl_b32 s68, s44, 16
  s_lshl_b32 s69, s45, 11
  s_add_u32 s68, s68, s69
  s_add_u32 s62, s68, 0xd000000
  v_bfe_u32 v22, v0, 3, 1
  v_lshlrev_b32 v10, 13, v22
  v_lshl_add_u32 v10, v20, 3, v10
  v_bfe_u32 v22, v0, 1, 1
  v_lshl_add_u32 v10, v22, 5, v10
  v_bfe_u32 v22, v0, 2, 1
  v_lshl_add_u32 v10, v22, 2, v10
  v_and_b32 v22, 1, v0
  v_lshl_add_u32 v10, v22, 1, v10
  s_lshl_b32 s64, s44, 11
  s_lshr_b32 s68, s45, 3
  s_lshl_b32 s68, s68, 9
  s_add_u32 s64, s64, s68
  s_and_b32 s68, s45, 1
  s_lshl_b32 s68, s68, 8
  s_add_u32 s64, s64, s68
  s_bfe_u32 s68, s45, 0x20001
  s_lshl_b32 s68, s68, 6
  s_add_u32 s64, s64, s68
  s_add_u32 s64, s64, 0xd040000
  s_mov_b32 s63, 0xd022000
  s_lshl_b32 s60, s45, 7
  s_add_u32 s60, s60, 0xd081000
  s_lshl_b32 s72, s45, 19
  s_add_u32 s72, s72, 0x3fe0000
  s_mov_b32 s94, 0xaaaaaaaa
  s_mov_b32 s95, 0xaaaaaaaa
  v_mov_b32 v17, 0
  v_mov_b32 v18, 0
  v_mov_b32 v16, 0
  v_mov_b32 v12, 0x3f803f80
  v_mov_b32 v13, 0x3f803f80
  v_mov_b32 v14, 0x3f803f80
  v_mov_b32 v15, 0x3f803f80
  s_mov_b32 s78, 0xff00ff00
  s_mov_b32 s79, 0xff00ff00
  s_mov_b32 s88, 0x3e0293ee
  s_mov_b32 s89, 0x21800000
  s_mov_b32 s91, 0x3c000000
  s_mov_b32 s90, 0xfffe
  s_lshl_b32 s68, s44, 11
  s_add_u32 s70, s68, 147456
  s_add_u32 s71, s68, 139264
  s_lshl_b32 s68, s45, 7
  s_add_u32 s68, s68, 0xd084000
  s_cmp_eq_u32 s44, 0
  s_cselect_b32 s66, s68, 0x40000000
  s_mov_b32 s80, 0x3030303
  s_mov_b32 s81, 0x3030303
  s_mov_b32 s74, 0xd000000
  s_mov_b32 s82, 0xc0c0c0c
  s_mov_b32 s83, 0xc0c0c0c
  s_mov_b32 s75, 0xd010000
  s_mov_b32 s84, 0x30303030
  s_mov_b32 s85, 0x30303030
  s_mov_b32 s76, 0xd020000
  s_mov_b32 s86, 0xc0c0c0c0
  s_mov_b32 s87, 0xc0c0c0c0
  s_mov_b32 s77, 0xd030000
  buffer_store_dwordx2 v[16:17], v8, s[40:43], s74 offen sc1
  buffer_store_dwordx2 v[16:17], v8, s[40:43], s75 offen sc1
  buffer_store_dwordx2 v[16:17], v8, s[40:43], s76 offen sc1
  buffer_store_dwordx2 v[16:17], v8, s[40:43], s77 offen sc1
  v_mov_b32 v22, 0xffff
  buffer_store_short v22, v10, s[40:43], s64 offen sc1
  s_mul_i32 s68, s44, 4
  s_lshr_b32 s68, 0x7640, s68
  s_and_b32 s68, s68, 15
  s_lshl_b32 s68, s68, 12
  s_lshl_b32 s69, s45, 7
  s_add_u32 s68, s68, s69
  s_add_u32 s68, s68, 0xd080000
  v_and_b32 v23, 31, v0
  v_lshlrev_b32 v23, 2, v23
  v_lshrrev_b32 v24, 5, v0
  v_lshl_add_u32 v23, v24, 12, v23
  buffer_store_dword v17, v23, s[40:43], s68 offen sc1
  s_mov_b32 s52, s22
  s_and_b32 s53, s23, 0xffff
  s_mov_b32 s54, 0x2000
  s_mov_b32 s55, 0x20000
  v_bfe_u32 v22, v0, 1, 3
  v_lshlrev_b32 v23, 10, v22
  v_lshrrev_b32 v22, 5, v0
  v_lshl_add_u32 v23, v22, 6, v23
  v_bfe_u32 v22, v0, 4, 1
  v_lshl_add_u32 v23, v22, 4, v23
  v_and_b32 v22, 1, v0
  v_lshl_add_u32 v23, v22, 3, v23
  s_lshl_b32 s68, s44, 8
  buffer_load_dwordx2 v[92:93], v23, s[52:55], s68 offen
  buffer_load_dwordx2 v[94:95], v23, s[52:55], s68 offen offset:32
  buffer_load_dwordx2 v[96:97], v23, s[52:55], s68 offen offset:128
  buffer_load_dwordx2 v[98:99], v23, s[52:55], s68 offen offset:160
  v_lshrrev_b32 v22, 5, v0
  v_lshlrev_b32 v46, 12, v22
  v_bfe_u32 v22, v0, 3, 1
  v_lshl_add_u32 v46, v22, 11, v46
  v_lshlrev_b32 v24, 2, v22
  v_bfe_u32 v22, v0, 4, 1
  v_lshl_add_u32 v46, v22, 10, v46
  v_lshl_add_u32 v24, v22, 1, v24
  v_bfe_u32 v22, v0, 2, 1
  v_lshl_add_u32 v46, v22, 8, v46
  v_add_u32 v24, v24, v22
  s_lshl_b32 s68, s44, 1
  v_xor_b32 v24, s68, v24
  v_lshl_add_u32 v46, v24, 5, v46
  v_and_b32 v22, 3, v0
  v_lshl_add_u32 v46, v22, 3, v46
  v_xor_b32 v47, 32, v46
  v_bfe_u32 v22, v0, 3, 1
  v_mul_u32_u24 v22, 2208, v22
  v_xor_b32 v50, v22, v46
  v_xor_b32 v51, 2176, v50
  s_mov_b32 s52, s38
  s_and_b32 s53, s39, 0xffff
  s_mov_b32 s54, 0x100
  s_mov_b32 s55, 0x20000
  s_add_u32 m0, s56, 32768
  s_mov_b32 s68, 256
  buffer_load_dwordx4 v45, s[48:51], s68 offen  lds
  s_add_u32 m0, s56, 36864
  s_mov_b32 s68, 4352
  buffer_load_dwordx4 v45, s[48:51], s68 offen  lds
  s_add_u32 m0, s56, 40960
  s_mov_b32 s68, 8448
  buffer_load_dwordx4 v45, s[48:51], s68 offen  lds
  s_add_u32 m0, s56, 45056
  s_mov_b32 s68, 12544
  buffer_load_dwordx4 v45, s[48:51], s68 offen  lds
  s_waitcnt vmcnt(8)
  s_barrier
  s_add_u32 m0, s56, 49152
  s_mov_b32 s68, 65792
  buffer_load_dwordx4 v45, s[48:51], s68 offen  lds
  s_add_u32 m0, s56, 53248
  s_mov_b32 s68, 69888
  buffer_load_dwordx4 v45, s[48:51], s68 offen  lds
  s_add_u32 m0, s56, 57344
  s_mov_b32 s68, 73984
  buffer_load_dwordx4 v45, s[48:51], s68 offen  lds
  s_add_u32 m0, s56, 61440
  s_mov_b32 s68, 78080
  buffer_load_dwordx4 v45, s[48:51], s68 offen  lds
  v_add_u32 v48, 0, v50
  v_add_u32 v49, 0, v51
  s_cmp_lg_u32 s44, 0
  s_cbranch_scc1 L_wr_0_1
  ds_read_b64_tr_b16 v[128:129], v48 offset:0
  ds_read_b64_tr_b16 v[130:131], v48 offset:512
  ds_read_b64_tr_b16 v[132:133], v48 offset:8192
  ds_read_b64_tr_b16 v[134:135], v48 offset:8704
  ds_read_b64_tr_b16 v[136:137], v49 offset:0
  ds_read_b64_tr_b16 v[138:139], v49 offset:512
  ds_read_b64_tr_b16 v[140:141], v49 offset:8192
  ds_read_b64_tr_b16 v[142:143], v49 offset:8704
  s_branch L_wr_0_e
L_wr_0_1:
  s_cmp_lg_u32 s44, 1
  s_cbranch_scc1 L_wr_0_2
  ds_read_b64_tr_b16 v[136:137], v48 offset:0
  ds_read_b64_tr_b16 v[138:139], v48 offset:512
  ds_read_b64_tr_b16 v[140:141], v48 offset:8192
  ds_read_b64_tr_b16 v[142:143], v48 offset:8704
  ds_read_b64_tr_b16 v[128:129], v49 offset:0
  ds_read_b64_tr_b16 v[130:131], v49 offset:512
  ds_read_b64_tr_b16 v[132:133], v49 offset:8192
  ds_read_b64_tr_b16 v[134:135], v49 offset:8704
  s_branch L_wr_0_e
L_wr_0_2:
  s_cmp_lg_u32 s44, 2
  s_cbranch_scc1 L_wr_0_3
  ds_read_b64_tr_b16 v[144:145], v48 offset:0
  ds_read_b64_tr_b16 v[146:147], v48 offset:512
  ds_read_b64_tr_b16 v[148:149], v48 offset:8192
  ds_read_b64_tr_b16 v[150:151], v48 offset:8704
  ds_read_b64_tr_b16 v[152:153], v49 offset:0
  ds_read_b64_tr_b16 v[154:155], v49 offset:512
  ds_read_b64_tr_b16 v[156:157], v49 offset:8192
  ds_read_b64_tr_b16 v[158:159], v49 offset:8704
  s_branch L_wr_0_e
L_wr_0_3:
  ds_read_b64_tr_b16 v[152:153], v48 offset:0
  ds_read_b64_tr_b16 v[154:155], v48 offset:512
  ds_read_b64_tr_b16 v[156:157], v48 offset:8192
  ds_read_b64_tr_b16 v[158:159], v48 offset:8704
  ds_read_b64_tr_b16 v[144:145], v49 offset:0
  ds_read_b64_tr_b16 v[146:147], v49 offset:512
  ds_read_b64_tr_b16 v[148:149], v49 offset:8192
  ds_read_b64_tr_b16 v[150:151], v49 offset:8704
L_wr_0_e:
  s_waitcnt lgkmcnt(0)
  s_waitcnt vmcnt(8)
  s_barrier
  s_add_u32 m0, s56, 65536
  s_mov_b32 s68, 512
  buffer_load_dwordx4 v45, s[48:51], s68 offen  lds
  s_add_u32 m0, s56, 69632
  s_mov_b32 s68, 4608
  buffer_load_dwordx4 v45, s[48:51], s68 offen  lds
  s_add_u32 m0, s56, 73728
  s_mov_b32 s68, 8704
  buffer_load_dwordx4 v45, s[48:51], s68 offen  lds
  s_add_u32 m0, s56, 77824
  s_mov_b32 s68, 12800
  buffer_load_dwordx4 v45, s[48:51], s68 offen  lds
  v_add_u32 v48, 16384, v50
  v_add_u32 v49, 16384, v51
  s_cmp_lg_u32 s44, 0
  s_cbranch_scc1 L_wr_1_1
  ds_read_b64_tr_b16 v[144:145], v48 offset:0
  ds_read_b64_tr_b16 v[146:147], v48 offset:512
  ds_read_b64_tr_b16 v[148:149], v48 offset:8192
  ds_read_b64_tr_b16 v[150:151], v48 offset:8704
  ds_read_b64_tr_b16 v[152:153], v49 offset:0
  ds_read_b64_tr_b16 v[154:155], v49 offset:512
  ds_read_b64_tr_b16 v[156:157], v49 offset:8192
  ds_read_b64_tr_b16 v[158:159], v49 offset:8704
  s_branch L_wr_1_e
L_wr_1_1:
  s_cmp_lg_u32 s44, 1
  s_cbranch_scc1 L_wr_1_2
  ds_read_b64_tr_b16 v[152:153], v48 offset:0
  ds_read_b64_tr_b16 v[154:155], v48 offset:512
  ds_read_b64_tr_b16 v[156:157], v48 offset:8192
  ds_read_b64_tr_b16 v[158:159], v48 offset:8704
  ds_read_b64_tr_b16 v[144:145], v49 offset:0
  ds_read_b64_tr_b16 v[146:147], v49 offset:512
  ds_read_b64_tr_b16 v[148:149], v49 offset:8192
  ds_read_b64_tr_b16 v[150:151], v49 offset:8704
  s_branch L_wr_1_e
L_wr_1_2:
  s_cmp_lg_u32 s44, 2
  s_cbranch_scc1 L_wr_1_3
  ds_read_b64_tr_b16 v[128:129], v48 offset:0
  ds_read_b64_tr_b16 v[130:131], v48 offset:512
  ds_read_b64_tr_b16 v[132:133], v48 offset:8192
  ds_read_b64_tr_b16 v[134:135], v48 offset:8704
  ds_read_b64_tr_b16 v[136:137], v49 offset:0
  ds_read_b64_tr_b16 v[138:139], v49 offset:512
  ds_read_b64_tr_b16 v[140:141], v49 offset:8192
  ds_read_b64_tr_b16 v[142:143], v49 offset:8704
  s_branch L_wr_1_e
L_wr_1_3:
  ds_read_b64_tr_b16 v[136:137], v48 offset:0
  ds_read_b64_tr_b16 v[138:139], v48 offset:512
  ds_read_b64_tr_b16 v[140:141], v48 offset:8192
  ds_read_b64_tr_b16 v[142:143], v48 offset:8704
  ds_read_b64_tr_b16 v[128:129], v49 offset:0
  ds_read_b64_tr_b16 v[130:131], v49 offset:512
  ds_read_b64_tr_b16 v[132:133], v49 offset:8192
  ds_read_b64_tr_b16 v[134:135], v49 offset:8704
L_wr_1_e:
  s_waitcnt lgkmcnt(0)
  s_waitcnt vmcnt(8)
  s_barrier
  s_lshl_b32 s68, s46, 3
  s_lshl_b64 s[4:5], 1, s68
  v_mov_b64 v[22:23], s[4:5]
  s_cmp_eq_u32 s44, 0
  s_cselect_b32 s69, 0, 0x40000000
  s_mov_b64 exec, 1
  buffer_atomic_add_x2 v[22:23], v17, s[52:55], s69 offen
  s_mov_b64 exec, -1
  s_add_u32 m0, s56, 81920
  s_mov_b32 s68, 66048
  buffer_load_dwordx4 v45, s[48:51], s68 offen  lds
  s_add_u32 m0, s56, 86016
  s_mov_b32 s68, 70144
  buffer_load_dwordx4 v45, s[48:51], s68 offen  lds
  s_add_u32 m0, s56, 90112
  s_mov_b32 s68, 74240
  buffer_load_dwordx4 v45, s[48:51], s68 offen  lds
  s_add_u32 m0, s56, 94208
  s_mov_b32 s68, 78336
  buffer_load_dwordx4 v45, s[48:51], s68 offen  lds
  v_add_u32 v48, 32768, v50
  v_add_u32 v49, 32768, v51
  s_cmp_lg_u32 s44, 0
  s_cbranch_scc1 L_wr_2_1
  ds_read_b64_tr_b16 v[160:161], v48 offset:0
  ds_read_b64_tr_b16 v[162:163], v48 offset:512
  ds_read_b64_tr_b16 v[164:165], v48 offset:8192
  ds_read_b64_tr_b16 v[166:167], v48 offset:8704
  ds_read_b64_tr_b16 v[168:169], v49 offset:0
  ds_read_b64_tr_b16 v[170:171], v49 offset:512
  ds_read_b64_tr_b16 v[172:173], v49 offset:8192
  ds_read_b64_tr_b16 v[174:175], v49 offset:8704
  s_branch L_wr_2_e
L_wr_2_1:
  s_cmp_lg_u32 s44, 1
  s_cbranch_scc1 L_wr_2_2
  ds_read_b64_tr_b16 v[168:169], v48 offset:0
  ds_read_b64_tr_b16 v[170:171], v48 offset:512
  ds_read_b64_tr_b16 v[172:173], v48 offset:8192
  ds_read_b64_tr_b16 v[174:175], v48 offset:8704
  ds_read_b64_tr_b16 v[160:161], v49 offset:0
  ds_read_b64_tr_b16 v[162:163], v49 offset:512
  ds_read_b64_tr_b16 v[164:165], v49 offset:8192
  ds_read_b64_tr_b16 v[166:167], v49 offset:8704
  s_branch L_wr_2_e
L_wr_2_2:
  s_cmp_lg_u32 s44, 2
  s_cbranch_scc1 L_wr_2_3
  ds_read_b64_tr_b16 v[176:177], v48 offset:0
  ds_read_b64_tr_b16 v[178:179], v48 offset:512
  ds_read_b64_tr_b16 v[180:181], v48 offset:8192
  ds_read_b64_tr_b16 v[182:183], v48 offset:8704
  ds_read_b64_tr_b16 v[184:185], v49 offset:0
  ds_read_b64_tr_b16 v[186:187], v49 offset:512
  ds_read_b64_tr_b16 v[188:189], v49 offset:8192
  ds_read_b64_tr_b16 v[190:191], v49 offset:8704
  s_branch L_wr_2_e
L_wr_2_3:
  ds_read_b64_tr_b16 v[184:185], v48 offset:0
  ds_read_b64_tr_b16 v[186:187], v48 offset:512
  ds_read_b64_tr_b16 v[188:189], v48 offset:8192
  ds_read_b64_tr_b16 v[190:191], v48 offset:8704
  ds_read_b64_tr_b16 v[176:177], v49 offset:0
  ds_read_b64_tr_b16 v[178:179], v49 offset:512
  ds_read_b64_tr_b16 v[180:181], v49 offset:8192
  ds_read_b64_tr_b16 v[182:183], v49 offset:8704
L_wr_2_e:
  s_waitcnt lgkmcnt(0)
  s_waitcnt vmcnt(8)
  s_barrier
  v_and_b32 v22, 1, v0
  v_cmp_eq_u32 vcc, 1, v22
  v_mov_b32 v23, 0x44444444
  v_mov_b32 v24, 0xeeeeeeee
  v_cndmask_b32 v1, v23, v24, vcc
  v_lshlrev_b32 v0, 4, v0
  v_add_u32 v0, 147456, v0
  s_mov_b32 s68, 0x05040100
  s_mov_b32 s69, 0x07060302
  v_perm_b32 v20, v94, v92, s68
  v_perm_b32 v21, v94, v92, s69
  v_perm_b32 v22, v95, v93, s68
  v_perm_b32 v23, v95, v93, s69
  v_min_u32 v20, -2, v20
  v_min_u32 v21, -2, v21
  v_min_u32 v22, -2, v22
  v_min_u32 v23, -2, v23
  v_perm_b32 v24, v98, v96, s68
  v_perm_b32 v25, v98, v96, s69
  v_perm_b32 v26, v99, v97, s68
  v_perm_b32 v27, v99, v97, s69
  v_min_u32 v24, -2, v24
  v_min_u32 v25, -2, v25
  v_min_u32 v26, -2, v26
  v_min_u32 v27, -2, v27
  s_add_u32 m0, s56, 98304
  s_mov_b32 s68, 768
  buffer_load_dwordx4 v45, s[48:51], s68 offen  lds
  s_add_u32 m0, s56, 102400
  s_mov_b32 s68, 4864
  buffer_load_dwordx4 v45, s[48:51], s68 offen  lds
  s_add_u32 m0, s56, 106496
  s_mov_b32 s68, 8960
  buffer_load_dwordx4 v45, s[48:51], s68 offen  lds
  s_add_u32 m0, s56, 110592
  s_mov_b32 s68, 13056
  buffer_load_dwordx4 v45, s[48:51], s68 offen  lds
  v_add_u32 v48, 49152, v50
  v_add_u32 v49, 49152, v51
  s_cmp_lg_u32 s44, 0
  s_cbranch_scc1 L_wr_3_1
  ds_read_b64_tr_b16 v[176:177], v48 offset:0
  ds_read_b64_tr_b16 v[178:179], v48 offset:512
  ds_read_b64_tr_b16 v[180:181], v48 offset:8192
  ds_read_b64_tr_b16 v[182:183], v48 offset:8704
  ds_read_b64_tr_b16 v[184:185], v49 offset:0
  ds_read_b64_tr_b16 v[186:187], v49 offset:512
  ds_read_b64_tr_b16 v[188:189], v49 offset:8192
  ds_read_b64_tr_b16 v[190:191], v49 offset:8704
  s_branch L_wr_3_e
L_wr_3_1:
  s_cmp_lg_u32 s44, 1
  s_cbranch_scc1 L_wr_3_2
  ds_read_b64_tr_b16 v[184:185], v48 offset:0
  ds_read_b64_tr_b16 v[186:187], v48 offset:512
  ds_read_b64_tr_b16 v[188:189], v48 offset:8192
  ds_read_b64_tr_b16 v[190:191], v48 offset:8704
  ds_read_b64_tr_b16 v[176:177], v49 offset:0
  ds_read_b64_tr_b16 v[178:179], v49 offset:512
  ds_read_b64_tr_b16 v[180:181], v49 offset:8192
  ds_read_b64_tr_b16 v[182:183], v49 offset:8704
  s_branch L_wr_3_e
L_wr_3_2:
  s_cmp_lg_u32 s44, 2
  s_cbranch_scc1 L_wr_3_3
  ds_read_b64_tr_b16 v[160:161], v48 offset:0
  ds_read_b64_tr_b16 v[162:163], v48 offset:512
  ds_read_b64_tr_b16 v[164:165], v48 offset:8192
  ds_read_b64_tr_b16 v[166:167], v48 offset:8704
  ds_read_b64_tr_b16 v[168:169], v49 offset:0
  ds_read_b64_tr_b16 v[170:171], v49 offset:512
  ds_read_b64_tr_b16 v[172:173], v49 offset:8192
  ds_read_b64_tr_b16 v[174:175], v49 offset:8704
  s_branch L_wr_3_e
L_wr_3_3:
  ds_read_b64_tr_b16 v[168:169], v48 offset:0
  ds_read_b64_tr_b16 v[170:171], v48 offset:512
  ds_read_b64_tr_b16 v[172:173], v48 offset:8192
  ds_read_b64_tr_b16 v[174:175], v48 offset:8704
  ds_read_b64_tr_b16 v[160:161], v49 offset:0
  ds_read_b64_tr_b16 v[162:163], v49 offset:512
  ds_read_b64_tr_b16 v[164:165], v49 offset:8192
  ds_read_b64_tr_b16 v[166:167], v49 offset:8704
L_wr_3_e:
  s_waitcnt lgkmcnt(0)
  s_waitcnt vmcnt(8)
  s_barrier
  s_add_u32 m0, s56, 114688
  s_mov_b32 s68, 66304
  buffer_load_dwordx4 v45, s[48:51], s68 offen  lds
  s_add_u32 m0, s56, 118784
  s_mov_b32 s68, 70400
  buffer_load_dwordx4 v45, s[48:51], s68 offen  lds
  s_add_u32 m0, s56, 122880
  s_mov_b32 s68, 74496
  buffer_load_dwordx4 v45, s[48:51], s68 offen  lds
  s_add_u32 m0, s56, 126976
  s_mov_b32 s68, 78592
  buffer_load_dwordx4 v45, s[48:51], s68 offen  lds
  v_add_u32 v48, 65536, v50
  v_add_u32 v49, 65536, v51
  s_cmp_lg_u32 s44, 0
  s_cbranch_scc1 L_wr_4_1
  ds_read_b64_tr_b16 v[192:193], v48 offset:0
  ds_read_b64_tr_b16 v[194:195], v48 offset:512
  ds_read_b64_tr_b16 v[196:197], v48 offset:8192
  ds_read_b64_tr_b16 v[198:199], v48 offset:8704
  ds_read_b64_tr_b16 v[200:201], v49 offset:0
  ds_read_b64_tr_b16 v[202:203], v49 offset:512
  ds_read_b64_tr_b16 v[204:205], v49 offset:8192
  ds_read_b64_tr_b16 v[206:207], v49 offset:8704
  s_branch L_wr_4_e
L_wr_4_1:
  s_cmp_lg_u32 s44, 1
  s_cbranch_scc1 L_wr_4_2
  ds_read_b64_tr_b16 v[200:201], v48 offset:0
  ds_read_b64_tr_b16 v[202:203], v48 offset:512
  ds_read_b64_tr_b16 v[204:205], v48 offset:8192
  ds_read_b64_tr_b16 v[206:207], v48 offset:8704
  ds_read_b64_tr_b16 v[192:193], v49 offset:0
  ds_read_b64_tr_b16 v[194:195], v49 offset:512
  ds_read_b64_tr_b16 v[196:197], v49 offset:8192
  ds_read_b64_tr_b16 v[198:199], v49 offset:8704
  s_branch L_wr_4_e
L_wr_4_2:
  s_cmp_lg_u32 s44, 2
  s_cbranch_scc1 L_wr_4_3
  ds_read_b64_tr_b16 v[208:209], v48 offset:0
  ds_read_b64_tr_b16 v[210:211], v48 offset:512
  ds_read_b64_tr_b16 v[212:213], v48 offset:8192
  ds_read_b64_tr_b16 v[214:215], v48 offset:8704
  ds_read_b64_tr_b16 v[216:217], v49 offset:0
  ds_read_b64_tr_b16 v[218:219], v49 offset:512
  ds_read_b64_tr_b16 v[220:221], v49 offset:8192
  ds_read_b64_tr_b16 v[222:223], v49 offset:8704
  s_branch L_wr_4_e
L_wr_4_3:
  ds_read_b64_tr_b16 v[216:217], v48 offset:0
  ds_read_b64_tr_b16 v[218:219], v48 offset:512
  ds_read_b64_tr_b16 v[220:221], v48 offset:8192
  ds_read_b64_tr_b16 v[222:223], v48 offset:8704
  ds_read_b64_tr_b16 v[208:209], v49 offset:0
  ds_read_b64_tr_b16 v[210:211], v49 offset:512
  ds_read_b64_tr_b16 v[212:213], v49 offset:8192
  ds_read_b64_tr_b16 v[214:215], v49 offset:8704
L_wr_4_e:
  s_waitcnt lgkmcnt(0)
  s_waitcnt vmcnt(8)
  s_barrier
  s_mov_b32 s48, s24
  s_and_b32 s49, s25, 0xffff
  s_add_u32 m0, s56, 0
  s_mov_b32 s68, 0
  buffer_load_dwordx4 v44, s[48:51], s68 offen  lds
  s_add_u32 m0, s56, 4096
  s_mov_b32 s68, 65536
  buffer_load_dwordx4 v44, s[48:51], s68 offen  lds
  s_add_u32 m0, s56, 8192
  s_mov_b32 s68, 262144
  buffer_load_dwordx4 v44, s[48:51], s68 offen  lds
  s_add_u32 m0, s56, 12288
  s_mov_b32 s68, 327680
  buffer_load_dwordx4 v44, s[48:51], s68 offen  lds
  v_add_u32 v48, 81920, v50
  v_add_u32 v49, 81920, v51
  s_cmp_lg_u32 s44, 0
  s_cbranch_scc1 L_wr_5_1
  ds_read_b64_tr_b16 v[208:209], v48 offset:0
  ds_read_b64_tr_b16 v[210:211], v48 offset:512
  ds_read_b64_tr_b16 v[212:213], v48 offset:8192
  ds_read_b64_tr_b16 v[214:215], v48 offset:8704
  ds_read_b64_tr_b16 v[216:217], v49 offset:0
  ds_read_b64_tr_b16 v[218:219], v49 offset:512
  ds_read_b64_tr_b16 v[220:221], v49 offset:8192
  ds_read_b64_tr_b16 v[222:223], v49 offset:8704
  s_branch L_wr_5_e
L_wr_5_1:
  s_cmp_lg_u32 s44, 1
  s_cbranch_scc1 L_wr_5_2
  ds_read_b64_tr_b16 v[216:217], v48 offset:0
  ds_read_b64_tr_b16 v[218:219], v48 offset:512
  ds_read_b64_tr_b16 v[220:221], v48 offset:8192
  ds_read_b64_tr_b16 v[222:223], v48 offset:8704
  ds_read_b64_tr_b16 v[208:209], v49 offset:0
  ds_read_b64_tr_b16 v[210:211], v49 offset:512
  ds_read_b64_tr_b16 v[212:213], v49 offset:8192
  ds_read_b64_tr_b16 v[214:215], v49 offset:8704
  s_branch L_wr_5_e
L_wr_5_2:
  s_cmp_lg_u32 s44, 2
  s_cbranch_scc1 L_wr_5_3
  ds_read_b64_tr_b16 v[192:193], v48 offset:0
  ds_read_b64_tr_b16 v[194:195], v48 offset:512
  ds_read_b64_tr_b16 v[196:197], v48 offset:8192
  ds_read_b64_tr_b16 v[198:199], v48 offset:8704
  ds_read_b64_tr_b16 v[200:201], v49 offset:0
  ds_read_b64_tr_b16 v[202:203], v49 offset:512
  ds_read_b64_tr_b16 v[204:205], v49 offset:8192
  ds_read_b64_tr_b16 v[206:207], v49 offset:8704
  s_branch L_wr_5_e
L_wr_5_3:
  ds_read_b64_tr_b16 v[200:201], v48 offset:0
  ds_read_b64_tr_b16 v[202:203], v48 offset:512
  ds_read_b64_tr_b16 v[204:205], v48 offset:8192
  ds_read_b64_tr_b16 v[206:207], v48 offset:8704
  ds_read_b64_tr_b16 v[192:193], v49 offset:0
  ds_read_b64_tr_b16 v[194:195], v49 offset:512
  ds_read_b64_tr_b16 v[196:197], v49 offset:8192
  ds_read_b64_tr_b16 v[198:199], v49 offset:8704
L_wr_5_e:
  s_waitcnt lgkmcnt(0)
  s_waitcnt vmcnt(8)
  s_barrier
  s_add_u32 m0, s56, 16384
  s_mov_b32 s68, 524288
  buffer_load_dwordx4 v44, s[48:51], s68 offen  lds
  s_add_u32 m0, s56, 20480
  s_mov_b32 s68, 589824
  buffer_load_dwordx4 v44, s[48:51], s68 offen  lds
  s_add_u32 m0, s56, 24576
  s_mov_b32 s68, 786432
  buffer_load_dwordx4 v44, s[48:51], s68 offen  lds
  s_add_u32 m0, s56, 28672
  s_mov_b32 s68, 851968
  buffer_load_dwordx4 v44, s[48:51], s68 offen  lds
  v_add_u32 v48, 98304, v50
  v_add_u32 v49, 98304, v51
  s_cmp_lg_u32 s44, 0
  s_cbranch_scc1 L_wr_6_1
  ds_read_b64_tr_b16 v[224:225], v48 offset:0
  ds_read_b64_tr_b16 v[226:227], v48 offset:512
  ds_read_b64_tr_b16 v[228:229], v48 offset:8192
  ds_read_b64_tr_b16 v[230:231], v48 offset:8704
  ds_read_b64_tr_b16 v[232:233], v49 offset:0
  ds_read_b64_tr_b16 v[234:235], v49 offset:512
  ds_read_b64_tr_b16 v[236:237], v49 offset:8192
  ds_read_b64_tr_b16 v[238:239], v49 offset:8704
  s_branch L_wr_6_e
L_wr_6_1:
  s_cmp_lg_u32 s44, 1
  s_cbranch_scc1 L_wr_6_2
  ds_read_b64_tr_b16 v[232:233], v48 offset:0
  ds_read_b64_tr_b16 v[234:235], v48 offset:512
  ds_read_b64_tr_b16 v[236:237], v48 offset:8192
  ds_read_b64_tr_b16 v[238:239], v48 offset:8704
  ds_read_b64_tr_b16 v[224:225], v49 offset:0
  ds_read_b64_tr_b16 v[226:227], v49 offset:512
  ds_read_b64_tr_b16 v[228:229], v49 offset:8192
  ds_read_b64_tr_b16 v[230:231], v49 offset:8704
  s_branch L_wr_6_e
L_wr_6_2:
  s_cmp_lg_u32 s44, 2
  s_cbranch_scc1 L_wr_6_3
  ds_read_b64_tr_b16 v[240:241], v48 offset:0
  ds_read_b64_tr_b16 v[242:243], v48 offset:512
  ds_read_b64_tr_b16 v[244:245], v48 offset:8192
  ds_read_b64_tr_b16 v[246:247], v48 offset:8704
  ds_read_b64_tr_b16 v[248:249], v49 offset:0
  ds_read_b64_tr_b16 v[250:251], v49 offset:512
  ds_read_b64_tr_b16 v[252:253], v49 offset:8192
  ds_read_b64_tr_b16 v[254:255], v49 offset:8704
  s_branch L_wr_6_e
L_wr_6_3:
  ds_read_b64_tr_b16 v[248:249], v48 offset:0
  ds_read_b64_tr_b16 v[250:251], v48 offset:512
  ds_read_b64_tr_b16 v[252:253], v48 offset:8192
  ds_read_b64_tr_b16 v[254:255], v48 offset:8704
  ds_read_b64_tr_b16 v[240:241], v49 offset:0
  ds_read_b64_tr_b16 v[242:243], v49 offset:512
  ds_read_b64_tr_b16 v[244:245], v49 offset:8192
  ds_read_b64_tr_b16 v[246:247], v49 offset:8704
L_wr_6_e:
  s_waitcnt lgkmcnt(0)
  s_waitcnt vmcnt(8)
  s_barrier
  s_add_u32 m0, s56, 32768
  s_mov_b32 s68, 1048576
  buffer_load_dwordx4 v44, s[48:51], s68 offen  lds
  s_add_u32 m0, s56, 36864
  s_mov_b32 s68, 1114112
  buffer_load_dwordx4 v44, s[48:51], s68 offen  lds
  s_add_u32 m0, s56, 40960
  s_mov_b32 s68, 1310720
  buffer_load_dwordx4 v44, s[48:51], s68 offen  lds
  s_add_u32 m0, s56, 45056
  s_mov_b32 s68, 1376256
  buffer_load_dwordx4 v44, s[48:51], s68 offen  lds
  v_add_u32 v48, 114688, v50
  v_add_u32 v49, 114688, v51
  s_cmp_lg_u32 s44, 0
  s_cbranch_scc1 L_wr_7_1
  ds_read_b64_tr_b16 v[240:241], v48 offset:0
  ds_read_b64_tr_b16 v[242:243], v48 offset:512
  ds_read_b64_tr_b16 v[244:245], v48 offset:8192
  ds_read_b64_tr_b16 v[246:247], v48 offset:8704
  ds_read_b64_tr_b16 v[248:249], v49 offset:0
  ds_read_b64_tr_b16 v[250:251], v49 offset:512
  ds_read_b64_tr_b16 v[252:253], v49 offset:8192
  ds_read_b64_tr_b16 v[254:255], v49 offset:8704
  s_branch L_wr_7_e
L_wr_7_1:
  s_cmp_lg_u32 s44, 1
  s_cbranch_scc1 L_wr_7_2
  ds_read_b64_tr_b16 v[248:249], v48 offset:0
  ds_read_b64_tr_b16 v[250:251], v48 offset:512
  ds_read_b64_tr_b16 v[252:253], v48 offset:8192
  ds_read_b64_tr_b16 v[254:255], v48 offset:8704
  ds_read_b64_tr_b16 v[240:241], v49 offset:0
  ds_read_b64_tr_b16 v[242:243], v49 offset:512
  ds_read_b64_tr_b16 v[244:245], v49 offset:8192
  ds_read_b64_tr_b16 v[246:247], v49 offset:8704
  s_branch L_wr_7_e
L_wr_7_2:
  s_cmp_lg_u32 s44, 2
  s_cbranch_scc1 L_wr_7_3
  ds_read_b64_tr_b16 v[224:225], v48 offset:0
  ds_read_b64_tr_b16 v[226:227], v48 offset:512
  ds_read_b64_tr_b16 v[228:229], v48 offset:8192
  ds_read_b64_tr_b16 v[230:231], v48 offset:8704
  ds_read_b64_tr_b16 v[232:233], v49 offset:0
  ds_read_b64_tr_b16 v[234:235], v49 offset:512
  ds_read_b64_tr_b16 v[236:237], v49 offset:8192
  ds_read_b64_tr_b16 v[238:239], v49 offset:8704
  s_branch L_wr_7_e
L_wr_7_3:
  ds_read_b64_tr_b16 v[232:233], v48 offset:0
  ds_read_b64_tr_b16 v[234:235], v48 offset:512
  ds_read_b64_tr_b16 v[236:237], v48 offset:8192
  ds_read_b64_tr_b16 v[238:239], v48 offset:8704
  ds_read_b64_tr_b16 v[224:225], v49 offset:0
  ds_read_b64_tr_b16 v[226:227], v49 offset:512
  ds_read_b64_tr_b16 v[228:229], v49 offset:8192
  ds_read_b64_tr_b16 v[230:231], v49 offset:8704
L_wr_7_e:
  s_waitcnt lgkmcnt(0)
  s_waitcnt vmcnt(8)
  s_barrier
  s_add_u32 m0, s56, 49152
  s_mov_b32 s68, 1572864
  buffer_load_dwordx4 v44, s[48:51], s68 offen  lds
  s_add_u32 m0, s56, 53248
  s_mov_b32 s68, 1638400
  buffer_load_dwordx4 v44, s[48:51], s68 offen  lds
  s_add_u32 m0, s56, 57344
  s_mov_b32 s68, 1835008
  buffer_load_dwordx4 v44, s[48:51], s68 offen  lds
  s_add_u32 m0, s56, 61440
  s_mov_b32 s68, 1900544
  buffer_load_dwordx4 v44, s[48:51], s68 offen  lds
  v_add_u32 v48, 0, v46
  v_add_u32 v49, 0, v47
  s_cmp_lg_u32 s44, 0
  s_cbranch_scc1 L_wr_8_1
  ds_read_b64_tr_b16 a[0:1], v48 offset:0
  ds_read_b64_tr_b16 a[2:3], v48 offset:512
  ds_read_b64_tr_b16 a[4:5], v48 offset:8192
  ds_read_b64_tr_b16 a[6:7], v48 offset:8704
  ds_read_b64_tr_b16 a[64:65], v49 offset:0
  ds_read_b64_tr_b16 a[66:67], v49 offset:512
  ds_read_b64_tr_b16 a[68:69], v49 offset:8192
  ds_read_b64_tr_b16 a[70:71], v49 offset:8704
  s_branch L_wr_8_e
L_wr_8_1:
  s_cmp_lg_u32 s44, 1
  s_cbranch_scc1 L_wr_8_2
  ds_read_b64_tr_b16 a[16:17], v48 offset:0
  ds_read_b64_tr_b16 a[18:19], v48 offset:512
  ds_read_b64_tr_b16 a[20:21], v48 offset:8192
  ds_read_b64_tr_b16 a[22:23], v48 offset:8704
  ds_read_b64_tr_b16 a[80:81], v49 offset:0
  ds_read_b64_tr_b16 a[82:83], v49 offset:512
  ds_read_b64_tr_b16 a[84:85], v49 offset:8192
  ds_read_b64_tr_b16 a[86:87], v49 offset:8704
  s_branch L_wr_8_e
L_wr_8_2:
  s_cmp_lg_u32 s44, 2
  s_cbranch_scc1 L_wr_8_3
  ds_read_b64_tr_b16 a[32:33], v48 offset:0
  ds_read_b64_tr_b16 a[34:35], v48 offset:512
  ds_read_b64_tr_b16 a[36:37], v48 offset:8192
  ds_read_b64_tr_b16 a[38:39], v48 offset:8704
  ds_read_b64_tr_b16 a[96:97], v49 offset:0
  ds_read_b64_tr_b16 a[98:99], v49 offset:512
  ds_read_b64_tr_b16 a[100:101], v49 offset:8192
  ds_read_b64_tr_b16 a[102:103], v49 offset:8704
  s_branch L_wr_8_e
L_wr_8_3:
  ds_read_b64_tr_b16 a[48:49], v48 offset:0
  ds_read_b64_tr_b16 a[50:51], v48 offset:512
  ds_read_b64_tr_b16 a[52:53], v48 offset:8192
  ds_read_b64_tr_b16 a[54:55], v48 offset:8704
  ds_read_b64_tr_b16 a[112:113], v49 offset:0
  ds_read_b64_tr_b16 a[114:115], v49 offset:512
  ds_read_b64_tr_b16 a[116:117], v49 offset:8192
  ds_read_b64_tr_b16 a[118:119], v49 offset:8704
L_wr_8_e:
  s_waitcnt lgkmcnt(0)
  s_waitcnt vmcnt(8)
  s_barrier
  s_add_u32 m0, s56, 65536
  s_mov_b32 s68, 2097152
  buffer_load_dwordx4 v44, s[48:51], s68 offen  lds
  s_add_u32 m0, s56, 69632
  s_mov_b32 s68, 2162688
  buffer_load_dwordx4 v44, s[48:51], s68 offen  lds
  s_add_u32 m0, s56, 73728
  s_mov_b32 s68, 2359296
  buffer_load_dwordx4 v44, s[48:51], s68 offen  lds
  s_add_u32 m0, s56, 77824
  s_mov_b32 s68, 2424832
  buffer_load_dwordx4 v44, s[48:51], s68 offen  lds
  v_add_u32 v48, 16384, v46
  v_add_u32 v49, 16384, v47
  s_cmp_lg_u32 s44, 0
  s_cbranch_scc1 L_wr_9_1
  ds_read_b64_tr_b16 a[8:9], v48 offset:0
  ds_read_b64_tr_b16 a[10:11], v48 offset:512
  ds_read_b64_tr_b16 a[12:13], v48 offset:8192
  ds_read_b64_tr_b16 a[14:15], v48 offset:8704
  ds_read_b64_tr_b16 a[72:73], v49 offset:0
  ds_read_b64_tr_b16 a[74:75], v49 offset:512
  ds_read_b64_tr_b16 a[76:77], v49 offset:8192
  ds_read_b64_tr_b16 a[78:79], v49 offset:8704
  s_branch L_wr_9_e
L_wr_9_1:
  s_cmp_lg_u32 s44, 1
  s_cbranch_scc1 L_wr_9_2
  ds_read_b64_tr_b16 a[24:25], v48 offset:0
  ds_read_b64_tr_b16 a[26:27], v48 offset:512
  ds_read_b64_tr_b16 a[28:29], v48 offset:8192
  ds_read_b64_tr_b16 a[30:31], v48 offset:8704
  ds_read_b64_tr_b16 a[88:89], v49 offset:0
  ds_read_b64_tr_b16 a[90:91], v49 offset:512
  ds_read_b64_tr_b16 a[92:93], v49 offset:8192
  ds_read_b64_tr_b16 a[94:95], v49 offset:8704
  s_branch L_wr_9_e
L_wr_9_2:
  s_cmp_lg_u32 s44, 2
  s_cbranch_scc1 L_wr_9_3
  ds_read_b64_tr_b16 a[40:41], v48 offset:0
  ds_read_b64_tr_b16 a[42:43], v48 offset:512
  ds_read_b64_tr_b16 a[44:45], v48 offset:8192
  ds_read_b64_tr_b16 a[46:47], v48 offset:8704
  ds_read_b64_tr_b16 a[104:105], v49 offset:0
  ds_read_b64_tr_b16 a[106:107], v49 offset:512
  ds_read_b64_tr_b16 a[108:109], v49 offset:8192
  ds_read_b64_tr_b16 a[110:111], v49 offset:8704
  s_branch L_wr_9_e
L_wr_9_3:
  ds_read_b64_tr_b16 a[56:57], v48 offset:0
  ds_read_b64_tr_b16 a[58:59], v48 offset:512
  ds_read_b64_tr_b16 a[60:61], v48 offset:8192
  ds_read_b64_tr_b16 a[62:63], v48 offset:8704
  ds_read_b64_tr_b16 a[120:121], v49 offset:0
  ds_read_b64_tr_b16 a[122:123], v49 offset:512
  ds_read_b64_tr_b16 a[124:125], v49 offset:8192
  ds_read_b64_tr_b16 a[126:127], v49 offset:8704
L_wr_9_e:
  s_waitcnt lgkmcnt(0)
  s_waitcnt vmcnt(8)
  s_barrier
  s_add_u32 m0, s56, 81920
  s_mov_b32 s68, 2621440
  buffer_load_dwordx4 v44, s[48:51], s68 offen  lds
  s_add_u32 m0, s56, 86016
  s_mov_b32 s68, 2686976
  buffer_load_dwordx4 v44, s[48:51], s68 offen  lds
  s_add_u32 m0, s56, 90112
  s_mov_b32 s68, 2883584
  buffer_load_dwordx4 v44, s[48:51], s68 offen  lds
  s_add_u32 m0, s56, 94208
  s_mov_b32 s68, 2949120
  buffer_load_dwordx4 v44, s[48:51], s68 offen  lds
  v_add_u32 v48, 32768, v46
  v_add_u32 v49, 32768, v47
  s_cmp_lg_u32 s44, 0
  s_cbranch_scc1 L_wr_10_1
  ds_read_b64_tr_b16 a[16:17], v48 offset:0
  ds_read_b64_tr_b16 a[18:19], v48 offset:512
  ds_read_b64_tr_b16 a[20:21], v48 offset:8192
  ds_read_b64_tr_b16 a[22:23], v48 offset:8704
  ds_read_b64_tr_b16 a[80:81], v49 offset:0
  ds_read_b64_tr_b16 a[82:83], v49 offset:512
  ds_read_b64_tr_b16 a[84:85], v49 offset:8192
  ds_read_b64_tr_b16 a[86:87], v49 offset:8704
  s_branch L_wr_10_e
L_wr_10_1:
  s_cmp_lg_u32 s44, 1
  s_cbranch_scc1 L_wr_10_2
  ds_read_b64_tr_b16 a[0:1], v48 offset:0
  ds_read_b64_tr_b16 a[2:3], v48 offset:512
  ds_read_b64_tr_b16 a[4:5], v48 offset:8192
  ds_read_b64_tr_b16 a[6:7], v48 offset:8704
  ds_read_b64_tr_b16 a[64:65], v49 offset:0
  ds_read_b64_tr_b16 a[66:67], v49 offset:512
  ds_read_b64_tr_b16 a[68:69], v49 offset:8192
  ds_read_b64_tr_b16 a[70:71], v49 offset:8704
  s_branch L_wr_10_e
L_wr_10_2:
  s_cmp_lg_u32 s44, 2
  s_cbranch_scc1 L_wr_10_3
  ds_read_b64_tr_b16 a[48:49], v48 offset:0
  ds_read_b64_tr_b16 a[50:51], v48 offset:512
  ds_read_b64_tr_b16 a[52:53], v48 offset:8192
  ds_read_b64_tr_b16 a[54:55], v48 offset:8704
  ds_read_b64_tr_b16 a[112:113], v49 offset:0
  ds_read_b64_tr_b16 a[114:115], v49 offset:512
  ds_read_b64_tr_b16 a[116:117], v49 offset:8192
  ds_read_b64_tr_b16 a[118:119], v49 offset:8704
  s_branch L_wr_10_e
L_wr_10_3:
  ds_read_b64_tr_b16 a[32:33], v48 offset:0
  ds_read_b64_tr_b16 a[34:35], v48 offset:512
  ds_read_b64_tr_b16 a[36:37], v48 offset:8192
  ds_read_b64_tr_b16 a[38:39], v48 offset:8704
  ds_read_b64_tr_b16 a[96:97], v49 offset:0
  ds_read_b64_tr_b16 a[98:99], v49 offset:512
  ds_read_b64_tr_b16 a[100:101], v49 offset:8192
  ds_read_b64_tr_b16 a[102:103], v49 offset:8704
L_wr_10_e:
  s_waitcnt lgkmcnt(0)
  s_waitcnt vmcnt(8)
  s_barrier
  s_add_u32 m0, s56, 98304
  s_mov_b32 s68, 3145728
  buffer_load_dwordx4 v44, s[48:51], s68 offen  lds
  s_add_u32 m0, s56, 102400
  s_mov_b32 s68, 3211264
  buffer_load_dwordx4 v44, s[48:51], s68 offen  lds
  s_add_u32 m0, s56, 106496
  s_mov_b32 s68, 3407872
  buffer_load_dwordx4 v44, s[48:51], s68 offen  lds
  s_add_u32 m0, s56, 110592
  s_mov_b32 s68, 3473408
  buffer_load_dwordx4 v44, s[48:51], s68 offen  lds
  v_add_u32 v48, 49152, v46
  v_add_u32 v49, 49152, v47
  s_cmp_lg_u32 s44, 0
  s_cbranch_scc1 L_wr_11_1
  ds_read_b64_tr_b16 a[24:25], v48 offset:0
  ds_read_b64_tr_b16 a[26:27], v48 offset:512
  ds_read_b64_tr_b16 a[28:29], v48 offset:8192
  ds_read_b64_tr_b16 a[30:31], v48 offset:8704
  ds_read_b64_tr_b16 a[88:89], v49 offset:0
  ds_read_b64_tr_b16 a[90:91], v49 offset:512
  ds_read_b64_tr_b16 a[92:93], v49 offset:8192
  ds_read_b64_tr_b16 a[94:95], v49 offset:8704
  s_branch L_wr_11_e
L_wr_11_1:
  s_cmp_lg_u32 s44, 1
  s_cbranch_scc1 L_wr_11_2
  ds_read_b64_tr_b16 a[8:9], v48 offset:0
  ds_read_b64_tr_b16 a[10:11], v48 offset:512
  ds_read_b64_tr_b16 a[12:13], v48 offset:8192
  ds_read_b64_tr_b16 a[14:15], v48 offset:8704
  ds_read_b64_tr_b16 a[72:73], v49 offset:0
  ds_read_b64_tr_b16 a[74:75], v49 offset:512
  ds_read_b64_tr_b16 a[76:77], v49 offset:8192
  ds_read_b64_tr_b16 a[78:79], v49 offset:8704
  s_branch L_wr_11_e
L_wr_11_2:
  s_cmp_lg_u32 s44, 2
  s_cbranch_scc1 L_wr_11_3
  ds_read_b64_tr_b16 a[56:57], v48 offset:0
  ds_read_b64_tr_b16 a[58:59], v48 offset:512
  ds_read_b64_tr_b16 a[60:61], v48 offset:8192
  ds_read_b64_tr_b16 a[62:63], v48 offset:8704
  ds_read_b64_tr_b16 a[120:121], v49 offset:0
  ds_read_b64_tr_b16 a[122:123], v49 offset:512
  ds_read_b64_tr_b16 a[124:125], v49 offset:8192
  ds_read_b64_tr_b16 a[126:127], v49 offset:8704
  s_branch L_wr_11_e
L_wr_11_3:
  ds_read_b64_tr_b16 a[40:41], v48 offset:0
  ds_read_b64_tr_b16 a[42:43], v48 offset:512
  ds_read_b64_tr_b16 a[44:45], v48 offset:8192
  ds_read_b64_tr_b16 a[46:47], v48 offset:8704
  ds_read_b64_tr_b16 a[104:105], v49 offset:0
  ds_read_b64_tr_b16 a[106:107], v49 offset:512
  ds_read_b64_tr_b16 a[108:109], v49 offset:8192
  ds_read_b64_tr_b16 a[110:111], v49 offset:8704
L_wr_11_e:
  s_waitcnt lgkmcnt(0)
  s_waitcnt vmcnt(8)
  s_barrier
  s_add_u32 m0, s56, 114688
  s_mov_b32 s68, 3670016
  buffer_load_dwordx4 v44, s[48:51], s68 offen  lds
  s_add_u32 m0, s56, 118784
  s_mov_b32 s68, 3735552
  buffer_load_dwordx4 v44, s[48:51], s68 offen  lds
  s_add_u32 m0, s56, 122880
  s_mov_b32 s68, 3932160
  buffer_load_dwordx4 v44, s[48:51], s68 offen  lds
  s_add_u32 m0, s56, 126976
  s_mov_b32 s68, 3997696
  buffer_load_dwordx4 v44, s[48:51], s68 offen  lds
  v_add_u32 v48, 65536, v46
  v_add_u32 v49, 65536, v47
  s_cmp_lg_u32 s44, 0
  s_cbranch_scc1 L_wr_12_1
  ds_read_b64_tr_b16 a[32:33], v48 offset:0
  ds_read_b64_tr_b16 a[34:35], v48 offset:512
  ds_read_b64_tr_b16 a[36:37], v48 offset:8192
  ds_read_b64_tr_b16 a[38:39], v48 offset:8704
  ds_read_b64_tr_b16 a[96:97], v49 offset:0
  ds_read_b64_tr_b16 a[98:99], v49 offset:512
  ds_read_b64_tr_b16 a[100:101], v49 offset:8192
  ds_read_b64_tr_b16 a[102:103], v49 offset:8704
  s_branch L_wr_12_e
L_wr_12_1:
  s_cmp_lg_u32 s44, 1
  s_cbranch_scc1 L_wr_12_2
  ds_read_b64_tr_b16 a[48:49], v48 offset:0
  ds_read_b64_tr_b16 a[50:51], v48 offset:512
  ds_read_b64_tr_b16 a[52:53], v48 offset:8192
  ds_read_b64_tr_b16 a[54:55], v48 offset:8704
  ds_read_b64_tr_b16 a[112:113], v49 offset:0
  ds_read_b64_tr_b16 a[114:115], v49 offset:512
  ds_read_b64_tr_b16 a[116:117], v49 offset:8192
  ds_read_b64_tr_b16 a[118:119], v49 offset:8704
  s_branch L_wr_12_e
L_wr_12_2:
  s_cmp_lg_u32 s44, 2
  s_cbranch_scc1 L_wr_12_3
  ds_read_b64_tr_b16 a[0:1], v48 offset:0
  ds_read_b64_tr_b16 a[2:3], v48 offset:512
  ds_read_b64_tr_b16 a[4:5], v48 offset:8192
  ds_read_b64_tr_b16 a[6:7], v48 offset:8704
  ds_read_b64_tr_b16 a[64:65], v49 offset:0
  ds_read_b64_tr_b16 a[66:67], v49 offset:512
  ds_read_b64_tr_b16 a[68:69], v49 offset:8192
  ds_read_b64_tr_b16 a[70:71], v49 offset:8704
  s_branch L_wr_12_e
L_wr_12_3:
  ds_read_b64_tr_b16 a[16:17], v48 offset:0
  ds_read_b64_tr_b16 a[18:19], v48 offset:512
  ds_read_b64_tr_b16 a[20:21], v48 offset:8192
  ds_read_b64_tr_b16 a[22:23], v48 offset:8704
  ds_read_b64_tr_b16 a[80:81], v49 offset:0
  ds_read_b64_tr_b16 a[82:83], v49 offset:512
  ds_read_b64_tr_b16 a[84:85], v49 offset:8192
  ds_read_b64_tr_b16 a[86:87], v49 offset:8704
L_wr_12_e:
  s_waitcnt lgkmcnt(0)
  s_waitcnt vmcnt(8)
  s_barrier
  s_mov_b32 s48, s26
  s_and_b32 s49, s27, 0xffff
  s_add_u32 m0, s56, 0
  s_mov_b32 s68, 0
  buffer_load_dwordx4 v44, s[48:51], s68 offen  lds
  s_add_u32 m0, s56, 4096
  s_mov_b32 s68, 65536
  buffer_load_dwordx4 v44, s[48:51], s68 offen  lds
  s_add_u32 m0, s56, 8192
  s_mov_b32 s68, 262144
  buffer_load_dwordx4 v44, s[48:51], s68 offen  lds
  s_add_u32 m0, s56, 12288
  s_mov_b32 s68, 327680
  buffer_load_dwordx4 v44, s[48:51], s68 offen  lds
  v_add_u32 v48, 81920, v46
  v_add_u32 v49, 81920, v47
  s_cmp_lg_u32 s44, 0
  s_cbranch_scc1 L_wr_13_1
  ds_read_b64_tr_b16 a[40:41], v48 offset:0
  ds_read_b64_tr_b16 a[42:43], v48 offset:512
  ds_read_b64_tr_b16 a[44:45], v48 offset:8192
  ds_read_b64_tr_b16 a[46:47], v48 offset:8704
  ds_read_b64_tr_b16 a[104:105], v49 offset:0
  ds_read_b64_tr_b16 a[106:107], v49 offset:512
  ds_read_b64_tr_b16 a[108:109], v49 offset:8192
  ds_read_b64_tr_b16 a[110:111], v49 offset:8704
  s_branch L_wr_13_e
L_wr_13_1:
  s_cmp_lg_u32 s44, 1
  s_cbranch_scc1 L_wr_13_2
  ds_read_b64_tr_b16 a[56:57], v48 offset:0
  ds_read_b64_tr_b16 a[58:59], v48 offset:512
  ds_read_b64_tr_b16 a[60:61], v48 offset:8192
  ds_read_b64_tr_b16 a[62:63], v48 offset:8704
  ds_read_b64_tr_b16 a[120:121], v49 offset:0
  ds_read_b64_tr_b16 a[122:123], v49 offset:512
  ds_read_b64_tr_b16 a[124:125], v49 offset:8192
  ds_read_b64_tr_b16 a[126:127], v49 offset:8704
  s_branch L_wr_13_e
L_wr_13_2:
  s_cmp_lg_u32 s44, 2
  s_cbranch_scc1 L_wr_13_3
  ds_read_b64_tr_b16 a[8:9], v48 offset:0
  ds_read_b64_tr_b16 a[10:11], v48 offset:512
  ds_read_b64_tr_b16 a[12:13], v48 offset:8192
  ds_read_b64_tr_b16 a[14:15], v48 offset:8704
  ds_read_b64_tr_b16 a[72:73], v49 offset:0
  ds_read_b64_tr_b16 a[74:75], v49 offset:512
  ds_read_b64_tr_b16 a[76:77], v49 offset:8192
  ds_read_b64_tr_b16 a[78:79], v49 offset:8704
  s_branch L_wr_13_e
L_wr_13_3:
  ds_read_b64_tr_b16 a[24:25], v48 offset:0
  ds_read_b64_tr_b16 a[26:27], v48 offset:512
  ds_read_b64_tr_b16 a[28:29], v48 offset:8192
  ds_read_b64_tr_b16 a[30:31], v48 offset:8704
  ds_read_b64_tr_b16 a[88:89], v49 offset:0
  ds_read_b64_tr_b16 a[90:91], v49 offset:512
  ds_read_b64_tr_b16 a[92:93], v49 offset:8192
  ds_read_b64_tr_b16 a[94:95], v49 offset:8704
L_wr_13_e:
  s_waitcnt lgkmcnt(0)
  s_waitcnt vmcnt(8)
  s_barrier
  s_add_u32 m0, s56, 16384
  s_mov_b32 s68, 524288
  buffer_load_dwordx4 v44, s[48:51], s68 offen  lds
  s_add_u32 m0, s56, 20480
  s_mov_b32 s68, 589824
  buffer_load_dwordx4 v44, s[48:51], s68 offen  lds
  s_add_u32 m0, s56, 24576
  s_mov_b32 s68, 786432
  buffer_load_dwordx4 v44, s[48:51], s68 offen  lds
  s_add_u32 m0, s56, 28672
  s_mov_b32 s68, 851968
  buffer_load_dwordx4 v44, s[48:51], s68 offen  lds
  v_add_u32 v48, 98304, v46
  v_add_u32 v49, 98304, v47
  s_cmp_lg_u32 s44, 0
  s_cbranch_scc1 L_wr_14_1
  ds_read_b64_tr_b16 a[48:49], v48 offset:0
  ds_read_b64_tr_b16 a[50:51], v48 offset:512
  ds_read_b64_tr_b16 a[52:53], v48 offset:8192
  ds_read_b64_tr_b16 a[54:55], v48 offset:8704
  ds_read_b64_tr_b16 a[112:113], v49 offset:0
  ds_read_b64_tr_b16 a[114:115], v49 offset:512
  ds_read_b64_tr_b16 a[116:117], v49 offset:8192
  ds_read_b64_tr_b16 a[118:119], v49 offset:8704
  s_branch L_wr_14_e
L_wr_14_1:
  s_cmp_lg_u32 s44, 1
  s_cbranch_scc1 L_wr_14_2
  ds_read_b64_tr_b16 a[32:33], v48 offset:0
  ds_read_b64_tr_b16 a[34:35], v48 offset:512
  ds_read_b64_tr_b16 a[36:37], v48 offset:8192
  ds_read_b64_tr_b16 a[38:39], v48 offset:8704
  ds_read_b64_tr_b16 a[96:97], v49 offset:0
  ds_read_b64_tr_b16 a[98:99], v49 offset:512
  ds_read_b64_tr_b16 a[100:101], v49 offset:8192
  ds_read_b64_tr_b16 a[102:103], v49 offset:8704
  s_branch L_wr_14_e
L_wr_14_2:
  s_cmp_lg_u32 s44, 2
  s_cbranch_scc1 L_wr_14_3
  ds_read_b64_tr_b16 a[16:17], v48 offset:0
  ds_read_b64_tr_b16 a[18:19], v48 offset:512
  ds_read_b64_tr_b16 a[20:21], v48 offset:8192
  ds_read_b64_tr_b16 a[22:23], v48 offset:8704
  ds_read_b64_tr_b16 a[80:81], v49 offset:0
  ds_read_b64_tr_b16 a[82:83], v49 offset:512
  ds_read_b64_tr_b16 a[84:85], v49 offset:8192
  ds_read_b64_tr_b16 a[86:87], v49 offset:8704
  s_branch L_wr_14_e
L_wr_14_3:
  ds_read_b64_tr_b16 a[0:1], v48 offset:0
  ds_read_b64_tr_b16 a[2:3], v48 offset:512
  ds_read_b64_tr_b16 a[4:5], v48 offset:8192
  ds_read_b64_tr_b16 a[6:7], v48 offset:8704
  ds_read_b64_tr_b16 a[64:65], v49 offset:0
  ds_read_b64_tr_b16 a[66:67], v49 offset:512
  ds_read_b64_tr_b16 a[68:69], v49 offset:8192
  ds_read_b64_tr_b16 a[70:71], v49 offset:8704
L_wr_14_e:
  s_waitcnt lgkmcnt(0)
  s_waitcnt vmcnt(8)
  s_barrier
  s_add_u32 m0, s56, 32768
  s_mov_b32 s68, 1048576
  buffer_load_dwordx4 v44, s[48:51], s68 offen  lds
  s_add_u32 m0, s56, 36864
  s_mov_b32 s68, 1114112
  buffer_load_dwordx4 v44, s[48:51], s68 offen  lds
  s_add_u32 m0, s56, 40960
  s_mov_b32 s68, 1310720
  buffer_load_dwordx4 v44, s[48:51], s68 offen  lds
  s_add_u32 m0, s56, 45056
  s_mov_b32 s68, 1376256
  buffer_load_dwordx4 v44, s[48:51], s68 offen  lds
  v_add_u32 v48, 114688, v46
  v_add_u32 v49, 114688, v47
  s_cmp_lg_u32 s44, 0
  s_cbranch_scc1 L_wr_15_1
  ds_read_b64_tr_b16 a[56:57], v48 offset:0
  ds_read_b64_tr_b16 a[58:59], v48 offset:512
  ds_read_b64_tr_b16 a[60:61], v48 offset:8192
  ds_read_b64_tr_b16 a[62:63], v48 offset:8704
  ds_read_b64_tr_b16 a[120:121], v49 offset:0
  ds_read_b64_tr_b16 a[122:123], v49 offset:512
  ds_read_b64_tr_b16 a[124:125], v49 offset:8192
  ds_read_b64_tr_b16 a[126:127], v49 offset:8704
  s_branch L_wr_15_e
L_wr_15_1:
  s_cmp_lg_u32 s44, 1
  s_cbranch_scc1 L_wr_15_2
  ds_read_b64_tr_b16 a[40:41], v48 offset:0
  ds_read_b64_tr_b16 a[42:43], v48 offset:512
  ds_read_b64_tr_b16 a[44:45], v48 offset:8192
  ds_read_b64_tr_b16 a[46:47], v48 offset:8704
  ds_read_b64_tr_b16 a[104:105], v49 offset:0
  ds_read_b64_tr_b16 a[106:107], v49 offset:512
  ds_read_b64_tr_b16 a[108:109], v49 offset:8192
  ds_read_b64_tr_b16 a[110:111], v49 offset:8704
  s_branch L_wr_15_e
L_wr_15_2:
  s_cmp_lg_u32 s44, 2
  s_cbranch_scc1 L_wr_15_3
  ds_read_b64_tr_b16 a[24:25], v48 offset:0
  ds_read_b64_tr_b16 a[26:27], v48 offset:512
  ds_read_b64_tr_b16 a[28:29], v48 offset:8192
  ds_read_b64_tr_b16 a[30:31], v48 offset:8704
  ds_read_b64_tr_b16 a[88:89], v49 offset:0
  ds_read_b64_tr_b16 a[90:91], v49 offset:512
  ds_read_b64_tr_b16 a[92:93], v49 offset:8192
  ds_read_b64_tr_b16 a[94:95], v49 offset:8704
  s_branch L_wr_15_e
L_wr_15_3:
  ds_read_b64_tr_b16 a[8:9], v48 offset:0
  ds_read_b64_tr_b16 a[10:11], v48 offset:512
  ds_read_b64_tr_b16 a[12:13], v48 offset:8192
  ds_read_b64_tr_b16 a[14:15], v48 offset:8704
  ds_read_b64_tr_b16 a[72:73], v49 offset:0
  ds_read_b64_tr_b16 a[74:75], v49 offset:512
  ds_read_b64_tr_b16 a[76:77], v49 offset:8192
  ds_read_b64_tr_b16 a[78:79], v49 offset:8704
L_wr_15_e:
  s_waitcnt lgkmcnt(0)
  s_waitcnt vmcnt(8)
  s_barrier
  s_add_u32 m0, s56, 49152
  s_mov_b32 s68, 1572864
  buffer_load_dwordx4 v44, s[48:51], s68 offen  lds
  s_add_u32 m0, s56, 53248
  s_mov_b32 s68, 1638400
  buffer_load_dwordx4 v44, s[48:51], s68 offen  lds
  s_add_u32 m0, s56, 57344
  s_mov_b32 s68, 1835008
  buffer_load_dwordx4 v44, s[48:51], s68 offen  lds
  s_add_u32 m0, s56, 61440
  s_mov_b32 s68, 1900544
  buffer_load_dwordx4 v44, s[48:51], s68 offen  lds
  v_add_u32 v48, 0, v46
  v_add_u32 v49, 0, v47
  s_cmp_lg_u32 s44, 0
  s_cbranch_scc1 L_wr_16_1
  ds_read_b64_tr_b16 a[128:129], v48 offset:0
  ds_read_b64_tr_b16 a[130:131], v48 offset:512
  ds_read_b64_tr_b16 a[132:133], v48 offset:8192
  ds_read_b64_tr_b16 a[134:135], v48 offset:8704
  ds_read_b64_tr_b16 a[192:193], v49 offset:0
  ds_read_b64_tr_b16 a[194:195], v49 offset:512
  ds_read_b64_tr_b16 a[196:197], v49 offset:8192
  ds_read_b64_tr_b16 a[198:199], v49 offset:8704
  s_branch L_wr_16_e
L_wr_16_1:
  s_cmp_lg_u32 s44, 1
  s_cbranch_scc1 L_wr_16_2
  ds_read_b64_tr_b16 a[144:145], v48 offset:0
  ds_read_b64_tr_b16 a[146:147], v48 offset:512
  ds_read_b64_tr_b16 a[148:149], v48 offset:8192
  ds_read_b64_tr_b16 a[150:151], v48 offset:8704
  ds_read_b64_tr_b16 a[208:209], v49 offset:0
  ds_read_b64_tr_b16 a[210:211], v49 offset:512
  ds_read_b64_tr_b16 a[212:213], v49 offset:8192
  ds_read_b64_tr_b16 a[214:215], v49 offset:8704
  s_branch L_wr_16_e
L_wr_16_2:
  s_cmp_lg_u32 s44, 2
  s_cbranch_scc1 L_wr_16_3
  ds_read_b64_tr_b16 a[160:161], v48 offset:0
  ds_read_b64_tr_b16 a[162:163], v48 offset:512
  ds_read_b64_tr_b16 a[164:165], v48 offset:8192
  ds_read_b64_tr_b16 a[166:167], v48 offset:8704
  ds_read_b64_tr_b16 a[224:225], v49 offset:0
  ds_read_b64_tr_b16 a[226:227], v49 offset:512
  ds_read_b64_tr_b16 a[228:229], v49 offset:8192
  ds_read_b64_tr_b16 a[230:231], v49 offset:8704
  s_branch L_wr_16_e
L_wr_16_3:
  ds_read_b64_tr_b16 a[176:177], v48 offset:0
  ds_read_b64_tr_b16 a[178:179], v48 offset:512
  ds_read_b64_tr_b16 a[180:181], v48 offset:8192
  ds_read_b64_tr_b16 a[182:183], v48 offset:8704
  ds_read_b64_tr_b16 a[240:241], v49 offset:0
  ds_read_b64_tr_b16 a[242:243], v49 offset:512
  ds_read_b64_tr_b16 a[244:245], v49 offset:8192
  ds_read_b64_tr_b16 a[246:247], v49 offset:8704
L_wr_16_e:
  s_waitcnt lgkmcnt(0)
  s_waitcnt vmcnt(8)
  s_barrier
  s_add_u32 m0, s56, 65536
  s_mov_b32 s68, 2097152
  buffer_load_dwordx4 v44, s[48:51], s68 offen  lds
  s_add_u32 m0, s56, 69632
  s_mov_b32 s68, 2162688
  buffer_load_dwordx4 v44, s[48:51], s68 offen  lds
  s_add_u32 m0, s56, 73728
  s_mov_b32 s68, 2359296
  buffer_load_dwordx4 v44, s[48:51], s68 offen  lds
  s_add_u32 m0, s56, 77824
  s_mov_b32 s68, 2424832
  buffer_load_dwordx4 v44, s[48:51], s68 offen  lds
  v_add_u32 v48, 16384, v46
  v_add_u32 v49, 16384, v47
  s_cmp_lg_u32 s44, 0
  s_cbranch_scc1 L_wr_17_1
  ds_read_b64_tr_b16 a[136:137], v48 offset:0
  ds_read_b64_tr_b16 a[138:139], v48 offset:512
  ds_read_b64_tr_b16 a[140:141], v48 offset:8192
  ds_read_b64_tr_b16 a[142:143], v48 offset:8704
  ds_read_b64_tr_b16 a[200:201], v49 offset:0
  ds_read_b64_tr_b16 a[202:203], v49 offset:512
  ds_read_b64_tr_b16 a[204:205], v49 offset:8192
  ds_read_b64_tr_b16 a[206:207], v49 offset:8704
  s_branch L_wr_17_e
L_wr_17_1:
  s_cmp_lg_u32 s44, 1
  s_cbranch_scc1 L_wr_17_2
  ds_read_b64_tr_b16 a[152:153], v48 offset:0
  ds_read_b64_tr_b16 a[154:155], v48 offset:512
  ds_read_b64_tr_b16 a[156:157], v48 offset:8192
  ds_read_b64_tr_b16 a[158:159], v48 offset:8704
  ds_read_b64_tr_b16 a[216:217], v49 offset:0
  ds_read_b64_tr_b16 a[218:219], v49 offset:512
  ds_read_b64_tr_b16 a[220:221], v49 offset:8192
  ds_read_b64_tr_b16 a[222:223], v49 offset:8704
  s_branch L_wr_17_e
L_wr_17_2:
  s_cmp_lg_u32 s44, 2
  s_cbranch_scc1 L_wr_17_3
  ds_read_b64_tr_b16 a[168:169], v48 offset:0
  ds_read_b64_tr_b16 a[170:171], v48 offset:512
  ds_read_b64_tr_b16 a[172:173], v48 offset:8192
  ds_read_b64_tr_b16 a[174:175], v48 offset:8704
  ds_read_b64_tr_b16 a[232:233], v49 offset:0
  ds_read_b64_tr_b16 a[234:235], v49 offset:512
  ds_read_b64_tr_b16 a[236:237], v49 offset:8192
  ds_read_b64_tr_b16 a[238:239], v49 offset:8704
  s_branch L_wr_17_e
L_wr_17_3:
  ds_read_b64_tr_b16 a[184:185], v48 offset:0
  ds_read_b64_tr_b16 a[186:187], v48 offset:512
  ds_read_b64_tr_b16 a[188:189], v48 offset:8192
  ds_read_b64_tr_b16 a[190:191], v48 offset:8704
  ds_read_b64_tr_b16 a[248:249], v49 offset:0
  ds_read_b64_tr_b16 a[250:251], v49 offset:512
  ds_read_b64_tr_b16 a[252:253], v49 offset:8192
  ds_read_b64_tr_b16 a[254:255], v49 offset:8704
L_wr_17_e:
  s_waitcnt lgkmcnt(0)
  s_waitcnt vmcnt(8)
  s_barrier
  s_add_u32 m0, s56, 81920
  s_mov_b32 s68, 2621440
  buffer_load_dwordx4 v44, s[48:51], s68 offen  lds
  s_add_u32 m0, s56, 86016
  s_mov_b32 s68, 2686976
  buffer_load_dwordx4 v44, s[48:51], s68 offen  lds
  s_add_u32 m0, s56, 90112
  s_mov_b32 s68, 2883584
  buffer_load_dwordx4 v44, s[48:51], s68 offen  lds
  s_add_u32 m0, s56, 94208
  s_mov_b32 s68, 2949120
  buffer_load_dwordx4 v44, s[48:51], s68 offen  lds
  v_add_u32 v48, 32768, v46
  v_add_u32 v49, 32768, v47
  s_cmp_lg_u32 s44, 0
  s_cbranch_scc1 L_wr_18_1
  ds_read_b64_tr_b16 a[144:145], v48 offset:0
  ds_read_b64_tr_b16 a[146:147], v48 offset:512
  ds_read_b64_tr_b16 a[148:149], v48 offset:8192
  ds_read_b64_tr_b16 a[150:151], v48 offset:8704
  ds_read_b64_tr_b16 a[208:209], v49 offset:0
  ds_read_b64_tr_b16 a[210:211], v49 offset:512
  ds_read_b64_tr_b16 a[212:213], v49 offset:8192
  ds_read_b64_tr_b16 a[214:215], v49 offset:8704
  s_branch L_wr_18_e
L_wr_18_1:
  s_cmp_lg_u32 s44, 1
  s_cbranch_scc1 L_wr_18_2
  ds_read_b64_tr_b16 a[128:129], v48 offset:0
  ds_read_b64_tr_b16 a[130:131], v48 offset:512
  ds_read_b64_tr_b16 a[132:133], v48 offset:8192
  ds_read_b64_tr_b16 a[134:135], v48 offset:8704
  ds_read_b64_tr_b16 a[192:193], v49 offset:0
  ds_read_b64_tr_b16 a[194:195], v49 offset:512
  ds_read_b64_tr_b16 a[196:197], v49 offset:8192
  ds_read_b64_tr_b16 a[198:199], v49 offset:8704
  s_branch L_wr_18_e
L_wr_18_2:
  s_cmp_lg_u32 s44, 2
  s_cbranch_scc1 L_wr_18_3
  ds_read_b64_tr_b16 a[176:177], v48 offset:0
  ds_read_b64_tr_b16 a[178:179], v48 offset:512
  ds_read_b64_tr_b16 a[180:181], v48 offset:8192
  ds_read_b64_tr_b16 a[182:183], v48 offset:8704
  ds_read_b64_tr_b16 a[240:241], v49 offset:0
  ds_read_b64_tr_b16 a[242:243], v49 offset:512
  ds_read_b64_tr_b16 a[244:245], v49 offset:8192
  ds_read_b64_tr_b16 a[246:247], v49 offset:8704
  s_branch L_wr_18_e
L_wr_18_3:
  ds_read_b64_tr_b16 a[160:161], v48 offset:0
  ds_read_b64_tr_b16 a[162:163], v48 offset:512
  ds_read_b64_tr_b16 a[164:165], v48 offset:8192
  ds_read_b64_tr_b16 a[166:167], v48 offset:8704
  ds_read_b64_tr_b16 a[224:225], v49 offset:0
  ds_read_b64_tr_b16 a[226:227], v49 offset:512
  ds_read_b64_tr_b16 a[228:229], v49 offset:8192
  ds_read_b64_tr_b16 a[230:231], v49 offset:8704
L_wr_18_e:
  s_waitcnt lgkmcnt(0)
  s_waitcnt vmcnt(8)
  s_barrier
  s_add_u32 m0, s56, 98304
  s_mov_b32 s68, 3145728
  buffer_load_dwordx4 v44, s[48:51], s68 offen  lds
  s_add_u32 m0, s56, 102400
  s_mov_b32 s68, 3211264
  buffer_load_dwordx4 v44, s[48:51], s68 offen  lds
  s_add_u32 m0, s56, 106496
  s_mov_b32 s68, 3407872
  buffer_load_dwordx4 v44, s[48:51], s68 offen  lds
  s_add_u32 m0, s56, 110592
  s_mov_b32 s68, 3473408
  buffer_load_dwordx4 v44, s[48:51], s68 offen  lds
  v_add_u32 v48, 49152, v46
  v_add_u32 v49, 49152, v47
  s_cmp_lg_u32 s44, 0
  s_cbranch_scc1 L_wr_19_1
  ds_read_b64_tr_b16 a[152:153], v48 offset:0
  ds_read_b64_tr_b16 a[154:155], v48 offset:512
  ds_read_b64_tr_b16 a[156:157], v48 offset:8192
  ds_read_b64_tr_b16 a[158:159], v48 offset:8704
  ds_read_b64_tr_b16 a[216:217], v49 offset:0
  ds_read_b64_tr_b16 a[218:219], v49 offset:512
  ds_read_b64_tr_b16 a[220:221], v49 offset:8192
  ds_read_b64_tr_b16 a[222:223], v49 offset:8704
  s_branch L_wr_19_e
L_wr_19_1:
  s_cmp_lg_u32 s44, 1
  s_cbranch_scc1 L_wr_19_2
  ds_read_b64_tr_b16 a[136:137], v48 offset:0
  ds_read_b64_tr_b16 a[138:139], v48 offset:512
  ds_read_b64_tr_b16 a[140:141], v48 offset:8192
  ds_read_b64_tr_b16 a[142:143], v48 offset:8704
  ds_read_b64_tr_b16 a[200:201], v49 offset:0
  ds_read_b64_tr_b16 a[202:203], v49 offset:512
  ds_read_b64_tr_b16 a[204:205], v49 offset:8192
  ds_read_b64_tr_b16 a[206:207], v49 offset:8704
  s_branch L_wr_19_e
L_wr_19_2:
  s_cmp_lg_u32 s44, 2
  s_cbranch_scc1 L_wr_19_3
  ds_read_b64_tr_b16 a[184:185], v48 offset:0
  ds_read_b64_tr_b16 a[186:187], v48 offset:512
  ds_read_b64_tr_b16 a[188:189], v48 offset:8192
  ds_read_b64_tr_b16 a[190:191], v48 offset:8704
  ds_read_b64_tr_b16 a[248:249], v49 offset:0
  ds_read_b64_tr_b16 a[250:251], v49 offset:512
  ds_read_b64_tr_b16 a[252:253], v49 offset:8192
  ds_read_b64_tr_b16 a[254:255], v49 offset:8704
  s_branch L_wr_19_e
L_wr_19_3:
  ds_read_b64_tr_b16 a[168:169], v48 offset:0
  ds_read_b64_tr_b16 a[170:171], v48 offset:512
  ds_read_b64_tr_b16 a[172:173], v48 offset:8192
  ds_read_b64_tr_b16 a[174:175], v48 offset:8704
  ds_read_b64_tr_b16 a[232:233], v49 offset:0
  ds_read_b64_tr_b16 a[234:235], v49 offset:512
  ds_read_b64_tr_b16 a[236:237], v49 offset:8192
  ds_read_b64_tr_b16 a[238:239], v49 offset:8704
L_wr_19_e:
  s_waitcnt lgkmcnt(0)
  s_waitcnt vmcnt(8)
  s_barrier
  s_add_u32 m0, s56, 114688
  s_mov_b32 s68, 3670016
  buffer_load_dwordx4 v44, s[48:51], s68 offen  lds
  s_add_u32 m0, s56, 118784
  s_mov_b32 s68, 3735552
  buffer_load_dwordx4 v44, s[48:51], s68 offen  lds
  s_add_u32 m0, s56, 122880
  s_mov_b32 s68, 3932160
  buffer_load_dwordx4 v44, s[48:51], s68 offen  lds
  s_add_u32 m0, s56, 126976
  s_mov_b32 s68, 3997696
  buffer_load_dwordx4 v44, s[48:51], s68 offen  lds
  v_add_u32 v48, 65536, v46
  v_add_u32 v49, 65536, v47
  s_cmp_lg_u32 s44, 0
  s_cbranch_scc1 L_wr_20_1
  ds_read_b64_tr_b16 a[160:161], v48 offset:0
  ds_read_b64_tr_b16 a[162:163], v48 offset:512
  ds_read_b64_tr_b16 a[164:165], v48 offset:8192
  ds_read_b64_tr_b16 a[166:167], v48 offset:8704
  ds_read_b64_tr_b16 a[224:225], v49 offset:0
  ds_read_b64_tr_b16 a[226:227], v49 offset:512
  ds_read_b64_tr_b16 a[228:229], v49 offset:8192
  ds_read_b64_tr_b16 a[230:231], v49 offset:8704
  s_branch L_wr_20_e
L_wr_20_1:
  s_cmp_lg_u32 s44, 1
  s_cbranch_scc1 L_wr_20_2
  ds_read_b64_tr_b16 a[176:177], v48 offset:0
  ds_read_b64_tr_b16 a[178:179], v48 offset:512
  ds_read_b64_tr_b16 a[180:181], v48 offset:8192
  ds_read_b64_tr_b16 a[182:183], v48 offset:8704
  ds_read_b64_tr_b16 a[240:241], v49 offset:0
  ds_read_b64_tr_b16 a[242:243], v49 offset:512
  ds_read_b64_tr_b16 a[244:245], v49 offset:8192
  ds_read_b64_tr_b16 a[246:247], v49 offset:8704
  s_branch L_wr_20_e
L_wr_20_2:
  s_cmp_lg_u32 s44, 2
  s_cbranch_scc1 L_wr_20_3
  ds_read_b64_tr_b16 a[128:129], v48 offset:0
  ds_read_b64_tr_b16 a[130:131], v48 offset:512
  ds_read_b64_tr_b16 a[132:133], v48 offset:8192
  ds_read_b64_tr_b16 a[134:135], v48 offset:8704
  ds_read_b64_tr_b16 a[192:193], v49 offset:0
  ds_read_b64_tr_b16 a[194:195], v49 offset:512
  ds_read_b64_tr_b16 a[196:197], v49 offset:8192
  ds_read_b64_tr_b16 a[198:199], v49 offset:8704
  s_branch L_wr_20_e
L_wr_20_3:
  ds_read_b64_tr_b16 a[144:145], v48 offset:0
  ds_read_b64_tr_b16 a[146:147], v48 offset:512
  ds_read_b64_tr_b16 a[148:149], v48 offset:8192
  ds_read_b64_tr_b16 a[150:151], v48 offset:8704
  ds_read_b64_tr_b16 a[208:209], v49 offset:0
  ds_read_b64_tr_b16 a[210:211], v49 offset:512
  ds_read_b64_tr_b16 a[212:213], v49 offset:8192
  ds_read_b64_tr_b16 a[214:215], v49 offset:8704
L_wr_20_e:
  s_waitcnt lgkmcnt(0)
  s_waitcnt vmcnt(8)
  s_barrier
  s_mov_b32 s48, s28
  s_and_b32 s49, s29, 0xffff
  s_add_u32 m0, s56, 0
  s_mov_b32 s68, 0
  buffer_load_dwordx4 v44, s[48:51], s68 offen  lds
  s_add_u32 m0, s56, 4096
  s_mov_b32 s68, 65536
  buffer_load_dwordx4 v44, s[48:51], s68 offen  lds
  s_add_u32 m0, s56, 8192
  s_mov_b32 s68, 262144
  buffer_load_dwordx4 v44, s[48:51], s68 offen  lds
  s_add_u32 m0, s56, 12288
  s_mov_b32 s68, 327680
  buffer_load_dwordx4 v44, s[48:51], s68 offen  lds
  v_add_u32 v48, 81920, v46
  v_add_u32 v49, 81920, v47
  s_cmp_lg_u32 s44, 0
  s_cbranch_scc1 L_wr_21_1
  ds_read_b64_tr_b16 a[168:169], v48 offset:0
  ds_read_b64_tr_b16 a[170:171], v48 offset:512
  ds_read_b64_tr_b16 a[172:173], v48 offset:8192
  ds_read_b64_tr_b16 a[174:175], v48 offset:8704
  ds_read_b64_tr_b16 a[232:233], v49 offset:0
  ds_read_b64_tr_b16 a[234:235], v49 offset:512
  ds_read_b64_tr_b16 a[236:237], v49 offset:8192
  ds_read_b64_tr_b16 a[238:239], v49 offset:8704
  s_branch L_wr_21_e
L_wr_21_1:
  s_cmp_lg_u32 s44, 1
  s_cbranch_scc1 L_wr_21_2
  ds_read_b64_tr_b16 a[184:185], v48 offset:0
  ds_read_b64_tr_b16 a[186:187], v48 offset:512
  ds_read_b64_tr_b16 a[188:189], v48 offset:8192
  ds_read_b64_tr_b16 a[190:191], v48 offset:8704
  ds_read_b64_tr_b16 a[248:249], v49 offset:0
  ds_read_b64_tr_b16 a[250:251], v49 offset:512
  ds_read_b64_tr_b16 a[252:253], v49 offset:8192
  ds_read_b64_tr_b16 a[254:255], v49 offset:8704
  s_branch L_wr_21_e
L_wr_21_2:
  s_cmp_lg_u32 s44, 2
  s_cbranch_scc1 L_wr_21_3
  ds_read_b64_tr_b16 a[136:137], v48 offset:0
  ds_read_b64_tr_b16 a[138:139], v48 offset:512
  ds_read_b64_tr_b16 a[140:141], v48 offset:8192
  ds_read_b64_tr_b16 a[142:143], v48 offset:8704
  ds_read_b64_tr_b16 a[200:201], v49 offset:0
  ds_read_b64_tr_b16 a[202:203], v49 offset:512
  ds_read_b64_tr_b16 a[204:205], v49 offset:8192
  ds_read_b64_tr_b16 a[206:207], v49 offset:8704
  s_branch L_wr_21_e
L_wr_21_3:
  ds_read_b64_tr_b16 a[152:153], v48 offset:0
  ds_read_b64_tr_b16 a[154:155], v48 offset:512
  ds_read_b64_tr_b16 a[156:157], v48 offset:8192
  ds_read_b64_tr_b16 a[158:159], v48 offset:8704
  ds_read_b64_tr_b16 a[216:217], v49 offset:0
  ds_read_b64_tr_b16 a[218:219], v49 offset:512
  ds_read_b64_tr_b16 a[220:221], v49 offset:8192
  ds_read_b64_tr_b16 a[222:223], v49 offset:8704
L_wr_21_e:
  s_waitcnt lgkmcnt(0)
  s_waitcnt vmcnt(8)
  s_barrier
  s_add_u32 m0, s56, 16384
  s_mov_b32 s68, 524288
  buffer_load_dwordx4 v44, s[48:51], s68 offen  lds
  s_add_u32 m0, s56, 20480
  s_mov_b32 s68, 589824
  buffer_load_dwordx4 v44, s[48:51], s68 offen  lds
  s_add_u32 m0, s56, 24576
  s_mov_b32 s68, 786432
  buffer_load_dwordx4 v44, s[48:51], s68 offen  lds
  s_add_u32 m0, s56, 28672
  s_mov_b32 s68, 851968
  buffer_load_dwordx4 v44, s[48:51], s68 offen  lds
  v_add_u32 v48, 98304, v46
  v_add_u32 v49, 98304, v47
  s_cmp_lg_u32 s44, 0
  s_cbranch_scc1 L_wr_22_1
  ds_read_b64_tr_b16 a[176:177], v48 offset:0
  ds_read_b64_tr_b16 a[178:179], v48 offset:512
  ds_read_b64_tr_b16 a[180:181], v48 offset:8192
  ds_read_b64_tr_b16 a[182:183], v48 offset:8704
  ds_read_b64_tr_b16 a[240:241], v49 offset:0
  ds_read_b64_tr_b16 a[242:243], v49 offset:512
  ds_read_b64_tr_b16 a[244:245], v49 offset:8192
  ds_read_b64_tr_b16 a[246:247], v49 offset:8704
  s_branch L_wr_22_e
L_wr_22_1:
  s_cmp_lg_u32 s44, 1
  s_cbranch_scc1 L_wr_22_2
  ds_read_b64_tr_b16 a[160:161], v48 offset:0
  ds_read_b64_tr_b16 a[162:163], v48 offset:512
  ds_read_b64_tr_b16 a[164:165], v48 offset:8192
  ds_read_b64_tr_b16 a[166:167], v48 offset:8704
  ds_read_b64_tr_b16 a[224:225], v49 offset:0
  ds_read_b64_tr_b16 a[226:227], v49 offset:512
  ds_read_b64_tr_b16 a[228:229], v49 offset:8192
  ds_read_b64_tr_b16 a[230:231], v49 offset:8704
  s_branch L_wr_22_e
L_wr_22_2:
  s_cmp_lg_u32 s44, 2
  s_cbranch_scc1 L_wr_22_3
  ds_read_b64_tr_b16 a[144:145], v48 offset:0
  ds_read_b64_tr_b16 a[146:147], v48 offset:512
  ds_read_b64_tr_b16 a[148:149], v48 offset:8192
  ds_read_b64_tr_b16 a[150:151], v48 offset:8704
  ds_read_b64_tr_b16 a[208:209], v49 offset:0
  ds_read_b64_tr_b16 a[210:211], v49 offset:512
  ds_read_b64_tr_b16 a[212:213], v49 offset:8192
  ds_read_b64_tr_b16 a[214:215], v49 offset:8704
  s_branch L_wr_22_e
L_wr_22_3:
  ds_read_b64_tr_b16 a[128:129], v48 offset:0
  ds_read_b64_tr_b16 a[130:131], v48 offset:512
  ds_read_b64_tr_b16 a[132:133], v48 offset:8192
  ds_read_b64_tr_b16 a[134:135], v48 offset:8704
  ds_read_b64_tr_b16 a[192:193], v49 offset:0
  ds_read_b64_tr_b16 a[194:195], v49 offset:512
  ds_read_b64_tr_b16 a[196:197], v49 offset:8192
  ds_read_b64_tr_b16 a[198:199], v49 offset:8704
L_wr_22_e:
  s_waitcnt lgkmcnt(0)
  s_waitcnt vmcnt(8)
  s_barrier
  s_add_u32 m0, s56, 32768
  s_mov_b32 s68, 1048576
  buffer_load_dwordx4 v44, s[48:51], s68 offen  lds
  s_add_u32 m0, s56, 36864
  s_mov_b32 s68, 1114112
  buffer_load_dwordx4 v44, s[48:51], s68 offen  lds
  s_add_u32 m0, s56, 40960
  s_mov_b32 s68, 1310720
  buffer_load_dwordx4 v44, s[48:51], s68 offen  lds
  s_add_u32 m0, s56, 45056
  s_mov_b32 s68, 1376256
  buffer_load_dwordx4 v44, s[48:51], s68 offen  lds
  v_add_u32 v48, 114688, v46
  v_add_u32 v49, 114688, v47
  s_cmp_lg_u32 s44, 0
  s_cbranch_scc1 L_wr_23_1
  ds_read_b64_tr_b16 a[184:185], v48 offset:0
  ds_read_b64_tr_b16 a[186:187], v48 offset:512
  ds_read_b64_tr_b16 a[188:189], v48 offset:8192
  ds_read_b64_tr_b16 a[190:191], v48 offset:8704
  ds_read_b64_tr_b16 a[248:249], v49 offset:0
  ds_read_b64_tr_b16 a[250:251], v49 offset:512
  ds_read_b64_tr_b16 a[252:253], v49 offset:8192
  ds_read_b64_tr_b16 a[254:255], v49 offset:8704
  s_branch L_wr_23_e
L_wr_23_1:
  s_cmp_lg_u32 s44, 1
  s_cbranch_scc1 L_wr_23_2
  ds_read_b64_tr_b16 a[168:169], v48 offset:0
  ds_read_b64_tr_b16 a[170:171], v48 offset:512
  ds_read_b64_tr_b16 a[172:173], v48 offset:8192
  ds_read_b64_tr_b16 a[174:175], v48 offset:8704
  ds_read_b64_tr_b16 a[232:233], v49 offset:0
  ds_read_b64_tr_b16 a[234:235], v49 offset:512
  ds_read_b64_tr_b16 a[236:237], v49 offset:8192
  ds_read_b64_tr_b16 a[238:239], v49 offset:8704
  s_branch L_wr_23_e
L_wr_23_2:
  s_cmp_lg_u32 s44, 2
  s_cbranch_scc1 L_wr_23_3
  ds_read_b64_tr_b16 a[152:153], v48 offset:0
  ds_read_b64_tr_b16 a[154:155], v48 offset:512
  ds_read_b64_tr_b16 a[156:157], v48 offset:8192
  ds_read_b64_tr_b16 a[158:159], v48 offset:8704
  ds_read_b64_tr_b16 a[216:217], v49 offset:0
  ds_read_b64_tr_b16 a[218:219], v49 offset:512
  ds_read_b64_tr_b16 a[220:221], v49 offset:8192
  ds_read_b64_tr_b16 a[222:223], v49 offset:8704
  s_branch L_wr_23_e
L_wr_23_3:
  ds_read_b64_tr_b16 a[136:137], v48 offset:0
  ds_read_b64_tr_b16 a[138:139], v48 offset:512
  ds_read_b64_tr_b16 a[140:141], v48 offset:8192
  ds_read_b64_tr_b16 a[142:143], v48 offset:8704
  ds_read_b64_tr_b16 a[200:201], v49 offset:0
  ds_read_b64_tr_b16 a[202:203], v49 offset:512
  ds_read_b64_tr_b16 a[204:205], v49 offset:8192
  ds_read_b64_tr_b16 a[206:207], v49 offset:8704
L_wr_23_e:
  s_waitcnt lgkmcnt(0)
  s_waitcnt vmcnt(8)
  s_barrier
  s_add_u32 m0, s56, 49152
  s_mov_b32 s68, 1572864
  buffer_load_dwordx4 v44, s[48:51], s68 offen  lds
  s_add_u32 m0, s56, 53248
  s_mov_b32 s68, 1638400
  buffer_load_dwordx4 v44, s[48:51], s68 offen  lds
  s_add_u32 m0, s56, 57344
  s_mov_b32 s68, 1835008
  buffer_load_dwordx4 v44, s[48:51], s68 offen  lds
  s_add_u32 m0, s56, 61440
  s_mov_b32 s68, 1900544
  buffer_load_dwordx4 v44, s[48:51], s68 offen  lds
  v_add_u32 v48, 0, v46
  v_add_u32 v49, 0, v47
  ds_read_b64_tr_b16 v[108:109], v48 offset:0
  ds_read_b64_tr_b16 v[110:111], v48 offset:512
  ds_read_b64_tr_b16 v[112:113], v48 offset:8192
  ds_read_b64_tr_b16 v[114:115], v48 offset:8704
  ds_read_b64_tr_b16 v[116:117], v49 offset:0
  ds_read_b64_tr_b16 v[118:119], v49 offset:512
  ds_read_b64_tr_b16 v[120:121], v49 offset:8192
  ds_read_b64_tr_b16 v[122:123], v49 offset:8704
  s_waitcnt lgkmcnt(0)
  s_barrier
  v_add_u32 v48, 0, v3
  ds_write_b128 v48, v[108:111] offset:0
  ds_write_b128 v48, v[112:115] offset:1024
  ds_write_b128 v48, v[116:119] offset:2048
  ds_write_b128 v48, v[120:123] offset:3072
  s_waitcnt lgkmcnt(0)
  s_waitcnt vmcnt(8)
  s_barrier
  s_add_u32 m0, s56, 65536
  s_mov_b32 s68, 2097152
  buffer_load_dwordx4 v44, s[48:51], s68 offen  lds
  s_add_u32 m0, s56, 69632
  s_mov_b32 s68, 2162688
  buffer_load_dwordx4 v44, s[48:51], s68 offen  lds
  s_add_u32 m0, s56, 73728
  s_mov_b32 s68, 2359296
  buffer_load_dwordx4 v44, s[48:51], s68 offen  lds
  s_add_u32 m0, s56, 77824
  s_mov_b32 s68, 2424832
  buffer_load_dwordx4 v44, s[48:51], s68 offen  lds
  v_add_u32 v48, 16384, v46
  v_add_u32 v49, 16384, v47
  ds_read_b64_tr_b16 v[108:109], v48 offset:0
  ds_read_b64_tr_b16 v[110:111], v48 offset:512
  ds_read_b64_tr_b16 v[112:113], v48 offset:8192
  ds_read_b64_tr_b16 v[114:115], v48 offset:8704
  ds_read_b64_tr_b16 v[116:117], v49 offset:0
  ds_read_b64_tr_b16 v[118:119], v49 offset:512
  ds_read_b64_tr_b16 v[120:121], v49 offset:8192
  ds_read_b64_tr_b16 v[122:123], v49 offset:8704
  s_waitcnt lgkmcnt(0)
  s_barrier
  v_add_u32 v48, 16384, v3
  ds_write_b128 v48, v[108:111] offset:0
  ds_write_b128 v48, v[112:115] offset:1024
  ds_write_b128 v48, v[116:119] offset:2048
  ds_write_b128 v48, v[120:123] offset:3072
  s_waitcnt lgkmcnt(0)
  s_waitcnt vmcnt(8)
  s_barrier
  s_add_u32 m0, s56, 81920
  s_mov_b32 s68, 2621440
  buffer_load_dwordx4 v44, s[48:51], s68 offen  lds
  s_add_u32 m0, s56, 86016
  s_mov_b32 s68, 2686976
  buffer_load_dwordx4 v44, s[48:51], s68 offen  lds
  s_add_u32 m0, s56, 90112
  s_mov_b32 s68, 2883584
  buffer_load_dwordx4 v44, s[48:51], s68 offen  lds
  s_add_u32 m0, s56, 94208
  s_mov_b32 s68, 2949120
  buffer_load_dwordx4 v44, s[48:51], s68 offen  lds
  v_add_u32 v48, 32768, v46
  v_add_u32 v49, 32768, v47
  ds_read_b64_tr_b16 v[108:109], v48 offset:0
  ds_read_b64_tr_b16 v[110:111], v48 offset:512
  ds_read_b64_tr_b16 v[112:113], v48 offset:8192
  ds_read_b64_tr_b16 v[114:115], v48 offset:8704
  ds_read_b64_tr_b16 v[116:117], v49 offset:0
  ds_read_b64_tr_b16 v[118:119], v49 offset:512
  ds_read_b64_tr_b16 v[120:121], v49 offset:8192
  ds_read_b64_tr_b16 v[122:123], v49 offset:8704
  s_waitcnt lgkmcnt(0)
  s_barrier
  v_add_u32 v48, 32768, v3
  ds_write_b128 v48, v[108:111] offset:0
  ds_write_b128 v48, v[112:115] offset:1024
  ds_write_b128 v48, v[116:119] offset:2048
  ds_write_b128 v48, v[120:123] offset:3072
  s_waitcnt lgkmcnt(0)
  s_waitcnt vmcnt(8)
  s_barrier
  buffer_load_dwordx2 v[52:53], v17, s[52:55], 0 offen sc1
  buffer_load_dword v4, v17, s[40:43], s60 offen sc1
  s_add_u32 m0, s56, 98304
  s_mov_b32 s68, 3145728
  buffer_load_dwordx4 v44, s[48:51], s68 offen  lds
  s_add_u32 m0, s56, 102400
  s_mov_b32 s68, 3211264
  buffer_load_dwordx4 v44, s[48:51], s68 offen  lds
  s_add_u32 m0, s56, 106496
  s_mov_b32 s68, 3407872
  buffer_load_dwordx4 v44, s[48:51], s68 offen  lds
  s_add_u32 m0, s56, 110592
  s_mov_b32 s68, 3473408
  buffer_load_dwordx4 v44, s[48:51], s68 offen  lds
  v_add_u32 v48, 49152, v46
  v_add_u32 v49, 49152, v47
  ds_read_b64_tr_b16 v[108:109], v48 offset:0
  ds_read_b64_tr_b16 v[110:111], v48 offset:512
  ds_read_b64_tr_b16 v[112:113], v48 offset:8192
  ds_read_b64_tr_b16 v[114:115], v48 offset:8704
  ds_read_b64_tr_b16 v[116:117], v49 offset:0
  ds_read_b64_tr_b16 v[118:119], v49 offset:512
  ds_read_b64_tr_b16 v[120:121], v49 offset:8192
  ds_read_b64_tr_b16 v[122:123], v49 offset:8704
  s_waitcnt lgkmcnt(0)
  s_barrier
  v_add_u32 v48, 49152, v3
  ds_write_b128 v48, v[108:111] offset:0
  ds_write_b128 v48, v[112:115] offset:1024
  ds_write_b128 v48, v[116:119] offset:2048
  ds_write_b128 v48, v[120:123] offset:3072
  s_waitcnt lgkmcnt(0)
  s_waitcnt vmcnt(8)
  s_barrier
  s_add_u32 m0, s56, 114688
  s_mov_b32 s68, 3670016
  buffer_load_dwordx4 v44, s[48:51], s68 offen  lds
  s_add_u32 m0, s56, 118784
  s_mov_b32 s68, 3735552
  buffer_load_dwordx4 v44, s[48:51], s68 offen  lds
  s_add_u32 m0, s56, 122880
  s_mov_b32 s68, 3932160
  buffer_load_dwordx4 v44, s[48:51], s68 offen  lds
  s_add_u32 m0, s56, 126976
  s_mov_b32 s68, 3997696
  buffer_load_dwordx4 v44, s[48:51], s68 offen  lds
  v_add_u32 v48, 65536, v46
  v_add_u32 v49, 65536, v47
  ds_read_b64_tr_b16 v[108:109], v48 offset:0
  ds_read_b64_tr_b16 v[110:111], v48 offset:512
  ds_read_b64_tr_b16 v[112:113], v48 offset:8192
  ds_read_b64_tr_b16 v[114:115], v48 offset:8704
  ds_read_b64_tr_b16 v[116:117], v49 offset:0
  ds_read_b64_tr_b16 v[118:119], v49 offset:512
  ds_read_b64_tr_b16 v[120:121], v49 offset:8192
  ds_read_b64_tr_b16 v[122:123], v49 offset:8704
  s_waitcnt lgkmcnt(0)
  s_barrier
  v_add_u32 v48, 65536, v3
  ds_write_b128 v48, v[108:111] offset:0
  ds_write_b128 v48, v[112:115] offset:1024
  ds_write_b128 v48, v[116:119] offset:2048
  ds_write_b128 v48, v[120:123] offset:3072
  s_waitcnt lgkmcnt(0)
  s_waitcnt vmcnt(8)
  s_barrier
  v_add_u32 v48, 81920, v46
  v_add_u32 v49, 81920, v47
  ds_read_b64_tr_b16 v[108:109], v48 offset:0
  ds_read_b64_tr_b16 v[110:111], v48 offset:512
  ds_read_b64_tr_b16 v[112:113], v48 offset:8192
  ds_read_b64_tr_b16 v[114:115], v48 offset:8704
  ds_read_b64_tr_b16 v[116:117], v49 offset:0
  ds_read_b64_tr_b16 v[118:119], v49 offset:512
  ds_read_b64_tr_b16 v[120:121], v49 offset:8192
  ds_read_b64_tr_b16 v[122:123], v49 offset:8704
  s_waitcnt lgkmcnt(0)
  s_barrier
  v_add_u32 v48, 81920, v3
  ds_write_b128 v48, v[108:111] offset:0
  ds_write_b128 v48, v[112:115] offset:1024
  ds_write_b128 v48, v[116:119] offset:2048
  ds_write_b128 v48, v[120:123] offset:3072
  s_waitcnt lgkmcnt(0)
  s_waitcnt vmcnt(4)
  s_barrier
L_team_init:
  v_sad_u8 v54, v52, 0, 0
  v_sad_u8 v54, v53, 0, v54
  v_cmp_gt_u32 vcc, 32, v54
  v_cmp_gt_u32 s[4:5], 2, v4
  s_nop 0
  s_or_b64 vcc, vcc, s[4:5]
  s_cbranch_scc0 L_team_ready
  buffer_load_dwordx2 v[52:53], v17, s[52:55], 0 offen sc1
  buffer_load_dword v4, v17, s[40:43], s60 offen sc1
  s_add_u32 s67, s67, 1
  s_cmp_gt_u32 s67, 1048576
  s_cbranch_scc1 L_exit
  s_waitcnt vmcnt(0)
  s_branch L_team_init
L_team_ready:
  s_lshl_b32 s69, s46, 3
  s_mov_b32 m0, s70
  s_mov_b32 s57, s72
  buffer_load_dwordx4 v2, s[40:43], s57 offen sc1 lds
  buffer_load_dwordx4 v2, s[40:43], s57 offen offset:1024 sc1 lds
  s_mov_b32 m0, s71
  s_add_u32 s58, s57, 0x1000000
  buffer_load_dwordx4 v2, s[40:43], s58 offen sc1 lds
  buffer_load_dwordx4 v2, s[40:43], s58 offen offset:1024 sc1 lds
  v_lshrrev_b64 v[52:53], s69, v[52:53]
  v_and_b32 v52, 0xff, v52
  v_cmp_eq_u32 s[4:5], v52, v54
  v_add_u32 v48, 98304, v46
  v_add_u32 v49, 98304, v47
  ds_read_b64_tr_b16 v[108:109], v48 offset:0
  ds_read_b64_tr_b16 v[110:111], v48 offset:512
  ds_read_b64_tr_b16 v[112:113], v48 offset:8192
  ds_read_b64_tr_b16 v[114:115], v48 offset:8704
  ds_read_b64_tr_b16 v[116:117], v49 offset:0
  ds_read_b64_tr_b16 v[118:119], v49 offset:512
  ds_read_b64_tr_b16 v[120:121], v49 offset:8192
  ds_read_b64_tr_b16 v[122:123], v49 offset:8704
  s_waitcnt lgkmcnt(0)
  s_barrier
  v_add_u32 v48, 98304, v3
  ds_write_b128 v48, v[108:111] offset:0
  ds_write_b128 v48, v[112:115] offset:1024
  ds_write_b128 v48, v[116:119] offset:2048
  ds_write_b128 v48, v[120:123] offset:3072
  s_waitcnt lgkmcnt(0)
  s_waitcnt vmcnt(4)
  s_barrier
  v_add_u32 v48, 114688, v46
  v_add_u32 v49, 114688, v47
  ds_read_b64_tr_b16 v[108:109], v48 offset:0
  ds_read_b64_tr_b16 v[110:111], v48 offset:512
  ds_read_b64_tr_b16 v[112:113], v48 offset:8192
  ds_read_b64_tr_b16 v[114:115], v48 offset:8704
  ds_read_b64_tr_b16 v[116:117], v49 offset:0
  ds_read_b64_tr_b16 v[118:119], v49 offset:512
  ds_read_b64_tr_b16 v[120:121], v49 offset:8192
  ds_read_b64_tr_b16 v[122:123], v49 offset:8704
  s_waitcnt lgkmcnt(0)
  s_barrier
  v_add_u32 v48, 114688, v3
  ds_write_b128 v48, v[108:111] offset:0
  ds_write_b128 v48, v[112:115] offset:1024
  ds_write_b128 v48, v[116:119] offset:2048
  ds_write_b128 v48, v[120:123] offset:3072
  s_waitcnt lgkmcnt(0)
  s_lshl_b32 s68, s44, 15
  v_add_u32 v3, s68, v3
  s_mov_b32 s56, -1
  s_mov_b32 s65, 0
  s_lshl_b32 s61, s45, 12
  s_lshl_b32 s68, s44, 10
  s_sub_u32 s61, s61, s68
  s_add_u32 s61, s61, 0xbfc0000
  ds_read_b128 v[76:79], v3 offset:0
  ds_read_b128 v[80:83], v3 offset:1024
  ds_read_b128 v[84:87], v3 offset:2048
  ds_read_b128 v[88:91], v3 offset:3072
  ds_read_b128 v[92:95], v3 offset:16384
  ds_read_b128 v[96:99], v3 offset:17408
  ds_read_b128 v[100:103], v3 offset:18432
  ds_read_b128 v[104:107], v3 offset:19456
  v_xor_b32 v3, 0x8000, v3
  ds_read_b128 v[108:111], v3 offset:0
  ds_read_b128 v[112:115], v3 offset:1024
  s_add_u32 s56, s56, 1
  s_xor_b32 s65, s65, 1
  s_add_u32 s68, s56, 1
  s_min_u32 s68, s68, 63
  s_lshl_b32 s68, s68, 13
  s_add_u32 s57, s72, s68
  s_add_u32 s58, s57, 0x1000000
  s_add_u32 s68, s56, 3
  s_min_u32 s92, s68, 64
  s_add_u32 s61, s61, 0x20000
  s_xor_b32 s70, s70, 0x2000
  v_mov_b64 v[52:53], 0
  v_mov_b64 v[54:55], 0
  v_mov_b64 v[56:57], 0
  v_mov_b64 v[58:59], 0
  v_mov_b64 v[60:61], 0
  v_mov_b64 v[62:63], 0
  v_mov_b64 v[64:65], 0
  v_mov_b64 v[66:67], 0
  v_mov_b64 v[68:69], 0
  v_mov_b64 v[70:71], 0
  v_mov_b64 v[72:73], 0
  v_mov_b64 v[74:75], 0
  v_xor_b32 v32, 2048, v2
  v_xor_b32 v40, 4096, v2
  v_xor_b32 v48, 6144, v2
  v_min_u32 v124, -2, v124
  v_bfe_u32 v45, v2, 9, 1
  v_and_b32 v4, 0x1ff, v2
  v_lshlrev_b32 v4, 2, v4
  s_add_u32 s59, s57, s73
  v_lshl_add_u32 v4, v45, 24, v4
  s_sub_u32 s68, s60, s59
  v_writelane_b32 v4, s68, 1
  s_waitcnt vmcnt(0)
  ds_read_b128 v[116:119], v2 offset:8192
  ds_read_b128 v[120:123], v2 offset:9216
  s_cmp_eq_u32 s4, 0
  s_cbranch_scc1 L_entry_x
  s_branch L_entry_f
L_poll2_f:
  buffer_load_dwordx4 v[20:23], v2, s[40:43], s63 offen sc1
  buffer_load_dwordx4 v[24:27], v2, s[40:43], s63 offen offset:1024 sc1
  s_nop 15
  s_nop 6
  buffer_load_dwordx4 v[28:31], v2, s[40:43], s63 offen sc1
  buffer_load_dwordx4 v[36:39], v2, s[40:43], s63 offen offset:1024 sc1
  ds_read_b128 v[116:119], v2 offset:8192
  ds_read_b128 v[120:123], v2 offset:9216
  v_readlane_b32 s69, v4, 1
  v_xor_b32 v10, 0x2000, v10
  s_waitcnt vmcnt(5)
  v_xor_b32 v32, 2048, v2
  v_xor_b32 v40, 4096, v2
  v_xor_b32 v48, 6144, v2
  s_cmp_lt_u32 s69, s92
  s_cbranch_scc1 L_fs_f
L_fsback_f:
  s_add_u32 s56, s56, 1
  s_xor_b32 s65, s65, 1
  s_add_u32 s68, s56, 1
  s_min_u32 s68, s68, 63
  s_lshl_b32 s68, s68, 13
  s_add_u32 s57, s72, s68
  s_add_u32 s58, s57, 0x1000000
  s_add_u32 s68, s56, 3
  s_min_u32 s92, s68, 64
  s_add_u32 s61, s61, 0x20000
  s_xor_b32 s70, s70, 0x2000
  v_min_u32 v124, -2, v124
  v_bfe_u32 v45, v2, 9, 1
  v_and_b32 v4, 0x1ff, v2
  v_lshlrev_b32 v4, 2, v4
  s_add_u32 s59, s57, s73
  v_lshl_add_u32 v4, v45, 24, v4
  s_sub_u32 s68, s60, s59
  v_writelane_b32 v4, s68, 1
L_entry_f:
  s_waitcnt vmcnt(3)
  ds_write_b128 v2, v[20:23] offset:0
  v_smfmac_f32_16x16x64_bf16 v[52:55], v[20:23], a[0:7], v1
  s_waitcnt vmcnt(2)
  ds_write_b128 v2, v[24:27] offset:1024
  v_max3_u32 v44, v20, v21, v22
  v_max3_u32 v44, v44, v23, v24
  v_max3_u32 v44, v44, v25, v26
  v_max_u32 v44, v44, v27
  v_cmp_eq_u32 vcc, -1, v44
  v_smfmac_f32_16x16x64_bf16 v[56:59], v[20:23], a[64:71], v1
  s_mov_b32 m0, s70
  v_smfmac_f32_16x16x64_bf16 v[52:55], v[24:27], a[8:15], v1
  s_cbranch_vccnz L_retry2_f
  buffer_load_dwordx4 v2, s[40:43], s57 offen offset:0 sc1 lds
  v_smfmac_f32_16x16x64_bf16 v[56:59], v[24:27], a[72:79], v1
  buffer_load_dwordx4 v2, s[40:43], s57 offen offset:1024 sc1 lds
  s_mov_b32 m0, s71
  v_smfmac_f32_16x16x64_bf16 v[60:63], v[20:23], a[128:135], v1
  s_waitcnt lgkmcnt(2)
  buffer_load_dwordx4 v2, s[40:43], s58 offen offset:0 sc1 lds
  v_smfmac_f32_16x16x64_bf16 v[64:67], v[20:23], a[192:199], v1
  buffer_load_dwordx4 v2, s[40:43], s58 offen offset:1024 sc1 lds
  v_smfmac_f32_16x16x64_bf16 v[60:63], v[24:27], a[136:143], v1
  s_waitcnt vmcnt(4) lgkmcnt(0)
  s_barrier
  ds_read_b128 v[28:31], v32 offset:0
  ds_read_b128 v[32:35], v32 offset:1024
  v_smfmac_f32_16x16x64_bf16 v[64:67], v[24:27], a[200:207], v1
  ds_read_b128 v[36:39], v40 offset:0
  buffer_load_dword v4, v4, s[40:43], s59 offen sc1
  v_smfmac_f32_16x16x64_bf16 v[68:71], v[20:23], v[76:83], v1
  ds_read_b128 v[40:43], v40 offset:1024
  ds_read_b128 v[44:47], v48 offset:0
  v_smfmac_f32_16x16x64_bf16 v[72:75], v[20:23], v[84:91], v1
  ds_read_b128 v[48:51], v48 offset:1024
  v_smfmac_f32_16x16x64_bf16 v[68:71], v[24:27], v[92:99], v1
  buffer_store_dwordx4 v[124:127], v2, s[40:43], s61 offen sc1
  v_smfmac_f32_16x16x64_bf16 v[72:75], v[24:27], v[100:107], v1
  s_waitcnt lgkmcnt(5)
  ds_read_b128 v[76:79], v3 offset:16384
  v_smfmac_f32_16x16x64_bf16 v[52:55], v[28:31], a[16:23], v1
  s_waitcnt lgkmcnt(5)
  ds_read_b128 v[20:23], v3 offset:2048
  v_smfmac_f32_16x16x64_bf16 v[52:55], v[32:35], a[24:31], v1
  s_waitcnt lgkmcnt(5)
  ds_read_b128 v[24:27], v3 offset:3072
  v_smfmac_f32_16x16x64_bf16 v[52:55], v[36:39], a[32:39], v1
  s_waitcnt lgkmcnt(5)
  ds_read_b128 v[80:83], v3 offset:17408
  v_smfmac_f32_16x16x64_bf16 v[52:55], v[40:43], a[40:47], v1
  s_waitcnt lgkmcnt(4)
  ds_read_b128 v[84:87], v3 offset:18432
  v_smfmac_f32_16x16x64_bf16 v[52:55], v[44:47], a[48:55], v1
  ds_read_b128 v[88:91], v3 offset:19456
  v_smfmac_f32_16x16x64_bf16 v[52:55], v[48:51], a[56:63], v1
  s_nop 0
  ds_read_b128 v[92:95], v0 offset:0
  v_xor_b32 v3, 0x18000, v3
  v_smfmac_f32_16x16x64_bf16 v[68:71], v[28:31], v[108:115], v1
  s_nop 0
  ds_read_b128 v[96:99], v0 offset:2048
  v_smfmac_f32_16x16x64_bf16 v[56:59], v[28:31], a[80:87], v1
  s_nop 0
  ds_read_b128 v[108:111], v3 offset:0
  v_add_f32 v52, v52, v53
  v_smfmac_f32_16x16x64_bf16 v[56:59], v[32:35], a[88:95], v1
  s_waitcnt lgkmcnt(6)
  ds_read_b128 v[112:115], v3 offset:1024
  v_add_f32 v54, v54, v55
  v_smfmac_f32_16x16x64_bf16 v[72:75], v[28:31], v[20:27], v1
  ds_read_b128 v[100:103], v0 offset:4096
  v_mul_f32 v52, s88, v52
  v_smfmac_f32_16x16x64_bf16 v[56:59], v[36:39], a[96:103], v1
  ds_read_b128 v[20:23], v3 offset:2048
  v_mul_f32 v54, s88, v54
  v_smfmac_f32_16x16x64_bf16 v[56:59], v[40:43], a[104:111], v1
  ds_read_b128 v[24:27], v3 offset:3072
  v_cvt_pk_bf16_f32 v52, v52, v52
  v_smfmac_f32_16x16x64_bf16 v[56:59], v[44:47], a[112:119], v1
  s_barrier
  v_cvt_pk_bf16_f32 v53, v54, v54
  v_smfmac_f32_16x16x64_bf16 v[56:59], v[48:51], a[120:127], v1
  s_waitcnt lgkmcnt(7)
  ds_write_b64 v5, v[52:53] offset:0
  v_smfmac_f32_16x16x64_bf16 v[68:71], v[32:35], v[76:83], v1
  s_nop 0
  ds_read_b128 v[104:107], v0 offset:6144
  v_smfmac_f32_16x16x64_bf16 v[72:75], v[32:35], v[84:91], v1
  s_nop 0
  ds_read_b128 v[76:79], v3 offset:16384
  v_add_f32 v56, v56, v57
  v_smfmac_f32_16x16x64_bf16 v[60:63], v[28:31], a[144:151], v1
  ds_read_b128 v[80:83], v3 offset:17408
  v_add_f32 v58, v58, v59
  v_smfmac_f32_16x16x64_bf16 v[60:63], v[32:35], a[152:159], v1
  s_waitcnt lgkmcnt(4)
  ds_read_b128 v[84:87], v3 offset:18432
  v_mul_f32 v56, s88, v56
  v_smfmac_f32_16x16x64_bf16 v[68:71], v[36:39], v[108:115], v1
  ds_read_b128 v[88:91], v3 offset:19456
  v_mul_f32 v58, s88, v58
  v_smfmac_f32_16x16x64_bf16 v[60:63], v[36:39], a[160:167], v1
  v_cvt_pk_bf16_f32 v56, v56, v56
  v_smfmac_f32_16x16x64_bf16 v[72:75], v[36:39], v[20:27], v1
  v_cvt_pk_bf16_f32 v57, v58, v58
  v_smfmac_f32_16x16x64_bf16 v[60:63], v[40:43], a[168:175], v1
  ds_write_b64 v5, v[56:57] offset:2048
  v_xor_b32 v3, 0x8000, v3
  v_smfmac_f32_16x16x64_bf16 v[60:63], v[44:47], a[176:183], v1
  ds_read_b128 v[108:111], v3 offset:0
  v_smfmac_f32_16x16x64_bf16 v[60:63], v[48:51], a[184:191], v1
  s_waitcnt lgkmcnt(2)
  ds_read_b128 v[112:115], v3 offset:1024
  v_smfmac_f32_16x16x64_bf16 v[68:71], v[40:43], v[76:83], v1
  s_nop 0
  ds_read_b128 v[20:23], v3 offset:16384
  v_smfmac_f32_16x16x64_bf16 v[72:75], v[40:43], v[84:91], v1
  s_nop 0
  ds_read_b128 v[24:27], v3 offset:17408
  v_add_f32 v60, v60, v61
  v_smfmac_f32_16x16x64_bf16 v[64:67], v[28:31], a[208:215], v1
  s_waitcnt lgkmcnt(4)
  s_barrier
  v_add_f32 v62, v62, v63
  v_smfmac_f32_16x16x64_bf16 v[64:67], v[32:35], a[216:223], v1
  ds_read_b64_tr_b16 v[76:77], v6 offset:0
  ds_read_b64_tr_b16 v[78:79], v6 offset:2048
  v_smfmac_f32_16x16x64_bf16 v[64:67], v[36:39], a[224:231], v1
  ds_read_b64_tr_b16 v[80:81], v6 offset:512
  ds_read_b64_tr_b16 v[82:83], v6 offset:2560
  v_smfmac_f32_16x16x64_bf16 v[64:67], v[40:43], a[232:239], v1
  ds_read_b64_tr_b16 v[84:85], v6 offset:1024
  ds_read_b64_tr_b16 v[86:87], v6 offset:3072
  v_smfmac_f32_16x16x64_bf16 v[64:67], v[44:47], a[240:247], v1
  ds_read_b64_tr_b16 v[88:89], v6 offset:1536
  ds_read_b64_tr_b16 v[90:91], v6 offset:3584
  v_smfmac_f32_16x16x64_bf16 v[64:67], v[48:51], a[248:255], v1
  s_waitcnt lgkmcnt(8)
  ds_read_b128 v[28:31], v0 offset:1024
  v_cvt_pk_bf16_f32 v124, v60, v62
  v_smfmac_f32_16x16x64_bf16 v[68:71], v[44:47], v[108:115], v1
  s_nop 0
  ds_read_b128 v[32:35], v0 offset:3072
  v_smfmac_f32_16x16x64_bf16 v[68:71], v[48:51], v[20:27], v1
  s_waitcnt lgkmcnt(2)
  ds_read_b128 v[36:39], v0 offset:5120
  v_add_f32 v64, v64, v65
  v_mfma_f32_16x16x32_bf16 v[52:55], v[92:95], v[76:79], 0
  v_add_f32 v66, v66, v67
  v_cvt_pk_bf16_f32 v125, v64, v66
  v_mfma_f32_16x16x32_bf16 v[52:55], v[96:99], v[80:83], v[52:55]
  ds_write2st64_b32 v5, v124, v125 offset0:16 offset1:24
  ds_read_b128 v[40:43], v0 offset:7168
  v_mfma_f32_16x16x32_bf16 v[52:55], v[100:103], v[84:87], v[52:55]
  ds_read_b128 v[108:111], v3 offset:2048
  v_add_f32 v68, v68, v69
  v_mfma_f32_16x16x32_bf16 v[52:55], v[104:107], v[88:91], v[52:55]
  s_waitcnt lgkmcnt(3)
  ds_read_b128 v[112:115], v3 offset:3072
  v_add_f32 v70, v70, v71
  v_mfma_f32_16x16x32_bf16 v[56:59], v[28:31], v[76:79], 0
  ds_read_b128 v[20:23], v3 offset:18432
  v_cvt_pk_bf16_f32 v126, v68, v70
  v_mfma_f32_16x16x32_bf16 v[56:59], v[32:35], v[80:83], v[56:59]
  ds_read_b128 v[24:27], v3 offset:19456
  v_mfma_f32_16x16x32_bf16 v[56:59], v[36:39], v[84:87], v[56:59]
  s_waitcnt lgkmcnt(4)
  s_barrier
  ds_read_b64_tr_b16 v[92:93], v6 offset:4096
  ds_read_b64_tr_b16 v[94:95], v6 offset:6144
  v_mfma_f32_16x16x32_bf16 v[56:59], v[40:43], v[88:91], v[56:59]
  s_waitcnt lgkmcnt(4)
  ds_read_b64_tr_b16 v[96:97], v6 offset:4608
  ds_read_b64_tr_b16 v[98:99], v6 offset:6656
  v_smfmac_f32_16x16x64_bf16 v[72:75], v[44:47], v[108:115], v1
  s_waitcnt lgkmcnt(4)
  ds_read_b64_tr_b16 v[100:101], v6 offset:5120
  ds_read_b64_tr_b16 v[102:103], v6 offset:7168
  v_smfmac_f32_16x16x64_bf16 v[72:75], v[48:51], v[20:27], v1
  ds_read_b64_tr_b16 v[104:105], v6 offset:5632
  ds_read_b64_tr_b16 v[106:107], v6 offset:7680
  v_exp_f32 v28, v52
  v_exp_f32 v29, v53
  v_exp_f32 v30, v54
  s_waitcnt lgkmcnt(4)
  v_mfma_f32_16x16x32_bf16 v[60:63], v[92:95], v[76:79], 0
  v_exp_f32 v31, v55
  v_mfma_f32_16x16x32_bf16 v[60:63], v[96:99], v[80:83], v[60:63]
  s_waitcnt lgkmcnt(0)
  v_exp_f32 v36, v56
  v_mfma_f32_16x16x32_bf16 v[60:63], v[100:103], v[84:87], v[60:63]
  v_exp_f32 v37, v57
  v_mfma_f32_16x16x32_bf16 v[60:63], v[104:107], v[88:91], v[60:63]
  s_cmp_eq_u32 s56, 63
  v_exp_f32 v38, v58
  v_exp_f32 v39, v59
  v_cvt_pk_bf16_f32 v32, v28, v29
  v_cvt_pk_bf16_f32 v33, v30, v31
  v_cvt_pk_bf16_f32 v34, v36, v37
  v_cvt_pk_bf16_f32 v35, v38, v39
  v_add_f32 v72, v72, v73
  v_exp_f32 v28, v60
  v_mfma_f32_16x16x32_bf16 v[64:67], v[12:15], v[32:35], 0
  v_exp_f32 v29, v61
  v_mfma_f32_16x16x32_bf16 v[80:83], v[116:119], v[32:35], 0
  v_add_f32 v74, v74, v75
  v_cvt_pk_bf16_f32 v16, v28, v29
  v_mfma_f32_16x16x32_bf16 v[84:87], v[120:123], v[32:35], 0
  v_cvt_pk_bf16_f32 v127, v72, v74
  v_cvt_pk_bf16_f32 v19, v28, v29
  v_mfma_f32_16x16x16_bf16 v[64:67], v[12:13], v[16:17], v[64:67]
  s_cbranch_scc1 L_team_last
  v_xor_b32 v3, 0x18000, v3
  v_mov_b64 v[44:45], 0
  v_mfma_f32_16x16x16_bf16 v[80:83], v[126:127], v[16:17], v[80:83]
  s_nop 0
  v_mov_b64 v[46:47], 0
  v_mov_b64 v[48:49], 0
  v_mfma_f32_16x16x16_bf16 v[84:87], v[126:127], v[18:19], v[84:87]
  v_rcp_f32 v65, v64
  v_subrev_u32 v66, s89, v64
  v_cmp_le_u32 vcc, s91, v66
  v_mov_b64 v[50:51], 0
L_smback_f:
  v_mul_f32 v80, v80, v65
  v_mul_f32 v81, v81, v65
  v_mul_f32 v82, v82, v65
  v_mul_f32 v83, v83, v65
  v_cvt_pk_bf16_f32 v88, v80, v81
  v_cvt_pk_bf16_f32 v89, v82, v83
  ds_write_b64 v7, v[88:89]
  v_mul_f32 v84, v84, v65
  v_mul_f32 v85, v85, v65
  v_mul_f32 v86, v86, v65
  v_mul_f32 v87, v87, v65
  v_cvt_pk_bf16_f32 v90, v84, v85
  v_cvt_pk_bf16_f32 v91, v86, v87
  s_cbranch_vccnz L_smslow_f
  ds_write_b64 v7, v[90:91] offset:8
  v_xor_b32 v96, 512, v7
  v_xor_b32 v100, 1024, v7
  v_xor_b32 v104, 1536, v7
  v_mov_b64 v[36:37], 0
  v_mov_b64 v[38:39], 0
  v_mov_b64 v[40:41], 0
  v_mov_b64 v[42:43], 0
  v_lshrrev_b32 v24, 16, v12
  v_cndmask_b32 v24, v24, 1.0, s[94:95]
  v_cndmask_b32 v20, 0, v24, s[80:81]
  v_cndmask_b32 v21, 0, v24, s[82:83]
  v_cndmask_b32 v22, 0, v24, s[84:85]
  v_cndmask_b32 v23, 0, v24, s[86:87]
  v_smfmac_f32_16x16x64_bf16 v[48:51], v[88:91], v[224:231], v1
  s_waitcnt lgkmcnt(0)
  s_barrier
  ds_read_b128 v[96:99], v96
  v_smfmac_f32_16x16x64_bf16 v[44:47], v[88:91], v[192:199], v1
  ds_read_b128 v[100:103], v100
  ds_read_b128 v[104:107], v104
  v_smfmac_f32_16x16x64_bf16 v[40:43], v[88:91], v[160:167], v1
  v_mov_b64 v[60:61], 0
  v_smfmac_f32_16x16x64_bf16 v[36:39], v[88:91], v[128:135], v1
  v_mov_b64 v[62:63], 0
  v_mov_b64 v[64:65], 0
  v_mov_b64 v[66:67], 0
  s_waitcnt lgkmcnt(2)
  v_smfmac_f32_16x16x64_bf16 v[36:39], v[96:99], v[136:143], v1
  s_waitcnt lgkmcnt(1)
  v_mov_b64 v[52:53], 0
  v_smfmac_f32_16x16x64_bf16 v[36:39], v[100:103], v[144:151], v1
  s_waitcnt lgkmcnt(0)
  v_mov_b64 v[54:55], 0
  v_smfmac_f32_16x16x64_bf16 v[36:39], v[104:107], v[152:159], v1
  s_nop 1
  v_mov_b64 v[56:57], 0
  v_smfmac_f32_16x16x64_bf16 v[40:43], v[96:99], v[168:175], v1
  s_nop 1
  v_mov_b64 v[58:59], 0
  v_smfmac_f32_16x16x64_bf16 v[40:43], v[100:103], v[176:183], v1
  v_cvt_pk_bf16_f32 v36, v36, v37
  v_cvt_pk_bf16_f32 v37, v38, v39
  v_and_or_b32 v36, v36, -2, s65
  v_smfmac_f32_16x16x64_bf16 v[40:43], v[104:107], v[184:191], v1
  s_nop 1
  buffer_store_dwordx2 v[36:37], v8, s[40:43], s74 offen
  v_smfmac_f32_16x16x64_bf16 v[44:47], v[96:99], v[200:207], v1
  s_nop 2
  v_smfmac_f32_16x16x64_bf16 v[44:47], v[100:103], v[208:215], v1
  v_cvt_pk_bf16_f32 v40, v40, v41
  v_cvt_pk_bf16_f32 v41, v42, v43
  v_and_or_b32 v40, v40, -2, s65
  v_smfmac_f32_16x16x64_bf16 v[44:47], v[104:107], v[216:223], v1
  s_nop 1
  buffer_store_dwordx2 v[40:41], v8, s[40:43], s75 offen
  v_smfmac_f32_16x16x64_bf16 v[48:51], v[96:99], v[232:239], v1
  s_nop 2
  v_smfmac_f32_16x16x64_bf16 v[48:51], v[100:103], v[240:247], v1
  v_cvt_pk_bf16_f32 v44, v44, v45
  v_cvt_pk_bf16_f32 v45, v46, v47
  v_and_or_b32 v44, v44, -2, s65
  v_smfmac_f32_16x16x64_bf16 v[48:51], v[104:107], v[248:255], v1
  s_nop 1
  buffer_store_dwordx2 v[44:45], v8, s[40:43], s76 offen
  s_nop 4
  v_cvt_pk_bf16_f32 v48, v48, v49
  v_cvt_pk_bf16_f32 v49, v50, v51
  v_and_or_b32 v48, v48, -2, s65
  buffer_store_dwordx2 v[48:49], v8, s[40:43], s77 offen
  s_barrier
  s_nop 15
  s_nop 9
  s_cmp_lt_u32 s44, 1
  s_cbranch_scc1 L_poll1_f
  s_nop 9
  s_cmp_lt_u32 s44, 2
  s_cbranch_scc1 L_poll1_f
  s_nop 9
  s_cmp_lt_u32 s44, 3
  s_cbranch_scc1 L_poll1_f
  s_nop 9
L_poll1_f:
  buffer_load_dwordx4 v[28:31], v9, s[40:43], s62 offen sc1
  buffer_load_dwordx4 v[32:35], v9, s[40:43], s62 offen offset:1024 sc1
  v_mov_b64 v[64:65], 0
  v_mov_b64 v[66:67], 0
  v_mov_b64 v[68:69], 0
  v_mov_b64 v[70:71], 0
  v_mov_b64 v[72:73], 0
  v_mov_b64 v[74:75], 0
  s_xor_b32 s63, s63, 0x2000
  v_xor_b32 v0, 0x2000, v0
  v_xor_b32 v7, 0x2000, v7
  s_nop 15
  s_nop 3
  buffer_load_dwordx4 v[36:39], v9, s[40:43], s62 offen sc1
  buffer_load_dwordx4 v[40:43], v9, s[40:43], s62 offen offset:1024 sc1
  ds_read_b128 v[76:79], v3 offset:0
  ds_read_b128 v[80:83], v3 offset:1024
  ds_read_b128 v[84:87], v3 offset:2048
  ds_read_b128 v[88:91], v3 offset:3072
  ds_read_b128 v[92:95], v3 offset:16384
  ds_read_b128 v[96:99], v3 offset:17408
  ds_read_b128 v[100:103], v3 offset:18432
  ds_read_b128 v[104:107], v3 offset:19456
  v_xor_b32 v3, 0x8000, v3
  ds_read_b128 v[108:111], v3 offset:0
  ds_read_b128 v[112:115], v3 offset:1024
L_poll1b_f:
  s_waitcnt vmcnt(3)
  v_mfma_f32_16x16x32_bf16 v[24:27], v[28:31], v[20:23], 0
  v_bitop3_b32 v44, v28, v30, s65 bitop3:0x7e
  s_waitcnt vmcnt(2)
  v_mfma_f32_16x16x32_bf16 v[24:27], v[32:35], v[20:23], v[24:27]
  v_bitop3_b32 v45, v32, v34, s65 bitop3:0x7e
  v_or_b32 v44, v44, v45
  v_and_b32 v44, 1, v44
  v_cmp_ne_u32 vcc, 0, v44
  s_nop 2
  s_cbranch_vccnz L_retry1_f
L_got1_f:
  v_add_f32 v24, v24, v25
  v_add_f32 v26, v26, v27
  s_nop 1
  v_permlane16_swap_b32 v24, v26
  v_add_f32 v24, v24, v26
  v_cvt_pk_bf16_f32 v24, v24, v17
  v_min_u32 v24, s90, v24
  v_cndmask_b32 v24, v24, -1, s[78:79]
  buffer_store_short v24, v10, s[40:43], s64 offen
  s_nop 15
  s_nop 15
  s_nop 15
  s_nop 1
  s_branch L_poll2_f
L_retry2_f:
  s_waitcnt vmcnt(0)
  v_max3_u32 v44, v28, v29, v30
  v_max3_u32 v45, v31, v36, v37
  v_max3_u32 v44, v44, v38, v39
  v_max_u32 v44, v44, v45
  v_cmp_eq_u32 vcc, -1, v44
  v_mov_b64 v[20:21], v[28:29]
  v_mov_b64 v[22:23], v[30:31]
  v_mov_b64 v[24:25], v[36:37]
  v_mov_b64 v[26:27], v[38:39]
  v_mov_b64 v[52:53], 0
  v_mov_b64 v[54:55], 0
  v_mov_b64 v[56:57], 0
  v_mov_b64 v[58:59], 0
  s_cbranch_vccz L_entry_f
  buffer_load_dwordx4 v[20:23], v2, s[40:43], s63 offen sc1
  buffer_load_dwordx4 v[24:27], v2, s[40:43], s63 offen offset:1024 sc1
  s_add_u32 s67, s67, 1
  s_cmp_gt_u32 s67, 1048576
  s_cbranch_scc1 L_exit
  s_nop 15
  s_nop 3
  buffer_load_dwordx4 v[28:31], v2, s[40:43], s63 offen sc1
  buffer_load_dwordx4 v[36:39], v2, s[40:43], s63 offen offset:1024 sc1
  s_branch L_entry_f
L_retry1_f:
  buffer_load_dwordx4 v[28:31], v9, s[40:43], s62 offen sc1
  buffer_load_dwordx4 v[32:35], v9, s[40:43], s62 offen offset:1024 sc1
  s_waitcnt vmcnt(3)
  v_mfma_f32_16x16x32_bf16 v[24:27], v[36:39], v[20:23], 0
  v_bitop3_b32 v44, v36, v38, s65 bitop3:0x7e
  s_waitcnt vmcnt(2)
  v_mfma_f32_16x16x32_bf16 v[24:27], v[40:43], v[20:23], v[24:27]
  v_bitop3_b32 v45, v40, v42, s65 bitop3:0x7e
  v_or_b32 v44, v44, v45
  v_and_b32 v44, 1, v44
  v_cmp_ne_u32 vcc, 0, v44
  s_nop 2
  s_cbranch_vccnz L_retry1b_f
  v_add_f32 v24, v24, v25
  v_add_f32 v26, v26, v27
  s_nop 1
  v_permlane16_swap_b32 v24, v26
  v_add_f32 v24, v24, v26
  v_cvt_pk_bf16_f32 v24, v24, v17
  v_min_u32 v24, s90, v24
  v_cndmask_b32 v24, v24, -1, s[78:79]
  buffer_store_short v24, v10, s[40:43], s64 offen
  s_nop 15
  s_nop 15
  s_nop 15
  s_nop 1
  s_branch L_poll2_f
L_retry1b_f:
  buffer_load_dwordx4 v[36:39], v9, s[40:43], s62 offen sc1
  buffer_load_dwordx4 v[40:43], v9, s[40:43], s62 offen offset:1024 sc1
  s_add_u32 s67, s67, 1
  s_cmp_gt_u32 s67, 1048576
  s_cbranch_scc1 L_exit
  s_branch L_poll1b_f
L_smslow_f:
  v_max3_f32 v30, v52, v53, v54
  v_max3_f32 v30, v30, v55, v56
  v_max3_f32 v30, v30, v57, v58
  v_max3_f32 v30, v30, v59, v60
  v_max_f32 v30, v30, v61
  v_mov_b32 v28, v30
  s_nop 1
  v_permlane32_swap_b32 v28, v30
  v_max_f32 v30, v30, v28
  v_mov_b32 v28, v30
  s_nop 1
  v_permlane16_swap_b32 v28, v30
  v_max_f32 v30, v30, v28
  v_sub_f32 v28, v52, v30
  v_sub_f32 v29, v53, v30
  v_exp_f32 v28, v28
  v_exp_f32 v29, v29
  s_nop 0
  v_cvt_pk_bf16_f32 v32, v28, v29
  v_sub_f32 v28, v54, v30
  v_sub_f32 v29, v55, v30
  v_exp_f32 v28, v28
  v_exp_f32 v29, v29
  s_nop 0
  v_cvt_pk_bf16_f32 v33, v28, v29
  v_sub_f32 v28, v56, v30
  v_sub_f32 v29, v57, v30
  v_exp_f32 v28, v28
  v_exp_f32 v29, v29
  s_nop 0
  v_cvt_pk_bf16_f32 v34, v28, v29
  v_sub_f32 v28, v58, v30
  v_sub_f32 v29, v59, v30
  v_exp_f32 v28, v28
  v_exp_f32 v29, v29
  s_nop 0
  v_cvt_pk_bf16_f32 v35, v28, v29
  v_sub_f32 v28, v60, v30
  v_sub_f32 v29, v61, v30
  v_exp_f32 v28, v28
  v_exp_f32 v29, v29
  s_nop 0
  v_cvt_pk_bf16_f32 v16, v28, v29
  v_cvt_pk_bf16_f32 v19, v28, v29
  s_nop 1
  v_mfma_f32_16x16x32_bf16 v[64:67], v[12:15], v[32:35], 0
  v_mfma_f32_16x16x32_bf16 v[80:83], v[116:119], v[32:35], 0
  v_mfma_f32_16x16x32_bf16 v[84:87], v[120:123], v[32:35], 0
  s_nop 3
  v_mfma_f32_16x16x16_bf16 v[64:67], v[12:13], v[16:17], v[64:67]
  v_mfma_f32_16x16x16_bf16 v[80:83], v[126:127], v[16:17], v[80:83]
  v_mfma_f32_16x16x16_bf16 v[84:87], v[126:127], v[18:19], v[84:87]
  s_nop 7
  v_rcp_f32 v65, v64
  s_mov_b64 vcc, 0
  s_branch L_smback_f
L_fs_f:
  buffer_load_dword v4, v17, s[40:43], s60 offen sc1
  s_add_u32 s67, s67, 1
  s_cmp_gt_u32 s67, 1048576
  s_cbranch_scc1 L_exit
  s_waitcnt vmcnt(0)
  v_cmp_gt_u32 vcc, s92, v4
  s_cbranch_vccnz L_fs_f
  s_branch L_fsback_f
L_poll2_x:
  buffer_load_dwordx4 v[20:23], v2, s[40:43], s63 offen sc1
  buffer_load_dwordx4 v[24:27], v2, s[40:43], s63 offen offset:1024 sc1
  s_nop 15
  s_nop 6
  buffer_load_dwordx4 v[28:31], v2, s[40:43], s63 offen sc1
  buffer_load_dwordx4 v[36:39], v2, s[40:43], s63 offen offset:1024 sc1
  ds_read_b128 v[116:119], v2 offset:8192
  ds_read_b128 v[120:123], v2 offset:9216
  v_readlane_b32 s69, v4, 1
  v_xor_b32 v10, 0x2000, v10
  s_waitcnt vmcnt(5)
  v_xor_b32 v32, 2048, v2
  v_xor_b32 v40, 4096, v2
  v_xor_b32 v48, 6144, v2
  s_cmp_lt_u32 s69, s92
  s_cbranch_scc1 L_fs_x
L_fsback_x:
  s_add_u32 s56, s56, 1
  s_xor_b32 s65, s65, 1
  s_add_u32 s68, s56, 1
  s_min_u32 s68, s68, 63
  s_lshl_b32 s68, s68, 13
  s_add_u32 s57, s72, s68
  s_add_u32 s58, s57, 0x1000000
  s_add_u32 s68, s56, 3
  s_min_u32 s92, s68, 64
  s_add_u32 s61, s61, 0x20000
  s_xor_b32 s70, s70, 0x2000
  v_min_u32 v124, -2, v124
  v_bfe_u32 v45, v2, 9, 1
  v_and_b32 v4, 0x1ff, v2
  v_lshlrev_b32 v4, 2, v4
  s_add_u32 s59, s57, s73
  v_lshl_add_u32 v4, v45, 24, v4
  s_sub_u32 s68, s60, s59
  v_writelane_b32 v4, s68, 1
L_entry_x:
  s_waitcnt vmcnt(3)
  ds_write_b128 v2, v[20:23] offset:0
  v_smfmac_f32_16x16x64_bf16 v[52:55], v[20:23], a[0:7], v1
  s_waitcnt vmcnt(2)
  ds_write_b128 v2, v[24:27] offset:1024
  v_max3_u32 v44, v20, v21, v22
  v_max3_u32 v44, v44, v23, v24
  v_max3_u32 v44, v44, v25, v26
  v_max_u32 v44, v44, v27
  v_cmp_eq_u32 vcc, -1, v44
  v_smfmac_f32_16x16x64_bf16 v[56:59], v[20:23], a[64:71], v1
  s_mov_b32 m0, s70
  v_smfmac_f32_16x16x64_bf16 v[52:55], v[24:27], a[8:15], v1
  s_cbranch_vccnz L_retry2_x
  buffer_load_dwordx4 v2, s[40:43], s57 offen offset:0 sc1 lds
  v_smfmac_f32_16x16x64_bf16 v[56:59], v[24:27], a[72:79], v1
  buffer_load_dwordx4 v2, s[40:43], s57 offen offset:1024 sc1 lds
  s_mov_b32 m0, s71
  v_smfmac_f32_16x16x64_bf16 v[60:63], v[20:23], a[128:135], v1
  s_waitcnt lgkmcnt(2)
  buffer_load_dwordx4 v2, s[40:43], s58 offen offset:0 sc1 lds
  v_smfmac_f32_16x16x64_bf16 v[64:67], v[20:23], a[192:199], v1
  buffer_load_dwordx4 v2, s[40:43], s58 offen offset:1024 sc1 lds
  v_smfmac_f32_16x16x64_bf16 v[60:63], v[24:27], a[136:143], v1
  s_waitcnt vmcnt(4) lgkmcnt(0)
  s_barrier
  ds_read_b128 v[28:31], v32 offset:0
  ds_read_b128 v[32:35], v32 offset:1024
  v_smfmac_f32_16x16x64_bf16 v[64:67], v[24:27], a[200:207], v1
  ds_read_b128 v[36:39], v40 offset:0
  buffer_load_dword v4, v4, s[40:43], s59 offen sc1
  v_smfmac_f32_16x16x64_bf16 v[68:71], v[20:23], v[76:83], v1
  ds_read_b128 v[40:43], v40 offset:1024
  ds_read_b128 v[44:47], v48 offset:0
  v_smfmac_f32_16x16x64_bf16 v[72:75], v[20:23], v[84:91], v1
  ds_read_b128 v[48:51], v48 offset:1024
  v_smfmac_f32_16x16x64_bf16 v[68:71], v[24:27], v[92:99], v1
  buffer_store_dwordx4 v[124:127], v2, s[40:43], s61 offen sc1
  v_smfmac_f32_16x16x64_bf16 v[72:75], v[24:27], v[100:107], v1
  s_waitcnt lgkmcnt(5)
  ds_read_b128 v[76:79], v3 offset:16384
  v_smfmac_f32_16x16x64_bf16 v[52:55], v[28:31], a[16:23], v1
  s_waitcnt lgkmcnt(5)
  ds_read_b128 v[20:23], v3 offset:2048
  v_smfmac_f32_16x16x64_bf16 v[52:55], v[32:35], a[24:31], v1
  s_waitcnt lgkmcnt(5)
  ds_read_b128 v[24:27], v3 offset:3072
  v_smfmac_f32_16x16x64_bf16 v[52:55], v[36:39], a[32:39], v1
  s_waitcnt lgkmcnt(5)
  ds_read_b128 v[80:83], v3 offset:17408
  v_smfmac_f32_16x16x64_bf16 v[52:55], v[40:43], a[40:47], v1
  s_waitcnt lgkmcnt(4)
  ds_read_b128 v[84:87], v3 offset:18432
  v_smfmac_f32_16x16x64_bf16 v[52:55], v[44:47], a[48:55], v1
  ds_read_b128 v[88:91], v3 offset:19456
  v_smfmac_f32_16x16x64_bf16 v[52:55], v[48:51], a[56:63], v1
  s_nop 0
  ds_read_b128 v[92:95], v0 offset:0
  v_xor_b32 v3, 0x18000, v3
  v_smfmac_f32_16x16x64_bf16 v[68:71], v[28:31], v[108:115], v1
  s_nop 0
  ds_read_b128 v[96:99], v0 offset:2048
  v_smfmac_f32_16x16x64_bf16 v[56:59], v[28:31], a[80:87], v1
  s_nop 0
  ds_read_b128 v[108:111], v3 offset:0
  v_add_f32 v52, v52, v53
  v_smfmac_f32_16x16x64_bf16 v[56:59], v[32:35], a[88:95], v1
  s_waitcnt lgkmcnt(6)
  ds_read_b128 v[112:115], v3 offset:1024
  v_add_f32 v54, v54, v55
  v_smfmac_f32_16x16x64_bf16 v[72:75], v[28:31], v[20:27], v1
  ds_read_b128 v[100:103], v0 offset:4096
  v_mul_f32 v52, s88, v52
  v_smfmac_f32_16x16x64_bf16 v[56:59], v[36:39], a[96:103], v1
  ds_read_b128 v[20:23], v3 offset:2048
  v_mul_f32 v54, s88, v54
  v_smfmac_f32_16x16x64_bf16 v[56:59], v[40:43], a[104:111], v1
  ds_read_b128 v[24:27], v3 offset:3072
  v_cvt_pk_bf16_f32 v52, v52, v52
  v_smfmac_f32_16x16x64_bf16 v[56:59], v[44:47], a[112:119], v1
  s_barrier
  v_cvt_pk_bf16_f32 v53, v54, v54
  v_smfmac_f32_16x16x64_bf16 v[56:59], v[48:51], a[120:127], v1
  s_waitcnt lgkmcnt(7)
  ds_write_b64 v5, v[52:53] offset:0
  v_smfmac_f32_16x16x64_bf16 v[68:71], v[32:35], v[76:83], v1
  s_nop 0
  ds_read_b128 v[104:107], v0 offset:6144
  v_smfmac_f32_16x16x64_bf16 v[72:75], v[32:35], v[84:91], v1
  s_nop 0
  ds_read_b128 v[76:79], v3 offset:16384
  v_add_f32 v56, v56, v57
  v_smfmac_f32_16x16x64_bf16 v[60:63], v[28:31], a[144:151], v1
  ds_read_b128 v[80:83], v3 offset:17408
  v_add_f32 v58, v58, v59
  v_smfmac_f32_16x16x64_bf16 v[60:63], v[32:35], a[152:159], v1
  s_waitcnt lgkmcnt(4)
  ds_read_b128 v[84:87], v3 offset:18432
  v_mul_f32 v56, s88, v56
  v_smfmac_f32_16x16x64_bf16 v[68:71], v[36:39], v[108:115], v1
  ds_read_b128 v[88:91], v3 offset:19456
  v_mul_f32 v58, s88, v58
  v_smfmac_f32_16x16x64_bf16 v[60:63], v[36:39], a[160:167], v1
  v_cvt_pk_bf16_f32 v56, v56, v56
  v_smfmac_f32_16x16x64_bf16 v[72:75], v[36:39], v[20:27], v1
  v_cvt_pk_bf16_f32 v57, v58, v58
  v_smfmac_f32_16x16x64_bf16 v[60:63], v[40:43], a[168:175], v1
  ds_write_b64 v5, v[56:57] offset:2048
  v_xor_b32 v3, 0x8000, v3
  v_smfmac_f32_16x16x64_bf16 v[60:63], v[44:47], a[176:183], v1
  ds_read_b128 v[108:111], v3 offset:0
  v_smfmac_f32_16x16x64_bf16 v[60:63], v[48:51], a[184:191], v1
  s_waitcnt lgkmcnt(2)
  ds_read_b128 v[112:115], v3 offset:1024
  v_smfmac_f32_16x16x64_bf16 v[68:71], v[40:43], v[76:83], v1
  s_nop 0
  ds_read_b128 v[20:23], v3 offset:16384
  v_smfmac_f32_16x16x64_bf16 v[72:75], v[40:43], v[84:91], v1
  s_nop 0
  ds_read_b128 v[24:27], v3 offset:17408
  v_add_f32 v60, v60, v61
  v_smfmac_f32_16x16x64_bf16 v[64:67], v[28:31], a[208:215], v1
  s_waitcnt lgkmcnt(4)
  s_barrier
  v_add_f32 v62, v62, v63
  v_smfmac_f32_16x16x64_bf16 v[64:67], v[32:35], a[216:223], v1
  ds_read_b64_tr_b16 v[76:77], v6 offset:0
  ds_read_b64_tr_b16 v[78:79], v6 offset:2048
  v_smfmac_f32_16x16x64_bf16 v[64:67], v[36:39], a[224:231], v1
  ds_read_b64_tr_b16 v[80:81], v6 offset:512
  ds_read_b64_tr_b16 v[82:83], v6 offset:2560
  v_smfmac_f32_16x16x64_bf16 v[64:67], v[40:43], a[232:239], v1
  ds_read_b64_tr_b16 v[84:85], v6 offset:1024
  ds_read_b64_tr_b16 v[86:87], v6 offset:3072
  v_smfmac_f32_16x16x64_bf16 v[64:67], v[44:47], a[240:247], v1
  ds_read_b64_tr_b16 v[88:89], v6 offset:1536
  ds_read_b64_tr_b16 v[90:91], v6 offset:3584
  v_smfmac_f32_16x16x64_bf16 v[64:67], v[48:51], a[248:255], v1
  s_waitcnt lgkmcnt(8)
  ds_read_b128 v[28:31], v0 offset:1024
  v_cvt_pk_bf16_f32 v124, v60, v62
  v_smfmac_f32_16x16x64_bf16 v[68:71], v[44:47], v[108:115], v1
  s_nop 0
  ds_read_b128 v[32:35], v0 offset:3072
  v_smfmac_f32_16x16x64_bf16 v[68:71], v[48:51], v[20:27], v1
  s_waitcnt lgkmcnt(2)
  ds_read_b128 v[36:39], v0 offset:5120
  v_add_f32 v64, v64, v65
  v_mfma_f32_16x16x32_bf16 v[52:55], v[92:95], v[76:79], 0
  v_add_f32 v66, v66, v67
  v_cvt_pk_bf16_f32 v125, v64, v66
  v_mfma_f32_16x16x32_bf16 v[52:55], v[96:99], v[80:83], v[52:55]
  ds_write2st64_b32 v5, v124, v125 offset0:16 offset1:24
  ds_read_b128 v[40:43], v0 offset:7168
  v_mfma_f32_16x16x32_bf16 v[52:55], v[100:103], v[84:87], v[52:55]
  ds_read_b128 v[108:111], v3 offset:2048
  v_add_f32 v68, v68, v69
  v_mfma_f32_16x16x32_bf16 v[52:55], v[104:107], v[88:91], v[52:55]
  s_waitcnt lgkmcnt(3)
  ds_read_b128 v[112:115], v3 offset:3072
  v_add_f32 v70, v70, v71
  v_mfma_f32_16x16x32_bf16 v[56:59], v[28:31], v[76:79], 0
  ds_read_b128 v[20:23], v3 offset:18432
  v_cvt_pk_bf16_f32 v126, v68, v70
  v_mfma_f32_16x16x32_bf16 v[56:59], v[32:35], v[80:83], v[56:59]
  ds_read_b128 v[24:27], v3 offset:19456
  v_mfma_f32_16x16x32_bf16 v[56:59], v[36:39], v[84:87], v[56:59]
  s_waitcnt lgkmcnt(4)
  s_barrier
  ds_read_b64_tr_b16 v[92:93], v6 offset:4096
  ds_read_b64_tr_b16 v[94:95], v6 offset:6144
  v_mfma_f32_16x16x32_bf16 v[56:59], v[40:43], v[88:91], v[56:59]
  s_waitcnt lgkmcnt(4)
  ds_read_b64_tr_b16 v[96:97], v6 offset:4608
  ds_read_b64_tr_b16 v[98:99], v6 offset:6656
  v_smfmac_f32_16x16x64_bf16 v[72:75], v[44:47], v[108:115], v1
  s_waitcnt lgkmcnt(4)
  ds_read_b64_tr_b16 v[100:101], v6 offset:5120
  ds_read_b64_tr_b16 v[102:103], v6 offset:7168
  v_smfmac_f32_16x16x64_bf16 v[72:75], v[48:51], v[20:27], v1
  ds_read_b64_tr_b16 v[104:105], v6 offset:5632
  ds_read_b64_tr_b16 v[106:107], v6 offset:7680
  v_exp_f32 v28, v52
  v_exp_f32 v29, v53
  v_exp_f32 v30, v54
  s_waitcnt lgkmcnt(4)
  v_mfma_f32_16x16x32_bf16 v[60:63], v[92:95], v[76:79], 0
  v_exp_f32 v31, v55
  v_mfma_f32_16x16x32_bf16 v[60:63], v[96:99], v[80:83], v[60:63]
  s_waitcnt lgkmcnt(0)
  v_exp_f32 v36, v56
  v_mfma_f32_16x16x32_bf16 v[60:63], v[100:103], v[84:87], v[60:63]
  v_exp_f32 v37, v57
  v_mfma_f32_16x16x32_bf16 v[60:63], v[104:107], v[88:91], v[60:63]
  s_cmp_eq_u32 s56, 63
  v_exp_f32 v38, v58
  v_exp_f32 v39, v59
  v_cvt_pk_bf16_f32 v32, v28, v29
  v_cvt_pk_bf16_f32 v33, v30, v31
  v_cvt_pk_bf16_f32 v34, v36, v37
  v_cvt_pk_bf16_f32 v35, v38, v39
  v_add_f32 v72, v72, v73
  v_exp_f32 v28, v60
  v_mfma_f32_16x16x32_bf16 v[64:67], v[12:15], v[32:35], 0
  v_exp_f32 v29, v61
  v_mfma_f32_16x16x32_bf16 v[80:83], v[116:119], v[32:35], 0
  v_add_f32 v74, v74, v75
  v_cvt_pk_bf16_f32 v16, v28, v29
  v_mfma_f32_16x16x32_bf16 v[84:87], v[120:123], v[32:35], 0
  v_cvt_pk_bf16_f32 v127, v72, v74
  v_cvt_pk_bf16_f32 v19, v28, v29
  v_mfma_f32_16x16x16_bf16 v[64:67], v[12:13], v[16:17], v[64:67]
  s_cbranch_scc1 L_team_last
  v_xor_b32 v3, 0x18000, v3
  v_mov_b64 v[44:45], 0
  v_mfma_f32_16x16x16_bf16 v[80:83], v[126:127], v[16:17], v[80:83]
  s_nop 0
  v_mov_b64 v[46:47], 0
  v_mov_b64 v[48:49], 0
  v_mfma_f32_16x16x16_bf16 v[84:87], v[126:127], v[18:19], v[84:87]
  v_rcp_f32 v65, v64
  v_subrev_u32 v66, s89, v64
  v_cmp_le_u32 vcc, s91, v66
  v_mov_b64 v[50:51], 0
L_smback_x:
  v_mul_f32 v80, v80, v65
  v_mul_f32 v81, v81, v65
  v_mul_f32 v82, v82, v65
  v_mul_f32 v83, v83, v65
  v_cvt_pk_bf16_f32 v88, v80, v81
  v_cvt_pk_bf16_f32 v89, v82, v83
  ds_write_b64 v7, v[88:89]
  v_mul_f32 v84, v84, v65
  v_mul_f32 v85, v85, v65
  v_mul_f32 v86, v86, v65
  v_mul_f32 v87, v87, v65
  v_cvt_pk_bf16_f32 v90, v84, v85
  v_cvt_pk_bf16_f32 v91, v86, v87
  s_cbranch_vccnz L_smslow_x
  ds_write_b64 v7, v[90:91] offset:8
  v_xor_b32 v96, 512, v7
  v_xor_b32 v100, 1024, v7
  v_xor_b32 v104, 1536, v7
  v_mov_b64 v[36:37], 0
  v_mov_b64 v[38:39], 0
  v_mov_b64 v[40:41], 0
  v_mov_b64 v[42:43], 0
  v_lshrrev_b32 v24, 16, v12
  v_cndmask_b32 v24, v24, 1.0, s[94:95]
  v_cndmask_b32 v20, 0, v24, s[80:81]
  v_cndmask_b32 v21, 0, v24, s[82:83]
  v_cndmask_b32 v22, 0, v24, s[84:85]
  v_cndmask_b32 v23, 0, v24, s[86:87]
  v_smfmac_f32_16x16x64_bf16 v[48:51], v[88:91], v[224:231], v1
  s_waitcnt lgkmcnt(0)
  s_barrier
  ds_read_b128 v[96:99], v96
  v_smfmac_f32_16x16x64_bf16 v[44:47], v[88:91], v[192:199], v1
  ds_read_b128 v[100:103], v100
  ds_read_b128 v[104:107], v104
  v_smfmac_f32_16x16x64_bf16 v[40:43], v[88:91], v[160:167], v1
  v_mov_b64 v[60:61], 0
  v_smfmac_f32_16x16x64_bf16 v[36:39], v[88:91], v[128:135], v1
  v_mov_b64 v[62:63], 0
  v_mov_b64 v[64:65], 0
  v_mov_b64 v[66:67], 0
  s_waitcnt lgkmcnt(2)
  v_smfmac_f32_16x16x64_bf16 v[36:39], v[96:99], v[136:143], v1
  s_waitcnt lgkmcnt(1)
  v_mov_b64 v[52:53], 0
  v_smfmac_f32_16x16x64_bf16 v[36:39], v[100:103], v[144:151], v1
  s_waitcnt lgkmcnt(0)
  v_mov_b64 v[54:55], 0
  v_smfmac_f32_16x16x64_bf16 v[36:39], v[104:107], v[152:159], v1
  s_nop 1
  v_mov_b64 v[56:57], 0
  v_smfmac_f32_16x16x64_bf16 v[40:43], v[96:99], v[168:175], v1
  s_nop 1
  v_mov_b64 v[58:59], 0
  v_smfmac_f32_16x16x64_bf16 v[40:43], v[100:103], v[176:183], v1
  v_cvt_pk_bf16_f32 v36, v36, v37
  v_cvt_pk_bf16_f32 v37, v38, v39
  v_and_or_b32 v36, v36, -2, s65
  v_smfmac_f32_16x16x64_bf16 v[40:43], v[104:107], v[184:191], v1
  s_nop 1
  buffer_store_dwordx2 v[36:37], v8, s[40:43], s74 offen sc1
  v_smfmac_f32_16x16x64_bf16 v[44:47], v[96:99], v[200:207], v1
  s_nop 2
  v_smfmac_f32_16x16x64_bf16 v[44:47], v[100:103], v[208:215], v1
  v_cvt_pk_bf16_f32 v40, v40, v41
  v_cvt_pk_bf16_f32 v41, v42, v43
  v_and_or_b32 v40, v40, -2, s65
  v_smfmac_f32_16x16x64_bf16 v[44:47], v[104:107], v[216:223], v1
  s_nop 1
  buffer_store_dwordx2 v[40:41], v8, s[40:43], s75 offen sc1
  v_smfmac_f32_16x16x64_bf16 v[48:51], v[96:99], v[232:239], v1
  s_nop 2
  v_smfmac_f32_16x16x64_bf16 v[48:51], v[100:103], v[240:247], v1
  v_cvt_pk_bf16_f32 v44, v44, v45
  v_cvt_pk_bf16_f32 v45, v46, v47
  v_and_or_b32 v44, v44, -2, s65
  v_smfmac_f32_16x16x64_bf16 v[48:51], v[104:107], v[248:255], v1
  s_nop 1
  buffer_store_dwordx2 v[44:45], v8, s[40:43], s76 offen sc1
  s_nop 4
  v_cvt_pk_bf16_f32 v48, v48, v49
  v_cvt_pk_bf16_f32 v49, v50, v51
  v_and_or_b32 v48, v48, -2, s65
  buffer_store_dwordx2 v[48:49], v8, s[40:43], s77 offen sc1
  s_barrier
  s_nop 15
  s_nop 9
  s_cmp_lt_u32 s44, 1
  s_cbranch_scc1 L_poll1_x
  s_nop 9
  s_cmp_lt_u32 s44, 2
  s_cbranch_scc1 L_poll1_x
  s_nop 9
  s_cmp_lt_u32 s44, 3
  s_cbranch_scc1 L_poll1_x
  s_nop 9
L_poll1_x:
  buffer_load_dwordx4 v[28:31], v9, s[40:43], s62 offen sc1
  buffer_load_dwordx4 v[32:35], v9, s[40:43], s62 offen offset:1024 sc1
  v_mov_b64 v[64:65], 0
  v_mov_b64 v[66:67], 0
  v_mov_b64 v[68:69], 0
  v_mov_b64 v[70:71], 0
  v_mov_b64 v[72:73], 0
  v_mov_b64 v[74:75], 0
  s_xor_b32 s63, s63, 0x2000
  v_xor_b32 v0, 0x2000, v0
  v_xor_b32 v7, 0x2000, v7
  s_nop 15
  s_nop 3
  buffer_load_dwordx4 v[36:39], v9, s[40:43], s62 offen sc1
  buffer_load_dwordx4 v[40:43], v9, s[40:43], s62 offen offset:1024 sc1
  ds_read_b128 v[76:79], v3 offset:0
  ds_read_b128 v[80:83], v3 offset:1024
  ds_read_b128 v[84:87], v3 offset:2048
  ds_read_b128 v[88:91], v3 offset:3072
  ds_read_b128 v[92:95], v3 offset:16384
  ds_read_b128 v[96:99], v3 offset:17408
  ds_read_b128 v[100:103], v3 offset:18432
  ds_read_b128 v[104:107], v3 offset:19456
  v_xor_b32 v3, 0x8000, v3
  ds_read_b128 v[108:111], v3 offset:0
  ds_read_b128 v[112:115], v3 offset:1024
L_poll1b_x:
  s_waitcnt vmcnt(3)
  v_mfma_f32_16x16x32_bf16 v[24:27], v[28:31], v[20:23], 0
  v_bitop3_b32 v44, v28, v30, s65 bitop3:0x7e
  s_waitcnt vmcnt(2)
  v_mfma_f32_16x16x32_bf16 v[24:27], v[32:35], v[20:23], v[24:27]
  v_bitop3_b32 v45, v32, v34, s65 bitop3:0x7e
  v_or_b32 v44, v44, v45
  v_and_b32 v44, 1, v44
  v_cmp_ne_u32 vcc, 0, v44
  s_nop 2
  s_cbranch_vccnz L_retry1_x
L_got1_x:
  v_add_f32 v24, v24, v25
  v_add_f32 v26, v26, v27
  s_nop 1
  v_permlane16_swap_b32 v24, v26
  v_add_f32 v24, v24, v26
  v_cvt_pk_bf16_f32 v24, v24, v17
  v_min_u32 v24, s90, v24
  v_cndmask_b32 v24, v24, -1, s[78:79]
  buffer_store_short v24, v10, s[40:43], s64 offen sc1
  s_nop 15
  s_nop 15
  s_nop 15
  s_nop 1
  s_branch L_poll2_x
L_retry2_x:
  s_waitcnt vmcnt(0)
  v_max3_u32 v44, v28, v29, v30
  v_max3_u32 v45, v31, v36, v37
  v_max3_u32 v44, v44, v38, v39
  v_max_u32 v44, v44, v45
  v_cmp_eq_u32 vcc, -1, v44
  v_mov_b64 v[20:21], v[28:29]
  v_mov_b64 v[22:23], v[30:31]
  v_mov_b64 v[24:25], v[36:37]
  v_mov_b64 v[26:27], v[38:39]
  v_mov_b64 v[52:53], 0
  v_mov_b64 v[54:55], 0
  v_mov_b64 v[56:57], 0
  v_mov_b64 v[58:59], 0
  s_cbranch_vccz L_entry_x
  buffer_load_dwordx4 v[20:23], v2, s[40:43], s63 offen sc1
  buffer_load_dwordx4 v[24:27], v2, s[40:43], s63 offen offset:1024 sc1
  s_add_u32 s67, s67, 1
  s_cmp_gt_u32 s67, 1048576
  s_cbranch_scc1 L_exit
  s_nop 15
  s_nop 3
  buffer_load_dwordx4 v[28:31], v2, s[40:43], s63 offen sc1
  buffer_load_dwordx4 v[36:39], v2, s[40:43], s63 offen offset:1024 sc1
  s_branch L_entry_x
L_retry1_x:
  buffer_load_dwordx4 v[28:31], v9, s[40:43], s62 offen sc1
  buffer_load_dwordx4 v[32:35], v9, s[40:43], s62 offen offset:1024 sc1
  s_waitcnt vmcnt(3)
  v_mfma_f32_16x16x32_bf16 v[24:27], v[36:39], v[20:23], 0
  v_bitop3_b32 v44, v36, v38, s65 bitop3:0x7e
  s_waitcnt vmcnt(2)
  v_mfma_f32_16x16x32_bf16 v[24:27], v[40:43], v[20:23], v[24:27]
  v_bitop3_b32 v45, v40, v42, s65 bitop3:0x7e
  v_or_b32 v44, v44, v45
  v_and_b32 v44, 1, v44
  v_cmp_ne_u32 vcc, 0, v44
  s_nop 2
  s_cbranch_vccnz L_retry1b_x
  v_add_f32 v24, v24, v25
  v_add_f32 v26, v26, v27
  s_nop 1
  v_permlane16_swap_b32 v24, v26
  v_add_f32 v24, v24, v26
  v_cvt_pk_bf16_f32 v24, v24, v17
  v_min_u32 v24, s90, v24
  v_cndmask_b32 v24, v24, -1, s[78:79]
  buffer_store_short v24, v10, s[40:43], s64 offen sc1
  s_nop 15
  s_nop 15
  s_nop 15
  s_nop 1
  s_branch L_poll2_x
L_retry1b_x:
  buffer_load_dwordx4 v[36:39], v9, s[40:43], s62 offen sc1
  buffer_load_dwordx4 v[40:43], v9, s[40:43], s62 offen offset:1024 sc1
  s_add_u32 s67, s67, 1
  s_cmp_gt_u32 s67, 1048576
  s_cbranch_scc1 L_exit
  s_branch L_poll1b_x
L_smslow_x:
  v_max3_f32 v30, v52, v53, v54
  v_max3_f32 v30, v30, v55, v56
  v_max3_f32 v30, v30, v57, v58
  v_max3_f32 v30, v30, v59, v60
  v_max_f32 v30, v30, v61
  v_mov_b32 v28, v30
  s_nop 1
  v_permlane32_swap_b32 v28, v30
  v_max_f32 v30, v30, v28
  v_mov_b32 v28, v30
  s_nop 1
  v_permlane16_swap_b32 v28, v30
  v_max_f32 v30, v30, v28
  v_sub_f32 v28, v52, v30
  v_sub_f32 v29, v53, v30
  v_exp_f32 v28, v28
  v_exp_f32 v29, v29
  s_nop 0
  v_cvt_pk_bf16_f32 v32, v28, v29
  v_sub_f32 v28, v54, v30
  v_sub_f32 v29, v55, v30
  v_exp_f32 v28, v28
  v_exp_f32 v29, v29
  s_nop 0
  v_cvt_pk_bf16_f32 v33, v28, v29
  v_sub_f32 v28, v56, v30
  v_sub_f32 v29, v57, v30
  v_exp_f32 v28, v28
  v_exp_f32 v29, v29
  s_nop 0
  v_cvt_pk_bf16_f32 v34, v28, v29
  v_sub_f32 v28, v58, v30
  v_sub_f32 v29, v59, v30
  v_exp_f32 v28, v28
  v_exp_f32 v29, v29
  s_nop 0
  v_cvt_pk_bf16_f32 v35, v28, v29
  v_sub_f32 v28, v60, v30
  v_sub_f32 v29, v61, v30
  v_exp_f32 v28, v28
  v_exp_f32 v29, v29
  s_nop 0
  v_cvt_pk_bf16_f32 v16, v28, v29
  v_cvt_pk_bf16_f32 v19, v28, v29
  s_nop 1
  v_mfma_f32_16x16x32_bf16 v[64:67], v[12:15], v[32:35], 0
  v_mfma_f32_16x16x32_bf16 v[80:83], v[116:119], v[32:35], 0
  v_mfma_f32_16x16x32_bf16 v[84:87], v[120:123], v[32:35], 0
  s_nop 3
  v_mfma_f32_16x16x16_bf16 v[64:67], v[12:13], v[16:17], v[64:67]
  v_mfma_f32_16x16x16_bf16 v[80:83], v[126:127], v[16:17], v[80:83]
  v_mfma_f32_16x16x16_bf16 v[84:87], v[126:127], v[18:19], v[84:87]
  s_nop 7
  v_rcp_f32 v65, v64
  s_mov_b64 vcc, 0
  s_branch L_smback_x
L_fs_x:
  buffer_load_dword v4, v17, s[40:43], s60 offen sc1
  s_add_u32 s67, s67, 1
  s_cmp_gt_u32 s67, 1048576
  s_cbranch_scc1 L_exit
  s_waitcnt vmcnt(0)
  v_cmp_gt_u32 vcc, s92, v4
  s_cbranch_vccnz L_fs_x
  s_branch L_fsback_x
L_team_last:
  s_add_u32 s61, s61, 0x20000
  v_min_u32 v124, -2, v124
  buffer_store_dwordx4 v[124:127], v2, s[40:43], s61 offen sc1
  s_waitcnt vmcnt(0)
  s_endpgm
L_exit:
  s_endpgm
.p2align 8
.type L_ptab,@object
L_ptab:
.long 0xd,0x10,0x1047005,0xe,0,0xc0,0x1e,0x180,0x240,4,4,4,4,4,4,4,4,4,4,4,4,4,4,4,4,4,4,4,4,4,4,4
.long 0x100d,0x32,0x846005,6,0x20,0x80,0xe0,0x140,0x1a0,0x200,0x260,0x2c0,0x320,0x380,0x3e0,4,4,4,4,4,4,4,4,4,4,4,4,4,4,4,4,4
.long 0x200d,0x54,0x1055005,0x1850005,0xe,0x10,0xd0,0x1e,0x190,0x250,4,4,4,4,4,4,4,4,4,4,4,4,4,4,4,4,4,4,4,4,4,4
.long 0x300d,0x76,0x854005,0x2051005,0xe,0x20,0xe0,0x1e,0x1a0,0x260,4,4,4,4,4,4,4,4,4,4,4,4,4,4,4,4,4,4,4,4,4,4
.long 0x400d,0x3276,0x2043005,6,0x40,0xa0,0x100,0x160,0x1c0,0x220,0x280,0x2e0,0x340,0x3a0,4,4,4,4,4,4,4,4,4,4,4,4,4,4,4,4,4,4
.long 0x500d,0x1054,0x1842005,6,0,0x60,0xc0,0x120,0x180,0x1e0,0x240,0x2a0,0x300,0x360,0x3c0,4,4,4,4,4,4,4,4,4,4,4,4,4,4,4,4,4
.long 0x600d,0x76543210,0x1e,0x300,0x340,0x380,0x3c0,4,4,4,4,4,4,4,4,4,4,4,4,4,4,4,4,4,4,4,4,4,4,4,4,4
.long 0x1d,0x10,0x1047015,0xe,0x1000,0x10c0,0x1e,0x1180,0x1240,4,4,4,4,4,4,4,4,4,4,4,4,4,4,4,4,4,4,4,4,4,4,4
.long 0x101d,0x32,0x846015,0x16,0x20,0x80,0xe0,0x140,0x1a0,0x200,0x260,0x2c0,0x320,0x380,0x3e0,4,4,4,4,4,4,4,4,4,4,4,4,4,4,4,4,4
.long 0x201d,0x54,0x1055015,0x1850015,0xe,0x1010,0x10d0,0x1e,0x1190,0x1250,4,4,4,4,4,4,4,4,4,4,4,4,4,4,4,4,4,4,4,4,4,4
.long 0x301d,0x76,0x854015,0x2051015,0xe,0x1020,0x10e0,0x1e,0x11a0,0x1260,4,4,4,4,4,4,4,4,4,4,4,4,4,4,4,4,4,4,4,4,4,4
.long 0x401d,0x3276,0x2043015,0x16,0x40,0xa0,0x100,0x160,0x1c0,0x220,0x280,0x2e0,0x340,0x3a0,4,4,4,4,4,4,4,4,4,4,4,4,4,4,4,4,4,4
.long 0x501d,0x1054,0x1842015,0x16,0,0x60,0xc0,0x120,0x180,0x1e0,0x240,0x2a0,0x300,0x360,0x3c0,4,4,4,4,4,4,4,4,4,4,4,4,4,4,4,4,4
.long 0x601d,0x76543210,0x1e,0x1300,0x1340,0x1380,0x13c0,4,4,4,4,4,4,4,4,4,4,4,4,4,4,4,4,4,4,4,4,4,4,4,4,4
.long 0x2d,0x10,0x1047025,0xe,0x2000,0x20c0,0x1e,0x2180,0x2240,4,4,4,4,4,4,4,4,4,4,4,4,4,4,4,4,4,4,4,4,4,4,4
.long 0x102d,0x32,0x846025,0x26,0x20,0x80,0xe0,0x140,0x1a0,0x200,0x260,0x2c0,0x320,0x380,0x3e0,4,4,4,4,4,4,4,4,4,4,4,4,4,4,4,4,4
.long 0x202d,0x54,0x1055025,0x1850025,0xe,0x2010,0x20d0,0x1e,0x2190,0x2250,4,4,4,4,4,4,4,4,4,4,4,4,4,4,4,4,4,4,4,4,4,4
.long 0x302d,0x76,0x854025,0x2051025,0xe,0x2020,0x20e0,0x1e,0x21a0,0x2260,4,4,4,4,4,4,4,4,4,4,4,4,4,4,4,4,4,4,4,4,4,4
.long 0x402d,0x3276,0x2043025,0x26,0x40,0xa0,0x100,0x160,0x1c0,0x220,0x280,0x2e0,0x340,0x3a0,4,4,4,4,4,4,4,4,4,4,4,4,4,4,4,4,4,4
.long 0x502d,0x1054,0x1842025,0x26,0,0x60,0xc0,0x120,0x180,0x1e0,0x240,0x2a0,0x300,0x360,0x3c0,4,4,4,4,4,4,4,4,4,4,4,4,4,4,4,4,4
.long 0x602d,0x76543210,0x1e,0x2300,0x2340,0x2380,0x23c0,4,4,4,4,4,4,4,4,4,4,4,4,4,4,4,4,4,4,4,4,4,4,4,4,4
.long 0x3d,0x10,0x1047035,0xe,0x3000,0x30c0,0x1e,0x3180,0x3240,4,4,4,4,4,4,4,4,4,4,4,4,4,4,4,4,4,4,4,4,4,4,4
.long 0x103d,0x32,0x846035,0x36,0x20,0x80,0xe0,0x140,0x1a0,0x200,0x260,0x2c0,0x320,0x380,0x3e0,4,4,4,4,4,4,4,4,4,4,4,4,4,4,4,4,4
.long 0x203d,0x54,0x1055035,0x1850035,0xe,0x3010,0x30d0,0x1e,0x3190,0x3250,4,4,4,4,4,4,4,4,4,4,4,4,4,4,4,4,4,4,4,4,4,4
.long 0x303d,0x76,0x854035,0x2051035,0xe,0x3020,0x30e0,0x1e,0x31a0,0x3260,4,4,4,4,4,4,4,4,4,4,4,4,4,4,4,4,4,4,4,4,4,4
.long 0x403d,0x3276,0x2043035,0x36,0x40,0xa0,0x100,0x160,0x1c0,0x220,0x280,0x2e0,0x340,0x3a0,4,4,4,4,4,4,4,4,4,4,4,4,4,4,4,4,4,4
.long 0x503d,0x1054,0x1842035,0x36,0,0x60,0xc0,0x120,0x180,0x1e0,0x240,0x2a0,0x300,0x360,0x3c0,4,4,4,4,4,4,4,4,4,4,4,4,4,4,4,4,4
.long 0x603d,0x76543210,0x1e,0x3300,0x3340,0x3380,0x33c0,4,4,4,4,4,4,4,4,4,4,4,4,4,4,4,4,4,4,4,4,4,4,4,4,4
.long 0x4d,0x10,0x1047045,0xe,0x4000,0x40c0,0x1e,0x4180,0x4240,4,4,4,4,4,4,4,4,4,4,4,4,4,4,4,4,4,4,4,4,4,4,4
.long 0x104d,0x32,0x846045,0x46,0x20,0x80,0xe0,0x140,0x1a0,0x200,0x260,0x2c0,0x320,0x380,0x3e0,4,4,4,4,4,4,4,4,4,4,4,4,4,4,4,4,4
.long 0x204d,0x54,0x1055045,0x1850045,0xe,0x4010,0x40d0,0x1e,0x4190,0x4250,4,4,4,4,4,4,4,4,4,4,4,4,4,4,4,4,4,4,4,4,4,4
.long 0x304d,0x76,0x854045,0x2051045,0xe,0x4020,0x40e0,0x1e,0x41a0,0x4260,4,4,4,4,4,4,4,4,4,4,4,4,4,4,4,4,4,4,4,4,4,4
.long 0x404d,0x3276,0x2043045,0x46,0x40,0xa0,0x100,0x160,0x1c0,0x220,0x280,0x2e0,0x340,0x3a0,4,4,4,4,4,4,4,4,4,4,4,4,4,4,4,4,4,4
.long 0x504d,0x1054,0x1842045,0x46,0,0x60,0xc0,0x120,0x180,0x1e0,0x240,0x2a0,0x300,0x360,0x3c0,4,4,4,4,4,4,4,4,4,4,4,4,4,4,4,4,4
.long 0x604d,0x76543210,0x1e,0x4300,0x4340,0x4380,0x43c0,4,4,4,4,4,4,4,4,4,4,4,4,4,4,4,4,4,4,4,4,4,4,4,4,4
.long 0x5d,0x10,0x1047055,0xe,0x5000,0x50c0,0x1e,0x5180,0x5240,4,4,4,4,4,4,4,4,4,4,4,4,4,4,4,4,4,4,4,4,4,4,4
.long 0x105d,0x32,0x846055,0x56,0x20,0x80,0xe0,0x140,0x1a0,0x200,0x260,0x2c0,0x320,0x380,0x3e0,4,4,4,4,4,4,4,4,4,4,4,4,4,4,4,4,4
.long 0x205d,0x54,0x1055055,0x1850055,0xe,0x5010,0x50d0,0x1e,0x5190,0x5250,4,4,4,4,4,4,4,4,4,4,4,4,4,4,4,4,4,4,4,4,4,4
.long 0x305d,0x76,0x854055,0x2051055,0xe,0x5020,0x50e0,0x1e,0x51a0,0x5260,4,4,4,4,4,4,4,4,4,4,4,4,4,4,4,4,4,4,4,4,4,4
.long 0x405d,0x3276,0x2043055,0x56,0x40,0xa0,0x100,0x160,0x1c0,0x220,0x280,0x2e0,0x340,0x3a0,4,4,4,4,4,4,4,4,4,4,4,4,4,4,4,4,4,4
.long 0x505d,0x1054,0x1842055,0x56,0,0x60,0xc0,0x120,0x180,0x1e0,0x240,0x2a0,0x300,0x360,0x3c0,4,4,4,4,4,4,4,4,4,4,4,4,4,4,4,4,4
.long 0x605d,0x76543210,0x1e,0x5300,0x5340,0x5380,0x53c0,4,4,4,4,4,4,4,4,4,4,4,4,4,4,4,4,4,4,4,4,4,4,4,4,4
.long 0x6d,0x10,0x1047065,0xe,0x6000,0x60c0,0x1e,0x6180,0x6240,4,4,4,4,4,4,4,4,4,4,4,4,4,4,4,4,4,4,4,4,4,4,4
.long 0x106d,0x32,0x846065,0x66,0x20,0x80,0xe0,0x140,0x1a0,0x200,0x260,0x2c0,0x320,0x380,0x3e0,4,4,4,4,4,4,4,4,4,4,4,4,4,4,4,4,4
.long 0x206d,0x54,0x1055065,0x1850065,0xe,0x6010,0x60d0,0x1e,0x6190,0x6250,4,4,4,4,4,4,4,4,4,4,4,4,4,4,4,4,4,4,4,4,4,4
.long 0x306d,0x76,0x854065,0x2051065,0xe,0x6020,0x60e0,0x1e,0x61a0,0x6260,4,4,4,4,4,4,4,4,4,4,4,4,4,4,4,4,4,4,4,4,4,4
.long 0x406d,0x3276,0x2043065,0x66,0x40,0xa0,0x100,0x160,0x1c0,0x220,0x280,0x2e0,0x340,0x3a0,4,4,4,4,4,4,4,4,4,4,4,4,4,4,4,4,4,4
.long 0x506d,0x1054,0x1842065,0x66,0,0x60,0xc0,0x120,0x180,0x1e0,0x240,0x2a0,0x300,0x360,0x3c0,4,4,4,4,4,4,4,4,4,4,4,4,4,4,4,4,4
.long 0x606d,0x76543210,0x1e,0x6300,0x6340,0x6380,0x63c0,4,4,4,4,4,4,4,4,4,4,4,4,4,4,4,4,4,4,4,4,4,4,4,4,4
.long 0x7d,0x10,0x1047075,0xe,0x7000,0x70c0,0x1e,0x7180,0x7240,4,4,4,4,4,4,4,4,4,4,4,4,4,4,4,4,4,4,4,4,4,4,4
.long 0x107d,0x32,0x846075,0x76,0x20,0x80,0xe0,0x140,0x1a0,0x200,0x260,0x2c0,0x320,0x380,0x3e0,4,4,4,4,4,4,4,4,4,4,4,4,4,4,4,4,4
.long 0x207d,0x54,0x1055075,0x1850075,0xe,0x7010,0x70d0,0x1e,0x7190,0x7250,4,4,4,4,4,4,4,4,4,4,4,4,4,4,4,4,4,4,4,4,4,4
.long 0x307d,0x76,0x854075,0x2051075,0xe,0x7020,0x70e0,0x1e,0x71a0,0x7260,4,4,4,4,4,4,4,4,4,4,4,4,4,4,4,4,4,4,4,4,4,4
.long 0x407d,0x3276,0x2043075,0x76,0x40,0xa0,0x100,0x160,0x1c0,0x220,0x280,0x2e0,0x340,0x3a0,4,4,4,4,4,4,4,4,4,4,4,4,4,4,4,4,4,4
.long 0x507d,0x1054,0x1842075,0x76,0,0x60,0xc0,0x120,0x180,0x1e0,0x240,0x2a0,0x300,0x360,0x3c0,4,4,4,4,4,4,4,4,4,4,4,4,4,4,4,4,4
.long 0x607d,0x76543210,0x1e,0x7300,0x7340,0x7380,0x73c0,4,4,4,4,4,4,4,4,4,4,4,4,4,4,4,4,4,4,4,4,4,4,4,4,4
.long 0x8d,0x10,0x1047085,0xe,0x30,0xf0,0x1e,0x1b0,0x270,4,4,4,4,4,4,4,4,4,4,4,4,4,4,4,4,4,4,4,4,4,4,4
.long 0x108d,0x32,0x846085,0x86,0x20,0x80,0xe0,0x140,0x1a0,0x200,0x260,0x2c0,0x320,0x380,0x3e0,4,4,4,4,4,4,4,4,4,4,4,4,4,4,4,4,4
.long 0x208d,0x54,0x1055085,0x1850085,0xe,0x40,0x100,0x1e,0x1c0,0x280,4,4,4,4,4,4,4,4,4,4,4,4,4,4,4,4,4,4,4,4,4,4
.long 0x308d,0x76,0x854085,0x2051085,0xe,0x50,0x110,0x1e,0x1d0,0x290,4,4,4,4,4,4,4,4,4,4,4,4,4,4,4,4,4,4,4,4,4,4
.long 0x408d,0x3276,0x2043085,0x86,0x40,0xa0,0x100,0x160,0x1c0,0x220,0x280,0x2e0,0x340,0x3a0,4,4,4,4,4,4,4,4,4,4,4,4,4,4,4,4,4,4
.long 0x508d,0x1054,0x1842085,0x86,0,0x60,0xc0,0x120,0x180,0x1e0,0x240,0x2a0,0x300,0x360,0x3c0,4,4,4,4,4,4,4,4,4,4,4,4,4,4,4,4,4
.long 0x608d,0x76543210,0x1e,0x310,0x350,0x390,0x3d0,4,4,4,4,4,4,4,4,4,4,4,4,4,4,4,4,4,4,4,4,4,4,4,4,4
.long 0x9d,0x10,0x1047095,0xe,0x1030,0x10f0,0x1e,0x11b0,0x1270,4,4,4,4,4,4,4,4,4,4,4,4,4,4,4,4,4,4,4,4,4,4,4
.long 0x109d,0x32,0x846095,0x96,0x20,0x80,0xe0,0x140,0x1a0,0x200,0x260,0x2c0,0x320,0x380,0x3e0,4,4,4,4,4,4,4,4,4,4,4,4,4,4,4,4,4
.long 0x209d,0x54,0x1055095,0x1850095,0xe,0x1040,0x1100,0x1e,0x11c0,0x1280,4,4,4,4,4,4,4,4,4,4,4,4,4,4,4,4,4,4,4,4,4,4
.long 0x309d,0x76,0x854095,0x2051095,0xe,0x1050,0x1110,0x1e,0x11d0,0x1290,4,4,4,4,4,4,4,4,4,4,4,4,4,4,4,4,4,4,4,4,4,4
.long 0x409d,0x3276,0x2043095,0x96,0x40,0xa0,0x100,0x160,0x1c0,0x220,0x280,0x2e0,0x340,0x3a0,4,4,4,4,4,4,4,4,4,4,4,4,4,4,4,4,4,4
.long 0x509d,0x1054,0x1842095,0x96,0,0x60,0xc0,0x120,0x180,0x1e0,0x240,0x2a0,0x300,0x360,0x3c0,4,4,4,4,4,4,4,4,4,4,4,4,4,4,4,4,4
.long 0x609d,0x76543210,0x1e,0x1310,0x1350,0x1390,0x13d0,4,4,4,4,4,4,4,4,4,4,4,4,4,4,4,4,4,4,4,4,4,4,4,4,4
.long 0xad,0x10,0x10470a5,0xe,0x2030,0x20f0,0x1e,0x21b0,0x2270,4,4,4,4,4,4,4,4,4,4,4,4,4,4,4,4,4,4,4,4,4,4,4
.long 0x10ad,0x32,0x8460a5,0xa6,0x20,0x80,0xe0,0x140,0x1a0,0x200,0x260,0x2c0,0x320,0x380,0x3e0,4,4,4,4,4,4,4,4,4,4,4,4,4,4,4,4,4
.long 0x20ad,0x54,0x10550a5,0x18500a5,0xe,0x2040,0x2100,0x1e,0x21c0,0x2280,4,4,4,4,4,4,4,4,4,4,4,4,4,4,4,4,4,4,4,4,4,4
.long 0x30ad,0x76,0x8540a5,0x20510a5,0xe,0x2050,0x2110,0x1e,0x21d0,0x2290,4,4,4,4,4,4,4,4,4,4,4,4,4,4,4,4,4,4,4,4,4,4
.long 0x40ad,0x3276,0x20430a5,0xa6,0x40,0xa0,0x100,0x160,0x1c0,0x220,0x280,0x2e0,0x340,0x3a0,4,4,4,4,4,4,4,4,4,4,4,4,4,4,4,4,4,4
.long 0x50ad,0x1054,0x18420a5,0xa6,0,0x60,0xc0,0x120,0x180,0x1e0,0x240,0x2a0,0x300,0x360,0x3c0,4,4,4,4,4,4,4,4,4,4,4,4,4,4,4,4,4
.long 0x60ad,0x76543210,0x1e,0x2310,0x2350,0x2390,0x23d0,4,4,4,4,4,4,4,4,4,4,4,4,4,4,4,4,4,4,4,4,4,4,4,4,4
.long 0xbd,0x10,0x10470b5,0xe,0x3030,0x30f0,0x1e,0x31b0,0x3270,4,4,4,4,4,4,4,4,4,4,4,4,4,4,4,4,4,4,4,4,4,4,4
.long 0x10bd,0x32,0x8460b5,0xb6,0x20,0x80,0xe0,0x140,0x1a0,0x200,0x260,0x2c0,0x320,0x380,0x3e0,4,4,4,4,4,4,4,4,4,4,4,4,4,4,4,4,4
.long 0x20bd,0x54,0x10550b5,0x18500b5,0xe,0x3040,0x3100,0x1e,0x31c0,0x3280,4,4,4,4,4,4,4,4,4,4,4,4,4,4,4,4,4,4,4,4,4,4
.long 0x30bd,0x76,0x8540b5,0x20510b5,0xe,0x3050,0x3110,0x1e,0x31d0,0x3290,4,4,4,4,4,4,4,4,4,4,4,4,4,4,4,4,4,4,4,4,4,4
.long 0x40bd,0x3276,0x20430b5,0xb6,0x40,0xa0,0x100,0x160,0x1c0,0x220,0x280,0x2e0,0x340,0x3a0,4,4,4,4,4,4,4,4,4,4,4,4,4,4,4,4,4,4
.long 0x50bd,0x1054,0x18420b5,0xb6,0,0x60,0xc0,0x120,0x180,0x1e0,0x240,0x2a0,0x300,0x360,0x3c0,4,4,4,4,4,4,4,4,4,4,4,4,4,4,4,4,4
.long 0x60bd,0x76543210,0x1e,0x3310,0x3350,0x3390,0x33d0,4,4,4,4,4,4,4,4,4,4,4,4,4,4,4,4,4,4,4,4,4,4,4,4,4
.long 0xcd,0x10,0x10470c5,0xe,0x4030,0x40f0,0x1e,0x41b0,0x4270,4,4,4,4,4,4,4,4,4,4,4,4,4,4,4,4,4,4,4,4,4,4,4
.long 0x10cd,0x32,0x8460c5,0xc6,0x20,0x80,0xe0,0x140,0x1a0,0x200,0x260,0x2c0,0x320,0x380,0x3e0,4,4,4,4,4,4,4,4,4,4,4,4,4,4,4,4,4
.long 0x20cd,0x54,0x10550c5,0x18500c5,0xe,0x4040,0x4100,0x1e,0x41c0,0x4280,4,4,4,4,4,4,4,4,4,4,4,4,4,4,4,4,4,4,4,4,4,4
.long 0x30cd,0x76,0x8540c5,0x20510c5,0xe,0x4050,0x4110,0x1e,0x41d0,0x4290,4,4,4,4,4,4,4,4,4,4,4,4,4,4,4,4,4,4,4,4,4,4
.long 0x40cd,0x3276,0x20430c5,0xc6,0x40,0xa0,0x100,0x160,0x1c0,0x220,0x280,0x2e0,0x340,0x3a0,4,4,4,4,4,4,4,4,4,4,4,4,4,4,4,4,4,4
.long 0x50cd,0x1054,0x18420c5,0xc6,0,0x60,0xc0,0x120,0x180,0x1e0,0x240,0x2a0,0x300,0x360,0x3c0,4,4,4,4,4,4,4,4,4,4,4,4,4,4,4,4,4
.long 0x60cd,0x76543210,0x1e,0x4310,0x4350,0x4390,0x43d0,4,4,4,4,4,4,4,4,4,4,4,4,4,4,4,4,4,4,4,4,4,4,4,4,4
.long 0xdd,0x10,0x10470d5,0xe,0x5030,0x50f0,0x1e,0x51b0,0x5270,4,4,4,4,4,4,4,4,4,4,4,4,4,4,4,4,4,4,4,4,4,4,4
.long 0x10dd,0x32,0x8460d5,0xd6,0x20,0x80,0xe0,0x140,0x1a0,0x200,0x260,0x2c0,0x320,0x380,0x3e0,4,4,4,4,4,4,4,4,4,4,4,4,4,4,4,4,4
.long 0x20dd,0x54,0x10550d5,0x18500d5,0xe,0x5040,0x5100,0x1e,0x51c0,0x5280,4,4,4,4,4,4,4,4,4,4,4,4,4,4,4,4,4,4,4,4,4,4
.long 0x30dd,0x76,0x8540d5,0x20510d5,0xe,0x5050,0x5110,0x1e,0x51d0,0x5290,4,4,4,4,4,4,4,4,4,4,4,4,4,4,4,4,4,4,4,4,4,4
.long 0x40dd,0x3276,0x20430d5,0xd6,0x40,0xa0,0x100,0x160,0x1c0,0x220,0x280,0x2e0,0x340,0x3a0,4,4,4,4,4,4,4,4,4,4,4,4,4,4,4,4,4,4
.long 0x50dd,0x1054,0x18420d5,0xd6,0,0x60,0xc0,0x120,0x180,0x1e0,0x240,0x2a0,0x300,0x360,0x3c0,4,4,4,4,4,4,4,4,4,4,4,4,4,4,4,4,4
.long 0x60dd,0x76543210,0x1e,0x5310,0x5350,0x5390,0x53d0,4,4,4,4,4,4,4,4,4,4,4,4,4,4,4,4,4,4,4,4,4,4,4,4,4
.long 0xed,0x10,0x10470e5,0xe,0x6030,0x60f0,0x1e,0x61b0,0x6270,4,4,4,4,4,4,4,4,4,4,4,4,4,4,4,4,4,4,4,4,4,4,4
.long 0x10ed,0x32,0x8460e5,0xe6,0x20,0x80,0xe0,0x140,0x1a0,0x200,0x260,0x2c0,0x320,0x380,0x3e0,4,4,4,4,4,4,4,4,4,4,4,4,4,4,4,4,4
.long 0x20ed,0x54,0x10550e5,0x18500e5,0xe,0x6040,0x6100,0x1e,0x61c0,0x6280,4,4,4,4,4,4,4,4,4,4,4,4,4,4,4,4,4,4,4,4,4,4
.long 0x30ed,0x76,0x8540e5,0x20510e5,0xe,0x6050,0x6110,0x1e,0x61d0,0x6290,4,4,4,4,4,4,4,4,4,4,4,4,4,4,4,4,4,4,4,4,4,4
.long 0x40ed,0x3276,0x20430e5,0xe6,0x40,0xa0,0x100,0x160,0x1c0,0x220,0x280,0x2e0,0x340,0x3a0,4,4,4,4,4,4,4,4,4,4,4,4,4,4,4,4,4,4
.long 0x50ed,0x1054,0x18420e5,0xe6,0,0x60,0xc0,0x120,0x180,0x1e0,0x240,0x2a0,0x300,0x360,0x3c0,4,4,4,4,4,4,4,4,4,4,4,4,4,4,4,4,4
.long 0x60ed,0x76543210,0x1e,0x6310,0x6350,0x6390,0x63d0,4,4,4,4,4,4,4,4,4,4,4,4,4,4,4,4,4,4,4,4,4,4,4,4,4
.long 0xfd,0x10,0x10470f5,0xe,0x7030,0x70f0,0x1e,0x71b0,0x7270,4,4,4,4,4,4,4,4,4,4,4,4,4,4,4,4,4,4,4,4,4,4,4
.long 0x10fd,0x32,0x8460f5,0xf6,0x20,0x80,0xe0,0x140,0x1a0,0x200,0x260,0x2c0,0x320,0x380,0x3e0,4,4,4,4,4,4,4,4,4,4,4,4,4,4,4,4,4
.long 0x20fd,0x54,0x10550f5,0x18500f5,0xe,0x7040,0x7100,0x1e,0x71c0,0x7280,4,4,4,4,4,4,4,4,4,4,4,4,4,4,4,4,4,4,4,4,4,4
.long 0x30fd,0x76,0x8540f5,0x20510f5,0xe,0x7050,0x7110,0x1e,0x71d0,0x7290,4,4,4,4,4,4,4,4,4,4,4,4,4,4,4,4,4,4,4,4,4,4
.long 0x40fd,0x3276,0x20430f5,0xf6,0x40,0xa0,0x100,0x160,0x1c0,0x220,0x280,0x2e0,0x340,0x3a0,4,4,4,4,4,4,4,4,4,4,4,4,4,4,4,4,4,4
.long 0x50fd,0x1054,0x18420f5,0xf6,0,0x60,0xc0,0x120,0x180,0x1e0,0x240,0x2a0,0x300,0x360,0x3c0,4,4,4,4,4,4,4,4,4,4,4,4,4,4,4,4,4
.long 0x60fd,0x76543210,0x1e,0x7310,0x7350,0x7390,0x73d0,4,4,4,4,4,4,4,4,4,4,4,4,4,4,4,4,4,4,4,4,4,4,4,4,4
.long 0x10d,0x10,0x1047105,0xe,0x60,0x120,0x1e,0x1e0,0x2a0,4,4,4,4,4,4,4,4,4,4,4,4,4,4,4,4,4,4,4,4,4,4,4
.long 0x110d,0x32,0x846105,6,0x30,0x90,0xf0,0x150,0x1b0,0x210,0x270,0x2d0,0x330,0x390,0x3f0,4,4,4,4,4,4,4,4,4,4,4,4,4,4,4,4,4
.long 0x210d,0x54,0x1055105,0x1850105,0xe,0x70,0x130,0x1e,0x1f0,0x2b0,4,4,4,4,4,4,4,4,4,4,4,4,4,4,4,4,4,4,4,4,4,4
.long 0x310d,0x76,0x854105,0x2051105,0xe,0x80,0x140,0x1e,0x200,0x2c0,4,4,4,4,4,4,4,4,4,4,4,4,4,4,4,4,4,4,4,4,4,4
.long 0x410d,0x3276,0x2043105,6,0x50,0xb0,0x110,0x170,0x1d0,0x230,0x290,0x2f0,0x350,0x3b0,4,4,4,4,4,4,4,4,4,4,4,4,4,4,4,4,4,4
.long 0x510d,0x1054,0x1842105,6,0x10,0x70,0xd0,0x130,0x190,0x1f0,0x250,0x2b0,0x310,0x370,0x3d0,4,4,4,4,4,4,4,4,4,4,4,4,4,4,4,4,4
.long 0x610d,0x76543210,0x1e,0x320,0x360,0x3a0,0x3e0,4,4,4,4,4,4,4,4,4,4,4,4,4,4,4,4,4,4,4,4,4,4,4,4,4
.long 0x11d,0x10,0x1047115,0xe,0x1060,0x1120,0x1e,0x11e0,0x12a0,4,4,4,4,4,4,4,4,4,4,4,4,4,4,4,4,4,4,4,4,4,4,4
.long 0x111d,0x32,0x846115,0x16,0x30,0x90,0xf0,0x150,0x1b0,0x210,0x270,0x2d0,0x330,0x390,0x3f0,4,4,4,4,4,4,4,4,4,4,4,4,4,4,4,4,4
.long 0x211d,0x54,0x1055115,0x1850115,0xe,0x1070,0x1130,0x1e,0x11f0,0x12b0,4,4,4,4,4,4,4,4,4,4,4,4,4,4,4,4,4,4,4,4,4,4
.long 0x311d,0x76,0x854115,0x2051115,0xe,0x1080,0x1140,0x1e,0x1200,0x12c0,4,4,4,4,4,4,4,4,4,4,4,4,4,4,4,4,4,4,4,4,4,4
.long 0x411d,0x3276,0x2043115,0x16,0x50,0xb0,0x110,0x170,0x1d0,0x230,0x290,0x2f0,0x350,0x3b0,4,4,4,4,4,4,4,4,4,4,4,4,4,4,4,4,4,4
.long 0x511d,0x1054,0x1842115,0x16,0x10,0x70,0xd0,0x130,0x190,0x1f0,0x250,0x2b0,0x310,0x370,0x3d0,4,4,4,4,4,4,4,4,4,4,4,4,4,4,4,4,4
.long 0x611d,0x76543210,0x1e,0x1320,0x1360,0x13a0,0x13e0,4,4,4,4,4,4,4,4,4,4,4,4,4,4,4,4,4,4,4,4,4,4,4,4,4
.long 0x12d,0x10,0x1047125,0xe,0x2060,0x2120,0x1e,0x21e0,0x22a0,4,4,4,4,4,4,4,4,4,4,4,4,4,4,4,4,4,4,4,4,4,4,4
.long 0x112d,0x32,0x846125,0x26,0x30,0x90,0xf0,0x150,0x1b0,0x210,0x270,0x2d0,0x330,0x390,0x3f0,4,4,4,4,4,4,4,4,4,4,4,4,4,4,4,4,4
.long 0x212d,0x54,0x1055125,0x1850125,0xe,0x2070,0x2130,0x1e,0x21f0,0x22b0,4,4,4,4,4,4,4,4,4,4,4,4,4,4,4,4,4,4,4,4,4,4
.long 0x312d,0x76,0x854125,0x2051125,0xe,0x2080,0x2140,0x1e,0x2200,0x22c0,4,4,4,4,4,4,4,4,4,4,4,4,4,4,4,4,4,4,4,4,4,4
.long 0x412d,0x3276,0x2043125,0x26,0x50,0xb0,0x110,0x170,0x1d0,0x230,0x290,0x2f0,0x350,0x3b0,4,4,4,4,4,4,4,4,4,4,4,4,4,4,4,4,4,4
.long 0x512d,0x1054,0x1842125,0x26,0x10,0x70,0xd0,0x130,0x190,0x1f0,0x250,0x2b0,0x310,0x370,0x3d0,4,4,4,4,4,4,4,4,4,4,4,4,4,4,4,4,4
.long 0x612d,0x76543210,0x1e,0x2320,0x2360,0x23a0,0x23e0,4,4,4,4,4,4,4,4,4,4,4,4,4,4,4,4,4,4,4,4,4,4,4,4,4
.long 0x13d,0x10,0x1047135,0xe,0x3060,0x3120,0x1e,0x31e0,0x32a0,4,4,4,4,4,4,4,4,4,4,4,4,4,4,4,4,4,4,4,4,4,4,4
.long 0x113d,0x32,0x846135,0x36,0x30,0x90,0xf0,0x150,0x1b0,0x210,0x270,0x2d0,0x330,0x390,0x3f0,4,4,4,4,4,4,4,4,4,4,4,4,4,4,4,4,4
.long 0x213d,0x54,0x1055135,0x1850135,0xe,0x3070,0x3130,0x1e,0x31f0,0x32b0,4,4,4,4,4,4,4,4,4,4,4,4,4,4,4,4,4,4,4,4,4,4
.long 0x313d,0x76,0x854135,0x2051135,0xe,0x3080,0x3140,0x1e,0x3200,0x32c0,4,4,4,4,4,4,4,4,4,4,4,4,4,4,4,4,4,4,4,4,4,4
.long 0x413d,0x3276,0x2043135,0x36,0x50,0xb0,0x110,0x170,0x1d0,0x230,0x290,0x2f0,0x350,0x3b0,4,4,4,4,4,4,4,4,4,4,4,4,4,4,4,4,4,4
.long 0x513d,0x1054,0x1842135,0x36,0x10,0x70,0xd0,0x130,0x190,0x1f0,0x250,0x2b0,0x310,0x370,0x3d0,4,4,4,4,4,4,4,4,4,4,4,4,4,4,4,4,4
.long 0x613d,0x76543210,0x1e,0x3320,0x3360,0x33a0,0x33e0,4,4,4,4,4,4,4,4,4,4,4,4,4,4,4,4,4,4,4,4,4,4,4,4,4
.long 0x14d,0x10,0x1047145,0xe,0x4060,0x4120,0x1e,0x41e0,0x42a0,4,4,4,4,4,4,4,4,4,4,4,4,4,4,4,4,4,4,4,4,4,4,4
.long 0x114d,0x32,0x846145,0x46,0x30,0x90,0xf0,0x150,0x1b0,0x210,0x270,0x2d0,0x330,0x390,0x3f0,4,4,4,4,4,4,4,4,4,4,4,4,4,4,4,4,4
.long 0x214d,0x54,0x1055145,0x1850145,0xe,0x4070,0x4130,0x1e,0x41f0,0x42b0,4,4,4,4,4,4,4,4,4,4,4,4,4,4,4,4,4,4,4,4,4,4
.long 0x314d,0x76,0x854145,0x2051145,0xe,0x4080,0x4140,0x1e,0x4200,0x42c0,4,4,4,4,4,4,4,4,4,4,4,4,4,4,4,4,4,4,4,4,4,4
.long 0x414d,0x3276,0x2043145,0x46,0x50,0xb0,0x110,0x170,0x1d0,0x230,0x290,0x2f0,0x350,0x3b0,4,4,4,4,4,4,4,4,4,4,4,4,4,4,4,4,4,4
.long 0x514d,0x1054,0x1842145,0x46,0x10,0x70,0xd0,0x130,0x190,0x1f0,0x250,0x2b0,0x310,0x370,0x3d0,4,4,4,4,4,4,4,4,4,4,4,4,4,4,4,4,4
.long 0x614d,0x76543210,0x1e,0x4320,0x4360,0x43a0,0x43e0,4,4,4,4,4,4,4,4,4,4,4,4,4,4,4,4,4,4,4,4,4,4,4,4,4
.long 0x15d,0x10,0x1047155,0xe,0x5060,0x5120,0x1e,0x51e0,0x52a0,4,4,4,4,4,4,4,4,4,4,4,4,4,4,4,4,4,4,4,4,4,4,4
.long 0x115d,0x32,0x846155,0x56,0x30,0x90,0xf0,0x150,0x1b0,0x210,0x270,0x2d0,0x330,0x390,0x3f0,4,4,4,4,4,4,4,4,4,4,4,4,4,4,4,4,4
.long 0x215d,0x54,0x1055155,0x1850155,0xe,0x5070,0x5130,0x1e,0x51f0,0x52b0,4,4,4,4,4,4,4,4,4,4,4,4,4,4,4,4,4,4,4,4,4,4
.long 0x315d,0x76,0x854155,0x2051155,0xe,0x5080,0x5140,0x1e,0x5200,0x52c0,4,4,4,4,4,4,4,4,4,4,4,4,4,4,4,4,4,4,4,4,4,4
.long 0x415d,0x3276,0x2043155,0x56,0x50,0xb0,0x110,0x170,0x1d0,0x230,0x290,0x2f0,0x350,0x3b0,4,4,4,4,4,4,4,4,4,4,4,4,4,4,4,4,4,4
.long 0x515d,0x1054,0x1842155,0x56,0x10,0x70,0xd0,0x130,0x190,0x1f0,0x250,0x2b0,0x310,0x370,0x3d0,4,4,4,4,4,4,4,4,4,4,4,4,4,4,4,4,4
.long 0x615d,0x76543210,0x1e,0x5320,0x5360,0x53a0,0x53e0,4,4,4,4,4,4,4,4,4,4,4,4,4,4,4,4,4,4,4,4,4,4,4,4,4
.long 0x16d,0x10,0x1047165,0xe,0x6060,0x6120,0x1e,0x61e0,0x62a0,4,4,4,4,4,4,4,4,4,4,4,4,4,4,4,4,4,4,4,4,4,4,4
.long 0x116d,0x32,0x846165,0x66,0x30,0x90,0xf0,0x150,0x1b0,0x210,0x270,0x2d0,0x330,0x390,0x3f0,4,4,4,4,4,4,4,4,4,4,4,4,4,4,4,4,4
.long 0x216d,0x54,0x1055165,0x1850165,0xe,0x6070,0x6130,0x1e,0x61f0,0x62b0,4,4,4,4,4,4,4,4,4,4,4,4,4,4,4,4,4,4,4,4,4,4
.long 0x316d,0x76,0x854165,0x2051165,0xe,0x6080,0x6140,0x1e,0x6200,0x62c0,4,4,4,4,4,4,4,4,4,4,4,4,4,4,4,4,4,4,4,4,4,4
.long 0x416d,0x3276,0x2043165,0x66,0x50,0xb0,0x110,0x170,0x1d0,0x230,0x290,0x2f0,0x350,0x3b0,4,4,4,4,4,4,4,4,4,4,4,4,4,4,4,4,4,4
.long 0x516d,0x1054,0x1842165,0x66,0x10,0x70,0xd0,0x130,0x190,0x1f0,0x250,0x2b0,0x310,0x370,0x3d0,4,4,4,4,4,4,4,4,4,4,4,4,4,4,4,4,4
.long 0x616d,0x76543210,0x1e,0x6320,0x6360,0x63a0,0x63e0,4,4,4,4,4,4,4,4,4,4,4,4,4,4,4,4,4,4,4,4,4,4,4,4,4
.long 0x17d,0x10,0x1047175,0xe,0x7060,0x7120,0x1e,0x71e0,0x72a0,4,4,4,4,4,4,4,4,4,4,4,4,4,4,4,4,4,4,4,4,4,4,4
.long 0x117d,0x32,0x846175,0x76,0x30,0x90,0xf0,0x150,0x1b0,0x210,0x270,0x2d0,0x330,0x390,0x3f0,4,4,4,4,4,4,4,4,4,4,4,4,4,4,4,4,4
.long 0x217d,0x54,0x1055175,0x1850175,0xe,0x7070,0x7130,0x1e,0x71f0,0x72b0,4,4,4,4,4,4,4,4,4,4,4,4,4,4,4,4,4,4,4,4,4,4
.long 0x317d,0x76,0x854175,0x2051175,0xe,0x7080,0x7140,0x1e,0x7200,0x72c0,4,4,4,4,4,4,4,4,4,4,4,4,4,4,4,4,4,4,4,4,4,4
.long 0x417d,0x3276,0x2043175,0x76,0x50,0xb0,0x110,0x170,0x1d0,0x230,0x290,0x2f0,0x350,0x3b0,4,4,4,4,4,4,4,4,4,4,4,4,4,4,4,4,4,4
.long 0x517d,0x1054,0x1842175,0x76,0x10,0x70,0xd0,0x130,0x190,0x1f0,0x250,0x2b0,0x310,0x370,0x3d0,4,4,4,4,4,4,4,4,4,4,4,4,4,4,4,4,4
.long 0x617d,0x76543210,0x1e,0x7320,0x7360,0x73a0,0x73e0,4,4,4,4,4,4,4,4,4,4,4,4,4,4,4,4,4,4,4,4,4,4,4,4,4
.long 0x18d,0x10,0x1047185,0xe,0x90,0x150,0x1e,0x210,0x2d0,4,4,4,4,4,4,4,4,4,4,4,4,4,4,4,4,4,4,4,4,4,4,4
.long 0x118d,0x32,0x846185,0x86,0x30,0x90,0xf0,0x150,0x1b0,0x210,0x270,0x2d0,0x330,0x390,0x3f0,4,4,4,4,4,4,4,4,4,4,4,4,4,4,4,4,4
.long 0x218d,0x54,0x1055185,0x1850185,0xe,0xa0,0x160,0x1e,0x220,0x2e0,4,4,4,4,4,4,4,4,4,4,4,4,4,4,4,4,4,4,4,4,4,4
.long 0x318d,0x76,0x854185,0x2051185,0xe,0xb0,0x170,0x1e,0x230,0x2f0,4,4,4,4,4,4,4,4,4,4,4,4,4,4,4,4,4,4,4,4,4,4
.long 0x418d,0x3276,0x2043185,0x86,0x50,0xb0,0x110,0x170,0x1d0,0x230,0x290,0x2f0,0x350,0x3b0,4,4,4,4,4,4,4,4,4,4,4,4,4,4,4,4,4,4
.long 0x518d,0x1054,0x1842185,0x86,0x10,0x70,0xd0,0x130,0x190,0x1f0,0x250,0x2b0,0x310,0x370,0x3d0,4,4,4,4,4,4,4,4,4,4,4,4,4,4,4,4,4
.long 0x618d,0x76543210,0x1e,0x330,0x370,0x3b0,0x3f0,4,4,4,4,4,4,4,4,4,4,4,4,4,4,4,4,4,4,4,4,4,4,4,4,4
.long 0x19d,0x10,0x1047195,0xe,0x1090,0x1150,0x1e,0x1210,0x12d0,4,4,4,4,4,4,4,4,4,4,4,4,4,4,4,4,4,4,4,4,4,4,4
.long 0x119d,0x32,0x846195,0x96,0x30,0x90,0xf0,0x150,0x1b0,0x210,0x270,0x2d0,0x330,0x390,0x3f0,4,4,4,4,4,4,4,4,4,4,4,4,4,4,4,4,4
.long 0x219d,0x54,0x1055195,0x1850195,0xe,0x10a0,0x1160,0x1e,0x1220,0x12e0,4,4,4,4,4,4,4,4,4,4,4,4,4,4,4,4,4,4,4,4,4,4
.long 0x319d,0x76,0x854195,0x2051195,0xe,0x10b0,0x1170,0x1e,0x1230,0x12f0,4,4,4,4,4,4,4,4,4,4,4,4,4,4,4,4,4,4,4,4,4,4
.long 0x419d,0x3276,0x2043195,0x96,0x50,0xb0,0x110,0x170,0x1d0,0x230,0x290,0x2f0,0x350,0x3b0,4,4,4,4,4,4,4,4,4,4,4,4,4,4,4,4,4,4
.long 0x519d,0x1054,0x1842195,0x96,0x10,0x70,0xd0,0x130,0x190,0x1f0,0x250,0x2b0,0x310,0x370,0x3d0,4,4,4,4,4,4,4,4,4,4,4,4,4,4,4,4,4
.long 0x619d,0x76543210,0x1e,0x1330,0x1370,0x13b0,0x13f0,4,4,4,4,4,4,4,4,4,4,4,4,4,4,4,4,4,4,4,4,4,4,4,4,4
.long 0x1ad,0x10,0x10471a5,0xe,0x2090,0x2150,0x1e,0x2210,0x22d0,4,4,4,4,4,4,4,4,4,4,4,4,4,4,4,4,4,4,4,4,4,4,4
.long 0x11ad,0x32,0x8461a5,0xa6,0x30,0x90,0xf0,0x150,0x1b0,0x210,0x270,0x2d0,0x330,0x390,0x3f0,4,4,4,4,4,4,4,4,4,4,4,4,4,4,4,4,4
.long 0x21ad,0x54,0x10551a5,0x18501a5,0xe,0x20a0,0x2160,0x1e,0x2220,0x22e0,4,4,4,4,4,4,4,4,4,4,4,4,4,4,4,4,4,4,4,4,4,4
.long 0x31ad,0x76,0x8541a5,0x20511a5,0xe,0x20b0,0x2170,0x1e,0x2230,0x22f0,4,4,4,4,4,4,4,4,4,4,4,4,4,4,4,4,4,4,4,4,4,4
.long 0x41ad,0x3276,0x20431a5,0xa6,0x50,0xb0,0x110,0x170,0x1d0,0x230,0x290,0x2f0,0x350,0x3b0,4,4,4,4,4,4,4,4,4,4,4,4,4,4,4,4,4,4
.long 0x51ad,0x1054,0x18421a5,0xa6,0x10,0x70,0xd0,0x130,0x190,0x1f0,0x250,0x2b0,0x310,0x370,0x3d0,4,4,4,4,4,4,4,4,4,4,4,4,4,4,4,4,4
.long 0x61ad,0x76543210,0x1e,0x2330,0x2370,0x23b0,0x23f0,4,4,4,4,4,4,4,4,4,4,4,4,4,4,4,4,4,4,4,4,4,4,4,4,4
.long 0x1bd,0x10,0x10471b5,0xe,0x3090,0x3150,0x1e,0x3210,0x32d0,4,4,4,4,4,4,4,4,4,4,4,4,4,4,4,4,4,4,4,4,4,4,4
.long 0x11bd,0x32,0x8461b5,0xb6,0x30,0x90,0xf0,0x150,0x1b0,0x210,0x270,0x2d0,0x330,0x390,0x3f0,4,4,4,4,4,4,4,4,4,4,4,4,4,4,4,4,4
.long 0x21bd,0x54,0x10551b5,0x18501b5,0xe,0x30a0,0x3160,0x1e,0x3220,0x32e0,4,4,4,4,4,4,4,4,4,4,4,4,4,4,4,4,4,4,4,4,4,4
.long 0x31bd,0x76,0x8541b5,0x20511b5,0xe,0x30b0,0x3170,0x1e,0x3230,0x32f0,4,4,4,4,4,4,4,4,4,4,4,4,4,4,4,4,4,4,4,4,4,4
.long 0x41bd,0x3276,0x20431b5,0xb6,0x50,0xb0,0x110,0x170,0x1d0,0x230,0x290,0x2f0,0x350,0x3b0,4,4,4,4,4,4,4,4,4,4,4,4,4,4,4,4,4,4
.long 0x51bd,0x1054,0x18421b5,0xb6,0x10,0x70,0xd0,0x130,0x190,0x1f0,0x250,0x2b0,0x310,0x370,0x3d0,4,4,4,4,4,4,4,4,4,4,4,4,4,4,4,4,4
.long 0x61bd,0x76543210,0x1e,0x3330,0x3370,0x33b0,0x33f0,4,4,4,4,4,4,4,4,4,4,4,4,4,4,4,4,4,4,4,4,4,4,4,4,4
.long 0x1cd,0x10,0x10471c5,0xe,0x4090,0x4150,0x1e,0x4210,0x42d0,4,4,4,4,4,4,4,4,4,4,4,4,4,4,4,4,4,4,4,4,4,4,4
.long 0x11cd,0x32,0x8461c5,0xc6,0x30,0x90,0xf0,0x150,0x1b0,0x210,0x270,0x2d0,0x330,0x390,0x3f0,4,4,4,4,4,4,4,4,4,4,4,4,4,4,4,4,4
.long 0x21cd,0x54,0x10551c5,0x18501c5,0xe,0x40a0,0x4160,0x1e,0x4220,0x42e0,4,4,4,4,4,4,4,4,4,4,4,4,4,4,4,4,4,4,4,4,4,4
.long 0x31cd,0x76,0x8541c5,0x20511c5,0xe,0x40b0,0x4170,0x1e,0x4230,0x42f0,4,4,4,4,4,4,4,4,4,4,4,4,4,4,4,4,4,4,4,4,4,4
.long 0x41cd,0x3276,0x20431c5,0xc6,0x50,0xb0,0x110,0x170,0x1d0,0x230,0x290,0x2f0,0x350,0x3b0,4,4,4,4,4,4,4,4,4,4,4,4,4,4,4,4,4,4
.long 0x51cd,0x1054,0x18421c5,0xc6,0x10,0x70,0xd0,0x130,0x190,0x1f0,0x250,0x2b0,0x310,0x370,0x3d0,4,4,4,4,4,4,4,4,4,4,4,4,4,4,4,4,4
.long 0x61cd,0x76543210,0x1e,0x4330,0x4370,0x43b0,0x43f0,4,4,4,4,4,4,4,4,4,4,4,4,4,4,4,4,4,4,4,4,4,4,4,4,4
.long 0x1dd,0x10,0x10471d5,0xe,0x5090,0x5150,0x1e,0x5210,0x52d0,4,4,4,4,4,4,4,4,4,4,4,4,4,4,4,4,4,4,4,4,4,4,4
.long 0x11dd,0x32,0x8461d5,0xd6,0x30,0x90,0xf0,0x150,0x1b0,0x210,0x270,0x2d0,0x330,0x390,0x3f0,4,4,4,4,4,4,4,4,4,4,4,4,4,4,4,4,4
.long 0x21dd,0x54,0x10551d5,0x18501d5,0xe,0x50a0,0x5160,0x1e,0x5220,0x52e0,4,4,4,4,4,4,4,4,4,4,4,4,4,4,4,4,4,4,4,4,4,4
.long 0x31dd,0x76,0x8541d5,0x20511d5,0xe,0x50b0,0x5170,0x1e,0x5230,0x52f0,4,4,4,4,4,4,4,4,4,4,4,4,4,4,4,4,4,4,4,4,4,4
.long 0x41dd,0x3276,0x20431d5,0xd6,0x50,0xb0,0x110,0x170,0x1d0,0x230,0x290,0x2f0,0x350,0x3b0,4,4,4,4,4,4,4,4,4,4,4,4,4,4,4,4,4,4
.long 0x51dd,0x1054,0x18421d5,0xd6,0x10,0x70,0xd0,0x130,0x190,0x1f0,0x250,0x2b0,0x310,0x370,0x3d0,4,4,4,4,4,4,4,4,4,4,4,4,4,4,4,4,4
.long 0x61dd,0x76543210,0x1e,0x5330,0x5370,0x53b0,0x53f0,4,4,4,4,4,4,4,4,4,4,4,4,4,4,4,4,4,4,4,4,4,4,4,4,4
.long 0x1ed,0x10,0x10471e5,0xe,0x6090,0x6150,0x1e,0x6210,0x62d0,4,4,4,4,4,4,4,4,4,4,4,4,4,4,4,4,4,4,4,4,4,4,4
.long 0x11ed,0x32,0x8461e5,0xe6,0x30,0x90,0xf0,0x150,0x1b0,0x210,0x270,0x2d0,0x330,0x390,0x3f0,4,4,4,4,4,4,4,4,4,4,4,4,4,4,4,4,4
.long 0x21ed,0x54,0x10551e5,0x18501e5,0xe,0x60a0,0x6160,0x1e,0x6220,0x62e0,4,4,4,4,4,4,4,4,4,4,4,4,4,4,4,4,4,4,4,4,4,4
.long 0x31ed,0x76,0x8541e5,0x20511e5,0xe,0x60b0,0x6170,0x1e,0x6230,0x62f0,4,4,4,4,4,4,4,4,4,4,4,4,4,4,4,4,4,4,4,4,4,4
.long 0x41ed,0x3276,0x20431e5,0xe6,0x50,0xb0,0x110,0x170,0x1d0,0x230,0x290,0x2f0,0x350,0x3b0,4,4,4,4,4,4,4,4,4,4,4,4,4,4,4,4,4,4
.long 0x51ed,0x1054,0x18421e5,0xe6,0x10,0x70,0xd0,0x130,0x190,0x1f0,0x250,0x2b0,0x310,0x370,0x3d0,4,4,4,4,4,4,4,4,4,4,4,4,4,4,4,4,4
.long 0x61ed,0x76543210,0x1e,0x6330,0x6370,0x63b0,0x63f0,4,4,4,4,4,4,4,4,4,4,4,4,4,4,4,4,4,4,4,4,4,4,4,4,4
.long 0x1fd,0x10,0x10471f5,0xe,0x7090,0x7150,0x1e,0x7210,0x72d0,4,4,4,4,4,4,4,4,4,4,4,4,4,4,4,4,4,4,4,4,4,4,4
.long 0x11fd,0x32,0x8461f5,0xf6,0x30,0x90,0xf0,0x150,0x1b0,0x210,0x270,0x2d0,0x330,0x390,0x3f0,4,4,4,4,4,4,4,4,4,4,4,4,4,4,4,4,4
.long 0x21fd,0x54,0x10551f5,0x18501f5,0xe,0x70a0,0x7160,0x1e,0x7220,0x72e0,4,4,4,4,4,4,4,4,4,4,4,4,4,4,4,4,4,4,4,4,4,4
.long 0x31fd,0x76,0x8541f5,0x20511f5,0xe,0x70b0,0x7170,0x1e,0x7230,0x72f0,4,4,4,4,4,4,4,4,4,4,4,4,4,4,4,4,4,4,4,4,4,4
.long 0x41fd,0x3276,0x20431f5,0xf6,0x50,0xb0,0x110,0x170,0x1d0,0x230,0x290,0x2f0,0x350,0x3b0,4,4,4,4,4,4,4,4,4,4,4,4,4,4,4,4,4,4
.long 0x51fd,0x1054,0x18421f5,0xf6,0x10,0x70,0xd0,0x130,0x190,0x1f0,0x250,0x2b0,0x310,0x370,0x3d0,4,4,4,4,4,4,4,4,4,4,4,4,4,4,4,4,4
.long 0x61fd,0x76543210,0x1e,0x7330,0x7370,0x73b0,0x73f0,4,4,4,4,4,4,4,4,4,4,4,4,4,4,4,4,4,4,4,4,4,4,4,4,4
.section .rodata,"a"
.p2align 6
.amdhsa_kernel gated_mix__compressed_kv_cla__memory_aug_recurrent_mem_tr__prompt_kernel
  .amdhsa_next_free_vgpr 512
  .amdhsa_next_free_sgpr 102
  .amdhsa_accum_offset 256
  .amdhsa_group_segment_fixed_size 0
  .amdhsa_kernarg_size 136
  .amdhsa_user_sgpr_count 2
  .amdhsa_user_sgpr_kernarg_segment_ptr 1
  .amdhsa_system_sgpr_workgroup_id_x 1
  .amdhsa_float_denorm_mode_32 3
.end_amdhsa_kernel
```

```asm
; @launch grid=(256,1,1) block=(256,1,1) lds=163840
.amdgcn_target "amdgcn-amd-amdhsa--gfx950"
.text
.globl gated_mix__compressed_kv_cla__memory_aug_recurrent_mem_tr__prompt_kernel
.p2align 8
.type gated_mix__compressed_kv_cla__memory_aug_recurrent_mem_tr__prompt_kernel,@function
gated_mix__compressed_kv_cla__memory_aug_recurrent_mem_tr__prompt_kernel:
  s_cmp_ge_u32 s2, 256
  s_cbranch_scc1 L_exit
  s_load_dwordx16 s[8:23], s[0:1], 0
  s_load_dwordx16 s[24:39], s[0:1], 64
  s_load_dwordx2 s[40:41], s[0:1], 128
  s_and_b32 s47, s2, 7
  s_lshr_b32 s45, s2, 3
  s_max_u32 s3, s47, 1
  s_sub_u32 s3, s3, 1
  s_lshl_b32 s3, s3, 5
  s_add_u32 s94, s3, s45
  s_getpc_b64 s[4:5]
L_pc0:
  s_add_u32 s4, s4, L_ptab-L_pc0
  s_addc_u32 s5, s5, 0
  s_lshl_b32 s3, s94, 7
  v_and_b32 v2, 31, v0
  v_lshl_add_u32 v2, v2, 2, s3
  global_load_dword v1, v2, s[4:5]
  s_getreg_b32 s46, hwreg(HW_REG_XCC_ID, 0, 4)
  v_lshrrev_b32 v3, 6, v0
  v_and_b32 v0, 63, v0
  v_readfirstlane_b32 s44, v3
  s_sub_u32 s4, s4, L_ptab-L_pc0
  s_subb_u32 s5, s5, 0
  s_and_b32 s3, s45, 15
  s_lshl_b32 s3, s3, 13
  v_lshl_add_u32 v2, v0, 7, s3
  v_min_u32 v2, L_ptab-L_pc0, v2
  s_cmp_lg_u32 s44, 3
  s_cbranch_scc1 L_nocodepf
  global_load_dword v31, v2, s[4:5]
L_nocodepf:
  s_and_b32 s46, s46, 7
  s_waitcnt lgkmcnt(0)
  s_add_u32 s40, s40, 0x0
  s_addc_u32 s41, s41, 0
  s_and_b32 s41, s41, 0xffff
  s_mov_b32 s42, 0x10000000
  s_mov_b32 s43, 0x20000
  s_cmp_eq_u32 s47, 0
  s_cbranch_scc1 L_team
  s_lshl2_add_u32 s3, s94, s44
  v_lshlrev_b32 v2, 7, v0
  s_mov_b32 s95, 0
  s_mov_b32 s50, 0x200000
  s_mov_b32 s51, 0x20000
  s_add_u32 s4, s3, 0
  s_lshr_b32 s5, s4, 8
  s_and_b32 s4, s4, 255
  s_lshl_b32 s4, s4, 13
  s_mov_b64 s[48:49], s[8:9]
  s_mov_b32 s6, 0
  s_cmp_eq_u32 s5, 0
  s_cselect_b64 s[48:49], s[8:9], s[48:49]
  s_cselect_b32 s6, 0x0, s6
  s_cmp_eq_u32 s5, 1
  s_cselect_b64 s[48:49], s[10:11], s[48:49]
  s_cselect_b32 s6, 0x0, s6
  s_add_u32 s48, s48, s6
  s_addc_u32 s49, s49, 0
  s_and_b32 s49, s49, 0xffff
  s_cmp_lt_u32 s5, 2
  s_cselect_b32 s4, s4, 0x40000000
  buffer_load_dword v31, v2, s[48:51], s4 offen
  s_waitcnt vmcnt(1)
L_next:
  v_readlane_b32 s3, v1, s95
  s_add_u32 s95, s95, 1
  s_nop 0
  s_and_b32 s4, s3, 3
  s_cmp_eq_u32 s4, 0
  s_cbranch_scc1 L_after_p
  s_cmp_eq_u32 s4, 2
  s_cbranch_scc1 L_go_outx
L_go_att:
  s_bfe_u32 s56, s3, 0x50004
  s_bfe_u32 s57, s3, 0x3000c
  s_bitcmp1_b32 s3, 3
  s_cbranch_scc1 L_feed
L_att:
  v_lshlrev_b32 v2, 4, v0
  s_lshl_b32 s65, s44, 11
  v_add_u32 v3, s65, v2
  s_mov_b32 s74, 0
  v_and_b32 v6, 7, v0
  s_lshl3_add_u32 s67, s57, 8
  v_lshlrev_b32 v7, 4, v6
  v_sub_u32 v7, s67, v7
  v_med3_i32 v7, v7, 0, 16
  s_lshl_b32 s66, s56, 7
  s_add_u32 s66, s66, 0xd080000
  v_lshl_add_u32 v6, v6, 2, s66
  s_bfe_u32 m0, s3, 0x30010
  s_bfe_u32 s67, s3, 0x60014
  s_nop 0
  v_writelane_b32 v7, s67, m0
  s_lshl_b32 s66, s57, 7
  s_add_u32 s66, s66, 0xd086400
  v_writelane_b32 v6, s66, 63
  v_writelane_b32 v7, 16, 63
  buffer_load_dword v24, v6, s[40:43], 0 offen sc1
  v_mov_b64 v[128:129], 0
  v_mov_b64 v[130:131], 0
  v_mov_b64 v[132:133], 0
  v_mov_b64 v[134:135], 0
  v_mov_b64 v[136:137], 0
  v_mov_b64 v[138:139], 0
  v_mov_b64 v[140:141], 0
  v_mov_b64 v[142:143], 0
  v_mov_b64 v[144:145], 0
  v_mov_b64 v[146:147], 0
  v_mov_b64 v[148:149], 0
  v_mov_b64 v[150:151], 0
  v_mov_b64 v[152:153], 0
  v_mov_b64 v[154:155], 0
  v_mov_b64 v[156:157], 0
  v_mov_b64 v[158:159], 0
  v_mov_b64 v[160:161], 0
  v_mov_b64 v[162:163], 0
  v_mov_b64 v[164:165], 0
  v_mov_b64 v[166:167], 0
  v_mov_b64 v[168:169], 0
  v_mov_b64 v[170:171], 0
  v_mov_b64 v[172:173], 0
  v_mov_b64 v[174:175], 0
  v_mov_b64 v[176:177], 0
  v_mov_b64 v[178:179], 0
  v_mov_b64 v[180:181], 0
  v_mov_b64 v[182:183], 0
  v_mov_b64 v[184:185], 0
  v_mov_b64 v[186:187], 0
  v_mov_b64 v[188:189], 0
  v_mov_b64 v[190:191], 0
  v_mov_b64 v[192:193], 0
  v_mov_b64 v[194:195], 0
  v_mov_b64 v[196:197], 0
  v_mov_b64 v[198:199], 0
  v_mov_b64 v[200:201], 0
  v_mov_b64 v[202:203], 0
  v_mov_b64 v[204:205], 0
  v_mov_b64 v[206:207], 0
  v_mov_b64 v[208:209], 0
  v_mov_b64 v[210:211], 0
  v_mov_b64 v[212:213], 0
  v_mov_b64 v[214:215], 0
  v_mov_b64 v[216:217], 0
  v_mov_b64 v[218:219], 0
  v_mov_b64 v[220:221], 0
  v_mov_b64 v[222:223], 0
  v_mov_b64 v[224:225], 0
  v_mov_b64 v[226:227], 0
  v_mov_b64 v[228:229], 0
  v_mov_b64 v[230:231], 0
  v_mov_b64 v[232:233], 0
  v_mov_b64 v[234:235], 0
  v_mov_b64 v[236:237], 0
  v_mov_b64 v[238:239], 0
  v_mov_b64 v[240:241], 0
  v_mov_b64 v[242:243], 0
  v_mov_b64 v[244:245], 0
  v_mov_b64 v[246:247], 0
  v_mov_b64 v[248:249], 0
  v_mov_b64 v[250:251], 0
  v_mov_b64 v[252:253], 0
  v_mov_b64 v[254:255], 0
  v_mov_b64 v[96:97], 0
  v_accvgpr_write_b32 a128, 0
  v_mov_b64 v[98:99], 0
  v_accvgpr_write_b32 a129, 0
  v_mov_b64 v[100:101], 0
  v_accvgpr_write_b32 a130, 0
  v_mov_b64 v[102:103], 0
  v_accvgpr_write_b32 a131, 0
  v_mov_b64 v[104:105], 0
  v_accvgpr_write_b32 a132, 0
  v_mov_b64 v[106:107], 0
  v_accvgpr_write_b32 a133, 0
  v_mov_b64 v[108:109], 0
  v_accvgpr_write_b32 a134, 0
  v_mov_b64 v[110:111], 0
  v_accvgpr_write_b32 a135, 0
  v_mov_b64 v[112:113], 0
  v_accvgpr_write_b32 a136, 0
  v_mov_b64 v[114:115], 0
  v_accvgpr_write_b32 a137, 0
  v_mov_b64 v[116:117], 0
  v_accvgpr_write_b32 a138, 0
  v_mov_b64 v[118:119], 0
  v_accvgpr_write_b32 a139, 0
  v_mov_b64 v[120:121], 0
  v_accvgpr_write_b32 a140, 0
  v_mov_b64 v[122:123], 0
  v_accvgpr_write_b32 a141, 0
  v_mov_b64 v[124:125], 0
  v_accvgpr_write_b32 a142, 0
  v_mov_b64 v[126:127], 0
  v_accvgpr_write_b32 a143, 0
  v_mov_b32 v16, 0x3f803f80
  v_mov_b32 v17, 0x3f803f80
  v_mov_b32 v18, 0x3f803f80
  v_mov_b32 v19, 0x3f803f80
  s_mov_b32 s48, s18
  s_and_b32 s49, s19, 0xffff
  s_mov_b32 s50, 0x400000
  s_mov_b32 s51, 0x20000
  s_lshl_b32 s66, s56, 19
  s_add_u32 s60, s66, 0x1000000
  s_add_u32 s61, s66, 0x2000000
  s_lshl_b32 s59, s57, 3
  s_lshr_b32 s67, s44, 1
  s_add_u32 s67, s67, s59
  s_lshl_b32 s68, s67, 13
  s_add_u32 s68, s68, s66
  s_and_b32 s67, s44, 1
  s_lshl_b32 s67, s67, 10
  s_add_u32 s68, s68, s67
  s_lshl4_add_u32 s69, s57, s44
  s_add_u32 s63, s59, 7
  s_lshl_b32 s63, s63, 13
  s_add_u32 s63, s63, s60
  s_sub_u32 s59, s59, 1
  s_add_u32 s62, s60, 0x4000
  s_mov_b32 s64, 0
  s_mov_b32 s70, 0x40004000
  s_lshl_b32 s73, s44, 12
  s_lshl_b32 s72, s56, 17
  s_lshl_b32 s67, s44, 15
  s_add_u32 s72, s72, s67
  s_and_b32 s67, s56, 3
  s_lshl_b32 s67, s67, 8
  s_add_u32 s72, s72, s67
  s_lshl_b32 s75, s57, 5
  s_add_u32 s75, s75, s56
  s_lshl2_add_u32 s75, s75, s44
  s_lshl_b32 s75, s75, 14
  s_add_u32 s75, s75, 0x9000000
  v_lshrrev_b32 v8, 4, v0
  v_and_b32 v9, 15, v0
  s_lshl_b32 s67, s44, 4
  v_add_u32 v25, s67, v9
  v_lshlrev_b32 v10, 2, v8
  v_sub_u32 v25, v25, v10
  v_lshlrev_b32 v8, 1, v8
  v_and_b32 v10, 7, v0
  v_xor_b32 v8, v8, v10
  v_lshlrev_b32 v8, 4, v8
  v_lshrrev_b32 v10, 3, v0
  v_lshl_add_u32 v26, v10, 10, v8
  v_lshlrev_b32 v9, 2, v9
  v_add_u32 v4, 122880, v2
L_a_wait:
  s_waitcnt vmcnt(0)
  v_cmp_gt_u32 vcc, v7, v24
  s_cbranch_vccz L_a_go
  s_sleep 4
  buffer_load_dword v24, v6, s[40:43], 0 offen sc1
  s_add_u32 s74, s74, 1
  s_cmp_gt_u32 s74, 1048576
  s_cbranch_scc1 L_exit
  s_branch L_a_wait
L_a_go:
  s_add_u32 m0, s65, 131072
  s_add_u32 s66, s60, 0x2000
  buffer_load_dwordx4 v3, s[40:43], s60 offen sc1 lds
  buffer_load_dwordx4 v3, s[40:43], s60 offen offset:1024 sc1 lds
  s_add_u32 m0, s65, 139264
  s_lshl_b32 s67, s69, 6
  buffer_load_dwordx4 v3, s[40:43], s66 offen sc1 lds
  buffer_load_dwordx4 v3, s[40:43], s66 offen offset:1024 sc1 lds
  s_add_u32 s67, s67, 0xd0c0000
  s_add_u32 s58, s68, 0x1000
  buffer_load_dwordx4 a[0:3], v2, s[40:43], s68 offen offset:0 sc1
  buffer_load_dwordx4 a[4:7], v2, s[40:43], s68 offen offset:2048 sc1
  buffer_load_dwordx4 a[8:11], v2, s[40:43], s58 offen offset:0 sc1
  buffer_load_dwordx4 a[12:15], v2, s[40:43], s58 offen offset:2048 sc1
  s_add_u32 s68, s68, 0x4000
  s_add_u32 s58, s68, 0x1000
  buffer_load_dwordx4 a[16:19], v2, s[40:43], s68 offen offset:0 sc1
  buffer_load_dwordx4 a[20:23], v2, s[40:43], s68 offen offset:2048 sc1
  buffer_load_dwordx4 a[24:27], v2, s[40:43], s58 offen offset:0 sc1
  buffer_load_dwordx4 a[28:31], v2, s[40:43], s58 offen offset:2048 sc1
  s_add_u32 s68, s68, 0x4000
  s_add_u32 s58, s68, 0x1000
  buffer_load_dwordx4 a[32:35], v2, s[40:43], s68 offen offset:0 sc1
  buffer_load_dwordx4 a[36:39], v2, s[40:43], s68 offen offset:2048 sc1
  buffer_load_dwordx4 a[40:43], v2, s[40:43], s58 offen offset:0 sc1
  buffer_load_dwordx4 a[44:47], v2, s[40:43], s58 offen offset:2048 sc1
  s_add_u32 s68, s68, 0x4000
  s_add_u32 s58, s68, 0x1000
  buffer_load_dwordx4 a[48:51], v2, s[40:43], s68 offen offset:0 sc1
  buffer_load_dwordx4 a[52:55], v2, s[40:43], s68 offen offset:2048 sc1
  buffer_load_dwordx4 a[56:59], v2, s[40:43], s58 offen offset:0 sc1
  buffer_load_dwordx4 a[60:63], v2, s[40:43], s58 offen offset:2048 sc1
  s_add_u32 s68, s68, 0x4000
  buffer_load_dword v20, v9, s[40:43], s67 offen offset:0 sc1
  buffer_load_dword v21, v9, s[40:43], s67 offen offset:256 sc1
  buffer_load_dword v22, v9, s[40:43], s67 offen offset:512 sc1
  buffer_load_dword v23, v9, s[40:43], s67 offen offset:768 sc1
  s_add_u32 m0, s64, s65
  s_nop 0
  buffer_load_dwordx4 v3, s[40:43], s61 offen sc1 lds
  s_min_u32 s66, s62, s63
  s_nop 0
  buffer_load_dwordx4 v3, s[40:43], s61 offen offset:1024 sc1 lds
  s_add_u32 m0, m0, 0x2000
  s_nop 0
  buffer_load_dwordx4 v3, s[40:43], s66 offen sc1 lds
  s_add_u32 s61, s61, 0x2000
  s_nop 0
  buffer_load_dwordx4 v3, s[40:43], s66 offen offset:1024 sc1 lds
  s_add_u32 s62, s62, 0x2000
  s_add_u32 s64, s64, 0x4000
  s_and_b32 s64, s64, 0x1ffff
  s_add_u32 m0, s64, s65
  s_nop 0
  buffer_load_dwordx4 v3, s[40:43], s61 offen sc1 lds
  s_min_u32 s66, s62, s63
  s_nop 0
  buffer_load_dwordx4 v3, s[40:43], s61 offen offset:1024 sc1 lds
  s_add_u32 m0, m0, 0x2000
  s_nop 0
  buffer_load_dwordx4 v3, s[40:43], s66 offen sc1 lds
  s_add_u32 s61, s61, 0x2000
  s_nop 0
  buffer_load_dwordx4 v3, s[40:43], s66 offen offset:1024 sc1 lds
  s_add_u32 s62, s62, 0x2000
  s_add_u32 s64, s64, 0x4000
  s_and_b32 s64, s64, 0x1ffff
  s_mul_i32 s69, s69, 393216
  s_lshl_b32 s67, s56, 12
  s_add_u32 s69, s69, s67
  s_add_u32 s76, s69, 0x6000000
  s_add_u32 s77, s69, 0x6180000
  s_add_u32 s78, s69, 0x6300000
  s_add_u32 s79, s69, 0x6480000
  v_mov_b32 v24, 0xff800000
  s_cmp_lg_u32 s57, 0
  s_cbranch_scc1 L_a_nomask0
  v_cmp_gt_i32 s[80:81], 0, v25
  v_cmp_gt_i32 s[82:83], 1, v25
  v_cmp_gt_i32 s[84:85], 2, v25
  v_cmp_gt_i32 s[86:87], 3, v25
  v_cndmask_b32 v96, v96, v24, s[80:81]
  v_cndmask_b32 v97, v97, v24, s[82:83]
  v_cndmask_b32 v98, v98, v24, s[84:85]
  v_cndmask_b32 v99, v99, v24, s[86:87]
  v_cmp_gt_i32 s[80:81], 16, v25
  v_cmp_gt_i32 s[82:83], 17, v25
  v_cmp_gt_i32 s[84:85], 18, v25
  v_cmp_gt_i32 s[86:87], 19, v25
  v_cndmask_b32 v100, v100, v24, s[80:81]
  v_cndmask_b32 v101, v101, v24, s[82:83]
  v_cndmask_b32 v102, v102, v24, s[84:85]
  v_cndmask_b32 v103, v103, v24, s[86:87]
L_a_nomask0:
  s_waitcnt vmcnt(28)
  s_barrier
  ds_read_b128 a[64:67], v4 offset:8192
  ds_read_b128 a[68:71], v4 offset:9216
  ds_read_b128 a[72:75], v4 offset:10240
  ds_read_b128 a[76:79], v4 offset:11264
  ds_read_b128 a[80:83], v4 offset:12288
  ds_read_b128 a[84:87], v4 offset:13312
  ds_read_b128 a[88:91], v4 offset:14336
  ds_read_b128 a[92:95], v4 offset:15360
  v_add_u32 v4, 0x2000, v4
  s_waitcnt vmcnt(24) lgkmcnt(0)
  v_mfma_f32_16x16x32_bf16 v[32:35], a[64:67], a[0:3], v[96:99]
  v_mfma_f32_16x16x32_bf16 v[32:35], a[72:75], a[4:7], v[32:35]
  v_mfma_f32_16x16x32_bf16 v[32:35], a[80:83], a[8:11], v[32:35]
  v_mfma_f32_16x16x32_bf16 v[32:35], a[88:91], a[12:15], v[32:35]
  v_mfma_f32_16x16x32_bf16 v[36:39], a[68:71], a[0:3], v[100:103]
  v_mfma_f32_16x16x32_bf16 v[36:39], a[76:79], a[4:7], v[36:39]
  v_mfma_f32_16x16x32_bf16 v[36:39], a[84:87], a[8:11], v[36:39]
  v_mfma_f32_16x16x32_bf16 v[36:39], a[92:95], a[12:15], v[36:39]
  s_waitcnt vmcnt(20) lgkmcnt(0)
  v_mfma_f32_16x16x32_bf16 v[40:43], a[64:67], a[16:19], v[104:107]
  v_mfma_f32_16x16x32_bf16 v[40:43], a[72:75], a[20:23], v[40:43]
  v_mfma_f32_16x16x32_bf16 v[40:43], a[80:83], a[24:27], v[40:43]
  v_mfma_f32_16x16x32_bf16 v[40:43], a[88:91], a[28:31], v[40:43]
  v_mfma_f32_16x16x32_bf16 v[44:47], a[68:71], a[16:19], v[108:111]
  v_mfma_f32_16x16x32_bf16 v[44:47], a[76:79], a[20:23], v[44:47]
  v_mfma_f32_16x16x32_bf16 v[44:47], a[84:87], a[24:27], v[44:47]
  v_mfma_f32_16x16x32_bf16 v[44:47], a[92:95], a[28:31], v[44:47]
  s_waitcnt vmcnt(16) lgkmcnt(0)
  v_mfma_f32_16x16x32_bf16 v[48:51], a[64:67], a[32:35], v[112:115]
  v_mfma_f32_16x16x32_bf16 v[48:51], a[72:75], a[36:39], v[48:51]
  v_mfma_f32_16x16x32_bf16 v[48:51], a[80:83], a[40:43], v[48:51]
  v_mfma_f32_16x16x32_bf16 v[48:51], a[88:91], a[44:47], v[48:51]
  v_mfma_f32_16x16x32_bf16 v[52:55], a[68:71], a[32:35], v[116:119]
  v_mfma_f32_16x16x32_bf16 v[52:55], a[76:79], a[36:39], v[52:55]
  v_mfma_f32_16x16x32_bf16 v[52:55], a[84:87], a[40:43], v[52:55]
  v_mfma_f32_16x16x32_bf16 v[52:55], a[92:95], a[44:47], v[52:55]
  s_waitcnt vmcnt(12) lgkmcnt(0)
  v_mfma_f32_16x16x32_bf16 v[56:59], a[64:67], a[48:51], v[120:123]
  v_mfma_f32_16x16x32_bf16 v[56:59], a[72:75], a[52:55], v[56:59]
  v_mfma_f32_16x16x32_bf16 v[56:59], a[80:83], a[56:59], v[56:59]
  v_mfma_f32_16x16x32_bf16 v[56:59], a[88:91], a[60:63], v[56:59]
  v_mfma_f32_16x16x32_bf16 v[60:63], a[68:71], a[48:51], v[124:127]
  v_mfma_f32_16x16x32_bf16 v[60:63], a[76:79], a[52:55], v[60:63]
  v_mfma_f32_16x16x32_bf16 v[60:63], a[84:87], a[56:59], v[60:63]
  v_mfma_f32_16x16x32_bf16 v[60:63], a[92:95], a[60:63], v[60:63]
  ds_read_b128 a[64:67], v4 offset:8192
  ds_read_b128 a[68:71], v4 offset:9216
  ds_read_b128 a[72:75], v4 offset:10240
  ds_read_b128 a[76:79], v4 offset:11264
  ds_read_b128 a[80:83], v4 offset:12288
  ds_read_b128 a[84:87], v4 offset:13312
  ds_read_b128 a[88:91], v4 offset:14336
  ds_read_b128 a[92:95], v4 offset:15360
  v_mov_b32 v4, v2
  s_add_u32 m0, s64, s65
  s_nop 0
  buffer_load_dwordx4 v3, s[40:43], s61 offen sc1 lds
  s_min_u32 s66, s62, s63
  s_nop 0
  buffer_load_dwordx4 v3, s[40:43], s61 offen offset:1024 sc1 lds
  s_add_u32 m0, m0, 0x2000
  s_nop 0
  buffer_load_dwordx4 v3, s[40:43], s66 offen sc1 lds
  s_add_u32 s61, s61, 0x2000
  s_nop 0
  buffer_load_dwordx4 v3, s[40:43], s66 offen offset:1024 sc1 lds
  s_add_u32 s62, s62, 0x2000
  s_add_u32 s64, s64, 0x4000
  s_and_b32 s64, s64, 0x1ffff
  v_max3_f32 v6, v32, v33, v34
  v_max3_f32 v7, v35, v36, v37
  v_max3_f32 v6, v6, v38, v39
  v_max_f32 v6, v6, v7
  v_mov_b32 v7, v6
  s_nop 1
  v_permlane32_swap_b32 v7, v6
  v_max_f32 v6, v6, v7
  v_mov_b32 v7, v6
  s_nop 1
  v_permlane16_swap_b32 v7, v6
  v_max_f32 v6, v6, v7
  v_add_f32 v6, 0x41800000, v6
  v_sub_f32 v96, v96, v6
  v_sub_f32 v97, v97, v6
  v_sub_f32 v98, v98, v6
  v_sub_f32 v99, v99, v6
  v_sub_f32 v100, v100, v6
  v_sub_f32 v101, v101, v6
  v_sub_f32 v102, v102, v6
  v_sub_f32 v103, v103, v6
  v_sub_f32 v8, v32, v6
  v_sub_f32 v9, v33, v6
  v_sub_f32 v10, v34, v6
  v_sub_f32 v11, v35, v6
  v_sub_f32 v12, v36, v6
  v_sub_f32 v13, v37, v6
  v_sub_f32 v14, v38, v6
  v_sub_f32 v15, v39, v6
  v_exp_f32 v8, v8
  v_exp_f32 v9, v9
  v_exp_f32 v10, v10
  v_exp_f32 v11, v11
  v_exp_f32 v12, v12
  v_exp_f32 v13, v13
  v_exp_f32 v14, v14
  v_exp_f32 v15, v15
  v_cvt_pk_bf16_f32 v64, v8, v9
  v_cvt_pk_bf16_f32 v65, v10, v11
  v_cvt_pk_bf16_f32 v66, v12, v13
  v_cvt_pk_bf16_f32 v67, v14, v15
  s_add_u32 m0, s64, s65
  s_nop 0
  buffer_load_dwordx4 v3, s[40:43], s61 offen sc1 lds
  s_min_u32 s66, s62, s63
  s_nop 0
  buffer_load_dwordx4 v3, s[40:43], s61 offen offset:1024 sc1 lds
  s_add_u32 m0, m0, 0x2000
  s_nop 0
  buffer_load_dwordx4 v3, s[40:43], s66 offen sc1 lds
  s_add_u32 s61, s61, 0x2000
  s_nop 0
  buffer_load_dwordx4 v3, s[40:43], s66 offen offset:1024 sc1 lds
  s_add_u32 s62, s62, 0x2000
  s_add_u32 s64, s64, 0x4000
  s_and_b32 s64, s64, 0x1ffff
  v_max3_f32 v6, v40, v41, v42
  v_max3_f32 v7, v43, v44, v45
  v_max3_f32 v6, v6, v46, v47
  v_max_f32 v6, v6, v7
  v_mov_b32 v7, v6
  s_nop 1
  v_permlane32_swap_b32 v7, v6
  v_max_f32 v6, v6, v7
  v_mov_b32 v7, v6
  s_nop 1
  v_permlane16_swap_b32 v7, v6
  v_max_f32 v6, v6, v7
  v_add_f32 v6, 0x41800000, v6
  v_sub_f32 v104, v104, v6
  v_sub_f32 v105, v105, v6
  v_sub_f32 v106, v106, v6
  v_sub_f32 v107, v107, v6
  v_sub_f32 v108, v108, v6
  v_sub_f32 v109, v109, v6
  v_sub_f32 v110, v110, v6
  v_sub_f32 v111, v111, v6
  v_sub_f32 v8, v40, v6
  v_sub_f32 v9, v41, v6
  v_sub_f32 v10, v42, v6
  v_sub_f32 v11, v43, v6
  v_sub_f32 v12, v44, v6
  v_sub_f32 v13, v45, v6
  v_sub_f32 v14, v46, v6
  v_sub_f32 v15, v47, v6
  v_exp_f32 v8, v8
  v_exp_f32 v9, v9
  v_exp_f32 v10, v10
  v_exp_f32 v11, v11
  v_exp_f32 v12, v12
  v_exp_f32 v13, v13
  v_exp_f32 v14, v14
  v_exp_f32 v15, v15
  v_cvt_pk_bf16_f32 v68, v8, v9
  v_cvt_pk_bf16_f32 v69, v10, v11
  v_cvt_pk_bf16_f32 v70, v12, v13
  v_cvt_pk_bf16_f32 v71, v14, v15
  s_add_u32 m0, s64, s65
  s_nop 0
  buffer_load_dwordx4 v3, s[40:43], s61 offen sc1 lds
  s_min_u32 s66, s62, s63
  s_nop 0
  buffer_load_dwordx4 v3, s[40:43], s61 offen offset:1024 sc1 lds
  s_add_u32 m0, m0, 0x2000
  s_nop 0
  buffer_load_dwordx4 v3, s[40:43], s66 offen sc1 lds
  s_add_u32 s61, s61, 0x2000
  s_nop 0
  buffer_load_dwordx4 v3, s[40:43], s66 offen offset:1024 sc1 lds
  s_add_u32 s62, s62, 0x2000
  s_add_u32 s64, s64, 0x4000
  s_and_b32 s64, s64, 0x1ffff
  v_max3_f32 v6, v48, v49, v50
  v_max3_f32 v7, v51, v52, v53
  v_max3_f32 v6, v6, v54, v55
  v_max_f32 v6, v6, v7
  v_mov_b32 v7, v6
  s_nop 1
  v_permlane32_swap_b32 v7, v6
  v_max_f32 v6, v6, v7
  v_mov_b32 v7, v6
  s_nop 1
  v_permlane16_swap_b32 v7, v6
  v_max_f32 v6, v6, v7
  v_add_f32 v6, 0x41800000, v6
  v_sub_f32 v112, v112, v6
  v_sub_f32 v113, v113, v6
  v_sub_f32 v114, v114, v6
  v_sub_f32 v115, v115, v6
  v_sub_f32 v116, v116, v6
  v_sub_f32 v117, v117, v6
  v_sub_f32 v118, v118, v6
  v_sub_f32 v119, v119, v6
  v_sub_f32 v8, v48, v6
  v_sub_f32 v9, v49, v6
  v_sub_f32 v10, v50, v6
  v_sub_f32 v11, v51, v6
  v_sub_f32 v12, v52, v6
  v_sub_f32 v13, v53, v6
  v_sub_f32 v14, v54, v6
  v_sub_f32 v15, v55, v6
  v_exp_f32 v8, v8
  v_exp_f32 v9, v9
  v_exp_f32 v10, v10
  v_exp_f32 v11, v11
  v_exp_f32 v12, v12
  v_exp_f32 v13, v13
  v_exp_f32 v14, v14
  v_exp_f32 v15, v15
  v_cvt_pk_bf16_f32 v72, v8, v9
  v_cvt_pk_bf16_f32 v73, v10, v11
  v_cvt_pk_bf16_f32 v74, v12, v13
  v_cvt_pk_bf16_f32 v75, v14, v15
  s_add_u32 m0, s64, s65
  s_nop 0
  buffer_load_dwordx4 v3, s[40:43], s61 offen sc1 lds
  s_min_u32 s66, s62, s63
  s_nop 0
  buffer_load_dwordx4 v3, s[40:43], s61 offen offset:1024 sc1 lds
  s_add_u32 m0, m0, 0x2000
  s_nop 0
  buffer_load_dwordx4 v3, s[40:43], s66 offen sc1 lds
  s_add_u32 s61, s61, 0x2000
  s_nop 0
  buffer_load_dwordx4 v3, s[40:43], s66 offen offset:1024 sc1 lds
  s_add_u32 s62, s62, 0x2000
  s_add_u32 s64, s64, 0x4000
  s_and_b32 s64, s64, 0x1ffff
  v_max3_f32 v6, v56, v57, v58
  v_max3_f32 v7, v59, v60, v61
  v_max3_f32 v6, v6, v62, v63
  v_max_f32 v6, v6, v7
  v_mov_b32 v7, v6
  s_nop 1
  v_permlane32_swap_b32 v7, v6
  v_max_f32 v6, v6, v7
  v_mov_b32 v7, v6
  s_nop 1
  v_permlane16_swap_b32 v7, v6
  v_max_f32 v6, v6, v7
  v_add_f32 v6, 0x41800000, v6
  v_sub_f32 v120, v120, v6
  v_sub_f32 v121, v121, v6
  v_sub_f32 v122, v122, v6
  v_sub_f32 v123, v123, v6
  v_sub_f32 v124, v124, v6
  v_sub_f32 v125, v125, v6
  v_sub_f32 v126, v126, v6
  v_sub_f32 v127, v127, v6
  v_sub_f32 v8, v56, v6
  v_sub_f32 v9, v57, v6
  v_sub_f32 v10, v58, v6
  v_sub_f32 v11, v59, v6
  v_sub_f32 v12, v60, v6
  v_sub_f32 v13, v61, v6
  v_sub_f32 v14, v62, v6
  v_sub_f32 v15, v63, v6
  v_exp_f32 v8, v8
  v_exp_f32 v9, v9
  v_exp_f32 v10, v10
  v_exp_f32 v11, v11
  v_exp_f32 v12, v12
  v_exp_f32 v13, v13
  v_exp_f32 v14, v14
  v_exp_f32 v15, v15
  v_cvt_pk_bf16_f32 v76, v8, v9
  v_cvt_pk_bf16_f32 v77, v10, v11
  v_cvt_pk_bf16_f32 v78, v12, v13
  v_cvt_pk_bf16_f32 v79, v14, v15
  s_add_u32 m0, s64, s65
  s_nop 0
  buffer_load_dwordx4 v3, s[40:43], s61 offen sc1 lds
  s_min_u32 s66, s62, s63
  s_nop 0
  buffer_load_dwordx4 v3, s[40:43], s61 offen offset:1024 sc1 lds
  s_add_u32 m0, m0, 0x2000
  s_nop 0
  buffer_load_dwordx4 v3, s[40:43], s66 offen sc1 lds
  s_add_u32 s61, s61, 0x2000
  s_nop 0
  buffer_load_dwordx4 v3, s[40:43], s66 offen offset:1024 sc1 lds
  s_add_u32 s62, s62, 0x2000
  s_add_u32 s64, s64, 0x4000
  s_and_b32 s64, s64, 0x1ffff
  s_mov_b32 s58, 0
  s_cmp_lg_u32 s57, 0
  s_cbranch_scc1 L_a_s0
  v_cmp_gt_i32 s[80:81], 32, v25
  v_cmp_gt_i32 s[82:83], 33, v25
  v_cmp_gt_i32 s[84:85], 34, v25
  v_cmp_gt_i32 s[86:87], 35, v25
  v_cndmask_b32 v96, v96, v24, s[80:81]
  v_cndmask_b32 v97, v97, v24, s[82:83]
  v_cndmask_b32 v98, v98, v24, s[84:85]
  v_cndmask_b32 v99, v99, v24, s[86:87]
  v_cmp_gt_i32 s[80:81], 48, v25
  v_cmp_gt_i32 s[82:83], 49, v25
  v_cmp_gt_i32 s[84:85], 50, v25
  v_cmp_gt_i32 s[86:87], 51, v25
  v_cndmask_b32 v100, v100, v24, s[80:81]
  v_cndmask_b32 v101, v101, v24, s[82:83]
  v_cndmask_b32 v102, v102, v24, s[84:85]
  v_cndmask_b32 v103, v103, v24, s[86:87]
  s_branch L_a_d1
L_a_s1:
  s_waitcnt vmcnt(24) lgkmcnt(0)
  v_mfma_f32_16x16x32_bf16 v[32:35], a[64:67], a[0:3], v[96:99]
  s_barrier
  ds_read_b128 a[96:99], v4 offset:0
  v_mfma_f32_16x16x32_bf16 v[32:35], a[72:75], a[4:7], v[32:35]
  s_nop 0
  ds_read_b128 a[100:103], v4 offset:1024
  v_mfma_f32_16x16x32_bf16 v[32:35], a[80:83], a[8:11], v[32:35]
  s_nop 0
  ds_read_b128 a[104:107], v4 offset:2048
  v_mfma_f32_16x16x32_bf16 v[32:35], a[88:91], a[12:15], v[32:35]
  s_nop 0
  ds_read_b128 a[108:111], v4 offset:3072
  v_mfma_f32_16x16x32_bf16 v[36:39], a[68:71], a[0:3], v[100:103]
  s_nop 0
  ds_read_b128 a[112:115], v4 offset:4096
  v_mfma_f32_16x16x32_bf16 v[36:39], a[76:79], a[4:7], v[36:39]
  s_nop 0
  ds_read_b128 a[116:119], v4 offset:5120
  v_mfma_f32_16x16x32_bf16 v[36:39], a[84:87], a[8:11], v[36:39]
  s_nop 0
  ds_read_b128 a[120:123], v4 offset:6144
  v_mfma_f32_16x16x32_bf16 v[36:39], a[92:95], a[12:15], v[36:39]
  s_nop 0
  ds_read_b128 a[124:127], v4 offset:7168
  v_mfma_f32_16x16x32_bf16 v[40:43], a[64:67], a[16:19], v[104:107]
  s_nop 0
  v_exp_f32 v8, v32
  v_mfma_f32_16x16x32_bf16 v[40:43], a[72:75], a[20:23], v[40:43]
  s_nop 0
  v_exp_f32 v9, v33
  v_mfma_f32_16x16x32_bf16 v[40:43], a[80:83], a[24:27], v[40:43]
  s_nop 0
  v_exp_f32 v10, v34
  v_mfma_f32_16x16x32_bf16 v[40:43], a[88:91], a[28:31], v[40:43]
  s_nop 0
  v_exp_f32 v11, v35
  v_mfma_f32_16x16x32_bf16 v[44:47], a[68:71], a[16:19], v[108:111]
  s_nop 0
  v_cvt_pk_bf16_f32 v64, v8, v9
  v_cvt_pk_bf16_f32 v65, v10, v11
  v_mfma_f32_16x16x32_bf16 v[44:47], a[76:79], a[20:23], v[44:47]
  s_nop 0
  v_or_b32 v5, v64, v65
  v_mfma_f32_16x16x32_bf16 v[44:47], a[84:87], a[24:27], v[44:47]
  s_nop 0
  v_exp_f32 v12, v36
  v_mfma_f32_16x16x32_bf16 v[44:47], a[92:95], a[28:31], v[44:47]
  s_nop 0
  v_exp_f32 v13, v37
  v_mfma_f32_16x16x32_bf16 v[48:51], a[64:67], a[32:35], v[112:115]
  s_nop 0
  v_exp_f32 v14, v38
  v_mfma_f32_16x16x32_bf16 v[48:51], a[72:75], a[36:39], v[48:51]
  s_nop 0
  v_exp_f32 v15, v39
  v_mfma_f32_16x16x32_bf16 v[48:51], a[80:83], a[40:43], v[48:51]
  s_nop 0
  v_cvt_pk_bf16_f32 v66, v12, v13
  v_cvt_pk_bf16_f32 v67, v14, v15
  v_mfma_f32_16x16x32_bf16 v[48:51], a[88:91], a[44:47], v[48:51]
  s_add_u32 m0, s64, s65
  s_nop 0
  buffer_load_dwordx4 v3, s[40:43], s61 offen sc1 lds
  v_or3_b32 v5, v5, v66, v67
  v_mfma_f32_16x16x32_bf16 v[52:55], a[68:71], a[32:35], v[116:119]
  s_nop 0
  v_exp_f32 v8, v40
  v_mfma_f32_16x16x32_bf16 v[52:55], a[76:79], a[36:39], v[52:55]
  s_nop 0
  v_exp_f32 v9, v41
  v_mfma_f32_16x16x32_bf16 v[52:55], a[84:87], a[40:43], v[52:55]
  s_min_u32 s66, s62, s63
  buffer_load_dwordx4 v3, s[40:43], s61 offen offset:1024 sc1 lds
  v_mfma_f32_16x16x32_bf16 v[52:55], a[92:95], a[44:47], v[52:55]
  s_nop 0
  v_exp_f32 v10, v42
  v_mfma_f32_16x16x32_bf16 v[56:59], a[64:67], a[48:51], v[120:123]
  s_nop 0
  v_exp_f32 v11, v43
  v_mfma_f32_16x16x32_bf16 v[56:59], a[72:75], a[52:55], v[56:59]
  s_add_u32 m0, m0, 0x2000
  s_nop 0
  buffer_load_dwordx4 v3, s[40:43], s66 offen sc1 lds
  v_cvt_pk_bf16_f32 v68, v8, v9
  v_mfma_f32_16x16x32_bf16 v[56:59], a[80:83], a[56:59], v[56:59]
  s_nop 0
  v_cvt_pk_bf16_f32 v69, v10, v11
  v_or3_b32 v5, v5, v68, v69
  v_mfma_f32_16x16x32_bf16 v[56:59], a[88:91], a[60:63], v[56:59]
  s_nop 0
  v_exp_f32 v12, v44
  v_mfma_f32_16x16x32_bf16 v[60:63], a[68:71], a[48:51], v[124:127]
  s_add_u32 s61, s61, 0x2000
  buffer_load_dwordx4 v3, s[40:43], s66 offen offset:1024 sc1 lds
  v_mfma_f32_16x16x32_bf16 v[60:63], a[76:79], a[52:55], v[60:63]
  s_add_u32 s62, s62, 0x2000
  v_exp_f32 v13, v45
  v_mfma_f32_16x16x32_bf16 v[60:63], a[84:87], a[56:59], v[60:63]
  s_add_u32 s64, s64, 0x4000
  v_exp_f32 v14, v46
  v_mfma_f32_16x16x32_bf16 v[60:63], a[92:95], a[60:63], v[60:63]
  s_and_b32 s64, s64, 0x1ffff
  v_exp_f32 v15, v47
  v_mfma_f32_16x16x32_bf16 a[128:131], v[16:19], v[80:83], a[128:131]
  s_add_u32 s58, s58, 1
  v_cvt_pk_bf16_f32 v70, v12, v13
  v_cvt_pk_bf16_f32 v71, v14, v15
  v_mfma_f32_16x16x32_bf16 a[132:135], v[16:19], v[84:87], a[132:135]
  s_nop 0
  ds_read_b128 a[64:67], v4 offset:8192
  v_or3_b32 v5, v5, v70, v71
  v_mfma_f32_16x16x32_bf16 a[136:139], v[16:19], v[88:91], a[136:139]
  s_nop 0
  v_exp_f32 v8, v48
  v_mfma_f32_16x16x32_bf16 a[140:143], v[16:19], v[92:95], a[140:143]
  s_nop 0
  v_exp_f32 v9, v49
  s_waitcnt lgkmcnt(1)
  v_mfma_f32_16x16x32_bf16 v[128:131], a[96:99], v[80:83], v[128:131]
  ds_read_b128 a[68:71], v4 offset:9216
  v_mfma_f32_16x16x32_bf16 v[160:163], a[96:99], v[84:87], v[160:163]
  v_exp_f32 v10, v50
  v_mfma_f32_16x16x32_bf16 v[192:195], a[96:99], v[88:91], v[192:195]
  v_exp_f32 v11, v51
  v_mfma_f32_16x16x32_bf16 v[224:227], a[96:99], v[92:95], v[224:227]
  ds_read_b128 a[72:75], v4 offset:10240
  v_cvt_pk_bf16_f32 v72, v8, v9
  v_mfma_f32_16x16x32_bf16 v[132:135], a[100:103], v[80:83], v[132:135]
  v_cvt_pk_bf16_f32 v73, v10, v11
  v_or3_b32 v5, v5, v72, v73
  v_mfma_f32_16x16x32_bf16 v[164:167], a[100:103], v[84:87], v[164:167]
  v_exp_f32 v12, v52
  v_mfma_f32_16x16x32_bf16 v[196:199], a[100:103], v[88:91], v[196:199]
  ds_read_b128 a[76:79], v4 offset:11264
  v_mfma_f32_16x16x32_bf16 v[228:231], a[100:103], v[92:95], v[228:231]
  v_exp_f32 v13, v53
  v_mfma_f32_16x16x32_bf16 v[136:139], a[104:107], v[80:83], v[136:139]
  v_exp_f32 v14, v54
  v_mfma_f32_16x16x32_bf16 v[168:171], a[104:107], v[84:87], v[168:171]
  ds_read_b128 a[80:83], v4 offset:12288
  v_mfma_f32_16x16x32_bf16 v[200:203], a[104:107], v[88:91], v[200:203]
  v_exp_f32 v15, v55
  v_mfma_f32_16x16x32_bf16 v[232:235], a[104:107], v[92:95], v[232:235]
  v_cvt_pk_bf16_f32 v74, v12, v13
  v_cvt_pk_bf16_f32 v75, v14, v15
  v_mfma_f32_16x16x32_bf16 v[140:143], a[108:111], v[80:83], v[140:143]
  ds_read_b128 a[84:87], v4 offset:13312
  v_or3_b32 v5, v5, v74, v75
  v_mfma_f32_16x16x32_bf16 v[172:175], a[108:111], v[84:87], v[172:175]
  v_exp_f32 v8, v56
  v_mfma_f32_16x16x32_bf16 v[204:207], a[108:111], v[88:91], v[204:207]
  v_exp_f32 v9, v57
  v_mfma_f32_16x16x32_bf16 v[236:239], a[108:111], v[92:95], v[236:239]
  ds_read_b128 a[88:91], v4 offset:14336
  v_mfma_f32_16x16x32_bf16 v[144:147], a[112:115], v[80:83], v[144:147]
  v_exp_f32 v10, v58
  v_mfma_f32_16x16x32_bf16 v[176:179], a[112:115], v[84:87], v[176:179]
  v_exp_f32 v11, v59
  v_mfma_f32_16x16x32_bf16 v[208:211], a[112:115], v[88:91], v[208:211]
  ds_read_b128 a[92:95], v4 offset:15360
  v_cvt_pk_bf16_f32 v76, v8, v9
  v_mfma_f32_16x16x32_bf16 v[240:243], a[112:115], v[92:95], v[240:243]
  v_cvt_pk_bf16_f32 v77, v10, v11
  v_or3_b32 v5, v5, v76, v77
  v_mfma_f32_16x16x32_bf16 v[148:151], a[116:119], v[80:83], v[148:151]
  v_exp_f32 v12, v60
  v_mfma_f32_16x16x32_bf16 v[180:183], a[116:119], v[84:87], v[180:183]
  v_exp_f32 v13, v61
  v_mfma_f32_16x16x32_bf16 v[212:215], a[116:119], v[88:91], v[212:215]
  v_exp_f32 v14, v62
  v_mfma_f32_16x16x32_bf16 v[244:247], a[116:119], v[92:95], v[244:247]
  v_exp_f32 v15, v63
  v_mfma_f32_16x16x32_bf16 v[152:155], a[120:123], v[80:83], v[152:155]
  v_cvt_pk_bf16_f32 v78, v12, v13
  v_cvt_pk_bf16_f32 v79, v14, v15
  v_mfma_f32_16x16x32_bf16 v[184:187], a[120:123], v[84:87], v[184:187]
  v_or3_b32 v5, v5, v78, v79
  v_and_b32 v5, s70, v5
  v_mfma_f32_16x16x32_bf16 v[216:219], a[120:123], v[88:91], v[216:219]
  v_cmp_ne_u32 vcc, 0, v5
  v_add_u32 v4, 0x4000, v4
  v_mfma_f32_16x16x32_bf16 v[248:251], a[120:123], v[92:95], v[248:251]
  v_and_b32 v4, 0x1ffff, v4
  v_mfma_f32_16x16x32_bf16 v[156:159], a[124:127], v[80:83], v[156:159]
  v_mfma_f32_16x16x32_bf16 v[188:191], a[124:127], v[84:87], v[188:191]
  v_mfma_f32_16x16x32_bf16 v[220:223], a[124:127], v[88:91], v[220:223]
  v_mfma_f32_16x16x32_bf16 v[252:255], a[124:127], v[92:95], v[252:255]
  s_cbranch_vccnz L_a_s1_t
L_a_s1_r:
L_a_s0:
  s_waitcnt vmcnt(24) lgkmcnt(0)
  v_mfma_f32_16x16x32_bf16 v[32:35], a[64:67], a[0:3], v[96:99]
  s_barrier
  ds_read_b128 a[96:99], v4 offset:0
  v_mfma_f32_16x16x32_bf16 v[32:35], a[72:75], a[4:7], v[32:35]
  s_nop 0
  ds_read_b128 a[100:103], v4 offset:1024
  v_mfma_f32_16x16x32_bf16 v[32:35], a[80:83], a[8:11], v[32:35]
  s_nop 0
  ds_read_b128 a[104:107], v4 offset:2048
  v_mfma_f32_16x16x32_bf16 v[32:35], a[88:91], a[12:15], v[32:35]
  s_nop 0
  ds_read_b128 a[108:111], v4 offset:3072
  v_mfma_f32_16x16x32_bf16 v[36:39], a[68:71], a[0:3], v[100:103]
  s_nop 0
  ds_read_b128 a[112:115], v4 offset:4096
  v_mfma_f32_16x16x32_bf16 v[36:39], a[76:79], a[4:7], v[36:39]
  s_nop 0
  ds_read_b128 a[116:119], v4 offset:5120
  v_mfma_f32_16x16x32_bf16 v[36:39], a[84:87], a[8:11], v[36:39]
  s_nop 0
  ds_read_b128 a[120:123], v4 offset:6144
  v_mfma_f32_16x16x32_bf16 v[36:39], a[92:95], a[12:15], v[36:39]
  s_nop 0
  ds_read_b128 a[124:127], v4 offset:7168
  v_mfma_f32_16x16x32_bf16 v[40:43], a[64:67], a[16:19], v[104:107]
  s_nop 0
  v_exp_f32 v8, v32
  v_mfma_f32_16x16x32_bf16 v[40:43], a[72:75], a[20:23], v[40:43]
  s_nop 0
  v_exp_f32 v9, v33
  v_mfma_f32_16x16x32_bf16 v[40:43], a[80:83], a[24:27], v[40:43]
  s_nop 0
  v_exp_f32 v10, v34
  v_mfma_f32_16x16x32_bf16 v[40:43], a[88:91], a[28:31], v[40:43]
  s_nop 0
  v_exp_f32 v11, v35
  v_mfma_f32_16x16x32_bf16 v[44:47], a[68:71], a[16:19], v[108:111]
  s_nop 0
  v_cvt_pk_bf16_f32 v80, v8, v9
  v_cvt_pk_bf16_f32 v81, v10, v11
  v_mfma_f32_16x16x32_bf16 v[44:47], a[76:79], a[20:23], v[44:47]
  s_nop 0
  v_or_b32 v5, v80, v81
  v_mfma_f32_16x16x32_bf16 v[44:47], a[84:87], a[24:27], v[44:47]
  s_nop 0
  v_exp_f32 v12, v36
  v_mfma_f32_16x16x32_bf16 v[44:47], a[92:95], a[28:31], v[44:47]
  s_nop 0
  v_exp_f32 v13, v37
  v_mfma_f32_16x16x32_bf16 v[48:51], a[64:67], a[32:35], v[112:115]
  s_nop 0
  v_exp_f32 v14, v38
  v_mfma_f32_16x16x32_bf16 v[48:51], a[72:75], a[36:39], v[48:51]
  s_nop 0
  v_exp_f32 v15, v39
  v_mfma_f32_16x16x32_bf16 v[48:51], a[80:83], a[40:43], v[48:51]
  s_nop 0
  v_cvt_pk_bf16_f32 v82, v12, v13
  v_cvt_pk_bf16_f32 v83, v14, v15
  v_mfma_f32_16x16x32_bf16 v[48:51], a[88:91], a[44:47], v[48:51]
  s_add_u32 m0, s64, s65
  s_nop 0
  buffer_load_dwordx4 v3, s[40:43], s61 offen sc1 lds
  v_or3_b32 v5, v5, v82, v83
  v_mfma_f32_16x16x32_bf16 v[52:55], a[68:71], a[32:35], v[116:119]
  s_nop 0
  v_exp_f32 v8, v40
  v_mfma_f32_16x16x32_bf16 v[52:55], a[76:79], a[36:39], v[52:55]
  s_nop 0
  v_exp_f32 v9, v41
  v_mfma_f32_16x16x32_bf16 v[52:55], a[84:87], a[40:43], v[52:55]
  s_min_u32 s66, s62, s63
  buffer_load_dwordx4 v3, s[40:43], s61 offen offset:1024 sc1 lds
  v_mfma_f32_16x16x32_bf16 v[52:55], a[92:95], a[44:47], v[52:55]
  s_nop 0
  v_exp_f32 v10, v42
  v_mfma_f32_16x16x32_bf16 v[56:59], a[64:67], a[48:51], v[120:123]
  s_nop 0
  v_exp_f32 v11, v43
  v_mfma_f32_16x16x32_bf16 v[56:59], a[72:75], a[52:55], v[56:59]
  s_add_u32 m0, m0, 0x2000
  s_nop 0
  buffer_load_dwordx4 v3, s[40:43], s66 offen sc1 lds
  v_cvt_pk_bf16_f32 v84, v8, v9
  v_mfma_f32_16x16x32_bf16 v[56:59], a[80:83], a[56:59], v[56:59]
  s_nop 0
  v_cvt_pk_bf16_f32 v85, v10, v11
  v_or3_b32 v5, v5, v84, v85
  v_mfma_f32_16x16x32_bf16 v[56:59], a[88:91], a[60:63], v[56:59]
  s_nop 0
  v_exp_f32 v12, v44
  v_mfma_f32_16x16x32_bf16 v[60:63], a[68:71], a[48:51], v[124:127]
  s_add_u32 s61, s61, 0x2000
  buffer_load_dwordx4 v3, s[40:43], s66 offen offset:1024 sc1 lds
  v_mfma_f32_16x16x32_bf16 v[60:63], a[76:79], a[52:55], v[60:63]
  s_add_u32 s62, s62, 0x2000
  v_exp_f32 v13, v45
  v_mfma_f32_16x16x32_bf16 v[60:63], a[84:87], a[56:59], v[60:63]
  s_add_u32 s64, s64, 0x4000
  v_exp_f32 v14, v46
  v_mfma_f32_16x16x32_bf16 v[60:63], a[92:95], a[60:63], v[60:63]
  s_and_b32 s64, s64, 0x1ffff
  v_exp_f32 v15, v47
  v_mfma_f32_16x16x32_bf16 a[128:131], v[16:19], v[64:67], a[128:131]
  s_add_u32 s58, s58, 1
  v_cvt_pk_bf16_f32 v86, v12, v13
  v_cvt_pk_bf16_f32 v87, v14, v15
  v_mfma_f32_16x16x32_bf16 a[132:135], v[16:19], v[68:71], a[132:135]
  s_nop 0
  ds_read_b128 a[64:67], v4 offset:8192
  v_or3_b32 v5, v5, v86, v87
  v_mfma_f32_16x16x32_bf16 a[136:139], v[16:19], v[72:75], a[136:139]
  s_nop 0
  v_exp_f32 v8, v48
  v_mfma_f32_16x16x32_bf16 a[140:143], v[16:19], v[76:79], a[140:143]
  s_nop 0
  v_exp_f32 v9, v49
  s_waitcnt lgkmcnt(1)
  v_mfma_f32_16x16x32_bf16 v[128:131], a[96:99], v[64:67], v[128:131]
  ds_read_b128 a[68:71], v4 offset:9216
  v_mfma_f32_16x16x32_bf16 v[160:163], a[96:99], v[68:71], v[160:163]
  v_exp_f32 v10, v50
  v_mfma_f32_16x16x32_bf16 v[192:195], a[96:99], v[72:75], v[192:195]
  v_exp_f32 v11, v51
  v_mfma_f32_16x16x32_bf16 v[224:227], a[96:99], v[76:79], v[224:227]
  ds_read_b128 a[72:75], v4 offset:10240
  v_cvt_pk_bf16_f32 v88, v8, v9
  v_mfma_f32_16x16x32_bf16 v[132:135], a[100:103], v[64:67], v[132:135]
  v_cvt_pk_bf16_f32 v89, v10, v11
  v_or3_b32 v5, v5, v88, v89
  v_mfma_f32_16x16x32_bf16 v[164:167], a[100:103], v[68:71], v[164:167]
  v_exp_f32 v12, v52
  v_mfma_f32_16x16x32_bf16 v[196:199], a[100:103], v[72:75], v[196:199]
  ds_read_b128 a[76:79], v4 offset:11264
  v_mfma_f32_16x16x32_bf16 v[228:231], a[100:103], v[76:79], v[228:231]
  v_exp_f32 v13, v53
  v_mfma_f32_16x16x32_bf16 v[136:139], a[104:107], v[64:67], v[136:139]
  v_exp_f32 v14, v54
  v_mfma_f32_16x16x32_bf16 v[168:171], a[104:107], v[68:71], v[168:171]
  ds_read_b128 a[80:83], v4 offset:12288
  v_mfma_f32_16x16x32_bf16 v[200:203], a[104:107], v[72:75], v[200:203]
  v_exp_f32 v15, v55
  v_mfma_f32_16x16x32_bf16 v[232:235], a[104:107], v[76:79], v[232:235]
  v_cvt_pk_bf16_f32 v90, v12, v13
  v_cvt_pk_bf16_f32 v91, v14, v15
  v_mfma_f32_16x16x32_bf16 v[140:143], a[108:111], v[64:67], v[140:143]
  ds_read_b128 a[84:87], v4 offset:13312
  v_or3_b32 v5, v5, v90, v91
  v_mfma_f32_16x16x32_bf16 v[172:175], a[108:111], v[68:71], v[172:175]
  v_exp_f32 v8, v56
  v_mfma_f32_16x16x32_bf16 v[204:207], a[108:111], v[72:75], v[204:207]
  v_exp_f32 v9, v57
  v_mfma_f32_16x16x32_bf16 v[236:239], a[108:111], v[76:79], v[236:239]
  ds_read_b128 a[88:91], v4 offset:14336
  v_mfma_f32_16x16x32_bf16 v[144:147], a[112:115], v[64:67], v[144:147]
  v_exp_f32 v10, v58
  v_mfma_f32_16x16x32_bf16 v[176:179], a[112:115], v[68:71], v[176:179]
  v_exp_f32 v11, v59
  v_mfma_f32_16x16x32_bf16 v[208:211], a[112:115], v[72:75], v[208:211]
  ds_read_b128 a[92:95], v4 offset:15360
  v_cvt_pk_bf16_f32 v92, v8, v9
  v_mfma_f32_16x16x32_bf16 v[240:243], a[112:115], v[76:79], v[240:243]
  v_cvt_pk_bf16_f32 v93, v10, v11
  v_or3_b32 v5, v5, v92, v93
  v_mfma_f32_16x16x32_bf16 v[148:151], a[116:119], v[64:67], v[148:151]
  v_exp_f32 v12, v60
  v_mfma_f32_16x16x32_bf16 v[180:183], a[116:119], v[68:71], v[180:183]
  v_exp_f32 v13, v61
  v_mfma_f32_16x16x32_bf16 v[212:215], a[116:119], v[72:75], v[212:215]
  v_exp_f32 v14, v62
  v_mfma_f32_16x16x32_bf16 v[244:247], a[116:119], v[76:79], v[244:247]
  v_exp_f32 v15, v63
  v_mfma_f32_16x16x32_bf16 v[152:155], a[120:123], v[64:67], v[152:155]
  v_cvt_pk_bf16_f32 v94, v12, v13
  v_cvt_pk_bf16_f32 v95, v14, v15
  v_mfma_f32_16x16x32_bf16 v[184:187], a[120:123], v[68:71], v[184:187]
  v_or3_b32 v5, v5, v94, v95
  v_and_b32 v5, s70, v5
  v_mfma_f32_16x16x32_bf16 v[216:219], a[120:123], v[72:75], v[216:219]
  v_cmp_ne_u32 vcc, 0, v5
  v_add_u32 v4, 0x4000, v4
  v_mfma_f32_16x16x32_bf16 v[248:251], a[120:123], v[76:79], v[248:251]
  v_and_b32 v4, 0x1ffff, v4
  v_mfma_f32_16x16x32_bf16 v[156:159], a[124:127], v[64:67], v[156:159]
  v_mfma_f32_16x16x32_bf16 v[188:191], a[124:127], v[68:71], v[188:191]
  v_mfma_f32_16x16x32_bf16 v[220:223], a[124:127], v[72:75], v[220:223]
  v_mfma_f32_16x16x32_bf16 v[252:255], a[124:127], v[76:79], v[252:255]
  s_cbranch_vccnz L_a_s0_t
L_a_s0_r:
  s_cmp_eq_u32 s58, s59
  s_cbranch_scc0 L_a_s1
  v_cmp_gt_i32 s[80:81], 0, v25
  v_cmp_gt_i32 s[82:83], 1, v25
  v_cmp_gt_i32 s[84:85], 2, v25
  v_cmp_gt_i32 s[86:87], 3, v25
  v_cndmask_b32 v96, v96, v24, s[80:81]
  v_cndmask_b32 v97, v97, v24, s[82:83]
  v_cndmask_b32 v98, v98, v24, s[84:85]
  v_cndmask_b32 v99, v99, v24, s[86:87]
  v_cmp_gt_i32 s[80:81], 16, v25
  v_cmp_gt_i32 s[82:83], 17, v25
  v_cmp_gt_i32 s[84:85], 18, v25
  v_cmp_gt_i32 s[86:87], 19, v25
  v_cndmask_b32 v100, v100, v24, s[80:81]
  v_cndmask_b32 v101, v101, v24, s[82:83]
  v_cndmask_b32 v102, v102, v24, s[84:85]
  v_cndmask_b32 v103, v103, v24, s[86:87]
  s_nop 0
L_a_d0:
  s_waitcnt vmcnt(24) lgkmcnt(0)
  v_mfma_f32_16x16x32_bf16 v[32:35], a[64:67], a[0:3], v[96:99]
  s_barrier
  ds_read_b128 a[96:99], v4 offset:0
  v_mfma_f32_16x16x32_bf16 v[32:35], a[72:75], a[4:7], v[32:35]
  s_nop 0
  ds_read_b128 a[100:103], v4 offset:1024
  v_mfma_f32_16x16x32_bf16 v[32:35], a[80:83], a[8:11], v[32:35]
  s_nop 0
  ds_read_b128 a[104:107], v4 offset:2048
  v_mfma_f32_16x16x32_bf16 v[32:35], a[88:91], a[12:15], v[32:35]
  s_nop 0
  ds_read_b128 a[108:111], v4 offset:3072
  v_mfma_f32_16x16x32_bf16 v[36:39], a[68:71], a[0:3], v[100:103]
  s_nop 0
  ds_read_b128 a[112:115], v4 offset:4096
  v_mfma_f32_16x16x32_bf16 v[36:39], a[76:79], a[4:7], v[36:39]
  s_nop 0
  ds_read_b128 a[116:119], v4 offset:5120
  v_mfma_f32_16x16x32_bf16 v[36:39], a[84:87], a[8:11], v[36:39]
  s_nop 0
  ds_read_b128 a[120:123], v4 offset:6144
  v_mfma_f32_16x16x32_bf16 v[36:39], a[92:95], a[12:15], v[36:39]
  s_nop 0
  ds_read_b128 a[124:127], v4 offset:7168
  v_mfma_f32_16x16x32_bf16 v[40:43], a[64:67], a[16:19], v[104:107]
  s_nop 0
  v_exp_f32 v8, v32
  v_mfma_f32_16x16x32_bf16 v[40:43], a[72:75], a[20:23], v[40:43]
  s_nop 0
  v_exp_f32 v9, v33
  v_mfma_f32_16x16x32_bf16 v[40:43], a[80:83], a[24:27], v[40:43]
  s_nop 0
  v_exp_f32 v10, v34
  v_mfma_f32_16x16x32_bf16 v[40:43], a[88:91], a[28:31], v[40:43]
  s_nop 0
  v_exp_f32 v11, v35
  v_mfma_f32_16x16x32_bf16 v[44:47], a[68:71], a[16:19], v[108:111]
  s_nop 0
  v_cvt_pk_bf16_f32 v64, v8, v9
  v_cvt_pk_bf16_f32 v65, v10, v11
  v_mfma_f32_16x16x32_bf16 v[44:47], a[76:79], a[20:23], v[44:47]
  s_nop 0
  v_or_b32 v5, v64, v65
  v_mfma_f32_16x16x32_bf16 v[44:47], a[84:87], a[24:27], v[44:47]
  s_nop 0
  v_exp_f32 v12, v36
  v_mfma_f32_16x16x32_bf16 v[44:47], a[92:95], a[28:31], v[44:47]
  s_nop 0
  v_exp_f32 v13, v37
  v_mfma_f32_16x16x32_bf16 v[48:51], a[64:67], a[32:35], v[112:115]
  s_nop 0
  v_exp_f32 v14, v38
  v_mfma_f32_16x16x32_bf16 v[48:51], a[72:75], a[36:39], v[48:51]
  s_nop 0
  v_exp_f32 v15, v39
  v_mfma_f32_16x16x32_bf16 v[48:51], a[80:83], a[40:43], v[48:51]
  s_nop 0
  v_cvt_pk_bf16_f32 v66, v12, v13
  v_cvt_pk_bf16_f32 v67, v14, v15
  v_mfma_f32_16x16x32_bf16 v[48:51], a[88:91], a[44:47], v[48:51]
  s_add_u32 m0, s64, s65
  s_nop 0
  buffer_load_dwordx4 v3, s[40:43], s61 offen sc1 lds
  v_or3_b32 v5, v5, v66, v67
  v_mfma_f32_16x16x32_bf16 v[52:55], a[68:71], a[32:35], v[116:119]
  s_nop 0
  v_exp_f32 v8, v40
  v_mfma_f32_16x16x32_bf16 v[52:55], a[76:79], a[36:39], v[52:55]
  s_nop 0
  v_exp_f32 v9, v41
  v_mfma_f32_16x16x32_bf16 v[52:55], a[84:87], a[40:43], v[52:55]
  s_min_u32 s66, s62, s63
  buffer_load_dwordx4 v3, s[40:43], s61 offen offset:1024 sc1 lds
  v_mfma_f32_16x16x32_bf16 v[52:55], a[92:95], a[44:47], v[52:55]
  s_nop 0
  v_exp_f32 v10, v42
  v_mfma_f32_16x16x32_bf16 v[56:59], a[64:67], a[48:51], v[120:123]
  s_nop 0
  v_exp_f32 v11, v43
  v_mfma_f32_16x16x32_bf16 v[56:59], a[72:75], a[52:55], v[56:59]
  s_add_u32 m0, m0, 0x2000
  s_nop 0
  buffer_load_dwordx4 v3, s[40:43], s66 offen sc1 lds
  v_cvt_pk_bf16_f32 v68, v8, v9
  v_mfma_f32_16x16x32_bf16 v[56:59], a[80:83], a[56:59], v[56:59]
  s_nop 0
  v_cvt_pk_bf16_f32 v69, v10, v11
  v_or3_b32 v5, v5, v68, v69
  v_mfma_f32_16x16x32_bf16 v[56:59], a[88:91], a[60:63], v[56:59]
  s_nop 0
  v_exp_f32 v12, v44
  v_mfma_f32_16x16x32_bf16 v[60:63], a[68:71], a[48:51], v[124:127]
  s_add_u32 s61, s61, 0x2000
  buffer_load_dwordx4 v3, s[40:43], s66 offen offset:1024 sc1 lds
  v_mfma_f32_16x16x32_bf16 v[60:63], a[76:79], a[52:55], v[60:63]
  s_add_u32 s62, s62, 0x2000
  v_exp_f32 v13, v45
  v_mfma_f32_16x16x32_bf16 v[60:63], a[84:87], a[56:59], v[60:63]
  s_add_u32 s64, s64, 0x4000
  v_exp_f32 v14, v46
  v_mfma_f32_16x16x32_bf16 v[60:63], a[92:95], a[60:63], v[60:63]
  s_and_b32 s64, s64, 0x1ffff
  v_exp_f32 v15, v47
  v_mfma_f32_16x16x32_bf16 a[128:131], v[16:19], v[80:83], a[128:131]
  s_add_u32 s58, s58, 1
  v_cvt_pk_bf16_f32 v70, v12, v13
  v_cvt_pk_bf16_f32 v71, v14, v15
  v_mfma_f32_16x16x32_bf16 a[132:135], v[16:19], v[84:87], a[132:135]
  s_nop 0
  ds_read_b128 a[64:67], v4 offset:8192
  v_or3_b32 v5, v5, v70, v71
  v_mfma_f32_16x16x32_bf16 a[136:139], v[16:19], v[88:91], a[136:139]
  s_nop 0
  v_exp_f32 v8, v48
  v_mfma_f32_16x16x32_bf16 a[140:143], v[16:19], v[92:95], a[140:143]
  s_nop 0
  v_exp_f32 v9, v49
  s_waitcnt lgkmcnt(1)
  v_mfma_f32_16x16x32_bf16 v[128:131], a[96:99], v[80:83], v[128:131]
  ds_read_b128 a[68:71], v4 offset:9216
  v_mfma_f32_16x16x32_bf16 v[160:163], a[96:99], v[84:87], v[160:163]
  v_exp_f32 v10, v50
  v_mfma_f32_16x16x32_bf16 v[192:195], a[96:99], v[88:91], v[192:195]
  v_exp_f32 v11, v51
  v_mfma_f32_16x16x32_bf16 v[224:227], a[96:99], v[92:95], v[224:227]
  ds_read_b128 a[72:75], v4 offset:10240
  v_cvt_pk_bf16_f32 v72, v8, v9
  v_mfma_f32_16x16x32_bf16 v[132:135], a[100:103], v[80:83], v[132:135]
  v_cvt_pk_bf16_f32 v73, v10, v11
  v_or3_b32 v5, v5, v72, v73
  v_mfma_f32_16x16x32_bf16 v[164:167], a[100:103], v[84:87], v[164:167]
  v_exp_f32 v12, v52
  v_mfma_f32_16x16x32_bf16 v[196:199], a[100:103], v[88:91], v[196:199]
  ds_read_b128 a[76:79], v4 offset:11264
  v_mfma_f32_16x16x32_bf16 v[228:231], a[100:103], v[92:95], v[228:231]
  v_exp_f32 v13, v53
  v_mfma_f32_16x16x32_bf16 v[136:139], a[104:107], v[80:83], v[136:139]
  v_exp_f32 v14, v54
  v_mfma_f32_16x16x32_bf16 v[168:171], a[104:107], v[84:87], v[168:171]
  ds_read_b128 a[80:83], v4 offset:12288
  v_mfma_f32_16x16x32_bf16 v[200:203], a[104:107], v[88:91], v[200:203]
  v_exp_f32 v15, v55
  v_mfma_f32_16x16x32_bf16 v[232:235], a[104:107], v[92:95], v[232:235]
  v_cvt_pk_bf16_f32 v74, v12, v13
  v_cvt_pk_bf16_f32 v75, v14, v15
  v_mfma_f32_16x16x32_bf16 v[140:143], a[108:111], v[80:83], v[140:143]
  ds_read_b128 a[84:87], v4 offset:13312
  v_or3_b32 v5, v5, v74, v75
  v_mfma_f32_16x16x32_bf16 v[172:175], a[108:111], v[84:87], v[172:175]
  v_exp_f32 v8, v56
  v_mfma_f32_16x16x32_bf16 v[204:207], a[108:111], v[88:91], v[204:207]
  v_exp_f32 v9, v57
  v_mfma_f32_16x16x32_bf16 v[236:239], a[108:111], v[92:95], v[236:239]
  ds_read_b128 a[88:91], v4 offset:14336
  v_mfma_f32_16x16x32_bf16 v[144:147], a[112:115], v[80:83], v[144:147]
  v_exp_f32 v10, v58
  v_mfma_f32_16x16x32_bf16 v[176:179], a[112:115], v[84:87], v[176:179]
  v_exp_f32 v11, v59
  v_mfma_f32_16x16x32_bf16 v[208:211], a[112:115], v[88:91], v[208:211]
  ds_read_b128 a[92:95], v4 offset:15360
  v_cvt_pk_bf16_f32 v76, v8, v9
  v_mfma_f32_16x16x32_bf16 v[240:243], a[112:115], v[92:95], v[240:243]
  v_cvt_pk_bf16_f32 v77, v10, v11
  v_or3_b32 v5, v5, v76, v77
  v_mfma_f32_16x16x32_bf16 v[148:151], a[116:119], v[80:83], v[148:151]
  v_exp_f32 v12, v60
  v_mfma_f32_16x16x32_bf16 v[180:183], a[116:119], v[84:87], v[180:183]
  v_exp_f32 v13, v61
  v_mfma_f32_16x16x32_bf16 v[212:215], a[116:119], v[88:91], v[212:215]
  v_exp_f32 v14, v62
  v_mfma_f32_16x16x32_bf16 v[244:247], a[116:119], v[92:95], v[244:247]
  v_exp_f32 v15, v63
  v_mfma_f32_16x16x32_bf16 v[152:155], a[120:123], v[80:83], v[152:155]
  v_cvt_pk_bf16_f32 v78, v12, v13
  v_cvt_pk_bf16_f32 v79, v14, v15
  v_mfma_f32_16x16x32_bf16 v[184:187], a[120:123], v[84:87], v[184:187]
  v_or3_b32 v5, v5, v78, v79
  v_and_b32 v5, s70, v5
  v_mfma_f32_16x16x32_bf16 v[216:219], a[120:123], v[88:91], v[216:219]
  v_cmp_ne_u32 vcc, 0, v5
  v_cmp_gt_i32 s[80:81], 32, v25
  v_mfma_f32_16x16x32_bf16 v[248:251], a[120:123], v[92:95], v[248:251]
  v_cmp_gt_i32 s[82:83], 33, v25
  v_cmp_gt_i32 s[84:85], 34, v25
  v_mfma_f32_16x16x32_bf16 v[156:159], a[124:127], v[80:83], v[156:159]
  v_cmp_gt_i32 s[86:87], 35, v25
  v_cndmask_b32 v96, v96, v24, s[80:81]
  v_mfma_f32_16x16x32_bf16 v[188:191], a[124:127], v[84:87], v[188:191]
  v_cndmask_b32 v97, v97, v24, s[82:83]
  v_cndmask_b32 v98, v98, v24, s[84:85]
  v_mfma_f32_16x16x32_bf16 v[220:223], a[124:127], v[88:91], v[220:223]
  v_cndmask_b32 v99, v99, v24, s[86:87]
  v_cmp_gt_i32 s[80:81], 48, v25
  v_mfma_f32_16x16x32_bf16 v[252:255], a[124:127], v[92:95], v[252:255]
  v_cmp_gt_i32 s[82:83], 49, v25
  v_cmp_gt_i32 s[84:85], 50, v25
  v_cmp_gt_i32 s[86:87], 51, v25
  v_cndmask_b32 v100, v100, v24, s[80:81]
  v_cndmask_b32 v101, v101, v24, s[82:83]
  v_cndmask_b32 v102, v102, v24, s[84:85]
  v_cndmask_b32 v103, v103, v24, s[86:87]
  v_add_u32 v4, 0x4000, v4
  v_and_b32 v4, 0x1ffff, v4
  s_cbranch_vccnz L_a_d0_t
L_a_d0_r:
L_a_d1:
  s_waitcnt vmcnt(24) lgkmcnt(0)
  v_mfma_f32_16x16x32_bf16 v[32:35], a[64:67], a[0:3], v[96:99]
  s_barrier
  ds_read_b128 a[96:99], v4 offset:0
  v_mfma_f32_16x16x32_bf16 v[32:35], a[72:75], a[4:7], v[32:35]
  s_nop 0
  ds_read_b128 a[100:103], v4 offset:1024
  v_mfma_f32_16x16x32_bf16 v[32:35], a[80:83], a[8:11], v[32:35]
  s_nop 0
  ds_read_b128 a[104:107], v4 offset:2048
  v_mfma_f32_16x16x32_bf16 v[32:35], a[88:91], a[12:15], v[32:35]
  s_nop 0
  ds_read_b128 a[108:111], v4 offset:3072
  v_mfma_f32_16x16x32_bf16 v[36:39], a[68:71], a[0:3], v[100:103]
  s_nop 0
  ds_read_b128 a[112:115], v4 offset:4096
  v_mfma_f32_16x16x32_bf16 v[36:39], a[76:79], a[4:7], v[36:39]
  s_nop 0
  ds_read_b128 a[116:119], v4 offset:5120
  v_mfma_f32_16x16x32_bf16 v[36:39], a[84:87], a[8:11], v[36:39]
  s_nop 0
  ds_read_b128 a[120:123], v4 offset:6144
  v_mfma_f32_16x16x32_bf16 v[36:39], a[92:95], a[12:15], v[36:39]
  s_nop 0
  ds_read_b128 a[124:127], v4 offset:7168
  v_mfma_f32_16x16x32_bf16 v[40:43], a[64:67], a[16:19], v[104:107]
  s_nop 0
  v_exp_f32 v8, v32
  v_mfma_f32_16x16x32_bf16 v[40:43], a[72:75], a[20:23], v[40:43]
  s_nop 0
  v_exp_f32 v9, v33
  v_mfma_f32_16x16x32_bf16 v[40:43], a[80:83], a[24:27], v[40:43]
  s_nop 0
  v_exp_f32 v10, v34
  v_mfma_f32_16x16x32_bf16 v[40:43], a[88:91], a[28:31], v[40:43]
  s_nop 0
  v_exp_f32 v11, v35
  v_mfma_f32_16x16x32_bf16 v[44:47], a[68:71], a[16:19], v[108:111]
  s_nop 0
  v_cvt_pk_bf16_f32 v80, v8, v9
  v_cvt_pk_bf16_f32 v81, v10, v11
  v_mfma_f32_16x16x32_bf16 v[44:47], a[76:79], a[20:23], v[44:47]
  s_nop 0
  v_or_b32 v5, v80, v81
  v_mfma_f32_16x16x32_bf16 v[44:47], a[84:87], a[24:27], v[44:47]
  s_nop 0
  v_exp_f32 v12, v36
  v_mfma_f32_16x16x32_bf16 v[44:47], a[92:95], a[28:31], v[44:47]
  s_nop 0
  v_exp_f32 v13, v37
  v_mfma_f32_16x16x32_bf16 v[48:51], a[64:67], a[32:35], v[112:115]
  s_nop 0
  v_exp_f32 v14, v38
  v_mfma_f32_16x16x32_bf16 v[48:51], a[72:75], a[36:39], v[48:51]
  s_nop 0
  v_exp_f32 v15, v39
  v_mfma_f32_16x16x32_bf16 v[48:51], a[80:83], a[40:43], v[48:51]
  s_nop 0
  v_cvt_pk_bf16_f32 v82, v12, v13
  v_cvt_pk_bf16_f32 v83, v14, v15
  v_mfma_f32_16x16x32_bf16 v[48:51], a[88:91], a[44:47], v[48:51]
  s_add_u32 m0, s64, s65
  s_nop 0
  buffer_load_dwordx4 v3, s[40:43], s61 offen sc1 lds
  v_or3_b32 v5, v5, v82, v83
  v_mfma_f32_16x16x32_bf16 v[52:55], a[68:71], a[32:35], v[116:119]
  s_nop 0
  v_exp_f32 v8, v40
  v_mfma_f32_16x16x32_bf16 v[52:55], a[76:79], a[36:39], v[52:55]
  s_nop 0
  v_exp_f32 v9, v41
  v_mfma_f32_16x16x32_bf16 v[52:55], a[84:87], a[40:43], v[52:55]
  s_min_u32 s66, s62, s63
  buffer_load_dwordx4 v3, s[40:43], s61 offen offset:1024 sc1 lds
  v_mfma_f32_16x16x32_bf16 v[52:55], a[92:95], a[44:47], v[52:55]
  s_nop 0
  v_exp_f32 v10, v42
  v_mfma_f32_16x16x32_bf16 v[56:59], a[64:67], a[48:51], v[120:123]
  s_nop 0
  v_exp_f32 v11, v43
  v_mfma_f32_16x16x32_bf16 v[56:59], a[72:75], a[52:55], v[56:59]
  s_add_u32 m0, m0, 0x2000
  s_nop 0
  buffer_load_dwordx4 v3, s[40:43], s66 offen sc1 lds
  v_cvt_pk_bf16_f32 v84, v8, v9
  v_mfma_f32_16x16x32_bf16 v[56:59], a[80:83], a[56:59], v[56:59]
  s_nop 0
  v_cvt_pk_bf16_f32 v85, v10, v11
  v_or3_b32 v5, v5, v84, v85
  v_mfma_f32_16x16x32_bf16 v[56:59], a[88:91], a[60:63], v[56:59]
  s_nop 0
  v_exp_f32 v12, v44
  v_mfma_f32_16x16x32_bf16 v[60:63], a[68:71], a[48:51], v[124:127]
  s_add_u32 s61, s61, 0x2000
  buffer_load_dwordx4 v3, s[40:43], s66 offen offset:1024 sc1 lds
  v_mfma_f32_16x16x32_bf16 v[60:63], a[76:79], a[52:55], v[60:63]
  s_add_u32 s62, s62, 0x2000
  v_exp_f32 v13, v45
  v_mfma_f32_16x16x32_bf16 v[60:63], a[84:87], a[56:59], v[60:63]
  s_add_u32 s64, s64, 0x4000
  v_exp_f32 v14, v46
  v_mfma_f32_16x16x32_bf16 v[60:63], a[92:95], a[60:63], v[60:63]
  s_and_b32 s64, s64, 0x1ffff
  v_exp_f32 v15, v47
  v_mfma_f32_16x16x32_bf16 a[128:131], v[16:19], v[64:67], a[128:131]
  s_add_u32 s58, s58, 1
  v_cvt_pk_bf16_f32 v86, v12, v13
  v_cvt_pk_bf16_f32 v87, v14, v15
  v_mfma_f32_16x16x32_bf16 a[132:135], v[16:19], v[68:71], a[132:135]
  s_nop 0
  ds_read_b128 a[64:67], v4 offset:8192
  v_or3_b32 v5, v5, v86, v87
  v_mfma_f32_16x16x32_bf16 a[136:139], v[16:19], v[72:75], a[136:139]
  s_nop 0
  v_exp_f32 v8, v48
  v_mfma_f32_16x16x32_bf16 a[140:143], v[16:19], v[76:79], a[140:143]
  s_nop 0
  v_exp_f32 v9, v49
  s_waitcnt lgkmcnt(1)
  v_mfma_f32_16x16x32_bf16 v[128:131], a[96:99], v[64:67], v[128:131]
  ds_read_b128 a[68:71], v4 offset:9216
  v_mfma_f32_16x16x32_bf16 v[160:163], a[96:99], v[68:71], v[160:163]
  v_exp_f32 v10, v50
  v_mfma_f32_16x16x32_bf16 v[192:195], a[96:99], v[72:75], v[192:195]
  v_exp_f32 v11, v51
  v_mfma_f32_16x16x32_bf16 v[224:227], a[96:99], v[76:79], v[224:227]
  ds_read_b128 a[72:75], v4 offset:10240
  v_cvt_pk_bf16_f32 v88, v8, v9
  v_mfma_f32_16x16x32_bf16 v[132:135], a[100:103], v[64:67], v[132:135]
  v_cvt_pk_bf16_f32 v89, v10, v11
  v_or3_b32 v5, v5, v88, v89
  v_mfma_f32_16x16x32_bf16 v[164:167], a[100:103], v[68:71], v[164:167]
  v_exp_f32 v12, v52
  v_mfma_f32_16x16x32_bf16 v[196:199], a[100:103], v[72:75], v[196:199]
  ds_read_b128 a[76:79], v4 offset:11264
  v_mfma_f32_16x16x32_bf16 v[228:231], a[100:103], v[76:79], v[228:231]
  v_exp_f32 v13, v53
  v_mfma_f32_16x16x32_bf16 v[136:139], a[104:107], v[64:67], v[136:139]
  v_exp_f32 v14, v54
  v_mfma_f32_16x16x32_bf16 v[168:171], a[104:107], v[68:71], v[168:171]
  ds_read_b128 a[80:83], v4 offset:12288
  v_mfma_f32_16x16x32_bf16 v[200:203], a[104:107], v[72:75], v[200:203]
  v_exp_f32 v15, v55
  v_mfma_f32_16x16x32_bf16 v[232:235], a[104:107], v[76:79], v[232:235]
  v_cvt_pk_bf16_f32 v90, v12, v13
  v_cvt_pk_bf16_f32 v91, v14, v15
  v_mfma_f32_16x16x32_bf16 v[140:143], a[108:111], v[64:67], v[140:143]
  ds_read_b128 a[84:87], v4 offset:13312
  v_or3_b32 v5, v5, v90, v91
  v_mfma_f32_16x16x32_bf16 v[172:175], a[108:111], v[68:71], v[172:175]
  v_exp_f32 v8, v56
  v_mfma_f32_16x16x32_bf16 v[204:207], a[108:111], v[72:75], v[204:207]
  v_exp_f32 v9, v57
  v_mfma_f32_16x16x32_bf16 v[236:239], a[108:111], v[76:79], v[236:239]
  ds_read_b128 a[88:91], v4 offset:14336
  v_mfma_f32_16x16x32_bf16 v[144:147], a[112:115], v[64:67], v[144:147]
  v_exp_f32 v10, v58
  v_mfma_f32_16x16x32_bf16 v[176:179], a[112:115], v[68:71], v[176:179]
  v_exp_f32 v11, v59
  v_mfma_f32_16x16x32_bf16 v[208:211], a[112:115], v[72:75], v[208:211]
  ds_read_b128 a[92:95], v4 offset:15360
  v_cvt_pk_bf16_f32 v92, v8, v9
  v_mfma_f32_16x16x32_bf16 v[240:243], a[112:115], v[76:79], v[240:243]
  v_cvt_pk_bf16_f32 v93, v10, v11
  v_or3_b32 v5, v5, v92, v93
  v_mfma_f32_16x16x32_bf16 v[148:151], a[116:119], v[64:67], v[148:151]
  v_exp_f32 v12, v60
  v_mfma_f32_16x16x32_bf16 v[180:183], a[116:119], v[68:71], v[180:183]
  v_exp_f32 v13, v61
  v_mfma_f32_16x16x32_bf16 v[212:215], a[116:119], v[72:75], v[212:215]
  v_exp_f32 v14, v62
  v_mfma_f32_16x16x32_bf16 v[244:247], a[116:119], v[76:79], v[244:247]
  v_exp_f32 v15, v63
  v_mfma_f32_16x16x32_bf16 v[152:155], a[120:123], v[64:67], v[152:155]
  v_cvt_pk_bf16_f32 v94, v12, v13
  v_cvt_pk_bf16_f32 v95, v14, v15
  v_mfma_f32_16x16x32_bf16 v[184:187], a[120:123], v[68:71], v[184:187]
  v_or3_b32 v5, v5, v94, v95
  v_and_b32 v5, s70, v5
  v_mfma_f32_16x16x32_bf16 v[216:219], a[120:123], v[72:75], v[216:219]
  v_cmp_ne_u32 vcc, 0, v5
  v_cmp_gt_i32 s[80:81], 0, v25
  v_mfma_f32_16x16x32_bf16 v[248:251], a[120:123], v[76:79], v[248:251]
  v_cmp_gt_i32 s[82:83], 1, v25
  v_cmp_gt_i32 s[84:85], 2, v25
  v_mfma_f32_16x16x32_bf16 v[156:159], a[124:127], v[64:67], v[156:159]
  v_cmp_gt_i32 s[86:87], 3, v25
  v_cndmask_b32 v104, v104, v24, s[80:81]
  v_mfma_f32_16x16x32_bf16 v[188:191], a[124:127], v[68:71], v[188:191]
  v_cndmask_b32 v105, v105, v24, s[82:83]
  v_cndmask_b32 v106, v106, v24, s[84:85]
  v_mfma_f32_16x16x32_bf16 v[220:223], a[124:127], v[72:75], v[220:223]
  v_cndmask_b32 v107, v107, v24, s[86:87]
  v_cmp_gt_i32 s[80:81], 16, v25
  v_mfma_f32_16x16x32_bf16 v[252:255], a[124:127], v[76:79], v[252:255]
  v_cmp_gt_i32 s[82:83], 17, v25
  v_cmp_gt_i32 s[84:85], 18, v25
  v_cmp_gt_i32 s[86:87], 19, v25
  v_cndmask_b32 v108, v108, v24, s[80:81]
  v_cndmask_b32 v109, v109, v24, s[82:83]
  v_cndmask_b32 v110, v110, v24, s[84:85]
  v_cndmask_b32 v111, v111, v24, s[86:87]
  v_add_u32 v4, 0x4000, v4
  v_and_b32 v4, 0x1ffff, v4
  s_cbranch_vccnz L_a_d1_t
L_a_d1_r:
L_a_d2:
  s_waitcnt vmcnt(24) lgkmcnt(0)
  v_mfma_f32_16x16x32_bf16 v[40:43], a[64:67], a[16:19], v[104:107]
  s_barrier
  ds_read_b128 a[96:99], v4 offset:0
  v_mfma_f32_16x16x32_bf16 v[40:43], a[72:75], a[20:23], v[40:43]
  s_nop 0
  ds_read_b128 a[100:103], v4 offset:1024
  v_mfma_f32_16x16x32_bf16 v[40:43], a[80:83], a[24:27], v[40:43]
  s_nop 0
  ds_read_b128 a[104:107], v4 offset:2048
  v_mfma_f32_16x16x32_bf16 v[40:43], a[88:91], a[28:31], v[40:43]
  s_nop 0
  ds_read_b128 a[108:111], v4 offset:3072
  v_mfma_f32_16x16x32_bf16 v[44:47], a[68:71], a[16:19], v[108:111]
  s_nop 0
  ds_read_b128 a[112:115], v4 offset:4096
  v_mfma_f32_16x16x32_bf16 v[44:47], a[76:79], a[20:23], v[44:47]
  s_nop 0
  ds_read_b128 a[116:119], v4 offset:5120
  v_mfma_f32_16x16x32_bf16 v[44:47], a[84:87], a[24:27], v[44:47]
  s_nop 0
  ds_read_b128 a[120:123], v4 offset:6144
  v_mfma_f32_16x16x32_bf16 v[44:47], a[92:95], a[28:31], v[44:47]
  s_nop 0
  ds_read_b128 a[124:127], v4 offset:7168
  v_mfma_f32_16x16x32_bf16 v[48:51], a[64:67], a[32:35], v[112:115]
  s_add_u32 m0, s73, 0
  s_xor_b32 s66, s72, 0x0
  buffer_load_dwordx4 v26, s[48:51], s66 offen lds
  v_mfma_f32_16x16x32_bf16 v[48:51], a[72:75], a[36:39], v[48:51]
  s_add_u32 m0, s73, 1024
  s_xor_b32 s66, s72, 0x2000
  buffer_load_dwordx4 v26, s[48:51], s66 offen lds
  v_mfma_f32_16x16x32_bf16 v[48:51], a[80:83], a[40:43], v[48:51]
  s_add_u32 m0, s73, 2048
  s_xor_b32 s66, s72, 0x4000
  buffer_load_dwordx4 v26, s[48:51], s66 offen lds
  v_mfma_f32_16x16x32_bf16 v[48:51], a[88:91], a[44:47], v[48:51]
  s_add_u32 m0, s73, 3072
  s_xor_b32 s66, s72, 0x6000
  buffer_load_dwordx4 v26, s[48:51], s66 offen lds
  v_mfma_f32_16x16x32_bf16 v[52:55], a[68:71], a[32:35], v[116:119]
  s_add_u32 s58, s58, 1
  v_exp_f32 v8, v40
  v_mfma_f32_16x16x32_bf16 v[52:55], a[76:79], a[36:39], v[52:55]
  s_nop 0
  v_exp_f32 v9, v41
  v_mfma_f32_16x16x32_bf16 v[52:55], a[84:87], a[40:43], v[52:55]
  s_nop 0
  v_exp_f32 v10, v42
  v_mfma_f32_16x16x32_bf16 v[52:55], a[92:95], a[44:47], v[52:55]
  s_nop 0
  v_exp_f32 v11, v43
  v_mfma_f32_16x16x32_bf16 v[56:59], a[64:67], a[48:51], v[120:123]
  s_nop 0
  v_cvt_pk_bf16_f32 v68, v8, v9
  v_cvt_pk_bf16_f32 v69, v10, v11
  v_mfma_f32_16x16x32_bf16 v[56:59], a[72:75], a[52:55], v[56:59]
  s_nop 0
  v_or_b32 v5, v68, v69
  v_mfma_f32_16x16x32_bf16 v[56:59], a[80:83], a[56:59], v[56:59]
  s_nop 0
  v_exp_f32 v12, v44
  v_mfma_f32_16x16x32_bf16 v[56:59], a[88:91], a[60:63], v[56:59]
  s_nop 0
  v_exp_f32 v13, v45
  v_mfma_f32_16x16x32_bf16 v[60:63], a[68:71], a[48:51], v[124:127]
  s_nop 0
  v_exp_f32 v14, v46
  v_mfma_f32_16x16x32_bf16 v[60:63], a[76:79], a[52:55], v[60:63]
  s_nop 0
  v_exp_f32 v15, v47
  v_mfma_f32_16x16x32_bf16 v[60:63], a[84:87], a[56:59], v[60:63]
  s_nop 0
  v_cvt_pk_bf16_f32 v70, v12, v13
  v_cvt_pk_bf16_f32 v71, v14, v15
  v_mfma_f32_16x16x32_bf16 v[60:63], a[92:95], a[60:63], v[60:63]
  s_nop 0
  v_or3_b32 v5, v5, v70, v71
  v_mfma_f32_16x16x32_bf16 a[128:131], v[16:19], v[80:83], a[128:131]
  s_nop 0
  v_exp_f32 v8, v48
  v_mfma_f32_16x16x32_bf16 a[132:135], v[16:19], v[84:87], a[132:135]
  s_nop 0
  ds_read_b128 a[64:67], v4 offset:8192
  v_mfma_f32_16x16x32_bf16 a[136:139], v[16:19], v[88:91], a[136:139]
  s_nop 0
  v_exp_f32 v9, v49
  v_mfma_f32_16x16x32_bf16 a[140:143], v[16:19], v[92:95], a[140:143]
  s_nop 0
  v_exp_f32 v10, v50
  s_waitcnt lgkmcnt(1)
  v_mfma_f32_16x16x32_bf16 v[128:131], a[96:99], v[80:83], v[128:131]
  ds_read_b128 a[68:71], v4 offset:9216
  v_mfma_f32_16x16x32_bf16 v[160:163], a[96:99], v[84:87], v[160:163]
  v_exp_f32 v11, v51
  v_mfma_f32_16x16x32_bf16 v[192:195], a[96:99], v[88:91], v[192:195]
  v_cvt_pk_bf16_f32 v72, v8, v9
  v_cvt_pk_bf16_f32 v73, v10, v11
  v_mfma_f32_16x16x32_bf16 v[224:227], a[96:99], v[92:95], v[224:227]
  ds_read_b128 a[72:75], v4 offset:10240
  v_or3_b32 v5, v5, v72, v73
  v_mfma_f32_16x16x32_bf16 v[132:135], a[100:103], v[80:83], v[132:135]
  v_exp_f32 v12, v52
  v_mfma_f32_16x16x32_bf16 v[164:167], a[100:103], v[84:87], v[164:167]
  v_exp_f32 v13, v53
  v_mfma_f32_16x16x32_bf16 v[196:199], a[100:103], v[88:91], v[196:199]
  ds_read_b128 a[76:79], v4 offset:11264
  v_mfma_f32_16x16x32_bf16 v[228:231], a[100:103], v[92:95], v[228:231]
  v_exp_f32 v14, v54
  v_mfma_f32_16x16x32_bf16 v[136:139], a[104:107], v[80:83], v[136:139]
  v_exp_f32 v15, v55
  v_mfma_f32_16x16x32_bf16 v[168:171], a[104:107], v[84:87], v[168:171]
  ds_read_b128 a[80:83], v4 offset:12288
  v_cvt_pk_bf16_f32 v74, v12, v13
  v_mfma_f32_16x16x32_bf16 v[200:203], a[104:107], v[88:91], v[200:203]
  v_cvt_pk_bf16_f32 v75, v14, v15
  v_or3_b32 v5, v5, v74, v75
  v_mfma_f32_16x16x32_bf16 v[232:235], a[104:107], v[92:95], v[232:235]
  v_exp_f32 v8, v56
  v_mfma_f32_16x16x32_bf16 v[140:143], a[108:111], v[80:83], v[140:143]
  ds_read_b128 a[84:87], v4 offset:13312
  v_mfma_f32_16x16x32_bf16 v[172:175], a[108:111], v[84:87], v[172:175]
  v_exp_f32 v9, v57
  v_mfma_f32_16x16x32_bf16 v[204:207], a[108:111], v[88:91], v[204:207]
  v_exp_f32 v10, v58
  v_mfma_f32_16x16x32_bf16 v[236:239], a[108:111], v[92:95], v[236:239]
  ds_read_b128 a[88:91], v4 offset:14336
  v_mfma_f32_16x16x32_bf16 v[144:147], a[112:115], v[80:83], v[144:147]
  v_exp_f32 v11, v59
  v_mfma_f32_16x16x32_bf16 v[176:179], a[112:115], v[84:87], v[176:179]
  v_cvt_pk_bf16_f32 v76, v8, v9
  v_cvt_pk_bf16_f32 v77, v10, v11
  v_mfma_f32_16x16x32_bf16 v[208:211], a[112:115], v[88:91], v[208:211]
  ds_read_b128 a[92:95], v4 offset:15360
  v_or3_b32 v5, v5, v76, v77
  v_mfma_f32_16x16x32_bf16 v[240:243], a[112:115], v[92:95], v[240:243]
  v_exp_f32 v12, v60
  v_mfma_f32_16x16x32_bf16 v[148:151], a[116:119], v[80:83], v[148:151]
  v_exp_f32 v13, v61
  v_mfma_f32_16x16x32_bf16 v[180:183], a[116:119], v[84:87], v[180:183]
  v_exp_f32 v14, v62
  v_mfma_f32_16x16x32_bf16 v[212:215], a[116:119], v[88:91], v[212:215]
  v_exp_f32 v15, v63
  v_mfma_f32_16x16x32_bf16 v[244:247], a[116:119], v[92:95], v[244:247]
  v_cvt_pk_bf16_f32 v78, v12, v13
  v_cvt_pk_bf16_f32 v79, v14, v15
  v_mfma_f32_16x16x32_bf16 v[152:155], a[120:123], v[80:83], v[152:155]
  v_or3_b32 v5, v5, v78, v79
  v_and_b32 v5, s70, v5
  v_mfma_f32_16x16x32_bf16 v[184:187], a[120:123], v[84:87], v[184:187]
  v_cmp_ne_u32 vcc, 0, v5
  v_cmp_gt_i32 s[80:81], 32, v25
  v_mfma_f32_16x16x32_bf16 v[216:219], a[120:123], v[88:91], v[216:219]
  v_cmp_gt_i32 s[82:83], 33, v25
  v_cmp_gt_i32 s[84:85], 34, v25
  v_mfma_f32_16x16x32_bf16 v[248:251], a[120:123], v[92:95], v[248:251]
  v_cmp_gt_i32 s[86:87], 35, v25
  v_cndmask_b32 v104, v104, v24, s[80:81]
  v_mfma_f32_16x16x32_bf16 v[156:159], a[124:127], v[80:83], v[156:159]
  v_cndmask_b32 v105, v105, v24, s[82:83]
  v_cndmask_b32 v106, v106, v24, s[84:85]
  v_mfma_f32_16x16x32_bf16 v[188:191], a[124:127], v[84:87], v[188:191]
  v_cndmask_b32 v107, v107, v24, s[86:87]
  v_cmp_gt_i32 s[80:81], 48, v25
  v_mfma_f32_16x16x32_bf16 v[220:223], a[124:127], v[88:91], v[220:223]
  v_cmp_gt_i32 s[82:83], 49, v25
  v_cmp_gt_i32 s[84:85], 50, v25
  v_mfma_f32_16x16x32_bf16 v[252:255], a[124:127], v[92:95], v[252:255]
  v_cmp_gt_i32 s[86:87], 51, v25
  v_cndmask_b32 v108, v108, v24, s[80:81]
  v_cndmask_b32 v109, v109, v24, s[82:83]
  v_cndmask_b32 v110, v110, v24, s[84:85]
  v_cndmask_b32 v111, v111, v24, s[86:87]
  v_add_u32 v4, 0x4000, v4
  v_and_b32 v4, 0x1ffff, v4
  s_cbranch_vccnz L_a_d2_t
L_a_d2_r:
L_a_d3:
  s_waitcnt vmcnt(24) lgkmcnt(0)
  v_mfma_f32_16x16x32_bf16 v[40:43], a[64:67], a[16:19], v[104:107]
  s_barrier
  ds_read_b128 a[96:99], v4 offset:0
  v_mfma_f32_16x16x32_bf16 v[40:43], a[72:75], a[20:23], v[40:43]
  s_nop 0
  ds_read_b128 a[100:103], v4 offset:1024
  v_mfma_f32_16x16x32_bf16 v[40:43], a[80:83], a[24:27], v[40:43]
  s_nop 0
  ds_read_b128 a[104:107], v4 offset:2048
  v_mfma_f32_16x16x32_bf16 v[40:43], a[88:91], a[28:31], v[40:43]
  s_nop 0
  ds_read_b128 a[108:111], v4 offset:3072
  v_mfma_f32_16x16x32_bf16 v[44:47], a[68:71], a[16:19], v[108:111]
  s_nop 0
  ds_read_b128 a[112:115], v4 offset:4096
  v_mfma_f32_16x16x32_bf16 v[44:47], a[76:79], a[20:23], v[44:47]
  s_nop 0
  ds_read_b128 a[116:119], v4 offset:5120
  v_mfma_f32_16x16x32_bf16 v[44:47], a[84:87], a[24:27], v[44:47]
  s_nop 0
  ds_read_b128 a[120:123], v4 offset:6144
  v_mfma_f32_16x16x32_bf16 v[44:47], a[92:95], a[28:31], v[44:47]
  s_nop 0
  ds_read_b128 a[124:127], v4 offset:7168
  v_mfma_f32_16x16x32_bf16 v[48:51], a[64:67], a[32:35], v[112:115]
  s_add_u32 m0, s73, 16384
  s_xor_b32 s66, s72, 0x80
  buffer_load_dwordx4 v26, s[48:51], s66 offen lds
  v_mfma_f32_16x16x32_bf16 v[48:51], a[72:75], a[36:39], v[48:51]
  s_add_u32 m0, s73, 17408
  s_xor_b32 s66, s72, 0x2080
  buffer_load_dwordx4 v26, s[48:51], s66 offen lds
  v_mfma_f32_16x16x32_bf16 v[48:51], a[80:83], a[40:43], v[48:51]
  s_add_u32 m0, s73, 18432
  s_xor_b32 s66, s72, 0x4080
  buffer_load_dwordx4 v26, s[48:51], s66 offen lds
  v_mfma_f32_16x16x32_bf16 v[48:51], a[88:91], a[44:47], v[48:51]
  s_add_u32 m0, s73, 19456
  s_xor_b32 s66, s72, 0x6080
  buffer_load_dwordx4 v26, s[48:51], s66 offen lds
  v_mfma_f32_16x16x32_bf16 v[52:55], a[68:71], a[32:35], v[116:119]
  s_add_u32 s58, s58, 1
  v_exp_f32 v8, v40
  v_mfma_f32_16x16x32_bf16 v[52:55], a[76:79], a[36:39], v[52:55]
  s_nop 0
  v_exp_f32 v9, v41
  v_mfma_f32_16x16x32_bf16 v[52:55], a[84:87], a[40:43], v[52:55]
  s_nop 0
  v_exp_f32 v10, v42
  v_mfma_f32_16x16x32_bf16 v[52:55], a[92:95], a[44:47], v[52:55]
  s_nop 0
  v_exp_f32 v11, v43
  v_mfma_f32_16x16x32_bf16 v[56:59], a[64:67], a[48:51], v[120:123]
  s_nop 0
  v_cvt_pk_bf16_f32 v84, v8, v9
  v_cvt_pk_bf16_f32 v85, v10, v11
  v_mfma_f32_16x16x32_bf16 v[56:59], a[72:75], a[52:55], v[56:59]
  s_nop 0
  v_or_b32 v5, v84, v85
  v_mfma_f32_16x16x32_bf16 v[56:59], a[80:83], a[56:59], v[56:59]
  s_nop 0
  v_exp_f32 v12, v44
  v_mfma_f32_16x16x32_bf16 v[56:59], a[88:91], a[60:63], v[56:59]
  s_nop 0
  v_exp_f32 v13, v45
  v_mfma_f32_16x16x32_bf16 v[60:63], a[68:71], a[48:51], v[124:127]
  s_nop 0
  v_exp_f32 v14, v46
  v_mfma_f32_16x16x32_bf16 v[60:63], a[76:79], a[52:55], v[60:63]
  s_nop 0
  v_exp_f32 v15, v47
  v_mfma_f32_16x16x32_bf16 v[60:63], a[84:87], a[56:59], v[60:63]
  s_nop 0
  v_cvt_pk_bf16_f32 v86, v12, v13
  v_cvt_pk_bf16_f32 v87, v14, v15
  v_mfma_f32_16x16x32_bf16 v[60:63], a[92:95], a[60:63], v[60:63]
  s_nop 0
  v_or3_b32 v5, v5, v86, v87
  v_mfma_f32_16x16x32_bf16 a[132:135], v[16:19], v[68:71], a[132:135]
  s_nop 0
  ds_read_b128 a[64:67], v4 offset:8192
  v_mfma_f32_16x16x32_bf16 a[136:139], v[16:19], v[72:75], a[136:139]
  s_nop 0
  ds_read_b128 a[68:71], v4 offset:9216
  v_mfma_f32_16x16x32_bf16 a[140:143], v[16:19], v[76:79], a[140:143]
  s_nop 0
  ds_read_b128 a[72:75], v4 offset:10240
  s_waitcnt lgkmcnt(3)
  v_mfma_f32_16x16x32_bf16 v[160:163], a[96:99], v[68:71], v[160:163]
  s_nop 0
  ds_read_b128 a[76:79], v4 offset:11264
  v_mfma_f32_16x16x32_bf16 v[192:195], a[96:99], v[72:75], v[192:195]
  ds_read_b128 a[80:83], v4 offset:12288
  v_mfma_f32_16x16x32_bf16 v[224:227], a[96:99], v[76:79], v[224:227]
  ds_read_b128 a[84:87], v4 offset:13312
  v_mfma_f32_16x16x32_bf16 v[164:167], a[100:103], v[68:71], v[164:167]
  ds_read_b128 a[88:91], v4 offset:14336
  v_mfma_f32_16x16x32_bf16 v[196:199], a[100:103], v[72:75], v[196:199]
  ds_read_b128 a[92:95], v4 offset:15360
  v_mfma_f32_16x16x32_bf16 v[228:231], a[100:103], v[76:79], v[228:231]
  v_exp_f32 v8, v48
  v_mfma_f32_16x16x32_bf16 v[168:171], a[104:107], v[68:71], v[168:171]
  v_exp_f32 v9, v49
  v_mfma_f32_16x16x32_bf16 v[200:203], a[104:107], v[72:75], v[200:203]
  v_exp_f32 v10, v50
  v_mfma_f32_16x16x32_bf16 v[232:235], a[104:107], v[76:79], v[232:235]
  v_exp_f32 v11, v51
  v_mfma_f32_16x16x32_bf16 v[172:175], a[108:111], v[68:71], v[172:175]
  v_cvt_pk_bf16_f32 v88, v8, v9
  v_cvt_pk_bf16_f32 v89, v10, v11
  v_mfma_f32_16x16x32_bf16 v[204:207], a[108:111], v[72:75], v[204:207]
  v_or3_b32 v5, v5, v88, v89
  v_mfma_f32_16x16x32_bf16 v[236:239], a[108:111], v[76:79], v[236:239]
  v_exp_f32 v12, v52
  v_mfma_f32_16x16x32_bf16 v[176:179], a[112:115], v[68:71], v[176:179]
  v_exp_f32 v13, v53
  v_mfma_f32_16x16x32_bf16 v[208:211], a[112:115], v[72:75], v[208:211]
  v_exp_f32 v14, v54
  v_mfma_f32_16x16x32_bf16 v[240:243], a[112:115], v[76:79], v[240:243]
  v_exp_f32 v15, v55
  v_mfma_f32_16x16x32_bf16 v[180:183], a[116:119], v[68:71], v[180:183]
  v_cvt_pk_bf16_f32 v90, v12, v13
  v_cvt_pk_bf16_f32 v91, v14, v15
  v_mfma_f32_16x16x32_bf16 v[212:215], a[116:119], v[72:75], v[212:215]
  v_or3_b32 v5, v5, v90, v91
  v_mfma_f32_16x16x32_bf16 v[244:247], a[116:119], v[76:79], v[244:247]
  v_exp_f32 v8, v56
  v_mfma_f32_16x16x32_bf16 v[184:187], a[120:123], v[68:71], v[184:187]
  v_exp_f32 v9, v57
  v_mfma_f32_16x16x32_bf16 v[216:219], a[120:123], v[72:75], v[216:219]
  v_exp_f32 v10, v58
  v_mfma_f32_16x16x32_bf16 v[248:251], a[120:123], v[76:79], v[248:251]
  v_exp_f32 v11, v59
  v_mfma_f32_16x16x32_bf16 v[188:191], a[124:127], v[68:71], v[188:191]
  v_cvt_pk_bf16_f32 v92, v8, v9
  v_cvt_pk_bf16_f32 v93, v10, v11
  v_mfma_f32_16x16x32_bf16 v[220:223], a[124:127], v[72:75], v[220:223]
  v_or3_b32 v5, v5, v92, v93
  v_mfma_f32_16x16x32_bf16 v[252:255], a[124:127], v[76:79], v[252:255]
  v_exp_f32 v12, v60
  v_exp_f32 v13, v61
  v_exp_f32 v14, v62
  v_exp_f32 v15, v63
  s_nop 0
  v_cvt_pk_bf16_f32 v94, v12, v13
  v_cvt_pk_bf16_f32 v95, v14, v15
  v_or3_b32 v5, v5, v94, v95
  v_and_b32 v5, s70, v5
  v_cmp_ne_u32 vcc, 0, v5
  v_cmp_gt_i32 s[80:81], 0, v25
  v_cmp_gt_i32 s[82:83], 1, v25
  v_cmp_gt_i32 s[84:85], 2, v25
  v_cmp_gt_i32 s[86:87], 3, v25
  v_cndmask_b32 v112, v112, v24, s[80:81]
  v_cndmask_b32 v113, v113, v24, s[82:83]
  v_cndmask_b32 v114, v114, v24, s[84:85]
  v_cndmask_b32 v115, v115, v24, s[86:87]
  v_cmp_gt_i32 s[80:81], 16, v25
  v_cmp_gt_i32 s[82:83], 17, v25
  v_cmp_gt_i32 s[84:85], 18, v25
  v_cmp_gt_i32 s[86:87], 19, v25
  v_cndmask_b32 v116, v116, v24, s[80:81]
  v_cndmask_b32 v117, v117, v24, s[82:83]
  v_cndmask_b32 v118, v118, v24, s[84:85]
  v_cndmask_b32 v119, v119, v24, s[86:87]
  v_add_u32 v4, 0x4000, v4
  v_and_b32 v4, 0x1ffff, v4
  s_cbranch_vccnz L_a_d3_t
L_a_d3_r:
L_a_d4:
  s_waitcnt vmcnt(24) lgkmcnt(0)
  v_mfma_f32_16x16x32_bf16 v[48:51], a[64:67], a[32:35], v[112:115]
  s_barrier
  ds_read_b128 a[96:99], v4 offset:0
  v_mfma_f32_16x16x32_bf16 v[48:51], a[72:75], a[36:39], v[48:51]
  s_nop 0
  ds_read_b128 a[100:103], v4 offset:1024
  v_mfma_f32_16x16x32_bf16 v[48:51], a[80:83], a[40:43], v[48:51]
  s_nop 0
  ds_read_b128 a[104:107], v4 offset:2048
  v_mfma_f32_16x16x32_bf16 v[48:51], a[88:91], a[44:47], v[48:51]
  s_nop 0
  ds_read_b128 a[108:111], v4 offset:3072
  v_mfma_f32_16x16x32_bf16 v[52:55], a[68:71], a[32:35], v[116:119]
  s_nop 0
  ds_read_b128 a[112:115], v4 offset:4096
  v_mfma_f32_16x16x32_bf16 v[52:55], a[76:79], a[36:39], v[52:55]
  s_nop 0
  ds_read_b128 a[116:119], v4 offset:5120
  v_mfma_f32_16x16x32_bf16 v[52:55], a[84:87], a[40:43], v[52:55]
  s_nop 0
  ds_read_b128 a[120:123], v4 offset:6144
  v_mfma_f32_16x16x32_bf16 v[52:55], a[92:95], a[44:47], v[52:55]
  s_nop 0
  ds_read_b128 a[124:127], v4 offset:7168
  v_mfma_f32_16x16x32_bf16 v[56:59], a[64:67], a[48:51], v[120:123]
  s_add_u32 m0, s73, 32768
  s_xor_b32 s66, s72, 0x20000
  buffer_load_dwordx4 v26, s[48:51], s66 offen lds
  v_mfma_f32_16x16x32_bf16 v[56:59], a[72:75], a[52:55], v[56:59]
  s_add_u32 m0, s73, 33792
  s_xor_b32 s66, s72, 0x22000
  buffer_load_dwordx4 v26, s[48:51], s66 offen lds
  v_mfma_f32_16x16x32_bf16 v[56:59], a[80:83], a[56:59], v[56:59]
  s_add_u32 m0, s73, 34816
  s_xor_b32 s66, s72, 0x24000
  buffer_load_dwordx4 v26, s[48:51], s66 offen lds
  v_mfma_f32_16x16x32_bf16 v[56:59], a[88:91], a[60:63], v[56:59]
  s_add_u32 m0, s73, 35840
  s_xor_b32 s66, s72, 0x26000
  buffer_load_dwordx4 v26, s[48:51], s66 offen lds
  v_mfma_f32_16x16x32_bf16 v[60:63], a[68:71], a[48:51], v[124:127]
  s_add_u32 s58, s58, 1
  v_exp_f32 v8, v48
  v_mfma_f32_16x16x32_bf16 v[60:63], a[76:79], a[52:55], v[60:63]
  s_nop 0
  v_exp_f32 v9, v49
  v_mfma_f32_16x16x32_bf16 v[60:63], a[84:87], a[56:59], v[60:63]
  s_nop 0
  v_exp_f32 v10, v50
  v_mfma_f32_16x16x32_bf16 v[60:63], a[92:95], a[60:63], v[60:63]
  s_nop 0
  v_exp_f32 v11, v51
  v_mfma_f32_16x16x32_bf16 a[132:135], v[16:19], v[84:87], a[132:135]
  s_nop 0
  ds_read_b128 a[64:67], v4 offset:8192
  v_cvt_pk_bf16_f32 v72, v8, v9
  v_mfma_f32_16x16x32_bf16 a[136:139], v[16:19], v[88:91], a[136:139]
  s_nop 0
  ds_read_b128 a[68:71], v4 offset:9216
  v_cvt_pk_bf16_f32 v73, v10, v11
  v_mfma_f32_16x16x32_bf16 a[140:143], v[16:19], v[92:95], a[140:143]
  s_nop 0
  ds_read_b128 a[72:75], v4 offset:10240
  v_or_b32 v5, v72, v73
  s_waitcnt lgkmcnt(3)
  v_mfma_f32_16x16x32_bf16 v[160:163], a[96:99], v[84:87], v[160:163]
  s_nop 0
  ds_read_b128 a[76:79], v4 offset:11264
  v_mfma_f32_16x16x32_bf16 v[192:195], a[96:99], v[88:91], v[192:195]
  ds_read_b128 a[80:83], v4 offset:12288
  v_mfma_f32_16x16x32_bf16 v[224:227], a[96:99], v[92:95], v[224:227]
  ds_read_b128 a[84:87], v4 offset:13312
  v_mfma_f32_16x16x32_bf16 v[164:167], a[100:103], v[84:87], v[164:167]
  ds_read_b128 a[88:91], v4 offset:14336
  v_mfma_f32_16x16x32_bf16 v[196:199], a[100:103], v[88:91], v[196:199]
  ds_read_b128 a[92:95], v4 offset:15360
  v_mfma_f32_16x16x32_bf16 v[228:231], a[100:103], v[92:95], v[228:231]
  v_exp_f32 v12, v52
  v_mfma_f32_16x16x32_bf16 v[168:171], a[104:107], v[84:87], v[168:171]
  v_exp_f32 v13, v53
  v_mfma_f32_16x16x32_bf16 v[200:203], a[104:107], v[88:91], v[200:203]
  v_exp_f32 v14, v54
  v_mfma_f32_16x16x32_bf16 v[232:235], a[104:107], v[92:95], v[232:235]
  v_exp_f32 v15, v55
  v_mfma_f32_16x16x32_bf16 v[172:175], a[108:111], v[84:87], v[172:175]
  v_cvt_pk_bf16_f32 v74, v12, v13
  v_cvt_pk_bf16_f32 v75, v14, v15
  v_mfma_f32_16x16x32_bf16 v[204:207], a[108:111], v[88:91], v[204:207]
  v_or3_b32 v5, v5, v74, v75
  v_mfma_f32_16x16x32_bf16 v[236:239], a[108:111], v[92:95], v[236:239]
  v_exp_f32 v8, v56
  v_mfma_f32_16x16x32_bf16 v[176:179], a[112:115], v[84:87], v[176:179]
  v_exp_f32 v9, v57
  v_mfma_f32_16x16x32_bf16 v[208:211], a[112:115], v[88:91], v[208:211]
  v_exp_f32 v10, v58
  v_mfma_f32_16x16x32_bf16 v[240:243], a[112:115], v[92:95], v[240:243]
  v_exp_f32 v11, v59
  v_mfma_f32_16x16x32_bf16 v[180:183], a[116:119], v[84:87], v[180:183]
  v_cvt_pk_bf16_f32 v76, v8, v9
  v_cvt_pk_bf16_f32 v77, v10, v11
  v_mfma_f32_16x16x32_bf16 v[212:215], a[116:119], v[88:91], v[212:215]
  v_or3_b32 v5, v5, v76, v77
  v_mfma_f32_16x16x32_bf16 v[244:247], a[116:119], v[92:95], v[244:247]
  v_exp_f32 v12, v60
  v_mfma_f32_16x16x32_bf16 v[184:187], a[120:123], v[84:87], v[184:187]
  v_exp_f32 v13, v61
  v_mfma_f32_16x16x32_bf16 v[216:219], a[120:123], v[88:91], v[216:219]
  v_exp_f32 v14, v62
  v_mfma_f32_16x16x32_bf16 v[248:251], a[120:123], v[92:95], v[248:251]
  v_exp_f32 v15, v63
  v_mfma_f32_16x16x32_bf16 v[188:191], a[124:127], v[84:87], v[188:191]
  v_cvt_pk_bf16_f32 v78, v12, v13
  v_cvt_pk_bf16_f32 v79, v14, v15
  v_mfma_f32_16x16x32_bf16 v[220:223], a[124:127], v[88:91], v[220:223]
  v_or3_b32 v5, v5, v78, v79
  v_and_b32 v5, s70, v5
  v_mfma_f32_16x16x32_bf16 v[252:255], a[124:127], v[92:95], v[252:255]
  v_cmp_ne_u32 vcc, 0, v5
  v_cmp_gt_i32 s[80:81], 32, v25
  v_cmp_gt_i32 s[82:83], 33, v25
  v_cmp_gt_i32 s[84:85], 34, v25
  v_cmp_gt_i32 s[86:87], 35, v25
  v_cndmask_b32 v112, v112, v24, s[80:81]
  v_cndmask_b32 v113, v113, v24, s[82:83]
  v_cndmask_b32 v114, v114, v24, s[84:85]
  v_cndmask_b32 v115, v115, v24, s[86:87]
  v_cmp_gt_i32 s[80:81], 48, v25
  v_cmp_gt_i32 s[82:83], 49, v25
  v_cmp_gt_i32 s[84:85], 50, v25
  v_cmp_gt_i32 s[86:87], 51, v25
  v_cndmask_b32 v116, v116, v24, s[80:81]
  v_cndmask_b32 v117, v117, v24, s[82:83]
  v_cndmask_b32 v118, v118, v24, s[84:85]
  v_cndmask_b32 v119, v119, v24, s[86:87]
  v_add_u32 v4, 0x4000, v4
  v_and_b32 v4, 0x1ffff, v4
  s_cbranch_vccnz L_a_d4_t
L_a_d4_r:
L_a_d5:
  s_waitcnt vmcnt(24) lgkmcnt(0)
  v_mfma_f32_16x16x32_bf16 v[48:51], a[64:67], a[32:35], v[112:115]
  s_barrier
  ds_read_b128 a[96:99], v4 offset:0
  v_mfma_f32_16x16x32_bf16 v[48:51], a[72:75], a[36:39], v[48:51]
  s_nop 0
  ds_read_b128 a[100:103], v4 offset:1024
  v_mfma_f32_16x16x32_bf16 v[48:51], a[80:83], a[40:43], v[48:51]
  s_nop 0
  ds_read_b128 a[104:107], v4 offset:2048
  v_mfma_f32_16x16x32_bf16 v[48:51], a[88:91], a[44:47], v[48:51]
  s_nop 0
  ds_read_b128 a[108:111], v4 offset:3072
  v_mfma_f32_16x16x32_bf16 v[52:55], a[68:71], a[32:35], v[116:119]
  s_nop 0
  ds_read_b128 a[112:115], v4 offset:4096
  v_mfma_f32_16x16x32_bf16 v[52:55], a[76:79], a[36:39], v[52:55]
  s_nop 0
  ds_read_b128 a[116:119], v4 offset:5120
  v_mfma_f32_16x16x32_bf16 v[52:55], a[84:87], a[40:43], v[52:55]
  s_nop 0
  ds_read_b128 a[120:123], v4 offset:6144
  v_mfma_f32_16x16x32_bf16 v[52:55], a[92:95], a[44:47], v[52:55]
  s_nop 0
  ds_read_b128 a[124:127], v4 offset:7168
  v_mfma_f32_16x16x32_bf16 v[56:59], a[64:67], a[48:51], v[120:123]
  s_add_u32 m0, s73, 49152
  s_xor_b32 s66, s72, 0x20080
  buffer_load_dwordx4 v26, s[48:51], s66 offen lds
  v_mfma_f32_16x16x32_bf16 v[56:59], a[72:75], a[52:55], v[56:59]
  s_add_u32 m0, s73, 50176
  s_xor_b32 s66, s72, 0x22080
  buffer_load_dwordx4 v26, s[48:51], s66 offen lds
  v_mfma_f32_16x16x32_bf16 v[56:59], a[80:83], a[56:59], v[56:59]
  s_add_u32 m0, s73, 51200
  s_xor_b32 s66, s72, 0x24080
  buffer_load_dwordx4 v26, s[48:51], s66 offen lds
  v_mfma_f32_16x16x32_bf16 v[56:59], a[88:91], a[60:63], v[56:59]
  s_add_u32 m0, s73, 52224
  s_xor_b32 s66, s72, 0x26080
  buffer_load_dwordx4 v26, s[48:51], s66 offen lds
  v_mfma_f32_16x16x32_bf16 v[60:63], a[68:71], a[48:51], v[124:127]
  s_add_u32 s58, s58, 1
  v_exp_f32 v8, v48
  v_mfma_f32_16x16x32_bf16 v[60:63], a[76:79], a[52:55], v[60:63]
  s_nop 0
  v_exp_f32 v9, v49
  v_mfma_f32_16x16x32_bf16 v[60:63], a[84:87], a[56:59], v[60:63]
  s_nop 0
  v_exp_f32 v10, v50
  v_mfma_f32_16x16x32_bf16 v[60:63], a[92:95], a[60:63], v[60:63]
  s_nop 0
  v_exp_f32 v11, v51
  v_mfma_f32_16x16x32_bf16 a[136:139], v[16:19], v[72:75], a[136:139]
  s_nop 0
  ds_read_b128 a[64:67], v4 offset:8192
  v_cvt_pk_bf16_f32 v88, v8, v9
  v_mfma_f32_16x16x32_bf16 a[140:143], v[16:19], v[76:79], a[140:143]
  s_nop 0
  ds_read_b128 a[68:71], v4 offset:9216
  v_cvt_pk_bf16_f32 v89, v10, v11
  s_waitcnt lgkmcnt(2)
  v_mfma_f32_16x16x32_bf16 v[192:195], a[96:99], v[72:75], v[192:195]
  s_nop 0
  ds_read_b128 a[72:75], v4 offset:10240
  v_or_b32 v5, v88, v89
  v_mfma_f32_16x16x32_bf16 v[224:227], a[96:99], v[76:79], v[224:227]
  s_nop 0
  ds_read_b128 a[76:79], v4 offset:11264
  v_mfma_f32_16x16x32_bf16 v[196:199], a[100:103], v[72:75], v[196:199]
  ds_read_b128 a[80:83], v4 offset:12288
  v_mfma_f32_16x16x32_bf16 v[228:231], a[100:103], v[76:79], v[228:231]
  ds_read_b128 a[84:87], v4 offset:13312
  v_mfma_f32_16x16x32_bf16 v[200:203], a[104:107], v[72:75], v[200:203]
  ds_read_b128 a[88:91], v4 offset:14336
  v_mfma_f32_16x16x32_bf16 v[232:235], a[104:107], v[76:79], v[232:235]
  ds_read_b128 a[92:95], v4 offset:15360
  v_mfma_f32_16x16x32_bf16 v[204:207], a[108:111], v[72:75], v[204:207]
  v_exp_f32 v12, v52
  v_mfma_f32_16x16x32_bf16 v[236:239], a[108:111], v[76:79], v[236:239]
  v_exp_f32 v13, v53
  v_mfma_f32_16x16x32_bf16 v[208:211], a[112:115], v[72:75], v[208:211]
  v_exp_f32 v14, v54
  v_mfma_f32_16x16x32_bf16 v[240:243], a[112:115], v[76:79], v[240:243]
  v_exp_f32 v15, v55
  v_mfma_f32_16x16x32_bf16 v[212:215], a[116:119], v[72:75], v[212:215]
  v_cvt_pk_bf16_f32 v90, v12, v13
  v_cvt_pk_bf16_f32 v91, v14, v15
  v_mfma_f32_16x16x32_bf16 v[244:247], a[116:119], v[76:79], v[244:247]
  v_or3_b32 v5, v5, v90, v91
  v_mfma_f32_16x16x32_bf16 v[216:219], a[120:123], v[72:75], v[216:219]
  v_exp_f32 v8, v56
  v_mfma_f32_16x16x32_bf16 v[248:251], a[120:123], v[76:79], v[248:251]
  v_exp_f32 v9, v57
  v_mfma_f32_16x16x32_bf16 v[220:223], a[124:127], v[72:75], v[220:223]
  v_exp_f32 v10, v58
  v_mfma_f32_16x16x32_bf16 v[252:255], a[124:127], v[76:79], v[252:255]
  v_exp_f32 v11, v59
  s_nop 0
  v_cvt_pk_bf16_f32 v92, v8, v9
  v_cvt_pk_bf16_f32 v93, v10, v11
  v_or3_b32 v5, v5, v92, v93
  v_exp_f32 v12, v60
  v_exp_f32 v13, v61
  v_exp_f32 v14, v62
  v_exp_f32 v15, v63
  s_nop 0
  v_cvt_pk_bf16_f32 v94, v12, v13
  v_cvt_pk_bf16_f32 v95, v14, v15
  v_or3_b32 v5, v5, v94, v95
  v_and_b32 v5, s70, v5
  v_cmp_ne_u32 vcc, 0, v5
  v_cmp_gt_i32 s[80:81], 0, v25
  v_cmp_gt_i32 s[82:83], 1, v25
  v_cmp_gt_i32 s[84:85], 2, v25
  v_cmp_gt_i32 s[86:87], 3, v25
  v_cndmask_b32 v120, v120, v24, s[80:81]
  v_cndmask_b32 v121, v121, v24, s[82:83]
  v_cndmask_b32 v122, v122, v24, s[84:85]
  v_cndmask_b32 v123, v123, v24, s[86:87]
  v_cmp_gt_i32 s[80:81], 16, v25
  v_cmp_gt_i32 s[82:83], 17, v25
  v_cmp_gt_i32 s[84:85], 18, v25
  v_cmp_gt_i32 s[86:87], 19, v25
  v_cndmask_b32 v124, v124, v24, s[80:81]
  v_cndmask_b32 v125, v125, v24, s[82:83]
  v_cndmask_b32 v126, v126, v24, s[84:85]
  v_cndmask_b32 v127, v127, v24, s[86:87]
  v_add_u32 v4, 0x4000, v4
  v_and_b32 v4, 0x1ffff, v4
  s_cbranch_vccnz L_a_d5_t
L_a_d5_r:
L_a_d6:
  s_waitcnt vmcnt(24) lgkmcnt(0)
  v_mfma_f32_16x16x32_bf16 v[56:59], a[64:67], a[48:51], v[120:123]
  s_barrier
  ds_read_b128 a[96:99], v4 offset:0
  v_mfma_f32_16x16x32_bf16 v[56:59], a[72:75], a[52:55], v[56:59]
  s_nop 0
  ds_read_b128 a[100:103], v4 offset:1024
  v_mfma_f32_16x16x32_bf16 v[56:59], a[80:83], a[56:59], v[56:59]
  s_nop 0
  ds_read_b128 a[104:107], v4 offset:2048
  v_mfma_f32_16x16x32_bf16 v[56:59], a[88:91], a[60:63], v[56:59]
  s_nop 0
  ds_read_b128 a[108:111], v4 offset:3072
  v_mfma_f32_16x16x32_bf16 v[60:63], a[68:71], a[48:51], v[124:127]
  s_nop 0
  ds_read_b128 a[112:115], v4 offset:4096
  v_mfma_f32_16x16x32_bf16 v[60:63], a[76:79], a[52:55], v[60:63]
  s_nop 0
  ds_read_b128 a[116:119], v4 offset:5120
  v_mfma_f32_16x16x32_bf16 v[60:63], a[84:87], a[56:59], v[60:63]
  s_nop 0
  ds_read_b128 a[120:123], v4 offset:6144
  v_mfma_f32_16x16x32_bf16 v[60:63], a[92:95], a[60:63], v[60:63]
  s_nop 0
  ds_read_b128 a[124:127], v4 offset:7168
  v_mfma_f32_16x16x32_bf16 a[136:139], v[16:19], v[88:91], a[136:139]
  s_add_u32 m0, s73, 65536
  s_xor_b32 s66, s72, 0x40000
  buffer_load_dwordx4 v26, s[48:51], s66 offen lds
  v_mfma_f32_16x16x32_bf16 a[140:143], v[16:19], v[92:95], a[140:143]
  s_add_u32 m0, s73, 66560
  s_xor_b32 s66, s72, 0x42000
  buffer_load_dwordx4 v26, s[48:51], s66 offen lds
  s_waitcnt lgkmcnt(0)
  v_mfma_f32_16x16x32_bf16 v[192:195], a[96:99], v[88:91], v[192:195]
  s_add_u32 m0, s73, 67584
  s_xor_b32 s66, s72, 0x44000
  buffer_load_dwordx4 v26, s[48:51], s66 offen lds
  v_mfma_f32_16x16x32_bf16 v[224:227], a[96:99], v[92:95], v[224:227]
  s_add_u32 m0, s73, 68608
  s_xor_b32 s66, s72, 0x46000
  buffer_load_dwordx4 v26, s[48:51], s66 offen lds
  v_mfma_f32_16x16x32_bf16 v[196:199], a[100:103], v[88:91], v[196:199]
  s_add_u32 s58, s58, 1
  ds_read_b128 a[64:67], v4 offset:8192
  v_mfma_f32_16x16x32_bf16 v[228:231], a[100:103], v[92:95], v[228:231]
  ds_read_b128 a[68:71], v4 offset:9216
  v_mfma_f32_16x16x32_bf16 v[200:203], a[104:107], v[88:91], v[200:203]
  ds_read_b128 a[72:75], v4 offset:10240
  v_mfma_f32_16x16x32_bf16 v[232:235], a[104:107], v[92:95], v[232:235]
  ds_read_b128 a[76:79], v4 offset:11264
  v_mfma_f32_16x16x32_bf16 v[204:207], a[108:111], v[88:91], v[204:207]
  ds_read_b128 a[80:83], v4 offset:12288
  v_mfma_f32_16x16x32_bf16 v[236:239], a[108:111], v[92:95], v[236:239]
  ds_read_b128 a[84:87], v4 offset:13312
  v_mfma_f32_16x16x32_bf16 v[208:211], a[112:115], v[88:91], v[208:211]
  ds_read_b128 a[88:91], v4 offset:14336
  v_mfma_f32_16x16x32_bf16 v[240:243], a[112:115], v[92:95], v[240:243]
  ds_read_b128 a[92:95], v4 offset:15360
  v_mfma_f32_16x16x32_bf16 v[212:215], a[116:119], v[88:91], v[212:215]
  v_exp_f32 v8, v56
  v_mfma_f32_16x16x32_bf16 v[244:247], a[116:119], v[92:95], v[244:247]
  v_exp_f32 v9, v57
  v_mfma_f32_16x16x32_bf16 v[216:219], a[120:123], v[88:91], v[216:219]
  v_exp_f32 v10, v58
  v_mfma_f32_16x16x32_bf16 v[248:251], a[120:123], v[92:95], v[248:251]
  v_exp_f32 v11, v59
  v_mfma_f32_16x16x32_bf16 v[220:223], a[124:127], v[88:91], v[220:223]
  v_cvt_pk_bf16_f32 v76, v8, v9
  v_cvt_pk_bf16_f32 v77, v10, v11
  v_mfma_f32_16x16x32_bf16 v[252:255], a[124:127], v[92:95], v[252:255]
  v_or_b32 v5, v76, v77
  v_exp_f32 v12, v60
  v_exp_f32 v13, v61
  v_exp_f32 v14, v62
  v_exp_f32 v15, v63
  s_nop 0
  v_cvt_pk_bf16_f32 v78, v12, v13
  v_cvt_pk_bf16_f32 v79, v14, v15
  v_or3_b32 v5, v5, v78, v79
  v_and_b32 v5, s70, v5
  v_cmp_ne_u32 vcc, 0, v5
  v_cmp_gt_i32 s[80:81], 32, v25
  v_cmp_gt_i32 s[82:83], 33, v25
  v_cmp_gt_i32 s[84:85], 34, v25
  v_cmp_gt_i32 s[86:87], 35, v25
  v_cndmask_b32 v120, v120, v24, s[80:81]
  v_cndmask_b32 v121, v121, v24, s[82:83]
  v_cndmask_b32 v122, v122, v24, s[84:85]
  v_cndmask_b32 v123, v123, v24, s[86:87]
  v_cmp_gt_i32 s[80:81], 48, v25
  v_cmp_gt_i32 s[82:83], 49, v25
  v_cmp_gt_i32 s[84:85], 50, v25
  v_cmp_gt_i32 s[86:87], 51, v25
  v_cndmask_b32 v124, v124, v24, s[80:81]
  v_cndmask_b32 v125, v125, v24, s[82:83]
  v_cndmask_b32 v126, v126, v24, s[84:85]
  v_cndmask_b32 v127, v127, v24, s[86:87]
  v_add_u32 v4, 0x4000, v4
  v_and_b32 v4, 0x1ffff, v4
  s_cbranch_vccnz L_a_d6_t
L_a_d6_r:
L_a_d7:
  s_waitcnt vmcnt(24) lgkmcnt(0)
  v_mfma_f32_16x16x32_bf16 v[56:59], a[64:67], a[48:51], v[120:123]
  s_barrier
  ds_read_b128 a[96:99], v4 offset:0
  v_mfma_f32_16x16x32_bf16 v[56:59], a[72:75], a[52:55], v[56:59]
  s_nop 0
  ds_read_b128 a[100:103], v4 offset:1024
  v_mfma_f32_16x16x32_bf16 v[56:59], a[80:83], a[56:59], v[56:59]
  s_nop 0
  ds_read_b128 a[104:107], v4 offset:2048
  v_mfma_f32_16x16x32_bf16 v[56:59], a[88:91], a[60:63], v[56:59]
  s_nop 0
  ds_read_b128 a[108:111], v4 offset:3072
  v_mfma_f32_16x16x32_bf16 v[60:63], a[68:71], a[48:51], v[124:127]
  s_nop 0
  ds_read_b128 a[112:115], v4 offset:4096
  v_mfma_f32_16x16x32_bf16 v[60:63], a[76:79], a[52:55], v[60:63]
  s_nop 0
  ds_read_b128 a[116:119], v4 offset:5120
  v_mfma_f32_16x16x32_bf16 v[60:63], a[84:87], a[56:59], v[60:63]
  s_nop 0
  ds_read_b128 a[120:123], v4 offset:6144
  v_mfma_f32_16x16x32_bf16 v[60:63], a[92:95], a[60:63], v[60:63]
  s_nop 0
  ds_read_b128 a[124:127], v4 offset:7168
  v_mfma_f32_16x16x32_bf16 a[140:143], v[16:19], v[76:79], a[140:143]
  s_add_u32 m0, s73, 81920
  s_xor_b32 s66, s72, 0x40080
  buffer_load_dwordx4 v26, s[48:51], s66 offen lds
  s_waitcnt lgkmcnt(0)
  v_mfma_f32_16x16x32_bf16 v[224:227], a[96:99], v[76:79], v[224:227]
  s_add_u32 m0, s73, 82944
  s_xor_b32 s66, s72, 0x42080
  buffer_load_dwordx4 v26, s[48:51], s66 offen lds
  v_mfma_f32_16x16x32_bf16 v[228:231], a[100:103], v[76:79], v[228:231]
  s_add_u32 m0, s73, 83968
  s_xor_b32 s66, s72, 0x44080
  buffer_load_dwordx4 v26, s[48:51], s66 offen lds
  v_mfma_f32_16x16x32_bf16 v[232:235], a[104:107], v[76:79], v[232:235]
  s_add_u32 m0, s73, 84992
  s_xor_b32 s66, s72, 0x46080
  buffer_load_dwordx4 v26, s[48:51], s66 offen lds
  v_mfma_f32_16x16x32_bf16 v[236:239], a[108:111], v[76:79], v[236:239]
  s_add_u32 s58, s58, 1
  v_exp_f32 v8, v56
  v_mfma_f32_16x16x32_bf16 v[240:243], a[112:115], v[76:79], v[240:243]
  v_exp_f32 v9, v57
  v_mfma_f32_16x16x32_bf16 v[244:247], a[116:119], v[76:79], v[244:247]
  v_exp_f32 v10, v58
  v_mfma_f32_16x16x32_bf16 v[248:251], a[120:123], v[76:79], v[248:251]
  v_exp_f32 v11, v59
  v_mfma_f32_16x16x32_bf16 v[252:255], a[124:127], v[76:79], v[252:255]
  v_cvt_pk_bf16_f32 v92, v8, v9
  v_cvt_pk_bf16_f32 v93, v10, v11
  v_or_b32 v5, v92, v93
  v_exp_f32 v12, v60
  v_exp_f32 v13, v61
  v_exp_f32 v14, v62
  v_exp_f32 v15, v63
  s_nop 0
  v_cvt_pk_bf16_f32 v94, v12, v13
  v_cvt_pk_bf16_f32 v95, v14, v15
  v_or3_b32 v5, v5, v94, v95
  v_and_b32 v5, s70, v5
  v_cmp_ne_u32 vcc, 0, v5
  v_add_u32 v4, 0x4000, v4
  v_and_b32 v4, 0x1ffff, v4
  s_cbranch_vccnz L_a_d7_t
L_a_d7_r:
  s_waitcnt vmcnt(24)
  s_barrier
  ds_read_b128 a[96:99], v4 offset:0
  ds_read_b128 a[100:103], v4 offset:1024
  ds_read_b128 a[104:107], v4 offset:2048
  ds_read_b128 a[108:111], v4 offset:3072
  ds_read_b128 a[112:115], v4 offset:4096
  ds_read_b128 a[116:119], v4 offset:5120
  ds_read_b128 a[120:123], v4 offset:6144
  ds_read_b128 a[124:127], v4 offset:7168
  s_add_u32 m0, s73, 98304
  s_xor_b32 s66, s72, 0x60000
  buffer_load_dwordx4 v26, s[48:51], s66 offen lds
  s_add_u32 m0, s73, 99328
  s_xor_b32 s66, s72, 0x62000
  buffer_load_dwordx4 v26, s[48:51], s66 offen lds
  s_add_u32 m0, s73, 100352
  s_xor_b32 s66, s72, 0x64000
  buffer_load_dwordx4 v26, s[48:51], s66 offen lds
  s_add_u32 m0, s73, 101376
  s_xor_b32 s66, s72, 0x66000
  buffer_load_dwordx4 v26, s[48:51], s66 offen lds
  v_mfma_f32_16x16x32_bf16 a[140:143], v[16:19], v[92:95], a[140:143]
  s_waitcnt lgkmcnt(7)
  v_mfma_f32_16x16x32_bf16 v[224:227], a[96:99], v[92:95], v[224:227]
  s_waitcnt lgkmcnt(6)
  v_mfma_f32_16x16x32_bf16 v[228:231], a[100:103], v[92:95], v[228:231]
  s_waitcnt lgkmcnt(5)
  v_mfma_f32_16x16x32_bf16 v[232:235], a[104:107], v[92:95], v[232:235]
  s_waitcnt lgkmcnt(4)
  v_mfma_f32_16x16x32_bf16 v[236:239], a[108:111], v[92:95], v[236:239]
  s_waitcnt lgkmcnt(3)
  v_mfma_f32_16x16x32_bf16 v[240:243], a[112:115], v[92:95], v[240:243]
  s_waitcnt lgkmcnt(2)
  v_mfma_f32_16x16x32_bf16 v[244:247], a[116:119], v[92:95], v[244:247]
  s_waitcnt lgkmcnt(1)
  v_mfma_f32_16x16x32_bf16 v[248:251], a[120:123], v[92:95], v[248:251]
  s_waitcnt lgkmcnt(0)
  v_mfma_f32_16x16x32_bf16 v[252:255], a[124:127], v[92:95], v[252:255]
  s_barrier
  s_add_u32 m0, s73, 114688
  s_xor_b32 s66, s72, 0x60080
  buffer_load_dwordx4 v26, s[48:51], s66 offen lds
  s_add_u32 m0, s73, 115712
  s_xor_b32 s66, s72, 0x62080
  buffer_load_dwordx4 v26, s[48:51], s66 offen lds
  s_add_u32 m0, s73, 116736
  s_xor_b32 s66, s72, 0x64080
  buffer_load_dwordx4 v26, s[48:51], s66 offen lds
  s_add_u32 m0, s73, 117760
  s_xor_b32 s66, s72, 0x66080
  buffer_load_dwordx4 v26, s[48:51], s66 offen lds
  v_accvgpr_read_b32 v6, a128
  v_rcp_f32 v6, v6
  s_nop 0
  v_mul_f32 v20, v20, v6
  v_accvgpr_read_b32 v6, a132
  v_rcp_f32 v6, v6
  s_nop 0
  v_mul_f32 v21, v21, v6
  v_accvgpr_read_b32 v6, a136
  v_rcp_f32 v6, v6
  s_nop 0
  v_mul_f32 v22, v22, v6
  v_accvgpr_read_b32 v6, a140
  v_rcp_f32 v6, v6
  s_nop 0
  v_mul_f32 v23, v23, v6
  v_mul_f32 v128, v128, v20
  v_mul_f32 v129, v129, v20
  v_mul_f32 v130, v130, v20
  v_mul_f32 v131, v131, v20
  v_mul_f32 v132, v132, v20
  v_mul_f32 v133, v133, v20
  v_mul_f32 v134, v134, v20
  v_mul_f32 v135, v135, v20
  v_cvt_pk_bf16_f32 v32, v128, v129
  v_cvt_pk_bf16_f32 v33, v130, v131
  v_cvt_pk_bf16_f32 v34, v132, v133
  v_cvt_pk_bf16_f32 v35, v134, v135
  s_add_u32 s66, s75, 0
  buffer_store_dwordx4 v[32:35], v2, s[40:43], s66 offen offset:0 sc1
  v_mul_f32 v136, v136, v20
  v_mul_f32 v137, v137, v20
  v_mul_f32 v138, v138, v20
  v_mul_f32 v139, v139, v20
  v_mul_f32 v140, v140, v20
  v_mul_f32 v141, v141, v20
  v_mul_f32 v142, v142, v20
  v_mul_f32 v143, v143, v20
  v_cvt_pk_bf16_f32 v36, v136, v137
  v_cvt_pk_bf16_f32 v37, v138, v139
  v_cvt_pk_bf16_f32 v38, v140, v141
  v_cvt_pk_bf16_f32 v39, v142, v143
  buffer_store_dwordx4 v[36:39], v2, s[40:43], s66 offen offset:1024 sc1
  v_mul_f32 v144, v144, v20
  v_mul_f32 v145, v145, v20
  v_mul_f32 v146, v146, v20
  v_mul_f32 v147, v147, v20
  v_mul_f32 v148, v148, v20
  v_mul_f32 v149, v149, v20
  v_mul_f32 v150, v150, v20
  v_mul_f32 v151, v151, v20
  v_cvt_pk_bf16_f32 v40, v144, v145
  v_cvt_pk_bf16_f32 v41, v146, v147
  v_cvt_pk_bf16_f32 v42, v148, v149
  v_cvt_pk_bf16_f32 v43, v150, v151
  buffer_store_dwordx4 v[40:43], v2, s[40:43], s66 offen offset:2048 sc1
  v_mul_f32 v152, v152, v20
  v_mul_f32 v153, v153, v20
  v_mul_f32 v154, v154, v20
  v_mul_f32 v155, v155, v20
  v_mul_f32 v156, v156, v20
  v_mul_f32 v157, v157, v20
  v_mul_f32 v158, v158, v20
  v_mul_f32 v159, v159, v20
  v_cvt_pk_bf16_f32 v44, v152, v153
  v_cvt_pk_bf16_f32 v45, v154, v155
  v_cvt_pk_bf16_f32 v46, v156, v157
  v_cvt_pk_bf16_f32 v47, v158, v159
  buffer_store_dwordx4 v[44:47], v2, s[40:43], s66 offen offset:3072 sc1
  v_mul_f32 v160, v160, v21
  v_mul_f32 v161, v161, v21
  v_mul_f32 v162, v162, v21
  v_mul_f32 v163, v163, v21
  v_mul_f32 v164, v164, v21
  v_mul_f32 v165, v165, v21
  v_mul_f32 v166, v166, v21
  v_mul_f32 v167, v167, v21
  v_cvt_pk_bf16_f32 v48, v160, v161
  v_cvt_pk_bf16_f32 v49, v162, v163
  v_cvt_pk_bf16_f32 v50, v164, v165
  v_cvt_pk_bf16_f32 v51, v166, v167
  s_add_u32 s66, s75, 4096
  buffer_store_dwordx4 v[48:51], v2, s[40:43], s66 offen offset:0 sc1
  v_mul_f32 v168, v168, v21
  v_mul_f32 v169, v169, v21
  v_mul_f32 v170, v170, v21
  v_mul_f32 v171, v171, v21
  v_mul_f32 v172, v172, v21
  v_mul_f32 v173, v173, v21
  v_mul_f32 v174, v174, v21
  v_mul_f32 v175, v175, v21
  v_cvt_pk_bf16_f32 v52, v168, v169
  v_cvt_pk_bf16_f32 v53, v170, v171
  v_cvt_pk_bf16_f32 v54, v172, v173
  v_cvt_pk_bf16_f32 v55, v174, v175
  buffer_store_dwordx4 v[52:55], v2, s[40:43], s66 offen offset:1024 sc1
  v_mul_f32 v176, v176, v21
  v_mul_f32 v177, v177, v21
  v_mul_f32 v178, v178, v21
  v_mul_f32 v179, v179, v21
  v_mul_f32 v180, v180, v21
  v_mul_f32 v181, v181, v21
  v_mul_f32 v182, v182, v21
  v_mul_f32 v183, v183, v21
  v_cvt_pk_bf16_f32 v56, v176, v177
  v_cvt_pk_bf16_f32 v57, v178, v179
  v_cvt_pk_bf16_f32 v58, v180, v181
  v_cvt_pk_bf16_f32 v59, v182, v183
  buffer_store_dwordx4 v[56:59], v2, s[40:43], s66 offen offset:2048 sc1
  v_mul_f32 v184, v184, v21
  v_mul_f32 v185, v185, v21
  v_mul_f32 v186, v186, v21
  v_mul_f32 v187, v187, v21
  v_mul_f32 v188, v188, v21
  v_mul_f32 v189, v189, v21
  v_mul_f32 v190, v190, v21
  v_mul_f32 v191, v191, v21
  v_cvt_pk_bf16_f32 v60, v184, v185
  v_cvt_pk_bf16_f32 v61, v186, v187
  v_cvt_pk_bf16_f32 v62, v188, v189
  v_cvt_pk_bf16_f32 v63, v190, v191
  buffer_store_dwordx4 v[60:63], v2, s[40:43], s66 offen offset:3072 sc1
  v_mul_f32 v192, v192, v22
  v_mul_f32 v193, v193, v22
  v_mul_f32 v194, v194, v22
  v_mul_f32 v195, v195, v22
  v_mul_f32 v196, v196, v22
  v_mul_f32 v197, v197, v22
  v_mul_f32 v198, v198, v22
  v_mul_f32 v199, v199, v22
  v_cvt_pk_bf16_f32 v64, v192, v193
  v_cvt_pk_bf16_f32 v65, v194, v195
  v_cvt_pk_bf16_f32 v66, v196, v197
  v_cvt_pk_bf16_f32 v67, v198, v199
  s_add_u32 s66, s75, 8192
  buffer_store_dwordx4 v[64:67], v2, s[40:43], s66 offen offset:0 sc1
  v_mul_f32 v200, v200, v22
  v_mul_f32 v201, v201, v22
  v_mul_f32 v202, v202, v22
  v_mul_f32 v203, v203, v22
  v_mul_f32 v204, v204, v22
  v_mul_f32 v205, v205, v22
  v_mul_f32 v206, v206, v22
  v_mul_f32 v207, v207, v22
  v_cvt_pk_bf16_f32 v68, v200, v201
  v_cvt_pk_bf16_f32 v69, v202, v203
  v_cvt_pk_bf16_f32 v70, v204, v205
  v_cvt_pk_bf16_f32 v71, v206, v207
  buffer_store_dwordx4 v[68:71], v2, s[40:43], s66 offen offset:1024 sc1
  v_mul_f32 v208, v208, v22
  v_mul_f32 v209, v209, v22
  v_mul_f32 v210, v210, v22
  v_mul_f32 v211, v211, v22
  v_mul_f32 v212, v212, v22
  v_mul_f32 v213, v213, v22
  v_mul_f32 v214, v214, v22
  v_mul_f32 v215, v215, v22
  v_cvt_pk_bf16_f32 v72, v208, v209
  v_cvt_pk_bf16_f32 v73, v210, v211
  v_cvt_pk_bf16_f32 v74, v212, v213
  v_cvt_pk_bf16_f32 v75, v214, v215
  buffer_store_dwordx4 v[72:75], v2, s[40:43], s66 offen offset:2048 sc1
  v_mul_f32 v216, v216, v22
  v_mul_f32 v217, v217, v22
  v_mul_f32 v218, v218, v22
  v_mul_f32 v219, v219, v22
  v_mul_f32 v220, v220, v22
  v_mul_f32 v221, v221, v22
  v_mul_f32 v222, v222, v22
  v_mul_f32 v223, v223, v22
  v_cvt_pk_bf16_f32 v76, v216, v217
  v_cvt_pk_bf16_f32 v77, v218, v219
  v_cvt_pk_bf16_f32 v78, v220, v221
  v_cvt_pk_bf16_f32 v79, v222, v223
  buffer_store_dwordx4 v[76:79], v2, s[40:43], s66 offen offset:3072 sc1
  v_mul_f32 v224, v224, v23
  v_mul_f32 v225, v225, v23
  v_mul_f32 v226, v226, v23
  v_mul_f32 v227, v227, v23
  v_mul_f32 v228, v228, v23
  v_mul_f32 v229, v229, v23
  v_mul_f32 v230, v230, v23
  v_mul_f32 v231, v231, v23
  v_cvt_pk_bf16_f32 v80, v224, v225
  v_cvt_pk_bf16_f32 v81, v226, v227
  v_cvt_pk_bf16_f32 v82, v228, v229
  v_cvt_pk_bf16_f32 v83, v230, v231
  s_add_u32 s66, s75, 12288
  buffer_store_dwordx4 v[80:83], v2, s[40:43], s66 offen offset:0 sc1
  v_mul_f32 v232, v232, v23
  v_mul_f32 v233, v233, v23
  v_mul_f32 v234, v234, v23
  v_mul_f32 v235, v235, v23
  v_mul_f32 v236, v236, v23
  v_mul_f32 v237, v237, v23
  v_mul_f32 v238, v238, v23
  v_mul_f32 v239, v239, v23
  v_cvt_pk_bf16_f32 v84, v232, v233
  v_cvt_pk_bf16_f32 v85, v234, v235
  v_cvt_pk_bf16_f32 v86, v236, v237
  v_cvt_pk_bf16_f32 v87, v238, v239
  buffer_store_dwordx4 v[84:87], v2, s[40:43], s66 offen offset:1024 sc1
  v_mul_f32 v240, v240, v23
  v_mul_f32 v241, v241, v23
  v_mul_f32 v242, v242, v23
  v_mul_f32 v243, v243, v23
  v_mul_f32 v244, v244, v23
  v_mul_f32 v245, v245, v23
  v_mul_f32 v246, v246, v23
  v_mul_f32 v247, v247, v23
  v_cvt_pk_bf16_f32 v88, v240, v241
  v_cvt_pk_bf16_f32 v89, v242, v243
  v_cvt_pk_bf16_f32 v90, v244, v245
  v_cvt_pk_bf16_f32 v91, v246, v247
  buffer_store_dwordx4 v[88:91], v2, s[40:43], s66 offen offset:2048 sc1
  v_mul_f32 v248, v248, v23
  v_mul_f32 v249, v249, v23
  v_mul_f32 v250, v250, v23
  v_mul_f32 v251, v251, v23
  v_mul_f32 v252, v252, v23
  v_mul_f32 v253, v253, v23
  v_mul_f32 v254, v254, v23
  v_mul_f32 v255, v255, v23
  v_cvt_pk_bf16_f32 v92, v248, v249
  v_cvt_pk_bf16_f32 v93, v250, v251
  v_cvt_pk_bf16_f32 v94, v252, v253
  v_cvt_pk_bf16_f32 v95, v254, v255
  buffer_store_dwordx4 v[92:95], v2, s[40:43], s66 offen offset:3072 sc1
  v_and_b32 v6, 3, v0
  v_xor_b32 v6, s56, v6
  s_lshl2_add_u32 s66, s57, s44
  s_lshl2_add_u32 s66, s66, 0xd084000
  v_lshl_add_u32 v24, v6, 7, s66
  v_lshrrev_b32 v6, 2, v0
  v_lshlrev_b32 v8, 7, v6
  v_bfe_u32 v6, v0, 3, 2
  v_lshl_add_u32 v8, v6, 5, v8
  v_and_b32 v6, 3, v0
  v_lshl_add_u32 v8, v6, 3, v8
  v_xor_b32 v9, 32, v8
  v_xor_b32 v10, 64, v8
  v_xor_b32 v11, 96, v8
  v_add_u32 v12, 0x10000, v8
  v_add_u32 v13, 0x10000, v9
  v_add_u32 v14, 0x10000, v10
  v_add_u32 v15, 0x10000, v11
  s_waitcnt vmcnt(20)
  s_barrier
  ds_read_b64_tr_b16 a[64:65], v8 offset:0
  ds_read_b64_tr_b16 a[66:67], v8 offset:2048
  ds_read_b64_tr_b16 a[68:69], v8 offset:4096
  ds_read_b64_tr_b16 a[70:71], v8 offset:6144
  ds_read_b64_tr_b16 a[72:73], v8 offset:8192
  ds_read_b64_tr_b16 a[74:75], v8 offset:10240
  ds_read_b64_tr_b16 a[76:77], v8 offset:12288
  ds_read_b64_tr_b16 a[78:79], v8 offset:14336
  ds_read_b64_tr_b16 a[80:81], v9 offset:0
  ds_read_b64_tr_b16 a[82:83], v9 offset:2048
  ds_read_b64_tr_b16 a[84:85], v9 offset:4096
  ds_read_b64_tr_b16 a[86:87], v9 offset:6144
  ds_read_b64_tr_b16 a[88:89], v9 offset:8192
  ds_read_b64_tr_b16 a[90:91], v9 offset:10240
  ds_read_b64_tr_b16 a[92:93], v9 offset:12288
  ds_read_b64_tr_b16 a[94:95], v9 offset:14336
  s_waitcnt lgkmcnt(8)
  v_mfma_f32_16x16x32_bf16 v[128:131], a[64:67], v[32:35], 0
  ds_read_b64_tr_b16 a[96:97], v10 offset:0
  v_mfma_f32_16x16x32_bf16 v[128:131], a[68:71], v[36:39], v[128:131]
  v_mfma_f32_16x16x32_bf16 v[128:131], a[72:75], v[40:43], v[128:131]
  ds_read_b64_tr_b16 a[98:99], v10 offset:2048
  v_mfma_f32_16x16x32_bf16 v[128:131], a[76:79], v[44:47], v[128:131]
  v_mfma_f32_16x16x32_bf16 v[136:139], a[64:67], v[48:51], 0
  ds_read_b64_tr_b16 a[100:101], v10 offset:4096
  v_mfma_f32_16x16x32_bf16 v[136:139], a[68:71], v[52:55], v[136:139]
  v_mfma_f32_16x16x32_bf16 v[136:139], a[72:75], v[56:59], v[136:139]
  ds_read_b64_tr_b16 a[102:103], v10 offset:6144
  v_mfma_f32_16x16x32_bf16 v[136:139], a[76:79], v[60:63], v[136:139]
  v_mfma_f32_16x16x32_bf16 v[144:147], a[64:67], v[64:67], 0
  ds_read_b64_tr_b16 a[104:105], v10 offset:8192
  v_mfma_f32_16x16x32_bf16 v[144:147], a[68:71], v[68:71], v[144:147]
  v_mfma_f32_16x16x32_bf16 v[144:147], a[72:75], v[72:75], v[144:147]
  ds_read_b64_tr_b16 a[106:107], v10 offset:10240
  v_mfma_f32_16x16x32_bf16 v[144:147], a[76:79], v[76:79], v[144:147]
  v_mfma_f32_16x16x32_bf16 v[152:155], a[64:67], v[80:83], 0
  ds_read_b64_tr_b16 a[108:109], v10 offset:12288
  v_mfma_f32_16x16x32_bf16 v[152:155], a[68:71], v[84:87], v[152:155]
  v_mfma_f32_16x16x32_bf16 v[152:155], a[72:75], v[88:91], v[152:155]
  ds_read_b64_tr_b16 a[110:111], v10 offset:14336
  v_mfma_f32_16x16x32_bf16 v[152:155], a[76:79], v[92:95], v[152:155]
  s_waitcnt lgkmcnt(8)
  v_mfma_f32_16x16x32_bf16 v[132:135], a[80:83], v[32:35], 0
  ds_read_b64_tr_b16 a[112:113], v11 offset:0
  v_mfma_f32_16x16x32_bf16 v[132:135], a[84:87], v[36:39], v[132:135]
  v_mfma_f32_16x16x32_bf16 v[132:135], a[88:91], v[40:43], v[132:135]
  ds_read_b64_tr_b16 a[114:115], v11 offset:2048
  v_mfma_f32_16x16x32_bf16 v[132:135], a[92:95], v[44:47], v[132:135]
  v_mfma_f32_16x16x32_bf16 v[140:143], a[80:83], v[48:51], 0
  ds_read_b64_tr_b16 a[116:117], v11 offset:4096
  v_mfma_f32_16x16x32_bf16 v[140:143], a[84:87], v[52:55], v[140:143]
  v_mfma_f32_16x16x32_bf16 v[140:143], a[88:91], v[56:59], v[140:143]
  ds_read_b64_tr_b16 a[118:119], v11 offset:6144
  v_mfma_f32_16x16x32_bf16 v[140:143], a[92:95], v[60:63], v[140:143]
  v_mfma_f32_16x16x32_bf16 v[148:151], a[80:83], v[64:67], 0
  ds_read_b64_tr_b16 a[120:121], v11 offset:8192
  v_mfma_f32_16x16x32_bf16 v[148:151], a[84:87], v[68:71], v[148:151]
  v_mfma_f32_16x16x32_bf16 v[148:151], a[88:91], v[72:75], v[148:151]
  ds_read_b64_tr_b16 a[122:123], v11 offset:10240
  v_mfma_f32_16x16x32_bf16 v[148:151], a[92:95], v[76:79], v[148:151]
  v_mfma_f32_16x16x32_bf16 v[156:159], a[80:83], v[80:83], 0
  ds_read_b64_tr_b16 a[124:125], v11 offset:12288
  v_mfma_f32_16x16x32_bf16 v[156:159], a[84:87], v[84:87], v[156:159]
  v_mfma_f32_16x16x32_bf16 v[156:159], a[88:91], v[88:91], v[156:159]
  ds_read_b64_tr_b16 a[126:127], v11 offset:14336
  v_mfma_f32_16x16x32_bf16 v[156:159], a[92:95], v[92:95], v[156:159]
  s_waitcnt lgkmcnt(8)
  s_waitcnt vmcnt(0)
  s_mov_b64 exec, 1
  buffer_store_dword v16, v24, s[40:43], 0 offen sc1
  s_mov_b64 exec, -1
  v_mfma_f32_16x16x32_bf16 v[160:163], a[96:99], v[32:35], 0
  ds_read_b64_tr_b16 a[64:65], v8 offset:16384
  v_mfma_f32_16x16x32_bf16 v[160:163], a[100:103], v[36:39], v[160:163]
  v_mfma_f32_16x16x32_bf16 v[160:163], a[104:107], v[40:43], v[160:163]
  ds_read_b64_tr_b16 a[66:67], v8 offset:18432
  v_mfma_f32_16x16x32_bf16 v[160:163], a[108:111], v[44:47], v[160:163]
  v_mfma_f32_16x16x32_bf16 v[168:171], a[96:99], v[48:51], 0
  ds_read_b64_tr_b16 a[68:69], v8 offset:20480
  v_mfma_f32_16x16x32_bf16 v[168:171], a[100:103], v[52:55], v[168:171]
  v_mfma_f32_16x16x32_bf16 v[168:171], a[104:107], v[56:59], v[168:171]
  ds_read_b64_tr_b16 a[70:71], v8 offset:22528
  v_mfma_f32_16x16x32_bf16 v[168:171], a[108:111], v[60:63], v[168:171]
  v_mfma_f32_16x16x32_bf16 v[176:179], a[96:99], v[64:67], 0
  ds_read_b64_tr_b16 a[72:73], v8 offset:24576
  v_mfma_f32_16x16x32_bf16 v[176:179], a[100:103], v[68:71], v[176:179]
  v_mfma_f32_16x16x32_bf16 v[176:179], a[104:107], v[72:75], v[176:179]
  ds_read_b64_tr_b16 a[74:75], v8 offset:26624
  v_mfma_f32_16x16x32_bf16 v[176:179], a[108:111], v[76:79], v[176:179]
  v_mfma_f32_16x16x32_bf16 v[184:187], a[96:99], v[80:83], 0
  ds_read_b64_tr_b16 a[76:77], v8 offset:28672
  v_mfma_f32_16x16x32_bf16 v[184:187], a[100:103], v[84:87], v[184:187]
  v_mfma_f32_16x16x32_bf16 v[184:187], a[104:107], v[88:91], v[184:187]
  ds_read_b64_tr_b16 a[78:79], v8 offset:30720
  v_mfma_f32_16x16x32_bf16 v[184:187], a[108:111], v[92:95], v[184:187]
  s_waitcnt lgkmcnt(8)
  v_mfma_f32_16x16x32_bf16 v[164:167], a[112:115], v[32:35], 0
  ds_read_b64_tr_b16 a[80:81], v9 offset:16384
  v_mfma_f32_16x16x32_bf16 v[164:167], a[116:119], v[36:39], v[164:167]
  v_mfma_f32_16x16x32_bf16 v[164:167], a[120:123], v[40:43], v[164:167]
  ds_read_b64_tr_b16 a[82:83], v9 offset:18432
  v_mfma_f32_16x16x32_bf16 v[164:167], a[124:127], v[44:47], v[164:167]
  v_mfma_f32_16x16x32_bf16 v[172:175], a[112:115], v[48:51], 0
  ds_read_b64_tr_b16 a[84:85], v9 offset:20480
  v_mfma_f32_16x16x32_bf16 v[172:175], a[116:119], v[52:55], v[172:175]
  v_mfma_f32_16x16x32_bf16 v[172:175], a[120:123], v[56:59], v[172:175]
  ds_read_b64_tr_b16 a[86:87], v9 offset:22528
  v_mfma_f32_16x16x32_bf16 v[172:175], a[124:127], v[60:63], v[172:175]
  v_mfma_f32_16x16x32_bf16 v[180:183], a[112:115], v[64:67], 0
  ds_read_b64_tr_b16 a[88:89], v9 offset:24576
  v_mfma_f32_16x16x32_bf16 v[180:183], a[116:119], v[68:71], v[180:183]
  v_mfma_f32_16x16x32_bf16 v[180:183], a[120:123], v[72:75], v[180:183]
  ds_read_b64_tr_b16 a[90:91], v9 offset:26624
  v_mfma_f32_16x16x32_bf16 v[180:183], a[124:127], v[76:79], v[180:183]
  v_mfma_f32_16x16x32_bf16 v[188:191], a[112:115], v[80:83], 0
  ds_read_b64_tr_b16 a[92:93], v9 offset:28672
  v_mfma_f32_16x16x32_bf16 v[188:191], a[116:119], v[84:87], v[188:191]
  v_mfma_f32_16x16x32_bf16 v[188:191], a[120:123], v[88:91], v[188:191]
  ds_read_b64_tr_b16 a[94:95], v9 offset:30720
  v_mfma_f32_16x16x32_bf16 v[188:191], a[124:127], v[92:95], v[188:191]
  s_waitcnt lgkmcnt(8)
  v_mfma_f32_16x16x32_bf16 v[192:195], a[64:67], v[32:35], 0
  ds_read_b64_tr_b16 a[96:97], v10 offset:16384
  v_mfma_f32_16x16x32_bf16 v[192:195], a[68:71], v[36:39], v[192:195]
  v_mfma_f32_16x16x32_bf16 v[192:195], a[72:75], v[40:43], v[192:195]
  ds_read_b64_tr_b16 a[98:99], v10 offset:18432
  v_mfma_f32_16x16x32_bf16 v[192:195], a[76:79], v[44:47], v[192:195]
  v_mfma_f32_16x16x32_bf16 v[200:203], a[64:67], v[48:51], 0
  ds_read_b64_tr_b16 a[100:101], v10 offset:20480
  v_mfma_f32_16x16x32_bf16 v[200:203], a[68:71], v[52:55], v[200:203]
  v_mfma_f32_16x16x32_bf16 v[200:203], a[72:75], v[56:59], v[200:203]
  ds_read_b64_tr_b16 a[102:103], v10 offset:22528
  v_mfma_f32_16x16x32_bf16 v[200:203], a[76:79], v[60:63], v[200:203]
  v_mfma_f32_16x16x32_bf16 v[208:211], a[64:67], v[64:67], 0
  ds_read_b64_tr_b16 a[104:105], v10 offset:24576
  v_mfma_f32_16x16x32_bf16 v[208:211], a[68:71], v[68:71], v[208:211]
  v_mfma_f32_16x16x32_bf16 v[208:211], a[72:75], v[72:75], v[208:211]
  ds_read_b64_tr_b16 a[106:107], v10 offset:26624
  v_mfma_f32_16x16x32_bf16 v[208:211], a[76:79], v[76:79], v[208:211]
  v_mfma_f32_16x16x32_bf16 v[216:219], a[64:67], v[80:83], 0
  ds_read_b64_tr_b16 a[108:109], v10 offset:28672
  v_mfma_f32_16x16x32_bf16 v[216:219], a[68:71], v[84:87], v[216:219]
  v_mfma_f32_16x16x32_bf16 v[216:219], a[72:75], v[88:91], v[216:219]
  ds_read_b64_tr_b16 a[110:111], v10 offset:30720
  v_mfma_f32_16x16x32_bf16 v[216:219], a[76:79], v[92:95], v[216:219]
  s_waitcnt lgkmcnt(8)
  v_mfma_f32_16x16x32_bf16 v[196:199], a[80:83], v[32:35], 0
  ds_read_b64_tr_b16 a[112:113], v11 offset:16384
  v_mfma_f32_16x16x32_bf16 v[196:199], a[84:87], v[36:39], v[196:199]
  buffer_load_dword v6, v24, s[40:43], 0 offen sc1
  v_mfma_f32_16x16x32_bf16 v[196:199], a[88:91], v[40:43], v[196:199]
  ds_read_b64_tr_b16 a[114:115], v11 offset:18432
  v_mfma_f32_16x16x32_bf16 v[196:199], a[92:95], v[44:47], v[196:199]
  v_mfma_f32_16x16x32_bf16 v[204:207], a[80:83], v[48:51], 0
  ds_read_b64_tr_b16 a[116:117], v11 offset:20480
  v_mfma_f32_16x16x32_bf16 v[204:207], a[84:87], v[52:55], v[204:207]
  v_mfma_f32_16x16x32_bf16 v[204:207], a[88:91], v[56:59], v[204:207]
  ds_read_b64_tr_b16 a[118:119], v11 offset:22528
  v_mfma_f32_16x16x32_bf16 v[204:207], a[92:95], v[60:63], v[204:207]
  v_mfma_f32_16x16x32_bf16 v[212:215], a[80:83], v[64:67], 0
  ds_read_b64_tr_b16 a[120:121], v11 offset:24576
  v_mfma_f32_16x16x32_bf16 v[212:215], a[84:87], v[68:71], v[212:215]
  v_mfma_f32_16x16x32_bf16 v[212:215], a[88:91], v[72:75], v[212:215]
  ds_read_b64_tr_b16 a[122:123], v11 offset:26624
  v_mfma_f32_16x16x32_bf16 v[212:215], a[92:95], v[76:79], v[212:215]
  v_mfma_f32_16x16x32_bf16 v[220:223], a[80:83], v[80:83], 0
  ds_read_b64_tr_b16 a[124:125], v11 offset:28672
  v_mfma_f32_16x16x32_bf16 v[220:223], a[84:87], v[84:87], v[220:223]
  v_mfma_f32_16x16x32_bf16 v[220:223], a[88:91], v[88:91], v[220:223]
  ds_read_b64_tr_b16 a[126:127], v11 offset:30720
  v_mfma_f32_16x16x32_bf16 v[220:223], a[92:95], v[92:95], v[220:223]
  s_waitcnt lgkmcnt(8)
  v_mfma_f32_16x16x32_bf16 v[224:227], a[96:99], v[32:35], 0
  ds_read_b64_tr_b16 a[64:65], v8 offset:32768
  v_mfma_f32_16x16x32_bf16 v[224:227], a[100:103], v[36:39], v[224:227]
  v_mfma_f32_16x16x32_bf16 v[224:227], a[104:107], v[40:43], v[224:227]
  ds_read_b64_tr_b16 a[66:67], v8 offset:34816
  v_mfma_f32_16x16x32_bf16 v[224:227], a[108:111], v[44:47], v[224:227]
  v_mfma_f32_16x16x32_bf16 v[232:235], a[96:99], v[48:51], 0
  ds_read_b64_tr_b16 a[68:69], v8 offset:36864
  v_mfma_f32_16x16x32_bf16 v[232:235], a[100:103], v[52:55], v[232:235]
  v_mfma_f32_16x16x32_bf16 v[232:235], a[104:107], v[56:59], v[232:235]
  ds_read_b64_tr_b16 a[70:71], v8 offset:38912
  v_mfma_f32_16x16x32_bf16 v[232:235], a[108:111], v[60:63], v[232:235]
  v_mfma_f32_16x16x32_bf16 v[240:243], a[96:99], v[64:67], 0
  ds_read_b64_tr_b16 a[72:73], v8 offset:40960
  v_mfma_f32_16x16x32_bf16 v[240:243], a[100:103], v[68:71], v[240:243]
  v_mfma_f32_16x16x32_bf16 v[240:243], a[104:107], v[72:75], v[240:243]
  ds_read_b64_tr_b16 a[74:75], v8 offset:43008
  v_mfma_f32_16x16x32_bf16 v[240:243], a[108:111], v[76:79], v[240:243]
  v_mfma_f32_16x16x32_bf16 v[248:251], a[96:99], v[80:83], 0
  ds_read_b64_tr_b16 a[76:77], v8 offset:45056
  v_mfma_f32_16x16x32_bf16 v[248:251], a[100:103], v[84:87], v[248:251]
  v_mfma_f32_16x16x32_bf16 v[248:251], a[104:107], v[88:91], v[248:251]
  ds_read_b64_tr_b16 a[78:79], v8 offset:47104
  v_mfma_f32_16x16x32_bf16 v[248:251], a[108:111], v[92:95], v[248:251]
  s_waitcnt lgkmcnt(8)
  v_mfma_f32_16x16x32_bf16 v[228:231], a[112:115], v[32:35], 0
  ds_read_b64_tr_b16 a[80:81], v9 offset:32768
  v_mfma_f32_16x16x32_bf16 v[228:231], a[116:119], v[36:39], v[228:231]
  v_mfma_f32_16x16x32_bf16 v[228:231], a[120:123], v[40:43], v[228:231]
  ds_read_b64_tr_b16 a[82:83], v9 offset:34816
  v_mfma_f32_16x16x32_bf16 v[228:231], a[124:127], v[44:47], v[228:231]
  v_mfma_f32_16x16x32_bf16 v[236:239], a[112:115], v[48:51], 0
  ds_read_b64_tr_b16 a[84:85], v9 offset:36864
  v_mfma_f32_16x16x32_bf16 v[236:239], a[116:119], v[52:55], v[236:239]
  v_mfma_f32_16x16x32_bf16 v[236:239], a[120:123], v[56:59], v[236:239]
  ds_read_b64_tr_b16 a[86:87], v9 offset:38912
  v_mfma_f32_16x16x32_bf16 v[236:239], a[124:127], v[60:63], v[236:239]
  v_mfma_f32_16x16x32_bf16 v[244:247], a[112:115], v[64:67], 0
  ds_read_b64_tr_b16 a[88:89], v9 offset:40960
  v_mfma_f32_16x16x32_bf16 v[244:247], a[116:119], v[68:71], v[244:247]
  v_mfma_f32_16x16x32_bf16 v[244:247], a[120:123], v[72:75], v[244:247]
  ds_read_b64_tr_b16 a[90:91], v9 offset:43008
  v_mfma_f32_16x16x32_bf16 v[244:247], a[124:127], v[76:79], v[244:247]
  v_mfma_f32_16x16x32_bf16 v[252:255], a[112:115], v[80:83], 0
  ds_read_b64_tr_b16 a[92:93], v9 offset:45056
  v_mfma_f32_16x16x32_bf16 v[252:255], a[116:119], v[84:87], v[252:255]
  v_mfma_f32_16x16x32_bf16 v[252:255], a[120:123], v[88:91], v[252:255]
  ds_read_b64_tr_b16 a[94:95], v9 offset:47104
  v_mfma_f32_16x16x32_bf16 v[252:255], a[124:127], v[92:95], v[252:255]
  s_waitcnt lgkmcnt(8)
L_a_fw:
  s_waitcnt vmcnt(0)
  v_cmp_eq_u32 vcc, 0, v6
  s_cbranch_vccnz L_a_fspin
  s_xor_b32 s66, s75, 0x10000
  buffer_load_dwordx4 a[0:3], v2, s[40:43], s66 offen offset:0 sc1
  buffer_load_dwordx4 a[4:7], v2, s[40:43], s66 offen offset:1024 sc1
  buffer_load_dwordx4 a[8:11], v2, s[40:43], s66 offen offset:2048 sc1
  buffer_load_dwordx4 a[12:15], v2, s[40:43], s66 offen offset:3072 sc1
  s_xor_b32 s66, s75, 0x11000
  buffer_load_dwordx4 a[16:19], v2, s[40:43], s66 offen offset:0 sc1
  buffer_load_dwordx4 a[20:23], v2, s[40:43], s66 offen offset:1024 sc1
  buffer_load_dwordx4 a[24:27], v2, s[40:43], s66 offen offset:2048 sc1
  buffer_load_dwordx4 a[28:31], v2, s[40:43], s66 offen offset:3072 sc1
  s_xor_b32 s66, s75, 0x12000
  buffer_load_dwordx4 a[32:35], v2, s[40:43], s66 offen offset:0 sc1
  buffer_load_dwordx4 a[36:39], v2, s[40:43], s66 offen offset:1024 sc1
  buffer_load_dwordx4 a[40:43], v2, s[40:43], s66 offen offset:2048 sc1
  buffer_load_dwordx4 a[44:47], v2, s[40:43], s66 offen offset:3072 sc1
  s_xor_b32 s66, s75, 0x13000
  buffer_load_dwordx4 a[48:51], v2, s[40:43], s66 offen offset:0 sc1
  buffer_load_dwordx4 a[52:55], v2, s[40:43], s66 offen offset:1024 sc1
  buffer_load_dwordx4 a[56:59], v2, s[40:43], s66 offen offset:2048 sc1
  buffer_load_dwordx4 a[60:63], v2, s[40:43], s66 offen offset:3072 sc1
  s_waitcnt vmcnt(12)
  v_mfma_f32_16x16x32_bf16 v[128:131], a[64:67], a[0:3], v[128:131]
  ds_read_b64_tr_b16 a[96:97], v10 offset:32768
  v_mfma_f32_16x16x32_bf16 v[128:131], a[68:71], a[4:7], v[128:131]
  v_mfma_f32_16x16x32_bf16 v[128:131], a[72:75], a[8:11], v[128:131]
  ds_read_b64_tr_b16 a[98:99], v10 offset:34816
  v_mfma_f32_16x16x32_bf16 v[128:131], a[76:79], a[12:15], v[128:131]
  s_waitcnt vmcnt(8)
  v_mfma_f32_16x16x32_bf16 v[136:139], a[64:67], a[16:19], v[136:139]
  ds_read_b64_tr_b16 a[100:101], v10 offset:36864
  v_mfma_f32_16x16x32_bf16 v[136:139], a[68:71], a[20:23], v[136:139]
  v_mfma_f32_16x16x32_bf16 v[136:139], a[72:75], a[24:27], v[136:139]
  ds_read_b64_tr_b16 a[102:103], v10 offset:38912
  v_mfma_f32_16x16x32_bf16 v[136:139], a[76:79], a[28:31], v[136:139]
  s_waitcnt vmcnt(4)
  v_mfma_f32_16x16x32_bf16 v[144:147], a[64:67], a[32:35], v[144:147]
  ds_read_b64_tr_b16 a[104:105], v10 offset:40960
  v_mfma_f32_16x16x32_bf16 v[144:147], a[68:71], a[36:39], v[144:147]
  v_mfma_f32_16x16x32_bf16 v[144:147], a[72:75], a[40:43], v[144:147]
  ds_read_b64_tr_b16 a[106:107], v10 offset:43008
  v_mfma_f32_16x16x32_bf16 v[144:147], a[76:79], a[44:47], v[144:147]
  s_waitcnt vmcnt(0)
  v_mfma_f32_16x16x32_bf16 v[152:155], a[64:67], a[48:51], v[152:155]
  ds_read_b64_tr_b16 a[108:109], v10 offset:45056
  v_mfma_f32_16x16x32_bf16 v[152:155], a[68:71], a[52:55], v[152:155]
  v_mfma_f32_16x16x32_bf16 v[152:155], a[72:75], a[56:59], v[152:155]
  ds_read_b64_tr_b16 a[110:111], v10 offset:47104
  v_mfma_f32_16x16x32_bf16 v[152:155], a[76:79], a[60:63], v[152:155]
  s_waitcnt lgkmcnt(8)
  v_mfma_f32_16x16x32_bf16 v[132:135], a[80:83], a[0:3], v[132:135]
  ds_read_b64_tr_b16 a[112:113], v11 offset:32768
  v_mfma_f32_16x16x32_bf16 v[132:135], a[84:87], a[4:7], v[132:135]
  s_xor_b32 s66, s75, 0x20000
  buffer_load_dwordx4 a[128:131], v2, s[40:43], s66 offen offset:0 sc1
  v_mfma_f32_16x16x32_bf16 v[132:135], a[88:91], a[8:11], v[132:135]
  ds_read_b64_tr_b16 a[114:115], v11 offset:34816
  v_mfma_f32_16x16x32_bf16 v[132:135], a[92:95], a[12:15], v[132:135]
  v_mfma_f32_16x16x32_bf16 v[140:143], a[80:83], a[16:19], v[140:143]
  ds_read_b64_tr_b16 a[116:117], v11 offset:36864
  v_mfma_f32_16x16x32_bf16 v[140:143], a[84:87], a[20:23], v[140:143]
  v_mfma_f32_16x16x32_bf16 v[140:143], a[88:91], a[24:27], v[140:143]
  ds_read_b64_tr_b16 a[118:119], v11 offset:38912
  v_mfma_f32_16x16x32_bf16 v[140:143], a[92:95], a[28:31], v[140:143]
  buffer_load_dwordx4 a[132:135], v2, s[40:43], s66 offen offset:1024 sc1
  v_mfma_f32_16x16x32_bf16 v[148:151], a[80:83], a[32:35], v[148:151]
  ds_read_b64_tr_b16 a[120:121], v11 offset:40960
  v_mfma_f32_16x16x32_bf16 v[148:151], a[84:87], a[36:39], v[148:151]
  v_mfma_f32_16x16x32_bf16 v[148:151], a[88:91], a[40:43], v[148:151]
  ds_read_b64_tr_b16 a[122:123], v11 offset:43008
  v_mfma_f32_16x16x32_bf16 v[148:151], a[92:95], a[44:47], v[148:151]
  v_mfma_f32_16x16x32_bf16 v[156:159], a[80:83], a[48:51], v[156:159]
  ds_read_b64_tr_b16 a[124:125], v11 offset:45056
  v_mfma_f32_16x16x32_bf16 v[156:159], a[84:87], a[52:55], v[156:159]
  buffer_load_dwordx4 a[136:139], v2, s[40:43], s66 offen offset:2048 sc1
  v_mfma_f32_16x16x32_bf16 v[156:159], a[88:91], a[56:59], v[156:159]
  ds_read_b64_tr_b16 a[126:127], v11 offset:47104
  v_mfma_f32_16x16x32_bf16 v[156:159], a[92:95], a[60:63], v[156:159]
  s_waitcnt lgkmcnt(8)
  v_mfma_f32_16x16x32_bf16 v[160:163], a[96:99], a[0:3], v[160:163]
  ds_read_b64_tr_b16 a[64:65], v8 offset:49152
  v_mfma_f32_16x16x32_bf16 v[160:163], a[100:103], a[4:7], v[160:163]
  v_mfma_f32_16x16x32_bf16 v[160:163], a[104:107], a[8:11], v[160:163]
  ds_read_b64_tr_b16 a[66:67], v8 offset:51200
  v_mfma_f32_16x16x32_bf16 v[160:163], a[108:111], a[12:15], v[160:163]
  buffer_load_dwordx4 a[140:143], v2, s[40:43], s66 offen offset:3072 sc1
  v_mfma_f32_16x16x32_bf16 v[168:171], a[96:99], a[16:19], v[168:171]
  ds_read_b64_tr_b16 a[68:69], v8 offset:53248
  v_mfma_f32_16x16x32_bf16 v[168:171], a[100:103], a[20:23], v[168:171]
  v_mfma_f32_16x16x32_bf16 v[168:171], a[104:107], a[24:27], v[168:171]
  ds_read_b64_tr_b16 a[70:71], v8 offset:55296
  v_mfma_f32_16x16x32_bf16 v[168:171], a[108:111], a[28:31], v[168:171]
  v_mfma_f32_16x16x32_bf16 v[176:179], a[96:99], a[32:35], v[176:179]
  ds_read_b64_tr_b16 a[72:73], v8 offset:57344
  v_mfma_f32_16x16x32_bf16 v[176:179], a[100:103], a[36:39], v[176:179]
  s_xor_b32 s66, s75, 0x21000
  buffer_load_dwordx4 a[144:147], v2, s[40:43], s66 offen offset:0 sc1
  v_mfma_f32_16x16x32_bf16 v[176:179], a[104:107], a[40:43], v[176:179]
  ds_read_b64_tr_b16 a[74:75], v8 offset:59392
  v_mfma_f32_16x16x32_bf16 v[176:179], a[108:111], a[44:47], v[176:179]
  v_mfma_f32_16x16x32_bf16 v[184:187], a[96:99], a[48:51], v[184:187]
  ds_read_b64_tr_b16 a[76:77], v8 offset:61440
  v_mfma_f32_16x16x32_bf16 v[184:187], a[100:103], a[52:55], v[184:187]
  v_mfma_f32_16x16x32_bf16 v[184:187], a[104:107], a[56:59], v[184:187]
  ds_read_b64_tr_b16 a[78:79], v8 offset:63488
  v_mfma_f32_16x16x32_bf16 v[184:187], a[108:111], a[60:63], v[184:187]
  s_waitcnt lgkmcnt(8)
  buffer_load_dwordx4 a[148:151], v2, s[40:43], s66 offen offset:1024 sc1
  v_mfma_f32_16x16x32_bf16 v[164:167], a[112:115], a[0:3], v[164:167]
  ds_read_b64_tr_b16 a[80:81], v9 offset:49152
  v_mfma_f32_16x16x32_bf16 v[164:167], a[116:119], a[4:7], v[164:167]
  v_mfma_f32_16x16x32_bf16 v[164:167], a[120:123], a[8:11], v[164:167]
  ds_read_b64_tr_b16 a[82:83], v9 offset:51200
  v_mfma_f32_16x16x32_bf16 v[164:167], a[124:127], a[12:15], v[164:167]
  v_mfma_f32_16x16x32_bf16 v[172:175], a[112:115], a[16:19], v[172:175]
  ds_read_b64_tr_b16 a[84:85], v9 offset:53248
  v_mfma_f32_16x16x32_bf16 v[172:175], a[116:119], a[20:23], v[172:175]
  buffer_load_dwordx4 a[152:155], v2, s[40:43], s66 offen offset:2048 sc1
  v_mfma_f32_16x16x32_bf16 v[172:175], a[120:123], a[24:27], v[172:175]
  ds_read_b64_tr_b16 a[86:87], v9 offset:55296
  v_mfma_f32_16x16x32_bf16 v[172:175], a[124:127], a[28:31], v[172:175]
  v_mfma_f32_16x16x32_bf16 v[180:183], a[112:115], a[32:35], v[180:183]
  ds_read_b64_tr_b16 a[88:89], v9 offset:57344
  v_mfma_f32_16x16x32_bf16 v[180:183], a[116:119], a[36:39], v[180:183]
  v_mfma_f32_16x16x32_bf16 v[180:183], a[120:123], a[40:43], v[180:183]
  ds_read_b64_tr_b16 a[90:91], v9 offset:59392
  v_mfma_f32_16x16x32_bf16 v[180:183], a[124:127], a[44:47], v[180:183]
  buffer_load_dwordx4 a[156:159], v2, s[40:43], s66 offen offset:3072 sc1
  v_mfma_f32_16x16x32_bf16 v[188:191], a[112:115], a[48:51], v[188:191]
  ds_read_b64_tr_b16 a[92:93], v9 offset:61440
  v_mfma_f32_16x16x32_bf16 v[188:191], a[116:119], a[52:55], v[188:191]
  v_mfma_f32_16x16x32_bf16 v[188:191], a[120:123], a[56:59], v[188:191]
  ds_read_b64_tr_b16 a[94:95], v9 offset:63488
  v_mfma_f32_16x16x32_bf16 v[188:191], a[124:127], a[60:63], v[188:191]
  s_waitcnt lgkmcnt(8)
  v_mfma_f32_16x16x32_bf16 v[192:195], a[64:67], a[0:3], v[192:195]
  ds_read_b64_tr_b16 a[96:97], v10 offset:49152
  v_mfma_f32_16x16x32_bf16 v[192:195], a[68:71], a[4:7], v[192:195]
  s_xor_b32 s66, s75, 0x22000
  buffer_load_dwordx4 a[160:163], v2, s[40:43], s66 offen offset:0 sc1
  v_mfma_f32_16x16x32_bf16 v[192:195], a[72:75], a[8:11], v[192:195]
  ds_read_b64_tr_b16 a[98:99], v10 offset:51200
  v_mfma_f32_16x16x32_bf16 v[192:195], a[76:79], a[12:15], v[192:195]
  v_mfma_f32_16x16x32_bf16 v[200:203], a[64:67], a[16:19], v[200:203]
  ds_read_b64_tr_b16 a[100:101], v10 offset:53248
  v_mfma_f32_16x16x32_bf16 v[200:203], a[68:71], a[20:23], v[200:203]
  v_mfma_f32_16x16x32_bf16 v[200:203], a[72:75], a[24:27], v[200:203]
  ds_read_b64_tr_b16 a[102:103], v10 offset:55296
  v_mfma_f32_16x16x32_bf16 v[200:203], a[76:79], a[28:31], v[200:203]
  buffer_load_dwordx4 a[164:167], v2, s[40:43], s66 offen offset:1024 sc1
  v_mfma_f32_16x16x32_bf16 v[208:211], a[64:67], a[32:35], v[208:211]
  ds_read_b64_tr_b16 a[104:105], v10 offset:57344
  v_mfma_f32_16x16x32_bf16 v[208:211], a[68:71], a[36:39], v[208:211]
  v_mfma_f32_16x16x32_bf16 v[208:211], a[72:75], a[40:43], v[208:211]
  ds_read_b64_tr_b16 a[106:107], v10 offset:59392
  v_mfma_f32_16x16x32_bf16 v[208:211], a[76:79], a[44:47], v[208:211]
  v_mfma_f32_16x16x32_bf16 v[216:219], a[64:67], a[48:51], v[216:219]
  ds_read_b64_tr_b16 a[108:109], v10 offset:61440
  v_mfma_f32_16x16x32_bf16 v[216:219], a[68:71], a[52:55], v[216:219]
  buffer_load_dwordx4 a[168:171], v2, s[40:43], s66 offen offset:2048 sc1
  v_mfma_f32_16x16x32_bf16 v[216:219], a[72:75], a[56:59], v[216:219]
  ds_read_b64_tr_b16 a[110:111], v10 offset:63488
  v_mfma_f32_16x16x32_bf16 v[216:219], a[76:79], a[60:63], v[216:219]
  s_waitcnt lgkmcnt(8)
  v_mfma_f32_16x16x32_bf16 v[196:199], a[80:83], a[0:3], v[196:199]
  ds_read_b64_tr_b16 a[112:113], v11 offset:49152
  v_mfma_f32_16x16x32_bf16 v[196:199], a[84:87], a[4:7], v[196:199]
  v_mfma_f32_16x16x32_bf16 v[196:199], a[88:91], a[8:11], v[196:199]
  ds_read_b64_tr_b16 a[114:115], v11 offset:51200
  v_mfma_f32_16x16x32_bf16 v[196:199], a[92:95], a[12:15], v[196:199]
  buffer_load_dwordx4 a[172:175], v2, s[40:43], s66 offen offset:3072 sc1
  v_mfma_f32_16x16x32_bf16 v[204:207], a[80:83], a[16:19], v[204:207]
  ds_read_b64_tr_b16 a[116:117], v11 offset:53248
  v_mfma_f32_16x16x32_bf16 v[204:207], a[84:87], a[20:23], v[204:207]
  v_mfma_f32_16x16x32_bf16 v[204:207], a[88:91], a[24:27], v[204:207]
  ds_read_b64_tr_b16 a[118:119], v11 offset:55296
  v_mfma_f32_16x16x32_bf16 v[204:207], a[92:95], a[28:31], v[204:207]
  v_mfma_f32_16x16x32_bf16 v[212:215], a[80:83], a[32:35], v[212:215]
  ds_read_b64_tr_b16 a[120:121], v11 offset:57344
  v_mfma_f32_16x16x32_bf16 v[212:215], a[84:87], a[36:39], v[212:215]
  s_xor_b32 s66, s75, 0x23000
  buffer_load_dwordx4 a[176:179], v2, s[40:43], s66 offen offset:0 sc1
  v_mfma_f32_16x16x32_bf16 v[212:215], a[88:91], a[40:43], v[212:215]
  ds_read_b64_tr_b16 a[122:123], v11 offset:59392
  v_mfma_f32_16x16x32_bf16 v[212:215], a[92:95], a[44:47], v[212:215]
  v_mfma_f32_16x16x32_bf16 v[220:223], a[80:83], a[48:51], v[220:223]
  ds_read_b64_tr_b16 a[124:125], v11 offset:61440
  v_mfma_f32_16x16x32_bf16 v[220:223], a[84:87], a[52:55], v[220:223]
  v_mfma_f32_16x16x32_bf16 v[220:223], a[88:91], a[56:59], v[220:223]
  ds_read_b64_tr_b16 a[126:127], v11 offset:63488
  v_mfma_f32_16x16x32_bf16 v[220:223], a[92:95], a[60:63], v[220:223]
  s_waitcnt lgkmcnt(8)
  buffer_load_dwordx4 a[180:183], v2, s[40:43], s66 offen offset:1024 sc1
  v_mfma_f32_16x16x32_bf16 v[224:227], a[96:99], a[0:3], v[224:227]
  ds_read_b64_tr_b16 a[64:65], v12 offset:0
  v_mfma_f32_16x16x32_bf16 v[224:227], a[100:103], a[4:7], v[224:227]
  v_mfma_f32_16x16x32_bf16 v[224:227], a[104:107], a[8:11], v[224:227]
  ds_read_b64_tr_b16 a[66:67], v12 offset:2048
  v_mfma_f32_16x16x32_bf16 v[224:227], a[108:111], a[12:15], v[224:227]
  v_mfma_f32_16x16x32_bf16 v[232:235], a[96:99], a[16:19], v[232:235]
  ds_read_b64_tr_b16 a[68:69], v12 offset:4096
  v_mfma_f32_16x16x32_bf16 v[232:235], a[100:103], a[20:23], v[232:235]
  buffer_load_dwordx4 a[184:187], v2, s[40:43], s66 offen offset:2048 sc1
  v_mfma_f32_16x16x32_bf16 v[232:235], a[104:107], a[24:27], v[232:235]
  ds_read_b64_tr_b16 a[70:71], v12 offset:6144
  v_mfma_f32_16x16x32_bf16 v[232:235], a[108:111], a[28:31], v[232:235]
  v_mfma_f32_16x16x32_bf16 v[240:243], a[96:99], a[32:35], v[240:243]
  ds_read_b64_tr_b16 a[72:73], v12 offset:8192
  v_mfma_f32_16x16x32_bf16 v[240:243], a[100:103], a[36:39], v[240:243]
  v_mfma_f32_16x16x32_bf16 v[240:243], a[104:107], a[40:43], v[240:243]
  ds_read_b64_tr_b16 a[74:75], v12 offset:10240
  v_mfma_f32_16x16x32_bf16 v[240:243], a[108:111], a[44:47], v[240:243]
  buffer_load_dwordx4 a[188:191], v2, s[40:43], s66 offen offset:3072 sc1
  v_mfma_f32_16x16x32_bf16 v[248:251], a[96:99], a[48:51], v[248:251]
  ds_read_b64_tr_b16 a[76:77], v12 offset:12288
  v_mfma_f32_16x16x32_bf16 v[248:251], a[100:103], a[52:55], v[248:251]
  v_mfma_f32_16x16x32_bf16 v[248:251], a[104:107], a[56:59], v[248:251]
  ds_read_b64_tr_b16 a[78:79], v12 offset:14336
  v_mfma_f32_16x16x32_bf16 v[248:251], a[108:111], a[60:63], v[248:251]
  s_waitcnt lgkmcnt(8)
  v_mfma_f32_16x16x32_bf16 v[228:231], a[112:115], a[0:3], v[228:231]
  ds_read_b64_tr_b16 a[80:81], v13 offset:0
  v_mfma_f32_16x16x32_bf16 v[228:231], a[116:119], a[4:7], v[228:231]
  v_mfma_f32_16x16x32_bf16 v[228:231], a[120:123], a[8:11], v[228:231]
  ds_read_b64_tr_b16 a[82:83], v13 offset:2048
  v_mfma_f32_16x16x32_bf16 v[228:231], a[124:127], a[12:15], v[228:231]
  v_mfma_f32_16x16x32_bf16 v[236:239], a[112:115], a[16:19], v[236:239]
  ds_read_b64_tr_b16 a[84:85], v13 offset:4096
  v_mfma_f32_16x16x32_bf16 v[236:239], a[116:119], a[20:23], v[236:239]
  v_mfma_f32_16x16x32_bf16 v[236:239], a[120:123], a[24:27], v[236:239]
  ds_read_b64_tr_b16 a[86:87], v13 offset:6144
  v_mfma_f32_16x16x32_bf16 v[236:239], a[124:127], a[28:31], v[236:239]
  v_mfma_f32_16x16x32_bf16 v[244:247], a[112:115], a[32:35], v[244:247]
  ds_read_b64_tr_b16 a[88:89], v13 offset:8192
  v_mfma_f32_16x16x32_bf16 v[244:247], a[116:119], a[36:39], v[244:247]
  v_mfma_f32_16x16x32_bf16 v[244:247], a[120:123], a[40:43], v[244:247]
  ds_read_b64_tr_b16 a[90:91], v13 offset:10240
  v_mfma_f32_16x16x32_bf16 v[244:247], a[124:127], a[44:47], v[244:247]
  v_mfma_f32_16x16x32_bf16 v[252:255], a[112:115], a[48:51], v[252:255]
  ds_read_b64_tr_b16 a[92:93], v13 offset:12288
  v_mfma_f32_16x16x32_bf16 v[252:255], a[116:119], a[52:55], v[252:255]
  v_mfma_f32_16x16x32_bf16 v[252:255], a[120:123], a[56:59], v[252:255]
  ds_read_b64_tr_b16 a[94:95], v13 offset:14336
  v_mfma_f32_16x16x32_bf16 v[252:255], a[124:127], a[60:63], v[252:255]
  s_waitcnt lgkmcnt(8)
  s_waitcnt vmcnt(12)
  v_mfma_f32_16x16x32_bf16 v[128:131], a[64:67], a[128:131], v[128:131]
  ds_read_b64_tr_b16 a[96:97], v14 offset:0
  v_mfma_f32_16x16x32_bf16 v[128:131], a[68:71], a[132:135], v[128:131]
  s_xor_b32 s66, s75, 0x30000
  buffer_load_dwordx4 a[192:195], v2, s[40:43], s66 offen offset:0 sc1
  v_mfma_f32_16x16x32_bf16 v[128:131], a[72:75], a[136:139], v[128:131]
  ds_read_b64_tr_b16 a[98:99], v14 offset:2048
  v_mfma_f32_16x16x32_bf16 v[128:131], a[76:79], a[140:143], v[128:131]
  s_waitcnt vmcnt(9)
  v_mfma_f32_16x16x32_bf16 v[136:139], a[64:67], a[144:147], v[136:139]
  ds_read_b64_tr_b16 a[100:101], v14 offset:4096
  v_mfma_f32_16x16x32_bf16 v[136:139], a[68:71], a[148:151], v[136:139]
  v_mfma_f32_16x16x32_bf16 v[136:139], a[72:75], a[152:155], v[136:139]
  ds_read_b64_tr_b16 a[102:103], v14 offset:6144
  v_mfma_f32_16x16x32_bf16 v[136:139], a[76:79], a[156:159], v[136:139]
  buffer_load_dwordx4 a[196:199], v2, s[40:43], s66 offen offset:1024 sc1
  s_waitcnt vmcnt(6)
  v_mfma_f32_16x16x32_bf16 v[144:147], a[64:67], a[160:163], v[144:147]
  ds_read_b64_tr_b16 a[104:105], v14 offset:8192
  v_mfma_f32_16x16x32_bf16 v[144:147], a[68:71], a[164:167], v[144:147]
  v_mfma_f32_16x16x32_bf16 v[144:147], a[72:75], a[168:171], v[144:147]
  ds_read_b64_tr_b16 a[106:107], v14 offset:10240
  v_mfma_f32_16x16x32_bf16 v[144:147], a[76:79], a[172:175], v[144:147]
  s_waitcnt vmcnt(2)
  v_mfma_f32_16x16x32_bf16 v[152:155], a[64:67], a[176:179], v[152:155]
  ds_read_b64_tr_b16 a[108:109], v14 offset:12288
  v_mfma_f32_16x16x32_bf16 v[152:155], a[68:71], a[180:183], v[152:155]
  buffer_load_dwordx4 a[200:203], v2, s[40:43], s66 offen offset:2048 sc1
  v_mfma_f32_16x16x32_bf16 v[152:155], a[72:75], a[184:187], v[152:155]
  ds_read_b64_tr_b16 a[110:111], v14 offset:14336
  v_mfma_f32_16x16x32_bf16 v[152:155], a[76:79], a[188:191], v[152:155]
  s_waitcnt lgkmcnt(8)
  v_mfma_f32_16x16x32_bf16 v[132:135], a[80:83], a[128:131], v[132:135]
  ds_read_b64_tr_b16 a[112:113], v15 offset:0
  v_mfma_f32_16x16x32_bf16 v[132:135], a[84:87], a[132:135], v[132:135]
  v_mfma_f32_16x16x32_bf16 v[132:135], a[88:91], a[136:139], v[132:135]
  ds_read_b64_tr_b16 a[114:115], v15 offset:2048
  v_mfma_f32_16x16x32_bf16 v[132:135], a[92:95], a[140:143], v[132:135]
  buffer_load_dwordx4 a[204:207], v2, s[40:43], s66 offen offset:3072 sc1
  v_mfma_f32_16x16x32_bf16 v[140:143], a[80:83], a[144:147], v[140:143]
  ds_read_b64_tr_b16 a[116:117], v15 offset:4096
  v_mfma_f32_16x16x32_bf16 v[140:143], a[84:87], a[148:151], v[140:143]
  v_mfma_f32_16x16x32_bf16 v[140:143], a[88:91], a[152:155], v[140:143]
  ds_read_b64_tr_b16 a[118:119], v15 offset:6144
  v_mfma_f32_16x16x32_bf16 v[140:143], a[92:95], a[156:159], v[140:143]
  v_mfma_f32_16x16x32_bf16 v[148:151], a[80:83], a[160:163], v[148:151]
  ds_read_b64_tr_b16 a[120:121], v15 offset:8192
  v_mfma_f32_16x16x32_bf16 v[148:151], a[84:87], a[164:167], v[148:151]
  s_xor_b32 s66, s75, 0x31000
  buffer_load_dwordx4 a[208:211], v2, s[40:43], s66 offen offset:0 sc1
  v_mfma_f32_16x16x32_bf16 v[148:151], a[88:91], a[168:171], v[148:151]
  ds_read_b64_tr_b16 a[122:123], v15 offset:10240
  v_mfma_f32_16x16x32_bf16 v[148:151], a[92:95], a[172:175], v[148:151]
  v_mfma_f32_16x16x32_bf16 v[156:159], a[80:83], a[176:179], v[156:159]
  ds_read_b64_tr_b16 a[124:125], v15 offset:12288
  v_mfma_f32_16x16x32_bf16 v[156:159], a[84:87], a[180:183], v[156:159]
  v_mfma_f32_16x16x32_bf16 v[156:159], a[88:91], a[184:187], v[156:159]
  ds_read_b64_tr_b16 a[126:127], v15 offset:14336
  v_mfma_f32_16x16x32_bf16 v[156:159], a[92:95], a[188:191], v[156:159]
  s_waitcnt lgkmcnt(8)
  buffer_load_dwordx4 a[212:215], v2, s[40:43], s66 offen offset:1024 sc1
  v_mfma_f32_16x16x32_bf16 v[160:163], a[96:99], a[128:131], v[160:163]
  ds_read_b64_tr_b16 a[64:65], v12 offset:16384
  v_mfma_f32_16x16x32_bf16 v[160:163], a[100:103], a[132:135], v[160:163]
  v_mfma_f32_16x16x32_bf16 v[160:163], a[104:107], a[136:139], v[160:163]
  ds_read_b64_tr_b16 a[66:67], v12 offset:18432
  v_mfma_f32_16x16x32_bf16 v[160:163], a[108:111], a[140:143], v[160:163]
  v_mfma_f32_16x16x32_bf16 v[168:171], a[96:99], a[144:147], v[168:171]
  ds_read_b64_tr_b16 a[68:69], v12 offset:20480
  v_mfma_f32_16x16x32_bf16 v[168:171], a[100:103], a[148:151], v[168:171]
  buffer_load_dwordx4 a[216:219], v2, s[40:43], s66 offen offset:2048 sc1
  v_mfma_f32_16x16x32_bf16 v[168:171], a[104:107], a[152:155], v[168:171]
  ds_read_b64_tr_b16 a[70:71], v12 offset:22528
  v_mfma_f32_16x16x32_bf16 v[168:171], a[108:111], a[156:159], v[168:171]
  v_mfma_f32_16x16x32_bf16 v[176:179], a[96:99], a[160:163], v[176:179]
  ds_read_b64_tr_b16 a[72:73], v12 offset:24576
  v_mfma_f32_16x16x32_bf16 v[176:179], a[100:103], a[164:167], v[176:179]
  v_mfma_f32_16x16x32_bf16 v[176:179], a[104:107], a[168:171], v[176:179]
  ds_read_b64_tr_b16 a[74:75], v12 offset:26624
  v_mfma_f32_16x16x32_bf16 v[176:179], a[108:111], a[172:175], v[176:179]
  buffer_load_dwordx4 a[220:223], v2, s[40:43], s66 offen offset:3072 sc1
  v_mfma_f32_16x16x32_bf16 v[184:187], a[96:99], a[176:179], v[184:187]
  ds_read_b64_tr_b16 a[76:77], v12 offset:28672
  v_mfma_f32_16x16x32_bf16 v[184:187], a[100:103], a[180:183], v[184:187]
  v_mfma_f32_16x16x32_bf16 v[184:187], a[104:107], a[184:187], v[184:187]
  ds_read_b64_tr_b16 a[78:79], v12 offset:30720
  v_mfma_f32_16x16x32_bf16 v[184:187], a[108:111], a[188:191], v[184:187]
  s_waitcnt lgkmcnt(8)
  v_mfma_f32_16x16x32_bf16 v[164:167], a[112:115], a[128:131], v[164:167]
  ds_read_b64_tr_b16 a[80:81], v13 offset:16384
  v_mfma_f32_16x16x32_bf16 v[164:167], a[116:119], a[132:135], v[164:167]
  s_xor_b32 s66, s75, 0x32000
  buffer_load_dwordx4 a[224:227], v2, s[40:43], s66 offen offset:0 sc1
  v_mfma_f32_16x16x32_bf16 v[164:167], a[120:123], a[136:139], v[164:167]
  ds_read_b64_tr_b16 a[82:83], v13 offset:18432
  v_mfma_f32_16x16x32_bf16 v[164:167], a[124:127], a[140:143], v[164:167]
  v_mfma_f32_16x16x32_bf16 v[172:175], a[112:115], a[144:147], v[172:175]
  ds_read_b64_tr_b16 a[84:85], v13 offset:20480
  v_mfma_f32_16x16x32_bf16 v[172:175], a[116:119], a[148:151], v[172:175]
  v_mfma_f32_16x16x32_bf16 v[172:175], a[120:123], a[152:155], v[172:175]
  ds_read_b64_tr_b16 a[86:87], v13 offset:22528
  v_mfma_f32_16x16x32_bf16 v[172:175], a[124:127], a[156:159], v[172:175]
  buffer_load_dwordx4 a[228:231], v2, s[40:43], s66 offen offset:1024 sc1
  v_mfma_f32_16x16x32_bf16 v[180:183], a[112:115], a[160:163], v[180:183]
  ds_read_b64_tr_b16 a[88:89], v13 offset:24576
  v_mfma_f32_16x16x32_bf16 v[180:183], a[116:119], a[164:167], v[180:183]
  v_mfma_f32_16x16x32_bf16 v[180:183], a[120:123], a[168:171], v[180:183]
  ds_read_b64_tr_b16 a[90:91], v13 offset:26624
  v_mfma_f32_16x16x32_bf16 v[180:183], a[124:127], a[172:175], v[180:183]
  v_mfma_f32_16x16x32_bf16 v[188:191], a[112:115], a[176:179], v[188:191]
  ds_read_b64_tr_b16 a[92:93], v13 offset:28672
  v_mfma_f32_16x16x32_bf16 v[188:191], a[116:119], a[180:183], v[188:191]
  buffer_load_dwordx4 a[232:235], v2, s[40:43], s66 offen offset:2048 sc1
  v_mfma_f32_16x16x32_bf16 v[188:191], a[120:123], a[184:187], v[188:191]
  ds_read_b64_tr_b16 a[94:95], v13 offset:30720
  v_mfma_f32_16x16x32_bf16 v[188:191], a[124:127], a[188:191], v[188:191]
  s_waitcnt lgkmcnt(8)
  v_mfma_f32_16x16x32_bf16 v[192:195], a[64:67], a[128:131], v[192:195]
  ds_read_b64_tr_b16 a[96:97], v14 offset:16384
  v_mfma_f32_16x16x32_bf16 v[192:195], a[68:71], a[132:135], v[192:195]
  v_mfma_f32_16x16x32_bf16 v[192:195], a[72:75], a[136:139], v[192:195]
  ds_read_b64_tr_b16 a[98:99], v14 offset:18432
  v_mfma_f32_16x16x32_bf16 v[192:195], a[76:79], a[140:143], v[192:195]
  buffer_load_dwordx4 a[236:239], v2, s[40:43], s66 offen offset:3072 sc1
  v_mfma_f32_16x16x32_bf16 v[200:203], a[64:67], a[144:147], v[200:203]
  ds_read_b64_tr_b16 a[100:101], v14 offset:20480
  v_mfma_f32_16x16x32_bf16 v[200:203], a[68:71], a[148:151], v[200:203]
  v_mfma_f32_16x16x32_bf16 v[200:203], a[72:75], a[152:155], v[200:203]
  ds_read_b64_tr_b16 a[102:103], v14 offset:22528
  v_mfma_f32_16x16x32_bf16 v[200:203], a[76:79], a[156:159], v[200:203]
  v_mfma_f32_16x16x32_bf16 v[208:211], a[64:67], a[160:163], v[208:211]
  ds_read_b64_tr_b16 a[104:105], v14 offset:24576
  v_mfma_f32_16x16x32_bf16 v[208:211], a[68:71], a[164:167], v[208:211]
  s_xor_b32 s66, s75, 0x33000
  buffer_load_dwordx4 a[240:243], v2, s[40:43], s66 offen offset:0 sc1
  v_mfma_f32_16x16x32_bf16 v[208:211], a[72:75], a[168:171], v[208:211]
  ds_read_b64_tr_b16 a[106:107], v14 offset:26624
  v_mfma_f32_16x16x32_bf16 v[208:211], a[76:79], a[172:175], v[208:211]
  v_mfma_f32_16x16x32_bf16 v[216:219], a[64:67], a[176:179], v[216:219]
  ds_read_b64_tr_b16 a[108:109], v14 offset:28672
  v_mfma_f32_16x16x32_bf16 v[216:219], a[68:71], a[180:183], v[216:219]
  v_mfma_f32_16x16x32_bf16 v[216:219], a[72:75], a[184:187], v[216:219]
  ds_read_b64_tr_b16 a[110:111], v14 offset:30720
  v_mfma_f32_16x16x32_bf16 v[216:219], a[76:79], a[188:191], v[216:219]
  s_waitcnt lgkmcnt(8)
  buffer_load_dwordx4 a[244:247], v2, s[40:43], s66 offen offset:1024 sc1
  v_mfma_f32_16x16x32_bf16 v[196:199], a[80:83], a[128:131], v[196:199]
  ds_read_b64_tr_b16 a[112:113], v15 offset:16384
  v_mfma_f32_16x16x32_bf16 v[196:199], a[84:87], a[132:135], v[196:199]
  v_mfma_f32_16x16x32_bf16 v[196:199], a[88:91], a[136:139], v[196:199]
  ds_read_b64_tr_b16 a[114:115], v15 offset:18432
  v_mfma_f32_16x16x32_bf16 v[196:199], a[92:95], a[140:143], v[196:199]
  v_mfma_f32_16x16x32_bf16 v[204:207], a[80:83], a[144:147], v[204:207]
  ds_read_b64_tr_b16 a[116:117], v15 offset:20480
  v_mfma_f32_16x16x32_bf16 v[204:207], a[84:87], a[148:151], v[204:207]
  buffer_load_dwordx4 a[248:251], v2, s[40:43], s66 offen offset:2048 sc1
  v_mfma_f32_16x16x32_bf16 v[204:207], a[88:91], a[152:155], v[204:207]
  ds_read_b64_tr_b16 a[118:119], v15 offset:22528
  v_mfma_f32_16x16x32_bf16 v[204:207], a[92:95], a[156:159], v[204:207]
  v_mfma_f32_16x16x32_bf16 v[212:215], a[80:83], a[160:163], v[212:215]
  ds_read_b64_tr_b16 a[120:121], v15 offset:24576
  v_mfma_f32_16x16x32_bf16 v[212:215], a[84:87], a[164:167], v[212:215]
  v_mfma_f32_16x16x32_bf16 v[212:215], a[88:91], a[168:171], v[212:215]
  ds_read_b64_tr_b16 a[122:123], v15 offset:26624
  v_mfma_f32_16x16x32_bf16 v[212:215], a[92:95], a[172:175], v[212:215]
  buffer_load_dwordx4 a[252:255], v2, s[40:43], s66 offen offset:3072 sc1
  v_mfma_f32_16x16x32_bf16 v[220:223], a[80:83], a[176:179], v[220:223]
  ds_read_b64_tr_b16 a[124:125], v15 offset:28672
  v_mfma_f32_16x16x32_bf16 v[220:223], a[84:87], a[180:183], v[220:223]
  v_mfma_f32_16x16x32_bf16 v[220:223], a[88:91], a[184:187], v[220:223]
  ds_read_b64_tr_b16 a[126:127], v15 offset:30720
  v_mfma_f32_16x16x32_bf16 v[220:223], a[92:95], a[188:191], v[220:223]
  s_waitcnt lgkmcnt(8)
  v_mfma_f32_16x16x32_bf16 v[224:227], a[96:99], a[128:131], v[224:227]
  ds_read_b64_tr_b16 a[64:65], v12 offset:32768
  v_mfma_f32_16x16x32_bf16 v[224:227], a[100:103], a[132:135], v[224:227]
  v_mfma_f32_16x16x32_bf16 v[224:227], a[104:107], a[136:139], v[224:227]
  ds_read_b64_tr_b16 a[66:67], v12 offset:34816
  v_mfma_f32_16x16x32_bf16 v[224:227], a[108:111], a[140:143], v[224:227]
  v_mfma_f32_16x16x32_bf16 v[232:235], a[96:99], a[144:147], v[232:235]
  ds_read_b64_tr_b16 a[68:69], v12 offset:36864
  v_mfma_f32_16x16x32_bf16 v[232:235], a[100:103], a[148:151], v[232:235]
  v_mfma_f32_16x16x32_bf16 v[232:235], a[104:107], a[152:155], v[232:235]
  ds_read_b64_tr_b16 a[70:71], v12 offset:38912
  v_mfma_f32_16x16x32_bf16 v[232:235], a[108:111], a[156:159], v[232:235]
  v_mfma_f32_16x16x32_bf16 v[240:243], a[96:99], a[160:163], v[240:243]
  ds_read_b64_tr_b16 a[72:73], v12 offset:40960
  v_mfma_f32_16x16x32_bf16 v[240:243], a[100:103], a[164:167], v[240:243]
  v_mfma_f32_16x16x32_bf16 v[240:243], a[104:107], a[168:171], v[240:243]
  ds_read_b64_tr_b16 a[74:75], v12 offset:43008
  v_mfma_f32_16x16x32_bf16 v[240:243], a[108:111], a[172:175], v[240:243]
  v_mfma_f32_16x16x32_bf16 v[248:251], a[96:99], a[176:179], v[248:251]
  ds_read_b64_tr_b16 a[76:77], v12 offset:45056
  v_mfma_f32_16x16x32_bf16 v[248:251], a[100:103], a[180:183], v[248:251]
  v_mfma_f32_16x16x32_bf16 v[248:251], a[104:107], a[184:187], v[248:251]
  ds_read_b64_tr_b16 a[78:79], v12 offset:47104
  v_mfma_f32_16x16x32_bf16 v[248:251], a[108:111], a[188:191], v[248:251]
  s_waitcnt lgkmcnt(8)
  v_mfma_f32_16x16x32_bf16 v[228:231], a[112:115], a[128:131], v[228:231]
  ds_read_b64_tr_b16 a[80:81], v13 offset:32768
  v_mfma_f32_16x16x32_bf16 v[228:231], a[116:119], a[132:135], v[228:231]
  v_mfma_f32_16x16x32_bf16 v[228:231], a[120:123], a[136:139], v[228:231]
  ds_read_b64_tr_b16 a[82:83], v13 offset:34816
  v_mfma_f32_16x16x32_bf16 v[228:231], a[124:127], a[140:143], v[228:231]
  v_mfma_f32_16x16x32_bf16 v[236:239], a[112:115], a[144:147], v[236:239]
  ds_read_b64_tr_b16 a[84:85], v13 offset:36864
  v_mfma_f32_16x16x32_bf16 v[236:239], a[116:119], a[148:151], v[236:239]
  v_mfma_f32_16x16x32_bf16 v[236:239], a[120:123], a[152:155], v[236:239]
  ds_read_b64_tr_b16 a[86:87], v13 offset:38912
  v_mfma_f32_16x16x32_bf16 v[236:239], a[124:127], a[156:159], v[236:239]
  v_mfma_f32_16x16x32_bf16 v[244:247], a[112:115], a[160:163], v[244:247]
  ds_read_b64_tr_b16 a[88:89], v13 offset:40960
  v_mfma_f32_16x16x32_bf16 v[244:247], a[116:119], a[164:167], v[244:247]
  v_mfma_f32_16x16x32_bf16 v[244:247], a[120:123], a[168:171], v[244:247]
  ds_read_b64_tr_b16 a[90:91], v13 offset:43008
  v_mfma_f32_16x16x32_bf16 v[244:247], a[124:127], a[172:175], v[244:247]
  v_mfma_f32_16x16x32_bf16 v[252:255], a[112:115], a[176:179], v[252:255]
  ds_read_b64_tr_b16 a[92:93], v13 offset:45056
  v_mfma_f32_16x16x32_bf16 v[252:255], a[116:119], a[180:183], v[252:255]
  v_mfma_f32_16x16x32_bf16 v[252:255], a[120:123], a[184:187], v[252:255]
  ds_read_b64_tr_b16 a[94:95], v13 offset:47104
  v_mfma_f32_16x16x32_bf16 v[252:255], a[124:127], a[188:191], v[252:255]
  s_waitcnt lgkmcnt(8)
  s_waitcnt vmcnt(12)
  v_mfma_f32_16x16x32_bf16 v[128:131], a[64:67], a[192:195], v[128:131]
  ds_read_b64_tr_b16 a[96:97], v14 offset:32768
  v_mfma_f32_16x16x32_bf16 v[128:131], a[68:71], a[196:199], v[128:131]
  v_mfma_f32_16x16x32_bf16 v[128:131], a[72:75], a[200:203], v[128:131]
  ds_read_b64_tr_b16 a[98:99], v14 offset:34816
  v_mfma_f32_16x16x32_bf16 v[128:131], a[76:79], a[204:207], v[128:131]
  s_waitcnt vmcnt(8)
  v_mfma_f32_16x16x32_bf16 v[136:139], a[64:67], a[208:211], v[136:139]
  ds_read_b64_tr_b16 a[100:101], v14 offset:36864
  v_mfma_f32_16x16x32_bf16 v[136:139], a[68:71], a[212:215], v[136:139]
  v_mfma_f32_16x16x32_bf16 v[136:139], a[72:75], a[216:219], v[136:139]
  ds_read_b64_tr_b16 a[102:103], v14 offset:38912
  v_mfma_f32_16x16x32_bf16 v[136:139], a[76:79], a[220:223], v[136:139]
  s_waitcnt vmcnt(4)
  v_mfma_f32_16x16x32_bf16 v[144:147], a[64:67], a[224:227], v[144:147]
  ds_read_b64_tr_b16 a[104:105], v14 offset:40960
  v_mfma_f32_16x16x32_bf16 v[144:147], a[68:71], a[228:231], v[144:147]
  v_mfma_f32_16x16x32_bf16 v[144:147], a[72:75], a[232:235], v[144:147]
  ds_read_b64_tr_b16 a[106:107], v14 offset:43008
  v_mfma_f32_16x16x32_bf16 v[144:147], a[76:79], a[236:239], v[144:147]
  s_waitcnt vmcnt(0)
  v_mfma_f32_16x16x32_bf16 v[152:155], a[64:67], a[240:243], v[152:155]
  ds_read_b64_tr_b16 a[108:109], v14 offset:45056
  v_mfma_f32_16x16x32_bf16 v[152:155], a[68:71], a[244:247], v[152:155]
  v_mfma_f32_16x16x32_bf16 v[152:155], a[72:75], a[248:251], v[152:155]
  ds_read_b64_tr_b16 a[110:111], v14 offset:47104
  v_mfma_f32_16x16x32_bf16 v[152:155], a[76:79], a[252:255], v[152:155]
  s_waitcnt lgkmcnt(8)
  v_mfma_f32_16x16x32_bf16 v[132:135], a[80:83], a[192:195], v[132:135]
  ds_read_b64_tr_b16 a[112:113], v15 offset:32768
  v_mfma_f32_16x16x32_bf16 v[132:135], a[84:87], a[196:199], v[132:135]
  v_mfma_f32_16x16x32_bf16 v[132:135], a[88:91], a[200:203], v[132:135]
  ds_read_b64_tr_b16 a[114:115], v15 offset:34816
  v_mfma_f32_16x16x32_bf16 v[132:135], a[92:95], a[204:207], v[132:135]
  v_mfma_f32_16x16x32_bf16 v[140:143], a[80:83], a[208:211], v[140:143]
  ds_read_b64_tr_b16 a[116:117], v15 offset:36864
  v_mfma_f32_16x16x32_bf16 v[140:143], a[84:87], a[212:215], v[140:143]
  v_mfma_f32_16x16x32_bf16 v[140:143], a[88:91], a[216:219], v[140:143]
  ds_read_b64_tr_b16 a[118:119], v15 offset:38912
  v_mfma_f32_16x16x32_bf16 v[140:143], a[92:95], a[220:223], v[140:143]
  v_mfma_f32_16x16x32_bf16 v[148:151], a[80:83], a[224:227], v[148:151]
  ds_read_b64_tr_b16 a[120:121], v15 offset:40960
  v_mfma_f32_16x16x32_bf16 v[148:151], a[84:87], a[228:231], v[148:151]
  v_mfma_f32_16x16x32_bf16 v[148:151], a[88:91], a[232:235], v[148:151]
  ds_read_b64_tr_b16 a[122:123], v15 offset:43008
  v_mfma_f32_16x16x32_bf16 v[148:151], a[92:95], a[236:239], v[148:151]
  v_mfma_f32_16x16x32_bf16 v[156:159], a[80:83], a[240:243], v[156:159]
  ds_read_b64_tr_b16 a[124:125], v15 offset:45056
  v_mfma_f32_16x16x32_bf16 v[156:159], a[84:87], a[244:247], v[156:159]
  v_mfma_f32_16x16x32_bf16 v[156:159], a[88:91], a[248:251], v[156:159]
  s_barrier
  ds_read_b64_tr_b16 a[126:127], v15 offset:47104
  v_mfma_f32_16x16x32_bf16 v[156:159], a[92:95], a[252:255], v[156:159]
  s_waitcnt lgkmcnt(8)
  v_mfma_f32_16x16x32_bf16 v[160:163], a[96:99], a[192:195], v[160:163]
  ds_read_b64_tr_b16 a[64:65], v12 offset:49152
  v_mfma_f32_16x16x32_bf16 v[160:163], a[100:103], a[196:199], v[160:163]
  s_nop 1
  v_mfma_f32_16x16x32_bf16 v[160:163], a[104:107], a[200:203], v[160:163]
  ds_read_b64_tr_b16 a[66:67], v12 offset:51200
  v_mfma_f32_16x16x32_bf16 v[160:163], a[108:111], a[204:207], v[160:163]
  v_cvt_pk_bf16_f32 v96, v128, v129
  v_cvt_pk_bf16_f32 v97, v130, v131
  v_mfma_f32_16x16x32_bf16 v[168:171], a[96:99], a[208:211], v[168:171]
  ds_read_b64_tr_b16 a[68:69], v12 offset:53248
  v_mfma_f32_16x16x32_bf16 v[168:171], a[100:103], a[212:215], v[168:171]
  v_cvt_pk_bf16_f32 v98, v132, v133
  v_cvt_pk_bf16_f32 v99, v134, v135
  v_mfma_f32_16x16x32_bf16 v[168:171], a[104:107], a[216:219], v[168:171]
  ds_read_b64_tr_b16 a[70:71], v12 offset:55296
  v_mfma_f32_16x16x32_bf16 v[168:171], a[108:111], a[220:223], v[168:171]
  buffer_store_dwordx4 v[96:99], v2, s[40:43], s76 offen offset:0 sc1
  v_mfma_f32_16x16x32_bf16 v[176:179], a[96:99], a[224:227], v[176:179]
  ds_read_b64_tr_b16 a[72:73], v12 offset:57344
  v_mfma_f32_16x16x32_bf16 v[176:179], a[100:103], a[228:231], v[176:179]
  v_cvt_pk_bf16_f32 v100, v136, v137
  v_cvt_pk_bf16_f32 v101, v138, v139
  v_mfma_f32_16x16x32_bf16 v[176:179], a[104:107], a[232:235], v[176:179]
  ds_read_b64_tr_b16 a[74:75], v12 offset:59392
  v_mfma_f32_16x16x32_bf16 v[176:179], a[108:111], a[236:239], v[176:179]
  v_cvt_pk_bf16_f32 v102, v140, v141
  v_cvt_pk_bf16_f32 v103, v142, v143
  v_mfma_f32_16x16x32_bf16 v[184:187], a[96:99], a[240:243], v[184:187]
  ds_read_b64_tr_b16 a[76:77], v12 offset:61440
  v_mfma_f32_16x16x32_bf16 v[184:187], a[100:103], a[244:247], v[184:187]
  buffer_store_dwordx4 v[100:103], v2, s[40:43], s77 offen offset:0 sc1
  v_mfma_f32_16x16x32_bf16 v[184:187], a[104:107], a[248:251], v[184:187]
  ds_read_b64_tr_b16 a[78:79], v12 offset:63488
  v_mfma_f32_16x16x32_bf16 v[184:187], a[108:111], a[252:255], v[184:187]
  s_waitcnt lgkmcnt(8)
  v_cvt_pk_bf16_f32 v104, v144, v145
  v_cvt_pk_bf16_f32 v105, v146, v147
  v_mfma_f32_16x16x32_bf16 v[164:167], a[112:115], a[192:195], v[164:167]
  ds_read_b64_tr_b16 a[80:81], v13 offset:49152
  v_mfma_f32_16x16x32_bf16 v[164:167], a[116:119], a[196:199], v[164:167]
  v_cvt_pk_bf16_f32 v106, v148, v149
  v_cvt_pk_bf16_f32 v107, v150, v151
  v_mfma_f32_16x16x32_bf16 v[164:167], a[120:123], a[200:203], v[164:167]
  ds_read_b64_tr_b16 a[82:83], v13 offset:51200
  v_mfma_f32_16x16x32_bf16 v[164:167], a[124:127], a[204:207], v[164:167]
  buffer_store_dwordx4 v[104:107], v2, s[40:43], s78 offen offset:0 sc1
  v_mfma_f32_16x16x32_bf16 v[172:175], a[112:115], a[208:211], v[172:175]
  ds_read_b64_tr_b16 a[84:85], v13 offset:53248
  v_mfma_f32_16x16x32_bf16 v[172:175], a[116:119], a[212:215], v[172:175]
  v_cvt_pk_bf16_f32 v108, v152, v153
  v_cvt_pk_bf16_f32 v109, v154, v155
  v_mfma_f32_16x16x32_bf16 v[172:175], a[120:123], a[216:219], v[172:175]
  ds_read_b64_tr_b16 a[86:87], v13 offset:55296
  v_mfma_f32_16x16x32_bf16 v[172:175], a[124:127], a[220:223], v[172:175]
  v_cvt_pk_bf16_f32 v110, v156, v157
  v_cvt_pk_bf16_f32 v111, v158, v159
  v_mfma_f32_16x16x32_bf16 v[180:183], a[112:115], a[224:227], v[180:183]
  ds_read_b64_tr_b16 a[88:89], v13 offset:57344
  v_mfma_f32_16x16x32_bf16 v[180:183], a[116:119], a[228:231], v[180:183]
  buffer_store_dwordx4 v[108:111], v2, s[40:43], s79 offen offset:0 sc1
  v_mfma_f32_16x16x32_bf16 v[180:183], a[120:123], a[232:235], v[180:183]
  ds_read_b64_tr_b16 a[90:91], v13 offset:59392
  v_mfma_f32_16x16x32_bf16 v[180:183], a[124:127], a[236:239], v[180:183]
  v_mfma_f32_16x16x32_bf16 v[188:191], a[112:115], a[240:243], v[188:191]
  ds_read_b64_tr_b16 a[92:93], v13 offset:61440
  v_mfma_f32_16x16x32_bf16 v[188:191], a[116:119], a[244:247], v[188:191]
  v_mfma_f32_16x16x32_bf16 v[188:191], a[120:123], a[248:251], v[188:191]
  ds_read_b64_tr_b16 a[94:95], v13 offset:63488
  v_mfma_f32_16x16x32_bf16 v[188:191], a[124:127], a[252:255], v[188:191]
  s_waitcnt lgkmcnt(8)
  v_mfma_f32_16x16x32_bf16 v[192:195], a[64:67], a[192:195], v[192:195]
  ds_read_b64_tr_b16 a[96:97], v14 offset:49152
  v_mfma_f32_16x16x32_bf16 v[192:195], a[68:71], a[196:199], v[192:195]
  s_nop 1
  v_mfma_f32_16x16x32_bf16 v[192:195], a[72:75], a[200:203], v[192:195]
  ds_read_b64_tr_b16 a[98:99], v14 offset:51200
  v_mfma_f32_16x16x32_bf16 v[192:195], a[76:79], a[204:207], v[192:195]
  v_cvt_pk_bf16_f32 v112, v160, v161
  v_cvt_pk_bf16_f32 v113, v162, v163
  v_mfma_f32_16x16x32_bf16 v[200:203], a[64:67], a[208:211], v[200:203]
  ds_read_b64_tr_b16 a[100:101], v14 offset:53248
  v_mfma_f32_16x16x32_bf16 v[200:203], a[68:71], a[212:215], v[200:203]
  v_cvt_pk_bf16_f32 v114, v164, v165
  v_cvt_pk_bf16_f32 v115, v166, v167
  v_mfma_f32_16x16x32_bf16 v[200:203], a[72:75], a[216:219], v[200:203]
  ds_read_b64_tr_b16 a[102:103], v14 offset:55296
  v_mfma_f32_16x16x32_bf16 v[200:203], a[76:79], a[220:223], v[200:203]
  buffer_store_dwordx4 v[112:115], v2, s[40:43], s76 offen offset:1024 sc1
  v_mfma_f32_16x16x32_bf16 v[208:211], a[64:67], a[224:227], v[208:211]
  ds_read_b64_tr_b16 a[104:105], v14 offset:57344
  v_mfma_f32_16x16x32_bf16 v[208:211], a[68:71], a[228:231], v[208:211]
  v_cvt_pk_bf16_f32 v116, v168, v169
  v_cvt_pk_bf16_f32 v117, v170, v171
  v_mfma_f32_16x16x32_bf16 v[208:211], a[72:75], a[232:235], v[208:211]
  ds_read_b64_tr_b16 a[106:107], v14 offset:59392
  v_mfma_f32_16x16x32_bf16 v[208:211], a[76:79], a[236:239], v[208:211]
  v_cvt_pk_bf16_f32 v118, v172, v173
  v_cvt_pk_bf16_f32 v119, v174, v175
  v_mfma_f32_16x16x32_bf16 v[216:219], a[64:67], a[240:243], v[216:219]
  ds_read_b64_tr_b16 a[108:109], v14 offset:61440
  v_mfma_f32_16x16x32_bf16 v[216:219], a[68:71], a[244:247], v[216:219]
  buffer_store_dwordx4 v[116:119], v2, s[40:43], s77 offen offset:1024 sc1
  v_mfma_f32_16x16x32_bf16 v[216:219], a[72:75], a[248:251], v[216:219]
  ds_read_b64_tr_b16 a[110:111], v14 offset:63488
  v_mfma_f32_16x16x32_bf16 v[216:219], a[76:79], a[252:255], v[216:219]
  s_waitcnt lgkmcnt(8)
  v_cvt_pk_bf16_f32 v120, v176, v177
  v_cvt_pk_bf16_f32 v121, v178, v179
  v_mfma_f32_16x16x32_bf16 v[196:199], a[80:83], a[192:195], v[196:199]
  ds_read_b64_tr_b16 a[112:113], v15 offset:49152
  v_mfma_f32_16x16x32_bf16 v[196:199], a[84:87], a[196:199], v[196:199]
  v_cvt_pk_bf16_f32 v122, v180, v181
  v_cvt_pk_bf16_f32 v123, v182, v183
  v_mfma_f32_16x16x32_bf16 v[196:199], a[88:91], a[200:203], v[196:199]
  ds_read_b64_tr_b16 a[114:115], v15 offset:51200
  v_mfma_f32_16x16x32_bf16 v[196:199], a[92:95], a[204:207], v[196:199]
  buffer_store_dwordx4 v[120:123], v2, s[40:43], s78 offen offset:1024 sc1
  v_mfma_f32_16x16x32_bf16 v[204:207], a[80:83], a[208:211], v[204:207]
  ds_read_b64_tr_b16 a[116:117], v15 offset:53248
  v_mfma_f32_16x16x32_bf16 v[204:207], a[84:87], a[212:215], v[204:207]
  v_cvt_pk_bf16_f32 v124, v184, v185
  v_cvt_pk_bf16_f32 v125, v186, v187
  v_mfma_f32_16x16x32_bf16 v[204:207], a[88:91], a[216:219], v[204:207]
  ds_read_b64_tr_b16 a[118:119], v15 offset:55296
  v_mfma_f32_16x16x32_bf16 v[204:207], a[92:95], a[220:223], v[204:207]
  v_cvt_pk_bf16_f32 v126, v188, v189
  v_cvt_pk_bf16_f32 v127, v190, v191
  v_mfma_f32_16x16x32_bf16 v[212:215], a[80:83], a[224:227], v[212:215]
  ds_read_b64_tr_b16 a[120:121], v15 offset:57344
  v_mfma_f32_16x16x32_bf16 v[212:215], a[84:87], a[228:231], v[212:215]
  buffer_store_dwordx4 v[124:127], v2, s[40:43], s79 offen offset:1024 sc1
  v_mfma_f32_16x16x32_bf16 v[212:215], a[88:91], a[232:235], v[212:215]
  ds_read_b64_tr_b16 a[122:123], v15 offset:59392
  v_mfma_f32_16x16x32_bf16 v[212:215], a[92:95], a[236:239], v[212:215]
  v_mfma_f32_16x16x32_bf16 v[220:223], a[80:83], a[240:243], v[220:223]
  ds_read_b64_tr_b16 a[124:125], v15 offset:61440
  v_mfma_f32_16x16x32_bf16 v[220:223], a[84:87], a[244:247], v[220:223]
  v_mfma_f32_16x16x32_bf16 v[220:223], a[88:91], a[248:251], v[220:223]
  ds_read_b64_tr_b16 a[126:127], v15 offset:63488
  v_mfma_f32_16x16x32_bf16 v[220:223], a[92:95], a[252:255], v[220:223]
  s_waitcnt lgkmcnt(8)
  v_mfma_f32_16x16x32_bf16 v[224:227], a[96:99], a[192:195], v[224:227]
  v_mfma_f32_16x16x32_bf16 v[224:227], a[100:103], a[196:199], v[224:227]
  s_nop 1
  v_mfma_f32_16x16x32_bf16 v[224:227], a[104:107], a[200:203], v[224:227]
  v_mfma_f32_16x16x32_bf16 v[224:227], a[108:111], a[204:207], v[224:227]
  v_cvt_pk_bf16_f32 v96, v192, v193
  v_cvt_pk_bf16_f32 v97, v194, v195
  v_mfma_f32_16x16x32_bf16 v[232:235], a[96:99], a[208:211], v[232:235]
  v_mfma_f32_16x16x32_bf16 v[232:235], a[100:103], a[212:215], v[232:235]
  v_cvt_pk_bf16_f32 v98, v196, v197
  v_cvt_pk_bf16_f32 v99, v198, v199
  v_mfma_f32_16x16x32_bf16 v[232:235], a[104:107], a[216:219], v[232:235]
  v_mfma_f32_16x16x32_bf16 v[232:235], a[108:111], a[220:223], v[232:235]
  buffer_store_dwordx4 v[96:99], v2, s[40:43], s76 offen offset:2048 sc1
  v_mfma_f32_16x16x32_bf16 v[240:243], a[96:99], a[224:227], v[240:243]
  v_mfma_f32_16x16x32_bf16 v[240:243], a[100:103], a[228:231], v[240:243]
  v_cvt_pk_bf16_f32 v100, v200, v201
  v_cvt_pk_bf16_f32 v101, v202, v203
  v_mfma_f32_16x16x32_bf16 v[240:243], a[104:107], a[232:235], v[240:243]
  v_mfma_f32_16x16x32_bf16 v[240:243], a[108:111], a[236:239], v[240:243]
  v_cvt_pk_bf16_f32 v102, v204, v205
  v_cvt_pk_bf16_f32 v103, v206, v207
  v_mfma_f32_16x16x32_bf16 v[248:251], a[96:99], a[240:243], v[248:251]
  v_mfma_f32_16x16x32_bf16 v[248:251], a[100:103], a[244:247], v[248:251]
  buffer_store_dwordx4 v[100:103], v2, s[40:43], s77 offen offset:2048 sc1
  v_mfma_f32_16x16x32_bf16 v[248:251], a[104:107], a[248:251], v[248:251]
  v_mfma_f32_16x16x32_bf16 v[248:251], a[108:111], a[252:255], v[248:251]
  s_waitcnt lgkmcnt(0)
  v_cvt_pk_bf16_f32 v104, v208, v209
  v_cvt_pk_bf16_f32 v105, v210, v211
  v_mfma_f32_16x16x32_bf16 v[228:231], a[112:115], a[192:195], v[228:231]
  v_mfma_f32_16x16x32_bf16 v[228:231], a[116:119], a[196:199], v[228:231]
  v_cvt_pk_bf16_f32 v106, v212, v213
  v_cvt_pk_bf16_f32 v107, v214, v215
  v_mfma_f32_16x16x32_bf16 v[228:231], a[120:123], a[200:203], v[228:231]
  v_mfma_f32_16x16x32_bf16 v[228:231], a[124:127], a[204:207], v[228:231]
  buffer_store_dwordx4 v[104:107], v2, s[40:43], s78 offen offset:2048 sc1
  v_mfma_f32_16x16x32_bf16 v[236:239], a[112:115], a[208:211], v[236:239]
  v_mfma_f32_16x16x32_bf16 v[236:239], a[116:119], a[212:215], v[236:239]
  v_cvt_pk_bf16_f32 v108, v216, v217
  v_cvt_pk_bf16_f32 v109, v218, v219
  v_mfma_f32_16x16x32_bf16 v[236:239], a[120:123], a[216:219], v[236:239]
  v_mfma_f32_16x16x32_bf16 v[236:239], a[124:127], a[220:223], v[236:239]
  v_cvt_pk_bf16_f32 v110, v220, v221
  v_cvt_pk_bf16_f32 v111, v222, v223
  v_mfma_f32_16x16x32_bf16 v[244:247], a[112:115], a[224:227], v[244:247]
  v_mfma_f32_16x16x32_bf16 v[244:247], a[116:119], a[228:231], v[244:247]
  buffer_store_dwordx4 v[108:111], v2, s[40:43], s79 offen offset:2048 sc1
  v_mfma_f32_16x16x32_bf16 v[244:247], a[120:123], a[232:235], v[244:247]
  v_mfma_f32_16x16x32_bf16 v[244:247], a[124:127], a[236:239], v[244:247]
  v_mfma_f32_16x16x32_bf16 v[252:255], a[112:115], a[240:243], v[252:255]
  v_mfma_f32_16x16x32_bf16 v[252:255], a[116:119], a[244:247], v[252:255]
  v_mfma_f32_16x16x32_bf16 v[252:255], a[120:123], a[248:251], v[252:255]
  v_mfma_f32_16x16x32_bf16 v[252:255], a[124:127], a[252:255], v[252:255]
  s_nop 7
  v_cvt_pk_bf16_f32 v112, v224, v225
  v_cvt_pk_bf16_f32 v113, v226, v227
  v_cvt_pk_bf16_f32 v114, v228, v229
  v_cvt_pk_bf16_f32 v115, v230, v231
  buffer_store_dwordx4 v[112:115], v2, s[40:43], s76 offen offset:3072 sc1
  v_cvt_pk_bf16_f32 v116, v232, v233
  v_cvt_pk_bf16_f32 v117, v234, v235
  v_cvt_pk_bf16_f32 v118, v236, v237
  v_cvt_pk_bf16_f32 v119, v238, v239
  buffer_store_dwordx4 v[116:119], v2, s[40:43], s77 offen offset:3072 sc1
  v_cvt_pk_bf16_f32 v120, v240, v241
  v_cvt_pk_bf16_f32 v121, v242, v243
  v_cvt_pk_bf16_f32 v122, v244, v245
  v_cvt_pk_bf16_f32 v123, v246, v247
  buffer_store_dwordx4 v[120:123], v2, s[40:43], s78 offen offset:3072 sc1
  v_cvt_pk_bf16_f32 v124, v248, v249
  v_cvt_pk_bf16_f32 v125, v250, v251
  v_cvt_pk_bf16_f32 v126, v252, v253
  v_cvt_pk_bf16_f32 v127, v254, v255
  buffer_store_dwordx4 v[124:127], v2, s[40:43], s79 offen offset:3072 sc1
  s_lshl_b32 s66, s57, 7
  s_add_u32 s66, s66, 0xd086000
  s_cmp_eq_u32 s44, 0
  s_cselect_b32 s66, s66, 0x40000000
  v_mov_b32 v6, 1
  s_waitcnt vmcnt(0)
  s_barrier
  s_mov_b64 exec, 1
  buffer_atomic_add v6, v2, s[40:43], s66 offen
  s_mov_b64 exec, -1
  s_branch L_att_end
L_a_fspin:
  s_sleep 1
  buffer_load_dword v6, v24, s[40:43], 0 offen sc1
  s_add_u32 s74, s74, 1
  s_cmp_gt_u32 s74, 1048576
  s_cbranch_scc1 L_exit
  s_branch L_a_fw
L_a_s1_t:
  s_mov_b32 s71, 0
  s_nop 6
  s_branch L_a_slow0_0
L_a_s0_t:
  s_mov_b32 s71, 1
  s_nop 6
  s_branch L_a_slow1_0
L_a_d0_t:
  s_mov_b32 s71, 2
  s_nop 6
  s_branch L_a_slow0_0
L_a_d1_t:
  s_mov_b32 s71, 3
  s_nop 6
  s_branch L_a_slow1_0
L_a_d2_t:
  s_mov_b32 s71, 4
  s_nop 6
  s_branch L_a_slow0_1
L_a_d3_t:
  s_mov_b32 s71, 5
  s_nop 6
  s_branch L_a_slow1_1
L_a_d4_t:
  s_mov_b32 s71, 6
  s_nop 6
  s_branch L_a_slow0_2
L_a_d5_t:
  s_mov_b32 s71, 7
  s_nop 6
  s_branch L_a_slow1_2
L_a_d6_t:
  s_mov_b32 s71, 8
  s_nop 6
  s_branch L_a_slow0_3
L_a_d7_t:
  s_mov_b32 s71, 9
  s_nop 6
  s_branch L_a_slow1_3
L_a_slow0_0:
  v_max3_f32 v6, v32, v33, v34
  v_max3_f32 v7, v35, v36, v37
  v_max3_f32 v6, v6, v38, v39
  v_max_f32 v6, v6, v7
  v_mov_b32 v7, v6
  s_nop 1
  v_permlane32_swap_b32 v7, v6
  v_max_f32 v6, v6, v7
  v_mov_b32 v7, v6
  s_nop 1
  v_permlane16_swap_b32 v7, v6
  v_max_f32 v6, v6, v7
  v_add_f32 v6, 0x41800000, v6
  v_max_f32 v6, 0, v6
  v_exp_f32 v7, -v6
  v_sub_f32 v96, v96, v6
  v_sub_f32 v97, v97, v6
  v_sub_f32 v98, v98, v6
  v_sub_f32 v99, v99, v6
  v_sub_f32 v100, v100, v6
  v_sub_f32 v101, v101, v6
  v_sub_f32 v102, v102, v6
  v_sub_f32 v103, v103, v6
  v_mul_f32 v128, v128, v7
  v_mul_f32 v129, v129, v7
  v_mul_f32 v130, v130, v7
  v_mul_f32 v131, v131, v7
  v_mul_f32 v132, v132, v7
  v_mul_f32 v133, v133, v7
  v_mul_f32 v134, v134, v7
  v_mul_f32 v135, v135, v7
  v_mul_f32 v136, v136, v7
  v_mul_f32 v137, v137, v7
  v_mul_f32 v138, v138, v7
  v_mul_f32 v139, v139, v7
  v_mul_f32 v140, v140, v7
  v_mul_f32 v141, v141, v7
  v_mul_f32 v142, v142, v7
  v_mul_f32 v143, v143, v7
  v_mul_f32 v144, v144, v7
  v_mul_f32 v145, v145, v7
  v_mul_f32 v146, v146, v7
  v_mul_f32 v147, v147, v7
  v_mul_f32 v148, v148, v7
  v_mul_f32 v149, v149, v7
  v_mul_f32 v150, v150, v7
  v_mul_f32 v151, v151, v7
  v_mul_f32 v152, v152, v7
  v_mul_f32 v153, v153, v7
  v_mul_f32 v154, v154, v7
  v_mul_f32 v155, v155, v7
  v_mul_f32 v156, v156, v7
  v_mul_f32 v157, v157, v7
  v_mul_f32 v158, v158, v7
  v_mul_f32 v159, v159, v7
  v_accvgpr_read_b32 v8, a128
  v_mul_f32 v8, v8, v7
  v_accvgpr_write_b32 a128, v8
  v_accvgpr_read_b32 v8, a129
  v_mul_f32 v8, v8, v7
  v_accvgpr_write_b32 a129, v8
  v_accvgpr_read_b32 v8, a130
  v_mul_f32 v8, v8, v7
  v_accvgpr_write_b32 a130, v8
  v_accvgpr_read_b32 v8, a131
  v_mul_f32 v8, v8, v7
  v_accvgpr_write_b32 a131, v8
  v_sub_f32 v8, v32, v6
  v_sub_f32 v9, v33, v6
  v_sub_f32 v10, v34, v6
  v_sub_f32 v11, v35, v6
  v_sub_f32 v12, v36, v6
  v_sub_f32 v13, v37, v6
  v_sub_f32 v14, v38, v6
  v_sub_f32 v15, v39, v6
  v_exp_f32 v8, v8
  v_exp_f32 v9, v9
  v_exp_f32 v10, v10
  v_exp_f32 v11, v11
  v_exp_f32 v12, v12
  v_exp_f32 v13, v13
  v_exp_f32 v14, v14
  v_exp_f32 v15, v15
  v_cvt_pk_bf16_f32 v64, v8, v9
  v_cvt_pk_bf16_f32 v65, v10, v11
  v_cvt_pk_bf16_f32 v66, v12, v13
  v_cvt_pk_bf16_f32 v67, v14, v15
L_a_slow0_1:
  v_max3_f32 v6, v40, v41, v42
  v_max3_f32 v7, v43, v44, v45
  v_max3_f32 v6, v6, v46, v47
  v_max_f32 v6, v6, v7
  v_mov_b32 v7, v6
  s_nop 1
  v_permlane32_swap_b32 v7, v6
  v_max_f32 v6, v6, v7
  v_mov_b32 v7, v6
  s_nop 1
  v_permlane16_swap_b32 v7, v6
  v_max_f32 v6, v6, v7
  v_add_f32 v6, 0x41800000, v6
  v_max_f32 v6, 0, v6
  v_exp_f32 v7, -v6
  v_sub_f32 v104, v104, v6
  v_sub_f32 v105, v105, v6
  v_sub_f32 v106, v106, v6
  v_sub_f32 v107, v107, v6
  v_sub_f32 v108, v108, v6
  v_sub_f32 v109, v109, v6
  v_sub_f32 v110, v110, v6
  v_sub_f32 v111, v111, v6
  v_mul_f32 v160, v160, v7
  v_mul_f32 v161, v161, v7
  v_mul_f32 v162, v162, v7
  v_mul_f32 v163, v163, v7
  v_mul_f32 v164, v164, v7
  v_mul_f32 v165, v165, v7
  v_mul_f32 v166, v166, v7
  v_mul_f32 v167, v167, v7
  v_mul_f32 v168, v168, v7
  v_mul_f32 v169, v169, v7
  v_mul_f32 v170, v170, v7
  v_mul_f32 v171, v171, v7
  v_mul_f32 v172, v172, v7
  v_mul_f32 v173, v173, v7
  v_mul_f32 v174, v174, v7
  v_mul_f32 v175, v175, v7
  v_mul_f32 v176, v176, v7
  v_mul_f32 v177, v177, v7
  v_mul_f32 v178, v178, v7
  v_mul_f32 v179, v179, v7
  v_mul_f32 v180, v180, v7
  v_mul_f32 v181, v181, v7
  v_mul_f32 v182, v182, v7
  v_mul_f32 v183, v183, v7
  v_mul_f32 v184, v184, v7
  v_mul_f32 v185, v185, v7
  v_mul_f32 v186, v186, v7
  v_mul_f32 v187, v187, v7
  v_mul_f32 v188, v188, v7
  v_mul_f32 v189, v189, v7
  v_mul_f32 v190, v190, v7
  v_mul_f32 v191, v191, v7
  v_accvgpr_read_b32 v8, a132
  v_mul_f32 v8, v8, v7
  v_accvgpr_write_b32 a132, v8
  v_accvgpr_read_b32 v8, a133
  v_mul_f32 v8, v8, v7
  v_accvgpr_write_b32 a133, v8
  v_accvgpr_read_b32 v8, a134
  v_mul_f32 v8, v8, v7
  v_accvgpr_write_b32 a134, v8
  v_accvgpr_read_b32 v8, a135
  v_mul_f32 v8, v8, v7
  v_accvgpr_write_b32 a135, v8
  v_sub_f32 v8, v40, v6
  v_sub_f32 v9, v41, v6
  v_sub_f32 v10, v42, v6
  v_sub_f32 v11, v43, v6
  v_sub_f32 v12, v44, v6
  v_sub_f32 v13, v45, v6
  v_sub_f32 v14, v46, v6
  v_sub_f32 v15, v47, v6
  v_exp_f32 v8, v8
  v_exp_f32 v9, v9
  v_exp_f32 v10, v10
  v_exp_f32 v11, v11
  v_exp_f32 v12, v12
  v_exp_f32 v13, v13
  v_exp_f32 v14, v14
  v_exp_f32 v15, v15
  v_cvt_pk_bf16_f32 v68, v8, v9
  v_cvt_pk_bf16_f32 v69, v10, v11
  v_cvt_pk_bf16_f32 v70, v12, v13
  v_cvt_pk_bf16_f32 v71, v14, v15
L_a_slow0_2:
  v_max3_f32 v6, v48, v49, v50
  v_max3_f32 v7, v51, v52, v53
  v_max3_f32 v6, v6, v54, v55
  v_max_f32 v6, v6, v7
  v_mov_b32 v7, v6
  s_nop 1
  v_permlane32_swap_b32 v7, v6
  v_max_f32 v6, v6, v7
  v_mov_b32 v7, v6
  s_nop 1
  v_permlane16_swap_b32 v7, v6
  v_max_f32 v6, v6, v7
  v_add_f32 v6, 0x41800000, v6
  v_max_f32 v6, 0, v6
  v_exp_f32 v7, -v6
  v_sub_f32 v112, v112, v6
  v_sub_f32 v113, v113, v6
  v_sub_f32 v114, v114, v6
  v_sub_f32 v115, v115, v6
  v_sub_f32 v116, v116, v6
  v_sub_f32 v117, v117, v6
  v_sub_f32 v118, v118, v6
  v_sub_f32 v119, v119, v6
  v_mul_f32 v192, v192, v7
  v_mul_f32 v193, v193, v7
  v_mul_f32 v194, v194, v7
  v_mul_f32 v195, v195, v7
  v_mul_f32 v196, v196, v7
  v_mul_f32 v197, v197, v7
  v_mul_f32 v198, v198, v7
  v_mul_f32 v199, v199, v7
  v_mul_f32 v200, v200, v7
  v_mul_f32 v201, v201, v7
  v_mul_f32 v202, v202, v7
  v_mul_f32 v203, v203, v7
  v_mul_f32 v204, v204, v7
  v_mul_f32 v205, v205, v7
  v_mul_f32 v206, v206, v7
  v_mul_f32 v207, v207, v7
  v_mul_f32 v208, v208, v7
  v_mul_f32 v209, v209, v7
  v_mul_f32 v210, v210, v7
  v_mul_f32 v211, v211, v7
  v_mul_f32 v212, v212, v7
  v_mul_f32 v213, v213, v7
  v_mul_f32 v214, v214, v7
  v_mul_f32 v215, v215, v7
  v_mul_f32 v216, v216, v7
  v_mul_f32 v217, v217, v7
  v_mul_f32 v218, v218, v7
  v_mul_f32 v219, v219, v7
  v_mul_f32 v220, v220, v7
  v_mul_f32 v221, v221, v7
  v_mul_f32 v222, v222, v7
  v_mul_f32 v223, v223, v7
  v_accvgpr_read_b32 v8, a136
  v_mul_f32 v8, v8, v7
  v_accvgpr_write_b32 a136, v8
  v_accvgpr_read_b32 v8, a137
  v_mul_f32 v8, v8, v7
  v_accvgpr_write_b32 a137, v8
  v_accvgpr_read_b32 v8, a138
  v_mul_f32 v8, v8, v7
  v_accvgpr_write_b32 a138, v8
  v_accvgpr_read_b32 v8, a139
  v_mul_f32 v8, v8, v7
  v_accvgpr_write_b32 a139, v8
  v_sub_f32 v8, v48, v6
  v_sub_f32 v9, v49, v6
  v_sub_f32 v10, v50, v6
  v_sub_f32 v11, v51, v6
  v_sub_f32 v12, v52, v6
  v_sub_f32 v13, v53, v6
  v_sub_f32 v14, v54, v6
  v_sub_f32 v15, v55, v6
  v_exp_f32 v8, v8
  v_exp_f32 v9, v9
  v_exp_f32 v10, v10
  v_exp_f32 v11, v11
  v_exp_f32 v12, v12
  v_exp_f32 v13, v13
  v_exp_f32 v14, v14
  v_exp_f32 v15, v15
  v_cvt_pk_bf16_f32 v72, v8, v9
  v_cvt_pk_bf16_f32 v73, v10, v11
  v_cvt_pk_bf16_f32 v74, v12, v13
  v_cvt_pk_bf16_f32 v75, v14, v15
L_a_slow0_3:
  v_max3_f32 v6, v56, v57, v58
  v_max3_f32 v7, v59, v60, v61
  v_max3_f32 v6, v6, v62, v63
  v_max_f32 v6, v6, v7
  v_mov_b32 v7, v6
  s_nop 1
  v_permlane32_swap_b32 v7, v6
  v_max_f32 v6, v6, v7
  v_mov_b32 v7, v6
  s_nop 1
  v_permlane16_swap_b32 v7, v6
  v_max_f32 v6, v6, v7
  v_add_f32 v6, 0x41800000, v6
  v_max_f32 v6, 0, v6
  v_exp_f32 v7, -v6
  v_sub_f32 v120, v120, v6
  v_sub_f32 v121, v121, v6
  v_sub_f32 v122, v122, v6
  v_sub_f32 v123, v123, v6
  v_sub_f32 v124, v124, v6
  v_sub_f32 v125, v125, v6
  v_sub_f32 v126, v126, v6
  v_sub_f32 v127, v127, v6
  v_mul_f32 v224, v224, v7
  v_mul_f32 v225, v225, v7
  v_mul_f32 v226, v226, v7
  v_mul_f32 v227, v227, v7
  v_mul_f32 v228, v228, v7
  v_mul_f32 v229, v229, v7
  v_mul_f32 v230, v230, v7
  v_mul_f32 v231, v231, v7
  v_mul_f32 v232, v232, v7
  v_mul_f32 v233, v233, v7
  v_mul_f32 v234, v234, v7
  v_mul_f32 v235, v235, v7
  v_mul_f32 v236, v236, v7
  v_mul_f32 v237, v237, v7
  v_mul_f32 v238, v238, v7
  v_mul_f32 v239, v239, v7
  v_mul_f32 v240, v240, v7
  v_mul_f32 v241, v241, v7
  v_mul_f32 v242, v242, v7
  v_mul_f32 v243, v243, v7
  v_mul_f32 v244, v244, v7
  v_mul_f32 v245, v245, v7
  v_mul_f32 v246, v246, v7
  v_mul_f32 v247, v247, v7
  v_mul_f32 v248, v248, v7
  v_mul_f32 v249, v249, v7
  v_mul_f32 v250, v250, v7
  v_mul_f32 v251, v251, v7
  v_mul_f32 v252, v252, v7
  v_mul_f32 v253, v253, v7
  v_mul_f32 v254, v254, v7
  v_mul_f32 v255, v255, v7
  v_accvgpr_read_b32 v8, a140
  v_mul_f32 v8, v8, v7
  v_accvgpr_write_b32 a140, v8
  v_accvgpr_read_b32 v8, a141
  v_mul_f32 v8, v8, v7
  v_accvgpr_write_b32 a141, v8
  v_accvgpr_read_b32 v8, a142
  v_mul_f32 v8, v8, v7
  v_accvgpr_write_b32 a142, v8
  v_accvgpr_read_b32 v8, a143
  v_mul_f32 v8, v8, v7
  v_accvgpr_write_b32 a143, v8
  v_sub_f32 v8, v56, v6
  v_sub_f32 v9, v57, v6
  v_sub_f32 v10, v58, v6
  v_sub_f32 v11, v59, v6
  v_sub_f32 v12, v60, v6
  v_sub_f32 v13, v61, v6
  v_sub_f32 v14, v62, v6
  v_sub_f32 v15, v63, v6
  v_exp_f32 v8, v8
  v_exp_f32 v9, v9
  v_exp_f32 v10, v10
  v_exp_f32 v11, v11
  v_exp_f32 v12, v12
  v_exp_f32 v13, v13
  v_exp_f32 v14, v14
  v_exp_f32 v15, v15
  v_cvt_pk_bf16_f32 v76, v8, v9
  v_cvt_pk_bf16_f32 v77, v10, v11
  v_cvt_pk_bf16_f32 v78, v12, v13
  v_cvt_pk_bf16_f32 v79, v14, v15
  s_cmp_eq_u32 s71, 0
  s_cbranch_scc1 L_a_s1_r
  s_cmp_eq_u32 s71, 2
  s_cbranch_scc1 L_a_d0_r
  s_cmp_eq_u32 s71, 4
  s_cbranch_scc1 L_a_d2_r
  s_cmp_eq_u32 s71, 6
  s_cbranch_scc1 L_a_d4_r
  s_branch L_a_d6_r
L_a_slow1_0:
  v_max3_f32 v6, v32, v33, v34
  v_max3_f32 v7, v35, v36, v37
  v_max3_f32 v6, v6, v38, v39
  v_max_f32 v6, v6, v7
  v_mov_b32 v7, v6
  s_nop 1
  v_permlane32_swap_b32 v7, v6
  v_max_f32 v6, v6, v7
  v_mov_b32 v7, v6
  s_nop 1
  v_permlane16_swap_b32 v7, v6
  v_max_f32 v6, v6, v7
  v_add_f32 v6, 0x41800000, v6
  v_max_f32 v6, 0, v6
  v_exp_f32 v7, -v6
  v_sub_f32 v96, v96, v6
  v_sub_f32 v97, v97, v6
  v_sub_f32 v98, v98, v6
  v_sub_f32 v99, v99, v6
  v_sub_f32 v100, v100, v6
  v_sub_f32 v101, v101, v6
  v_sub_f32 v102, v102, v6
  v_sub_f32 v103, v103, v6
  v_mul_f32 v128, v128, v7
  v_mul_f32 v129, v129, v7
  v_mul_f32 v130, v130, v7
  v_mul_f32 v131, v131, v7
  v_mul_f32 v132, v132, v7
  v_mul_f32 v133, v133, v7
  v_mul_f32 v134, v134, v7
  v_mul_f32 v135, v135, v7
  v_mul_f32 v136, v136, v7
  v_mul_f32 v137, v137, v7
  v_mul_f32 v138, v138, v7
  v_mul_f32 v139, v139, v7
  v_mul_f32 v140, v140, v7
  v_mul_f32 v141, v141, v7
  v_mul_f32 v142, v142, v7
  v_mul_f32 v143, v143, v7
  v_mul_f32 v144, v144, v7
  v_mul_f32 v145, v145, v7
  v_mul_f32 v146, v146, v7
  v_mul_f32 v147, v147, v7
  v_mul_f32 v148, v148, v7
  v_mul_f32 v149, v149, v7
  v_mul_f32 v150, v150, v7
  v_mul_f32 v151, v151, v7
  v_mul_f32 v152, v152, v7
  v_mul_f32 v153, v153, v7
  v_mul_f32 v154, v154, v7
  v_mul_f32 v155, v155, v7
  v_mul_f32 v156, v156, v7
  v_mul_f32 v157, v157, v7
  v_mul_f32 v158, v158, v7
  v_mul_f32 v159, v159, v7
  v_accvgpr_read_b32 v8, a128
  v_mul_f32 v8, v8, v7
  v_accvgpr_write_b32 a128, v8
  v_accvgpr_read_b32 v8, a129
  v_mul_f32 v8, v8, v7
  v_accvgpr_write_b32 a129, v8
  v_accvgpr_read_b32 v8, a130
  v_mul_f32 v8, v8, v7
  v_accvgpr_write_b32 a130, v8
  v_accvgpr_read_b32 v8, a131
  v_mul_f32 v8, v8, v7
  v_accvgpr_write_b32 a131, v8
  v_sub_f32 v8, v32, v6
  v_sub_f32 v9, v33, v6
  v_sub_f32 v10, v34, v6
  v_sub_f32 v11, v35, v6
  v_sub_f32 v12, v36, v6
  v_sub_f32 v13, v37, v6
  v_sub_f32 v14, v38, v6
  v_sub_f32 v15, v39, v6
  v_exp_f32 v8, v8
  v_exp_f32 v9, v9
  v_exp_f32 v10, v10
  v_exp_f32 v11, v11
  v_exp_f32 v12, v12
  v_exp_f32 v13, v13
  v_exp_f32 v14, v14
  v_exp_f32 v15, v15
  v_cvt_pk_bf16_f32 v80, v8, v9
  v_cvt_pk_bf16_f32 v81, v10, v11
  v_cvt_pk_bf16_f32 v82, v12, v13
  v_cvt_pk_bf16_f32 v83, v14, v15
L_a_slow1_1:
  v_max3_f32 v6, v40, v41, v42
  v_max3_f32 v7, v43, v44, v45
  v_max3_f32 v6, v6, v46, v47
  v_max_f32 v6, v6, v7
  v_mov_b32 v7, v6
  s_nop 1
  v_permlane32_swap_b32 v7, v6
  v_max_f32 v6, v6, v7
  v_mov_b32 v7, v6
  s_nop 1
  v_permlane16_swap_b32 v7, v6
  v_max_f32 v6, v6, v7
  v_add_f32 v6, 0x41800000, v6
  v_max_f32 v6, 0, v6
  v_exp_f32 v7, -v6
  v_sub_f32 v104, v104, v6
  v_sub_f32 v105, v105, v6
  v_sub_f32 v106, v106, v6
  v_sub_f32 v107, v107, v6
  v_sub_f32 v108, v108, v6
  v_sub_f32 v109, v109, v6
  v_sub_f32 v110, v110, v6
  v_sub_f32 v111, v111, v6
  v_mul_f32 v160, v160, v7
  v_mul_f32 v161, v161, v7
  v_mul_f32 v162, v162, v7
  v_mul_f32 v163, v163, v7
  v_mul_f32 v164, v164, v7
  v_mul_f32 v165, v165, v7
  v_mul_f32 v166, v166, v7
  v_mul_f32 v167, v167, v7
  v_mul_f32 v168, v168, v7
  v_mul_f32 v169, v169, v7
  v_mul_f32 v170, v170, v7
  v_mul_f32 v171, v171, v7
  v_mul_f32 v172, v172, v7
  v_mul_f32 v173, v173, v7
  v_mul_f32 v174, v174, v7
  v_mul_f32 v175, v175, v7
  v_mul_f32 v176, v176, v7
  v_mul_f32 v177, v177, v7
  v_mul_f32 v178, v178, v7
  v_mul_f32 v179, v179, v7
  v_mul_f32 v180, v180, v7
  v_mul_f32 v181, v181, v7
  v_mul_f32 v182, v182, v7
  v_mul_f32 v183, v183, v7
  v_mul_f32 v184, v184, v7
  v_mul_f32 v185, v185, v7
  v_mul_f32 v186, v186, v7
  v_mul_f32 v187, v187, v7
  v_mul_f32 v188, v188, v7
  v_mul_f32 v189, v189, v7
  v_mul_f32 v190, v190, v7
  v_mul_f32 v191, v191, v7
  v_accvgpr_read_b32 v8, a132
  v_mul_f32 v8, v8, v7
  v_accvgpr_write_b32 a132, v8
  v_accvgpr_read_b32 v8, a133
  v_mul_f32 v8, v8, v7
  v_accvgpr_write_b32 a133, v8
  v_accvgpr_read_b32 v8, a134
  v_mul_f32 v8, v8, v7
  v_accvgpr_write_b32 a134, v8
  v_accvgpr_read_b32 v8, a135
  v_mul_f32 v8, v8, v7
  v_accvgpr_write_b32 a135, v8
  v_sub_f32 v8, v40, v6
  v_sub_f32 v9, v41, v6
  v_sub_f32 v10, v42, v6
  v_sub_f32 v11, v43, v6
  v_sub_f32 v12, v44, v6
  v_sub_f32 v13, v45, v6
  v_sub_f32 v14, v46, v6
  v_sub_f32 v15, v47, v6
  v_exp_f32 v8, v8
  v_exp_f32 v9, v9
  v_exp_f32 v10, v10
  v_exp_f32 v11, v11
  v_exp_f32 v12, v12
  v_exp_f32 v13, v13
  v_exp_f32 v14, v14
  v_exp_f32 v15, v15
  v_cvt_pk_bf16_f32 v84, v8, v9
  v_cvt_pk_bf16_f32 v85, v10, v11
  v_cvt_pk_bf16_f32 v86, v12, v13
  v_cvt_pk_bf16_f32 v87, v14, v15
L_a_slow1_2:
  v_max3_f32 v6, v48, v49, v50
  v_max3_f32 v7, v51, v52, v53
  v_max3_f32 v6, v6, v54, v55
  v_max_f32 v6, v6, v7
  v_mov_b32 v7, v6
  s_nop 1
  v_permlane32_swap_b32 v7, v6
  v_max_f32 v6, v6, v7
  v_mov_b32 v7, v6
  s_nop 1
  v_permlane16_swap_b32 v7, v6
  v_max_f32 v6, v6, v7
  v_add_f32 v6, 0x41800000, v6
  v_max_f32 v6, 0, v6
  v_exp_f32 v7, -v6
  v_sub_f32 v112, v112, v6
  v_sub_f32 v113, v113, v6
  v_sub_f32 v114, v114, v6
  v_sub_f32 v115, v115, v6
  v_sub_f32 v116, v116, v6
  v_sub_f32 v117, v117, v6
  v_sub_f32 v118, v118, v6
  v_sub_f32 v119, v119, v6
  v_mul_f32 v192, v192, v7
  v_mul_f32 v193, v193, v7
  v_mul_f32 v194, v194, v7
  v_mul_f32 v195, v195, v7
  v_mul_f32 v196, v196, v7
  v_mul_f32 v197, v197, v7
  v_mul_f32 v198, v198, v7
  v_mul_f32 v199, v199, v7
  v_mul_f32 v200, v200, v7
  v_mul_f32 v201, v201, v7
  v_mul_f32 v202, v202, v7
  v_mul_f32 v203, v203, v7
  v_mul_f32 v204, v204, v7
  v_mul_f32 v205, v205, v7
  v_mul_f32 v206, v206, v7
  v_mul_f32 v207, v207, v7
  v_mul_f32 v208, v208, v7
  v_mul_f32 v209, v209, v7
  v_mul_f32 v210, v210, v7
  v_mul_f32 v211, v211, v7
  v_mul_f32 v212, v212, v7
  v_mul_f32 v213, v213, v7
  v_mul_f32 v214, v214, v7
  v_mul_f32 v215, v215, v7
  v_mul_f32 v216, v216, v7
  v_mul_f32 v217, v217, v7
  v_mul_f32 v218, v218, v7
  v_mul_f32 v219, v219, v7
  v_mul_f32 v220, v220, v7
  v_mul_f32 v221, v221, v7
  v_mul_f32 v222, v222, v7
  v_mul_f32 v223, v223, v7
  v_accvgpr_read_b32 v8, a136
  v_mul_f32 v8, v8, v7
  v_accvgpr_write_b32 a136, v8
  v_accvgpr_read_b32 v8, a137
  v_mul_f32 v8, v8, v7
  v_accvgpr_write_b32 a137, v8
  v_accvgpr_read_b32 v8, a138
  v_mul_f32 v8, v8, v7
  v_accvgpr_write_b32 a138, v8
  v_accvgpr_read_b32 v8, a139
  v_mul_f32 v8, v8, v7
  v_accvgpr_write_b32 a139, v8
  v_sub_f32 v8, v48, v6
  v_sub_f32 v9, v49, v6
  v_sub_f32 v10, v50, v6
  v_sub_f32 v11, v51, v6
  v_sub_f32 v12, v52, v6
  v_sub_f32 v13, v53, v6
  v_sub_f32 v14, v54, v6
  v_sub_f32 v15, v55, v6
  v_exp_f32 v8, v8
  v_exp_f32 v9, v9
  v_exp_f32 v10, v10
  v_exp_f32 v11, v11
  v_exp_f32 v12, v12
  v_exp_f32 v13, v13
  v_exp_f32 v14, v14
  v_exp_f32 v15, v15
  v_cvt_pk_bf16_f32 v88, v8, v9
  v_cvt_pk_bf16_f32 v89, v10, v11
  v_cvt_pk_bf16_f32 v90, v12, v13
  v_cvt_pk_bf16_f32 v91, v14, v15
L_a_slow1_3:
  v_max3_f32 v6, v56, v57, v58
  v_max3_f32 v7, v59, v60, v61
  v_max3_f32 v6, v6, v62, v63
  v_max_f32 v6, v6, v7
  v_mov_b32 v7, v6
  s_nop 1
  v_permlane32_swap_b32 v7, v6
  v_max_f32 v6, v6, v7
  v_mov_b32 v7, v6
  s_nop 1
  v_permlane16_swap_b32 v7, v6
  v_max_f32 v6, v6, v7
  v_add_f32 v6, 0x41800000, v6
  v_max_f32 v6, 0, v6
  v_exp_f32 v7, -v6
  v_sub_f32 v120, v120, v6
  v_sub_f32 v121, v121, v6
  v_sub_f32 v122, v122, v6
  v_sub_f32 v123, v123, v6
  v_sub_f32 v124, v124, v6
  v_sub_f32 v125, v125, v6
  v_sub_f32 v126, v126, v6
  v_sub_f32 v127, v127, v6
  v_mul_f32 v224, v224, v7
  v_mul_f32 v225, v225, v7
  v_mul_f32 v226, v226, v7
  v_mul_f32 v227, v227, v7
  v_mul_f32 v228, v228, v7
  v_mul_f32 v229, v229, v7
  v_mul_f32 v230, v230, v7
  v_mul_f32 v231, v231, v7
  v_mul_f32 v232, v232, v7
  v_mul_f32 v233, v233, v7
  v_mul_f32 v234, v234, v7
  v_mul_f32 v235, v235, v7
  v_mul_f32 v236, v236, v7
  v_mul_f32 v237, v237, v7
  v_mul_f32 v238, v238, v7
  v_mul_f32 v239, v239, v7
  v_mul_f32 v240, v240, v7
  v_mul_f32 v241, v241, v7
  v_mul_f32 v242, v242, v7
  v_mul_f32 v243, v243, v7
  v_mul_f32 v244, v244, v7
  v_mul_f32 v245, v245, v7
  v_mul_f32 v246, v246, v7
  v_mul_f32 v247, v247, v7
  v_mul_f32 v248, v248, v7
  v_mul_f32 v249, v249, v7
  v_mul_f32 v250, v250, v7
  v_mul_f32 v251, v251, v7
  v_mul_f32 v252, v252, v7
  v_mul_f32 v253, v253, v7
  v_mul_f32 v254, v254, v7
  v_mul_f32 v255, v255, v7
  v_accvgpr_read_b32 v8, a140
  v_mul_f32 v8, v8, v7
  v_accvgpr_write_b32 a140, v8
  v_accvgpr_read_b32 v8, a141
  v_mul_f32 v8, v8, v7
  v_accvgpr_write_b32 a141, v8
  v_accvgpr_read_b32 v8, a142
  v_mul_f32 v8, v8, v7
  v_accvgpr_write_b32 a142, v8
  v_accvgpr_read_b32 v8, a143
  v_mul_f32 v8, v8, v7
  v_accvgpr_write_b32 a143, v8
  v_sub_f32 v8, v56, v6
  v_sub_f32 v9, v57, v6
  v_sub_f32 v10, v58, v6
  v_sub_f32 v11, v59, v6
  v_sub_f32 v12, v60, v6
  v_sub_f32 v13, v61, v6
  v_sub_f32 v14, v62, v6
  v_sub_f32 v15, v63, v6
  v_exp_f32 v8, v8
  v_exp_f32 v9, v9
  v_exp_f32 v10, v10
  v_exp_f32 v11, v11
  v_exp_f32 v12, v12
  v_exp_f32 v13, v13
  v_exp_f32 v14, v14
  v_exp_f32 v15, v15
  v_cvt_pk_bf16_f32 v92, v8, v9
  v_cvt_pk_bf16_f32 v93, v10, v11
  v_cvt_pk_bf16_f32 v94, v12, v13
  v_cvt_pk_bf16_f32 v95, v14, v15
  s_cmp_eq_u32 s71, 1
  s_cbranch_scc1 L_a_s0_r
  s_cmp_eq_u32 s71, 3
  s_cbranch_scc1 L_a_d1_r
  s_cmp_eq_u32 s71, 5
  s_cbranch_scc1 L_a_d3_r
  s_cmp_eq_u32 s71, 7
  s_cbranch_scc1 L_a_d5_r
  s_branch L_a_d7_r
L_att_end:
  s_branch L_next
L_go_outx:
  s_bfe_u32 s56, s3, 0x40004
  s_bfe_u32 s62, s3, 0x10004
  s_bitcmp1_b32 s3, 3
  s_cbranch_scc1 L_red
L_barr:
  s_mov_b32 s48, s30
  s_and_b32 s49, s31, 0xffff
  s_mov_b32 s50, 0x400000
  s_mov_b32 s51, 0x20000
  v_lshlrev_b32 v2, 4, v0
  v_mov_b32 v7, 0
  s_mov_b32 s57, 0
  v_lshrrev_b32 v3, 4, v0
  v_and_b32 v4, 15, v0
  v_lshlrev_b32 v5, 1, v3
  v_xor_b32 v5, v5, v4
  v_lshlrev_b32 v5, 4, v5
  v_lshl_add_u32 v80, v3, 10, v5
  v_xor_b32 v81, 128, v80
  s_lshl_b32 s66, s44, 15
  s_lshl_b32 s60, s56, 18
  s_lshl_b32 s58, s44, 8
  s_add_u32 s60, s60, s58
  s_add_u32 m0, s66, 0
  s_add_u32 s58, s60, 0
  buffer_load_dwordx4 v80, s[48:51], s58 offen lds
  s_add_u32 m0, s66, 1024
  s_add_u32 s58, s60, 4096
  buffer_load_dwordx4 v81, s[48:51], s58 offen lds
  s_add_u32 m0, s66, 2048
  s_add_u32 s58, s60, 8192
  buffer_load_dwordx4 v80, s[48:51], s58 offen lds
  s_add_u32 m0, s66, 3072
  s_add_u32 s58, s60, 12288
  buffer_load_dwordx4 v81, s[48:51], s58 offen lds
  s_add_u32 m0, s66, 4096
  s_add_u32 s58, s60, 16384
  buffer_load_dwordx4 v80, s[48:51], s58 offen lds
  s_add_u32 m0, s66, 5120
  s_add_u32 s58, s60, 20480
  buffer_load_dwordx4 v81, s[48:51], s58 offen lds
  s_add_u32 m0, s66, 6144
  s_add_u32 s58, s60, 24576
  buffer_load_dwordx4 v80, s[48:51], s58 offen lds
  s_add_u32 m0, s66, 7168
  s_add_u32 s58, s60, 28672
  buffer_load_dwordx4 v81, s[48:51], s58 offen lds
  s_add_u32 m0, s66, 8192
  s_add_u32 s58, s60, 32768
  buffer_load_dwordx4 v80, s[48:51], s58 offen lds
  s_add_u32 m0, s66, 9216
  s_add_u32 s58, s60, 36864
  buffer_load_dwordx4 v81, s[48:51], s58 offen lds
  s_add_u32 m0, s66, 10240
  s_add_u32 s58, s60, 40960
  buffer_load_dwordx4 v80, s[48:51], s58 offen lds
  s_add_u32 m0, s66, 11264
  s_add_u32 s58, s60, 45056
  buffer_load_dwordx4 v81, s[48:51], s58 offen lds
  s_add_u32 m0, s66, 12288
  s_add_u32 s58, s60, 49152
  buffer_load_dwordx4 v80, s[48:51], s58 offen lds
  s_add_u32 m0, s66, 13312
  s_add_u32 s58, s60, 53248
  buffer_load_dwordx4 v81, s[48:51], s58 offen lds
  s_add_u32 m0, s66, 14336
  s_add_u32 s58, s60, 57344
  buffer_load_dwordx4 v80, s[48:51], s58 offen lds
  s_add_u32 m0, s66, 15360
  s_add_u32 s58, s60, 61440
  buffer_load_dwordx4 v81, s[48:51], s58 offen lds
  s_add_u32 m0, s66, 16384
  s_add_u32 s58, s60, 65536
  buffer_load_dwordx4 v80, s[48:51], s58 offen lds
  s_add_u32 m0, s66, 17408
  s_add_u32 s58, s60, 69632
  buffer_load_dwordx4 v81, s[48:51], s58 offen lds
  s_add_u32 m0, s66, 18432
  s_add_u32 s58, s60, 73728
  buffer_load_dwordx4 v80, s[48:51], s58 offen lds
  s_add_u32 m0, s66, 19456
  s_add_u32 s58, s60, 77824
  buffer_load_dwordx4 v81, s[48:51], s58 offen lds
  s_add_u32 m0, s66, 20480
  s_add_u32 s58, s60, 81920
  buffer_load_dwordx4 v80, s[48:51], s58 offen lds
  s_add_u32 m0, s66, 21504
  s_add_u32 s58, s60, 86016
  buffer_load_dwordx4 v81, s[48:51], s58 offen lds
  s_add_u32 m0, s66, 22528
  s_add_u32 s58, s60, 90112
  buffer_load_dwordx4 v80, s[48:51], s58 offen lds
  s_add_u32 m0, s66, 23552
  s_add_u32 s58, s60, 94208
  buffer_load_dwordx4 v81, s[48:51], s58 offen lds
  s_add_u32 m0, s66, 24576
  s_add_u32 s58, s60, 98304
  buffer_load_dwordx4 v80, s[48:51], s58 offen lds
  s_add_u32 m0, s66, 25600
  s_add_u32 s58, s60, 102400
  buffer_load_dwordx4 v81, s[48:51], s58 offen lds
  s_add_u32 m0, s66, 26624
  s_add_u32 s58, s60, 106496
  buffer_load_dwordx4 v80, s[48:51], s58 offen lds
  s_add_u32 m0, s66, 27648
  s_add_u32 s58, s60, 110592
  buffer_load_dwordx4 v81, s[48:51], s58 offen lds
  s_add_u32 m0, s66, 28672
  s_add_u32 s58, s60, 114688
  buffer_load_dwordx4 v80, s[48:51], s58 offen lds
  s_add_u32 m0, s66, 29696
  s_add_u32 s58, s60, 118784
  buffer_load_dwordx4 v81, s[48:51], s58 offen lds
  s_add_u32 m0, s66, 30720
  s_add_u32 s58, s60, 122880
  buffer_load_dwordx4 v80, s[48:51], s58 offen lds
  s_add_u32 m0, s66, 31744
  s_add_u32 s58, s60, 126976
  buffer_load_dwordx4 v81, s[48:51], s58 offen lds
  v_lshrrev_b32 v5, 2, v0
  v_lshl_add_u32 v112, v5, 8, s66
  v_and_b32 v5, 7, v5
  v_lshl_add_u32 v112, v5, 5, v112
  v_and_b32 v5, 3, v0
  v_lshl_add_u32 v112, v5, 3, v112
  v_xor_b32 v113, 32, v112
  v_xor_b32 v114, 64, v112
  v_xor_b32 v115, 96, v112
  v_xor_b32 v116, 128, v112
  v_xor_b32 v117, 160, v112
  v_xor_b32 v118, 192, v112
  v_xor_b32 v119, 224, v112
  s_waitcnt vmcnt(24)
  ds_read_b64_tr_b16 a[0:1], v112 offset:0
  ds_read_b64_tr_b16 a[2:3], v112 offset:4096
  ds_read_b64_tr_b16 a[32:33], v113 offset:0
  ds_read_b64_tr_b16 a[34:35], v113 offset:4096
  ds_read_b64_tr_b16 a[64:65], v114 offset:0
  ds_read_b64_tr_b16 a[66:67], v114 offset:4096
  ds_read_b64_tr_b16 a[96:97], v115 offset:0
  ds_read_b64_tr_b16 a[98:99], v115 offset:4096
  ds_read_b64_tr_b16 a[128:129], v116 offset:0
  ds_read_b64_tr_b16 a[130:131], v116 offset:4096
  ds_read_b64_tr_b16 a[160:161], v117 offset:0
  ds_read_b64_tr_b16 a[162:163], v117 offset:4096
  ds_read_b64_tr_b16 a[192:193], v118 offset:0
  ds_read_b64_tr_b16 a[194:195], v118 offset:4096
  ds_read_b64_tr_b16 a[224:225], v119 offset:0
  ds_read_b64_tr_b16 a[226:227], v119 offset:4096
  s_waitcnt vmcnt(16)
  ds_read_b64_tr_b16 a[4:5], v112 offset:8192
  ds_read_b64_tr_b16 a[6:7], v112 offset:12288
  ds_read_b64_tr_b16 a[36:37], v113 offset:8192
  ds_read_b64_tr_b16 a[38:39], v113 offset:12288
  ds_read_b64_tr_b16 a[68:69], v114 offset:8192
  ds_read_b64_tr_b16 a[70:71], v114 offset:12288
  ds_read_b64_tr_b16 a[100:101], v115 offset:8192
  ds_read_b64_tr_b16 a[102:103], v115 offset:12288
  ds_read_b64_tr_b16 a[132:133], v116 offset:8192
  ds_read_b64_tr_b16 a[134:135], v116 offset:12288
  ds_read_b64_tr_b16 a[164:165], v117 offset:8192
  ds_read_b64_tr_b16 a[166:167], v117 offset:12288
  ds_read_b64_tr_b16 a[196:197], v118 offset:8192
  ds_read_b64_tr_b16 a[198:199], v118 offset:12288
  ds_read_b64_tr_b16 a[228:229], v119 offset:8192
  ds_read_b64_tr_b16 a[230:231], v119 offset:12288
  s_waitcnt vmcnt(8)
  ds_read_b64_tr_b16 a[8:9], v112 offset:16384
  ds_read_b64_tr_b16 a[10:11], v112 offset:20480
  ds_read_b64_tr_b16 a[40:41], v113 offset:16384
  ds_read_b64_tr_b16 a[42:43], v113 offset:20480
  ds_read_b64_tr_b16 a[72:73], v114 offset:16384
  ds_read_b64_tr_b16 a[74:75], v114 offset:20480
  ds_read_b64_tr_b16 a[104:105], v115 offset:16384
  ds_read_b64_tr_b16 a[106:107], v115 offset:20480
  ds_read_b64_tr_b16 a[136:137], v116 offset:16384
  ds_read_b64_tr_b16 a[138:139], v116 offset:20480
  ds_read_b64_tr_b16 a[168:169], v117 offset:16384
  ds_read_b64_tr_b16 a[170:171], v117 offset:20480
  ds_read_b64_tr_b16 a[200:201], v118 offset:16384
  ds_read_b64_tr_b16 a[202:203], v118 offset:20480
  ds_read_b64_tr_b16 a[232:233], v119 offset:16384
  ds_read_b64_tr_b16 a[234:235], v119 offset:20480
  s_waitcnt vmcnt(0)
  ds_read_b64_tr_b16 a[12:13], v112 offset:24576
  ds_read_b64_tr_b16 a[14:15], v112 offset:28672
  ds_read_b64_tr_b16 a[44:45], v113 offset:24576
  ds_read_b64_tr_b16 a[46:47], v113 offset:28672
  ds_read_b64_tr_b16 a[76:77], v114 offset:24576
  ds_read_b64_tr_b16 a[78:79], v114 offset:28672
  ds_read_b64_tr_b16 a[108:109], v115 offset:24576
  ds_read_b64_tr_b16 a[110:111], v115 offset:28672
  ds_read_b64_tr_b16 a[140:141], v116 offset:24576
  ds_read_b64_tr_b16 a[142:143], v116 offset:28672
  ds_read_b64_tr_b16 a[172:173], v117 offset:24576
  ds_read_b64_tr_b16 a[174:175], v117 offset:28672
  ds_read_b64_tr_b16 a[204:205], v118 offset:24576
  ds_read_b64_tr_b16 a[206:207], v118 offset:28672
  ds_read_b64_tr_b16 a[236:237], v119 offset:24576
  ds_read_b64_tr_b16 a[238:239], v119 offset:28672
  s_waitcnt lgkmcnt(0)
  s_add_u32 m0, s66, 0
  s_add_u32 s58, s60, 131072
  buffer_load_dwordx4 v80, s[48:51], s58 offen lds
  s_add_u32 m0, s66, 1024
  s_add_u32 s58, s60, 135168
  buffer_load_dwordx4 v81, s[48:51], s58 offen lds
  s_add_u32 m0, s66, 2048
  s_add_u32 s58, s60, 139264
  buffer_load_dwordx4 v80, s[48:51], s58 offen lds
  s_add_u32 m0, s66, 3072
  s_add_u32 s58, s60, 143360
  buffer_load_dwordx4 v81, s[48:51], s58 offen lds
  s_add_u32 m0, s66, 4096
  s_add_u32 s58, s60, 147456
  buffer_load_dwordx4 v80, s[48:51], s58 offen lds
  s_add_u32 m0, s66, 5120
  s_add_u32 s58, s60, 151552
  buffer_load_dwordx4 v81, s[48:51], s58 offen lds
  s_add_u32 m0, s66, 6144
  s_add_u32 s58, s60, 155648
  buffer_load_dwordx4 v80, s[48:51], s58 offen lds
  s_add_u32 m0, s66, 7168
  s_add_u32 s58, s60, 159744
  buffer_load_dwordx4 v81, s[48:51], s58 offen lds
  s_add_u32 m0, s66, 8192
  s_add_u32 s58, s60, 163840
  buffer_load_dwordx4 v80, s[48:51], s58 offen lds
  s_add_u32 m0, s66, 9216
  s_add_u32 s58, s60, 167936
  buffer_load_dwordx4 v81, s[48:51], s58 offen lds
  s_add_u32 m0, s66, 10240
  s_add_u32 s58, s60, 172032
  buffer_load_dwordx4 v80, s[48:51], s58 offen lds
  s_add_u32 m0, s66, 11264
  s_add_u32 s58, s60, 176128
  buffer_load_dwordx4 v81, s[48:51], s58 offen lds
  s_add_u32 m0, s66, 12288
  s_add_u32 s58, s60, 180224
  buffer_load_dwordx4 v80, s[48:51], s58 offen lds
  s_add_u32 m0, s66, 13312
  s_add_u32 s58, s60, 184320
  buffer_load_dwordx4 v81, s[48:51], s58 offen lds
  s_add_u32 m0, s66, 14336
  s_add_u32 s58, s60, 188416
  buffer_load_dwordx4 v80, s[48:51], s58 offen lds
  s_add_u32 m0, s66, 15360
  s_add_u32 s58, s60, 192512
  buffer_load_dwordx4 v81, s[48:51], s58 offen lds
  s_add_u32 m0, s66, 16384
  s_add_u32 s58, s60, 196608
  buffer_load_dwordx4 v80, s[48:51], s58 offen lds
  s_add_u32 m0, s66, 17408
  s_add_u32 s58, s60, 200704
  buffer_load_dwordx4 v81, s[48:51], s58 offen lds
  s_add_u32 m0, s66, 18432
  s_add_u32 s58, s60, 204800
  buffer_load_dwordx4 v80, s[48:51], s58 offen lds
  s_add_u32 m0, s66, 19456
  s_add_u32 s58, s60, 208896
  buffer_load_dwordx4 v81, s[48:51], s58 offen lds
  s_add_u32 m0, s66, 20480
  s_add_u32 s58, s60, 212992
  buffer_load_dwordx4 v80, s[48:51], s58 offen lds
  s_add_u32 m0, s66, 21504
  s_add_u32 s58, s60, 217088
  buffer_load_dwordx4 v81, s[48:51], s58 offen lds
  s_add_u32 m0, s66, 22528
  s_add_u32 s58, s60, 221184
  buffer_load_dwordx4 v80, s[48:51], s58 offen lds
  s_add_u32 m0, s66, 23552
  s_add_u32 s58, s60, 225280
  buffer_load_dwordx4 v81, s[48:51], s58 offen lds
  s_add_u32 m0, s66, 24576
  s_add_u32 s58, s60, 229376
  buffer_load_dwordx4 v80, s[48:51], s58 offen lds
  s_add_u32 m0, s66, 25600
  s_add_u32 s58, s60, 233472
  buffer_load_dwordx4 v81, s[48:51], s58 offen lds
  s_add_u32 m0, s66, 26624
  s_add_u32 s58, s60, 237568
  buffer_load_dwordx4 v80, s[48:51], s58 offen lds
  s_add_u32 m0, s66, 27648
  s_add_u32 s58, s60, 241664
  buffer_load_dwordx4 v81, s[48:51], s58 offen lds
  s_add_u32 m0, s66, 28672
  s_add_u32 s58, s60, 245760
  buffer_load_dwordx4 v80, s[48:51], s58 offen lds
  s_add_u32 m0, s66, 29696
  s_add_u32 s58, s60, 249856
  buffer_load_dwordx4 v81, s[48:51], s58 offen lds
  s_add_u32 m0, s66, 30720
  s_add_u32 s58, s60, 253952
  buffer_load_dwordx4 v80, s[48:51], s58 offen lds
  s_add_u32 m0, s66, 31744
  s_add_u32 s58, s60, 258048
  buffer_load_dwordx4 v81, s[48:51], s58 offen lds
  s_lshr_b32 s58, s44, 1
  s_lshl1_add_u32 s61, s56, s58
  s_and_b32 s59, s44, 1
  s_lshl_b32 s60, s44, 12
  s_add_u32 s60, s60, 131072
  v_bfe_u32 v6, v0, 3, 1
  v_lshl_add_u32 v8, v6, 8, s60
  v_lshl_add_u32 v8, v3, 6, v8
  v_and_b32 v6, 7, v0
  v_lshl_add_u32 v8, v6, 3, v8
  v_lshrrev_b32 v6, 5, v0
  v_lshl_add_u32 v9, v6, 8, s60
  v_and_b32 v6, 3, v0
  v_lshl_add_u32 v9, v6, 6, v9
  v_bfe_u32 v6, v0, 2, 3
  v_lshl_add_u32 v9, v6, 3, v9
  s_mul_i32 s60, s58, 24576
  v_add_u32 v12, s60, v2
  s_lshl_b32 s66, s59, 10
  v_add_u32 v15, s66, v12
  s_lshl_b32 s66, s59, 12
  s_lshl_b32 s67, s61, 19
  s_add_u32 s67, s67, s66
  s_add_u32 s67, s67, 0x3000000
  s_add_u32 s66, s66, s60
  s_lshl1_add_u32 s60, s59, s58
  s_lshl_b32 s60, s60, 12
  s_add_u32 s60, s60, 98304
  v_add_u32 v13, s60, v2
  v_add_u32 v14, 98304, v2
  s_lshl_b32 s60, s59, 4
  v_add_u32 v4, s60, v4
  v_lshlrev_b32 v31, 2, v4
  v_add_u32 v31, 0xd0c0000, v31
  v_lshlrev_b32 v3, 2, v3
  v_sub_u32 v4, v4, v3
  v_mov_b32 v6, 0xff800000
  s_lshl_b32 s73, s61, 7
  s_add_u32 s73, s73, 0xd081000
  s_lshl_b32 s69, s61, 12
  s_add_u32 s69, s69, 0xc020000
  s_lshl2_add_u32 s70, s56, s44
  s_lshl_b32 s70, s70, 12
  s_add_u32 s70, s70, 0x6020000
  v_mov_b32 v241, 1
  v_lshlrev_b32 v5, 2, v0
  v_add_u32 v5, 147456, v5
  ds_write_b32 v5, v7
  v_cmp_gt_i32 vcc, 0, v4
  v_mov_b32 v16, 0x3f803f80
  s_nop 0
  v_cndmask_b32 v20, 0, v6, vcc
  v_cmp_gt_i32 vcc, 1, v4
  v_mov_b32 v17, 0x3f803f80
  s_nop 0
  v_cndmask_b32 v21, 0, v6, vcc
  v_cmp_gt_i32 vcc, 2, v4
  v_mov_b32 v18, 0x3f803f80
  s_nop 0
  v_cndmask_b32 v22, 0, v6, vcc
  v_cmp_gt_i32 vcc, 3, v4
  v_mov_b32 v19, 0x3f803f80
  s_nop 0
  v_cndmask_b32 v23, 0, v6, vcc
  v_cmp_gt_i32 vcc, 16, v4
  v_mov_b32 v16, 0x3f803f80
  s_nop 0
  v_cndmask_b32 v24, 0, v6, vcc
  v_cmp_gt_i32 vcc, 17, v4
  v_mov_b32 v17, 0x3f803f80
  s_nop 0
  v_cndmask_b32 v25, 0, v6, vcc
  v_cmp_gt_i32 vcc, 18, v4
  v_mov_b32 v18, 0x3f803f80
  s_nop 0
  v_cndmask_b32 v26, 0, v6, vcc
  v_cmp_gt_i32 vcc, 19, v4
  v_mov_b32 v19, 0x3f803f80
  s_nop 0
  v_cndmask_b32 v27, 0, v6, vcc
  v_mov_b32 v33, 0
  v_mov_b32 v34, 0
  s_waitcnt vmcnt(24)
  ds_read_b64_tr_b16 a[16:17], v112 offset:0
  ds_read_b64_tr_b16 a[18:19], v112 offset:4096
  ds_read_b64_tr_b16 a[48:49], v113 offset:0
  ds_read_b64_tr_b16 a[50:51], v113 offset:4096
  ds_read_b64_tr_b16 a[80:81], v114 offset:0
  ds_read_b64_tr_b16 a[82:83], v114 offset:4096
  ds_read_b64_tr_b16 a[112:113], v115 offset:0
  ds_read_b64_tr_b16 a[114:115], v115 offset:4096
  ds_read_b64_tr_b16 a[144:145], v116 offset:0
  ds_read_b64_tr_b16 a[146:147], v116 offset:4096
  ds_read_b64_tr_b16 a[176:177], v117 offset:0
  ds_read_b64_tr_b16 a[178:179], v117 offset:4096
  ds_read_b64_tr_b16 a[208:209], v118 offset:0
  ds_read_b64_tr_b16 a[210:211], v118 offset:4096
  ds_read_b64_tr_b16 a[240:241], v119 offset:0
  ds_read_b64_tr_b16 a[242:243], v119 offset:4096
  s_waitcnt vmcnt(16)
  ds_read_b64_tr_b16 a[20:21], v112 offset:8192
  ds_read_b64_tr_b16 a[22:23], v112 offset:12288
  ds_read_b64_tr_b16 a[52:53], v113 offset:8192
  ds_read_b64_tr_b16 a[54:55], v113 offset:12288
  ds_read_b64_tr_b16 a[84:85], v114 offset:8192
  ds_read_b64_tr_b16 a[86:87], v114 offset:12288
  ds_read_b64_tr_b16 a[116:117], v115 offset:8192
  ds_read_b64_tr_b16 a[118:119], v115 offset:12288
  ds_read_b64_tr_b16 a[148:149], v116 offset:8192
  ds_read_b64_tr_b16 a[150:151], v116 offset:12288
  ds_read_b64_tr_b16 a[180:181], v117 offset:8192
  ds_read_b64_tr_b16 a[182:183], v117 offset:12288
  ds_read_b64_tr_b16 a[212:213], v118 offset:8192
  ds_read_b64_tr_b16 a[214:215], v118 offset:12288
  ds_read_b64_tr_b16 a[244:245], v119 offset:8192
  ds_read_b64_tr_b16 a[246:247], v119 offset:12288
  s_waitcnt vmcnt(8)
  ds_read_b64_tr_b16 a[24:25], v112 offset:16384
  ds_read_b64_tr_b16 a[26:27], v112 offset:20480
  ds_read_b64_tr_b16 a[56:57], v113 offset:16384
  ds_read_b64_tr_b16 a[58:59], v113 offset:20480
  ds_read_b64_tr_b16 a[88:89], v114 offset:16384
  ds_read_b64_tr_b16 a[90:91], v114 offset:20480
  ds_read_b64_tr_b16 a[120:121], v115 offset:16384
  ds_read_b64_tr_b16 a[122:123], v115 offset:20480
  ds_read_b64_tr_b16 a[152:153], v116 offset:16384
  ds_read_b64_tr_b16 a[154:155], v116 offset:20480
  ds_read_b64_tr_b16 a[184:185], v117 offset:16384
  ds_read_b64_tr_b16 a[186:187], v117 offset:20480
  ds_read_b64_tr_b16 a[216:217], v118 offset:16384
  ds_read_b64_tr_b16 a[218:219], v118 offset:20480
  ds_read_b64_tr_b16 a[248:249], v119 offset:16384
  ds_read_b64_tr_b16 a[250:251], v119 offset:20480
  s_waitcnt vmcnt(0)
  ds_read_b64_tr_b16 a[28:29], v112 offset:24576
  ds_read_b64_tr_b16 a[30:31], v112 offset:28672
  ds_read_b64_tr_b16 a[60:61], v113 offset:24576
  ds_read_b64_tr_b16 a[62:63], v113 offset:28672
  ds_read_b64_tr_b16 a[92:93], v114 offset:24576
  ds_read_b64_tr_b16 a[94:95], v114 offset:28672
  ds_read_b64_tr_b16 a[124:125], v115 offset:24576
  ds_read_b64_tr_b16 a[126:127], v115 offset:28672
  ds_read_b64_tr_b16 a[156:157], v116 offset:24576
  ds_read_b64_tr_b16 a[158:159], v116 offset:28672
  ds_read_b64_tr_b16 a[188:189], v117 offset:24576
  ds_read_b64_tr_b16 a[190:191], v117 offset:28672
  ds_read_b64_tr_b16 a[220:221], v118 offset:24576
  ds_read_b64_tr_b16 a[222:223], v118 offset:28672
  ds_read_b64_tr_b16 a[252:253], v119 offset:24576
  ds_read_b64_tr_b16 a[254:255], v119 offset:28672
  s_waitcnt lgkmcnt(0)
  s_lshl_b32 s58, s61, 7
  s_add_u32 s58, s58, 0xd080010
  v_lshl_add_u32 v3, v0, 2, s58
  v_and_b32 v4, 7, v0
  v_lshlrev_b32 v4, 7, v4
  v_add_u32 v4, 0xd086400, v4
  v_cmp_gt_u32 vcc, 2, v0
  v_mov_b32 v240, 0
  s_nop 0
  v_cndmask_b32 v3, v4, v3, vcc
  v_cndmask_b32 v4, 16, 32, vcc
L_b_w0:
  buffer_load_dword v5, v3, s[40:43], 0 offen sc1
  s_add_u32 s57, s57, 1
  s_cmp_gt_u32 s57, 1048576
  s_cbranch_scc1 L_exit
  s_waitcnt vmcnt(0)
  v_cmp_ne_u32 vcc, v4, v5
  s_cbranch_vccnz L_b_w0
  v_readlane_b32 s63, v1, s95
  s_add_u32 s95, s95, 1
  s_mov_b32 s64, 4
  v_readlane_b32 s65, v1, s95
  s_barrier
  s_lshr_b32 s59, s63, 4
  s_lshl_b32 s68, s63, 9
  s_add_u32 s68, s68, s67
  s_lshl_b32 s74, s63, 3
  s_bitcmp1_b32 s63, 2
  s_cselect_b32 s68, 0x40000000, s68
  s_cselect_b32 s74, 0x40000000, s74
  s_cselect_b32 s59, -1, s59
L_b_ff_1c:
  v_cmp_lt_i32 vcc, s59, v240
  s_cbranch_vccz L_b_ff_1
  s_add_u32 m0, s66, 0
  s_add_u32 s59, s68, 0x0
  buffer_load_dwordx4 v2, s[40:43], s59 offen offset:0 sc1 lds
  buffer_load_dwordx4 v2, s[40:43], s59 offen offset:1024 sc1 lds
  buffer_load_dwordx4 v2, s[40:43], s59 offen offset:2048 sc1 lds
  buffer_load_dwordx4 v2, s[40:43], s59 offen offset:3072 sc1 lds
  s_add_u32 m0, s66, 8192
  s_add_u32 s59, s68, 0x1000000
  buffer_load_dwordx4 v2, s[40:43], s59 offen offset:0 sc1 lds
  buffer_load_dwordx4 v2, s[40:43], s59 offen offset:1024 sc1 lds
  buffer_load_dwordx4 v2, s[40:43], s59 offen offset:2048 sc1 lds
  buffer_load_dwordx4 v2, s[40:43], s59 offen offset:3072 sc1 lds
  s_add_u32 m0, s66, 16384
  s_add_u32 s59, s68, 0x2000000
  buffer_load_dwordx4 v2, s[40:43], s59 offen offset:0 sc1 lds
  buffer_load_dwordx4 v2, s[40:43], s59 offen offset:1024 sc1 lds
  buffer_load_dwordx4 v2, s[40:43], s59 offen offset:2048 sc1 lds
  buffer_load_dwordx4 v2, s[40:43], s59 offen offset:3072 sc1 lds
  buffer_load_dword v11, v31, s[40:43], s74 offen sc1
  buffer_load_dword v240, v7, s[40:43], s73 offen sc1
  s_lshl_b32 s58, s63, 13
  s_add_u32 s58, s58, s69
  buffer_load_dwordx4 v[56:59], v2, s[40:43], s58 offen offset:0 sc1
  buffer_load_dwordx4 v[60:63], v2, s[40:43], s58 offen offset:1024 sc1
  buffer_load_dwordx4 v[64:67], v2, s[40:43], s58 offen offset:2048 sc1
  buffer_load_dwordx4 v[68:71], v2, s[40:43], s58 offen offset:3072 sc1
  s_cmp_ge_u32 s66, 49152
  s_mov_b32 s60, 49152
  s_cmov_b32 s60, -49152
  s_add_u32 s66, s66, s60
  s_waitcnt vmcnt(0)
  s_barrier
  v_sub_f32 v10, 1.0, v11
  s_lshr_b32 s59, s65, 4
  s_lshl_b32 s68, s65, 9
  s_add_u32 s68, s68, s67
  s_lshl_b32 s74, s65, 3
  s_bitcmp1_b32 s65, 2
  s_cselect_b32 s68, 0x40000000, s68
  s_cselect_b32 s74, 0x40000000, s74
  s_cselect_b32 s59, -1, s59
L_b_ff_2c:
  v_cmp_lt_i32 vcc, s59, v240
  s_cbranch_vccz L_b_ff_2
  s_add_u32 m0, s66, 0
  s_add_u32 s59, s68, 0x0
  buffer_load_dwordx4 v2, s[40:43], s59 offen offset:0 sc1 lds
  buffer_load_dwordx4 v2, s[40:43], s59 offen offset:1024 sc1 lds
  buffer_load_dwordx4 v2, s[40:43], s59 offen offset:2048 sc1 lds
  buffer_load_dwordx4 v2, s[40:43], s59 offen offset:3072 sc1 lds
  s_add_u32 m0, s66, 8192
  s_add_u32 s59, s68, 0x1000000
  buffer_load_dwordx4 v2, s[40:43], s59 offen offset:0 sc1 lds
  buffer_load_dwordx4 v2, s[40:43], s59 offen offset:1024 sc1 lds
  buffer_load_dwordx4 v2, s[40:43], s59 offen offset:2048 sc1 lds
  buffer_load_dwordx4 v2, s[40:43], s59 offen offset:3072 sc1 lds
  s_add_u32 m0, s66, 16384
  s_add_u32 s59, s68, 0x2000000
  buffer_load_dwordx4 v2, s[40:43], s59 offen offset:0 sc1 lds
  buffer_load_dwordx4 v2, s[40:43], s59 offen offset:1024 sc1 lds
  buffer_load_dwordx4 v2, s[40:43], s59 offen offset:2048 sc1 lds
  buffer_load_dwordx4 v2, s[40:43], s59 offen offset:3072 sc1 lds
  buffer_load_dword v11, v31, s[40:43], s74 offen sc1
  buffer_load_dword v240, v7, s[40:43], s73 offen sc1
  s_cmp_ge_u32 s66, 49152
  s_mov_b32 s60, 49152
  s_cmov_b32 s60, -49152
  s_add_u32 s66, s66, s60
L_b_chk:
  v_max3_u32 v3, v56, v60, v64
  v_max_u32 v3, v3, v68
  v_cmp_eq_u32 vcc, -1, v3
  s_cbranch_vccnz L_b_late
  ds_write2st64_b32 v8, v56, v57 offset0:0 offset1:8
  ds_write2st64_b32 v8, v60, v61 offset0:2 offset1:10
  ds_write2st64_b32 v8, v64, v65 offset0:4 offset1:12
  ds_write2st64_b32 v8, v68, v69 offset0:6 offset1:14
  ds_read_b128 v[80:83], v15 offset:0
  ds_read_b128 v[112:115], v12 offset:8192
  ds_read_b128 v[116:119], v12 offset:9216
  ds_read_b128 v[84:87], v15 offset:2048
  ds_read_b128 v[120:123], v12 offset:10240
  ds_read_b128 v[124:127], v12 offset:11264
  ds_read_b128 v[88:91], v15 offset:4096
  ds_read_b128 v[128:131], v12 offset:12288
  ds_read_b128 v[132:135], v12 offset:13312
  ds_read_b128 v[92:95], v15 offset:6144
  ds_read_b128 v[136:139], v12 offset:14336
  ds_read_b128 v[140:143], v12 offset:15360
  v_mov_b64 v[72:73], v[58:59]
  v_mov_b64 v[74:75], v[62:63]
  v_mov_b64 v[76:77], v[66:67]
  v_mov_b64 v[78:79], v[70:71]
  s_waitcnt lgkmcnt(12)
  s_lshl_b32 s58, s65, 13
  s_add_u32 s58, s58, s69
  buffer_load_dwordx4 v[56:59], v2, s[40:43], s58 offen offset:0 sc1
  buffer_load_dwordx4 v[60:63], v2, s[40:43], s58 offen offset:1024 sc1
  buffer_load_dwordx4 v[64:67], v2, s[40:43], s58 offen offset:2048 sc1
  buffer_load_dwordx4 v[68:71], v2, s[40:43], s58 offen offset:3072 sc1
  s_waitcnt lgkmcnt(9)
  v_mfma_f32_16x16x32_bf16 v[40:43], v[112:115], v[80:83], v[20:23]
  ds_read_b64_tr_b16 v[96:97], v9 offset:0
  v_mfma_f32_16x16x32_bf16 v[44:47], v[116:119], v[80:83], v[24:27]
  ds_read_b64_tr_b16 v[98:99], v9 offset:2048
  s_waitcnt lgkmcnt(8)
  v_mfma_f32_16x16x32_bf16 v[40:43], v[120:123], v[84:87], v[40:43]
  ds_read_b64_tr_b16 v[100:101], v9 offset:512
  v_mfma_f32_16x16x32_bf16 v[44:47], v[124:127], v[84:87], v[44:47]
  ds_read_b64_tr_b16 v[102:103], v9 offset:2560
  s_waitcnt lgkmcnt(7)
  v_mfma_f32_16x16x32_bf16 v[40:43], v[128:131], v[88:91], v[40:43]
  ds_read_b64_tr_b16 v[104:105], v9 offset:1024
  v_mfma_f32_16x16x32_bf16 v[44:47], v[132:135], v[88:91], v[44:47]
  ds_read_b64_tr_b16 v[106:107], v9 offset:3072
  s_waitcnt lgkmcnt(6)
  v_mfma_f32_16x16x32_bf16 v[40:43], v[136:139], v[92:95], v[40:43]
  ds_read_b64_tr_b16 v[108:109], v9 offset:1536
  v_mfma_f32_16x16x32_bf16 v[44:47], v[140:143], v[92:95], v[44:47]
  ds_read_b64_tr_b16 v[110:111], v9 offset:3584
  ds_read_b128 v[112:115], v12 offset:16384
  ds_read_b128 v[116:119], v12 offset:17408
  ds_read_b128 v[120:123], v12 offset:18432
  ds_read_b128 v[124:127], v12 offset:19456
  s_waitcnt lgkmcnt(4)
  v_mfma_f32_16x16x32_bf16 v[48:51], v[96:99], v[80:83], 0
  ds_read_b128 v[128:131], v12 offset:20480
  v_mfma_f32_16x16x32_bf16 v[48:51], v[100:103], v[84:87], v[48:51]
  ds_read_b128 v[132:135], v12 offset:21504
  v_mfma_f32_16x16x32_bf16 v[48:51], v[104:107], v[88:91], v[48:51]
  ds_read_b128 v[136:139], v12 offset:22528
  v_mfma_f32_16x16x32_bf16 v[48:51], v[108:111], v[92:95], v[48:51]
  ds_read_b128 v[140:143], v12 offset:23552
  v_subrev_u32 v12, s60, v12
  v_subrev_u32 v15, s60, v15
  v_max_f32 v3, v40, v41
  v_max3_f32 v3, v3, v42, v43
  v_max3_f32 v3, v3, v44, v45
  v_max3_f32 v3, v3, v46, v47
  s_nop 0
  v_max3_f32 v3, v3, v48, v49
  v_mov_b32 v4, v3
  s_nop 1
  v_permlane32_swap_b32 v4, v3
  v_max_f32 v3, v3, v4
  v_mov_b32 v4, v3
  s_nop 1
  v_permlane16_swap_b32 v4, v3
  v_max_f32 v3, v3, v4
  v_sub_f32 v40, v40, v3
  v_sub_f32 v41, v41, v3
  v_sub_f32 v42, v42, v3
  v_sub_f32 v43, v43, v3
  v_sub_f32 v44, v44, v3
  v_sub_f32 v45, v45, v3
  v_sub_f32 v46, v46, v3
  v_sub_f32 v47, v47, v3
  v_sub_f32 v48, v48, v3
  v_sub_f32 v49, v49, v3
  v_exp_f32 v40, v40
  v_exp_f32 v41, v41
  v_exp_f32 v42, v42
  v_exp_f32 v43, v43
  v_exp_f32 v44, v44
  v_exp_f32 v45, v45
  v_exp_f32 v46, v46
  v_exp_f32 v47, v47
  v_exp_f32 v48, v48
  v_exp_f32 v49, v49
  v_cvt_pk_bf16_f32 v36, v40, v41
  v_cvt_pk_bf16_f32 v37, v42, v43
  v_cvt_pk_bf16_f32 v38, v44, v45
  v_cvt_pk_bf16_f32 v39, v46, v47
  v_cvt_pk_bf16_f32 v32, v48, v49
  v_cvt_pk_bf16_f32 v35, v48, v49
  s_waitcnt lgkmcnt(0)
  v_mfma_f32_16x16x32_bf16 v[52:55], v[16:19], v[36:39], 0
  v_mfma_f32_16x16x32_bf16 v[80:83], v[112:115], v[36:39], 0
  v_mfma_f32_16x16x32_bf16 v[84:87], v[116:119], v[36:39], 0
  v_mfma_f32_16x16x32_bf16 v[88:91], v[120:123], v[36:39], 0
  v_mfma_f32_16x16x32_bf16 v[92:95], v[124:127], v[36:39], 0
  v_mfma_f32_16x16x32_bf16 v[96:99], v[128:131], v[36:39], 0
  v_mfma_f32_16x16x32_bf16 v[100:103], v[132:135], v[36:39], 0
  v_mfma_f32_16x16x16_bf16 v[52:55], v[16:17], v[32:33], v[52:55]
  v_mfma_f32_16x16x32_bf16 v[104:107], v[136:139], v[36:39], 0
  v_mfma_f32_16x16x32_bf16 v[108:111], v[140:143], v[36:39], 0
  v_mfma_f32_16x16x16_bf16 v[80:83], v[72:73], v[32:33], v[80:83]
  v_mfma_f32_16x16x16_bf16 v[84:87], v[72:73], v[34:35], v[84:87]
  v_mfma_f32_16x16x16_bf16 v[88:91], v[74:75], v[32:33], v[88:91]
  v_mfma_f32_16x16x16_bf16 v[92:95], v[74:75], v[34:35], v[92:95]
  v_mfma_f32_16x16x16_bf16 v[96:99], v[76:77], v[32:33], v[96:99]
  v_mfma_f32_16x16x16_bf16 v[100:103], v[76:77], v[34:35], v[100:103]
  v_rcp_f32 v3, v52
  v_mfma_f32_16x16x16_bf16 v[104:107], v[78:79], v[32:33], v[104:107]
  v_mul_f32 v3, v3, v10
  v_mfma_f32_16x16x16_bf16 v[108:111], v[78:79], v[34:35], v[108:111]
  v_mul_f32 v80, v80, v3
  v_mul_f32 v81, v81, v3
  v_mul_f32 v82, v82, v3
  v_mul_f32 v83, v83, v3
  v_mul_f32 v84, v84, v3
  v_mul_f32 v85, v85, v3
  v_mul_f32 v86, v86, v3
  v_mul_f32 v87, v87, v3
  v_cvt_pk_bf16_f32 v144, v80, v81
  v_cvt_pk_bf16_f32 v145, v82, v83
  v_cvt_pk_bf16_f32 v146, v84, v85
  v_cvt_pk_bf16_f32 v147, v86, v87
  ds_write_b128 v13, v[144:147] offset:0
  v_mul_f32 v88, v88, v3
  v_mul_f32 v89, v89, v3
  v_mul_f32 v90, v90, v3
  v_mul_f32 v91, v91, v3
  v_mul_f32 v92, v92, v3
  v_mul_f32 v93, v93, v3
  v_mul_f32 v94, v94, v3
  v_mul_f32 v95, v95, v3
  v_cvt_pk_bf16_f32 v148, v88, v89
  v_cvt_pk_bf16_f32 v149, v90, v91
  v_cvt_pk_bf16_f32 v150, v92, v93
  v_cvt_pk_bf16_f32 v151, v94, v95
  ds_write_b128 v13, v[148:151] offset:1024
  v_mul_f32 v96, v96, v3
  v_mul_f32 v97, v97, v3
  v_mul_f32 v98, v98, v3
  v_mul_f32 v99, v99, v3
  v_mul_f32 v100, v100, v3
  v_mul_f32 v101, v101, v3
  v_mul_f32 v102, v102, v3
  v_mul_f32 v103, v103, v3
  s_waitcnt lgkmcnt(1)
  v_cvt_pk_bf16_f32 v144, v96, v97
  v_cvt_pk_bf16_f32 v145, v98, v99
  v_cvt_pk_bf16_f32 v146, v100, v101
  v_cvt_pk_bf16_f32 v147, v102, v103
  ds_write_b128 v13, v[144:147] offset:2048
  v_mul_f32 v104, v104, v3
  v_mul_f32 v105, v105, v3
  v_mul_f32 v106, v106, v3
  v_mul_f32 v107, v107, v3
  v_mul_f32 v108, v108, v3
  v_mul_f32 v109, v109, v3
  v_mul_f32 v110, v110, v3
  v_mul_f32 v111, v111, v3
  s_waitcnt lgkmcnt(1)
  v_cvt_pk_bf16_f32 v148, v104, v105
  v_cvt_pk_bf16_f32 v149, v106, v107
  v_cvt_pk_bf16_f32 v150, v108, v109
  v_cvt_pk_bf16_f32 v151, v110, v111
  ds_write_b128 v13, v[148:151] offset:3072
  v_xor_b32 v13, 0x4000, v13
  s_waitcnt vmcnt(0)
L_b_join:
  s_mov_b32 s62, s63
  s_mov_b32 s63, s65
  s_bitcmp1_b32 s63, 2
  s_cselect_b32 s58, 0, 1
  s_add_u32 s95, s95, s58
  v_sub_f32 v10, 1.0, v11
  v_readlane_b32 s65, v1, s95
  s_mul_i32 s71, s62, 49152
  s_add_u32 s71, s71, s70
  s_lshr_b32 s59, s65, 4
  s_lshl_b32 s68, s65, 9
  s_add_u32 s68, s68, s67
  s_lshl_b32 s74, s65, 3
  s_bitcmp1_b32 s65, 2
  s_cselect_b32 s68, 0x40000000, s68
  s_cselect_b32 s74, 0x40000000, s74
  s_cselect_b32 s59, -1, s59
L_b_ff_3c:
  v_cmp_lt_i32 vcc, s59, v240
  s_cbranch_vccz L_b_ff_3
  v_max3_u32 v3, v56, v60, v64
  v_max_u32 v3, v3, v68
  v_cmp_eq_u32 vcc, -1, v3
  s_bitcmp1_b32 s63, 2
  s_waitcnt lgkmcnt(0)
  s_barrier
  s_cbranch_scc1 L_b_alone
  s_cbranch_vccnz L_b_alone
  s_sub_u32 s60, 0, s60
  ds_read_b128 v[152:155], v14 offset:0
  ds_read_b128 v[156:159], v14 offset:1024
  ds_read_b128 v[160:163], v14 offset:2048
  ds_read_b128 v[164:167], v14 offset:3072
  ds_read_b128 v[168:171], v14 offset:4096
  ds_read_b128 v[172:175], v14 offset:5120
  ds_read_b128 v[176:179], v14 offset:6144
  ds_read_b128 v[180:183], v14 offset:7168
  s_waitcnt lgkmcnt(7)
  v_mfma_f32_16x16x32_bf16 v[216:219], a[0:3], v[152:155], 0
  s_waitcnt lgkmcnt(6)
  v_mfma_f32_16x16x32_bf16 v[216:219], a[4:7], v[156:159], v[216:219]
  s_waitcnt lgkmcnt(5)
  v_mfma_f32_16x16x32_bf16 v[216:219], a[8:11], v[160:163], v[216:219]
  s_waitcnt lgkmcnt(4)
  v_mfma_f32_16x16x32_bf16 v[216:219], a[12:15], v[164:167], v[216:219]
  s_waitcnt lgkmcnt(3)
  ds_write2st64_b32 v8, v56, v57 offset0:0 offset1:8
  ds_write2st64_b32 v8, v60, v61 offset0:2 offset1:10
  v_mfma_f32_16x16x32_bf16 v[216:219], a[16:19], v[168:171], v[216:219]
  s_waitcnt lgkmcnt(4)
  ds_write2st64_b32 v8, v64, v65 offset0:4 offset1:12
  ds_write2st64_b32 v8, v68, v69 offset0:6 offset1:14
  v_mfma_f32_16x16x32_bf16 v[216:219], a[20:23], v[172:175], v[216:219]
  s_waitcnt lgkmcnt(5)
  ds_read_b128 v[80:83], v15 offset:0
  ds_read_b128 v[112:115], v12 offset:8192
  v_mfma_f32_16x16x32_bf16 v[216:219], a[24:27], v[176:179], v[216:219]
  s_waitcnt lgkmcnt(6)
  ds_read_b128 v[116:119], v12 offset:9216
  ds_read_b128 v[84:87], v15 offset:2048
  v_mfma_f32_16x16x32_bf16 v[216:219], a[28:31], v[180:183], v[216:219]
  s_nop 0
  ds_read_b128 v[120:123], v12 offset:10240
  ds_read_b128 v[124:127], v12 offset:11264
  v_mfma_f32_16x16x32_bf16 v[220:223], a[32:35], v[152:155], 0
  s_nop 0
  ds_read_b128 v[88:91], v15 offset:4096
  ds_read_b128 v[128:131], v12 offset:12288
  v_mfma_f32_16x16x32_bf16 v[220:223], a[36:39], v[156:159], v[220:223]
  s_nop 0
  ds_read_b128 v[132:135], v12 offset:13312
  ds_read_b128 v[92:95], v15 offset:6144
  v_mfma_f32_16x16x32_bf16 v[220:223], a[40:43], v[160:163], v[220:223]
  s_nop 0
  ds_read_b128 v[136:139], v12 offset:14336
  ds_read_b128 v[140:143], v12 offset:15360
  v_mfma_f32_16x16x32_bf16 v[220:223], a[44:47], v[164:167], v[220:223]
  s_nop 0
  v_mov_b64 v[72:73], v[58:59]
  v_mov_b64 v[74:75], v[62:63]
  v_mfma_f32_16x16x32_bf16 v[220:223], a[48:51], v[168:171], v[220:223]
  s_nop 0
  v_mov_b64 v[76:77], v[66:67]
  v_mov_b64 v[78:79], v[70:71]
  v_mfma_f32_16x16x32_bf16 v[220:223], a[52:55], v[172:175], v[220:223]
  s_waitcnt lgkmcnt(12)
  s_lshl_b32 s58, s65, 13
  s_add_u32 s58, s58, s69
  buffer_load_dwordx4 v[56:59], v2, s[40:43], s58 offen offset:0 sc1
  v_mfma_f32_16x16x32_bf16 v[220:223], a[56:59], v[176:179], v[220:223]
  s_nop 0
  buffer_load_dwordx4 v[60:63], v2, s[40:43], s58 offen offset:1024 sc1
  v_mfma_f32_16x16x32_bf16 v[220:223], a[60:63], v[180:183], v[220:223]
  s_nop 0
  buffer_load_dwordx4 v[64:67], v2, s[40:43], s58 offen offset:2048 sc1
  v_mfma_f32_16x16x32_bf16 v[224:227], a[64:67], v[152:155], 0
  s_nop 0
  buffer_load_dwordx4 v[68:71], v2, s[40:43], s58 offen offset:3072 sc1
  v_mfma_f32_16x16x32_bf16 v[224:227], a[68:71], v[156:159], v[224:227]
  s_waitcnt lgkmcnt(9)
  v_mfma_f32_16x16x32_bf16 v[40:43], v[112:115], v[80:83], v[20:23]
  s_nop 0
  ds_read_b64_tr_b16 v[96:97], v9 offset:0
  v_mfma_f32_16x16x32_bf16 v[44:47], v[116:119], v[80:83], v[24:27]
  s_nop 0
  ds_read_b64_tr_b16 v[98:99], v9 offset:2048
  v_mfma_f32_16x16x32_bf16 v[224:227], a[72:75], v[160:163], v[224:227]
  s_waitcnt lgkmcnt(8)
  v_mfma_f32_16x16x32_bf16 v[40:43], v[120:123], v[84:87], v[40:43]
  s_nop 0
  ds_read_b64_tr_b16 v[100:101], v9 offset:512
  v_mfma_f32_16x16x32_bf16 v[44:47], v[124:127], v[84:87], v[44:47]
  s_nop 0
  ds_read_b64_tr_b16 v[102:103], v9 offset:2560
  v_mfma_f32_16x16x32_bf16 v[224:227], a[76:79], v[164:167], v[224:227]
  s_waitcnt lgkmcnt(7)
  v_mfma_f32_16x16x32_bf16 v[40:43], v[128:131], v[88:91], v[40:43]
  s_nop 0
  ds_read_b64_tr_b16 v[104:105], v9 offset:1024
  v_mfma_f32_16x16x32_bf16 v[44:47], v[132:135], v[88:91], v[44:47]
  s_nop 0
  ds_read_b64_tr_b16 v[106:107], v9 offset:3072
  v_mfma_f32_16x16x32_bf16 v[224:227], a[80:83], v[168:171], v[224:227]
  s_waitcnt lgkmcnt(6)
  v_mfma_f32_16x16x32_bf16 v[40:43], v[136:139], v[92:95], v[40:43]
  s_nop 0
  ds_read_b64_tr_b16 v[108:109], v9 offset:1536
  v_mfma_f32_16x16x32_bf16 v[44:47], v[140:143], v[92:95], v[44:47]
  s_nop 0
  ds_read_b64_tr_b16 v[110:111], v9 offset:3584
  ds_read_b128 v[112:115], v12 offset:16384
  v_mfma_f32_16x16x32_bf16 v[224:227], a[84:87], v[172:175], v[224:227]
  s_nop 0
  ds_read_b128 v[116:119], v12 offset:17408
  ds_read_b128 v[120:123], v12 offset:18432
  v_mfma_f32_16x16x32_bf16 v[224:227], a[88:91], v[176:179], v[224:227]
  s_nop 0
  ds_read_b128 v[124:127], v12 offset:19456
  v_mfma_f32_16x16x32_bf16 v[224:227], a[92:95], v[180:183], v[224:227]
  s_nop 0
  v_cvt_pk_bf16_f32 v232, v216, v217
  v_cvt_pk_bf16_f32 v233, v218, v219
  v_mfma_f32_16x16x32_bf16 v[228:231], a[96:99], v[152:155], 0
  s_nop 0
  v_cvt_pk_bf16_f32 v234, v220, v221
  v_cvt_pk_bf16_f32 v235, v222, v223
  v_mfma_f32_16x16x32_bf16 v[228:231], a[100:103], v[156:159], v[228:231]
  s_nop 0
  buffer_store_dwordx4 v[232:235], v2, s[40:43], s71 offen offset:0 sc1
  v_mfma_f32_16x16x32_bf16 v[228:231], a[104:107], v[160:163], v[228:231]
  s_waitcnt lgkmcnt(4)
  v_mfma_f32_16x16x32_bf16 v[48:51], v[96:99], v[80:83], 0
  s_nop 0
  ds_read_b128 v[128:131], v12 offset:20480
  v_mfma_f32_16x16x32_bf16 v[48:51], v[100:103], v[84:87], v[48:51]
  s_nop 0
  ds_read_b128 v[132:135], v12 offset:21504
  v_mfma_f32_16x16x32_bf16 v[48:51], v[104:107], v[88:91], v[48:51]
  s_nop 0
  ds_read_b128 v[136:139], v12 offset:22528
  v_mfma_f32_16x16x32_bf16 v[48:51], v[108:111], v[92:95], v[48:51]
  s_nop 0
  ds_read_b128 v[140:143], v12 offset:23552
  v_subrev_u32 v12, s60, v12
  v_mfma_f32_16x16x32_bf16 v[228:231], a[108:111], v[164:167], v[228:231]
  s_add_u32 m0, s66, 0
  s_add_u32 s59, s68, 0x0
  buffer_load_dwordx4 v2, s[40:43], s59 offen offset:0 sc1 lds
  v_subrev_u32 v15, s60, v15
  v_mfma_f32_16x16x32_bf16 v[228:231], a[112:115], v[168:171], v[228:231]
  s_nop 0
  v_max_f32 v3, v40, v41
  v_max3_f32 v3, v3, v42, v43
  v_mfma_f32_16x16x32_bf16 v[228:231], a[116:119], v[172:175], v[228:231]
  s_nop 0
  v_max3_f32 v3, v3, v44, v45
  v_max3_f32 v3, v3, v46, v47
  v_mfma_f32_16x16x32_bf16 v[228:231], a[120:123], v[176:179], v[228:231]
  s_nop 0
  buffer_load_dwordx4 v2, s[40:43], s59 offen offset:1024 sc1 lds
  v_max3_f32 v3, v3, v48, v49
  v_mfma_f32_16x16x32_bf16 v[228:231], a[124:127], v[180:183], v[228:231]
  s_nop 0
  v_mov_b32 v4, v3
  v_mfma_f32_16x16x32_bf16 v[216:219], a[128:131], v[152:155], 0
  s_nop 0
  v_permlane32_swap_b32 v4, v3
  v_mfma_f32_16x16x32_bf16 v[216:219], a[132:135], v[156:159], v[216:219]
  s_nop 0
  buffer_load_dwordx4 v2, s[40:43], s59 offen offset:2048 sc1 lds
  v_max_f32 v3, v3, v4
  v_mfma_f32_16x16x32_bf16 v[216:219], a[136:139], v[160:163], v[216:219]
  s_nop 0
  v_mov_b32 v4, v3
  v_mfma_f32_16x16x32_bf16 v[216:219], a[140:143], v[164:167], v[216:219]
  s_nop 0
  v_permlane16_swap_b32 v4, v3
  v_mfma_f32_16x16x32_bf16 v[216:219], a[144:147], v[168:171], v[216:219]
  s_nop 0
  buffer_load_dwordx4 v2, s[40:43], s59 offen offset:3072 sc1 lds
  v_max_f32 v3, v3, v4
  v_mfma_f32_16x16x32_bf16 v[216:219], a[148:151], v[172:175], v[216:219]
  s_nop 0
  v_sub_f32 v40, v40, v3
  v_sub_f32 v41, v41, v3
  v_mfma_f32_16x16x32_bf16 v[216:219], a[152:155], v[176:179], v[216:219]
  s_nop 0
  v_sub_f32 v42, v42, v3
  v_sub_f32 v43, v43, v3
  v_mfma_f32_16x16x32_bf16 v[216:219], a[156:159], v[180:183], v[216:219]
  s_nop 0
  v_cvt_pk_bf16_f32 v236, v224, v225
  v_cvt_pk_bf16_f32 v237, v226, v227
  v_mfma_f32_16x16x32_bf16 v[220:223], a[160:163], v[152:155], 0
  s_nop 0
  ds_read_b128 v[184:187], v14 offset:8192
  v_cvt_pk_bf16_f32 v238, v228, v229
  v_cvt_pk_bf16_f32 v239, v230, v231
  v_mfma_f32_16x16x32_bf16 v[220:223], a[164:167], v[156:159], v[220:223]
  s_nop 0
  buffer_store_dwordx4 v[236:239], v2, s[40:43], s71 offen offset:1024 sc1
  v_sub_f32 v44, v44, v3
  v_mfma_f32_16x16x32_bf16 v[220:223], a[168:171], v[160:163], v[220:223]
  s_nop 0
  ds_read_b128 v[188:191], v14 offset:9216
  v_sub_f32 v45, v45, v3
  v_mfma_f32_16x16x32_bf16 v[220:223], a[172:175], v[164:167], v[220:223]
  s_add_u32 m0, s66, 8192
  s_add_u32 s59, s68, 0x1000000
  buffer_load_dwordx4 v2, s[40:43], s59 offen offset:0 sc1 lds
  v_sub_f32 v46, v46, v3
  v_mfma_f32_16x16x32_bf16 v[220:223], a[176:179], v[168:171], v[220:223]
  s_nop 0
  ds_read_b128 v[192:195], v14 offset:10240
  v_sub_f32 v47, v47, v3
  v_mfma_f32_16x16x32_bf16 v[220:223], a[180:183], v[172:175], v[220:223]
  s_nop 0
  v_sub_f32 v48, v48, v3
  v_sub_f32 v49, v49, v3
  v_mfma_f32_16x16x32_bf16 v[220:223], a[184:187], v[176:179], v[220:223]
  s_nop 0
  ds_read_b128 v[196:199], v14 offset:11264
  v_mfma_f32_16x16x32_bf16 v[220:223], a[188:191], v[180:183], v[220:223]
  s_nop 0
  buffer_load_dwordx4 v2, s[40:43], s59 offen offset:1024 sc1 lds
  v_mfma_f32_16x16x32_bf16 v[224:227], a[192:195], v[152:155], 0
  s_nop 0
  ds_read_b128 v[200:203], v14 offset:12288
  v_mfma_f32_16x16x32_bf16 v[224:227], a[196:199], v[156:159], v[224:227]
  s_nop 0
  v_exp_f32 v40, v40
  v_mfma_f32_16x16x32_bf16 v[224:227], a[200:203], v[160:163], v[224:227]
  s_nop 0
  ds_read_b128 v[204:207], v14 offset:13312
  v_mfma_f32_16x16x32_bf16 v[224:227], a[204:207], v[164:167], v[224:227]
  s_nop 0
  buffer_load_dwordx4 v2, s[40:43], s59 offen offset:2048 sc1 lds
  v_mfma_f32_16x16x32_bf16 v[224:227], a[208:211], v[168:171], v[224:227]
  s_nop 0
  ds_read_b128 v[208:211], v14 offset:14336
  v_mfma_f32_16x16x32_bf16 v[224:227], a[212:215], v[172:175], v[224:227]
  s_nop 0
  v_exp_f32 v41, v41
  v_mfma_f32_16x16x32_bf16 v[224:227], a[216:219], v[176:179], v[224:227]
  s_nop 0
  ds_read_b128 v[212:215], v14 offset:15360
  v_mfma_f32_16x16x32_bf16 v[224:227], a[220:223], v[180:183], v[224:227]
  s_nop 0
  v_cvt_pk_bf16_f32 v232, v216, v217
  v_cvt_pk_bf16_f32 v233, v218, v219
  v_mfma_f32_16x16x32_bf16 v[228:231], a[224:227], v[152:155], 0
  s_nop 0
  v_cvt_pk_bf16_f32 v234, v220, v221
  v_cvt_pk_bf16_f32 v235, v222, v223
  v_mfma_f32_16x16x32_bf16 v[228:231], a[228:231], v[156:159], v[228:231]
  s_nop 0
  buffer_store_dwordx4 v[232:235], v2, s[40:43], s71 offen offset:2048 sc1
  v_mfma_f32_16x16x32_bf16 v[228:231], a[232:235], v[160:163], v[228:231]
  s_nop 0
  buffer_load_dwordx4 v2, s[40:43], s59 offen offset:3072 sc1 lds
  v_mfma_f32_16x16x32_bf16 v[228:231], a[236:239], v[164:167], v[228:231]
  s_nop 0
  v_exp_f32 v42, v42
  v_mfma_f32_16x16x32_bf16 v[228:231], a[240:243], v[168:171], v[228:231]
  s_nop 0
  v_exp_f32 v43, v43
  v_mfma_f32_16x16x32_bf16 v[228:231], a[244:247], v[172:175], v[228:231]
  s_add_u32 m0, s66, 16384
  s_add_u32 s59, s68, 0x2000000
  buffer_load_dwordx4 v2, s[40:43], s59 offen offset:0 sc1 lds
  v_mfma_f32_16x16x32_bf16 v[228:231], a[248:251], v[176:179], v[228:231]
  s_nop 0
  v_exp_f32 v44, v44
  v_mfma_f32_16x16x32_bf16 v[228:231], a[252:255], v[180:183], v[228:231]
  s_waitcnt lgkmcnt(0)
  v_exp_f32 v45, v45
  v_mfma_f32_16x16x32_bf16 v[216:219], a[0:3], v[184:187], 0
  s_nop 0
  buffer_load_dwordx4 v2, s[40:43], s59 offen offset:1024 sc1 lds
  v_mfma_f32_16x16x32_bf16 v[216:219], a[4:7], v[188:191], v[216:219]
  s_nop 0
  v_exp_f32 v46, v46
  v_mfma_f32_16x16x32_bf16 v[216:219], a[8:11], v[192:195], v[216:219]
  s_nop 0
  v_xor_b32 v14, 0x4000, v14
  v_mfma_f32_16x16x32_bf16 v[216:219], a[12:15], v[196:199], v[216:219]
  s_nop 0
  buffer_load_dwordx4 v2, s[40:43], s59 offen offset:2048 sc1 lds
  v_mfma_f32_16x16x32_bf16 v[216:219], a[16:19], v[200:203], v[216:219]
  s_nop 0
  v_exp_f32 v47, v47
  v_mfma_f32_16x16x32_bf16 v[216:219], a[20:23], v[204:207], v[216:219]
  s_nop 0
  v_exp_f32 v48, v48
  v_mfma_f32_16x16x32_bf16 v[216:219], a[24:27], v[208:211], v[216:219]
  s_nop 0
  buffer_load_dwordx4 v2, s[40:43], s59 offen offset:3072 sc1 lds
  v_mfma_f32_16x16x32_bf16 v[216:219], a[28:31], v[212:215], v[216:219]
  s_nop 0
  v_cvt_pk_bf16_f32 v236, v224, v225
  v_cvt_pk_bf16_f32 v237, v226, v227
  v_mfma_f32_16x16x32_bf16 v[220:223], a[32:35], v[184:187], 0
  s_nop 0
  v_cvt_pk_bf16_f32 v238, v228, v229
  v_cvt_pk_bf16_f32 v239, v230, v231
  v_mfma_f32_16x16x32_bf16 v[220:223], a[36:39], v[188:191], v[220:223]
  s_nop 0
  buffer_store_dwordx4 v[236:239], v2, s[40:43], s71 offen offset:3072 sc1
  v_mfma_f32_16x16x32_bf16 v[220:223], a[40:43], v[192:195], v[220:223]
  s_nop 0
  buffer_load_dword v11, v31, s[40:43], s74 offen sc1
  v_mfma_f32_16x16x32_bf16 v[220:223], a[44:47], v[196:199], v[220:223]
  s_nop 0
  v_exp_f32 v49, v49
  v_mfma_f32_16x16x32_bf16 v[220:223], a[48:51], v[200:203], v[220:223]
  s_nop 0
  v_cvt_pk_bf16_f32 v36, v40, v41
  v_cvt_pk_bf16_f32 v37, v42, v43
  v_mfma_f32_16x16x32_bf16 v[220:223], a[52:55], v[204:207], v[220:223]
  s_nop 0
  buffer_load_dword v240, v7, s[40:43], s73 offen sc1
  v_cvt_pk_bf16_f32 v38, v44, v45
  v_mfma_f32_16x16x32_bf16 v[220:223], a[56:59], v[208:211], v[220:223]
  s_nop 0
  v_cvt_pk_bf16_f32 v39, v46, v47
  v_cvt_pk_bf16_f32 v32, v48, v49
  v_mfma_f32_16x16x32_bf16 v[220:223], a[60:63], v[212:215], v[220:223]
  s_nop 0
  v_cvt_pk_bf16_f32 v35, v48, v49
  v_mfma_f32_16x16x32_bf16 v[224:227], a[64:67], v[184:187], 0
  s_nop 0
  v_mfma_f32_16x16x32_bf16 v[52:55], v[16:19], v[36:39], 0
  s_nop 0
  v_mfma_f32_16x16x32_bf16 v[80:83], v[112:115], v[36:39], 0
  s_nop 0
  v_mfma_f32_16x16x32_bf16 v[84:87], v[116:119], v[36:39], 0
  s_nop 0
  v_mfma_f32_16x16x32_bf16 v[88:91], v[120:123], v[36:39], 0
  s_nop 0
  v_mfma_f32_16x16x32_bf16 v[92:95], v[124:127], v[36:39], 0
  s_nop 0
  v_mfma_f32_16x16x32_bf16 v[96:99], v[128:131], v[36:39], 0
  s_nop 0
  v_mfma_f32_16x16x32_bf16 v[100:103], v[132:135], v[36:39], 0
  s_nop 0
  v_mfma_f32_16x16x16_bf16 v[52:55], v[16:17], v[32:33], v[52:55]
  s_nop 0
  v_mfma_f32_16x16x32_bf16 v[104:107], v[136:139], v[36:39], 0
  s_nop 0
  v_mfma_f32_16x16x32_bf16 v[108:111], v[140:143], v[36:39], 0
  s_nop 0
  v_mfma_f32_16x16x16_bf16 v[80:83], v[72:73], v[32:33], v[80:83]
  s_nop 0
  v_mfma_f32_16x16x16_bf16 v[84:87], v[72:73], v[34:35], v[84:87]
  s_nop 0
  v_mfma_f32_16x16x16_bf16 v[88:91], v[74:75], v[32:33], v[88:91]
  s_nop 0
  v_mfma_f32_16x16x16_bf16 v[92:95], v[74:75], v[34:35], v[92:95]
  s_nop 0
  v_mfma_f32_16x16x16_bf16 v[96:99], v[76:77], v[32:33], v[96:99]
  s_nop 0
  v_mfma_f32_16x16x16_bf16 v[100:103], v[76:77], v[34:35], v[100:103]
  s_nop 0
  v_rcp_f32 v3, v52
  v_mfma_f32_16x16x16_bf16 v[104:107], v[78:79], v[32:33], v[104:107]
  s_nop 0
  v_mul_f32 v3, v3, v10
  v_mfma_f32_16x16x16_bf16 v[108:111], v[78:79], v[34:35], v[108:111]
  s_nop 0
  v_mul_f32 v80, v80, v3
  v_mul_f32 v81, v81, v3
  v_mfma_f32_16x16x32_bf16 v[224:227], a[68:71], v[188:191], v[224:227]
  s_nop 0
  v_mul_f32 v82, v82, v3
  v_mul_f32 v83, v83, v3
  v_mfma_f32_16x16x32_bf16 v[224:227], a[72:75], v[192:195], v[224:227]
  s_nop 0
  v_mul_f32 v84, v84, v3
  v_mul_f32 v85, v85, v3
  v_mfma_f32_16x16x32_bf16 v[224:227], a[76:79], v[196:199], v[224:227]
  s_nop 0
  v_mul_f32 v86, v86, v3
  v_mul_f32 v87, v87, v3
  v_mfma_f32_16x16x32_bf16 v[224:227], a[80:83], v[200:203], v[224:227]
  s_nop 0
  v_cvt_pk_bf16_f32 v144, v80, v81
  v_cvt_pk_bf16_f32 v145, v82, v83
  v_mfma_f32_16x16x32_bf16 v[224:227], a[84:87], v[204:207], v[224:227]
  s_nop 0
  v_cvt_pk_bf16_f32 v146, v84, v85
  v_cvt_pk_bf16_f32 v147, v86, v87
  v_mfma_f32_16x16x32_bf16 v[224:227], a[88:91], v[208:211], v[224:227]
  s_add_u32 s71, s71, 393216
  ds_write_b128 v13, v[144:147] offset:0
  v_mul_f32 v88, v88, v3
  v_mfma_f32_16x16x32_bf16 v[224:227], a[92:95], v[212:215], v[224:227]
  s_nop 0
  v_cvt_pk_bf16_f32 v232, v216, v217
  v_cvt_pk_bf16_f32 v233, v218, v219
  v_mfma_f32_16x16x32_bf16 v[228:231], a[96:99], v[184:187], 0
  s_nop 0
  v_cvt_pk_bf16_f32 v234, v220, v221
  v_cvt_pk_bf16_f32 v235, v222, v223
  v_mfma_f32_16x16x32_bf16 v[228:231], a[100:103], v[188:191], v[228:231]
  s_nop 0
  buffer_store_dwordx4 v[232:235], v2, s[40:43], s71 offen offset:0 sc1
  v_mul_f32 v89, v89, v3
  v_mfma_f32_16x16x32_bf16 v[228:231], a[104:107], v[192:195], v[228:231]
  s_nop 0
  v_mul_f32 v90, v90, v3
  v_mul_f32 v91, v91, v3
  v_mfma_f32_16x16x32_bf16 v[228:231], a[108:111], v[196:199], v[228:231]
  s_nop 0
  v_mul_f32 v92, v92, v3
  v_mul_f32 v93, v93, v3
  v_mfma_f32_16x16x32_bf16 v[228:231], a[112:115], v[200:203], v[228:231]
  s_nop 0
  v_mul_f32 v94, v94, v3
  v_mul_f32 v95, v95, v3
  v_mfma_f32_16x16x32_bf16 v[228:231], a[116:119], v[204:207], v[228:231]
  s_nop 0
  v_cvt_pk_bf16_f32 v148, v88, v89
  v_cvt_pk_bf16_f32 v149, v90, v91
  v_mfma_f32_16x16x32_bf16 v[228:231], a[120:123], v[208:211], v[228:231]
  s_nop 0
  v_cvt_pk_bf16_f32 v150, v92, v93
  v_cvt_pk_bf16_f32 v151, v94, v95
  v_mfma_f32_16x16x32_bf16 v[228:231], a[124:127], v[212:215], v[228:231]
  s_nop 0
  ds_write_b128 v13, v[148:151] offset:1024
  v_mul_f32 v96, v96, v3
  v_mfma_f32_16x16x32_bf16 v[216:219], a[128:131], v[184:187], 0
  s_nop 0
  v_mul_f32 v97, v97, v3
  v_mul_f32 v98, v98, v3
  v_mfma_f32_16x16x32_bf16 v[216:219], a[132:135], v[188:191], v[216:219]
  s_nop 0
  v_mul_f32 v99, v99, v3
  v_mul_f32 v100, v100, v3
  v_mfma_f32_16x16x32_bf16 v[216:219], a[136:139], v[192:195], v[216:219]
  s_nop 0
  v_mul_f32 v101, v101, v3
  v_mul_f32 v102, v102, v3
  v_mfma_f32_16x16x32_bf16 v[216:219], a[140:143], v[196:199], v[216:219]
  s_nop 0
  v_mul_f32 v103, v103, v3
  v_mfma_f32_16x16x32_bf16 v[216:219], a[144:147], v[200:203], v[216:219]
  s_waitcnt lgkmcnt(1)
  v_cvt_pk_bf16_f32 v144, v96, v97
  v_cvt_pk_bf16_f32 v145, v98, v99
  v_mfma_f32_16x16x32_bf16 v[216:219], a[148:151], v[204:207], v[216:219]
  s_nop 0
  v_cvt_pk_bf16_f32 v146, v100, v101
  v_cvt_pk_bf16_f32 v147, v102, v103
  v_mfma_f32_16x16x32_bf16 v[216:219], a[152:155], v[208:211], v[216:219]
  s_nop 0
  ds_write_b128 v13, v[144:147] offset:2048
  v_mul_f32 v104, v104, v3
  v_mfma_f32_16x16x32_bf16 v[216:219], a[156:159], v[212:215], v[216:219]
  s_nop 0
  v_cvt_pk_bf16_f32 v236, v224, v225
  v_cvt_pk_bf16_f32 v237, v226, v227
  v_mfma_f32_16x16x32_bf16 v[220:223], a[160:163], v[184:187], 0
  s_nop 0
  v_cvt_pk_bf16_f32 v238, v228, v229
  v_cvt_pk_bf16_f32 v239, v230, v231
  v_mfma_f32_16x16x32_bf16 v[220:223], a[164:167], v[188:191], v[220:223]
  s_nop 0
  buffer_store_dwordx4 v[236:239], v2, s[40:43], s71 offen offset:1024 sc1
  v_mul_f32 v105, v105, v3
  v_mfma_f32_16x16x32_bf16 v[220:223], a[168:171], v[192:195], v[220:223]
  s_nop 0
  v_mul_f32 v106, v106, v3
  v_mul_f32 v107, v107, v3
  v_mfma_f32_16x16x32_bf16 v[220:223], a[172:175], v[196:199], v[220:223]
  s_nop 0
  v_mul_f32 v108, v108, v3
  v_mul_f32 v109, v109, v3
  v_mfma_f32_16x16x32_bf16 v[220:223], a[176:179], v[200:203], v[220:223]
  s_nop 0
  v_mul_f32 v110, v110, v3
  v_mul_f32 v111, v111, v3
  v_mfma_f32_16x16x32_bf16 v[220:223], a[180:183], v[204:207], v[220:223]
  s_waitcnt lgkmcnt(1)
  v_cvt_pk_bf16_f32 v148, v104, v105
  v_cvt_pk_bf16_f32 v149, v106, v107
  v_mfma_f32_16x16x32_bf16 v[220:223], a[184:187], v[208:211], v[220:223]
  s_nop 0
  v_cvt_pk_bf16_f32 v150, v108, v109
  v_cvt_pk_bf16_f32 v151, v110, v111
  v_mfma_f32_16x16x32_bf16 v[220:223], a[188:191], v[212:215], v[220:223]
  s_nop 0
  ds_write_b128 v13, v[148:151] offset:3072
  v_xor_b32 v13, 0x4000, v13
  v_mfma_f32_16x16x32_bf16 v[224:227], a[192:195], v[184:187], 0
  s_nop 0
  v_mfma_f32_16x16x32_bf16 v[224:227], a[196:199], v[188:191], v[224:227]
  s_nop 0
  v_mfma_f32_16x16x32_bf16 v[224:227], a[200:203], v[192:195], v[224:227]
  s_nop 0
  v_mfma_f32_16x16x32_bf16 v[224:227], a[204:207], v[196:199], v[224:227]
  s_nop 0
  v_mfma_f32_16x16x32_bf16 v[224:227], a[208:211], v[200:203], v[224:227]
  s_nop 0
  v_mfma_f32_16x16x32_bf16 v[224:227], a[212:215], v[204:207], v[224:227]
  s_nop 0
  v_mfma_f32_16x16x32_bf16 v[224:227], a[216:219], v[208:211], v[224:227]
  s_nop 0
  v_mfma_f32_16x16x32_bf16 v[224:227], a[220:223], v[212:215], v[224:227]
  s_nop 0
  v_cvt_pk_bf16_f32 v232, v216, v217
  v_cvt_pk_bf16_f32 v233, v218, v219
  v_mfma_f32_16x16x32_bf16 v[228:231], a[224:227], v[184:187], 0
  s_nop 0
  v_cvt_pk_bf16_f32 v234, v220, v221
  v_cvt_pk_bf16_f32 v235, v222, v223
  v_mfma_f32_16x16x32_bf16 v[228:231], a[228:231], v[188:191], v[228:231]
  s_nop 0
  buffer_store_dwordx4 v[232:235], v2, s[40:43], s71 offen offset:2048 sc1
  v_mfma_f32_16x16x32_bf16 v[228:231], a[232:235], v[192:195], v[228:231]
  s_nop 0
  v_mfma_f32_16x16x32_bf16 v[228:231], a[236:239], v[196:199], v[228:231]
  s_nop 0
  v_mfma_f32_16x16x32_bf16 v[228:231], a[240:243], v[200:203], v[228:231]
  s_nop 0
  v_mfma_f32_16x16x32_bf16 v[228:231], a[244:247], v[204:207], v[228:231]
  s_nop 0
  v_mfma_f32_16x16x32_bf16 v[228:231], a[248:251], v[208:211], v[228:231]
  s_nop 0
  v_mfma_f32_16x16x32_bf16 v[228:231], a[252:255], v[212:215], v[228:231]
  s_nop 0
  s_nop 6
  v_cvt_pk_bf16_f32 v236, v224, v225
  v_cvt_pk_bf16_f32 v237, v226, v227
  v_cvt_pk_bf16_f32 v238, v228, v229
  v_cvt_pk_bf16_f32 v239, v230, v231
  buffer_store_dwordx4 v[236:239], v2, s[40:43], s71 offen offset:3072 sc1
  s_cmp_ge_u32 s66, 49152
  s_mov_b32 s60, 49152
  s_cmov_b32 s60, -49152
  s_add_u32 s66, s66, s60
  s_waitcnt vmcnt(4)
  s_bitcmp1_b32 s64, 2
  s_cbranch_scc1 L_b_sig_4
  s_lshr_b32 s58, s64, 2
  s_add_u32 s58, s58, 147456
  v_mov_b32 v3, s58
  s_mov_b64 exec, 1
  ds_add_rtn_u32 v3, v3, v241
  s_lshl_b32 s58, s64, 3
  s_add_u32 s58, s58, 0xd087000
  s_waitcnt lgkmcnt(0)
  v_cmp_eq_u32 vcc, 3, v3
  s_cbranch_vccz L_b_sig_4x
  buffer_atomic_add v241, v7, s[40:43], s58 offen
L_b_sig_4x:
  s_mov_b64 exec, -1
L_b_sig_4:
  s_mov_b32 s64, s62
  s_branch L_b_join
L_b_alone:
  ds_read_b128 v[152:155], v14 offset:0
  ds_read_b128 v[156:159], v14 offset:1024
  ds_read_b128 v[160:163], v14 offset:2048
  ds_read_b128 v[164:167], v14 offset:3072
  ds_read_b128 v[168:171], v14 offset:4096
  ds_read_b128 v[172:175], v14 offset:5120
  ds_read_b128 v[176:179], v14 offset:6144
  ds_read_b128 v[180:183], v14 offset:7168
  s_waitcnt lgkmcnt(7)
  v_mfma_f32_16x16x32_bf16 v[216:219], a[0:3], v[152:155], 0
  s_waitcnt lgkmcnt(6)
  v_mfma_f32_16x16x32_bf16 v[216:219], a[4:7], v[156:159], v[216:219]
  s_waitcnt lgkmcnt(5)
  v_mfma_f32_16x16x32_bf16 v[216:219], a[8:11], v[160:163], v[216:219]
  s_waitcnt lgkmcnt(4)
  v_mfma_f32_16x16x32_bf16 v[216:219], a[12:15], v[164:167], v[216:219]
  s_waitcnt lgkmcnt(3)
  v_mfma_f32_16x16x32_bf16 v[216:219], a[16:19], v[168:171], v[216:219]
  s_waitcnt lgkmcnt(2)
  v_mfma_f32_16x16x32_bf16 v[216:219], a[20:23], v[172:175], v[216:219]
  s_waitcnt lgkmcnt(1)
  v_mfma_f32_16x16x32_bf16 v[216:219], a[24:27], v[176:179], v[216:219]
  s_waitcnt lgkmcnt(0)
  v_mfma_f32_16x16x32_bf16 v[216:219], a[28:31], v[180:183], v[216:219]
  s_nop 0
  v_mfma_f32_16x16x32_bf16 v[220:223], a[32:35], v[152:155], 0
  s_add_u32 m0, s66, 0
  s_add_u32 s59, s68, 0x0
  buffer_load_dwordx4 v2, s[40:43], s59 offen offset:0 sc1 lds
  v_mfma_f32_16x16x32_bf16 v[220:223], a[36:39], v[156:159], v[220:223]
  s_nop 0
  v_mfma_f32_16x16x32_bf16 v[220:223], a[40:43], v[160:163], v[220:223]
  s_nop 0
  buffer_load_dwordx4 v2, s[40:43], s59 offen offset:1024 sc1 lds
  v_mfma_f32_16x16x32_bf16 v[220:223], a[44:47], v[164:167], v[220:223]
  s_nop 0
  v_mfma_f32_16x16x32_bf16 v[220:223], a[48:51], v[168:171], v[220:223]
  s_nop 0
  buffer_load_dwordx4 v2, s[40:43], s59 offen offset:2048 sc1 lds
  v_mfma_f32_16x16x32_bf16 v[220:223], a[52:55], v[172:175], v[220:223]
  s_nop 0
  v_mfma_f32_16x16x32_bf16 v[220:223], a[56:59], v[176:179], v[220:223]
  s_nop 0
  buffer_load_dwordx4 v2, s[40:43], s59 offen offset:3072 sc1 lds
  v_mfma_f32_16x16x32_bf16 v[220:223], a[60:63], v[180:183], v[220:223]
  s_nop 0
  v_mfma_f32_16x16x32_bf16 v[224:227], a[64:67], v[152:155], 0
  s_add_u32 m0, s66, 8192
  s_add_u32 s59, s68, 0x1000000
  buffer_load_dwordx4 v2, s[40:43], s59 offen offset:0 sc1 lds
  v_mfma_f32_16x16x32_bf16 v[224:227], a[68:71], v[156:159], v[224:227]
  s_nop 0
  v_mfma_f32_16x16x32_bf16 v[224:227], a[72:75], v[160:163], v[224:227]
  s_nop 0
  buffer_load_dwordx4 v2, s[40:43], s59 offen offset:1024 sc1 lds
  v_mfma_f32_16x16x32_bf16 v[224:227], a[76:79], v[164:167], v[224:227]
  s_nop 0
  v_mfma_f32_16x16x32_bf16 v[224:227], a[80:83], v[168:171], v[224:227]
  s_nop 0
  buffer_load_dwordx4 v2, s[40:43], s59 offen offset:2048 sc1 lds
  v_mfma_f32_16x16x32_bf16 v[224:227], a[84:87], v[172:175], v[224:227]
  s_nop 0
  v_mfma_f32_16x16x32_bf16 v[224:227], a[88:91], v[176:179], v[224:227]
  s_nop 0
  buffer_load_dwordx4 v2, s[40:43], s59 offen offset:3072 sc1 lds
  v_mfma_f32_16x16x32_bf16 v[224:227], a[92:95], v[180:183], v[224:227]
  s_nop 0
  v_cvt_pk_bf16_f32 v232, v216, v217
  v_cvt_pk_bf16_f32 v233, v218, v219
  v_mfma_f32_16x16x32_bf16 v[228:231], a[96:99], v[152:155], 0
  s_nop 0
  v_cvt_pk_bf16_f32 v234, v220, v221
  v_cvt_pk_bf16_f32 v235, v222, v223
  v_mfma_f32_16x16x32_bf16 v[228:231], a[100:103], v[156:159], v[228:231]
  s_nop 0
  buffer_store_dwordx4 v[232:235], v2, s[40:43], s71 offen offset:0 sc1
  v_mfma_f32_16x16x32_bf16 v[228:231], a[104:107], v[160:163], v[228:231]
  s_add_u32 m0, s66, 16384
  s_add_u32 s59, s68, 0x2000000
  buffer_load_dwordx4 v2, s[40:43], s59 offen offset:0 sc1 lds
  v_mfma_f32_16x16x32_bf16 v[228:231], a[108:111], v[164:167], v[228:231]
  s_nop 0
  v_mfma_f32_16x16x32_bf16 v[228:231], a[112:115], v[168:171], v[228:231]
  s_nop 0
  buffer_load_dwordx4 v2, s[40:43], s59 offen offset:1024 sc1 lds
  v_mfma_f32_16x16x32_bf16 v[228:231], a[116:119], v[172:175], v[228:231]
  s_nop 0
  v_mfma_f32_16x16x32_bf16 v[228:231], a[120:123], v[176:179], v[228:231]
  s_nop 0
  buffer_load_dwordx4 v2, s[40:43], s59 offen offset:2048 sc1 lds
  v_mfma_f32_16x16x32_bf16 v[228:231], a[124:127], v[180:183], v[228:231]
  s_nop 0
  v_mfma_f32_16x16x32_bf16 v[216:219], a[128:131], v[152:155], 0
  s_nop 0
  buffer_load_dwordx4 v2, s[40:43], s59 offen offset:3072 sc1 lds
  v_mfma_f32_16x16x32_bf16 v[216:219], a[132:135], v[156:159], v[216:219]
  s_nop 0
  v_mfma_f32_16x16x32_bf16 v[216:219], a[136:139], v[160:163], v[216:219]
  s_nop 0
  buffer_load_dword v11, v31, s[40:43], s74 offen sc1
  v_mfma_f32_16x16x32_bf16 v[216:219], a[140:143], v[164:167], v[216:219]
  s_nop 0
  v_mfma_f32_16x16x32_bf16 v[216:219], a[144:147], v[168:171], v[216:219]
  s_nop 0
  buffer_load_dword v240, v7, s[40:43], s73 offen sc1
  v_mfma_f32_16x16x32_bf16 v[216:219], a[148:151], v[172:175], v[216:219]
  s_nop 0
  v_mfma_f32_16x16x32_bf16 v[216:219], a[152:155], v[176:179], v[216:219]
  s_nop 0
  v_mfma_f32_16x16x32_bf16 v[216:219], a[156:159], v[180:183], v[216:219]
  s_nop 0
  v_cvt_pk_bf16_f32 v236, v224, v225
  v_cvt_pk_bf16_f32 v237, v226, v227
  v_mfma_f32_16x16x32_bf16 v[220:223], a[160:163], v[152:155], 0
  s_nop 0
  ds_read_b128 v[184:187], v14 offset:8192
  v_cvt_pk_bf16_f32 v238, v228, v229
  v_cvt_pk_bf16_f32 v239, v230, v231
  v_mfma_f32_16x16x32_bf16 v[220:223], a[164:167], v[156:159], v[220:223]
  s_nop 0
  buffer_store_dwordx4 v[236:239], v2, s[40:43], s71 offen offset:1024 sc1
  v_mfma_f32_16x16x32_bf16 v[220:223], a[168:171], v[160:163], v[220:223]
  s_nop 0
  ds_read_b128 v[188:191], v14 offset:9216
  v_mfma_f32_16x16x32_bf16 v[220:223], a[172:175], v[164:167], v[220:223]
  s_nop 0
  v_mfma_f32_16x16x32_bf16 v[220:223], a[176:179], v[168:171], v[220:223]
  s_nop 0
  ds_read_b128 v[192:195], v14 offset:10240
  v_mfma_f32_16x16x32_bf16 v[220:223], a[180:183], v[172:175], v[220:223]
  s_nop 0
  v_mfma_f32_16x16x32_bf16 v[220:223], a[184:187], v[176:179], v[220:223]
  s_nop 0
  ds_read_b128 v[196:199], v14 offset:11264
  v_mfma_f32_16x16x32_bf16 v[220:223], a[188:191], v[180:183], v[220:223]
  s_nop 0
  v_mfma_f32_16x16x32_bf16 v[224:227], a[192:195], v[152:155], 0
  s_nop 0
  ds_read_b128 v[200:203], v14 offset:12288
  v_mfma_f32_16x16x32_bf16 v[224:227], a[196:199], v[156:159], v[224:227]
  s_nop 0
  v_mfma_f32_16x16x32_bf16 v[224:227], a[200:203], v[160:163], v[224:227]
  s_nop 0
  ds_read_b128 v[204:207], v14 offset:13312
  v_mfma_f32_16x16x32_bf16 v[224:227], a[204:207], v[164:167], v[224:227]
  s_nop 0
  v_mfma_f32_16x16x32_bf16 v[224:227], a[208:211], v[168:171], v[224:227]
  s_nop 0
  ds_read_b128 v[208:211], v14 offset:14336
  v_mfma_f32_16x16x32_bf16 v[224:227], a[212:215], v[172:175], v[224:227]
  s_nop 0
  v_mfma_f32_16x16x32_bf16 v[224:227], a[216:219], v[176:179], v[224:227]
  s_nop 0
  ds_read_b128 v[212:215], v14 offset:15360
  v_mfma_f32_16x16x32_bf16 v[224:227], a[220:223], v[180:183], v[224:227]
  s_nop 0
  v_cvt_pk_bf16_f32 v232, v216, v217
  v_cvt_pk_bf16_f32 v233, v218, v219
  v_mfma_f32_16x16x32_bf16 v[228:231], a[224:227], v[152:155], 0
  s_nop 0
  v_cvt_pk_bf16_f32 v234, v220, v221
  v_cvt_pk_bf16_f32 v235, v222, v223
  v_mfma_f32_16x16x32_bf16 v[228:231], a[228:231], v[156:159], v[228:231]
  s_nop 0
  buffer_store_dwordx4 v[232:235], v2, s[40:43], s71 offen offset:2048 sc1
  v_mfma_f32_16x16x32_bf16 v[228:231], a[232:235], v[160:163], v[228:231]
  s_nop 0
  v_mfma_f32_16x16x32_bf16 v[228:231], a[236:239], v[164:167], v[228:231]
  s_nop 0
  v_mfma_f32_16x16x32_bf16 v[228:231], a[240:243], v[168:171], v[228:231]
  s_nop 0
  v_mfma_f32_16x16x32_bf16 v[228:231], a[244:247], v[172:175], v[228:231]
  s_nop 0
  v_mfma_f32_16x16x32_bf16 v[228:231], a[248:251], v[176:179], v[228:231]
  s_nop 0
  v_mfma_f32_16x16x32_bf16 v[228:231], a[252:255], v[180:183], v[228:231]
  s_waitcnt lgkmcnt(0)
  v_mfma_f32_16x16x32_bf16 v[216:219], a[0:3], v[184:187], 0
  s_nop 0
  v_mfma_f32_16x16x32_bf16 v[216:219], a[4:7], v[188:191], v[216:219]
  s_nop 0
  v_mfma_f32_16x16x32_bf16 v[216:219], a[8:11], v[192:195], v[216:219]
  s_nop 0
  v_xor_b32 v14, 0x4000, v14
  v_mfma_f32_16x16x32_bf16 v[216:219], a[12:15], v[196:199], v[216:219]
  s_nop 0
  v_mfma_f32_16x16x32_bf16 v[216:219], a[16:19], v[200:203], v[216:219]
  s_nop 0
  v_mfma_f32_16x16x32_bf16 v[216:219], a[20:23], v[204:207], v[216:219]
  s_nop 0
  v_mfma_f32_16x16x32_bf16 v[216:219], a[24:27], v[208:211], v[216:219]
  s_nop 0
  v_mfma_f32_16x16x32_bf16 v[216:219], a[28:31], v[212:215], v[216:219]
  s_nop 0
  v_cvt_pk_bf16_f32 v236, v224, v225
  v_cvt_pk_bf16_f32 v237, v226, v227
  v_mfma_f32_16x16x32_bf16 v[220:223], a[32:35], v[184:187], 0
  s_nop 0
  v_cvt_pk_bf16_f32 v238, v228, v229
  v_cvt_pk_bf16_f32 v239, v230, v231
  v_mfma_f32_16x16x32_bf16 v[220:223], a[36:39], v[188:191], v[220:223]
  s_nop 0
  buffer_store_dwordx4 v[236:239], v2, s[40:43], s71 offen offset:3072 sc1
  v_mfma_f32_16x16x32_bf16 v[220:223], a[40:43], v[192:195], v[220:223]
  s_nop 0
  v_mfma_f32_16x16x32_bf16 v[220:223], a[44:47], v[196:199], v[220:223]
  s_nop 0
  v_mfma_f32_16x16x32_bf16 v[220:223], a[48:51], v[200:203], v[220:223]
  s_nop 0
  v_mfma_f32_16x16x32_bf16 v[220:223], a[52:55], v[204:207], v[220:223]
  s_nop 0
  v_mfma_f32_16x16x32_bf16 v[220:223], a[56:59], v[208:211], v[220:223]
  s_nop 0
  v_mfma_f32_16x16x32_bf16 v[220:223], a[60:63], v[212:215], v[220:223]
  s_nop 0
  v_mfma_f32_16x16x32_bf16 v[224:227], a[64:67], v[184:187], 0
  s_nop 0
  v_mfma_f32_16x16x32_bf16 v[224:227], a[68:71], v[188:191], v[224:227]
  s_nop 0
  v_mfma_f32_16x16x32_bf16 v[224:227], a[72:75], v[192:195], v[224:227]
  s_nop 0
  v_mfma_f32_16x16x32_bf16 v[224:227], a[76:79], v[196:199], v[224:227]
  s_nop 0
  v_mfma_f32_16x16x32_bf16 v[224:227], a[80:83], v[200:203], v[224:227]
  s_nop 0
  v_mfma_f32_16x16x32_bf16 v[224:227], a[84:87], v[204:207], v[224:227]
  s_nop 0
  v_mfma_f32_16x16x32_bf16 v[224:227], a[88:91], v[208:211], v[224:227]
  s_add_u32 s71, s71, 393216
  v_mfma_f32_16x16x32_bf16 v[224:227], a[92:95], v[212:215], v[224:227]
  s_nop 0
  v_cvt_pk_bf16_f32 v232, v216, v217
  v_cvt_pk_bf16_f32 v233, v218, v219
  v_mfma_f32_16x16x32_bf16 v[228:231], a[96:99], v[184:187], 0
  s_nop 0
  v_cvt_pk_bf16_f32 v234, v220, v221
  v_cvt_pk_bf16_f32 v235, v222, v223
  v_mfma_f32_16x16x32_bf16 v[228:231], a[100:103], v[188:191], v[228:231]
  s_nop 0
  buffer_store_dwordx4 v[232:235], v2, s[40:43], s71 offen offset:0 sc1
  v_mfma_f32_16x16x32_bf16 v[228:231], a[104:107], v[192:195], v[228:231]
  s_nop 0
  v_mfma_f32_16x16x32_bf16 v[228:231], a[108:111], v[196:199], v[228:231]
  s_nop 0
  v_mfma_f32_16x16x32_bf16 v[228:231], a[112:115], v[200:203], v[228:231]
  s_nop 0
  v_mfma_f32_16x16x32_bf16 v[228:231], a[116:119], v[204:207], v[228:231]
  s_nop 0
  v_mfma_f32_16x16x32_bf16 v[228:231], a[120:123], v[208:211], v[228:231]
  s_nop 0
  v_mfma_f32_16x16x32_bf16 v[228:231], a[124:127], v[212:215], v[228:231]
  s_nop 0
  v_mfma_f32_16x16x32_bf16 v[216:219], a[128:131], v[184:187], 0
  s_nop 0
  v_mfma_f32_16x16x32_bf16 v[216:219], a[132:135], v[188:191], v[216:219]
  s_nop 0
  v_mfma_f32_16x16x32_bf16 v[216:219], a[136:139], v[192:195], v[216:219]
  s_nop 0
  v_mfma_f32_16x16x32_bf16 v[216:219], a[140:143], v[196:199], v[216:219]
  s_nop 0
  v_mfma_f32_16x16x32_bf16 v[216:219], a[144:147], v[200:203], v[216:219]
  s_nop 0
  v_mfma_f32_16x16x32_bf16 v[216:219], a[148:151], v[204:207], v[216:219]
  s_nop 0
  v_mfma_f32_16x16x32_bf16 v[216:219], a[152:155], v[208:211], v[216:219]
  s_nop 0
  v_mfma_f32_16x16x32_bf16 v[216:219], a[156:159], v[212:215], v[216:219]
  s_nop 0
  v_cvt_pk_bf16_f32 v236, v224, v225
  v_cvt_pk_bf16_f32 v237, v226, v227
  v_mfma_f32_16x16x32_bf16 v[220:223], a[160:163], v[184:187], 0
  s_nop 0
  v_cvt_pk_bf16_f32 v238, v228, v229
  v_cvt_pk_bf16_f32 v239, v230, v231
  v_mfma_f32_16x16x32_bf16 v[220:223], a[164:167], v[188:191], v[220:223]
  s_nop 0
  buffer_store_dwordx4 v[236:239], v2, s[40:43], s71 offen offset:1024 sc1
  v_mfma_f32_16x16x32_bf16 v[220:223], a[168:171], v[192:195], v[220:223]
  s_nop 0
  v_mfma_f32_16x16x32_bf16 v[220:223], a[172:175], v[196:199], v[220:223]
  s_nop 0
  v_mfma_f32_16x16x32_bf16 v[220:223], a[176:179], v[200:203], v[220:223]
  s_nop 0
  v_mfma_f32_16x16x32_bf16 v[220:223], a[180:183], v[204:207], v[220:223]
  s_nop 0
  v_mfma_f32_16x16x32_bf16 v[220:223], a[184:187], v[208:211], v[220:223]
  s_nop 0
  v_mfma_f32_16x16x32_bf16 v[220:223], a[188:191], v[212:215], v[220:223]
  s_nop 0
  v_mfma_f32_16x16x32_bf16 v[224:227], a[192:195], v[184:187], 0
  s_nop 0
  v_mfma_f32_16x16x32_bf16 v[224:227], a[196:199], v[188:191], v[224:227]
  s_nop 0
  v_mfma_f32_16x16x32_bf16 v[224:227], a[200:203], v[192:195], v[224:227]
  s_nop 0
  v_mfma_f32_16x16x32_bf16 v[224:227], a[204:207], v[196:199], v[224:227]
  s_nop 0
  v_mfma_f32_16x16x32_bf16 v[224:227], a[208:211], v[200:203], v[224:227]
  s_nop 0
  v_mfma_f32_16x16x32_bf16 v[224:227], a[212:215], v[204:207], v[224:227]
  s_nop 0
  v_mfma_f32_16x16x32_bf16 v[224:227], a[216:219], v[208:211], v[224:227]
  s_nop 0
  v_mfma_f32_16x16x32_bf16 v[224:227], a[220:223], v[212:215], v[224:227]
  s_nop 0
  v_cvt_pk_bf16_f32 v232, v216, v217
  v_cvt_pk_bf16_f32 v233, v218, v219
  v_mfma_f32_16x16x32_bf16 v[228:231], a[224:227], v[184:187], 0
  s_nop 0
  v_cvt_pk_bf16_f32 v234, v220, v221
  v_cvt_pk_bf16_f32 v235, v222, v223
  v_mfma_f32_16x16x32_bf16 v[228:231], a[228:231], v[188:191], v[228:231]
  s_nop 0
  buffer_store_dwordx4 v[232:235], v2, s[40:43], s71 offen offset:2048 sc1
  v_mfma_f32_16x16x32_bf16 v[228:231], a[232:235], v[192:195], v[228:231]
  s_nop 0
  v_mfma_f32_16x16x32_bf16 v[228:231], a[236:239], v[196:199], v[228:231]
  s_nop 0
  v_mfma_f32_16x16x32_bf16 v[228:231], a[240:243], v[200:203], v[228:231]
  s_nop 0
  v_mfma_f32_16x16x32_bf16 v[228:231], a[244:247], v[204:207], v[228:231]
  s_nop 0
  v_mfma_f32_16x16x32_bf16 v[228:231], a[248:251], v[208:211], v[228:231]
  s_nop 0
  v_mfma_f32_16x16x32_bf16 v[228:231], a[252:255], v[212:215], v[228:231]
  s_nop 0
  s_nop 6
  v_cvt_pk_bf16_f32 v236, v224, v225
  v_cvt_pk_bf16_f32 v237, v226, v227
  v_cvt_pk_bf16_f32 v238, v228, v229
  v_cvt_pk_bf16_f32 v239, v230, v231
  buffer_store_dwordx4 v[236:239], v2, s[40:43], s71 offen offset:3072 sc1
  s_cmp_ge_u32 s66, 49152
  s_mov_b32 s60, 49152
  s_cmov_b32 s60, -49152
  s_add_u32 s66, s66, s60
  s_waitcnt vmcnt(0)
  s_bitcmp1_b32 s62, 2
  s_cbranch_scc1 L_b_sig_5
  s_lshr_b32 s58, s62, 2
  s_add_u32 s58, s58, 147456
  v_mov_b32 v3, s58
  s_mov_b64 exec, 1
  ds_add_rtn_u32 v3, v3, v241
  s_lshl_b32 s58, s62, 3
  s_add_u32 s58, s58, 0xd087000
  s_waitcnt lgkmcnt(0)
  v_cmp_eq_u32 vcc, 3, v3
  s_cbranch_vccz L_b_sig_5x
  buffer_atomic_add v241, v7, s[40:43], s58 offen
L_b_sig_5x:
  s_mov_b64 exec, -1
L_b_sig_5:
  s_bitcmp1_b32 s64, 2
  s_cbranch_scc1 L_b_sig_6
  s_lshr_b32 s58, s64, 2
  s_add_u32 s58, s58, 147456
  v_mov_b32 v3, s58
  s_mov_b64 exec, 1
  ds_add_rtn_u32 v3, v3, v241
  s_lshl_b32 s58, s64, 3
  s_add_u32 s58, s58, 0xd087000
  s_waitcnt lgkmcnt(0)
  v_cmp_eq_u32 vcc, 3, v3
  s_cbranch_vccz L_b_sig_6x
  buffer_atomic_add v241, v7, s[40:43], s58 offen
L_b_sig_6x:
  s_mov_b64 exec, -1
L_b_sig_6:
  s_mov_b32 s64, 4
  s_bitcmp1_b32 s63, 2
  s_cbranch_scc0 L_b_chk
  s_barrier
  s_branch L_next
L_b_late:
  s_sleep 2
  s_lshl_b32 s58, s63, 13
  s_add_u32 s58, s58, s69
  buffer_load_dwordx4 v[56:59], v2, s[40:43], s58 offen offset:0 sc1
  buffer_load_dwordx4 v[60:63], v2, s[40:43], s58 offen offset:1024 sc1
  buffer_load_dwordx4 v[64:67], v2, s[40:43], s58 offen offset:2048 sc1
  buffer_load_dwordx4 v[68:71], v2, s[40:43], s58 offen offset:3072 sc1
  s_add_u32 s57, s57, 1
  s_cmp_gt_u32 s57, 1048576
  s_cbranch_scc1 L_exit
  s_waitcnt vmcnt(0)
  s_branch L_b_chk
L_b_ff_1:
  buffer_load_dword v240, v7, s[40:43], s73 offen sc1
  s_add_u32 s57, s57, 1
  s_cmp_gt_u32 s57, 1048576
  s_cbranch_scc1 L_exit
  s_waitcnt vmcnt(0)
  s_branch L_b_ff_1c
L_b_ff_2:
  buffer_load_dword v240, v7, s[40:43], s73 offen sc1
  s_add_u32 s57, s57, 1
  s_cmp_gt_u32 s57, 1048576
  s_cbranch_scc1 L_exit
  s_waitcnt vmcnt(0)
  s_branch L_b_ff_2c
L_b_ff_3:
  buffer_load_dword v240, v7, s[40:43], s73 offen sc1
  s_add_u32 s57, s57, 1
  s_cmp_gt_u32 s57, 1048576
  s_cbranch_scc1 L_exit
  s_waitcnt vmcnt(0)
  s_branch L_b_ff_3c
L_red:
  s_mov_b32 s48, s36
  s_and_b32 s49, s37, 0xffff
  s_mov_b32 s50, 0x200000
  s_mov_b32 s51, 0x20000
  v_lshlrev_b32 v2, 4, v0
  v_mov_b32 v7, 0
  s_mov_b32 s57, 0
  v_and_b32 v3, 4, v1
  v_cmp_ne_u32 vcc, 0, v3
  v_bfe_u32 v3, v1, 4, 6
  v_lshrrev_b32 v4, 3, v3
  s_lshr_b32 s58, vcc_lo, s95
  s_ff1_i32_b32 s58, s58
  s_bfm_b32 s58, s58, s95
  s_cmp_eq_u32 s62, 0
  s_cselect_b32 s59, s58, 0
  v_lshlrev_b32 v4, 7, v4
  v_add_u32 v4, 0xd086000, v4
  v_lshlrev_b32 v3, 7, v3
  v_add_u32 v3, 0xd087000, v3
  v_cmp_gt_u32 vcc, 32, v0
  v_and_b32 v5, 15, v0
  v_lshrrev_b32 v6, 4, v0
  v_cndmask_b32 v3, v3, v4, vcc
  v_cndmask_b32 v4, 16, 32, vcc
  buffer_load_dword v16, v3, s[40:43], 0 offen sc1
  v_lshlrev_b32 v24, 10, v5
  v_lshl_add_u32 v24, v6, 4, v24
  v_bfe_u32 v17, v0, 2, 1
  v_lshlrev_b32 v17, 1, v17
  v_sub_u32 v17, v6, v17
  v_bfe_u32 v18, v0, 3, 1
  v_bfe_u32 v19, v0, 1, 1
  v_lshl_add_u32 v18, v18, 1, v19
  v_lshl_add_u32 v17, v17, 2, v18
  v_and_b32 v18, 1, v0
  v_lshlrev_b32 v18, 4, v18
  v_mov_b32 v19, 0x3f80
  v_lshlrev_b32 v18, v18, v19
  v_cmp_eq_u32 vcc, 0, v17
  s_nop 1
  v_cndmask_b32 v8, 0, v18, vcc
  v_cmp_eq_u32 vcc, 1, v17
  s_nop 1
  v_cndmask_b32 v9, 0, v18, vcc
  v_cmp_eq_u32 vcc, 2, v17
  s_nop 1
  v_cndmask_b32 v10, 0, v18, vcc
  v_cmp_eq_u32 vcc, 3, v17
  s_nop 1
  v_cndmask_b32 v11, 0, v18, vcc
  v_cmp_eq_u32 vcc, 4, v17
  s_nop 1
  v_cndmask_b32 v12, 0, v18, vcc
  v_cmp_eq_u32 vcc, 5, v17
  s_nop 1
  v_cndmask_b32 v13, 0, v18, vcc
  v_cmp_eq_u32 vcc, 6, v17
  s_nop 1
  v_cndmask_b32 v14, 0, v18, vcc
  v_cmp_eq_u32 vcc, 7, v17
  s_nop 1
  v_cndmask_b32 v15, 0, v18, vcc
  v_readlane_b32 s63, v1, s95
L_r_wait:
  s_waitcnt vmcnt(0)
  v_cmp_gt_u32 vcc, v4, v16
  s_nop 0
  s_and_b64 vcc, vcc, s[58:59]
  s_cbranch_scc0 L_r_go
  s_sleep 4
  buffer_load_dword v16, v3, s[40:43], 0 offen sc1
  s_add_u32 s57, s57, 1
  s_cmp_gt_u32 s57, 1048576
  s_cbranch_scc1 L_exit
  s_branch L_r_wait
L_r_go:
  s_bfe_u32 s58, s63, 0x60004
  s_bfe_u32 s59, s63, 0x1000e
  s_lshl1_add_u32 s58, s58, s59
  s_mul_i32 s64, s58, 393216
  s_bfe_u32 s59, s63, 0x2000c
  s_lshl2_add_u32 s59, s59, s44
  s_lshl_b32 s58, s58, 14
  s_lshl_b32 s71, s59, 6
  s_add_u32 s71, s71, s58
  s_lshl_b32 s59, s59, 10
  s_add_u32 s64, s64, s59
  s_add_u32 s64, s64, 0x6000000
  s_bitcmp1_b32 s63, 2
  s_cselect_b32 s64, 0x40000000, s64
  buffer_load_dwordx4 v[64:67], v2, s[40:43], s64 offen sc1
  s_add_u32 s64, s64, 0x4000
  buffer_load_dwordx4 v[68:71], v2, s[40:43], s64 offen sc1
  s_add_u32 s64, s64, 0x4000
  buffer_load_dwordx4 v[72:75], v2, s[40:43], s64 offen sc1
  s_add_u32 s64, s64, 0x4000
  buffer_load_dwordx4 v[76:79], v2, s[40:43], s64 offen sc1
  s_add_u32 s64, s64, 0x4000
  buffer_load_dwordx4 v[80:83], v2, s[40:43], s64 offen sc1
  s_add_u32 s64, s64, 0x4000
  buffer_load_dwordx4 v[84:87], v2, s[40:43], s64 offen sc1
  s_add_u32 s64, s64, 0x4000
  buffer_load_dwordx4 v[88:91], v2, s[40:43], s64 offen sc1
  s_add_u32 s64, s64, 0x4000
  buffer_load_dwordx4 v[92:95], v2, s[40:43], s64 offen sc1
  s_add_u32 s64, s64, 0x4000
L_r_loop:
  s_mov_b32 s61, s63
  s_mov_b32 s65, s71
  s_add_u32 s95, s95, 1
  s_nop 0
  v_readlane_b32 s63, v1, s95
  s_cmp_lg_u32 s62, 0
  s_cbranch_scc1 L_r_stage
L_r_stageback:
  buffer_load_dwordx4 v[96:99], v2, s[40:43], s64 offen sc1
  s_add_u32 s64, s64, 0x4000
  s_waitcnt vmcnt(8)
  v_mfma_f32_16x16x32_bf16 v[16:19], v[8:11], v[64:67], 0
  v_mfma_f32_16x16x32_bf16 v[20:23], v[12:15], v[64:67], 0
  buffer_load_dwordx4 v[100:103], v2, s[40:43], s64 offen sc1
  s_add_u32 s64, s64, 0x4000
  s_waitcnt vmcnt(8)
  v_mfma_f32_16x16x32_bf16 v[16:19], v[8:11], v[68:71], v[16:19]
  v_mfma_f32_16x16x32_bf16 v[20:23], v[12:15], v[68:71], v[20:23]
  buffer_load_dwordx4 v[104:107], v2, s[40:43], s64 offen sc1
  s_add_u32 s64, s64, 0x4000
  s_waitcnt vmcnt(8)
  v_mfma_f32_16x16x32_bf16 v[16:19], v[8:11], v[72:75], v[16:19]
  v_mfma_f32_16x16x32_bf16 v[20:23], v[12:15], v[72:75], v[20:23]
  buffer_load_dwordx4 v[108:111], v2, s[40:43], s64 offen sc1
  s_add_u32 s64, s64, 0x4000
  s_waitcnt vmcnt(8)
  v_mfma_f32_16x16x32_bf16 v[16:19], v[8:11], v[76:79], v[16:19]
  v_mfma_f32_16x16x32_bf16 v[20:23], v[12:15], v[76:79], v[20:23]
  buffer_load_dwordx4 v[112:115], v2, s[40:43], s64 offen sc1
  s_add_u32 s64, s64, 0x4000
  s_waitcnt vmcnt(8)
  v_mfma_f32_16x16x32_bf16 v[16:19], v[8:11], v[80:83], v[16:19]
  v_mfma_f32_16x16x32_bf16 v[20:23], v[12:15], v[80:83], v[20:23]
  buffer_load_dwordx4 v[116:119], v2, s[40:43], s64 offen sc1
  s_add_u32 s64, s64, 0x4000
  s_waitcnt vmcnt(8)
  v_mfma_f32_16x16x32_bf16 v[16:19], v[8:11], v[84:87], v[16:19]
  v_mfma_f32_16x16x32_bf16 v[20:23], v[12:15], v[84:87], v[20:23]
  buffer_load_dwordx4 v[120:123], v2, s[40:43], s64 offen sc1
  s_add_u32 s64, s64, 0x4000
  s_waitcnt vmcnt(8)
  v_mfma_f32_16x16x32_bf16 v[16:19], v[8:11], v[88:91], v[16:19]
  v_mfma_f32_16x16x32_bf16 v[20:23], v[12:15], v[88:91], v[20:23]
  buffer_load_dwordx4 v[124:127], v2, s[40:43], s64 offen sc1
  s_add_u32 s64, s64, 0x4000
  s_waitcnt vmcnt(8)
  v_mfma_f32_16x16x32_bf16 v[16:19], v[8:11], v[92:95], v[16:19]
  v_mfma_f32_16x16x32_bf16 v[20:23], v[12:15], v[92:95], v[20:23]
  buffer_load_dwordx4 v[128:131], v2, s[40:43], s64 offen sc1
  s_add_u32 s64, s64, 0x4000
  s_waitcnt vmcnt(8)
  v_mfma_f32_16x16x32_bf16 v[16:19], v[8:11], v[96:99], v[16:19]
  v_mfma_f32_16x16x32_bf16 v[20:23], v[12:15], v[96:99], v[20:23]
  buffer_load_dwordx4 v[132:135], v2, s[40:43], s64 offen sc1
  s_add_u32 s64, s64, 0x4000
  s_waitcnt vmcnt(8)
  v_mfma_f32_16x16x32_bf16 v[16:19], v[8:11], v[100:103], v[16:19]
  v_mfma_f32_16x16x32_bf16 v[20:23], v[12:15], v[100:103], v[20:23]
  buffer_load_dwordx4 v[136:139], v2, s[40:43], s64 offen sc1
  s_add_u32 s64, s64, 0x4000
  s_waitcnt vmcnt(8)
  v_mfma_f32_16x16x32_bf16 v[16:19], v[8:11], v[104:107], v[16:19]
  v_mfma_f32_16x16x32_bf16 v[20:23], v[12:15], v[104:107], v[20:23]
  buffer_load_dwordx4 v[140:143], v2, s[40:43], s64 offen sc1
  s_add_u32 s64, s64, 0x4000
  s_waitcnt vmcnt(8)
  v_mfma_f32_16x16x32_bf16 v[16:19], v[8:11], v[108:111], v[16:19]
  v_mfma_f32_16x16x32_bf16 v[20:23], v[12:15], v[108:111], v[20:23]
  buffer_load_dwordx4 v[144:147], v2, s[40:43], s64 offen sc1
  s_add_u32 s64, s64, 0x4000
  s_waitcnt vmcnt(8)
  v_mfma_f32_16x16x32_bf16 v[16:19], v[8:11], v[112:115], v[16:19]
  v_mfma_f32_16x16x32_bf16 v[20:23], v[12:15], v[112:115], v[20:23]
  buffer_load_dwordx4 v[148:151], v2, s[40:43], s64 offen sc1
  s_add_u32 s64, s64, 0x4000
  s_waitcnt vmcnt(8)
  v_mfma_f32_16x16x32_bf16 v[16:19], v[8:11], v[116:119], v[16:19]
  v_mfma_f32_16x16x32_bf16 v[20:23], v[12:15], v[116:119], v[20:23]
  buffer_load_dwordx4 v[152:155], v2, s[40:43], s64 offen sc1
  s_add_u32 s64, s64, 0x4000
  s_waitcnt vmcnt(8)
  v_mfma_f32_16x16x32_bf16 v[16:19], v[8:11], v[120:123], v[16:19]
  v_mfma_f32_16x16x32_bf16 v[20:23], v[12:15], v[120:123], v[20:23]
  buffer_load_dwordx4 v[156:159], v2, s[40:43], s64 offen sc1
  s_add_u32 s64, s64, 0x4000
  s_waitcnt vmcnt(8)
  v_mfma_f32_16x16x32_bf16 v[16:19], v[8:11], v[124:127], v[16:19]
  v_mfma_f32_16x16x32_bf16 v[20:23], v[12:15], v[124:127], v[20:23]
  s_bfe_u32 s58, s63, 0x60004
  s_bfe_u32 s59, s63, 0x1000e
  s_lshl1_add_u32 s58, s58, s59
  s_mul_i32 s64, s58, 393216
  s_bfe_u32 s59, s63, 0x2000c
  s_lshl2_add_u32 s59, s59, s44
  s_lshl_b32 s58, s58, 14
  s_lshl_b32 s71, s59, 6
  s_add_u32 s71, s71, s58
  s_lshl_b32 s59, s59, 10
  s_add_u32 s64, s64, s59
  s_add_u32 s64, s64, 0x6000000
  s_bitcmp1_b32 s63, 2
  s_cselect_b32 s64, 0x40000000, s64
  buffer_load_dwordx4 v[64:67], v2, s[40:43], s64 offen sc1
  s_add_u32 s64, s64, 0x4000
  s_waitcnt vmcnt(8)
  v_mfma_f32_16x16x32_bf16 v[16:19], v[8:11], v[128:131], v[16:19]
  v_mfma_f32_16x16x32_bf16 v[20:23], v[12:15], v[128:131], v[20:23]
  buffer_load_dwordx4 v[68:71], v2, s[40:43], s64 offen sc1
  s_add_u32 s64, s64, 0x4000
  s_waitcnt vmcnt(8)
  v_mfma_f32_16x16x32_bf16 v[16:19], v[8:11], v[132:135], v[16:19]
  v_mfma_f32_16x16x32_bf16 v[20:23], v[12:15], v[132:135], v[20:23]
  buffer_load_dwordx4 v[72:75], v2, s[40:43], s64 offen sc1
  s_add_u32 s64, s64, 0x4000
  s_waitcnt vmcnt(8)
  v_mfma_f32_16x16x32_bf16 v[16:19], v[8:11], v[136:139], v[16:19]
  v_mfma_f32_16x16x32_bf16 v[20:23], v[12:15], v[136:139], v[20:23]
  buffer_load_dwordx4 v[76:79], v2, s[40:43], s64 offen sc1
  s_add_u32 s64, s64, 0x4000
  s_waitcnt vmcnt(8)
  v_mfma_f32_16x16x32_bf16 v[16:19], v[8:11], v[140:143], v[16:19]
  v_mfma_f32_16x16x32_bf16 v[20:23], v[12:15], v[140:143], v[20:23]
  buffer_load_dwordx4 v[80:83], v2, s[40:43], s64 offen sc1
  s_add_u32 s64, s64, 0x4000
  s_waitcnt vmcnt(8)
  v_mfma_f32_16x16x32_bf16 v[16:19], v[8:11], v[144:147], v[16:19]
  v_mfma_f32_16x16x32_bf16 v[20:23], v[12:15], v[144:147], v[20:23]
  buffer_load_dwordx4 v[84:87], v2, s[40:43], s64 offen sc1
  s_add_u32 s64, s64, 0x4000
  s_waitcnt vmcnt(8)
  v_mfma_f32_16x16x32_bf16 v[16:19], v[8:11], v[148:151], v[16:19]
  v_mfma_f32_16x16x32_bf16 v[20:23], v[12:15], v[148:151], v[20:23]
  buffer_load_dwordx4 v[88:91], v2, s[40:43], s64 offen sc1
  s_add_u32 s64, s64, 0x4000
  s_waitcnt vmcnt(8)
  v_mfma_f32_16x16x32_bf16 v[16:19], v[8:11], v[152:155], v[16:19]
  v_mfma_f32_16x16x32_bf16 v[20:23], v[12:15], v[152:155], v[20:23]
  buffer_load_dwordx4 v[92:95], v2, s[40:43], s64 offen sc1
  s_add_u32 s64, s64, 0x4000
  s_waitcnt vmcnt(8)
  v_mfma_f32_16x16x32_bf16 v[16:19], v[8:11], v[156:159], v[16:19]
  v_mfma_f32_16x16x32_bf16 v[20:23], v[12:15], v[156:159], v[20:23]
  s_nop 6
  v_cvt_pk_bf16_f32 v32, v16, v17
  v_cvt_pk_bf16_f32 v33, v18, v19
  v_cvt_pk_bf16_f32 v34, v20, v21
  v_cvt_pk_bf16_f32 v35, v22, v23
  buffer_store_dwordx4 v[32:35], v24, s[48:51], s65 offen
  s_bitcmp1_b32 s63, 2
  s_cbranch_scc0 L_r_loop
  s_waitcnt vmcnt(1)
  s_branch L_next
L_r_stage:
  s_bfe_u32 s66, s61, 0x60004
  s_lshl_b32 s66, s66, 7
  s_add_u32 s66, s66, 0xd087000
L_r_st2:
  buffer_load_dword v3, v7, s[40:43], s66 offen sc1
  s_add_u32 s57, s57, 1
  s_cmp_gt_u32 s57, 1048576
  s_cbranch_scc1 L_exit
  s_waitcnt vmcnt(0)
  v_cmp_gt_u32 vcc, 16, v3
  s_cbranch_vccz L_r_stageback
  s_sleep 4
  s_branch L_r_st2
L_feed:
  s_cmp_lt_u32 s57, 4
  s_cselect_b64 s[52:53], s[10:11], s[8:9]
  s_cselect_b64 s[48:49], s[14:15], s[12:13]
  s_cselect_b64 s[4:5], s[16:17], s[24:25]
  s_cselect_b32 s72, 0x21, 0x30
  s_cselect_b32 s67, 16, 32
  s_cselect_b32 s69, 1.0, 0x3e0293ee
  s_cselect_b32 s74, 2, 4
  s_cmp_eq_u32 s57, 6
  s_cselect_b64 s[48:49], s[26:27], s[48:49]
  s_cselect_b64 s[4:5], s[28:29], s[4:5]
  s_cselect_b32 s72, 0x54, s72
  s_cselect_b32 s67, 64, s67
  s_cselect_b32 s80, 4, 0
  s_cselect_b32 s69, 1.0, s69
  s_cselect_b32 s74, 2, s74
  v_readlane_b32 s73, v1, s95
  s_add_u32 s95, s95, 1
  s_and_b32 s53, s53, 0xffff
  s_mov_b32 s54, 0x200000
  s_mov_b32 s55, 0x20000
  s_cmp_lt_u32 s44, 2
  s_cselect_b64 s[48:49], s[48:49], s[4:5]
  s_cselect_b32 s58, 0, 4
  s_lshr_b32 s72, s72, s58
  s_and_b32 s72, s72, 15
  s_and_b32 s49, s49, 0xffff
  s_mov_b32 s50, 0x400000
  s_mov_b32 s51, 0x20000
  v_lshlrev_b32 v2, 4, v0
  v_mov_b32 v6, 0
  v_lshrrev_b32 v3, 3, v0
  v_lshlrev_b32 v20, 13, v3
  v_and_b32 v3, 2, v3
  v_and_b32 v4, 7, v0
  v_xor_b32 v3, v3, v4
  v_lshl_add_u32 v20, v3, 4, v20
  v_xor_b32 v21, 64, v20
  s_lshl_b32 s60, s44, 14
  s_add_u32 s60, s60, 0x18000
  s_and_b32 s59, s44, 1
  s_lshl1_add_u32 s75, s56, s59
  s_lshl_b32 s75, s75, 7
  s_lshl_b32 s58, s57, 2
  s_lshr_b32 s78, 0, s58
  s_and_b32 s78, s78, 15
  s_lshl_b32 s58, s78, 20
  s_or_b32 s75, s75, s58
  s_cmp_lt_u32 s72, 3
  s_cbranch_scc1 L_f_w_7
  s_add_u32 m0, s60, 0
  s_xor_b32 s58, s75, 0
  buffer_load_dwordx4 v20, s[48:51], s58 offen  lds
  s_add_u32 m0, s60, 1024
  s_xor_b32 s58, s75, 65536
  buffer_load_dwordx4 v21, s[48:51], s58 offen  lds
  s_add_u32 m0, s60, 2048
  s_xor_b32 s58, s75, 131072
  buffer_load_dwordx4 v20, s[48:51], s58 offen  lds
  s_add_u32 m0, s60, 3072
  s_xor_b32 s58, s75, 196608
  buffer_load_dwordx4 v21, s[48:51], s58 offen  lds
  s_branch L_f_w_7e
L_f_w_7:
  s_add_u32 m0, s60, 0
  s_xor_b32 s58, s75, 0
  buffer_load_dwordx4 v20, s[48:51], s58 offen nt lds
  s_add_u32 m0, s60, 1024
  s_xor_b32 s58, s75, 65536
  buffer_load_dwordx4 v21, s[48:51], s58 offen nt lds
  s_add_u32 m0, s60, 2048
  s_xor_b32 s58, s75, 131072
  buffer_load_dwordx4 v20, s[48:51], s58 offen nt lds
  s_add_u32 m0, s60, 3072
  s_xor_b32 s58, s75, 196608
  buffer_load_dwordx4 v21, s[48:51], s58 offen nt lds
L_f_w_7e:
  s_cmp_lt_u32 s72, 3
  s_cbranch_scc1 L_f_w_8
  s_add_u32 m0, s60, 4096
  s_xor_b32 s58, s75, 262144
  buffer_load_dwordx4 v20, s[48:51], s58 offen  lds
  s_add_u32 m0, s60, 5120
  s_xor_b32 s58, s75, 327680
  buffer_load_dwordx4 v21, s[48:51], s58 offen  lds
  s_add_u32 m0, s60, 6144
  s_xor_b32 s58, s75, 393216
  buffer_load_dwordx4 v20, s[48:51], s58 offen  lds
  s_add_u32 m0, s60, 7168
  s_xor_b32 s58, s75, 458752
  buffer_load_dwordx4 v21, s[48:51], s58 offen  lds
  s_branch L_f_w_8e
L_f_w_8:
  s_add_u32 m0, s60, 4096
  s_xor_b32 s58, s75, 262144
  buffer_load_dwordx4 v20, s[48:51], s58 offen nt lds
  s_add_u32 m0, s60, 5120
  s_xor_b32 s58, s75, 327680
  buffer_load_dwordx4 v21, s[48:51], s58 offen nt lds
  s_add_u32 m0, s60, 6144
  s_xor_b32 s58, s75, 393216
  buffer_load_dwordx4 v20, s[48:51], s58 offen nt lds
  s_add_u32 m0, s60, 7168
  s_xor_b32 s58, s75, 458752
  buffer_load_dwordx4 v21, s[48:51], s58 offen nt lds
L_f_w_8e:
  s_cmp_lt_u32 s72, 3
  s_cbranch_scc1 L_f_w_9
  s_add_u32 m0, s60, 8192
  s_xor_b32 s58, s75, 524288
  buffer_load_dwordx4 v20, s[48:51], s58 offen  lds
  s_add_u32 m0, s60, 9216
  s_xor_b32 s58, s75, 589824
  buffer_load_dwordx4 v21, s[48:51], s58 offen  lds
  s_add_u32 m0, s60, 10240
  s_xor_b32 s58, s75, 655360
  buffer_load_dwordx4 v20, s[48:51], s58 offen  lds
  s_add_u32 m0, s60, 11264
  s_xor_b32 s58, s75, 720896
  buffer_load_dwordx4 v21, s[48:51], s58 offen  lds
  s_branch L_f_w_9e
L_f_w_9:
  s_add_u32 m0, s60, 8192
  s_xor_b32 s58, s75, 524288
  buffer_load_dwordx4 v20, s[48:51], s58 offen nt lds
  s_add_u32 m0, s60, 9216
  s_xor_b32 s58, s75, 589824
  buffer_load_dwordx4 v21, s[48:51], s58 offen nt lds
  s_add_u32 m0, s60, 10240
  s_xor_b32 s58, s75, 655360
  buffer_load_dwordx4 v20, s[48:51], s58 offen nt lds
  s_add_u32 m0, s60, 11264
  s_xor_b32 s58, s75, 720896
  buffer_load_dwordx4 v21, s[48:51], s58 offen nt lds
L_f_w_9e:
  s_cmp_lt_u32 s72, 3
  s_cbranch_scc1 L_f_w_10
  s_add_u32 m0, s60, 12288
  s_xor_b32 s58, s75, 786432
  buffer_load_dwordx4 v20, s[48:51], s58 offen  lds
  s_add_u32 m0, s60, 13312
  s_xor_b32 s58, s75, 851968
  buffer_load_dwordx4 v21, s[48:51], s58 offen  lds
  s_add_u32 m0, s60, 14336
  s_xor_b32 s58, s75, 917504
  buffer_load_dwordx4 v20, s[48:51], s58 offen  lds
  s_add_u32 m0, s60, 15360
  s_xor_b32 s58, s75, 983040
  buffer_load_dwordx4 v21, s[48:51], s58 offen  lds
  s_branch L_f_w_10e
L_f_w_10:
  s_add_u32 m0, s60, 12288
  s_xor_b32 s58, s75, 786432
  buffer_load_dwordx4 v20, s[48:51], s58 offen nt lds
  s_add_u32 m0, s60, 13312
  s_xor_b32 s58, s75, 851968
  buffer_load_dwordx4 v21, s[48:51], s58 offen nt lds
  s_add_u32 m0, s60, 14336
  s_xor_b32 s58, s75, 917504
  buffer_load_dwordx4 v20, s[48:51], s58 offen nt lds
  s_add_u32 m0, s60, 15360
  s_xor_b32 s58, s75, 983040
  buffer_load_dwordx4 v21, s[48:51], s58 offen nt lds
L_f_w_10e:
  s_mov_b32 s76, 0x40000000
  v_and_b32 v32, 15, v0
  v_mov_b32 v33, 1
  s_lshl2_add_u32 s58, s44, s57
  s_cmp_ge_u32 s58, 4
  s_cbranch_scc1 L_f_nogate
  s_mov_b64 s[4:5], s[8:9]
  s_mov_b64 s[6:7], s[34:35]
  v_lshrrev_b32 v4, 4, v0
  v_lshlrev_b32 v4, 4, v4
  v_lshl_add_u32 v5, v32, 10, v4
  s_lshl2_add_u32 s77, s56, s57
  s_lshl_b32 s58, s77, 14
  v_add_u32 v5, s58, v5
  global_load_dwordx4 v[64:67], v5, s[4:5] offset:0
  global_load_dwordx4 v[128:131], v4, s[6:7] offset:0
  global_load_dwordx4 v[68:71], v5, s[4:5] offset:64
  global_load_dwordx4 v[132:135], v4, s[6:7] offset:64
  global_load_dwordx4 v[72:75], v5, s[4:5] offset:128
  global_load_dwordx4 v[136:139], v4, s[6:7] offset:128
  global_load_dwordx4 v[76:79], v5, s[4:5] offset:192
  global_load_dwordx4 v[140:143], v4, s[6:7] offset:192
  global_load_dwordx4 v[80:83], v5, s[4:5] offset:256
  global_load_dwordx4 v[144:147], v4, s[6:7] offset:256
  global_load_dwordx4 v[84:87], v5, s[4:5] offset:320
  global_load_dwordx4 v[148:151], v4, s[6:7] offset:320
  global_load_dwordx4 v[88:91], v5, s[4:5] offset:384
  global_load_dwordx4 v[152:155], v4, s[6:7] offset:384
  global_load_dwordx4 v[92:95], v5, s[4:5] offset:448
  global_load_dwordx4 v[156:159], v4, s[6:7] offset:448
  global_load_dwordx4 v[96:99], v5, s[4:5] offset:512
  global_load_dwordx4 v[160:163], v4, s[6:7] offset:512
  global_load_dwordx4 v[100:103], v5, s[4:5] offset:576
  global_load_dwordx4 v[164:167], v4, s[6:7] offset:576
  global_load_dwordx4 v[104:107], v5, s[4:5] offset:640
  global_load_dwordx4 v[168:171], v4, s[6:7] offset:640
  global_load_dwordx4 v[108:111], v5, s[4:5] offset:704
  global_load_dwordx4 v[172:175], v4, s[6:7] offset:704
  global_load_dwordx4 v[112:115], v5, s[4:5] offset:768
  global_load_dwordx4 v[176:179], v4, s[6:7] offset:768
  global_load_dwordx4 v[116:119], v5, s[4:5] offset:832
  global_load_dwordx4 v[180:183], v4, s[6:7] offset:832
  global_load_dwordx4 v[120:123], v5, s[4:5] offset:896
  global_load_dwordx4 v[184:187], v4, s[6:7] offset:896
  global_load_dwordx4 v[124:127], v5, s[4:5] offset:960
  global_load_dwordx4 v[188:191], v4, s[6:7] offset:960
  v_lshlrev_b32 v32, 2, v32
  s_lshl_b32 s77, s77, 6
  s_add_u32 s77, s77, 0xd0c0000
  s_lshr_b32 s76, s56, 2
  s_lshl_b32 s76, s76, 7
  s_add_u32 s76, s76, 0xd086400
L_f_nogate:
  v_lshrrev_b32 v3, 4, v0
  v_lshl_add_u32 v24, v3, 10, s60
  v_bfe_u32 v4, v0, 2, 2
  v_lshl_add_u32 v24, v4, 7, v24
  v_bfe_u32 v4, v0, 3, 2
  v_lshl_add_u32 v24, v4, 5, v24
  v_and_b32 v4, 3, v0
  v_lshl_add_u32 v24, v4, 3, v24
  v_and_b32 v4, 15, v0
  v_xor_b32 v3, v3, v4
  v_lshlrev_b32 v3, 4, v3
  v_lshl_add_u32 v16, v4, 10, v3
  s_lshl1_add_u32 s58, s78, s59
  s_lshl_b32 s58, s58, 7
  v_xor_b32 v8, s58, v2
  s_lshl_b32 s62, s72, 24
  s_lshl_b32 s58, s56, 19
  s_add_u32 s62, s62, s58
  s_lshl_b32 s58, s59, 12
  s_add_u32 s62, s62, s58
  s_add_u32 s65, s62, 0x0
  s_mov_b32 s62, 0x40000000
  s_lshl_b32 s58, s57, 2
  s_cmp_eq_u32 s57, 6
  s_cselect_b32 s58, 0x1000, s58
  s_lshl_b32 s64, s56, 7
  s_add_u32 s64, s64, s58
  s_add_u32 s64, s64, 0xd080000
  s_cmp_eq_u32 s44, 0
  s_cselect_b32 s64, s64, 0x40000000
  v_xor_b32 v25, 32, v24
  v_xor_b32 v17, 64, v16
  v_xor_b32 v26, 64, v24
  v_xor_b32 v18, 128, v16
  v_xor_b32 v27, 96, v24
  v_xor_b32 v19, 192, v16
  v_xor_b32 v9, 16, v8
  v_xor_b32 v10, 32, v8
  v_xor_b32 v11, 48, v8
  v_xor_b32 v12, 64, v8
  v_xor_b32 v13, 80, v8
  v_xor_b32 v14, 96, v8
  v_xor_b32 v15, 112, v8
  s_lshl_b32 s66, s44, 13
  s_mov_b32 s71, s66
  s_and_b32 s61, s73, 7
  s_lshl_b32 s61, s61, 18
  s_add_u32 s61, s61, s71
  s_mov_b32 s70, 0
  s_mov_b32 s63, 0
  s_mov_b32 s68, 0
  s_lshl2_add_u32 s79, s56, s44
  s_lshl_b32 s79, s79, 10
  s_add_u32 s79, s79, 0xc020000
  v_mov_b64 v[36:37], -1
  v_mov_b64 v[38:39], -1
  s_waitcnt vmcnt(12)
  ds_read_b64_tr_b16 a[0:1], v24 offset:0
  ds_read_b64_tr_b16 a[2:3], v24 offset:512
  ds_read_b64_tr_b16 a[64:65], v25 offset:0
  ds_read_b64_tr_b16 a[66:67], v25 offset:512
  ds_read_b64_tr_b16 a[128:129], v26 offset:0
  ds_read_b64_tr_b16 a[130:131], v26 offset:512
  ds_read_b64_tr_b16 a[192:193], v27 offset:0
  ds_read_b64_tr_b16 a[194:195], v27 offset:512
  s_waitcnt lgkmcnt(0)
  s_cmp_lt_u32 s72, 3
  s_cbranch_scc1 L_f_w_11
  s_add_u32 m0, s60, 0
  s_xor_b32 s58, s75, 1048576
  buffer_load_dwordx4 v20, s[48:51], s58 offen  lds
  s_add_u32 m0, s60, 1024
  s_xor_b32 s58, s75, 1114112
  buffer_load_dwordx4 v21, s[48:51], s58 offen  lds
  s_add_u32 m0, s60, 2048
  s_xor_b32 s58, s75, 1179648
  buffer_load_dwordx4 v20, s[48:51], s58 offen  lds
  s_add_u32 m0, s60, 3072
  s_xor_b32 s58, s75, 1245184
  buffer_load_dwordx4 v21, s[48:51], s58 offen  lds
  s_branch L_f_w_11e
L_f_w_11:
  s_add_u32 m0, s60, 0
  s_xor_b32 s58, s75, 1048576
  buffer_load_dwordx4 v20, s[48:51], s58 offen nt lds
  s_add_u32 m0, s60, 1024
  s_xor_b32 s58, s75, 1114112
  buffer_load_dwordx4 v21, s[48:51], s58 offen nt lds
  s_add_u32 m0, s60, 2048
  s_xor_b32 s58, s75, 1179648
  buffer_load_dwordx4 v20, s[48:51], s58 offen nt lds
  s_add_u32 m0, s60, 3072
  s_xor_b32 s58, s75, 1245184
  buffer_load_dwordx4 v21, s[48:51], s58 offen nt lds
L_f_w_11e:
  s_waitcnt vmcnt(12)
  ds_read_b64_tr_b16 a[4:5], v24 offset:4096
  ds_read_b64_tr_b16 a[6:7], v24 offset:4608
  ds_read_b64_tr_b16 a[68:69], v25 offset:4096
  ds_read_b64_tr_b16 a[70:71], v25 offset:4608
  ds_read_b64_tr_b16 a[132:133], v26 offset:4096
  ds_read_b64_tr_b16 a[134:135], v26 offset:4608
  ds_read_b64_tr_b16 a[196:197], v27 offset:4096
  ds_read_b64_tr_b16 a[198:199], v27 offset:4608
  s_waitcnt lgkmcnt(0)
  s_cmp_lt_u32 s72, 3
  s_cbranch_scc1 L_f_w_12
  s_add_u32 m0, s60, 4096
  s_xor_b32 s58, s75, 1310720
  buffer_load_dwordx4 v20, s[48:51], s58 offen  lds
  s_add_u32 m0, s60, 5120
  s_xor_b32 s58, s75, 1376256
  buffer_load_dwordx4 v21, s[48:51], s58 offen  lds
  s_add_u32 m0, s60, 6144
  s_xor_b32 s58, s75, 1441792
  buffer_load_dwordx4 v20, s[48:51], s58 offen  lds
  s_add_u32 m0, s60, 7168
  s_xor_b32 s58, s75, 1507328
  buffer_load_dwordx4 v21, s[48:51], s58 offen  lds
  s_branch L_f_w_12e
L_f_w_12:
  s_add_u32 m0, s60, 4096
  s_xor_b32 s58, s75, 1310720
  buffer_load_dwordx4 v20, s[48:51], s58 offen nt lds
  s_add_u32 m0, s60, 5120
  s_xor_b32 s58, s75, 1376256
  buffer_load_dwordx4 v21, s[48:51], s58 offen nt lds
  s_add_u32 m0, s60, 6144
  s_xor_b32 s58, s75, 1441792
  buffer_load_dwordx4 v20, s[48:51], s58 offen nt lds
  s_add_u32 m0, s60, 7168
  s_xor_b32 s58, s75, 1507328
  buffer_load_dwordx4 v21, s[48:51], s58 offen nt lds
L_f_w_12e:
  s_waitcnt vmcnt(12)
  ds_read_b64_tr_b16 a[8:9], v24 offset:8192
  ds_read_b64_tr_b16 a[10:11], v24 offset:8704
  ds_read_b64_tr_b16 a[72:73], v25 offset:8192
  ds_read_b64_tr_b16 a[74:75], v25 offset:8704
  ds_read_b64_tr_b16 a[136:137], v26 offset:8192
  ds_read_b64_tr_b16 a[138:139], v26 offset:8704
  ds_read_b64_tr_b16 a[200:201], v27 offset:8192
  ds_read_b64_tr_b16 a[202:203], v27 offset:8704
  s_waitcnt lgkmcnt(0)
  s_cmp_lt_u32 s72, 3
  s_cbranch_scc1 L_f_w_13
  s_add_u32 m0, s60, 8192
  s_xor_b32 s58, s75, 1572864
  buffer_load_dwordx4 v20, s[48:51], s58 offen  lds
  s_add_u32 m0, s60, 9216
  s_xor_b32 s58, s75, 1638400
  buffer_load_dwordx4 v21, s[48:51], s58 offen  lds
  s_add_u32 m0, s60, 10240
  s_xor_b32 s58, s75, 1703936
  buffer_load_dwordx4 v20, s[48:51], s58 offen  lds
  s_add_u32 m0, s60, 11264
  s_xor_b32 s58, s75, 1769472
  buffer_load_dwordx4 v21, s[48:51], s58 offen  lds
  s_branch L_f_w_13e
L_f_w_13:
  s_add_u32 m0, s60, 8192
  s_xor_b32 s58, s75, 1572864
  buffer_load_dwordx4 v20, s[48:51], s58 offen nt lds
  s_add_u32 m0, s60, 9216
  s_xor_b32 s58, s75, 1638400
  buffer_load_dwordx4 v21, s[48:51], s58 offen nt lds
  s_add_u32 m0, s60, 10240
  s_xor_b32 s58, s75, 1703936
  buffer_load_dwordx4 v20, s[48:51], s58 offen nt lds
  s_add_u32 m0, s60, 11264
  s_xor_b32 s58, s75, 1769472
  buffer_load_dwordx4 v21, s[48:51], s58 offen nt lds
L_f_w_13e:
  s_waitcnt vmcnt(12)
  ds_read_b64_tr_b16 a[12:13], v24 offset:12288
  ds_read_b64_tr_b16 a[14:15], v24 offset:12800
  ds_read_b64_tr_b16 a[76:77], v25 offset:12288
  ds_read_b64_tr_b16 a[78:79], v25 offset:12800
  ds_read_b64_tr_b16 a[140:141], v26 offset:12288
  ds_read_b64_tr_b16 a[142:143], v26 offset:12800
  ds_read_b64_tr_b16 a[204:205], v27 offset:12288
  ds_read_b64_tr_b16 a[206:207], v27 offset:12800
  s_waitcnt lgkmcnt(0)
  s_cmp_lt_u32 s72, 3
  s_cbranch_scc1 L_f_w_14
  s_add_u32 m0, s60, 12288
  s_xor_b32 s58, s75, 1835008
  buffer_load_dwordx4 v20, s[48:51], s58 offen  lds
  s_add_u32 m0, s60, 13312
  s_xor_b32 s58, s75, 1900544
  buffer_load_dwordx4 v21, s[48:51], s58 offen  lds
  s_add_u32 m0, s60, 14336
  s_xor_b32 s58, s75, 1966080
  buffer_load_dwordx4 v20, s[48:51], s58 offen  lds
  s_add_u32 m0, s60, 15360
  s_xor_b32 s58, s75, 2031616
  buffer_load_dwordx4 v21, s[48:51], s58 offen  lds
  s_branch L_f_w_14e
L_f_w_14:
  s_add_u32 m0, s60, 12288
  s_xor_b32 s58, s75, 1835008
  buffer_load_dwordx4 v20, s[48:51], s58 offen nt lds
  s_add_u32 m0, s60, 13312
  s_xor_b32 s58, s75, 1900544
  buffer_load_dwordx4 v21, s[48:51], s58 offen nt lds
  s_add_u32 m0, s60, 14336
  s_xor_b32 s58, s75, 1966080
  buffer_load_dwordx4 v20, s[48:51], s58 offen nt lds
  s_add_u32 m0, s60, 15360
  s_xor_b32 s58, s75, 2031616
  buffer_load_dwordx4 v21, s[48:51], s58 offen nt lds
L_f_w_14e:
  s_waitcnt vmcnt(12)
  ds_read_b64_tr_b16 a[16:17], v24 offset:0
  ds_read_b64_tr_b16 a[18:19], v24 offset:512
  ds_read_b64_tr_b16 a[80:81], v25 offset:0
  ds_read_b64_tr_b16 a[82:83], v25 offset:512
  ds_read_b64_tr_b16 a[144:145], v26 offset:0
  ds_read_b64_tr_b16 a[146:147], v26 offset:512
  ds_read_b64_tr_b16 a[208:209], v27 offset:0
  ds_read_b64_tr_b16 a[210:211], v27 offset:512
  s_waitcnt lgkmcnt(0)
  s_cmp_lt_u32 s72, 3
  s_cbranch_scc1 L_f_w_15
  s_add_u32 m0, s60, 0
  s_xor_b32 s58, s75, 2097152
  buffer_load_dwordx4 v20, s[48:51], s58 offen  lds
  s_add_u32 m0, s60, 1024
  s_xor_b32 s58, s75, 2162688
  buffer_load_dwordx4 v21, s[48:51], s58 offen  lds
  s_add_u32 m0, s60, 2048
  s_xor_b32 s58, s75, 2228224
  buffer_load_dwordx4 v20, s[48:51], s58 offen  lds
  s_add_u32 m0, s60, 3072
  s_xor_b32 s58, s75, 2293760
  buffer_load_dwordx4 v21, s[48:51], s58 offen  lds
  s_branch L_f_w_15e
L_f_w_15:
  s_add_u32 m0, s60, 0
  s_xor_b32 s58, s75, 2097152
  buffer_load_dwordx4 v20, s[48:51], s58 offen nt lds
  s_add_u32 m0, s60, 1024
  s_xor_b32 s58, s75, 2162688
  buffer_load_dwordx4 v21, s[48:51], s58 offen nt lds
  s_add_u32 m0, s60, 2048
  s_xor_b32 s58, s75, 2228224
  buffer_load_dwordx4 v20, s[48:51], s58 offen nt lds
  s_add_u32 m0, s60, 3072
  s_xor_b32 s58, s75, 2293760
  buffer_load_dwordx4 v21, s[48:51], s58 offen nt lds
L_f_w_15e:
  s_waitcnt vmcnt(12)
  ds_read_b64_tr_b16 a[20:21], v24 offset:4096
  ds_read_b64_tr_b16 a[22:23], v24 offset:4608
  ds_read_b64_tr_b16 a[84:85], v25 offset:4096
  ds_read_b64_tr_b16 a[86:87], v25 offset:4608
  ds_read_b64_tr_b16 a[148:149], v26 offset:4096
  ds_read_b64_tr_b16 a[150:151], v26 offset:4608
  ds_read_b64_tr_b16 a[212:213], v27 offset:4096
  ds_read_b64_tr_b16 a[214:215], v27 offset:4608
  s_waitcnt lgkmcnt(0)
  s_cmp_lt_u32 s72, 3
  s_cbranch_scc1 L_f_w_16
  s_add_u32 m0, s60, 4096
  s_xor_b32 s58, s75, 2359296
  buffer_load_dwordx4 v20, s[48:51], s58 offen  lds
  s_add_u32 m0, s60, 5120
  s_xor_b32 s58, s75, 2424832
  buffer_load_dwordx4 v21, s[48:51], s58 offen  lds
  s_add_u32 m0, s60, 6144
  s_xor_b32 s58, s75, 2490368
  buffer_load_dwordx4 v20, s[48:51], s58 offen  lds
  s_add_u32 m0, s60, 7168
  s_xor_b32 s58, s75, 2555904
  buffer_load_dwordx4 v21, s[48:51], s58 offen  lds
  s_branch L_f_w_16e
L_f_w_16:
  s_add_u32 m0, s60, 4096
  s_xor_b32 s58, s75, 2359296
  buffer_load_dwordx4 v20, s[48:51], s58 offen nt lds
  s_add_u32 m0, s60, 5120
  s_xor_b32 s58, s75, 2424832
  buffer_load_dwordx4 v21, s[48:51], s58 offen nt lds
  s_add_u32 m0, s60, 6144
  s_xor_b32 s58, s75, 2490368
  buffer_load_dwordx4 v20, s[48:51], s58 offen nt lds
  s_add_u32 m0, s60, 7168
  s_xor_b32 s58, s75, 2555904
  buffer_load_dwordx4 v21, s[48:51], s58 offen nt lds
L_f_w_16e:
  s_cmp_eq_u32 s76, 0x40000000
  s_cbranch_scc1 L_f_nogate2
  v_mfma_f32_16x16x32_bf16 v[192:195], v[128:131], v[64:67], 0
  v_mfma_f32_16x16x32_bf16 v[192:195], v[132:135], v[68:71], v[192:195]
  v_mfma_f32_16x16x32_bf16 v[192:195], v[136:139], v[72:75], v[192:195]
  v_mfma_f32_16x16x32_bf16 v[192:195], v[140:143], v[76:79], v[192:195]
  v_mfma_f32_16x16x32_bf16 v[192:195], v[144:147], v[80:83], v[192:195]
  v_mfma_f32_16x16x32_bf16 v[192:195], v[148:151], v[84:87], v[192:195]
  v_mfma_f32_16x16x32_bf16 v[192:195], v[152:155], v[88:91], v[192:195]
  v_mfma_f32_16x16x32_bf16 v[192:195], v[156:159], v[92:95], v[192:195]
  v_mfma_f32_16x16x32_bf16 v[192:195], v[160:163], v[96:99], v[192:195]
  v_mfma_f32_16x16x32_bf16 v[192:195], v[164:167], v[100:103], v[192:195]
  v_mfma_f32_16x16x32_bf16 v[192:195], v[168:171], v[104:107], v[192:195]
  v_mfma_f32_16x16x32_bf16 v[192:195], v[172:175], v[108:111], v[192:195]
  v_mfma_f32_16x16x32_bf16 v[192:195], v[176:179], v[112:115], v[192:195]
  v_mfma_f32_16x16x32_bf16 v[192:195], v[180:183], v[116:119], v[192:195]
  v_mfma_f32_16x16x32_bf16 v[192:195], v[184:187], v[120:123], v[192:195]
  v_mfma_f32_16x16x32_bf16 v[192:195], v[188:191], v[124:127], v[192:195]
  s_nop 7
  v_mul_f32 v192, 0xbfb8aa3b, v192
  v_exp_f32 v192, v192
  s_nop 0
  v_add_f32 v192, 1.0, v192
  v_rcp_f32 v192, v192
  s_nop 0
  buffer_store_dword v192, v32, s[40:43], s77 offen sc1
L_f_nogate2:
  s_waitcnt vmcnt(12)
  ds_read_b64_tr_b16 a[24:25], v24 offset:8192
  ds_read_b64_tr_b16 a[26:27], v24 offset:8704
  ds_read_b64_tr_b16 a[88:89], v25 offset:8192
  ds_read_b64_tr_b16 a[90:91], v25 offset:8704
  ds_read_b64_tr_b16 a[152:153], v26 offset:8192
  ds_read_b64_tr_b16 a[154:155], v26 offset:8704
  ds_read_b64_tr_b16 a[216:217], v27 offset:8192
  ds_read_b64_tr_b16 a[218:219], v27 offset:8704
  s_waitcnt lgkmcnt(0)
  s_cmp_lt_u32 s72, 3
  s_cbranch_scc1 L_f_w_17
  s_add_u32 m0, s60, 8192
  s_xor_b32 s58, s75, 2621440
  buffer_load_dwordx4 v20, s[48:51], s58 offen  lds
  s_add_u32 m0, s60, 9216
  s_xor_b32 s58, s75, 2686976
  buffer_load_dwordx4 v21, s[48:51], s58 offen  lds
  s_add_u32 m0, s60, 10240
  s_xor_b32 s58, s75, 2752512
  buffer_load_dwordx4 v20, s[48:51], s58 offen  lds
  s_add_u32 m0, s60, 11264
  s_xor_b32 s58, s75, 2818048
  buffer_load_dwordx4 v21, s[48:51], s58 offen  lds
  s_branch L_f_w_17e
L_f_w_17:
  s_add_u32 m0, s60, 8192
  s_xor_b32 s58, s75, 2621440
  buffer_load_dwordx4 v20, s[48:51], s58 offen nt lds
  s_add_u32 m0, s60, 9216
  s_xor_b32 s58, s75, 2686976
  buffer_load_dwordx4 v21, s[48:51], s58 offen nt lds
  s_add_u32 m0, s60, 10240
  s_xor_b32 s58, s75, 2752512
  buffer_load_dwordx4 v20, s[48:51], s58 offen nt lds
  s_add_u32 m0, s60, 11264
  s_xor_b32 s58, s75, 2818048
  buffer_load_dwordx4 v21, s[48:51], s58 offen nt lds
L_f_w_17e:
  s_waitcnt vmcnt(12)
  ds_read_b64_tr_b16 a[28:29], v24 offset:12288
  ds_read_b64_tr_b16 a[30:31], v24 offset:12800
  ds_read_b64_tr_b16 a[92:93], v25 offset:12288
  ds_read_b64_tr_b16 a[94:95], v25 offset:12800
  ds_read_b64_tr_b16 a[156:157], v26 offset:12288
  ds_read_b64_tr_b16 a[158:159], v26 offset:12800
  ds_read_b64_tr_b16 a[220:221], v27 offset:12288
  ds_read_b64_tr_b16 a[222:223], v27 offset:12800
  s_waitcnt lgkmcnt(0)
  s_cmp_lt_u32 s72, 3
  s_cbranch_scc1 L_f_w_18
  s_add_u32 m0, s60, 12288
  s_xor_b32 s58, s75, 2883584
  buffer_load_dwordx4 v20, s[48:51], s58 offen  lds
  s_add_u32 m0, s60, 13312
  s_xor_b32 s58, s75, 2949120
  buffer_load_dwordx4 v21, s[48:51], s58 offen  lds
  s_add_u32 m0, s60, 14336
  s_xor_b32 s58, s75, 3014656
  buffer_load_dwordx4 v20, s[48:51], s58 offen  lds
  s_add_u32 m0, s60, 15360
  s_xor_b32 s58, s75, 3080192
  buffer_load_dwordx4 v21, s[48:51], s58 offen  lds
  s_branch L_f_w_18e
L_f_w_18:
  s_add_u32 m0, s60, 12288
  s_xor_b32 s58, s75, 2883584
  buffer_load_dwordx4 v20, s[48:51], s58 offen nt lds
  s_add_u32 m0, s60, 13312
  s_xor_b32 s58, s75, 2949120
  buffer_load_dwordx4 v21, s[48:51], s58 offen nt lds
  s_add_u32 m0, s60, 14336
  s_xor_b32 s58, s75, 3014656
  buffer_load_dwordx4 v20, s[48:51], s58 offen nt lds
  s_add_u32 m0, s60, 15360
  s_xor_b32 s58, s75, 3080192
  buffer_load_dwordx4 v21, s[48:51], s58 offen nt lds
L_f_w_18e:
  s_waitcnt vmcnt(12)
  ds_read_b64_tr_b16 a[32:33], v24 offset:0
  ds_read_b64_tr_b16 a[34:35], v24 offset:512
  ds_read_b64_tr_b16 a[96:97], v25 offset:0
  ds_read_b64_tr_b16 a[98:99], v25 offset:512
  ds_read_b64_tr_b16 a[160:161], v26 offset:0
  ds_read_b64_tr_b16 a[162:163], v26 offset:512
  ds_read_b64_tr_b16 a[224:225], v27 offset:0
  ds_read_b64_tr_b16 a[226:227], v27 offset:512
  s_waitcnt lgkmcnt(0)
  s_cmp_lt_u32 s72, 3
  s_cbranch_scc1 L_f_w_19
  s_add_u32 m0, s60, 0
  s_xor_b32 s58, s75, 3145728
  buffer_load_dwordx4 v20, s[48:51], s58 offen  lds
  s_add_u32 m0, s60, 1024
  s_xor_b32 s58, s75, 3211264
  buffer_load_dwordx4 v21, s[48:51], s58 offen  lds
  s_add_u32 m0, s60, 2048
  s_xor_b32 s58, s75, 3276800
  buffer_load_dwordx4 v20, s[48:51], s58 offen  lds
  s_add_u32 m0, s60, 3072
  s_xor_b32 s58, s75, 3342336
  buffer_load_dwordx4 v21, s[48:51], s58 offen  lds
  s_branch L_f_w_19e
L_f_w_19:
  s_add_u32 m0, s60, 0
  s_xor_b32 s58, s75, 3145728
  buffer_load_dwordx4 v20, s[48:51], s58 offen nt lds
  s_add_u32 m0, s60, 1024
  s_xor_b32 s58, s75, 3211264
  buffer_load_dwordx4 v21, s[48:51], s58 offen nt lds
  s_add_u32 m0, s60, 2048
  s_xor_b32 s58, s75, 3276800
  buffer_load_dwordx4 v20, s[48:51], s58 offen nt lds
  s_add_u32 m0, s60, 3072
  s_xor_b32 s58, s75, 3342336
  buffer_load_dwordx4 v21, s[48:51], s58 offen nt lds
L_f_w_19e:
  s_waitcnt vmcnt(12)
  ds_read_b64_tr_b16 a[36:37], v24 offset:4096
  ds_read_b64_tr_b16 a[38:39], v24 offset:4608
  ds_read_b64_tr_b16 a[100:101], v25 offset:4096
  ds_read_b64_tr_b16 a[102:103], v25 offset:4608
  ds_read_b64_tr_b16 a[164:165], v26 offset:4096
  ds_read_b64_tr_b16 a[166:167], v26 offset:4608
  ds_read_b64_tr_b16 a[228:229], v27 offset:4096
  ds_read_b64_tr_b16 a[230:231], v27 offset:4608
  s_waitcnt lgkmcnt(0)
  s_cmp_lt_u32 s72, 3
  s_cbranch_scc1 L_f_w_20
  s_add_u32 m0, s60, 4096
  s_xor_b32 s58, s75, 3407872
  buffer_load_dwordx4 v20, s[48:51], s58 offen  lds
  s_add_u32 m0, s60, 5120
  s_xor_b32 s58, s75, 3473408
  buffer_load_dwordx4 v21, s[48:51], s58 offen  lds
  s_add_u32 m0, s60, 6144
  s_xor_b32 s58, s75, 3538944
  buffer_load_dwordx4 v20, s[48:51], s58 offen  lds
  s_add_u32 m0, s60, 7168
  s_xor_b32 s58, s75, 3604480
  buffer_load_dwordx4 v21, s[48:51], s58 offen  lds
  s_branch L_f_w_20e
L_f_w_20:
  s_add_u32 m0, s60, 4096
  s_xor_b32 s58, s75, 3407872
  buffer_load_dwordx4 v20, s[48:51], s58 offen nt lds
  s_add_u32 m0, s60, 5120
  s_xor_b32 s58, s75, 3473408
  buffer_load_dwordx4 v21, s[48:51], s58 offen nt lds
  s_add_u32 m0, s60, 6144
  s_xor_b32 s58, s75, 3538944
  buffer_load_dwordx4 v20, s[48:51], s58 offen nt lds
  s_add_u32 m0, s60, 7168
  s_xor_b32 s58, s75, 3604480
  buffer_load_dwordx4 v21, s[48:51], s58 offen nt lds
L_f_w_20e:
  s_waitcnt vmcnt(12)
  ds_read_b64_tr_b16 a[40:41], v24 offset:8192
  ds_read_b64_tr_b16 a[42:43], v24 offset:8704
  ds_read_b64_tr_b16 a[104:105], v25 offset:8192
  ds_read_b64_tr_b16 a[106:107], v25 offset:8704
  ds_read_b64_tr_b16 a[168:169], v26 offset:8192
  ds_read_b64_tr_b16 a[170:171], v26 offset:8704
  ds_read_b64_tr_b16 a[232:233], v27 offset:8192
  ds_read_b64_tr_b16 a[234:235], v27 offset:8704
  s_waitcnt lgkmcnt(0)
  s_cmp_lt_u32 s72, 3
  s_cbranch_scc1 L_f_w_21
  s_add_u32 m0, s60, 8192
  s_xor_b32 s58, s75, 3670016
  buffer_load_dwordx4 v20, s[48:51], s58 offen  lds
  s_add_u32 m0, s60, 9216
  s_xor_b32 s58, s75, 3735552
  buffer_load_dwordx4 v21, s[48:51], s58 offen  lds
  s_add_u32 m0, s60, 10240
  s_xor_b32 s58, s75, 3801088
  buffer_load_dwordx4 v20, s[48:51], s58 offen  lds
  s_add_u32 m0, s60, 11264
  s_xor_b32 s58, s75, 3866624
  buffer_load_dwordx4 v21, s[48:51], s58 offen  lds
  s_branch L_f_w_21e
L_f_w_21:
  s_add_u32 m0, s60, 8192
  s_xor_b32 s58, s75, 3670016
  buffer_load_dwordx4 v20, s[48:51], s58 offen nt lds
  s_add_u32 m0, s60, 9216
  s_xor_b32 s58, s75, 3735552
  buffer_load_dwordx4 v21, s[48:51], s58 offen nt lds
  s_add_u32 m0, s60, 10240
  s_xor_b32 s58, s75, 3801088
  buffer_load_dwordx4 v20, s[48:51], s58 offen nt lds
  s_add_u32 m0, s60, 11264
  s_xor_b32 s58, s75, 3866624
  buffer_load_dwordx4 v21, s[48:51], s58 offen nt lds
L_f_w_21e:
  s_waitcnt vmcnt(12)
  ds_read_b64_tr_b16 a[44:45], v24 offset:12288
  ds_read_b64_tr_b16 a[46:47], v24 offset:12800
  ds_read_b64_tr_b16 a[108:109], v25 offset:12288
  ds_read_b64_tr_b16 a[110:111], v25 offset:12800
  ds_read_b64_tr_b16 a[172:173], v26 offset:12288
  ds_read_b64_tr_b16 a[174:175], v26 offset:12800
  ds_read_b64_tr_b16 a[236:237], v27 offset:12288
  ds_read_b64_tr_b16 a[238:239], v27 offset:12800
  s_waitcnt lgkmcnt(0)
  s_cmp_lt_u32 s72, 3
  s_cbranch_scc1 L_f_w_22
  s_add_u32 m0, s60, 12288
  s_xor_b32 s58, s75, 3932160
  buffer_load_dwordx4 v20, s[48:51], s58 offen  lds
  s_add_u32 m0, s60, 13312
  s_xor_b32 s58, s75, 3997696
  buffer_load_dwordx4 v21, s[48:51], s58 offen  lds
  s_add_u32 m0, s60, 14336
  s_xor_b32 s58, s75, 4063232
  buffer_load_dwordx4 v20, s[48:51], s58 offen  lds
  s_add_u32 m0, s60, 15360
  s_xor_b32 s58, s75, 4128768
  buffer_load_dwordx4 v21, s[48:51], s58 offen  lds
  s_branch L_f_w_22e
L_f_w_22:
  s_add_u32 m0, s60, 12288
  s_xor_b32 s58, s75, 3932160
  buffer_load_dwordx4 v20, s[48:51], s58 offen nt lds
  s_add_u32 m0, s60, 13312
  s_xor_b32 s58, s75, 3997696
  buffer_load_dwordx4 v21, s[48:51], s58 offen nt lds
  s_add_u32 m0, s60, 14336
  s_xor_b32 s58, s75, 4063232
  buffer_load_dwordx4 v20, s[48:51], s58 offen nt lds
  s_add_u32 m0, s60, 15360
  s_xor_b32 s58, s75, 4128768
  buffer_load_dwordx4 v21, s[48:51], s58 offen nt lds
L_f_w_22e:
  s_waitcnt vmcnt(12)
  ds_read_b64_tr_b16 a[48:49], v24 offset:0
  ds_read_b64_tr_b16 a[50:51], v24 offset:512
  ds_read_b64_tr_b16 a[112:113], v25 offset:0
  ds_read_b64_tr_b16 a[114:115], v25 offset:512
  ds_read_b64_tr_b16 a[176:177], v26 offset:0
  ds_read_b64_tr_b16 a[178:179], v26 offset:512
  ds_read_b64_tr_b16 a[240:241], v27 offset:0
  ds_read_b64_tr_b16 a[242:243], v27 offset:512
  s_mov_b32 s48, s38
  s_and_b32 s49, s39, 0xffff
  s_mov_b32 s50, 0x100
  s_mov_b32 s51, 0x20000
  buffer_load_dwordx2 v[4:5], v6, s[48:51], 0 offen sc1
  s_add_u32 m0, s66, 0
  s_add_u32 s58, s61, 0
  buffer_load_dwordx4 v8, s[52:55], s58 offen lds
  s_add_u32 m0, s66, 1024
  s_add_u32 s58, s61, 1024
  buffer_load_dwordx4 v9, s[52:55], s58 offen lds
  s_add_u32 m0, s66, 2048
  s_add_u32 s58, s61, 2048
  buffer_load_dwordx4 v10, s[52:55], s58 offen lds
  s_add_u32 m0, s66, 3072
  s_add_u32 s58, s61, 3072
  buffer_load_dwordx4 v11, s[52:55], s58 offen lds
  s_add_u32 m0, s66, 4096
  s_add_u32 s58, s61, 4096
  buffer_load_dwordx4 v12, s[52:55], s58 offen lds
  s_add_u32 m0, s66, 5120
  s_add_u32 s58, s61, 5120
  buffer_load_dwordx4 v13, s[52:55], s58 offen lds
  s_add_u32 m0, s66, 6144
  s_add_u32 s58, s61, 6144
  buffer_load_dwordx4 v14, s[52:55], s58 offen lds
  s_add_u32 m0, s66, 7168
  s_add_u32 s58, s61, 7168
  buffer_load_dwordx4 v15, s[52:55], s58 offen lds
  s_add_u32 s70, s70, 1
  s_lshr_b32 s61, s70, 3
  s_lshl_b32 s61, s61, 2
  s_lshr_b32 s61, s73, s61
  s_and_b32 s61, s61, 7
  s_and_b32 s59, s70, 7
  s_lshl3_add_u32 s61, s61, s59
  s_lshl_b32 s61, s61, 15
  s_add_u32 s61, s61, s71
  s_add_u32 s66, s66, 0x8000
  s_and_b32 s66, s66, 0x1ffff
  s_waitcnt vmcnt(17)
  ds_read_b64_tr_b16 a[52:53], v24 offset:4096
  ds_read_b64_tr_b16 a[54:55], v24 offset:4608
  ds_read_b64_tr_b16 a[116:117], v25 offset:4096
  ds_read_b64_tr_b16 a[118:119], v25 offset:4608
  ds_read_b64_tr_b16 a[180:181], v26 offset:4096
  ds_read_b64_tr_b16 a[182:183], v26 offset:4608
  ds_read_b64_tr_b16 a[244:245], v27 offset:4096
  ds_read_b64_tr_b16 a[246:247], v27 offset:4608
  s_waitcnt vmcnt(13)
  ds_read_b64_tr_b16 a[56:57], v24 offset:8192
  ds_read_b64_tr_b16 a[58:59], v24 offset:8704
  ds_read_b64_tr_b16 a[120:121], v25 offset:8192
  ds_read_b64_tr_b16 a[122:123], v25 offset:8704
  ds_read_b64_tr_b16 a[184:185], v26 offset:8192
  ds_read_b64_tr_b16 a[186:187], v26 offset:8704
  ds_read_b64_tr_b16 a[248:249], v27 offset:8192
  ds_read_b64_tr_b16 a[250:251], v27 offset:8704
  s_waitcnt vmcnt(9)
  ds_read_b64_tr_b16 a[60:61], v24 offset:12288
  ds_read_b64_tr_b16 a[62:63], v24 offset:12800
  ds_read_b64_tr_b16 a[124:125], v25 offset:12288
  ds_read_b64_tr_b16 a[126:127], v25 offset:12800
  ds_read_b64_tr_b16 a[188:189], v26 offset:12288
  ds_read_b64_tr_b16 a[190:191], v26 offset:12800
  ds_read_b64_tr_b16 a[252:253], v27 offset:12288
  ds_read_b64_tr_b16 a[254:255], v27 offset:12800
  s_waitcnt vmcnt(0) lgkmcnt(0)
L_f_init:
  v_sad_u8 v3, v4, 0, 0
  v_sad_u8 v3, v5, 0, v3
  v_cmp_gt_u32 vcc, 32, v3
  s_cbranch_vccz L_f_go
  buffer_load_dwordx2 v[4:5], v6, s[48:51], 0 offen sc1
  s_add_u32 s68, s68, 1
  s_cmp_gt_u32 s68, 1048576
  s_cbranch_scc1 L_exit
  s_waitcnt vmcnt(0)
  s_branch L_f_init
L_f_go:
  s_barrier
  ds_read_b128 v[64:67], v16 offset:0
  ds_read_b128 v[68:71], v16 offset:16384
  ds_read_b128 v[72:75], v17 offset:0
  ds_read_b128 v[76:79], v17 offset:16384
  ds_read_b128 v[80:83], v18 offset:0
  ds_read_b128 v[84:87], v18 offset:16384
  ds_read_b128 v[88:91], v19 offset:0
  ds_read_b128 v[92:95], v19 offset:16384
  s_cmp_lt_u32 s44, s74
  s_waitcnt lgkmcnt(0)
  s_cbranch_scc0 L_f_10f
L_f_00f:
  v_mfma_f32_16x16x32_bf16 v[128:131], a[0:3], v[64:67], 0
  v_mfma_f32_16x16x32_bf16 v[128:131], a[4:7], v[72:75], v[128:131]
  v_mfma_f32_16x16x32_bf16 v[128:131], a[8:11], v[80:83], v[128:131]
  ds_read_b128 v[96:99], v16 offset:256
  v_mfma_f32_16x16x32_bf16 v[128:131], a[12:15], v[88:91], v[128:131]
  s_cmp_lg_u32 s57, 6
  s_cbranch_scc1 L_f_pw_23
  buffer_store_dwordx4 v[36:39], v2, s[40:43], s79 offen sc1
  s_add_u32 s79, s79, 0x20000
L_f_pw_23:
  v_mfma_f32_16x16x32_bf16 v[136:139], a[0:3], v[68:71], 0
  ds_read_b128 v[100:103], v16 offset:16640
  v_mfma_f32_16x16x32_bf16 v[136:139], a[4:7], v[76:79], v[136:139]
  s_add_u32 m0, s66, 0
  s_add_u32 s58, s61, 0
  buffer_load_dwordx4 v8, s[52:55], s58 offen lds
  v_mfma_f32_16x16x32_bf16 v[136:139], a[8:11], v[84:87], v[136:139]
  ds_read_b128 v[104:107], v17 offset:256
  v_mfma_f32_16x16x32_bf16 v[136:139], a[12:15], v[92:95], v[136:139]
  s_add_u32 m0, s66, 1024
  s_add_u32 s58, s61, 1024
  buffer_load_dwordx4 v9, s[52:55], s58 offen lds
  v_mfma_f32_16x16x32_bf16 v[132:135], a[64:67], v[64:67], 0
  ds_read_b128 v[108:111], v17 offset:16640
  v_mfma_f32_16x16x32_bf16 v[132:135], a[68:71], v[72:75], v[132:135]
  s_add_u32 m0, s66, 2048
  s_add_u32 s58, s61, 2048
  buffer_load_dwordx4 v10, s[52:55], s58 offen lds
  v_mfma_f32_16x16x32_bf16 v[132:135], a[72:75], v[80:83], v[132:135]
  ds_read_b128 v[112:115], v18 offset:256
  v_mfma_f32_16x16x32_bf16 v[132:135], a[76:79], v[88:91], v[132:135]
  s_add_u32 m0, s66, 3072
  s_add_u32 s58, s61, 3072
  buffer_load_dwordx4 v11, s[52:55], s58 offen lds
  v_mfma_f32_16x16x32_bf16 v[140:143], a[64:67], v[68:71], 0
  ds_read_b128 v[116:119], v18 offset:16640
  v_mfma_f32_16x16x32_bf16 v[140:143], a[68:71], v[76:79], v[140:143]
  s_add_u32 m0, s66, 4096
  s_add_u32 s58, s61, 4096
  buffer_load_dwordx4 v12, s[52:55], s58 offen lds
  v_mfma_f32_16x16x32_bf16 v[140:143], a[72:75], v[84:87], v[140:143]
  ds_read_b128 v[120:123], v19 offset:256
  v_mfma_f32_16x16x32_bf16 v[140:143], a[76:79], v[92:95], v[140:143]
  s_add_u32 m0, s66, 5120
  s_add_u32 s58, s61, 5120
  buffer_load_dwordx4 v13, s[52:55], s58 offen lds
  v_mfma_f32_16x16x32_bf16 v[144:147], a[128:131], v[64:67], 0
  ds_read_b128 v[124:127], v19 offset:16640
  v_mfma_f32_16x16x32_bf16 v[144:147], a[132:135], v[72:75], v[144:147]
  s_add_u32 m0, s66, 6144
  s_add_u32 s58, s61, 6144
  buffer_load_dwordx4 v14, s[52:55], s58 offen lds
  v_mfma_f32_16x16x32_bf16 v[144:147], a[136:139], v[80:83], v[144:147]
  v_mfma_f32_16x16x32_bf16 v[144:147], a[140:143], v[88:91], v[144:147]
  s_add_u32 m0, s66, 7168
  s_add_u32 s58, s61, 7168
  buffer_load_dwordx4 v15, s[52:55], s58 offen lds
  v_mfma_f32_16x16x32_bf16 v[152:155], a[128:131], v[68:71], 0
  v_mfma_f32_16x16x32_bf16 v[152:155], a[132:135], v[76:79], v[152:155]
  s_add_u32 s70, s70, 1
  s_lshr_b32 s61, s70, 3
  v_mfma_f32_16x16x32_bf16 v[152:155], a[136:139], v[84:87], v[152:155]
  s_lshl_b32 s61, s61, 2
  s_lshr_b32 s61, s73, s61
  v_mfma_f32_16x16x32_bf16 v[152:155], a[140:143], v[92:95], v[152:155]
  s_and_b32 s61, s61, 7
  s_and_b32 s59, s70, 7
  v_mfma_f32_16x16x32_bf16 v[148:151], a[192:195], v[64:67], 0
  s_lshl3_add_u32 s61, s61, s59
  s_lshl_b32 s61, s61, 15
  v_mfma_f32_16x16x32_bf16 v[148:151], a[196:199], v[72:75], v[148:151]
  s_add_u32 s61, s61, s71
  s_add_u32 s66, s66, 0x8000
  v_mfma_f32_16x16x32_bf16 v[148:151], a[200:203], v[80:83], v[148:151]
  s_and_b32 s66, s66, 0x1ffff
  v_mfma_f32_16x16x32_bf16 v[148:151], a[204:207], v[88:91], v[148:151]
  v_mfma_f32_16x16x32_bf16 v[156:159], a[192:195], v[68:71], 0
  s_add_u32 m0, s66, 0
  s_add_u32 s58, s61, 0
  buffer_load_dwordx4 v8, s[52:55], s58 offen lds
  v_mfma_f32_16x16x32_bf16 v[156:159], a[196:199], v[76:79], v[156:159]
  v_mfma_f32_16x16x32_bf16 v[156:159], a[200:203], v[84:87], v[156:159]
  s_add_u32 m0, s66, 1024
  s_add_u32 s58, s61, 1024
  buffer_load_dwordx4 v9, s[52:55], s58 offen lds
  v_mfma_f32_16x16x32_bf16 v[156:159], a[204:207], v[92:95], v[156:159]
  s_waitcnt lgkmcnt(0)
  v_mfma_f32_16x16x32_bf16 v[128:131], a[16:19], v[96:99], v[128:131]
  s_add_u32 m0, s66, 2048
  s_add_u32 s58, s61, 2048
  buffer_load_dwordx4 v10, s[52:55], s58 offen lds
  v_mfma_f32_16x16x32_bf16 v[128:131], a[20:23], v[104:107], v[128:131]
  s_add_u32 m0, s66, 3072
  s_add_u32 s58, s61, 3072
  buffer_load_dwordx4 v11, s[52:55], s58 offen lds
  v_mfma_f32_16x16x32_bf16 v[128:131], a[24:27], v[112:115], v[128:131]
  ds_read_b128 v[64:67], v16 offset:512
  v_mfma_f32_16x16x32_bf16 v[128:131], a[28:31], v[120:123], v[128:131]
  s_add_u32 m0, s66, 4096
  s_add_u32 s58, s61, 4096
  buffer_load_dwordx4 v12, s[52:55], s58 offen lds
  v_mfma_f32_16x16x32_bf16 v[136:139], a[16:19], v[100:103], v[136:139]
  ds_read_b128 v[68:71], v16 offset:16896
  v_mfma_f32_16x16x32_bf16 v[136:139], a[20:23], v[108:111], v[136:139]
  s_add_u32 m0, s66, 5120
  s_add_u32 s58, s61, 5120
  buffer_load_dwordx4 v13, s[52:55], s58 offen lds
  v_mfma_f32_16x16x32_bf16 v[136:139], a[24:27], v[116:119], v[136:139]
  ds_read_b128 v[72:75], v17 offset:512
  v_mfma_f32_16x16x32_bf16 v[136:139], a[28:31], v[124:127], v[136:139]
  s_add_u32 m0, s66, 6144
  s_add_u32 s58, s61, 6144
  buffer_load_dwordx4 v14, s[52:55], s58 offen lds
  v_mfma_f32_16x16x32_bf16 v[132:135], a[80:83], v[96:99], v[132:135]
  ds_read_b128 v[76:79], v17 offset:16896
  v_mfma_f32_16x16x32_bf16 v[132:135], a[84:87], v[104:107], v[132:135]
  s_add_u32 m0, s66, 7168
  s_add_u32 s58, s61, 7168
  buffer_load_dwordx4 v15, s[52:55], s58 offen lds
  v_mfma_f32_16x16x32_bf16 v[132:135], a[88:91], v[112:115], v[132:135]
  ds_read_b128 v[80:83], v18 offset:512
  v_mfma_f32_16x16x32_bf16 v[132:135], a[92:95], v[120:123], v[132:135]
  v_mfma_f32_16x16x32_bf16 v[140:143], a[80:83], v[100:103], v[140:143]
  ds_read_b128 v[84:87], v18 offset:16896
  s_add_u32 s70, s70, 1
  s_lshr_b32 s61, s70, 3
  v_mfma_f32_16x16x32_bf16 v[140:143], a[84:87], v[108:111], v[140:143]
  s_lshl_b32 s61, s61, 2
  s_lshr_b32 s61, s73, s61
  v_mfma_f32_16x16x32_bf16 v[140:143], a[88:91], v[116:119], v[140:143]
  ds_read_b128 v[88:91], v19 offset:512
  s_and_b32 s61, s61, 7
  s_and_b32 s59, s70, 7
  v_mfma_f32_16x16x32_bf16 v[140:143], a[92:95], v[124:127], v[140:143]
  s_lshl3_add_u32 s61, s61, s59
  s_lshl_b32 s61, s61, 15
  v_mfma_f32_16x16x32_bf16 v[144:147], a[144:147], v[96:99], v[144:147]
  ds_read_b128 v[92:95], v19 offset:16896
  s_add_u32 s61, s61, s71
  s_add_u32 s66, s66, 0x8000
  v_mfma_f32_16x16x32_bf16 v[144:147], a[148:151], v[104:107], v[144:147]
  s_and_b32 s66, s66, 0x1ffff
  v_mfma_f32_16x16x32_bf16 v[144:147], a[152:155], v[112:115], v[144:147]
  v_mfma_f32_16x16x32_bf16 v[144:147], a[156:159], v[120:123], v[144:147]
  s_add_u32 m0, s66, 0
  s_add_u32 s58, s61, 0
  v_mfma_f32_16x16x32_bf16 v[152:155], a[144:147], v[100:103], v[152:155]
  v_mfma_f32_16x16x32_bf16 v[152:155], a[148:151], v[108:111], v[152:155]
  buffer_load_dwordx4 v8, s[52:55], s58 offen lds
  v_mfma_f32_16x16x32_bf16 v[152:155], a[152:155], v[116:119], v[152:155]
  v_mfma_f32_16x16x32_bf16 v[152:155], a[156:159], v[124:127], v[152:155]
  s_add_u32 m0, s66, 1024
  s_add_u32 s58, s61, 1024
  v_mfma_f32_16x16x32_bf16 v[148:151], a[208:211], v[96:99], v[148:151]
  v_mfma_f32_16x16x32_bf16 v[148:151], a[212:215], v[104:107], v[148:151]
  buffer_load_dwordx4 v9, s[52:55], s58 offen lds
  v_mfma_f32_16x16x32_bf16 v[148:151], a[216:219], v[112:115], v[148:151]
  v_mfma_f32_16x16x32_bf16 v[148:151], a[220:223], v[120:123], v[148:151]
  s_add_u32 m0, s66, 2048
  s_add_u32 s58, s61, 2048
  v_mfma_f32_16x16x32_bf16 v[156:159], a[208:211], v[100:103], v[156:159]
  v_mfma_f32_16x16x32_bf16 v[156:159], a[212:215], v[108:111], v[156:159]
  buffer_load_dwordx4 v10, s[52:55], s58 offen lds
  v_mfma_f32_16x16x32_bf16 v[156:159], a[216:219], v[116:119], v[156:159]
  v_mfma_f32_16x16x32_bf16 v[156:159], a[220:223], v[124:127], v[156:159]
  s_waitcnt lgkmcnt(0)
  s_add_u32 m0, s66, 3072
  s_add_u32 s58, s61, 3072
  v_mfma_f32_16x16x32_bf16 v[128:131], a[32:35], v[64:67], v[128:131]
  v_mfma_f32_16x16x32_bf16 v[128:131], a[36:39], v[72:75], v[128:131]
  buffer_load_dwordx4 v11, s[52:55], s58 offen lds
  v_mfma_f32_16x16x32_bf16 v[128:131], a[40:43], v[80:83], v[128:131]
  ds_read_b128 v[96:99], v16 offset:768
  v_mfma_f32_16x16x32_bf16 v[128:131], a[44:47], v[88:91], v[128:131]
  s_add_u32 m0, s66, 4096
  s_add_u32 s58, s61, 4096
  v_mfma_f32_16x16x32_bf16 v[136:139], a[32:35], v[68:71], v[136:139]
  ds_read_b128 v[100:103], v16 offset:17152
  v_mfma_f32_16x16x32_bf16 v[136:139], a[36:39], v[76:79], v[136:139]
  buffer_load_dwordx4 v12, s[52:55], s58 offen lds
  v_mfma_f32_16x16x32_bf16 v[136:139], a[40:43], v[84:87], v[136:139]
  ds_read_b128 v[104:107], v17 offset:768
  v_mfma_f32_16x16x32_bf16 v[136:139], a[44:47], v[92:95], v[136:139]
  s_add_u32 m0, s66, 5120
  s_add_u32 s58, s61, 5120
  v_mfma_f32_16x16x32_bf16 v[132:135], a[96:99], v[64:67], v[132:135]
  ds_read_b128 v[108:111], v17 offset:17152
  v_mfma_f32_16x16x32_bf16 v[132:135], a[100:103], v[72:75], v[132:135]
  buffer_load_dwordx4 v13, s[52:55], s58 offen lds
  v_mfma_f32_16x16x32_bf16 v[132:135], a[104:107], v[80:83], v[132:135]
  ds_read_b128 v[112:115], v18 offset:768
  v_mfma_f32_16x16x32_bf16 v[132:135], a[108:111], v[88:91], v[132:135]
  s_add_u32 m0, s66, 6144
  s_add_u32 s58, s61, 6144
  v_mfma_f32_16x16x32_bf16 v[140:143], a[96:99], v[68:71], v[140:143]
  ds_read_b128 v[116:119], v18 offset:17152
  v_mfma_f32_16x16x32_bf16 v[140:143], a[100:103], v[76:79], v[140:143]
  buffer_load_dwordx4 v14, s[52:55], s58 offen lds
  v_mfma_f32_16x16x32_bf16 v[140:143], a[104:107], v[84:87], v[140:143]
  ds_read_b128 v[120:123], v19 offset:768
  v_mfma_f32_16x16x32_bf16 v[140:143], a[108:111], v[92:95], v[140:143]
  s_add_u32 m0, s66, 7168
  s_add_u32 s58, s61, 7168
  v_mfma_f32_16x16x32_bf16 v[144:147], a[160:163], v[64:67], v[144:147]
  ds_read_b128 v[124:127], v19 offset:17152
  v_mfma_f32_16x16x32_bf16 v[144:147], a[164:167], v[72:75], v[144:147]
  buffer_load_dwordx4 v15, s[52:55], s58 offen lds
  v_mfma_f32_16x16x32_bf16 v[144:147], a[168:171], v[80:83], v[144:147]
  v_mfma_f32_16x16x32_bf16 v[144:147], a[172:175], v[88:91], v[144:147]
  v_mfma_f32_16x16x32_bf16 v[152:155], a[160:163], v[68:71], v[152:155]
  v_add_u32 v16, 0x8000, v16
  v_mfma_f32_16x16x32_bf16 v[152:155], a[164:167], v[76:79], v[152:155]
  v_and_b32 v16, 0x1ffff, v16
  v_mfma_f32_16x16x32_bf16 v[152:155], a[168:171], v[84:87], v[152:155]
  v_add_u32 v17, 0x8000, v17
  v_mfma_f32_16x16x32_bf16 v[152:155], a[172:175], v[92:95], v[152:155]
  v_and_b32 v17, 0x1ffff, v17
  v_mfma_f32_16x16x32_bf16 v[148:151], a[224:227], v[64:67], v[148:151]
  v_add_u32 v18, 0x8000, v18
  v_mfma_f32_16x16x32_bf16 v[148:151], a[228:231], v[72:75], v[148:151]
  v_and_b32 v18, 0x1ffff, v18
  v_mfma_f32_16x16x32_bf16 v[148:151], a[232:235], v[80:83], v[148:151]
  v_add_u32 v19, 0x8000, v19
  v_mfma_f32_16x16x32_bf16 v[148:151], a[236:239], v[88:91], v[148:151]
  v_and_b32 v19, 0x1ffff, v19
  v_mfma_f32_16x16x32_bf16 v[156:159], a[224:227], v[68:71], v[156:159]
  s_sub_u32 s59, s63, 1
  s_max_i32 s59, s59, 0
  v_mfma_f32_16x16x32_bf16 v[156:159], a[228:231], v[76:79], v[156:159]
  v_mov_b32 v7, s59
  v_mfma_f32_16x16x32_bf16 v[156:159], a[232:235], v[84:87], v[156:159]
  s_cmp_lt_u32 s63, s80
  v_mfma_f32_16x16x32_bf16 v[156:159], a[236:239], v[92:95], v[156:159]
  s_waitcnt lgkmcnt(0)
  v_mfma_f32_16x16x32_bf16 v[128:131], a[48:51], v[96:99], v[128:131]
  s_waitcnt vmcnt(16)
  v_mfma_f32_16x16x32_bf16 v[128:131], a[52:55], v[104:107], v[128:131]
  s_barrier
  v_mfma_f32_16x16x32_bf16 v[128:131], a[56:59], v[112:115], v[128:131]
  ds_read_b128 v[64:67], v16 offset:0
  v_mfma_f32_16x16x32_bf16 v[128:131], a[60:63], v[120:123], v[128:131]
  buffer_store_dword v7, v6, s[40:43], s64 offen sc1
  v_mfma_f32_16x16x32_bf16 v[136:139], a[48:51], v[100:103], v[136:139]
  s_lshr_b32 s62, s63, 3
  ds_read_b128 v[68:71], v16 offset:16384
  v_mfma_f32_16x16x32_bf16 v[136:139], a[52:55], v[108:111], v[136:139]
  s_lshl_b32 s62, s62, 2
  v_mfma_f32_16x16x32_bf16 v[136:139], a[56:59], v[116:119], v[136:139]
  s_lshr_b32 s62, s73, s62
  ds_read_b128 v[72:75], v17 offset:0
  v_mfma_f32_16x16x32_bf16 v[136:139], a[60:63], v[124:127], v[136:139]
  s_and_b32 s62, s62, 7
  v_mfma_f32_16x16x32_bf16 v[132:135], a[112:115], v[96:99], v[132:135]
  s_and_b32 s59, s63, 7
  ds_read_b128 v[76:79], v17 offset:16384
  v_mfma_f32_16x16x32_bf16 v[132:135], a[116:119], v[104:107], v[132:135]
  s_lshl3_add_u32 s62, s62, s59
  v_mfma_f32_16x16x32_bf16 v[132:135], a[120:123], v[112:115], v[132:135]
  s_lshl_b32 s62, s62, 13
  ds_read_b128 v[80:83], v18 offset:0
  v_mfma_f32_16x16x32_bf16 v[132:135], a[124:127], v[120:123], v[132:135]
  s_add_u32 s62, s62, s65
  v_mfma_f32_16x16x32_bf16 v[140:143], a[112:115], v[100:103], v[140:143]
  s_add_u32 s70, s70, 1
  ds_read_b128 v[84:87], v18 offset:16384
  v_mfma_f32_16x16x32_bf16 v[140:143], a[116:119], v[108:111], v[140:143]
  s_lshr_b32 s61, s70, 3
  v_mfma_f32_16x16x32_bf16 v[140:143], a[120:123], v[116:119], v[140:143]
  s_lshl_b32 s61, s61, 2
  ds_read_b128 v[88:91], v19 offset:0
  v_mfma_f32_16x16x32_bf16 v[140:143], a[124:127], v[124:127], v[140:143]
  s_lshr_b32 s61, s73, s61
  v_mfma_f32_16x16x32_bf16 v[144:147], a[176:179], v[96:99], v[144:147]
  s_and_b32 s61, s61, 7
  ds_read_b128 v[92:95], v19 offset:16384
  v_mfma_f32_16x16x32_bf16 v[144:147], a[180:183], v[104:107], v[144:147]
  s_and_b32 s59, s70, 7
  v_mfma_f32_16x16x32_bf16 v[144:147], a[184:187], v[112:115], v[144:147]
  s_lshl3_add_u32 s61, s61, s59
  v_mfma_f32_16x16x32_bf16 v[144:147], a[188:191], v[120:123], v[144:147]
  s_lshl_b32 s61, s61, 15
  v_mfma_f32_16x16x32_bf16 v[152:155], a[176:179], v[100:103], v[152:155]
  s_add_u32 s61, s61, s71
  v_mfma_f32_16x16x32_bf16 v[152:155], a[180:183], v[108:111], v[152:155]
  s_add_u32 s66, s66, 0x8000
  v_mfma_f32_16x16x32_bf16 v[152:155], a[184:187], v[116:119], v[152:155]
  s_and_b32 s66, s66, 0x1ffff
  v_mfma_f32_16x16x32_bf16 v[152:155], a[188:191], v[124:127], v[152:155]
  v_mfma_f32_16x16x32_bf16 v[148:151], a[240:243], v[96:99], v[148:151]
  s_add_u32 s63, s63, 1
  v_mfma_f32_16x16x32_bf16 v[148:151], a[244:247], v[104:107], v[148:151]
  v_mfma_f32_16x16x32_bf16 v[148:151], a[248:251], v[112:115], v[148:151]
  v_mfma_f32_16x16x32_bf16 v[148:151], a[252:255], v[120:123], v[148:151]
  v_mfma_f32_16x16x32_bf16 v[156:159], a[240:243], v[100:103], v[156:159]
  v_mfma_f32_16x16x32_bf16 v[156:159], a[244:247], v[108:111], v[156:159]
  v_mfma_f32_16x16x32_bf16 v[156:159], a[248:251], v[116:119], v[156:159]
  s_cmp_lt_u32 s63, s67
  v_mfma_f32_16x16x32_bf16 v[156:159], a[252:255], v[124:127], v[156:159]
  s_waitcnt lgkmcnt(0)
  s_branch L_f_01
L_f_10f:
  v_mfma_f32_16x16x32_bf16 v[128:131], v[64:67], a[0:3], 0
  v_mfma_f32_16x16x32_bf16 v[128:131], v[72:75], a[4:7], v[128:131]
  v_mfma_f32_16x16x32_bf16 v[128:131], v[80:83], a[8:11], v[128:131]
  ds_read_b128 v[96:99], v16 offset:256
  v_mfma_f32_16x16x32_bf16 v[128:131], v[88:91], a[12:15], v[128:131]
  s_cmp_lg_u32 s57, 6
  s_cbranch_scc1 L_f_pw_24
  buffer_store_dwordx4 v[36:39], v2, s[40:43], s79 offen sc1
  s_add_u32 s79, s79, 0x20000
L_f_pw_24:
  v_mfma_f32_16x16x32_bf16 v[132:135], v[68:71], a[0:3], 0
  ds_read_b128 v[100:103], v16 offset:16640
  v_mfma_f32_16x16x32_bf16 v[132:135], v[76:79], a[4:7], v[132:135]
  s_add_u32 m0, s66, 0
  s_add_u32 s58, s61, 0
  buffer_load_dwordx4 v8, s[52:55], s58 offen lds
  v_mfma_f32_16x16x32_bf16 v[132:135], v[84:87], a[8:11], v[132:135]
  ds_read_b128 v[104:107], v17 offset:256
  v_mfma_f32_16x16x32_bf16 v[132:135], v[92:95], a[12:15], v[132:135]
  s_add_u32 m0, s66, 1024
  s_add_u32 s58, s61, 1024
  buffer_load_dwordx4 v9, s[52:55], s58 offen lds
  v_mfma_f32_16x16x32_bf16 v[136:139], v[64:67], a[64:67], 0
  ds_read_b128 v[108:111], v17 offset:16640
  v_mfma_f32_16x16x32_bf16 v[136:139], v[72:75], a[68:71], v[136:139]
  s_add_u32 m0, s66, 2048
  s_add_u32 s58, s61, 2048
  buffer_load_dwordx4 v10, s[52:55], s58 offen lds
  v_mfma_f32_16x16x32_bf16 v[136:139], v[80:83], a[72:75], v[136:139]
  ds_read_b128 v[112:115], v18 offset:256
  v_mfma_f32_16x16x32_bf16 v[136:139], v[88:91], a[76:79], v[136:139]
  s_add_u32 m0, s66, 3072
  s_add_u32 s58, s61, 3072
  buffer_load_dwordx4 v11, s[52:55], s58 offen lds
  v_mfma_f32_16x16x32_bf16 v[140:143], v[68:71], a[64:67], 0
  ds_read_b128 v[116:119], v18 offset:16640
  v_mfma_f32_16x16x32_bf16 v[140:143], v[76:79], a[68:71], v[140:143]
  s_add_u32 m0, s66, 4096
  s_add_u32 s58, s61, 4096
  buffer_load_dwordx4 v12, s[52:55], s58 offen lds
  v_mfma_f32_16x16x32_bf16 v[140:143], v[84:87], a[72:75], v[140:143]
  ds_read_b128 v[120:123], v19 offset:256
  v_mfma_f32_16x16x32_bf16 v[140:143], v[92:95], a[76:79], v[140:143]
  s_add_u32 m0, s66, 5120
  s_add_u32 s58, s61, 5120
  buffer_load_dwordx4 v13, s[52:55], s58 offen lds
  v_mfma_f32_16x16x32_bf16 v[144:147], v[64:67], a[128:131], 0
  ds_read_b128 v[124:127], v19 offset:16640
  v_mfma_f32_16x16x32_bf16 v[144:147], v[72:75], a[132:135], v[144:147]
  s_add_u32 m0, s66, 6144
  s_add_u32 s58, s61, 6144
  buffer_load_dwordx4 v14, s[52:55], s58 offen lds
  v_mfma_f32_16x16x32_bf16 v[144:147], v[80:83], a[136:139], v[144:147]
  v_mfma_f32_16x16x32_bf16 v[144:147], v[88:91], a[140:143], v[144:147]
  s_add_u32 m0, s66, 7168
  s_add_u32 s58, s61, 7168
  buffer_load_dwordx4 v15, s[52:55], s58 offen lds
  v_mfma_f32_16x16x32_bf16 v[148:151], v[68:71], a[128:131], 0
  v_mfma_f32_16x16x32_bf16 v[148:151], v[76:79], a[132:135], v[148:151]
  s_add_u32 s70, s70, 1
  s_lshr_b32 s61, s70, 3
  v_mfma_f32_16x16x32_bf16 v[148:151], v[84:87], a[136:139], v[148:151]
  s_lshl_b32 s61, s61, 2
  s_lshr_b32 s61, s73, s61
  v_mfma_f32_16x16x32_bf16 v[148:151], v[92:95], a[140:143], v[148:151]
  s_and_b32 s61, s61, 7
  s_and_b32 s59, s70, 7
  v_mfma_f32_16x16x32_bf16 v[152:155], v[64:67], a[192:195], 0
  s_lshl3_add_u32 s61, s61, s59
  s_lshl_b32 s61, s61, 15
  v_mfma_f32_16x16x32_bf16 v[152:155], v[72:75], a[196:199], v[152:155]
  s_add_u32 s61, s61, s71
  s_add_u32 s66, s66, 0x8000
  v_mfma_f32_16x16x32_bf16 v[152:155], v[80:83], a[200:203], v[152:155]
  s_and_b32 s66, s66, 0x1ffff
  v_mfma_f32_16x16x32_bf16 v[152:155], v[88:91], a[204:207], v[152:155]
  v_mfma_f32_16x16x32_bf16 v[156:159], v[68:71], a[192:195], 0
  s_add_u32 m0, s66, 0
  s_add_u32 s58, s61, 0
  buffer_load_dwordx4 v8, s[52:55], s58 offen lds
  v_mfma_f32_16x16x32_bf16 v[156:159], v[76:79], a[196:199], v[156:159]
  v_mfma_f32_16x16x32_bf16 v[156:159], v[84:87], a[200:203], v[156:159]
  s_add_u32 m0, s66, 1024
  s_add_u32 s58, s61, 1024
  buffer_load_dwordx4 v9, s[52:55], s58 offen lds
  v_mfma_f32_16x16x32_bf16 v[156:159], v[92:95], a[204:207], v[156:159]
  s_waitcnt lgkmcnt(0)
  v_mfma_f32_16x16x32_bf16 v[128:131], v[96:99], a[16:19], v[128:131]
  s_add_u32 m0, s66, 2048
  s_add_u32 s58, s61, 2048
  buffer_load_dwordx4 v10, s[52:55], s58 offen lds
  v_mfma_f32_16x16x32_bf16 v[128:131], v[104:107], a[20:23], v[128:131]
  s_add_u32 m0, s66, 3072
  s_add_u32 s58, s61, 3072
  buffer_load_dwordx4 v11, s[52:55], s58 offen lds
  v_mfma_f32_16x16x32_bf16 v[128:131], v[112:115], a[24:27], v[128:131]
  ds_read_b128 v[64:67], v16 offset:512
  v_mfma_f32_16x16x32_bf16 v[128:131], v[120:123], a[28:31], v[128:131]
  s_add_u32 m0, s66, 4096
  s_add_u32 s58, s61, 4096
  buffer_load_dwordx4 v12, s[52:55], s58 offen lds
  v_mfma_f32_16x16x32_bf16 v[132:135], v[100:103], a[16:19], v[132:135]
  ds_read_b128 v[68:71], v16 offset:16896
  v_mfma_f32_16x16x32_bf16 v[132:135], v[108:111], a[20:23], v[132:135]
  s_add_u32 m0, s66, 5120
  s_add_u32 s58, s61, 5120
  buffer_load_dwordx4 v13, s[52:55], s58 offen lds
  v_mfma_f32_16x16x32_bf16 v[132:135], v[116:119], a[24:27], v[132:135]
  ds_read_b128 v[72:75], v17 offset:512
  v_mfma_f32_16x16x32_bf16 v[132:135], v[124:127], a[28:31], v[132:135]
  s_add_u32 m0, s66, 6144
  s_add_u32 s58, s61, 6144
  buffer_load_dwordx4 v14, s[52:55], s58 offen lds
  v_mfma_f32_16x16x32_bf16 v[136:139], v[96:99], a[80:83], v[136:139]
  ds_read_b128 v[76:79], v17 offset:16896
  v_mfma_f32_16x16x32_bf16 v[136:139], v[104:107], a[84:87], v[136:139]
  s_add_u32 m0, s66, 7168
  s_add_u32 s58, s61, 7168
  buffer_load_dwordx4 v15, s[52:55], s58 offen lds
  v_mfma_f32_16x16x32_bf16 v[136:139], v[112:115], a[88:91], v[136:139]
  ds_read_b128 v[80:83], v18 offset:512
  v_mfma_f32_16x16x32_bf16 v[136:139], v[120:123], a[92:95], v[136:139]
  v_mfma_f32_16x16x32_bf16 v[140:143], v[100:103], a[80:83], v[140:143]
  ds_read_b128 v[84:87], v18 offset:16896
  s_add_u32 s70, s70, 1
  s_lshr_b32 s61, s70, 3
  v_mfma_f32_16x16x32_bf16 v[140:143], v[108:111], a[84:87], v[140:143]
  s_lshl_b32 s61, s61, 2
  s_lshr_b32 s61, s73, s61
  v_mfma_f32_16x16x32_bf16 v[140:143], v[116:119], a[88:91], v[140:143]
  ds_read_b128 v[88:91], v19 offset:512
  s_and_b32 s61, s61, 7
  s_and_b32 s59, s70, 7
  v_mfma_f32_16x16x32_bf16 v[140:143], v[124:127], a[92:95], v[140:143]
  s_lshl3_add_u32 s61, s61, s59
  s_lshl_b32 s61, s61, 15
  v_mfma_f32_16x16x32_bf16 v[144:147], v[96:99], a[144:147], v[144:147]
  ds_read_b128 v[92:95], v19 offset:16896
  s_add_u32 s61, s61, s71
  s_add_u32 s66, s66, 0x8000
  v_mfma_f32_16x16x32_bf16 v[144:147], v[104:107], a[148:151], v[144:147]
  s_and_b32 s66, s66, 0x1ffff
  v_mfma_f32_16x16x32_bf16 v[144:147], v[112:115], a[152:155], v[144:147]
  v_mfma_f32_16x16x32_bf16 v[144:147], v[120:123], a[156:159], v[144:147]
  s_add_u32 m0, s66, 0
  s_add_u32 s58, s61, 0
  v_mfma_f32_16x16x32_bf16 v[148:151], v[100:103], a[144:147], v[148:151]
  v_mfma_f32_16x16x32_bf16 v[148:151], v[108:111], a[148:151], v[148:151]
  buffer_load_dwordx4 v8, s[52:55], s58 offen lds
  v_mfma_f32_16x16x32_bf16 v[148:151], v[116:119], a[152:155], v[148:151]
  v_mfma_f32_16x16x32_bf16 v[148:151], v[124:127], a[156:159], v[148:151]
  s_add_u32 m0, s66, 1024
  s_add_u32 s58, s61, 1024
  v_mfma_f32_16x16x32_bf16 v[152:155], v[96:99], a[208:211], v[152:155]
  v_mfma_f32_16x16x32_bf16 v[152:155], v[104:107], a[212:215], v[152:155]
  buffer_load_dwordx4 v9, s[52:55], s58 offen lds
  v_mfma_f32_16x16x32_bf16 v[152:155], v[112:115], a[216:219], v[152:155]
  v_mfma_f32_16x16x32_bf16 v[152:155], v[120:123], a[220:223], v[152:155]
  s_add_u32 m0, s66, 2048
  s_add_u32 s58, s61, 2048
  v_mfma_f32_16x16x32_bf16 v[156:159], v[100:103], a[208:211], v[156:159]
  v_mfma_f32_16x16x32_bf16 v[156:159], v[108:111], a[212:215], v[156:159]
  buffer_load_dwordx4 v10, s[52:55], s58 offen lds
  v_mfma_f32_16x16x32_bf16 v[156:159], v[116:119], a[216:219], v[156:159]
  v_mfma_f32_16x16x32_bf16 v[156:159], v[124:127], a[220:223], v[156:159]
  s_waitcnt lgkmcnt(0)
  s_add_u32 m0, s66, 3072
  s_add_u32 s58, s61, 3072
  v_mfma_f32_16x16x32_bf16 v[128:131], v[64:67], a[32:35], v[128:131]
  v_mfma_f32_16x16x32_bf16 v[128:131], v[72:75], a[36:39], v[128:131]
  buffer_load_dwordx4 v11, s[52:55], s58 offen lds
  v_mfma_f32_16x16x32_bf16 v[128:131], v[80:83], a[40:43], v[128:131]
  ds_read_b128 v[96:99], v16 offset:768
  v_mfma_f32_16x16x32_bf16 v[128:131], v[88:91], a[44:47], v[128:131]
  s_add_u32 m0, s66, 4096
  s_add_u32 s58, s61, 4096
  v_mfma_f32_16x16x32_bf16 v[132:135], v[68:71], a[32:35], v[132:135]
  ds_read_b128 v[100:103], v16 offset:17152
  v_mfma_f32_16x16x32_bf16 v[132:135], v[76:79], a[36:39], v[132:135]
  buffer_load_dwordx4 v12, s[52:55], s58 offen lds
  v_mfma_f32_16x16x32_bf16 v[132:135], v[84:87], a[40:43], v[132:135]
  ds_read_b128 v[104:107], v17 offset:768
  v_mfma_f32_16x16x32_bf16 v[132:135], v[92:95], a[44:47], v[132:135]
  s_add_u32 m0, s66, 5120
  s_add_u32 s58, s61, 5120
  v_mfma_f32_16x16x32_bf16 v[136:139], v[64:67], a[96:99], v[136:139]
  ds_read_b128 v[108:111], v17 offset:17152
  v_mfma_f32_16x16x32_bf16 v[136:139], v[72:75], a[100:103], v[136:139]
  buffer_load_dwordx4 v13, s[52:55], s58 offen lds
  v_mfma_f32_16x16x32_bf16 v[136:139], v[80:83], a[104:107], v[136:139]
  ds_read_b128 v[112:115], v18 offset:768
  v_mfma_f32_16x16x32_bf16 v[136:139], v[88:91], a[108:111], v[136:139]
  s_add_u32 m0, s66, 6144
  s_add_u32 s58, s61, 6144
  v_mfma_f32_16x16x32_bf16 v[140:143], v[68:71], a[96:99], v[140:143]
  ds_read_b128 v[116:119], v18 offset:17152
  v_mfma_f32_16x16x32_bf16 v[140:143], v[76:79], a[100:103], v[140:143]
  buffer_load_dwordx4 v14, s[52:55], s58 offen lds
  v_mfma_f32_16x16x32_bf16 v[140:143], v[84:87], a[104:107], v[140:143]
  ds_read_b128 v[120:123], v19 offset:768
  v_mfma_f32_16x16x32_bf16 v[140:143], v[92:95], a[108:111], v[140:143]
  s_add_u32 m0, s66, 7168
  s_add_u32 s58, s61, 7168
  v_mfma_f32_16x16x32_bf16 v[144:147], v[64:67], a[160:163], v[144:147]
  ds_read_b128 v[124:127], v19 offset:17152
  v_mfma_f32_16x16x32_bf16 v[144:147], v[72:75], a[164:167], v[144:147]
  buffer_load_dwordx4 v15, s[52:55], s58 offen lds
  v_mfma_f32_16x16x32_bf16 v[144:147], v[80:83], a[168:171], v[144:147]
  v_mfma_f32_16x16x32_bf16 v[144:147], v[88:91], a[172:175], v[144:147]
  v_mfma_f32_16x16x32_bf16 v[148:151], v[68:71], a[160:163], v[148:151]
  v_add_u32 v16, 0x8000, v16
  v_mfma_f32_16x16x32_bf16 v[148:151], v[76:79], a[164:167], v[148:151]
  v_and_b32 v16, 0x1ffff, v16
  v_mfma_f32_16x16x32_bf16 v[148:151], v[84:87], a[168:171], v[148:151]
  v_add_u32 v17, 0x8000, v17
  v_mfma_f32_16x16x32_bf16 v[148:151], v[92:95], a[172:175], v[148:151]
  v_and_b32 v17, 0x1ffff, v17
  v_mfma_f32_16x16x32_bf16 v[152:155], v[64:67], a[224:227], v[152:155]
  v_add_u32 v18, 0x8000, v18
  v_mfma_f32_16x16x32_bf16 v[152:155], v[72:75], a[228:231], v[152:155]
  v_and_b32 v18, 0x1ffff, v18
  v_mfma_f32_16x16x32_bf16 v[152:155], v[80:83], a[232:235], v[152:155]
  v_add_u32 v19, 0x8000, v19
  v_mfma_f32_16x16x32_bf16 v[152:155], v[88:91], a[236:239], v[152:155]
  v_and_b32 v19, 0x1ffff, v19
  v_mfma_f32_16x16x32_bf16 v[156:159], v[68:71], a[224:227], v[156:159]
  s_sub_u32 s59, s63, 1
  s_max_i32 s59, s59, 0
  v_mfma_f32_16x16x32_bf16 v[156:159], v[76:79], a[228:231], v[156:159]
  v_mov_b32 v7, s59
  v_mfma_f32_16x16x32_bf16 v[156:159], v[84:87], a[232:235], v[156:159]
  s_cmp_lt_u32 s63, s80
  v_mfma_f32_16x16x32_bf16 v[156:159], v[92:95], a[236:239], v[156:159]
  s_waitcnt lgkmcnt(0)
  v_mfma_f32_16x16x32_bf16 v[128:131], v[96:99], a[48:51], v[128:131]
  s_waitcnt vmcnt(16)
  v_mfma_f32_16x16x32_bf16 v[128:131], v[104:107], a[52:55], v[128:131]
  s_barrier
  v_mfma_f32_16x16x32_bf16 v[128:131], v[112:115], a[56:59], v[128:131]
  ds_read_b128 v[64:67], v16 offset:0
  v_mfma_f32_16x16x32_bf16 v[128:131], v[120:123], a[60:63], v[128:131]
  buffer_store_dword v7, v6, s[40:43], s64 offen sc1
  v_mfma_f32_16x16x32_bf16 v[132:135], v[100:103], a[48:51], v[132:135]
  s_lshr_b32 s62, s63, 3
  ds_read_b128 v[68:71], v16 offset:16384
  v_mfma_f32_16x16x32_bf16 v[132:135], v[108:111], a[52:55], v[132:135]
  s_lshl_b32 s62, s62, 2
  v_mfma_f32_16x16x32_bf16 v[132:135], v[116:119], a[56:59], v[132:135]
  s_lshr_b32 s62, s73, s62
  ds_read_b128 v[72:75], v17 offset:0
  v_mfma_f32_16x16x32_bf16 v[132:135], v[124:127], a[60:63], v[132:135]
  s_and_b32 s62, s62, 7
  v_mfma_f32_16x16x32_bf16 v[136:139], v[96:99], a[112:115], v[136:139]
  s_and_b32 s59, s63, 7
  ds_read_b128 v[76:79], v17 offset:16384
  v_mfma_f32_16x16x32_bf16 v[136:139], v[104:107], a[116:119], v[136:139]
  s_lshl3_add_u32 s62, s62, s59
  v_mfma_f32_16x16x32_bf16 v[136:139], v[112:115], a[120:123], v[136:139]
  s_lshl_b32 s62, s62, 13
  ds_read_b128 v[80:83], v18 offset:0
  v_mfma_f32_16x16x32_bf16 v[136:139], v[120:123], a[124:127], v[136:139]
  s_add_u32 s62, s62, s65
  v_mfma_f32_16x16x32_bf16 v[140:143], v[100:103], a[112:115], v[140:143]
  s_add_u32 s70, s70, 1
  ds_read_b128 v[84:87], v18 offset:16384
  v_mfma_f32_16x16x32_bf16 v[140:143], v[108:111], a[116:119], v[140:143]
  s_lshr_b32 s61, s70, 3
  v_mfma_f32_16x16x32_bf16 v[140:143], v[116:119], a[120:123], v[140:143]
  s_lshl_b32 s61, s61, 2
  ds_read_b128 v[88:91], v19 offset:0
  v_mfma_f32_16x16x32_bf16 v[140:143], v[124:127], a[124:127], v[140:143]
  s_lshr_b32 s61, s73, s61
  v_mfma_f32_16x16x32_bf16 v[144:147], v[96:99], a[176:179], v[144:147]
  s_and_b32 s61, s61, 7
  ds_read_b128 v[92:95], v19 offset:16384
  v_mfma_f32_16x16x32_bf16 v[144:147], v[104:107], a[180:183], v[144:147]
  s_and_b32 s59, s70, 7
  v_mfma_f32_16x16x32_bf16 v[144:147], v[112:115], a[184:187], v[144:147]
  s_lshl3_add_u32 s61, s61, s59
  v_mfma_f32_16x16x32_bf16 v[144:147], v[120:123], a[188:191], v[144:147]
  s_lshl_b32 s61, s61, 15
  v_mfma_f32_16x16x32_bf16 v[148:151], v[100:103], a[176:179], v[148:151]
  s_add_u32 s61, s61, s71
  v_mfma_f32_16x16x32_bf16 v[148:151], v[108:111], a[180:183], v[148:151]
  s_add_u32 s66, s66, 0x8000
  v_mfma_f32_16x16x32_bf16 v[148:151], v[116:119], a[184:187], v[148:151]
  s_and_b32 s66, s66, 0x1ffff
  v_mfma_f32_16x16x32_bf16 v[148:151], v[124:127], a[188:191], v[148:151]
  v_mfma_f32_16x16x32_bf16 v[152:155], v[96:99], a[240:243], v[152:155]
  s_add_u32 s63, s63, 1
  v_mfma_f32_16x16x32_bf16 v[152:155], v[104:107], a[244:247], v[152:155]
  v_mfma_f32_16x16x32_bf16 v[152:155], v[112:115], a[248:251], v[152:155]
  v_mfma_f32_16x16x32_bf16 v[152:155], v[120:123], a[252:255], v[152:155]
  v_mfma_f32_16x16x32_bf16 v[156:159], v[100:103], a[240:243], v[156:159]
  v_mfma_f32_16x16x32_bf16 v[156:159], v[108:111], a[244:247], v[156:159]
  v_mfma_f32_16x16x32_bf16 v[156:159], v[116:119], a[248:251], v[156:159]
  s_cmp_lt_u32 s63, s67
  v_mfma_f32_16x16x32_bf16 v[156:159], v[124:127], a[252:255], v[156:159]
  s_waitcnt lgkmcnt(0)
  s_branch L_f_11
L_f_00:
  v_mfma_f32_16x16x32_bf16 v[128:131], a[0:3], v[64:67], 0
  v_mfma_f32_16x16x32_bf16 v[128:131], a[4:7], v[72:75], v[128:131]
  v_mfma_f32_16x16x32_bf16 v[128:131], a[8:11], v[80:83], v[128:131]
  ds_read_b128 v[96:99], v16 offset:256
  v_mfma_f32_16x16x32_bf16 v[128:131], a[12:15], v[88:91], v[128:131]
  s_cmp_lg_u32 s57, 6
  s_cbranch_scc1 L_f_pw_26
  buffer_store_dwordx4 v[36:39], v2, s[40:43], s79 offen sc1
  s_add_u32 s79, s79, 0x20000
L_f_pw_26:
  v_mfma_f32_16x16x32_bf16 v[136:139], a[0:3], v[68:71], 0
  ds_read_b128 v[100:103], v16 offset:16640
  v_mfma_f32_16x16x32_bf16 v[136:139], a[4:7], v[76:79], v[136:139]
  v_mfma_f32_16x16x32_bf16 v[136:139], a[8:11], v[84:87], v[136:139]
  ds_read_b128 v[104:107], v17 offset:256
  v_mfma_f32_16x16x32_bf16 v[136:139], a[12:15], v[92:95], v[136:139]
  v_mfma_f32_16x16x32_bf16 v[132:135], a[64:67], v[64:67], 0
  ds_read_b128 v[108:111], v17 offset:16640
  v_mfma_f32_16x16x32_bf16 v[132:135], a[68:71], v[72:75], v[132:135]
  v_mul_f32 v160, s69, v160
  v_mul_f32 v161, s69, v161
  v_mfma_f32_16x16x32_bf16 v[132:135], a[72:75], v[80:83], v[132:135]
  ds_read_b128 v[112:115], v18 offset:256
  v_mul_f32 v162, s69, v162
  v_mfma_f32_16x16x32_bf16 v[132:135], a[76:79], v[88:91], v[132:135]
  v_mul_f32 v163, s69, v163
  v_mul_f32 v164, s69, v164
  v_mfma_f32_16x16x32_bf16 v[140:143], a[64:67], v[68:71], 0
  ds_read_b128 v[116:119], v18 offset:16640
  v_mul_f32 v165, s69, v165
  v_mfma_f32_16x16x32_bf16 v[140:143], a[68:71], v[76:79], v[140:143]
  v_mul_f32 v166, s69, v166
  v_mul_f32 v167, s69, v167
  v_mfma_f32_16x16x32_bf16 v[140:143], a[72:75], v[84:87], v[140:143]
  ds_read_b128 v[120:123], v19 offset:256
  v_cvt_pk_bf16_f32 v192, v160, v161
  v_mfma_f32_16x16x32_bf16 v[140:143], a[76:79], v[92:95], v[140:143]
  v_cvt_pk_bf16_f32 v193, v162, v163
  v_cvt_pk_bf16_f32 v194, v164, v165
  v_mfma_f32_16x16x32_bf16 v[144:147], a[128:131], v[64:67], 0
  ds_read_b128 v[124:127], v19 offset:16640
  v_cvt_pk_bf16_f32 v195, v166, v167
  v_mfma_f32_16x16x32_bf16 v[144:147], a[132:135], v[72:75], v[144:147]
  buffer_store_dwordx4 v[192:195], v2, s[40:43], s62 offen offset:0 sc1
  v_mfma_f32_16x16x32_bf16 v[144:147], a[136:139], v[80:83], v[144:147]
  v_mul_f32 v168, s69, v168
  v_mul_f32 v169, s69, v169
  v_mfma_f32_16x16x32_bf16 v[144:147], a[140:143], v[88:91], v[144:147]
  v_mul_f32 v170, s69, v170
  v_mul_f32 v171, s69, v171
  v_mfma_f32_16x16x32_bf16 v[152:155], a[128:131], v[68:71], 0
  v_mul_f32 v172, s69, v172
  v_mul_f32 v173, s69, v173
  v_mfma_f32_16x16x32_bf16 v[152:155], a[132:135], v[76:79], v[152:155]
  v_mul_f32 v174, s69, v174
  v_mul_f32 v175, s69, v175
  v_mfma_f32_16x16x32_bf16 v[152:155], a[136:139], v[84:87], v[152:155]
  v_cvt_pk_bf16_f32 v196, v168, v169
  v_cvt_pk_bf16_f32 v197, v170, v171
  v_mfma_f32_16x16x32_bf16 v[152:155], a[140:143], v[92:95], v[152:155]
  v_cvt_pk_bf16_f32 v198, v172, v173
  v_cvt_pk_bf16_f32 v199, v174, v175
  v_mfma_f32_16x16x32_bf16 v[148:151], a[192:195], v[64:67], 0
  buffer_store_dwordx4 v[196:199], v2, s[40:43], s62 offen offset:1024 sc1
  v_mfma_f32_16x16x32_bf16 v[148:151], a[196:199], v[72:75], v[148:151]
  v_mul_f32 v176, s69, v176
  v_mul_f32 v177, s69, v177
  v_mfma_f32_16x16x32_bf16 v[148:151], a[200:203], v[80:83], v[148:151]
  v_mul_f32 v178, s69, v178
  v_mul_f32 v179, s69, v179
  v_mfma_f32_16x16x32_bf16 v[148:151], a[204:207], v[88:91], v[148:151]
  v_mul_f32 v180, s69, v180
  v_mul_f32 v181, s69, v181
  v_mfma_f32_16x16x32_bf16 v[156:159], a[192:195], v[68:71], 0
  v_mul_f32 v182, s69, v182
  v_mul_f32 v183, s69, v183
  v_mfma_f32_16x16x32_bf16 v[156:159], a[196:199], v[76:79], v[156:159]
  v_cvt_pk_bf16_f32 v200, v176, v177
  v_cvt_pk_bf16_f32 v201, v178, v179
  v_mfma_f32_16x16x32_bf16 v[156:159], a[200:203], v[84:87], v[156:159]
  v_cvt_pk_bf16_f32 v202, v180, v181
  v_cvt_pk_bf16_f32 v203, v182, v183
  v_mfma_f32_16x16x32_bf16 v[156:159], a[204:207], v[92:95], v[156:159]
  s_waitcnt lgkmcnt(0)
  buffer_store_dwordx4 v[200:203], v2, s[40:43], s62 offen offset:2048 sc1
  v_mfma_f32_16x16x32_bf16 v[128:131], a[16:19], v[96:99], v[128:131]
  v_mul_f32 v184, s69, v184
  v_mul_f32 v185, s69, v185
  v_mfma_f32_16x16x32_bf16 v[128:131], a[20:23], v[104:107], v[128:131]
  v_mul_f32 v186, s69, v186
  v_mul_f32 v187, s69, v187
  v_mfma_f32_16x16x32_bf16 v[128:131], a[24:27], v[112:115], v[128:131]
  ds_read_b128 v[64:67], v16 offset:512
  v_mul_f32 v188, s69, v188
  v_mfma_f32_16x16x32_bf16 v[128:131], a[28:31], v[120:123], v[128:131]
  v_mul_f32 v189, s69, v189
  v_mul_f32 v190, s69, v190
  v_mfma_f32_16x16x32_bf16 v[136:139], a[16:19], v[100:103], v[136:139]
  ds_read_b128 v[68:71], v16 offset:16896
  v_mul_f32 v191, s69, v191
  v_mfma_f32_16x16x32_bf16 v[136:139], a[20:23], v[108:111], v[136:139]
  v_cvt_pk_bf16_f32 v204, v184, v185
  v_cvt_pk_bf16_f32 v205, v186, v187
  v_mfma_f32_16x16x32_bf16 v[136:139], a[24:27], v[116:119], v[136:139]
  ds_read_b128 v[72:75], v17 offset:512
  v_cvt_pk_bf16_f32 v206, v188, v189
  v_mfma_f32_16x16x32_bf16 v[136:139], a[28:31], v[124:127], v[136:139]
  v_cvt_pk_bf16_f32 v207, v190, v191
  v_mfma_f32_16x16x32_bf16 v[132:135], a[80:83], v[96:99], v[132:135]
  ds_read_b128 v[76:79], v17 offset:16896
  v_mfma_f32_16x16x32_bf16 v[132:135], a[84:87], v[104:107], v[132:135]
  buffer_store_dwordx4 v[204:207], v2, s[40:43], s62 offen offset:3072 sc1
  v_mfma_f32_16x16x32_bf16 v[132:135], a[88:91], v[112:115], v[132:135]
  ds_read_b128 v[80:83], v18 offset:512
  v_mfma_f32_16x16x32_bf16 v[132:135], a[92:95], v[120:123], v[132:135]
  v_mfma_f32_16x16x32_bf16 v[140:143], a[80:83], v[100:103], v[140:143]
  ds_read_b128 v[84:87], v18 offset:16896
  v_mfma_f32_16x16x32_bf16 v[140:143], a[84:87], v[108:111], v[140:143]
  v_mfma_f32_16x16x32_bf16 v[140:143], a[88:91], v[116:119], v[140:143]
  ds_read_b128 v[88:91], v19 offset:512
  v_mfma_f32_16x16x32_bf16 v[140:143], a[92:95], v[124:127], v[140:143]
  v_mfma_f32_16x16x32_bf16 v[144:147], a[144:147], v[96:99], v[144:147]
  ds_read_b128 v[92:95], v19 offset:16896
  v_mfma_f32_16x16x32_bf16 v[144:147], a[148:151], v[104:107], v[144:147]
  v_mfma_f32_16x16x32_bf16 v[144:147], a[152:155], v[112:115], v[144:147]
  v_mfma_f32_16x16x32_bf16 v[144:147], a[156:159], v[120:123], v[144:147]
  s_add_u32 m0, s66, 0
  s_add_u32 s58, s61, 0
  v_mfma_f32_16x16x32_bf16 v[152:155], a[144:147], v[100:103], v[152:155]
  v_mfma_f32_16x16x32_bf16 v[152:155], a[148:151], v[108:111], v[152:155]
  buffer_load_dwordx4 v8, s[52:55], s58 offen lds
  v_mfma_f32_16x16x32_bf16 v[152:155], a[152:155], v[116:119], v[152:155]
  v_mfma_f32_16x16x32_bf16 v[152:155], a[156:159], v[124:127], v[152:155]
  s_add_u32 m0, s66, 1024
  s_add_u32 s58, s61, 1024
  v_mfma_f32_16x16x32_bf16 v[148:151], a[208:211], v[96:99], v[148:151]
  v_mfma_f32_16x16x32_bf16 v[148:151], a[212:215], v[104:107], v[148:151]
  buffer_load_dwordx4 v9, s[52:55], s58 offen lds
  v_mfma_f32_16x16x32_bf16 v[148:151], a[216:219], v[112:115], v[148:151]
  v_mfma_f32_16x16x32_bf16 v[148:151], a[220:223], v[120:123], v[148:151]
  s_add_u32 m0, s66, 2048
  s_add_u32 s58, s61, 2048
  v_mfma_f32_16x16x32_bf16 v[156:159], a[208:211], v[100:103], v[156:159]
  v_mfma_f32_16x16x32_bf16 v[156:159], a[212:215], v[108:111], v[156:159]
  buffer_load_dwordx4 v10, s[52:55], s58 offen lds
  v_mfma_f32_16x16x32_bf16 v[156:159], a[216:219], v[116:119], v[156:159]
  v_mfma_f32_16x16x32_bf16 v[156:159], a[220:223], v[124:127], v[156:159]
  s_waitcnt lgkmcnt(0)
  s_add_u32 m0, s66, 3072
  s_add_u32 s58, s61, 3072
  v_mfma_f32_16x16x32_bf16 v[128:131], a[32:35], v[64:67], v[128:131]
  v_mfma_f32_16x16x32_bf16 v[128:131], a[36:39], v[72:75], v[128:131]
  buffer_load_dwordx4 v11, s[52:55], s58 offen lds
  v_mfma_f32_16x16x32_bf16 v[128:131], a[40:43], v[80:83], v[128:131]
  ds_read_b128 v[96:99], v16 offset:768
  v_mfma_f32_16x16x32_bf16 v[128:131], a[44:47], v[88:91], v[128:131]
  s_add_u32 m0, s66, 4096
  s_add_u32 s58, s61, 4096
  v_mfma_f32_16x16x32_bf16 v[136:139], a[32:35], v[68:71], v[136:139]
  ds_read_b128 v[100:103], v16 offset:17152
  v_mfma_f32_16x16x32_bf16 v[136:139], a[36:39], v[76:79], v[136:139]
  buffer_load_dwordx4 v12, s[52:55], s58 offen lds
  v_mfma_f32_16x16x32_bf16 v[136:139], a[40:43], v[84:87], v[136:139]
  ds_read_b128 v[104:107], v17 offset:768
  v_mfma_f32_16x16x32_bf16 v[136:139], a[44:47], v[92:95], v[136:139]
  s_add_u32 m0, s66, 5120
  s_add_u32 s58, s61, 5120
  v_mfma_f32_16x16x32_bf16 v[132:135], a[96:99], v[64:67], v[132:135]
  ds_read_b128 v[108:111], v17 offset:17152
  v_mfma_f32_16x16x32_bf16 v[132:135], a[100:103], v[72:75], v[132:135]
  buffer_load_dwordx4 v13, s[52:55], s58 offen lds
  v_mfma_f32_16x16x32_bf16 v[132:135], a[104:107], v[80:83], v[132:135]
  ds_read_b128 v[112:115], v18 offset:768
  v_mfma_f32_16x16x32_bf16 v[132:135], a[108:111], v[88:91], v[132:135]
  s_add_u32 m0, s66, 6144
  s_add_u32 s58, s61, 6144
  v_mfma_f32_16x16x32_bf16 v[140:143], a[96:99], v[68:71], v[140:143]
  ds_read_b128 v[116:119], v18 offset:17152
  v_mfma_f32_16x16x32_bf16 v[140:143], a[100:103], v[76:79], v[140:143]
  buffer_load_dwordx4 v14, s[52:55], s58 offen lds
  v_mfma_f32_16x16x32_bf16 v[140:143], a[104:107], v[84:87], v[140:143]
  ds_read_b128 v[120:123], v19 offset:768
  v_mfma_f32_16x16x32_bf16 v[140:143], a[108:111], v[92:95], v[140:143]
  s_add_u32 m0, s66, 7168
  s_add_u32 s58, s61, 7168
  v_mfma_f32_16x16x32_bf16 v[144:147], a[160:163], v[64:67], v[144:147]
  ds_read_b128 v[124:127], v19 offset:17152
  v_mfma_f32_16x16x32_bf16 v[144:147], a[164:167], v[72:75], v[144:147]
  buffer_load_dwordx4 v15, s[52:55], s58 offen lds
  v_mfma_f32_16x16x32_bf16 v[144:147], a[168:171], v[80:83], v[144:147]
  v_mfma_f32_16x16x32_bf16 v[144:147], a[172:175], v[88:91], v[144:147]
  v_mfma_f32_16x16x32_bf16 v[152:155], a[160:163], v[68:71], v[152:155]
  v_add_u32 v16, 0x8000, v16
  v_mfma_f32_16x16x32_bf16 v[152:155], a[164:167], v[76:79], v[152:155]
  v_and_b32 v16, 0x1ffff, v16
  v_mfma_f32_16x16x32_bf16 v[152:155], a[168:171], v[84:87], v[152:155]
  v_add_u32 v17, 0x8000, v17
  v_mfma_f32_16x16x32_bf16 v[152:155], a[172:175], v[92:95], v[152:155]
  v_and_b32 v17, 0x1ffff, v17
  v_mfma_f32_16x16x32_bf16 v[148:151], a[224:227], v[64:67], v[148:151]
  v_add_u32 v18, 0x8000, v18
  v_mfma_f32_16x16x32_bf16 v[148:151], a[228:231], v[72:75], v[148:151]
  v_and_b32 v18, 0x1ffff, v18
  v_mfma_f32_16x16x32_bf16 v[148:151], a[232:235], v[80:83], v[148:151]
  v_add_u32 v19, 0x8000, v19
  v_mfma_f32_16x16x32_bf16 v[148:151], a[236:239], v[88:91], v[148:151]
  v_and_b32 v19, 0x1ffff, v19
  v_mfma_f32_16x16x32_bf16 v[156:159], a[224:227], v[68:71], v[156:159]
  s_sub_u32 s59, s63, 1
  s_max_i32 s59, s59, 0
  v_mfma_f32_16x16x32_bf16 v[156:159], a[228:231], v[76:79], v[156:159]
  v_mov_b32 v7, s59
  v_mfma_f32_16x16x32_bf16 v[156:159], a[232:235], v[84:87], v[156:159]
  s_cmp_lt_u32 s63, s80
  v_mfma_f32_16x16x32_bf16 v[156:159], a[236:239], v[92:95], v[156:159]
  s_waitcnt lgkmcnt(0)
  v_mfma_f32_16x16x32_bf16 v[128:131], a[48:51], v[96:99], v[128:131]
  s_waitcnt vmcnt(20)
  s_cbranch_scc1 L_f_e_25
L_f_e_25b:
  v_mfma_f32_16x16x32_bf16 v[128:131], a[52:55], v[104:107], v[128:131]
  s_barrier
  v_mfma_f32_16x16x32_bf16 v[128:131], a[56:59], v[112:115], v[128:131]
  ds_read_b128 v[64:67], v16 offset:0
  v_mfma_f32_16x16x32_bf16 v[128:131], a[60:63], v[120:123], v[128:131]
  buffer_store_dword v7, v6, s[40:43], s64 offen sc1
  v_mfma_f32_16x16x32_bf16 v[136:139], a[48:51], v[100:103], v[136:139]
  s_lshr_b32 s62, s63, 3
  ds_read_b128 v[68:71], v16 offset:16384
  v_mfma_f32_16x16x32_bf16 v[136:139], a[52:55], v[108:111], v[136:139]
  s_lshl_b32 s62, s62, 2
  v_mfma_f32_16x16x32_bf16 v[136:139], a[56:59], v[116:119], v[136:139]
  s_lshr_b32 s62, s73, s62
  ds_read_b128 v[72:75], v17 offset:0
  v_mfma_f32_16x16x32_bf16 v[136:139], a[60:63], v[124:127], v[136:139]
  s_and_b32 s62, s62, 7
  v_mfma_f32_16x16x32_bf16 v[132:135], a[112:115], v[96:99], v[132:135]
  s_and_b32 s59, s63, 7
  ds_read_b128 v[76:79], v17 offset:16384
  v_mfma_f32_16x16x32_bf16 v[132:135], a[116:119], v[104:107], v[132:135]
  s_lshl3_add_u32 s62, s62, s59
  v_mfma_f32_16x16x32_bf16 v[132:135], a[120:123], v[112:115], v[132:135]
  s_lshl_b32 s62, s62, 13
  ds_read_b128 v[80:83], v18 offset:0
  v_mfma_f32_16x16x32_bf16 v[132:135], a[124:127], v[120:123], v[132:135]
  s_add_u32 s62, s62, s65
  v_mfma_f32_16x16x32_bf16 v[140:143], a[112:115], v[100:103], v[140:143]
  s_add_u32 s70, s70, 1
  ds_read_b128 v[84:87], v18 offset:16384
  v_mfma_f32_16x16x32_bf16 v[140:143], a[116:119], v[108:111], v[140:143]
  s_lshr_b32 s61, s70, 3
  v_mfma_f32_16x16x32_bf16 v[140:143], a[120:123], v[116:119], v[140:143]
  s_lshl_b32 s61, s61, 2
  ds_read_b128 v[88:91], v19 offset:0
  v_mfma_f32_16x16x32_bf16 v[140:143], a[124:127], v[124:127], v[140:143]
  s_lshr_b32 s61, s73, s61
  v_mfma_f32_16x16x32_bf16 v[144:147], a[176:179], v[96:99], v[144:147]
  s_and_b32 s61, s61, 7
  ds_read_b128 v[92:95], v19 offset:16384
  v_mfma_f32_16x16x32_bf16 v[144:147], a[180:183], v[104:107], v[144:147]
  s_and_b32 s59, s70, 7
  v_mfma_f32_16x16x32_bf16 v[144:147], a[184:187], v[112:115], v[144:147]
  s_lshl3_add_u32 s61, s61, s59
  v_mfma_f32_16x16x32_bf16 v[144:147], a[188:191], v[120:123], v[144:147]
  s_lshl_b32 s61, s61, 15
  v_mfma_f32_16x16x32_bf16 v[152:155], a[176:179], v[100:103], v[152:155]
  s_add_u32 s61, s61, s71
  v_mfma_f32_16x16x32_bf16 v[152:155], a[180:183], v[108:111], v[152:155]
  s_add_u32 s66, s66, 0x8000
  v_mfma_f32_16x16x32_bf16 v[152:155], a[184:187], v[116:119], v[152:155]
  s_and_b32 s66, s66, 0x1ffff
  v_mfma_f32_16x16x32_bf16 v[152:155], a[188:191], v[124:127], v[152:155]
  v_mfma_f32_16x16x32_bf16 v[148:151], a[240:243], v[96:99], v[148:151]
  s_add_u32 s63, s63, 1
  v_mfma_f32_16x16x32_bf16 v[148:151], a[244:247], v[104:107], v[148:151]
  v_mfma_f32_16x16x32_bf16 v[148:151], a[248:251], v[112:115], v[148:151]
  v_mfma_f32_16x16x32_bf16 v[148:151], a[252:255], v[120:123], v[148:151]
  v_mfma_f32_16x16x32_bf16 v[156:159], a[240:243], v[100:103], v[156:159]
  v_mfma_f32_16x16x32_bf16 v[156:159], a[244:247], v[108:111], v[156:159]
  v_mfma_f32_16x16x32_bf16 v[156:159], a[248:251], v[116:119], v[156:159]
  s_cmp_lt_u32 s63, s67
  v_mfma_f32_16x16x32_bf16 v[156:159], a[252:255], v[124:127], v[156:159]
  s_waitcnt lgkmcnt(0)
L_f_01:
  v_mfma_f32_16x16x32_bf16 v[160:163], a[0:3], v[64:67], 0
  v_mfma_f32_16x16x32_bf16 v[160:163], a[4:7], v[72:75], v[160:163]
  v_mfma_f32_16x16x32_bf16 v[160:163], a[8:11], v[80:83], v[160:163]
  ds_read_b128 v[96:99], v16 offset:256
  v_mfma_f32_16x16x32_bf16 v[160:163], a[12:15], v[88:91], v[160:163]
  s_cmp_lg_u32 s57, 6
  s_cbranch_scc1 L_f_pw_28
  buffer_store_dwordx4 v[36:39], v2, s[40:43], s79 offen sc1
  s_add_u32 s79, s79, 0x20000
L_f_pw_28:
  v_mfma_f32_16x16x32_bf16 v[168:171], a[0:3], v[68:71], 0
  ds_read_b128 v[100:103], v16 offset:16640
  v_mfma_f32_16x16x32_bf16 v[168:171], a[4:7], v[76:79], v[168:171]
  v_mfma_f32_16x16x32_bf16 v[168:171], a[8:11], v[84:87], v[168:171]
  ds_read_b128 v[104:107], v17 offset:256
  v_mfma_f32_16x16x32_bf16 v[168:171], a[12:15], v[92:95], v[168:171]
  v_mfma_f32_16x16x32_bf16 v[164:167], a[64:67], v[64:67], 0
  ds_read_b128 v[108:111], v17 offset:16640
  v_mfma_f32_16x16x32_bf16 v[164:167], a[68:71], v[72:75], v[164:167]
  v_mul_f32 v128, s69, v128
  v_mul_f32 v129, s69, v129
  v_mfma_f32_16x16x32_bf16 v[164:167], a[72:75], v[80:83], v[164:167]
  ds_read_b128 v[112:115], v18 offset:256
  v_mul_f32 v130, s69, v130
  v_mfma_f32_16x16x32_bf16 v[164:167], a[76:79], v[88:91], v[164:167]
  v_mul_f32 v131, s69, v131
  v_mul_f32 v132, s69, v132
  v_mfma_f32_16x16x32_bf16 v[172:175], a[64:67], v[68:71], 0
  ds_read_b128 v[116:119], v18 offset:16640
  v_mul_f32 v133, s69, v133
  v_mfma_f32_16x16x32_bf16 v[172:175], a[68:71], v[76:79], v[172:175]
  v_mul_f32 v134, s69, v134
  v_mul_f32 v135, s69, v135
  v_mfma_f32_16x16x32_bf16 v[172:175], a[72:75], v[84:87], v[172:175]
  ds_read_b128 v[120:123], v19 offset:256
  v_cvt_pk_bf16_f32 v192, v128, v129
  v_mfma_f32_16x16x32_bf16 v[172:175], a[76:79], v[92:95], v[172:175]
  v_cvt_pk_bf16_f32 v193, v130, v131
  v_cvt_pk_bf16_f32 v194, v132, v133
  v_mfma_f32_16x16x32_bf16 v[176:179], a[128:131], v[64:67], 0
  ds_read_b128 v[124:127], v19 offset:16640
  v_cvt_pk_bf16_f32 v195, v134, v135
  v_mfma_f32_16x16x32_bf16 v[176:179], a[132:135], v[72:75], v[176:179]
  buffer_store_dwordx4 v[192:195], v2, s[40:43], s62 offen offset:0 sc1
  v_mfma_f32_16x16x32_bf16 v[176:179], a[136:139], v[80:83], v[176:179]
  v_mul_f32 v136, s69, v136
  v_mul_f32 v137, s69, v137
  v_mfma_f32_16x16x32_bf16 v[176:179], a[140:143], v[88:91], v[176:179]
  v_mul_f32 v138, s69, v138
  v_mul_f32 v139, s69, v139
  v_mfma_f32_16x16x32_bf16 v[184:187], a[128:131], v[68:71], 0
  v_mul_f32 v140, s69, v140
  v_mul_f32 v141, s69, v141
  v_mfma_f32_16x16x32_bf16 v[184:187], a[132:135], v[76:79], v[184:187]
  v_mul_f32 v142, s69, v142
  v_mul_f32 v143, s69, v143
  v_mfma_f32_16x16x32_bf16 v[184:187], a[136:139], v[84:87], v[184:187]
  v_cvt_pk_bf16_f32 v196, v136, v137
  v_cvt_pk_bf16_f32 v197, v138, v139
  v_mfma_f32_16x16x32_bf16 v[184:187], a[140:143], v[92:95], v[184:187]
  v_cvt_pk_bf16_f32 v198, v140, v141
  v_cvt_pk_bf16_f32 v199, v142, v143
  v_mfma_f32_16x16x32_bf16 v[180:183], a[192:195], v[64:67], 0
  buffer_store_dwordx4 v[196:199], v2, s[40:43], s62 offen offset:1024 sc1
  v_mfma_f32_16x16x32_bf16 v[180:183], a[196:199], v[72:75], v[180:183]
  v_mul_f32 v144, s69, v144
  v_mul_f32 v145, s69, v145
  v_mfma_f32_16x16x32_bf16 v[180:183], a[200:203], v[80:83], v[180:183]
  v_mul_f32 v146, s69, v146
  v_mul_f32 v147, s69, v147
  v_mfma_f32_16x16x32_bf16 v[180:183], a[204:207], v[88:91], v[180:183]
  v_mul_f32 v148, s69, v148
  v_mul_f32 v149, s69, v149
  v_mfma_f32_16x16x32_bf16 v[188:191], a[192:195], v[68:71], 0
  v_mul_f32 v150, s69, v150
  v_mul_f32 v151, s69, v151
  v_mfma_f32_16x16x32_bf16 v[188:191], a[196:199], v[76:79], v[188:191]
  v_cvt_pk_bf16_f32 v200, v144, v145
  v_cvt_pk_bf16_f32 v201, v146, v147
  v_mfma_f32_16x16x32_bf16 v[188:191], a[200:203], v[84:87], v[188:191]
  v_cvt_pk_bf16_f32 v202, v148, v149
  v_cvt_pk_bf16_f32 v203, v150, v151
  v_mfma_f32_16x16x32_bf16 v[188:191], a[204:207], v[92:95], v[188:191]
  s_waitcnt lgkmcnt(0)
  buffer_store_dwordx4 v[200:203], v2, s[40:43], s62 offen offset:2048 sc1
  v_mfma_f32_16x16x32_bf16 v[160:163], a[16:19], v[96:99], v[160:163]
  v_mul_f32 v152, s69, v152
  v_mul_f32 v153, s69, v153
  v_mfma_f32_16x16x32_bf16 v[160:163], a[20:23], v[104:107], v[160:163]
  v_mul_f32 v154, s69, v154
  v_mul_f32 v155, s69, v155
  v_mfma_f32_16x16x32_bf16 v[160:163], a[24:27], v[112:115], v[160:163]
  ds_read_b128 v[64:67], v16 offset:512
  v_mul_f32 v156, s69, v156
  v_mfma_f32_16x16x32_bf16 v[160:163], a[28:31], v[120:123], v[160:163]
  v_mul_f32 v157, s69, v157
  v_mul_f32 v158, s69, v158
  v_mfma_f32_16x16x32_bf16 v[168:171], a[16:19], v[100:103], v[168:171]
  ds_read_b128 v[68:71], v16 offset:16896
  v_mul_f32 v159, s69, v159
  v_mfma_f32_16x16x32_bf16 v[168:171], a[20:23], v[108:111], v[168:171]
  v_cvt_pk_bf16_f32 v204, v152, v153
  v_cvt_pk_bf16_f32 v205, v154, v155
  v_mfma_f32_16x16x32_bf16 v[168:171], a[24:27], v[116:119], v[168:171]
  ds_read_b128 v[72:75], v17 offset:512
  v_cvt_pk_bf16_f32 v206, v156, v157
  v_mfma_f32_16x16x32_bf16 v[168:171], a[28:31], v[124:127], v[168:171]
  v_cvt_pk_bf16_f32 v207, v158, v159
  v_mfma_f32_16x16x32_bf16 v[164:167], a[80:83], v[96:99], v[164:167]
  ds_read_b128 v[76:79], v17 offset:16896
  v_mfma_f32_16x16x32_bf16 v[164:167], a[84:87], v[104:107], v[164:167]
  buffer_store_dwordx4 v[204:207], v2, s[40:43], s62 offen offset:3072 sc1
  v_mfma_f32_16x16x32_bf16 v[164:167], a[88:91], v[112:115], v[164:167]
  ds_read_b128 v[80:83], v18 offset:512
  v_mfma_f32_16x16x32_bf16 v[164:167], a[92:95], v[120:123], v[164:167]
  v_mfma_f32_16x16x32_bf16 v[172:175], a[80:83], v[100:103], v[172:175]
  ds_read_b128 v[84:87], v18 offset:16896
  v_mfma_f32_16x16x32_bf16 v[172:175], a[84:87], v[108:111], v[172:175]
  v_mfma_f32_16x16x32_bf16 v[172:175], a[88:91], v[116:119], v[172:175]
  ds_read_b128 v[88:91], v19 offset:512
  v_mfma_f32_16x16x32_bf16 v[172:175], a[92:95], v[124:127], v[172:175]
  v_mfma_f32_16x16x32_bf16 v[176:179], a[144:147], v[96:99], v[176:179]
  ds_read_b128 v[92:95], v19 offset:16896
  v_mfma_f32_16x16x32_bf16 v[176:179], a[148:151], v[104:107], v[176:179]
  v_mfma_f32_16x16x32_bf16 v[176:179], a[152:155], v[112:115], v[176:179]
  v_mfma_f32_16x16x32_bf16 v[176:179], a[156:159], v[120:123], v[176:179]
  s_add_u32 m0, s66, 0
  s_add_u32 s58, s61, 0
  v_mfma_f32_16x16x32_bf16 v[184:187], a[144:147], v[100:103], v[184:187]
  v_mfma_f32_16x16x32_bf16 v[184:187], a[148:151], v[108:111], v[184:187]
  buffer_load_dwordx4 v8, s[52:55], s58 offen lds
  v_mfma_f32_16x16x32_bf16 v[184:187], a[152:155], v[116:119], v[184:187]
  v_mfma_f32_16x16x32_bf16 v[184:187], a[156:159], v[124:127], v[184:187]
  s_add_u32 m0, s66, 1024
  s_add_u32 s58, s61, 1024
  v_mfma_f32_16x16x32_bf16 v[180:183], a[208:211], v[96:99], v[180:183]
  v_mfma_f32_16x16x32_bf16 v[180:183], a[212:215], v[104:107], v[180:183]
  buffer_load_dwordx4 v9, s[52:55], s58 offen lds
  v_mfma_f32_16x16x32_bf16 v[180:183], a[216:219], v[112:115], v[180:183]
  v_mfma_f32_16x16x32_bf16 v[180:183], a[220:223], v[120:123], v[180:183]
  s_add_u32 m0, s66, 2048
  s_add_u32 s58, s61, 2048
  v_mfma_f32_16x16x32_bf16 v[188:191], a[208:211], v[100:103], v[188:191]
  v_mfma_f32_16x16x32_bf16 v[188:191], a[212:215], v[108:111], v[188:191]
  buffer_load_dwordx4 v10, s[52:55], s58 offen lds
  v_mfma_f32_16x16x32_bf16 v[188:191], a[216:219], v[116:119], v[188:191]
  v_mfma_f32_16x16x32_bf16 v[188:191], a[220:223], v[124:127], v[188:191]
  s_waitcnt lgkmcnt(0)
  s_add_u32 m0, s66, 3072
  s_add_u32 s58, s61, 3072
  v_mfma_f32_16x16x32_bf16 v[160:163], a[32:35], v[64:67], v[160:163]
  v_mfma_f32_16x16x32_bf16 v[160:163], a[36:39], v[72:75], v[160:163]
  buffer_load_dwordx4 v11, s[52:55], s58 offen lds
  v_mfma_f32_16x16x32_bf16 v[160:163], a[40:43], v[80:83], v[160:163]
  ds_read_b128 v[96:99], v16 offset:768
  v_mfma_f32_16x16x32_bf16 v[160:163], a[44:47], v[88:91], v[160:163]
  s_add_u32 m0, s66, 4096
  s_add_u32 s58, s61, 4096
  v_mfma_f32_16x16x32_bf16 v[168:171], a[32:35], v[68:71], v[168:171]
  ds_read_b128 v[100:103], v16 offset:17152
  v_mfma_f32_16x16x32_bf16 v[168:171], a[36:39], v[76:79], v[168:171]
  buffer_load_dwordx4 v12, s[52:55], s58 offen lds
  v_mfma_f32_16x16x32_bf16 v[168:171], a[40:43], v[84:87], v[168:171]
  ds_read_b128 v[104:107], v17 offset:768
  v_mfma_f32_16x16x32_bf16 v[168:171], a[44:47], v[92:95], v[168:171]
  s_add_u32 m0, s66, 5120
  s_add_u32 s58, s61, 5120
  v_mfma_f32_16x16x32_bf16 v[164:167], a[96:99], v[64:67], v[164:167]
  ds_read_b128 v[108:111], v17 offset:17152
  v_mfma_f32_16x16x32_bf16 v[164:167], a[100:103], v[72:75], v[164:167]
  buffer_load_dwordx4 v13, s[52:55], s58 offen lds
  v_mfma_f32_16x16x32_bf16 v[164:167], a[104:107], v[80:83], v[164:167]
  ds_read_b128 v[112:115], v18 offset:768
  v_mfma_f32_16x16x32_bf16 v[164:167], a[108:111], v[88:91], v[164:167]
  s_add_u32 m0, s66, 6144
  s_add_u32 s58, s61, 6144
  v_mfma_f32_16x16x32_bf16 v[172:175], a[96:99], v[68:71], v[172:175]
  ds_read_b128 v[116:119], v18 offset:17152
  v_mfma_f32_16x16x32_bf16 v[172:175], a[100:103], v[76:79], v[172:175]
  buffer_load_dwordx4 v14, s[52:55], s58 offen lds
  v_mfma_f32_16x16x32_bf16 v[172:175], a[104:107], v[84:87], v[172:175]
  ds_read_b128 v[120:123], v19 offset:768
  v_mfma_f32_16x16x32_bf16 v[172:175], a[108:111], v[92:95], v[172:175]
  s_add_u32 m0, s66, 7168
  s_add_u32 s58, s61, 7168
  v_mfma_f32_16x16x32_bf16 v[176:179], a[160:163], v[64:67], v[176:179]
  ds_read_b128 v[124:127], v19 offset:17152
  v_mfma_f32_16x16x32_bf16 v[176:179], a[164:167], v[72:75], v[176:179]
  buffer_load_dwordx4 v15, s[52:55], s58 offen lds
  v_mfma_f32_16x16x32_bf16 v[176:179], a[168:171], v[80:83], v[176:179]
  v_mfma_f32_16x16x32_bf16 v[176:179], a[172:175], v[88:91], v[176:179]
  v_mfma_f32_16x16x32_bf16 v[184:187], a[160:163], v[68:71], v[184:187]
  v_add_u32 v16, 0x8000, v16
  v_mfma_f32_16x16x32_bf16 v[184:187], a[164:167], v[76:79], v[184:187]
  v_and_b32 v16, 0x1ffff, v16
  v_mfma_f32_16x16x32_bf16 v[184:187], a[168:171], v[84:87], v[184:187]
  v_add_u32 v17, 0x8000, v17
  v_mfma_f32_16x16x32_bf16 v[184:187], a[172:175], v[92:95], v[184:187]
  v_and_b32 v17, 0x1ffff, v17
  v_mfma_f32_16x16x32_bf16 v[180:183], a[224:227], v[64:67], v[180:183]
  v_add_u32 v18, 0x8000, v18
  v_mfma_f32_16x16x32_bf16 v[180:183], a[228:231], v[72:75], v[180:183]
  v_and_b32 v18, 0x1ffff, v18
  v_mfma_f32_16x16x32_bf16 v[180:183], a[232:235], v[80:83], v[180:183]
  v_add_u32 v19, 0x8000, v19
  v_mfma_f32_16x16x32_bf16 v[180:183], a[236:239], v[88:91], v[180:183]
  v_and_b32 v19, 0x1ffff, v19
  v_mfma_f32_16x16x32_bf16 v[188:191], a[224:227], v[68:71], v[188:191]
  s_sub_u32 s59, s63, 1
  s_max_i32 s59, s59, 0
  v_mfma_f32_16x16x32_bf16 v[188:191], a[228:231], v[76:79], v[188:191]
  v_mov_b32 v7, s59
  v_mfma_f32_16x16x32_bf16 v[188:191], a[232:235], v[84:87], v[188:191]
  s_cmp_lt_u32 s63, s80
  v_mfma_f32_16x16x32_bf16 v[188:191], a[236:239], v[92:95], v[188:191]
  s_waitcnt lgkmcnt(0)
  v_mfma_f32_16x16x32_bf16 v[160:163], a[48:51], v[96:99], v[160:163]
  s_waitcnt vmcnt(20)
  s_cbranch_scc1 L_f_e_27
L_f_e_27b:
  v_mfma_f32_16x16x32_bf16 v[160:163], a[52:55], v[104:107], v[160:163]
  s_barrier
  v_mfma_f32_16x16x32_bf16 v[160:163], a[56:59], v[112:115], v[160:163]
  ds_read_b128 v[64:67], v16 offset:0
  v_mfma_f32_16x16x32_bf16 v[160:163], a[60:63], v[120:123], v[160:163]
  buffer_store_dword v7, v6, s[40:43], s64 offen sc1
  v_mfma_f32_16x16x32_bf16 v[168:171], a[48:51], v[100:103], v[168:171]
  s_lshr_b32 s62, s63, 3
  ds_read_b128 v[68:71], v16 offset:16384
  v_mfma_f32_16x16x32_bf16 v[168:171], a[52:55], v[108:111], v[168:171]
  s_lshl_b32 s62, s62, 2
  v_mfma_f32_16x16x32_bf16 v[168:171], a[56:59], v[116:119], v[168:171]
  s_lshr_b32 s62, s73, s62
  ds_read_b128 v[72:75], v17 offset:0
  v_mfma_f32_16x16x32_bf16 v[168:171], a[60:63], v[124:127], v[168:171]
  s_and_b32 s62, s62, 7
  v_mfma_f32_16x16x32_bf16 v[164:167], a[112:115], v[96:99], v[164:167]
  s_and_b32 s59, s63, 7
  ds_read_b128 v[76:79], v17 offset:16384
  v_mfma_f32_16x16x32_bf16 v[164:167], a[116:119], v[104:107], v[164:167]
  s_lshl3_add_u32 s62, s62, s59
  v_mfma_f32_16x16x32_bf16 v[164:167], a[120:123], v[112:115], v[164:167]
  s_lshl_b32 s62, s62, 13
  ds_read_b128 v[80:83], v18 offset:0
  v_mfma_f32_16x16x32_bf16 v[164:167], a[124:127], v[120:123], v[164:167]
  s_add_u32 s62, s62, s65
  v_mfma_f32_16x16x32_bf16 v[172:175], a[112:115], v[100:103], v[172:175]
  s_add_u32 s70, s70, 1
  ds_read_b128 v[84:87], v18 offset:16384
  v_mfma_f32_16x16x32_bf16 v[172:175], a[116:119], v[108:111], v[172:175]
  s_lshr_b32 s61, s70, 3
  v_mfma_f32_16x16x32_bf16 v[172:175], a[120:123], v[116:119], v[172:175]
  s_lshl_b32 s61, s61, 2
  ds_read_b128 v[88:91], v19 offset:0
  v_mfma_f32_16x16x32_bf16 v[172:175], a[124:127], v[124:127], v[172:175]
  s_lshr_b32 s61, s73, s61
  v_mfma_f32_16x16x32_bf16 v[176:179], a[176:179], v[96:99], v[176:179]
  s_and_b32 s61, s61, 7
  ds_read_b128 v[92:95], v19 offset:16384
  v_mfma_f32_16x16x32_bf16 v[176:179], a[180:183], v[104:107], v[176:179]
  s_and_b32 s59, s70, 7
  v_mfma_f32_16x16x32_bf16 v[176:179], a[184:187], v[112:115], v[176:179]
  s_lshl3_add_u32 s61, s61, s59
  v_mfma_f32_16x16x32_bf16 v[176:179], a[188:191], v[120:123], v[176:179]
  s_lshl_b32 s61, s61, 15
  v_mfma_f32_16x16x32_bf16 v[184:187], a[176:179], v[100:103], v[184:187]
  s_add_u32 s61, s61, s71
  v_mfma_f32_16x16x32_bf16 v[184:187], a[180:183], v[108:111], v[184:187]
  s_add_u32 s66, s66, 0x8000
  v_mfma_f32_16x16x32_bf16 v[184:187], a[184:187], v[116:119], v[184:187]
  s_and_b32 s66, s66, 0x1ffff
  v_mfma_f32_16x16x32_bf16 v[184:187], a[188:191], v[124:127], v[184:187]
  v_mfma_f32_16x16x32_bf16 v[180:183], a[240:243], v[96:99], v[180:183]
  s_add_u32 s63, s63, 1
  v_mfma_f32_16x16x32_bf16 v[180:183], a[244:247], v[104:107], v[180:183]
  s_mov_b64 exec, 1
  buffer_atomic_add v33, v6, s[40:43], s76 offen
  s_mov_b64 exec, -1
  v_mfma_f32_16x16x32_bf16 v[180:183], a[248:251], v[112:115], v[180:183]
  s_mov_b32 s76, 0x40000000
  v_mfma_f32_16x16x32_bf16 v[180:183], a[252:255], v[120:123], v[180:183]
  v_mfma_f32_16x16x32_bf16 v[188:191], a[240:243], v[100:103], v[188:191]
  v_mfma_f32_16x16x32_bf16 v[188:191], a[244:247], v[108:111], v[188:191]
  v_mfma_f32_16x16x32_bf16 v[188:191], a[248:251], v[116:119], v[188:191]
  s_cmp_lt_u32 s63, s67
  v_mfma_f32_16x16x32_bf16 v[188:191], a[252:255], v[124:127], v[188:191]
  s_waitcnt lgkmcnt(0)
  s_cbranch_scc1 L_f_00
  s_branch L_f_done
L_f_10:
  v_mfma_f32_16x16x32_bf16 v[128:131], v[64:67], a[0:3], 0
  v_mfma_f32_16x16x32_bf16 v[128:131], v[72:75], a[4:7], v[128:131]
  v_mfma_f32_16x16x32_bf16 v[128:131], v[80:83], a[8:11], v[128:131]
  ds_read_b128 v[96:99], v16 offset:256
  v_mfma_f32_16x16x32_bf16 v[128:131], v[88:91], a[12:15], v[128:131]
  s_cmp_lg_u32 s57, 6
  s_cbranch_scc1 L_f_pw_30
  buffer_store_dwordx4 v[36:39], v2, s[40:43], s79 offen sc1
  s_add_u32 s79, s79, 0x20000
L_f_pw_30:
  v_mfma_f32_16x16x32_bf16 v[132:135], v[68:71], a[0:3], 0
  ds_read_b128 v[100:103], v16 offset:16640
  v_mfma_f32_16x16x32_bf16 v[132:135], v[76:79], a[4:7], v[132:135]
  v_mfma_f32_16x16x32_bf16 v[132:135], v[84:87], a[8:11], v[132:135]
  ds_read_b128 v[104:107], v17 offset:256
  v_mfma_f32_16x16x32_bf16 v[132:135], v[92:95], a[12:15], v[132:135]
  v_mfma_f32_16x16x32_bf16 v[136:139], v[64:67], a[64:67], 0
  ds_read_b128 v[108:111], v17 offset:16640
  v_mfma_f32_16x16x32_bf16 v[136:139], v[72:75], a[68:71], v[136:139]
  v_cvt_pk_bf16_f32 v192, v160, v161
  v_cvt_pk_bf16_f32 v193, v162, v163
  v_mfma_f32_16x16x32_bf16 v[136:139], v[80:83], a[72:75], v[136:139]
  ds_read_b128 v[112:115], v18 offset:256
  v_cvt_pk_bf16_f32 v194, v164, v165
  v_mfma_f32_16x16x32_bf16 v[136:139], v[88:91], a[76:79], v[136:139]
  v_cvt_pk_bf16_f32 v195, v166, v167
  v_mfma_f32_16x16x32_bf16 v[140:143], v[68:71], a[64:67], 0
  ds_read_b128 v[116:119], v18 offset:16640
  v_mfma_f32_16x16x32_bf16 v[140:143], v[76:79], a[68:71], v[140:143]
  buffer_store_dwordx4 v[192:195], v2, s[40:43], s62 offen offset:0 sc1
  v_mfma_f32_16x16x32_bf16 v[140:143], v[84:87], a[72:75], v[140:143]
  ds_read_b128 v[120:123], v19 offset:256
  v_cvt_pk_bf16_f32 v196, v168, v169
  v_mfma_f32_16x16x32_bf16 v[140:143], v[92:95], a[76:79], v[140:143]
  v_cvt_pk_bf16_f32 v197, v170, v171
  v_cvt_pk_bf16_f32 v198, v172, v173
  v_mfma_f32_16x16x32_bf16 v[144:147], v[64:67], a[128:131], 0
  ds_read_b128 v[124:127], v19 offset:16640
  v_cvt_pk_bf16_f32 v199, v174, v175
  v_mfma_f32_16x16x32_bf16 v[144:147], v[72:75], a[132:135], v[144:147]
  buffer_store_dwordx4 v[196:199], v2, s[40:43], s62 offen offset:1024 sc1
  v_mfma_f32_16x16x32_bf16 v[144:147], v[80:83], a[136:139], v[144:147]
  v_cvt_pk_bf16_f32 v200, v176, v177
  v_cvt_pk_bf16_f32 v201, v178, v179
  v_mfma_f32_16x16x32_bf16 v[144:147], v[88:91], a[140:143], v[144:147]
  v_cvt_pk_bf16_f32 v202, v180, v181
  v_cvt_pk_bf16_f32 v203, v182, v183
  v_mfma_f32_16x16x32_bf16 v[148:151], v[68:71], a[128:131], 0
  buffer_store_dwordx4 v[200:203], v2, s[40:43], s62 offen offset:2048 sc1
  v_mfma_f32_16x16x32_bf16 v[148:151], v[76:79], a[132:135], v[148:151]
  v_cvt_pk_bf16_f32 v204, v184, v185
  v_cvt_pk_bf16_f32 v205, v186, v187
  v_mfma_f32_16x16x32_bf16 v[148:151], v[84:87], a[136:139], v[148:151]
  v_cvt_pk_bf16_f32 v206, v188, v189
  v_cvt_pk_bf16_f32 v207, v190, v191
  v_mfma_f32_16x16x32_bf16 v[148:151], v[92:95], a[140:143], v[148:151]
  buffer_store_dwordx4 v[204:207], v2, s[40:43], s62 offen offset:3072 sc1
  v_mfma_f32_16x16x32_bf16 v[152:155], v[64:67], a[192:195], 0
  v_mfma_f32_16x16x32_bf16 v[152:155], v[72:75], a[196:199], v[152:155]
  v_mfma_f32_16x16x32_bf16 v[152:155], v[80:83], a[200:203], v[152:155]
  v_mfma_f32_16x16x32_bf16 v[152:155], v[88:91], a[204:207], v[152:155]
  v_mfma_f32_16x16x32_bf16 v[156:159], v[68:71], a[192:195], 0
  v_mfma_f32_16x16x32_bf16 v[156:159], v[76:79], a[196:199], v[156:159]
  v_mfma_f32_16x16x32_bf16 v[156:159], v[84:87], a[200:203], v[156:159]
  v_mfma_f32_16x16x32_bf16 v[156:159], v[92:95], a[204:207], v[156:159]
  s_waitcnt lgkmcnt(0)
  v_mfma_f32_16x16x32_bf16 v[128:131], v[96:99], a[16:19], v[128:131]
  v_mfma_f32_16x16x32_bf16 v[128:131], v[104:107], a[20:23], v[128:131]
  v_mfma_f32_16x16x32_bf16 v[128:131], v[112:115], a[24:27], v[128:131]
  ds_read_b128 v[64:67], v16 offset:512
  v_mfma_f32_16x16x32_bf16 v[128:131], v[120:123], a[28:31], v[128:131]
  v_mfma_f32_16x16x32_bf16 v[132:135], v[100:103], a[16:19], v[132:135]
  ds_read_b128 v[68:71], v16 offset:16896
  v_mfma_f32_16x16x32_bf16 v[132:135], v[108:111], a[20:23], v[132:135]
  v_mfma_f32_16x16x32_bf16 v[132:135], v[116:119], a[24:27], v[132:135]
  ds_read_b128 v[72:75], v17 offset:512
  v_mfma_f32_16x16x32_bf16 v[132:135], v[124:127], a[28:31], v[132:135]
  v_mfma_f32_16x16x32_bf16 v[136:139], v[96:99], a[80:83], v[136:139]
  ds_read_b128 v[76:79], v17 offset:16896
  v_mfma_f32_16x16x32_bf16 v[136:139], v[104:107], a[84:87], v[136:139]
  v_mfma_f32_16x16x32_bf16 v[136:139], v[112:115], a[88:91], v[136:139]
  ds_read_b128 v[80:83], v18 offset:512
  v_mfma_f32_16x16x32_bf16 v[136:139], v[120:123], a[92:95], v[136:139]
  v_mfma_f32_16x16x32_bf16 v[140:143], v[100:103], a[80:83], v[140:143]
  ds_read_b128 v[84:87], v18 offset:16896
  v_mfma_f32_16x16x32_bf16 v[140:143], v[108:111], a[84:87], v[140:143]
  v_mfma_f32_16x16x32_bf16 v[140:143], v[116:119], a[88:91], v[140:143]
  ds_read_b128 v[88:91], v19 offset:512
  v_mfma_f32_16x16x32_bf16 v[140:143], v[124:127], a[92:95], v[140:143]
  v_mfma_f32_16x16x32_bf16 v[144:147], v[96:99], a[144:147], v[144:147]
  ds_read_b128 v[92:95], v19 offset:16896
  v_mfma_f32_16x16x32_bf16 v[144:147], v[104:107], a[148:151], v[144:147]
  v_mfma_f32_16x16x32_bf16 v[144:147], v[112:115], a[152:155], v[144:147]
  v_mfma_f32_16x16x32_bf16 v[144:147], v[120:123], a[156:159], v[144:147]
  s_add_u32 m0, s66, 0
  s_add_u32 s58, s61, 0
  v_mfma_f32_16x16x32_bf16 v[148:151], v[100:103], a[144:147], v[148:151]
  v_mfma_f32_16x16x32_bf16 v[148:151], v[108:111], a[148:151], v[148:151]
  buffer_load_dwordx4 v8, s[52:55], s58 offen lds
  v_mfma_f32_16x16x32_bf16 v[148:151], v[116:119], a[152:155], v[148:151]
  v_mfma_f32_16x16x32_bf16 v[148:151], v[124:127], a[156:159], v[148:151]
  s_add_u32 m0, s66, 1024
  s_add_u32 s58, s61, 1024
  v_mfma_f32_16x16x32_bf16 v[152:155], v[96:99], a[208:211], v[152:155]
  v_mfma_f32_16x16x32_bf16 v[152:155], v[104:107], a[212:215], v[152:155]
  buffer_load_dwordx4 v9, s[52:55], s58 offen lds
  v_mfma_f32_16x16x32_bf16 v[152:155], v[112:115], a[216:219], v[152:155]
  v_mfma_f32_16x16x32_bf16 v[152:155], v[120:123], a[220:223], v[152:155]
  s_add_u32 m0, s66, 2048
  s_add_u32 s58, s61, 2048
  v_mfma_f32_16x16x32_bf16 v[156:159], v[100:103], a[208:211], v[156:159]
  v_mfma_f32_16x16x32_bf16 v[156:159], v[108:111], a[212:215], v[156:159]
  buffer_load_dwordx4 v10, s[52:55], s58 offen lds
  v_mfma_f32_16x16x32_bf16 v[156:159], v[116:119], a[216:219], v[156:159]
  v_mfma_f32_16x16x32_bf16 v[156:159], v[124:127], a[220:223], v[156:159]
  s_waitcnt lgkmcnt(0)
  s_add_u32 m0, s66, 3072
  s_add_u32 s58, s61, 3072
  v_mfma_f32_16x16x32_bf16 v[128:131], v[64:67], a[32:35], v[128:131]
  v_mfma_f32_16x16x32_bf16 v[128:131], v[72:75], a[36:39], v[128:131]
  buffer_load_dwordx4 v11, s[52:55], s58 offen lds
  v_mfma_f32_16x16x32_bf16 v[128:131], v[80:83], a[40:43], v[128:131]
  ds_read_b128 v[96:99], v16 offset:768
  v_mfma_f32_16x16x32_bf16 v[128:131], v[88:91], a[44:47], v[128:131]
  s_add_u32 m0, s66, 4096
  s_add_u32 s58, s61, 4096
  v_mfma_f32_16x16x32_bf16 v[132:135], v[68:71], a[32:35], v[132:135]
  ds_read_b128 v[100:103], v16 offset:17152
  v_mfma_f32_16x16x32_bf16 v[132:135], v[76:79], a[36:39], v[132:135]
  buffer_load_dwordx4 v12, s[52:55], s58 offen lds
  v_mfma_f32_16x16x32_bf16 v[132:135], v[84:87], a[40:43], v[132:135]
  ds_read_b128 v[104:107], v17 offset:768
  v_mfma_f32_16x16x32_bf16 v[132:135], v[92:95], a[44:47], v[132:135]
  s_add_u32 m0, s66, 5120
  s_add_u32 s58, s61, 5120
  v_mfma_f32_16x16x32_bf16 v[136:139], v[64:67], a[96:99], v[136:139]
  ds_read_b128 v[108:111], v17 offset:17152
  v_mfma_f32_16x16x32_bf16 v[136:139], v[72:75], a[100:103], v[136:139]
  buffer_load_dwordx4 v13, s[52:55], s58 offen lds
  v_mfma_f32_16x16x32_bf16 v[136:139], v[80:83], a[104:107], v[136:139]
  ds_read_b128 v[112:115], v18 offset:768
  v_mfma_f32_16x16x32_bf16 v[136:139], v[88:91], a[108:111], v[136:139]
  s_add_u32 m0, s66, 6144
  s_add_u32 s58, s61, 6144
  v_mfma_f32_16x16x32_bf16 v[140:143], v[68:71], a[96:99], v[140:143]
  ds_read_b128 v[116:119], v18 offset:17152
  v_mfma_f32_16x16x32_bf16 v[140:143], v[76:79], a[100:103], v[140:143]
  buffer_load_dwordx4 v14, s[52:55], s58 offen lds
  v_mfma_f32_16x16x32_bf16 v[140:143], v[84:87], a[104:107], v[140:143]
  ds_read_b128 v[120:123], v19 offset:768
  v_mfma_f32_16x16x32_bf16 v[140:143], v[92:95], a[108:111], v[140:143]
  s_add_u32 m0, s66, 7168
  s_add_u32 s58, s61, 7168
  v_mfma_f32_16x16x32_bf16 v[144:147], v[64:67], a[160:163], v[144:147]
  ds_read_b128 v[124:127], v19 offset:17152
  v_mfma_f32_16x16x32_bf16 v[144:147], v[72:75], a[164:167], v[144:147]
  buffer_load_dwordx4 v15, s[52:55], s58 offen lds
  v_mfma_f32_16x16x32_bf16 v[144:147], v[80:83], a[168:171], v[144:147]
  v_mfma_f32_16x16x32_bf16 v[144:147], v[88:91], a[172:175], v[144:147]
  v_mfma_f32_16x16x32_bf16 v[148:151], v[68:71], a[160:163], v[148:151]
  v_add_u32 v16, 0x8000, v16
  v_mfma_f32_16x16x32_bf16 v[148:151], v[76:79], a[164:167], v[148:151]
  v_and_b32 v16, 0x1ffff, v16
  v_mfma_f32_16x16x32_bf16 v[148:151], v[84:87], a[168:171], v[148:151]
  v_add_u32 v17, 0x8000, v17
  v_mfma_f32_16x16x32_bf16 v[148:151], v[92:95], a[172:175], v[148:151]
  v_and_b32 v17, 0x1ffff, v17
  v_mfma_f32_16x16x32_bf16 v[152:155], v[64:67], a[224:227], v[152:155]
  v_add_u32 v18, 0x8000, v18
  v_mfma_f32_16x16x32_bf16 v[152:155], v[72:75], a[228:231], v[152:155]
  v_and_b32 v18, 0x1ffff, v18
  v_mfma_f32_16x16x32_bf16 v[152:155], v[80:83], a[232:235], v[152:155]
  v_add_u32 v19, 0x8000, v19
  v_mfma_f32_16x16x32_bf16 v[152:155], v[88:91], a[236:239], v[152:155]
  v_and_b32 v19, 0x1ffff, v19
  v_mfma_f32_16x16x32_bf16 v[156:159], v[68:71], a[224:227], v[156:159]
  s_sub_u32 s59, s63, 1
  s_max_i32 s59, s59, 0
  v_mfma_f32_16x16x32_bf16 v[156:159], v[76:79], a[228:231], v[156:159]
  v_mov_b32 v7, s59
  v_mfma_f32_16x16x32_bf16 v[156:159], v[84:87], a[232:235], v[156:159]
  s_cmp_lt_u32 s63, s80
  v_mfma_f32_16x16x32_bf16 v[156:159], v[92:95], a[236:239], v[156:159]
  s_waitcnt lgkmcnt(0)
  v_mfma_f32_16x16x32_bf16 v[128:131], v[96:99], a[48:51], v[128:131]
  s_waitcnt vmcnt(20)
  s_cbranch_scc1 L_f_e_29
L_f_e_29b:
  v_mfma_f32_16x16x32_bf16 v[128:131], v[104:107], a[52:55], v[128:131]
  s_barrier
  v_mfma_f32_16x16x32_bf16 v[128:131], v[112:115], a[56:59], v[128:131]
  ds_read_b128 v[64:67], v16 offset:0
  v_mfma_f32_16x16x32_bf16 v[128:131], v[120:123], a[60:63], v[128:131]
  buffer_store_dword v7, v6, s[40:43], s64 offen sc1
  v_mfma_f32_16x16x32_bf16 v[132:135], v[100:103], a[48:51], v[132:135]
  s_lshr_b32 s62, s63, 3
  ds_read_b128 v[68:71], v16 offset:16384
  v_mfma_f32_16x16x32_bf16 v[132:135], v[108:111], a[52:55], v[132:135]
  s_lshl_b32 s62, s62, 2
  v_mfma_f32_16x16x32_bf16 v[132:135], v[116:119], a[56:59], v[132:135]
  s_lshr_b32 s62, s73, s62
  ds_read_b128 v[72:75], v17 offset:0
  v_mfma_f32_16x16x32_bf16 v[132:135], v[124:127], a[60:63], v[132:135]
  s_and_b32 s62, s62, 7
  v_mfma_f32_16x16x32_bf16 v[136:139], v[96:99], a[112:115], v[136:139]
  s_and_b32 s59, s63, 7
  ds_read_b128 v[76:79], v17 offset:16384
  v_mfma_f32_16x16x32_bf16 v[136:139], v[104:107], a[116:119], v[136:139]
  s_lshl3_add_u32 s62, s62, s59
  v_mfma_f32_16x16x32_bf16 v[136:139], v[112:115], a[120:123], v[136:139]
  s_lshl_b32 s62, s62, 13
  ds_read_b128 v[80:83], v18 offset:0
  v_mfma_f32_16x16x32_bf16 v[136:139], v[120:123], a[124:127], v[136:139]
  s_add_u32 s62, s62, s65
  v_mfma_f32_16x16x32_bf16 v[140:143], v[100:103], a[112:115], v[140:143]
  s_add_u32 s70, s70, 1
  ds_read_b128 v[84:87], v18 offset:16384
  v_mfma_f32_16x16x32_bf16 v[140:143], v[108:111], a[116:119], v[140:143]
  s_lshr_b32 s61, s70, 3
  v_mfma_f32_16x16x32_bf16 v[140:143], v[116:119], a[120:123], v[140:143]
  s_lshl_b32 s61, s61, 2
  ds_read_b128 v[88:91], v19 offset:0
  v_mfma_f32_16x16x32_bf16 v[140:143], v[124:127], a[124:127], v[140:143]
  s_lshr_b32 s61, s73, s61
  v_mfma_f32_16x16x32_bf16 v[144:147], v[96:99], a[176:179], v[144:147]
  s_and_b32 s61, s61, 7
  ds_read_b128 v[92:95], v19 offset:16384
  v_mfma_f32_16x16x32_bf16 v[144:147], v[104:107], a[180:183], v[144:147]
  s_and_b32 s59, s70, 7
  v_mfma_f32_16x16x32_bf16 v[144:147], v[112:115], a[184:187], v[144:147]
  s_lshl3_add_u32 s61, s61, s59
  v_mfma_f32_16x16x32_bf16 v[144:147], v[120:123], a[188:191], v[144:147]
  s_lshl_b32 s61, s61, 15
  v_mfma_f32_16x16x32_bf16 v[148:151], v[100:103], a[176:179], v[148:151]
  s_add_u32 s61, s61, s71
  v_mfma_f32_16x16x32_bf16 v[148:151], v[108:111], a[180:183], v[148:151]
  s_add_u32 s66, s66, 0x8000
  v_mfma_f32_16x16x32_bf16 v[148:151], v[116:119], a[184:187], v[148:151]
  s_and_b32 s66, s66, 0x1ffff
  v_mfma_f32_16x16x32_bf16 v[148:151], v[124:127], a[188:191], v[148:151]
  v_mfma_f32_16x16x32_bf16 v[152:155], v[96:99], a[240:243], v[152:155]
  s_add_u32 s63, s63, 1
  v_mfma_f32_16x16x32_bf16 v[152:155], v[104:107], a[244:247], v[152:155]
  v_mfma_f32_16x16x32_bf16 v[152:155], v[112:115], a[248:251], v[152:155]
  v_mfma_f32_16x16x32_bf16 v[152:155], v[120:123], a[252:255], v[152:155]
  v_mfma_f32_16x16x32_bf16 v[156:159], v[100:103], a[240:243], v[156:159]
  v_mfma_f32_16x16x32_bf16 v[156:159], v[108:111], a[244:247], v[156:159]
  v_mfma_f32_16x16x32_bf16 v[156:159], v[116:119], a[248:251], v[156:159]
  s_cmp_lt_u32 s63, s67
  v_mfma_f32_16x16x32_bf16 v[156:159], v[124:127], a[252:255], v[156:159]
  s_waitcnt lgkmcnt(0)
L_f_11:
  v_mfma_f32_16x16x32_bf16 v[160:163], v[64:67], a[0:3], 0
  v_mfma_f32_16x16x32_bf16 v[160:163], v[72:75], a[4:7], v[160:163]
  v_mfma_f32_16x16x32_bf16 v[160:163], v[80:83], a[8:11], v[160:163]
  ds_read_b128 v[96:99], v16 offset:256
  v_mfma_f32_16x16x32_bf16 v[160:163], v[88:91], a[12:15], v[160:163]
  s_cmp_lg_u32 s57, 6
  s_cbranch_scc1 L_f_pw_32
  buffer_store_dwordx4 v[36:39], v2, s[40:43], s79 offen sc1
  s_add_u32 s79, s79, 0x20000
L_f_pw_32:
  v_mfma_f32_16x16x32_bf16 v[164:167], v[68:71], a[0:3], 0
  ds_read_b128 v[100:103], v16 offset:16640
  v_mfma_f32_16x16x32_bf16 v[164:167], v[76:79], a[4:7], v[164:167]
  v_mfma_f32_16x16x32_bf16 v[164:167], v[84:87], a[8:11], v[164:167]
  ds_read_b128 v[104:107], v17 offset:256
  v_mfma_f32_16x16x32_bf16 v[164:167], v[92:95], a[12:15], v[164:167]
  v_mfma_f32_16x16x32_bf16 v[168:171], v[64:67], a[64:67], 0
  ds_read_b128 v[108:111], v17 offset:16640
  v_mfma_f32_16x16x32_bf16 v[168:171], v[72:75], a[68:71], v[168:171]
  v_cvt_pk_bf16_f32 v192, v128, v129
  v_cvt_pk_bf16_f32 v193, v130, v131
  v_mfma_f32_16x16x32_bf16 v[168:171], v[80:83], a[72:75], v[168:171]
  ds_read_b128 v[112:115], v18 offset:256
  v_cvt_pk_bf16_f32 v194, v132, v133
  v_mfma_f32_16x16x32_bf16 v[168:171], v[88:91], a[76:79], v[168:171]
  v_cvt_pk_bf16_f32 v195, v134, v135
  v_mfma_f32_16x16x32_bf16 v[172:175], v[68:71], a[64:67], 0
  ds_read_b128 v[116:119], v18 offset:16640
  v_mfma_f32_16x16x32_bf16 v[172:175], v[76:79], a[68:71], v[172:175]
  buffer_store_dwordx4 v[192:195], v2, s[40:43], s62 offen offset:0 sc1
  v_mfma_f32_16x16x32_bf16 v[172:175], v[84:87], a[72:75], v[172:175]
  ds_read_b128 v[120:123], v19 offset:256
  v_cvt_pk_bf16_f32 v196, v136, v137
  v_mfma_f32_16x16x32_bf16 v[172:175], v[92:95], a[76:79], v[172:175]
  v_cvt_pk_bf16_f32 v197, v138, v139
  v_cvt_pk_bf16_f32 v198, v140, v141
  v_mfma_f32_16x16x32_bf16 v[176:179], v[64:67], a[128:131], 0
  ds_read_b128 v[124:127], v19 offset:16640
  v_cvt_pk_bf16_f32 v199, v142, v143
  v_mfma_f32_16x16x32_bf16 v[176:179], v[72:75], a[132:135], v[176:179]
  buffer_store_dwordx4 v[196:199], v2, s[40:43], s62 offen offset:1024 sc1
  v_mfma_f32_16x16x32_bf16 v[176:179], v[80:83], a[136:139], v[176:179]
  v_cvt_pk_bf16_f32 v200, v144, v145
  v_cvt_pk_bf16_f32 v201, v146, v147
  v_mfma_f32_16x16x32_bf16 v[176:179], v[88:91], a[140:143], v[176:179]
  v_cvt_pk_bf16_f32 v202, v148, v149
  v_cvt_pk_bf16_f32 v203, v150, v151
  v_mfma_f32_16x16x32_bf16 v[180:183], v[68:71], a[128:131], 0
  buffer_store_dwordx4 v[200:203], v2, s[40:43], s62 offen offset:2048 sc1
  v_mfma_f32_16x16x32_bf16 v[180:183], v[76:79], a[132:135], v[180:183]
  v_cvt_pk_bf16_f32 v204, v152, v153
  v_cvt_pk_bf16_f32 v205, v154, v155
  v_mfma_f32_16x16x32_bf16 v[180:183], v[84:87], a[136:139], v[180:183]
  v_cvt_pk_bf16_f32 v206, v156, v157
  v_cvt_pk_bf16_f32 v207, v158, v159
  v_mfma_f32_16x16x32_bf16 v[180:183], v[92:95], a[140:143], v[180:183]
  buffer_store_dwordx4 v[204:207], v2, s[40:43], s62 offen offset:3072 sc1
  v_mfma_f32_16x16x32_bf16 v[184:187], v[64:67], a[192:195], 0
  v_mfma_f32_16x16x32_bf16 v[184:187], v[72:75], a[196:199], v[184:187]
  v_mfma_f32_16x16x32_bf16 v[184:187], v[80:83], a[200:203], v[184:187]
  v_mfma_f32_16x16x32_bf16 v[184:187], v[88:91], a[204:207], v[184:187]
  v_mfma_f32_16x16x32_bf16 v[188:191], v[68:71], a[192:195], 0
  v_mfma_f32_16x16x32_bf16 v[188:191], v[76:79], a[196:199], v[188:191]
  v_mfma_f32_16x16x32_bf16 v[188:191], v[84:87], a[200:203], v[188:191]
  v_mfma_f32_16x16x32_bf16 v[188:191], v[92:95], a[204:207], v[188:191]
  s_waitcnt lgkmcnt(0)
  v_mfma_f32_16x16x32_bf16 v[160:163], v[96:99], a[16:19], v[160:163]
  v_mfma_f32_16x16x32_bf16 v[160:163], v[104:107], a[20:23], v[160:163]
  v_mfma_f32_16x16x32_bf16 v[160:163], v[112:115], a[24:27], v[160:163]
  ds_read_b128 v[64:67], v16 offset:512
  v_mfma_f32_16x16x32_bf16 v[160:163], v[120:123], a[28:31], v[160:163]
  v_mfma_f32_16x16x32_bf16 v[164:167], v[100:103], a[16:19], v[164:167]
  ds_read_b128 v[68:71], v16 offset:16896
  v_mfma_f32_16x16x32_bf16 v[164:167], v[108:111], a[20:23], v[164:167]
  v_mfma_f32_16x16x32_bf16 v[164:167], v[116:119], a[24:27], v[164:167]
  ds_read_b128 v[72:75], v17 offset:512
  v_mfma_f32_16x16x32_bf16 v[164:167], v[124:127], a[28:31], v[164:167]
  v_mfma_f32_16x16x32_bf16 v[168:171], v[96:99], a[80:83], v[168:171]
  ds_read_b128 v[76:79], v17 offset:16896
  v_mfma_f32_16x16x32_bf16 v[168:171], v[104:107], a[84:87], v[168:171]
  v_mfma_f32_16x16x32_bf16 v[168:171], v[112:115], a[88:91], v[168:171]
  ds_read_b128 v[80:83], v18 offset:512
  v_mfma_f32_16x16x32_bf16 v[168:171], v[120:123], a[92:95], v[168:171]
  v_mfma_f32_16x16x32_bf16 v[172:175], v[100:103], a[80:83], v[172:175]
  ds_read_b128 v[84:87], v18 offset:16896
  v_mfma_f32_16x16x32_bf16 v[172:175], v[108:111], a[84:87], v[172:175]
  v_mfma_f32_16x16x32_bf16 v[172:175], v[116:119], a[88:91], v[172:175]
  ds_read_b128 v[88:91], v19 offset:512
  v_mfma_f32_16x16x32_bf16 v[172:175], v[124:127], a[92:95], v[172:175]
  v_mfma_f32_16x16x32_bf16 v[176:179], v[96:99], a[144:147], v[176:179]
  ds_read_b128 v[92:95], v19 offset:16896
  v_mfma_f32_16x16x32_bf16 v[176:179], v[104:107], a[148:151], v[176:179]
  v_mfma_f32_16x16x32_bf16 v[176:179], v[112:115], a[152:155], v[176:179]
  v_mfma_f32_16x16x32_bf16 v[176:179], v[120:123], a[156:159], v[176:179]
  s_add_u32 m0, s66, 0
  s_add_u32 s58, s61, 0
  v_mfma_f32_16x16x32_bf16 v[180:183], v[100:103], a[144:147], v[180:183]
  v_mfma_f32_16x16x32_bf16 v[180:183], v[108:111], a[148:151], v[180:183]
  buffer_load_dwordx4 v8, s[52:55], s58 offen lds
  v_mfma_f32_16x16x32_bf16 v[180:183], v[116:119], a[152:155], v[180:183]
  v_mfma_f32_16x16x32_bf16 v[180:183], v[124:127], a[156:159], v[180:183]
  s_add_u32 m0, s66, 1024
  s_add_u32 s58, s61, 1024
  v_mfma_f32_16x16x32_bf16 v[184:187], v[96:99], a[208:211], v[184:187]
  v_mfma_f32_16x16x32_bf16 v[184:187], v[104:107], a[212:215], v[184:187]
  buffer_load_dwordx4 v9, s[52:55], s58 offen lds
  v_mfma_f32_16x16x32_bf16 v[184:187], v[112:115], a[216:219], v[184:187]
  v_mfma_f32_16x16x32_bf16 v[184:187], v[120:123], a[220:223], v[184:187]
  s_add_u32 m0, s66, 2048
  s_add_u32 s58, s61, 2048
  v_mfma_f32_16x16x32_bf16 v[188:191], v[100:103], a[208:211], v[188:191]
  v_mfma_f32_16x16x32_bf16 v[188:191], v[108:111], a[212:215], v[188:191]
  buffer_load_dwordx4 v10, s[52:55], s58 offen lds
  v_mfma_f32_16x16x32_bf16 v[188:191], v[116:119], a[216:219], v[188:191]
  v_mfma_f32_16x16x32_bf16 v[188:191], v[124:127], a[220:223], v[188:191]
  s_waitcnt lgkmcnt(0)
  s_add_u32 m0, s66, 3072
  s_add_u32 s58, s61, 3072
  v_mfma_f32_16x16x32_bf16 v[160:163], v[64:67], a[32:35], v[160:163]
  v_mfma_f32_16x16x32_bf16 v[160:163], v[72:75], a[36:39], v[160:163]
  buffer_load_dwordx4 v11, s[52:55], s58 offen lds
  v_mfma_f32_16x16x32_bf16 v[160:163], v[80:83], a[40:43], v[160:163]
  ds_read_b128 v[96:99], v16 offset:768
  v_mfma_f32_16x16x32_bf16 v[160:163], v[88:91], a[44:47], v[160:163]
  s_add_u32 m0, s66, 4096
  s_add_u32 s58, s61, 4096
  v_mfma_f32_16x16x32_bf16 v[164:167], v[68:71], a[32:35], v[164:167]
  ds_read_b128 v[100:103], v16 offset:17152
  v_mfma_f32_16x16x32_bf16 v[164:167], v[76:79], a[36:39], v[164:167]
  buffer_load_dwordx4 v12, s[52:55], s58 offen lds
  v_mfma_f32_16x16x32_bf16 v[164:167], v[84:87], a[40:43], v[164:167]
  ds_read_b128 v[104:107], v17 offset:768
  v_mfma_f32_16x16x32_bf16 v[164:167], v[92:95], a[44:47], v[164:167]
  s_add_u32 m0, s66, 5120
  s_add_u32 s58, s61, 5120
  v_mfma_f32_16x16x32_bf16 v[168:171], v[64:67], a[96:99], v[168:171]
  ds_read_b128 v[108:111], v17 offset:17152
  v_mfma_f32_16x16x32_bf16 v[168:171], v[72:75], a[100:103], v[168:171]
  buffer_load_dwordx4 v13, s[52:55], s58 offen lds
  v_mfma_f32_16x16x32_bf16 v[168:171], v[80:83], a[104:107], v[168:171]
  ds_read_b128 v[112:115], v18 offset:768
  v_mfma_f32_16x16x32_bf16 v[168:171], v[88:91], a[108:111], v[168:171]
  s_add_u32 m0, s66, 6144
  s_add_u32 s58, s61, 6144
  v_mfma_f32_16x16x32_bf16 v[172:175], v[68:71], a[96:99], v[172:175]
  ds_read_b128 v[116:119], v18 offset:17152
  v_mfma_f32_16x16x32_bf16 v[172:175], v[76:79], a[100:103], v[172:175]
  buffer_load_dwordx4 v14, s[52:55], s58 offen lds
  v_mfma_f32_16x16x32_bf16 v[172:175], v[84:87], a[104:107], v[172:175]
  ds_read_b128 v[120:123], v19 offset:768
  v_mfma_f32_16x16x32_bf16 v[172:175], v[92:95], a[108:111], v[172:175]
  s_add_u32 m0, s66, 7168
  s_add_u32 s58, s61, 7168
  v_mfma_f32_16x16x32_bf16 v[176:179], v[64:67], a[160:163], v[176:179]
  ds_read_b128 v[124:127], v19 offset:17152
  v_mfma_f32_16x16x32_bf16 v[176:179], v[72:75], a[164:167], v[176:179]
  buffer_load_dwordx4 v15, s[52:55], s58 offen lds
  v_mfma_f32_16x16x32_bf16 v[176:179], v[80:83], a[168:171], v[176:179]
  v_mfma_f32_16x16x32_bf16 v[176:179], v[88:91], a[172:175], v[176:179]
  v_mfma_f32_16x16x32_bf16 v[180:183], v[68:71], a[160:163], v[180:183]
  v_add_u32 v16, 0x8000, v16
  v_mfma_f32_16x16x32_bf16 v[180:183], v[76:79], a[164:167], v[180:183]
  v_and_b32 v16, 0x1ffff, v16
  v_mfma_f32_16x16x32_bf16 v[180:183], v[84:87], a[168:171], v[180:183]
  v_add_u32 v17, 0x8000, v17
  v_mfma_f32_16x16x32_bf16 v[180:183], v[92:95], a[172:175], v[180:183]
  v_and_b32 v17, 0x1ffff, v17
  v_mfma_f32_16x16x32_bf16 v[184:187], v[64:67], a[224:227], v[184:187]
  v_add_u32 v18, 0x8000, v18
  v_mfma_f32_16x16x32_bf16 v[184:187], v[72:75], a[228:231], v[184:187]
  v_and_b32 v18, 0x1ffff, v18
  v_mfma_f32_16x16x32_bf16 v[184:187], v[80:83], a[232:235], v[184:187]
  v_add_u32 v19, 0x8000, v19
  v_mfma_f32_16x16x32_bf16 v[184:187], v[88:91], a[236:239], v[184:187]
  v_and_b32 v19, 0x1ffff, v19
  v_mfma_f32_16x16x32_bf16 v[188:191], v[68:71], a[224:227], v[188:191]
  s_sub_u32 s59, s63, 1
  s_max_i32 s59, s59, 0
  v_mfma_f32_16x16x32_bf16 v[188:191], v[76:79], a[228:231], v[188:191]
  v_mov_b32 v7, s59
  v_mfma_f32_16x16x32_bf16 v[188:191], v[84:87], a[232:235], v[188:191]
  s_cmp_lt_u32 s63, s80
  v_mfma_f32_16x16x32_bf16 v[188:191], v[92:95], a[236:239], v[188:191]
  s_waitcnt lgkmcnt(0)
  v_mfma_f32_16x16x32_bf16 v[160:163], v[96:99], a[48:51], v[160:163]
  s_waitcnt vmcnt(20)
  s_cbranch_scc1 L_f_e_31
L_f_e_31b:
  v_mfma_f32_16x16x32_bf16 v[160:163], v[104:107], a[52:55], v[160:163]
  s_barrier
  v_mfma_f32_16x16x32_bf16 v[160:163], v[112:115], a[56:59], v[160:163]
  ds_read_b128 v[64:67], v16 offset:0
  v_mfma_f32_16x16x32_bf16 v[160:163], v[120:123], a[60:63], v[160:163]
  buffer_store_dword v7, v6, s[40:43], s64 offen sc1
  v_mfma_f32_16x16x32_bf16 v[164:167], v[100:103], a[48:51], v[164:167]
  s_lshr_b32 s62, s63, 3
  ds_read_b128 v[68:71], v16 offset:16384
  v_mfma_f32_16x16x32_bf16 v[164:167], v[108:111], a[52:55], v[164:167]
  s_lshl_b32 s62, s62, 2
  v_mfma_f32_16x16x32_bf16 v[164:167], v[116:119], a[56:59], v[164:167]
  s_lshr_b32 s62, s73, s62
  ds_read_b128 v[72:75], v17 offset:0
  v_mfma_f32_16x16x32_bf16 v[164:167], v[124:127], a[60:63], v[164:167]
  s_and_b32 s62, s62, 7
  v_mfma_f32_16x16x32_bf16 v[168:171], v[96:99], a[112:115], v[168:171]
  s_and_b32 s59, s63, 7
  ds_read_b128 v[76:79], v17 offset:16384
  v_mfma_f32_16x16x32_bf16 v[168:171], v[104:107], a[116:119], v[168:171]
  s_lshl3_add_u32 s62, s62, s59
  v_mfma_f32_16x16x32_bf16 v[168:171], v[112:115], a[120:123], v[168:171]
  s_lshl_b32 s62, s62, 13
  ds_read_b128 v[80:83], v18 offset:0
  v_mfma_f32_16x16x32_bf16 v[168:171], v[120:123], a[124:127], v[168:171]
  s_add_u32 s62, s62, s65
  v_mfma_f32_16x16x32_bf16 v[172:175], v[100:103], a[112:115], v[172:175]
  s_add_u32 s70, s70, 1
  ds_read_b128 v[84:87], v18 offset:16384
  v_mfma_f32_16x16x32_bf16 v[172:175], v[108:111], a[116:119], v[172:175]
  s_lshr_b32 s61, s70, 3
  v_mfma_f32_16x16x32_bf16 v[172:175], v[116:119], a[120:123], v[172:175]
  s_lshl_b32 s61, s61, 2
  ds_read_b128 v[88:91], v19 offset:0
  v_mfma_f32_16x16x32_bf16 v[172:175], v[124:127], a[124:127], v[172:175]
  s_lshr_b32 s61, s73, s61
  v_mfma_f32_16x16x32_bf16 v[176:179], v[96:99], a[176:179], v[176:179]
  s_and_b32 s61, s61, 7
  ds_read_b128 v[92:95], v19 offset:16384
  v_mfma_f32_16x16x32_bf16 v[176:179], v[104:107], a[180:183], v[176:179]
  s_and_b32 s59, s70, 7
  v_mfma_f32_16x16x32_bf16 v[176:179], v[112:115], a[184:187], v[176:179]
  s_lshl3_add_u32 s61, s61, s59
  v_mfma_f32_16x16x32_bf16 v[176:179], v[120:123], a[188:191], v[176:179]
  s_lshl_b32 s61, s61, 15
  v_mfma_f32_16x16x32_bf16 v[180:183], v[100:103], a[176:179], v[180:183]
  s_add_u32 s61, s61, s71
  v_mfma_f32_16x16x32_bf16 v[180:183], v[108:111], a[180:183], v[180:183]
  s_add_u32 s66, s66, 0x8000
  v_mfma_f32_16x16x32_bf16 v[180:183], v[116:119], a[184:187], v[180:183]
  s_and_b32 s66, s66, 0x1ffff
  v_mfma_f32_16x16x32_bf16 v[180:183], v[124:127], a[188:191], v[180:183]
  v_mfma_f32_16x16x32_bf16 v[184:187], v[96:99], a[240:243], v[184:187]
  s_add_u32 s63, s63, 1
  v_mfma_f32_16x16x32_bf16 v[184:187], v[104:107], a[244:247], v[184:187]
  v_mfma_f32_16x16x32_bf16 v[184:187], v[112:115], a[248:251], v[184:187]
  v_mfma_f32_16x16x32_bf16 v[184:187], v[120:123], a[252:255], v[184:187]
  v_mfma_f32_16x16x32_bf16 v[188:191], v[100:103], a[240:243], v[188:191]
  v_mfma_f32_16x16x32_bf16 v[188:191], v[108:111], a[244:247], v[188:191]
  v_mfma_f32_16x16x32_bf16 v[188:191], v[116:119], a[248:251], v[188:191]
  s_cmp_lt_u32 s63, s67
  v_mfma_f32_16x16x32_bf16 v[188:191], v[124:127], a[252:255], v[188:191]
  s_waitcnt lgkmcnt(0)
  s_cbranch_scc1 L_f_10
  s_branch L_f_done
L_f_e_25:
  v_mov_b32 v7, s63
  s_waitcnt vmcnt(8)
  s_branch L_f_e_25b
L_f_e_27:
  v_mov_b32 v7, s63
  s_waitcnt vmcnt(8)
  s_branch L_f_e_27b
L_f_e_29:
  v_mov_b32 v7, s63
  s_waitcnt vmcnt(8)
  s_branch L_f_e_29b
L_f_e_31:
  v_mov_b32 v7, s63
  s_waitcnt vmcnt(8)
  s_branch L_f_e_31b
L_f_done:
  s_nop 7
  v_mul_f32 v160, s69, v160
  v_mul_f32 v161, s69, v161
  v_mul_f32 v162, s69, v162
  v_mul_f32 v163, s69, v163
  v_mul_f32 v164, s69, v164
  v_mul_f32 v165, s69, v165
  v_mul_f32 v166, s69, v166
  v_mul_f32 v167, s69, v167
  v_cvt_pk_bf16_f32 v192, v160, v161
  v_cvt_pk_bf16_f32 v193, v162, v163
  v_cvt_pk_bf16_f32 v194, v164, v165
  v_cvt_pk_bf16_f32 v195, v166, v167
  buffer_store_dwordx4 v[192:195], v2, s[40:43], s62 offen offset:0 sc1
  v_mul_f32 v168, s69, v168
  v_mul_f32 v169, s69, v169
  v_mul_f32 v170, s69, v170
  v_mul_f32 v171, s69, v171
  v_mul_f32 v172, s69, v172
  v_mul_f32 v173, s69, v173
  v_mul_f32 v174, s69, v174
  v_mul_f32 v175, s69, v175
  v_cvt_pk_bf16_f32 v196, v168, v169
  v_cvt_pk_bf16_f32 v197, v170, v171
  v_cvt_pk_bf16_f32 v198, v172, v173
  v_cvt_pk_bf16_f32 v199, v174, v175
  buffer_store_dwordx4 v[196:199], v2, s[40:43], s62 offen offset:1024 sc1
  v_mul_f32 v176, s69, v176
  v_mul_f32 v177, s69, v177
  v_mul_f32 v178, s69, v178
  v_mul_f32 v179, s69, v179
  v_mul_f32 v180, s69, v180
  v_mul_f32 v181, s69, v181
  v_mul_f32 v182, s69, v182
  v_mul_f32 v183, s69, v183
  v_cvt_pk_bf16_f32 v200, v176, v177
  v_cvt_pk_bf16_f32 v201, v178, v179
  v_cvt_pk_bf16_f32 v202, v180, v181
  v_cvt_pk_bf16_f32 v203, v182, v183
  buffer_store_dwordx4 v[200:203], v2, s[40:43], s62 offen offset:2048 sc1
  v_mul_f32 v184, s69, v184
  v_mul_f32 v185, s69, v185
  v_mul_f32 v186, s69, v186
  v_mul_f32 v187, s69, v187
  v_mul_f32 v188, s69, v188
  v_mul_f32 v189, s69, v189
  v_mul_f32 v190, s69, v190
  v_mul_f32 v191, s69, v191
  v_cvt_pk_bf16_f32 v204, v184, v185
  v_cvt_pk_bf16_f32 v205, v186, v187
  v_cvt_pk_bf16_f32 v206, v188, v189
  v_cvt_pk_bf16_f32 v207, v190, v191
  buffer_store_dwordx4 v[204:207], v2, s[40:43], s62 offen offset:3072 sc1
  v_mov_b32 v7, s67
  s_waitcnt vmcnt(0) lgkmcnt(0)
  s_barrier
  buffer_store_dword v7, v6, s[40:43], s64 offen sc1
  s_branch L_next
L_after_p:
  s_waitcnt vmcnt(0)
  s_endpgm
L_team:
  s_mov_b32 s67, 0
  v_lshrrev_b32 v20, 4, v0
  v_and_b32 v21, 15, v0
  v_bfe_u32 v22, v0, 4, 1
  v_lshrrev_b32 v23, 5, v0
  s_lshl_b32 s68, s44, 1
  v_or_b32 v24, s68, v22
  v_lshlrev_b32 v24, 1, v24
  v_xor_b32 v24, v24, v21
  v_lshlrev_b32 v24, 4, v24
  v_lshl_add_u32 v25, v22, 4, v23
  v_add_u32 v25, s68, v25
  v_lshl_add_u32 v44, v25, 13, v24
  s_lshl_b32 s69, s45, 8
  v_add_u32 v44, s69, v44
  s_lshl_b32 s68, s44, 4
  v_add_u32 v25, s68, v20
  v_lshl_add_u32 v45, v25, 10, v24
  s_lshl_b32 s69, s45, 17
  v_add_u32 v45, s69, v45
  s_mov_b32 s50, 0x400000
  s_mov_b32 s51, 0x20000
  s_lshl_b32 s56, s44, 10
  s_mov_b32 s48, s30
  s_and_b32 s49, s31, 0xffff
  s_add_u32 m0, s56, 0
  s_mov_b32 s68, 0
  buffer_load_dwordx4 v45, s[48:51], s68 offen  lds
  s_add_u32 m0, s56, 4096
  s_mov_b32 s68, 4096
  buffer_load_dwordx4 v45, s[48:51], s68 offen  lds
  s_add_u32 m0, s56, 8192
  s_mov_b32 s68, 8192
  buffer_load_dwordx4 v45, s[48:51], s68 offen  lds
  s_add_u32 m0, s56, 12288
  s_mov_b32 s68, 12288
  buffer_load_dwordx4 v45, s[48:51], s68 offen  lds
  s_add_u32 m0, s56, 16384
  s_mov_b32 s68, 65536
  buffer_load_dwordx4 v45, s[48:51], s68 offen  lds
  s_add_u32 m0, s56, 20480
  s_mov_b32 s68, 69632
  buffer_load_dwordx4 v45, s[48:51], s68 offen  lds
  s_add_u32 m0, s56, 24576
  s_mov_b32 s68, 73728
  buffer_load_dwordx4 v45, s[48:51], s68 offen  lds
  s_add_u32 m0, s56, 28672
  s_mov_b32 s68, 77824
  buffer_load_dwordx4 v45, s[48:51], s68 offen  lds
  s_lshl_b32 s68, s44, 11
  s_add_u32 s68, s68, 131072
  v_lshl_add_u32 v2, v0, 4, s68
  s_add_u32 s73, s68, 8192
  s_lshl_b32 s68, s44, 12
  v_lshl_add_u32 v3, v0, 4, s68
  s_lshl_b32 s68, s44, 9
  s_add_u32 s68, s68, 131072
  v_bfe_u32 v22, v0, 3, 1
  v_lshl_add_u32 v5, v22, 8, s68
  v_lshl_add_u32 v5, v20, 6, v5
  v_and_b32 v22, 7, v0
  v_lshl_add_u32 v5, v22, 3, v5
  v_lshrrev_b32 v22, 5, v0
  v_lshlrev_b32 v6, 8, v22
  v_and_b32 v22, 3, v0
  v_lshl_add_u32 v6, v22, 6, v6
  v_bfe_u32 v22, v0, 2, 3
  v_lshl_add_u32 v6, v22, 3, v6
  v_add_u32 v6, 131072, v6
  s_lshl_b32 s68, s44, 9
  s_add_u32 s68, s68, 147456
  v_lshrrev_b32 v22, 1, v0
  v_lshl_add_u32 v7, v22, 4, s68
  s_lshl_b32 s68, s44, 14
  s_lshl_b32 s69, s45, 6
  s_add_u32 s68, s68, s69
  v_lshrrev_b32 v22, 3, v0
  v_lshl_add_u32 v8, v22, 11, s68
  v_and_b32 v22, 7, v0
  v_lshl_add_u32 v8, v22, 3, v8
  v_lshlrev_b32 v9, 8, v20
  v_bfe_u32 v22, v0, 2, 1
  v_lshl_add_u32 v9, v22, 7, v9
  v_and_b32 v22, 1, v0
  v_lshl_add_u32 v9, v22, 6, v9
  v_bfe_u32 v22, v0, 3, 1
  v_lshl_add_u32 v9, v22, 5, v9
  v_bfe_u32 v22, v0, 1, 1
  v_lshl_add_u32 v9, v22, 4, v9
  s_lshl_b32 s68, s44, 16
  s_lshl_b32 s69, s45, 11
  s_add_u32 s68, s68, s69
  s_add_u32 s62, s68, 0xd000000
  v_bfe_u32 v22, v0, 3, 1
  v_lshlrev_b32 v10, 13, v22
  v_lshl_add_u32 v10, v20, 3, v10
  v_bfe_u32 v22, v0, 1, 1
  v_lshl_add_u32 v10, v22, 5, v10
  v_bfe_u32 v22, v0, 2, 1
  v_lshl_add_u32 v10, v22, 2, v10
  v_and_b32 v22, 1, v0
  v_lshl_add_u32 v10, v22, 1, v10
  s_lshl_b32 s64, s44, 11
  s_lshr_b32 s68, s45, 3
  s_lshl_b32 s68, s68, 9
  s_add_u32 s64, s64, s68
  s_and_b32 s68, s45, 1
  s_lshl_b32 s68, s68, 8
  s_add_u32 s64, s64, s68
  s_bfe_u32 s68, s45, 0x20001
  s_lshl_b32 s68, s68, 6
  s_add_u32 s64, s64, s68
  s_add_u32 s64, s64, 0xd040000
  s_mov_b32 s63, 0xd022000
  s_lshl_b32 s60, s45, 7
  s_add_u32 s60, s60, 0xd081000
  s_lshl_b32 s72, s45, 19
  s_add_u32 s72, s72, 0x3fe0000
  s_mov_b32 s94, 0xaaaaaaaa
  s_mov_b32 s95, 0xaaaaaaaa
  v_mov_b32 v17, 0
  v_mov_b32 v18, 0
  v_mov_b32 v16, 0
  v_mov_b32 v12, 0x3f803f80
  v_mov_b32 v13, 0x3f803f80
  v_mov_b32 v14, 0x3f803f80
  v_mov_b32 v15, 0x3f803f80
  s_mov_b32 s78, 0xff00ff00
  s_mov_b32 s79, 0xff00ff00
  s_mov_b32 s88, 0x3e0293ee
  s_mov_b32 s89, 0x21800000
  s_mov_b32 s91, 0x3c000000
  s_mov_b32 s90, 0xfffe
  s_lshl_b32 s68, s44, 11
  s_add_u32 s70, s68, 147456
  s_add_u32 s71, s68, 139264
  s_lshl_b32 s68, s45, 7
  s_add_u32 s68, s68, 0xd084000
  s_cmp_eq_u32 s44, 0
  s_cselect_b32 s66, s68, 0x40000000
  s_mov_b32 s80, 0x3030303
  s_mov_b32 s81, 0x3030303
  s_mov_b32 s74, 0xd000000
  s_mov_b32 s82, 0xc0c0c0c
  s_mov_b32 s83, 0xc0c0c0c
  s_mov_b32 s75, 0xd010000
  s_mov_b32 s84, 0x30303030
  s_mov_b32 s85, 0x30303030
  s_mov_b32 s76, 0xd020000
  s_mov_b32 s86, 0xc0c0c0c0
  s_mov_b32 s87, 0xc0c0c0c0
  s_mov_b32 s77, 0xd030000
  buffer_store_dwordx2 v[16:17], v8, s[40:43], s74 offen sc1
  buffer_store_dwordx2 v[16:17], v8, s[40:43], s75 offen sc1
  buffer_store_dwordx2 v[16:17], v8, s[40:43], s76 offen sc1
  buffer_store_dwordx2 v[16:17], v8, s[40:43], s77 offen sc1
  v_mov_b32 v22, 0xffff
  buffer_store_short v22, v10, s[40:43], s64 offen sc1
  s_mul_i32 s68, s44, 4
  s_lshr_b32 s68, 0x7640, s68
  s_and_b32 s68, s68, 15
  s_lshl_b32 s68, s68, 12
  s_lshl_b32 s69, s45, 7
  s_add_u32 s68, s68, s69
  s_add_u32 s68, s68, 0xd080000
  v_and_b32 v23, 31, v0
  v_lshlrev_b32 v23, 2, v23
  v_lshrrev_b32 v24, 5, v0
  v_lshl_add_u32 v23, v24, 12, v23
  buffer_store_dword v17, v23, s[40:43], s68 offen sc1
  s_mov_b32 s52, s22
  s_and_b32 s53, s23, 0xffff
  s_mov_b32 s54, 0x2000
  s_mov_b32 s55, 0x20000
  v_bfe_u32 v22, v0, 1, 3
  v_lshlrev_b32 v23, 10, v22
  v_lshrrev_b32 v22, 5, v0
  v_lshl_add_u32 v23, v22, 6, v23
  v_bfe_u32 v22, v0, 4, 1
  v_lshl_add_u32 v23, v22, 4, v23
  v_and_b32 v22, 1, v0
  v_lshl_add_u32 v23, v22, 3, v23
  s_lshl_b32 s68, s44, 8
  buffer_load_dwordx2 v[92:93], v23, s[52:55], s68 offen
  buffer_load_dwordx2 v[94:95], v23, s[52:55], s68 offen offset:32
  buffer_load_dwordx2 v[96:97], v23, s[52:55], s68 offen offset:128
  buffer_load_dwordx2 v[98:99], v23, s[52:55], s68 offen offset:160
  v_lshrrev_b32 v22, 5, v0
  v_lshlrev_b32 v46, 12, v22
  v_bfe_u32 v22, v0, 3, 1
  v_lshl_add_u32 v46, v22, 11, v46
  v_lshlrev_b32 v24, 2, v22
  v_bfe_u32 v22, v0, 4, 1
  v_lshl_add_u32 v46, v22, 10, v46
  v_lshl_add_u32 v24, v22, 1, v24
  v_bfe_u32 v22, v0, 2, 1
  v_lshl_add_u32 v46, v22, 8, v46
  v_add_u32 v24, v24, v22
  s_lshl_b32 s68, s44, 1
  v_xor_b32 v24, s68, v24
  v_lshl_add_u32 v46, v24, 5, v46
  v_and_b32 v22, 3, v0
  v_lshl_add_u32 v46, v22, 3, v46
  v_xor_b32 v47, 32, v46
  v_bfe_u32 v22, v0, 3, 1
  v_mul_u32_u24 v22, 2208, v22
  v_xor_b32 v50, v22, v46
  v_xor_b32 v51, 2176, v50
  s_mov_b32 s52, s38
  s_and_b32 s53, s39, 0xffff
  s_mov_b32 s54, 0x100
  s_mov_b32 s55, 0x20000
  s_add_u32 m0, s56, 32768
  s_mov_b32 s68, 256
  buffer_load_dwordx4 v45, s[48:51], s68 offen  lds
  s_add_u32 m0, s56, 36864
  s_mov_b32 s68, 4352
  buffer_load_dwordx4 v45, s[48:51], s68 offen  lds
  s_add_u32 m0, s56, 40960
  s_mov_b32 s68, 8448
  buffer_load_dwordx4 v45, s[48:51], s68 offen  lds
  s_add_u32 m0, s56, 45056
  s_mov_b32 s68, 12544
  buffer_load_dwordx4 v45, s[48:51], s68 offen  lds
  s_waitcnt vmcnt(8)
  s_barrier
  s_add_u32 m0, s56, 49152
  s_mov_b32 s68, 65792
  buffer_load_dwordx4 v45, s[48:51], s68 offen  lds
  s_add_u32 m0, s56, 53248
  s_mov_b32 s68, 69888
  buffer_load_dwordx4 v45, s[48:51], s68 offen  lds
  s_add_u32 m0, s56, 57344
  s_mov_b32 s68, 73984
  buffer_load_dwordx4 v45, s[48:51], s68 offen  lds
  s_add_u32 m0, s56, 61440
  s_mov_b32 s68, 78080
  buffer_load_dwordx4 v45, s[48:51], s68 offen  lds
  v_add_u32 v48, 0, v50
  v_add_u32 v49, 0, v51
  s_cmp_lg_u32 s44, 0
  s_cbranch_scc1 L_wr_0_1
  ds_read_b64_tr_b16 v[128:129], v48 offset:0
  ds_read_b64_tr_b16 v[130:131], v48 offset:512
  ds_read_b64_tr_b16 v[132:133], v48 offset:8192
  ds_read_b64_tr_b16 v[134:135], v48 offset:8704
  ds_read_b64_tr_b16 v[136:137], v49 offset:0
  ds_read_b64_tr_b16 v[138:139], v49 offset:512
  ds_read_b64_tr_b16 v[140:141], v49 offset:8192
  ds_read_b64_tr_b16 v[142:143], v49 offset:8704
  s_branch L_wr_0_e
L_wr_0_1:
  s_cmp_lg_u32 s44, 1
  s_cbranch_scc1 L_wr_0_2
  ds_read_b64_tr_b16 v[136:137], v48 offset:0
  ds_read_b64_tr_b16 v[138:139], v48 offset:512
  ds_read_b64_tr_b16 v[140:141], v48 offset:8192
  ds_read_b64_tr_b16 v[142:143], v48 offset:8704
  ds_read_b64_tr_b16 v[128:129], v49 offset:0
  ds_read_b64_tr_b16 v[130:131], v49 offset:512
  ds_read_b64_tr_b16 v[132:133], v49 offset:8192
  ds_read_b64_tr_b16 v[134:135], v49 offset:8704
  s_branch L_wr_0_e
L_wr_0_2:
  s_cmp_lg_u32 s44, 2
  s_cbranch_scc1 L_wr_0_3
  ds_read_b64_tr_b16 v[144:145], v48 offset:0
  ds_read_b64_tr_b16 v[146:147], v48 offset:512
  ds_read_b64_tr_b16 v[148:149], v48 offset:8192
  ds_read_b64_tr_b16 v[150:151], v48 offset:8704
  ds_read_b64_tr_b16 v[152:153], v49 offset:0
  ds_read_b64_tr_b16 v[154:155], v49 offset:512
  ds_read_b64_tr_b16 v[156:157], v49 offset:8192
  ds_read_b64_tr_b16 v[158:159], v49 offset:8704
  s_branch L_wr_0_e
L_wr_0_3:
  ds_read_b64_tr_b16 v[152:153], v48 offset:0
  ds_read_b64_tr_b16 v[154:155], v48 offset:512
  ds_read_b64_tr_b16 v[156:157], v48 offset:8192
  ds_read_b64_tr_b16 v[158:159], v48 offset:8704
  ds_read_b64_tr_b16 v[144:145], v49 offset:0
  ds_read_b64_tr_b16 v[146:147], v49 offset:512
  ds_read_b64_tr_b16 v[148:149], v49 offset:8192
  ds_read_b64_tr_b16 v[150:151], v49 offset:8704
L_wr_0_e:
  s_waitcnt lgkmcnt(0)
  s_waitcnt vmcnt(8)
  s_barrier
  s_add_u32 m0, s56, 65536
  s_mov_b32 s68, 512
  buffer_load_dwordx4 v45, s[48:51], s68 offen  lds
  s_add_u32 m0, s56, 69632
  s_mov_b32 s68, 4608
  buffer_load_dwordx4 v45, s[48:51], s68 offen  lds
  s_add_u32 m0, s56, 73728
  s_mov_b32 s68, 8704
  buffer_load_dwordx4 v45, s[48:51], s68 offen  lds
  s_add_u32 m0, s56, 77824
  s_mov_b32 s68, 12800
  buffer_load_dwordx4 v45, s[48:51], s68 offen  lds
  v_add_u32 v48, 16384, v50
  v_add_u32 v49, 16384, v51
  s_cmp_lg_u32 s44, 0
  s_cbranch_scc1 L_wr_1_1
  ds_read_b64_tr_b16 v[144:145], v48 offset:0
  ds_read_b64_tr_b16 v[146:147], v48 offset:512
  ds_read_b64_tr_b16 v[148:149], v48 offset:8192
  ds_read_b64_tr_b16 v[150:151], v48 offset:8704
  ds_read_b64_tr_b16 v[152:153], v49 offset:0
  ds_read_b64_tr_b16 v[154:155], v49 offset:512
  ds_read_b64_tr_b16 v[156:157], v49 offset:8192
  ds_read_b64_tr_b16 v[158:159], v49 offset:8704
  s_branch L_wr_1_e
L_wr_1_1:
  s_cmp_lg_u32 s44, 1
  s_cbranch_scc1 L_wr_1_2
  ds_read_b64_tr_b16 v[152:153], v48 offset:0
  ds_read_b64_tr_b16 v[154:155], v48 offset:512
  ds_read_b64_tr_b16 v[156:157], v48 offset:8192
  ds_read_b64_tr_b16 v[158:159], v48 offset:8704
  ds_read_b64_tr_b16 v[144:145], v49 offset:0
  ds_read_b64_tr_b16 v[146:147], v49 offset:512
  ds_read_b64_tr_b16 v[148:149], v49 offset:8192
  ds_read_b64_tr_b16 v[150:151], v49 offset:8704
  s_branch L_wr_1_e
L_wr_1_2:
  s_cmp_lg_u32 s44, 2
  s_cbranch_scc1 L_wr_1_3
  ds_read_b64_tr_b16 v[128:129], v48 offset:0
  ds_read_b64_tr_b16 v[130:131], v48 offset:512
  ds_read_b64_tr_b16 v[132:133], v48 offset:8192
  ds_read_b64_tr_b16 v[134:135], v48 offset:8704
  ds_read_b64_tr_b16 v[136:137], v49 offset:0
  ds_read_b64_tr_b16 v[138:139], v49 offset:512
  ds_read_b64_tr_b16 v[140:141], v49 offset:8192
  ds_read_b64_tr_b16 v[142:143], v49 offset:8704
  s_branch L_wr_1_e
L_wr_1_3:
  ds_read_b64_tr_b16 v[136:137], v48 offset:0
  ds_read_b64_tr_b16 v[138:139], v48 offset:512
  ds_read_b64_tr_b16 v[140:141], v48 offset:8192
  ds_read_b64_tr_b16 v[142:143], v48 offset:8704
  ds_read_b64_tr_b16 v[128:129], v49 offset:0
  ds_read_b64_tr_b16 v[130:131], v49 offset:512
  ds_read_b64_tr_b16 v[132:133], v49 offset:8192
  ds_read_b64_tr_b16 v[134:135], v49 offset:8704
L_wr_1_e:
  s_waitcnt lgkmcnt(0)
  s_waitcnt vmcnt(8)
  s_barrier
  s_lshl_b32 s68, s46, 3
  s_lshl_b64 s[4:5], 1, s68
  v_mov_b64 v[22:23], s[4:5]
  s_cmp_eq_u32 s44, 0
  s_cselect_b32 s69, 0, 0x40000000
  s_mov_b64 exec, 1
  buffer_atomic_add_x2 v[22:23], v17, s[52:55], s69 offen
  s_mov_b64 exec, -1
  s_add_u32 m0, s56, 81920
  s_mov_b32 s68, 66048
  buffer_load_dwordx4 v45, s[48:51], s68 offen  lds
  s_add_u32 m0, s56, 86016
  s_mov_b32 s68, 70144
  buffer_load_dwordx4 v45, s[48:51], s68 offen  lds
  s_add_u32 m0, s56, 90112
  s_mov_b32 s68, 74240
  buffer_load_dwordx4 v45, s[48:51], s68 offen  lds
  s_add_u32 m0, s56, 94208
  s_mov_b32 s68, 78336
  buffer_load_dwordx4 v45, s[48:51], s68 offen  lds
  v_add_u32 v48, 32768, v50
  v_add_u32 v49, 32768, v51
  s_cmp_lg_u32 s44, 0
  s_cbranch_scc1 L_wr_2_1
  ds_read_b64_tr_b16 v[160:161], v48 offset:0
  ds_read_b64_tr_b16 v[162:163], v48 offset:512
  ds_read_b64_tr_b16 v[164:165], v48 offset:8192
  ds_read_b64_tr_b16 v[166:167], v48 offset:8704
  ds_read_b64_tr_b16 v[168:169], v49 offset:0
  ds_read_b64_tr_b16 v[170:171], v49 offset:512
  ds_read_b64_tr_b16 v[172:173], v49 offset:8192
  ds_read_b64_tr_b16 v[174:175], v49 offset:8704
  s_branch L_wr_2_e
L_wr_2_1:
  s_cmp_lg_u32 s44, 1
  s_cbranch_scc1 L_wr_2_2
  ds_read_b64_tr_b16 v[168:169], v48 offset:0
  ds_read_b64_tr_b16 v[170:171], v48 offset:512
  ds_read_b64_tr_b16 v[172:173], v48 offset:8192
  ds_read_b64_tr_b16 v[174:175], v48 offset:8704
  ds_read_b64_tr_b16 v[160:161], v49 offset:0
  ds_read_b64_tr_b16 v[162:163], v49 offset:512
  ds_read_b64_tr_b16 v[164:165], v49 offset:8192
  ds_read_b64_tr_b16 v[166:167], v49 offset:8704
  s_branch L_wr_2_e
L_wr_2_2:
  s_cmp_lg_u32 s44, 2
  s_cbranch_scc1 L_wr_2_3
  ds_read_b64_tr_b16 v[176:177], v48 offset:0
  ds_read_b64_tr_b16 v[178:179], v48 offset:512
  ds_read_b64_tr_b16 v[180:181], v48 offset:8192
  ds_read_b64_tr_b16 v[182:183], v48 offset:8704
  ds_read_b64_tr_b16 v[184:185], v49 offset:0
  ds_read_b64_tr_b16 v[186:187], v49 offset:512
  ds_read_b64_tr_b16 v[188:189], v49 offset:8192
  ds_read_b64_tr_b16 v[190:191], v49 offset:8704
  s_branch L_wr_2_e
L_wr_2_3:
  ds_read_b64_tr_b16 v[184:185], v48 offset:0
  ds_read_b64_tr_b16 v[186:187], v48 offset:512
  ds_read_b64_tr_b16 v[188:189], v48 offset:8192
  ds_read_b64_tr_b16 v[190:191], v48 offset:8704
  ds_read_b64_tr_b16 v[176:177], v49 offset:0
  ds_read_b64_tr_b16 v[178:179], v49 offset:512
  ds_read_b64_tr_b16 v[180:181], v49 offset:8192
  ds_read_b64_tr_b16 v[182:183], v49 offset:8704
L_wr_2_e:
  s_waitcnt lgkmcnt(0)
  s_waitcnt vmcnt(8)
  s_barrier
  v_and_b32 v22, 1, v0
  v_cmp_eq_u32 vcc, 1, v22
  v_mov_b32 v23, 0x44444444
  v_mov_b32 v24, 0xeeeeeeee
  v_cndmask_b32 v1, v23, v24, vcc
  v_lshlrev_b32 v0, 4, v0
  v_add_u32 v0, 147456, v0
  s_mov_b32 s68, 0x05040100
  s_mov_b32 s69, 0x07060302
  v_perm_b32 v20, v94, v92, s68
  v_perm_b32 v21, v94, v92, s69
  v_perm_b32 v22, v95, v93, s68
  v_perm_b32 v23, v95, v93, s69
  v_min_u32 v20, -2, v20
  v_min_u32 v21, -2, v21
  v_min_u32 v22, -2, v22
  v_min_u32 v23, -2, v23
  v_perm_b32 v24, v98, v96, s68
  v_perm_b32 v25, v98, v96, s69
  v_perm_b32 v26, v99, v97, s68
  v_perm_b32 v27, v99, v97, s69
  v_min_u32 v24, -2, v24
  v_min_u32 v25, -2, v25
  v_min_u32 v26, -2, v26
  v_min_u32 v27, -2, v27
  s_add_u32 m0, s56, 98304
  s_mov_b32 s68, 768
  buffer_load_dwordx4 v45, s[48:51], s68 offen  lds
  s_add_u32 m0, s56, 102400
  s_mov_b32 s68, 4864
  buffer_load_dwordx4 v45, s[48:51], s68 offen  lds
  s_add_u32 m0, s56, 106496
  s_mov_b32 s68, 8960
  buffer_load_dwordx4 v45, s[48:51], s68 offen  lds
  s_add_u32 m0, s56, 110592
  s_mov_b32 s68, 13056
  buffer_load_dwordx4 v45, s[48:51], s68 offen  lds
  v_add_u32 v48, 49152, v50
  v_add_u32 v49, 49152, v51
  s_cmp_lg_u32 s44, 0
  s_cbranch_scc1 L_wr_3_1
  ds_read_b64_tr_b16 v[176:177], v48 offset:0
  ds_read_b64_tr_b16 v[178:179], v48 offset:512
  ds_read_b64_tr_b16 v[180:181], v48 offset:8192
  ds_read_b64_tr_b16 v[182:183], v48 offset:8704
  ds_read_b64_tr_b16 v[184:185], v49 offset:0
  ds_read_b64_tr_b16 v[186:187], v49 offset:512
  ds_read_b64_tr_b16 v[188:189], v49 offset:8192
  ds_read_b64_tr_b16 v[190:191], v49 offset:8704
  s_branch L_wr_3_e
L_wr_3_1:
  s_cmp_lg_u32 s44, 1
  s_cbranch_scc1 L_wr_3_2
  ds_read_b64_tr_b16 v[184:185], v48 offset:0
  ds_read_b64_tr_b16 v[186:187], v48 offset:512
  ds_read_b64_tr_b16 v[188:189], v48 offset:8192
  ds_read_b64_tr_b16 v[190:191], v48 offset:8704
  ds_read_b64_tr_b16 v[176:177], v49 offset:0
  ds_read_b64_tr_b16 v[178:179], v49 offset:512
  ds_read_b64_tr_b16 v[180:181], v49 offset:8192
  ds_read_b64_tr_b16 v[182:183], v49 offset:8704
  s_branch L_wr_3_e
L_wr_3_2:
  s_cmp_lg_u32 s44, 2
  s_cbranch_scc1 L_wr_3_3
  ds_read_b64_tr_b16 v[160:161], v48 offset:0
  ds_read_b64_tr_b16 v[162:163], v48 offset:512
  ds_read_b64_tr_b16 v[164:165], v48 offset:8192
  ds_read_b64_tr_b16 v[166:167], v48 offset:8704
  ds_read_b64_tr_b16 v[168:169], v49 offset:0
  ds_read_b64_tr_b16 v[170:171], v49 offset:512
  ds_read_b64_tr_b16 v[172:173], v49 offset:8192
  ds_read_b64_tr_b16 v[174:175], v49 offset:8704
  s_branch L_wr_3_e
L_wr_3_3:
  ds_read_b64_tr_b16 v[168:169], v48 offset:0
  ds_read_b64_tr_b16 v[170:171], v48 offset:512
  ds_read_b64_tr_b16 v[172:173], v48 offset:8192
  ds_read_b64_tr_b16 v[174:175], v48 offset:8704
  ds_read_b64_tr_b16 v[160:161], v49 offset:0
  ds_read_b64_tr_b16 v[162:163], v49 offset:512
  ds_read_b64_tr_b16 v[164:165], v49 offset:8192
  ds_read_b64_tr_b16 v[166:167], v49 offset:8704
L_wr_3_e:
  s_waitcnt lgkmcnt(0)
  s_waitcnt vmcnt(8)
  s_barrier
  s_add_u32 m0, s56, 114688
  s_mov_b32 s68, 66304
  buffer_load_dwordx4 v45, s[48:51], s68 offen  lds
  s_add_u32 m0, s56, 118784
  s_mov_b32 s68, 70400
  buffer_load_dwordx4 v45, s[48:51], s68 offen  lds
  s_add_u32 m0, s56, 122880
  s_mov_b32 s68, 74496
  buffer_load_dwordx4 v45, s[48:51], s68 offen  lds
  s_add_u32 m0, s56, 126976
  s_mov_b32 s68, 78592
  buffer_load_dwordx4 v45, s[48:51], s68 offen  lds
  v_add_u32 v48, 65536, v50
  v_add_u32 v49, 65536, v51
  s_cmp_lg_u32 s44, 0
  s_cbranch_scc1 L_wr_4_1
  ds_read_b64_tr_b16 v[192:193], v48 offset:0
  ds_read_b64_tr_b16 v[194:195], v48 offset:512
  ds_read_b64_tr_b16 v[196:197], v48 offset:8192
  ds_read_b64_tr_b16 v[198:199], v48 offset:8704
  ds_read_b64_tr_b16 v[200:201], v49 offset:0
  ds_read_b64_tr_b16 v[202:203], v49 offset:512
  ds_read_b64_tr_b16 v[204:205], v49 offset:8192
  ds_read_b64_tr_b16 v[206:207], v49 offset:8704
  s_branch L_wr_4_e
L_wr_4_1:
  s_cmp_lg_u32 s44, 1
  s_cbranch_scc1 L_wr_4_2
  ds_read_b64_tr_b16 v[200:201], v48 offset:0
  ds_read_b64_tr_b16 v[202:203], v48 offset:512
  ds_read_b64_tr_b16 v[204:205], v48 offset:8192
  ds_read_b64_tr_b16 v[206:207], v48 offset:8704
  ds_read_b64_tr_b16 v[192:193], v49 offset:0
  ds_read_b64_tr_b16 v[194:195], v49 offset:512
  ds_read_b64_tr_b16 v[196:197], v49 offset:8192
  ds_read_b64_tr_b16 v[198:199], v49 offset:8704
  s_branch L_wr_4_e
L_wr_4_2:
  s_cmp_lg_u32 s44, 2
  s_cbranch_scc1 L_wr_4_3
  ds_read_b64_tr_b16 v[208:209], v48 offset:0
  ds_read_b64_tr_b16 v[210:211], v48 offset:512
  ds_read_b64_tr_b16 v[212:213], v48 offset:8192
  ds_read_b64_tr_b16 v[214:215], v48 offset:8704
  ds_read_b64_tr_b16 v[216:217], v49 offset:0
  ds_read_b64_tr_b16 v[218:219], v49 offset:512
  ds_read_b64_tr_b16 v[220:221], v49 offset:8192
  ds_read_b64_tr_b16 v[222:223], v49 offset:8704
  s_branch L_wr_4_e
L_wr_4_3:
  ds_read_b64_tr_b16 v[216:217], v48 offset:0
  ds_read_b64_tr_b16 v[218:219], v48 offset:512
  ds_read_b64_tr_b16 v[220:221], v48 offset:8192
  ds_read_b64_tr_b16 v[222:223], v48 offset:8704
  ds_read_b64_tr_b16 v[208:209], v49 offset:0
  ds_read_b64_tr_b16 v[210:211], v49 offset:512
  ds_read_b64_tr_b16 v[212:213], v49 offset:8192
  ds_read_b64_tr_b16 v[214:215], v49 offset:8704
L_wr_4_e:
  s_waitcnt lgkmcnt(0)
  s_waitcnt vmcnt(8)
  s_barrier
  s_mov_b32 s48, s24
  s_and_b32 s49, s25, 0xffff
  s_add_u32 m0, s56, 0
  s_mov_b32 s68, 0
  buffer_load_dwordx4 v44, s[48:51], s68 offen  lds
  s_add_u32 m0, s56, 4096
  s_mov_b32 s68, 65536
  buffer_load_dwordx4 v44, s[48:51], s68 offen  lds
  s_add_u32 m0, s56, 8192
  s_mov_b32 s68, 262144
  buffer_load_dwordx4 v44, s[48:51], s68 offen  lds
  s_add_u32 m0, s56, 12288
  s_mov_b32 s68, 327680
  buffer_load_dwordx4 v44, s[48:51], s68 offen  lds
  v_add_u32 v48, 81920, v50
  v_add_u32 v49, 81920, v51
  s_cmp_lg_u32 s44, 0
  s_cbranch_scc1 L_wr_5_1
  ds_read_b64_tr_b16 v[208:209], v48 offset:0
  ds_read_b64_tr_b16 v[210:211], v48 offset:512
  ds_read_b64_tr_b16 v[212:213], v48 offset:8192
  ds_read_b64_tr_b16 v[214:215], v48 offset:8704
  ds_read_b64_tr_b16 v[216:217], v49 offset:0
  ds_read_b64_tr_b16 v[218:219], v49 offset:512
  ds_read_b64_tr_b16 v[220:221], v49 offset:8192
  ds_read_b64_tr_b16 v[222:223], v49 offset:8704
  s_branch L_wr_5_e
L_wr_5_1:
  s_cmp_lg_u32 s44, 1
  s_cbranch_scc1 L_wr_5_2
  ds_read_b64_tr_b16 v[216:217], v48 offset:0
  ds_read_b64_tr_b16 v[218:219], v48 offset:512
  ds_read_b64_tr_b16 v[220:221], v48 offset:8192
  ds_read_b64_tr_b16 v[222:223], v48 offset:8704
  ds_read_b64_tr_b16 v[208:209], v49 offset:0
  ds_read_b64_tr_b16 v[210:211], v49 offset:512
  ds_read_b64_tr_b16 v[212:213], v49 offset:8192
  ds_read_b64_tr_b16 v[214:215], v49 offset:8704
  s_branch L_wr_5_e
L_wr_5_2:
  s_cmp_lg_u32 s44, 2
  s_cbranch_scc1 L_wr_5_3
  ds_read_b64_tr_b16 v[192:193], v48 offset:0
  ds_read_b64_tr_b16 v[194:195], v48 offset:512
  ds_read_b64_tr_b16 v[196:197], v48 offset:8192
  ds_read_b64_tr_b16 v[198:199], v48 offset:8704
  ds_read_b64_tr_b16 v[200:201], v49 offset:0
  ds_read_b64_tr_b16 v[202:203], v49 offset:512
  ds_read_b64_tr_b16 v[204:205], v49 offset:8192
  ds_read_b64_tr_b16 v[206:207], v49 offset:8704
  s_branch L_wr_5_e
L_wr_5_3:
  ds_read_b64_tr_b16 v[200:201], v48 offset:0
  ds_read_b64_tr_b16 v[202:203], v48 offset:512
  ds_read_b64_tr_b16 v[204:205], v48 offset:8192
  ds_read_b64_tr_b16 v[206:207], v48 offset:8704
  ds_read_b64_tr_b16 v[192:193], v49 offset:0
  ds_read_b64_tr_b16 v[194:195], v49 offset:512
  ds_read_b64_tr_b16 v[196:197], v49 offset:8192
  ds_read_b64_tr_b16 v[198:199], v49 offset:8704
L_wr_5_e:
  s_waitcnt lgkmcnt(0)
  s_waitcnt vmcnt(8)
  s_barrier
  s_add_u32 m0, s56, 16384
  s_mov_b32 s68, 524288
  buffer_load_dwordx4 v44, s[48:51], s68 offen  lds
  s_add_u32 m0, s56, 20480
  s_mov_b32 s68, 589824
  buffer_load_dwordx4 v44, s[48:51], s68 offen  lds
  s_add_u32 m0, s56, 24576
  s_mov_b32 s68, 786432
  buffer_load_dwordx4 v44, s[48:51], s68 offen  lds
  s_add_u32 m0, s56, 28672
  s_mov_b32 s68, 851968
  buffer_load_dwordx4 v44, s[48:51], s68 offen  lds
  v_add_u32 v48, 98304, v50
  v_add_u32 v49, 98304, v51
  s_cmp_lg_u32 s44, 0
  s_cbranch_scc1 L_wr_6_1
  ds_read_b64_tr_b16 v[224:225], v48 offset:0
  ds_read_b64_tr_b16 v[226:227], v48 offset:512
  ds_read_b64_tr_b16 v[228:229], v48 offset:8192
  ds_read_b64_tr_b16 v[230:231], v48 offset:8704
  ds_read_b64_tr_b16 v[232:233], v49 offset:0
  ds_read_b64_tr_b16 v[234:235], v49 offset:512
  ds_read_b64_tr_b16 v[236:237], v49 offset:8192
  ds_read_b64_tr_b16 v[238:239], v49 offset:8704
  s_branch L_wr_6_e
L_wr_6_1:
  s_cmp_lg_u32 s44, 1
  s_cbranch_scc1 L_wr_6_2
  ds_read_b64_tr_b16 v[232:233], v48 offset:0
  ds_read_b64_tr_b16 v[234:235], v48 offset:512
  ds_read_b64_tr_b16 v[236:237], v48 offset:8192
  ds_read_b64_tr_b16 v[238:239], v48 offset:8704
  ds_read_b64_tr_b16 v[224:225], v49 offset:0
  ds_read_b64_tr_b16 v[226:227], v49 offset:512
  ds_read_b64_tr_b16 v[228:229], v49 offset:8192
  ds_read_b64_tr_b16 v[230:231], v49 offset:8704
  s_branch L_wr_6_e
L_wr_6_2:
  s_cmp_lg_u32 s44, 2
  s_cbranch_scc1 L_wr_6_3
  ds_read_b64_tr_b16 v[240:241], v48 offset:0
  ds_read_b64_tr_b16 v[242:243], v48 offset:512
  ds_read_b64_tr_b16 v[244:245], v48 offset:8192
  ds_read_b64_tr_b16 v[246:247], v48 offset:8704
  ds_read_b64_tr_b16 v[248:249], v49 offset:0
  ds_read_b64_tr_b16 v[250:251], v49 offset:512
  ds_read_b64_tr_b16 v[252:253], v49 offset:8192
  ds_read_b64_tr_b16 v[254:255], v49 offset:8704
  s_branch L_wr_6_e
L_wr_6_3:
  ds_read_b64_tr_b16 v[248:249], v48 offset:0
  ds_read_b64_tr_b16 v[250:251], v48 offset:512
  ds_read_b64_tr_b16 v[252:253], v48 offset:8192
  ds_read_b64_tr_b16 v[254:255], v48 offset:8704
  ds_read_b64_tr_b16 v[240:241], v49 offset:0
  ds_read_b64_tr_b16 v[242:243], v49 offset:512
  ds_read_b64_tr_b16 v[244:245], v49 offset:8192
  ds_read_b64_tr_b16 v[246:247], v49 offset:8704
L_wr_6_e:
  s_waitcnt lgkmcnt(0)
  s_waitcnt vmcnt(8)
  s_barrier
  s_add_u32 m0, s56, 32768
  s_mov_b32 s68, 1048576
  buffer_load_dwordx4 v44, s[48:51], s68 offen  lds
  s_add_u32 m0, s56, 36864
  s_mov_b32 s68, 1114112
  buffer_load_dwordx4 v44, s[48:51], s68 offen  lds
  s_add_u32 m0, s56, 40960
  s_mov_b32 s68, 1310720
  buffer_load_dwordx4 v44, s[48:51], s68 offen  lds
  s_add_u32 m0, s56, 45056
  s_mov_b32 s68, 1376256
  buffer_load_dwordx4 v44, s[48:51], s68 offen  lds
  v_add_u32 v48, 114688, v50
  v_add_u32 v49, 114688, v51
  s_cmp_lg_u32 s44, 0
  s_cbranch_scc1 L_wr_7_1
  ds_read_b64_tr_b16 v[240:241], v48 offset:0
  ds_read_b64_tr_b16 v[242:243], v48 offset:512
  ds_read_b64_tr_b16 v[244:245], v48 offset:8192
  ds_read_b64_tr_b16 v[246:247], v48 offset:8704
  ds_read_b64_tr_b16 v[248:249], v49 offset:0
  ds_read_b64_tr_b16 v[250:251], v49 offset:512
  ds_read_b64_tr_b16 v[252:253], v49 offset:8192
  ds_read_b64_tr_b16 v[254:255], v49 offset:8704
  s_branch L_wr_7_e
L_wr_7_1:
  s_cmp_lg_u32 s44, 1
  s_cbranch_scc1 L_wr_7_2
  ds_read_b64_tr_b16 v[248:249], v48 offset:0
  ds_read_b64_tr_b16 v[250:251], v48 offset:512
  ds_read_b64_tr_b16 v[252:253], v48 offset:8192
  ds_read_b64_tr_b16 v[254:255], v48 offset:8704
  ds_read_b64_tr_b16 v[240:241], v49 offset:0
  ds_read_b64_tr_b16 v[242:243], v49 offset:512
  ds_read_b64_tr_b16 v[244:245], v49 offset:8192
  ds_read_b64_tr_b16 v[246:247], v49 offset:8704
  s_branch L_wr_7_e
L_wr_7_2:
  s_cmp_lg_u32 s44, 2
  s_cbranch_scc1 L_wr_7_3
  ds_read_b64_tr_b16 v[224:225], v48 offset:0
  ds_read_b64_tr_b16 v[226:227], v48 offset:512
  ds_read_b64_tr_b16 v[228:229], v48 offset:8192
  ds_read_b64_tr_b16 v[230:231], v48 offset:8704
  ds_read_b64_tr_b16 v[232:233], v49 offset:0
  ds_read_b64_tr_b16 v[234:235], v49 offset:512
  ds_read_b64_tr_b16 v[236:237], v49 offset:8192
  ds_read_b64_tr_b16 v[238:239], v49 offset:8704
  s_branch L_wr_7_e
L_wr_7_3:
  ds_read_b64_tr_b16 v[232:233], v48 offset:0
  ds_read_b64_tr_b16 v[234:235], v48 offset:512
  ds_read_b64_tr_b16 v[236:237], v48 offset:8192
  ds_read_b64_tr_b16 v[238:239], v48 offset:8704
  ds_read_b64_tr_b16 v[224:225], v49 offset:0
  ds_read_b64_tr_b16 v[226:227], v49 offset:512
  ds_read_b64_tr_b16 v[228:229], v49 offset:8192
  ds_read_b64_tr_b16 v[230:231], v49 offset:8704
L_wr_7_e:
  s_waitcnt lgkmcnt(0)
  s_waitcnt vmcnt(8)
  s_barrier
  s_add_u32 m0, s56, 49152
  s_mov_b32 s68, 1572864
  buffer_load_dwordx4 v44, s[48:51], s68 offen  lds
  s_add_u32 m0, s56, 53248
  s_mov_b32 s68, 1638400
  buffer_load_dwordx4 v44, s[48:51], s68 offen  lds
  s_add_u32 m0, s56, 57344
  s_mov_b32 s68, 1835008
  buffer_load_dwordx4 v44, s[48:51], s68 offen  lds
  s_add_u32 m0, s56, 61440
  s_mov_b32 s68, 1900544
  buffer_load_dwordx4 v44, s[48:51], s68 offen  lds
  v_add_u32 v48, 0, v46
  v_add_u32 v49, 0, v47
  s_cmp_lg_u32 s44, 0
  s_cbranch_scc1 L_wr_8_1
  ds_read_b64_tr_b16 a[0:1], v48 offset:0
  ds_read_b64_tr_b16 a[2:3], v48 offset:512
  ds_read_b64_tr_b16 a[4:5], v48 offset:8192
  ds_read_b64_tr_b16 a[6:7], v48 offset:8704
  ds_read_b64_tr_b16 a[64:65], v49 offset:0
  ds_read_b64_tr_b16 a[66:67], v49 offset:512
  ds_read_b64_tr_b16 a[68:69], v49 offset:8192
  ds_read_b64_tr_b16 a[70:71], v49 offset:8704
  s_branch L_wr_8_e
L_wr_8_1:
  s_cmp_lg_u32 s44, 1
  s_cbranch_scc1 L_wr_8_2
  ds_read_b64_tr_b16 a[16:17], v48 offset:0
  ds_read_b64_tr_b16 a[18:19], v48 offset:512
  ds_read_b64_tr_b16 a[20:21], v48 offset:8192
  ds_read_b64_tr_b16 a[22:23], v48 offset:8704
  ds_read_b64_tr_b16 a[80:81], v49 offset:0
  ds_read_b64_tr_b16 a[82:83], v49 offset:512
  ds_read_b64_tr_b16 a[84:85], v49 offset:8192
  ds_read_b64_tr_b16 a[86:87], v49 offset:8704
  s_branch L_wr_8_e
L_wr_8_2:
  s_cmp_lg_u32 s44, 2
  s_cbranch_scc1 L_wr_8_3
  ds_read_b64_tr_b16 a[32:33], v48 offset:0
  ds_read_b64_tr_b16 a[34:35], v48 offset:512
  ds_read_b64_tr_b16 a[36:37], v48 offset:8192
  ds_read_b64_tr_b16 a[38:39], v48 offset:8704
  ds_read_b64_tr_b16 a[96:97], v49 offset:0
  ds_read_b64_tr_b16 a[98:99], v49 offset:512
  ds_read_b64_tr_b16 a[100:101], v49 offset:8192
  ds_read_b64_tr_b16 a[102:103], v49 offset:8704
  s_branch L_wr_8_e
L_wr_8_3:
  ds_read_b64_tr_b16 a[48:49], v48 offset:0
  ds_read_b64_tr_b16 a[50:51], v48 offset:512
  ds_read_b64_tr_b16 a[52:53], v48 offset:8192
  ds_read_b64_tr_b16 a[54:55], v48 offset:8704
  ds_read_b64_tr_b16 a[112:113], v49 offset:0
  ds_read_b64_tr_b16 a[114:115], v49 offset:512
  ds_read_b64_tr_b16 a[116:117], v49 offset:8192
  ds_read_b64_tr_b16 a[118:119], v49 offset:8704
L_wr_8_e:
  s_waitcnt lgkmcnt(0)
  s_waitcnt vmcnt(8)
  s_barrier
  s_add_u32 m0, s56, 65536
  s_mov_b32 s68, 2097152
  buffer_load_dwordx4 v44, s[48:51], s68 offen  lds
  s_add_u32 m0, s56, 69632
  s_mov_b32 s68, 2162688
  buffer_load_dwordx4 v44, s[48:51], s68 offen  lds
  s_add_u32 m0, s56, 73728
  s_mov_b32 s68, 2359296
  buffer_load_dwordx4 v44, s[48:51], s68 offen  lds
  s_add_u32 m0, s56, 77824
  s_mov_b32 s68, 2424832
  buffer_load_dwordx4 v44, s[48:51], s68 offen  lds
  v_add_u32 v48, 16384, v46
  v_add_u32 v49, 16384, v47
  s_cmp_lg_u32 s44, 0
  s_cbranch_scc1 L_wr_9_1
  ds_read_b64_tr_b16 a[8:9], v48 offset:0
  ds_read_b64_tr_b16 a[10:11], v48 offset:512
  ds_read_b64_tr_b16 a[12:13], v48 offset:8192
  ds_read_b64_tr_b16 a[14:15], v48 offset:8704
  ds_read_b64_tr_b16 a[72:73], v49 offset:0
  ds_read_b64_tr_b16 a[74:75], v49 offset:512
  ds_read_b64_tr_b16 a[76:77], v49 offset:8192
  ds_read_b64_tr_b16 a[78:79], v49 offset:8704
  s_branch L_wr_9_e
L_wr_9_1:
  s_cmp_lg_u32 s44, 1
  s_cbranch_scc1 L_wr_9_2
  ds_read_b64_tr_b16 a[24:25], v48 offset:0
  ds_read_b64_tr_b16 a[26:27], v48 offset:512
  ds_read_b64_tr_b16 a[28:29], v48 offset:8192
  ds_read_b64_tr_b16 a[30:31], v48 offset:8704
  ds_read_b64_tr_b16 a[88:89], v49 offset:0
  ds_read_b64_tr_b16 a[90:91], v49 offset:512
  ds_read_b64_tr_b16 a[92:93], v49 offset:8192
  ds_read_b64_tr_b16 a[94:95], v49 offset:8704
  s_branch L_wr_9_e
L_wr_9_2:
  s_cmp_lg_u32 s44, 2
  s_cbranch_scc1 L_wr_9_3
  ds_read_b64_tr_b16 a[40:41], v48 offset:0
  ds_read_b64_tr_b16 a[42:43], v48 offset:512
  ds_read_b64_tr_b16 a[44:45], v48 offset:8192
  ds_read_b64_tr_b16 a[46:47], v48 offset:8704
  ds_read_b64_tr_b16 a[104:105], v49 offset:0
  ds_read_b64_tr_b16 a[106:107], v49 offset:512
  ds_read_b64_tr_b16 a[108:109], v49 offset:8192
  ds_read_b64_tr_b16 a[110:111], v49 offset:8704
  s_branch L_wr_9_e
L_wr_9_3:
  ds_read_b64_tr_b16 a[56:57], v48 offset:0
  ds_read_b64_tr_b16 a[58:59], v48 offset:512
  ds_read_b64_tr_b16 a[60:61], v48 offset:8192
  ds_read_b64_tr_b16 a[62:63], v48 offset:8704
  ds_read_b64_tr_b16 a[120:121], v49 offset:0
  ds_read_b64_tr_b16 a[122:123], v49 offset:512
  ds_read_b64_tr_b16 a[124:125], v49 offset:8192
  ds_read_b64_tr_b16 a[126:127], v49 offset:8704
L_wr_9_e:
  s_waitcnt lgkmcnt(0)
  s_waitcnt vmcnt(8)
  s_barrier
  s_add_u32 m0, s56, 81920
  s_mov_b32 s68, 2621440
  buffer_load_dwordx4 v44, s[48:51], s68 offen  lds
  s_add_u32 m0, s56, 86016
  s_mov_b32 s68, 2686976
  buffer_load_dwordx4 v44, s[48:51], s68 offen  lds
  s_add_u32 m0, s56, 90112
  s_mov_b32 s68, 2883584
  buffer_load_dwordx4 v44, s[48:51], s68 offen  lds
  s_add_u32 m0, s56, 94208
  s_mov_b32 s68, 2949120
  buffer_load_dwordx4 v44, s[48:51], s68 offen  lds
  v_add_u32 v48, 32768, v46
  v_add_u32 v49, 32768, v47
  s_cmp_lg_u32 s44, 0
  s_cbranch_scc1 L_wr_10_1
  ds_read_b64_tr_b16 a[16:17], v48 offset:0
  ds_read_b64_tr_b16 a[18:19], v48 offset:512
  ds_read_b64_tr_b16 a[20:21], v48 offset:8192
  ds_read_b64_tr_b16 a[22:23], v48 offset:8704
  ds_read_b64_tr_b16 a[80:81], v49 offset:0
  ds_read_b64_tr_b16 a[82:83], v49 offset:512
  ds_read_b64_tr_b16 a[84:85], v49 offset:8192
  ds_read_b64_tr_b16 a[86:87], v49 offset:8704
  s_branch L_wr_10_e
L_wr_10_1:
  s_cmp_lg_u32 s44, 1
  s_cbranch_scc1 L_wr_10_2
  ds_read_b64_tr_b16 a[0:1], v48 offset:0
  ds_read_b64_tr_b16 a[2:3], v48 offset:512
  ds_read_b64_tr_b16 a[4:5], v48 offset:8192
  ds_read_b64_tr_b16 a[6:7], v48 offset:8704
  ds_read_b64_tr_b16 a[64:65], v49 offset:0
  ds_read_b64_tr_b16 a[66:67], v49 offset:512
  ds_read_b64_tr_b16 a[68:69], v49 offset:8192
  ds_read_b64_tr_b16 a[70:71], v49 offset:8704
  s_branch L_wr_10_e
L_wr_10_2:
  s_cmp_lg_u32 s44, 2
  s_cbranch_scc1 L_wr_10_3
  ds_read_b64_tr_b16 a[48:49], v48 offset:0
  ds_read_b64_tr_b16 a[50:51], v48 offset:512
  ds_read_b64_tr_b16 a[52:53], v48 offset:8192
  ds_read_b64_tr_b16 a[54:55], v48 offset:8704
  ds_read_b64_tr_b16 a[112:113], v49 offset:0
  ds_read_b64_tr_b16 a[114:115], v49 offset:512
  ds_read_b64_tr_b16 a[116:117], v49 offset:8192
  ds_read_b64_tr_b16 a[118:119], v49 offset:8704
  s_branch L_wr_10_e
L_wr_10_3:
  ds_read_b64_tr_b16 a[32:33], v48 offset:0
  ds_read_b64_tr_b16 a[34:35], v48 offset:512
  ds_read_b64_tr_b16 a[36:37], v48 offset:8192
  ds_read_b64_tr_b16 a[38:39], v48 offset:8704
  ds_read_b64_tr_b16 a[96:97], v49 offset:0
  ds_read_b64_tr_b16 a[98:99], v49 offset:512
  ds_read_b64_tr_b16 a[100:101], v49 offset:8192
  ds_read_b64_tr_b16 a[102:103], v49 offset:8704
L_wr_10_e:
  s_waitcnt lgkmcnt(0)
  s_waitcnt vmcnt(8)
  s_barrier
  s_add_u32 m0, s56, 98304
  s_mov_b32 s68, 3145728
  buffer_load_dwordx4 v44, s[48:51], s68 offen  lds
  s_add_u32 m0, s56, 102400
  s_mov_b32 s68, 3211264
  buffer_load_dwordx4 v44, s[48:51], s68 offen  lds
  s_add_u32 m0, s56, 106496
  s_mov_b32 s68, 3407872
  buffer_load_dwordx4 v44, s[48:51], s68 offen  lds
  s_add_u32 m0, s56, 110592
  s_mov_b32 s68, 3473408
  buffer_load_dwordx4 v44, s[48:51], s68 offen  lds
  v_add_u32 v48, 49152, v46
  v_add_u32 v49, 49152, v47
  s_cmp_lg_u32 s44, 0
  s_cbranch_scc1 L_wr_11_1
  ds_read_b64_tr_b16 a[24:25], v48 offset:0
  ds_read_b64_tr_b16 a[26:27], v48 offset:512
  ds_read_b64_tr_b16 a[28:29], v48 offset:8192
  ds_read_b64_tr_b16 a[30:31], v48 offset:8704
  ds_read_b64_tr_b16 a[88:89], v49 offset:0
  ds_read_b64_tr_b16 a[90:91], v49 offset:512
  ds_read_b64_tr_b16 a[92:93], v49 offset:8192
  ds_read_b64_tr_b16 a[94:95], v49 offset:8704
  s_branch L_wr_11_e
L_wr_11_1:
  s_cmp_lg_u32 s44, 1
  s_cbranch_scc1 L_wr_11_2
  ds_read_b64_tr_b16 a[8:9], v48 offset:0
  ds_read_b64_tr_b16 a[10:11], v48 offset:512
  ds_read_b64_tr_b16 a[12:13], v48 offset:8192
  ds_read_b64_tr_b16 a[14:15], v48 offset:8704
  ds_read_b64_tr_b16 a[72:73], v49 offset:0
  ds_read_b64_tr_b16 a[74:75], v49 offset:512
  ds_read_b64_tr_b16 a[76:77], v49 offset:8192
  ds_read_b64_tr_b16 a[78:79], v49 offset:8704
  s_branch L_wr_11_e
L_wr_11_2:
  s_cmp_lg_u32 s44, 2
  s_cbranch_scc1 L_wr_11_3
  ds_read_b64_tr_b16 a[56:57], v48 offset:0
  ds_read_b64_tr_b16 a[58:59], v48 offset:512
  ds_read_b64_tr_b16 a[60:61], v48 offset:8192
  ds_read_b64_tr_b16 a[62:63], v48 offset:8704
  ds_read_b64_tr_b16 a[120:121], v49 offset:0
  ds_read_b64_tr_b16 a[122:123], v49 offset:512
  ds_read_b64_tr_b16 a[124:125], v49 offset:8192
  ds_read_b64_tr_b16 a[126:127], v49 offset:8704
  s_branch L_wr_11_e
L_wr_11_3:
  ds_read_b64_tr_b16 a[40:41], v48 offset:0
  ds_read_b64_tr_b16 a[42:43], v48 offset:512
  ds_read_b64_tr_b16 a[44:45], v48 offset:8192
  ds_read_b64_tr_b16 a[46:47], v48 offset:8704
  ds_read_b64_tr_b16 a[104:105], v49 offset:0
  ds_read_b64_tr_b16 a[106:107], v49 offset:512
  ds_read_b64_tr_b16 a[108:109], v49 offset:8192
  ds_read_b64_tr_b16 a[110:111], v49 offset:8704
L_wr_11_e:
  s_waitcnt lgkmcnt(0)
  s_waitcnt vmcnt(8)
  s_barrier
  s_add_u32 m0, s56, 114688
  s_mov_b32 s68, 3670016
  buffer_load_dwordx4 v44, s[48:51], s68 offen  lds
  s_add_u32 m0, s56, 118784
  s_mov_b32 s68, 3735552
  buffer_load_dwordx4 v44, s[48:51], s68 offen  lds
  s_add_u32 m0, s56, 122880
  s_mov_b32 s68, 3932160
  buffer_load_dwordx4 v44, s[48:51], s68 offen  lds
  s_add_u32 m0, s56, 126976
  s_mov_b32 s68, 3997696
  buffer_load_dwordx4 v44, s[48:51], s68 offen  lds
  v_add_u32 v48, 65536, v46
  v_add_u32 v49, 65536, v47
  s_cmp_lg_u32 s44, 0
  s_cbranch_scc1 L_wr_12_1
  ds_read_b64_tr_b16 a[32:33], v48 offset:0
  ds_read_b64_tr_b16 a[34:35], v48 offset:512
  ds_read_b64_tr_b16 a[36:37], v48 offset:8192
  ds_read_b64_tr_b16 a[38:39], v48 offset:8704
  ds_read_b64_tr_b16 a[96:97], v49 offset:0
  ds_read_b64_tr_b16 a[98:99], v49 offset:512
  ds_read_b64_tr_b16 a[100:101], v49 offset:8192
  ds_read_b64_tr_b16 a[102:103], v49 offset:8704
  s_branch L_wr_12_e
L_wr_12_1:
  s_cmp_lg_u32 s44, 1
  s_cbranch_scc1 L_wr_12_2
  ds_read_b64_tr_b16 a[48:49], v48 offset:0
  ds_read_b64_tr_b16 a[50:51], v48 offset:512
  ds_read_b64_tr_b16 a[52:53], v48 offset:8192
  ds_read_b64_tr_b16 a[54:55], v48 offset:8704
  ds_read_b64_tr_b16 a[112:113], v49 offset:0
  ds_read_b64_tr_b16 a[114:115], v49 offset:512
  ds_read_b64_tr_b16 a[116:117], v49 offset:8192
  ds_read_b64_tr_b16 a[118:119], v49 offset:8704
  s_branch L_wr_12_e
L_wr_12_2:
  s_cmp_lg_u32 s44, 2
  s_cbranch_scc1 L_wr_12_3
  ds_read_b64_tr_b16 a[0:1], v48 offset:0
  ds_read_b64_tr_b16 a[2:3], v48 offset:512
  ds_read_b64_tr_b16 a[4:5], v48 offset:8192
  ds_read_b64_tr_b16 a[6:7], v48 offset:8704
  ds_read_b64_tr_b16 a[64:65], v49 offset:0
  ds_read_b64_tr_b16 a[66:67], v49 offset:512
  ds_read_b64_tr_b16 a[68:69], v49 offset:8192
  ds_read_b64_tr_b16 a[70:71], v49 offset:8704
  s_branch L_wr_12_e
L_wr_12_3:
  ds_read_b64_tr_b16 a[16:17], v48 offset:0
  ds_read_b64_tr_b16 a[18:19], v48 offset:512
  ds_read_b64_tr_b16 a[20:21], v48 offset:8192
  ds_read_b64_tr_b16 a[22:23], v48 offset:8704
  ds_read_b64_tr_b16 a[80:81], v49 offset:0
  ds_read_b64_tr_b16 a[82:83], v49 offset:512
  ds_read_b64_tr_b16 a[84:85], v49 offset:8192
  ds_read_b64_tr_b16 a[86:87], v49 offset:8704
L_wr_12_e:
  s_waitcnt lgkmcnt(0)
  s_waitcnt vmcnt(8)
  s_barrier
  s_mov_b32 s48, s26
  s_and_b32 s49, s27, 0xffff
  s_add_u32 m0, s56, 0
  s_mov_b32 s68, 0
  buffer_load_dwordx4 v44, s[48:51], s68 offen  lds
  s_add_u32 m0, s56, 4096
  s_mov_b32 s68, 65536
  buffer_load_dwordx4 v44, s[48:51], s68 offen  lds
  s_add_u32 m0, s56, 8192
  s_mov_b32 s68, 262144
  buffer_load_dwordx4 v44, s[48:51], s68 offen  lds
  s_add_u32 m0, s56, 12288
  s_mov_b32 s68, 327680
  buffer_load_dwordx4 v44, s[48:51], s68 offen  lds
  v_add_u32 v48, 81920, v46
  v_add_u32 v49, 81920, v47
  s_cmp_lg_u32 s44, 0
  s_cbranch_scc1 L_wr_13_1
  ds_read_b64_tr_b16 a[40:41], v48 offset:0
  ds_read_b64_tr_b16 a[42:43], v48 offset:512
  ds_read_b64_tr_b16 a[44:45], v48 offset:8192
  ds_read_b64_tr_b16 a[46:47], v48 offset:8704
  ds_read_b64_tr_b16 a[104:105], v49 offset:0
  ds_read_b64_tr_b16 a[106:107], v49 offset:512
  ds_read_b64_tr_b16 a[108:109], v49 offset:8192
  ds_read_b64_tr_b16 a[110:111], v49 offset:8704
  s_branch L_wr_13_e
L_wr_13_1:
  s_cmp_lg_u32 s44, 1
  s_cbranch_scc1 L_wr_13_2
  ds_read_b64_tr_b16 a[56:57], v48 offset:0
  ds_read_b64_tr_b16 a[58:59], v48 offset:512
  ds_read_b64_tr_b16 a[60:61], v48 offset:8192
  ds_read_b64_tr_b16 a[62:63], v48 offset:8704
  ds_read_b64_tr_b16 a[120:121], v49 offset:0
  ds_read_b64_tr_b16 a[122:123], v49 offset:512
  ds_read_b64_tr_b16 a[124:125], v49 offset:8192
  ds_read_b64_tr_b16 a[126:127], v49 offset:8704
  s_branch L_wr_13_e
L_wr_13_2:
  s_cmp_lg_u32 s44, 2
  s_cbranch_scc1 L_wr_13_3
  ds_read_b64_tr_b16 a[8:9], v48 offset:0
  ds_read_b64_tr_b16 a[10:11], v48 offset:512
  ds_read_b64_tr_b16 a[12:13], v48 offset:8192
  ds_read_b64_tr_b16 a[14:15], v48 offset:8704
  ds_read_b64_tr_b16 a[72:73], v49 offset:0
  ds_read_b64_tr_b16 a[74:75], v49 offset:512
  ds_read_b64_tr_b16 a[76:77], v49 offset:8192
  ds_read_b64_tr_b16 a[78:79], v49 offset:8704
  s_branch L_wr_13_e
L_wr_13_3:
  ds_read_b64_tr_b16 a[24:25], v48 offset:0
  ds_read_b64_tr_b16 a[26:27], v48 offset:512
  ds_read_b64_tr_b16 a[28:29], v48 offset:8192
  ds_read_b64_tr_b16 a[30:31], v48 offset:8704
  ds_read_b64_tr_b16 a[88:89], v49 offset:0
  ds_read_b64_tr_b16 a[90:91], v49 offset:512
  ds_read_b64_tr_b16 a[92:93], v49 offset:8192
  ds_read_b64_tr_b16 a[94:95], v49 offset:8704
L_wr_13_e:
  s_waitcnt lgkmcnt(0)
  s_waitcnt vmcnt(8)
  s_barrier
  s_add_u32 m0, s56, 16384
  s_mov_b32 s68, 524288
  buffer_load_dwordx4 v44, s[48:51], s68 offen  lds
  s_add_u32 m0, s56, 20480
  s_mov_b32 s68, 589824
  buffer_load_dwordx4 v44, s[48:51], s68 offen  lds
  s_add_u32 m0, s56, 24576
  s_mov_b32 s68, 786432
  buffer_load_dwordx4 v44, s[48:51], s68 offen  lds
  s_add_u32 m0, s56, 28672
  s_mov_b32 s68, 851968
  buffer_load_dwordx4 v44, s[48:51], s68 offen  lds
  v_add_u32 v48, 98304, v46
  v_add_u32 v49, 98304, v47
  s_cmp_lg_u32 s44, 0
  s_cbranch_scc1 L_wr_14_1
  ds_read_b64_tr_b16 a[48:49], v48 offset:0
  ds_read_b64_tr_b16 a[50:51], v48 offset:512
  ds_read_b64_tr_b16 a[52:53], v48 offset:8192
  ds_read_b64_tr_b16 a[54:55], v48 offset:8704
  ds_read_b64_tr_b16 a[112:113], v49 offset:0
  ds_read_b64_tr_b16 a[114:115], v49 offset:512
  ds_read_b64_tr_b16 a[116:117], v49 offset:8192
  ds_read_b64_tr_b16 a[118:119], v49 offset:8704
  s_branch L_wr_14_e
L_wr_14_1:
  s_cmp_lg_u32 s44, 1
  s_cbranch_scc1 L_wr_14_2
  ds_read_b64_tr_b16 a[32:33], v48 offset:0
  ds_read_b64_tr_b16 a[34:35], v48 offset:512
  ds_read_b64_tr_b16 a[36:37], v48 offset:8192
  ds_read_b64_tr_b16 a[38:39], v48 offset:8704
  ds_read_b64_tr_b16 a[96:97], v49 offset:0
  ds_read_b64_tr_b16 a[98:99], v49 offset:512
  ds_read_b64_tr_b16 a[100:101], v49 offset:8192
  ds_read_b64_tr_b16 a[102:103], v49 offset:8704
  s_branch L_wr_14_e
L_wr_14_2:
  s_cmp_lg_u32 s44, 2
  s_cbranch_scc1 L_wr_14_3
  ds_read_b64_tr_b16 a[16:17], v48 offset:0
  ds_read_b64_tr_b16 a[18:19], v48 offset:512
  ds_read_b64_tr_b16 a[20:21], v48 offset:8192
  ds_read_b64_tr_b16 a[22:23], v48 offset:8704
  ds_read_b64_tr_b16 a[80:81], v49 offset:0
  ds_read_b64_tr_b16 a[82:83], v49 offset:512
  ds_read_b64_tr_b16 a[84:85], v49 offset:8192
  ds_read_b64_tr_b16 a[86:87], v49 offset:8704
  s_branch L_wr_14_e
L_wr_14_3:
  ds_read_b64_tr_b16 a[0:1], v48 offset:0
  ds_read_b64_tr_b16 a[2:3], v48 offset:512
  ds_read_b64_tr_b16 a[4:5], v48 offset:8192
  ds_read_b64_tr_b16 a[6:7], v48 offset:8704
  ds_read_b64_tr_b16 a[64:65], v49 offset:0
  ds_read_b64_tr_b16 a[66:67], v49 offset:512
  ds_read_b64_tr_b16 a[68:69], v49 offset:8192
  ds_read_b64_tr_b16 a[70:71], v49 offset:8704
L_wr_14_e:
  s_waitcnt lgkmcnt(0)
  s_waitcnt vmcnt(8)
  s_barrier
  s_add_u32 m0, s56, 32768
  s_mov_b32 s68, 1048576
  buffer_load_dwordx4 v44, s[48:51], s68 offen  lds
  s_add_u32 m0, s56, 36864
  s_mov_b32 s68, 1114112
  buffer_load_dwordx4 v44, s[48:51], s68 offen  lds
  s_add_u32 m0, s56, 40960
  s_mov_b32 s68, 1310720
  buffer_load_dwordx4 v44, s[48:51], s68 offen  lds
  s_add_u32 m0, s56, 45056
  s_mov_b32 s68, 1376256
  buffer_load_dwordx4 v44, s[48:51], s68 offen  lds
  v_add_u32 v48, 114688, v46
  v_add_u32 v49, 114688, v47
  s_cmp_lg_u32 s44, 0
  s_cbranch_scc1 L_wr_15_1
  ds_read_b64_tr_b16 a[56:57], v48 offset:0
  ds_read_b64_tr_b16 a[58:59], v48 offset:512
  ds_read_b64_tr_b16 a[60:61], v48 offset:8192
  ds_read_b64_tr_b16 a[62:63], v48 offset:8704
  ds_read_b64_tr_b16 a[120:121], v49 offset:0
  ds_read_b64_tr_b16 a[122:123], v49 offset:512
  ds_read_b64_tr_b16 a[124:125], v49 offset:8192
  ds_read_b64_tr_b16 a[126:127], v49 offset:8704
  s_branch L_wr_15_e
L_wr_15_1:
  s_cmp_lg_u32 s44, 1
  s_cbranch_scc1 L_wr_15_2
  ds_read_b64_tr_b16 a[40:41], v48 offset:0
  ds_read_b64_tr_b16 a[42:43], v48 offset:512
  ds_read_b64_tr_b16 a[44:45], v48 offset:8192
  ds_read_b64_tr_b16 a[46:47], v48 offset:8704
  ds_read_b64_tr_b16 a[104:105], v49 offset:0
  ds_read_b64_tr_b16 a[106:107], v49 offset:512
  ds_read_b64_tr_b16 a[108:109], v49 offset:8192
  ds_read_b64_tr_b16 a[110:111], v49 offset:8704
  s_branch L_wr_15_e
L_wr_15_2:
  s_cmp_lg_u32 s44, 2
  s_cbranch_scc1 L_wr_15_3
  ds_read_b64_tr_b16 a[24:25], v48 offset:0
  ds_read_b64_tr_b16 a[26:27], v48 offset:512
  ds_read_b64_tr_b16 a[28:29], v48 offset:8192
  ds_read_b64_tr_b16 a[30:31], v48 offset:8704
  ds_read_b64_tr_b16 a[88:89], v49 offset:0
  ds_read_b64_tr_b16 a[90:91], v49 offset:512
  ds_read_b64_tr_b16 a[92:93], v49 offset:8192
  ds_read_b64_tr_b16 a[94:95], v49 offset:8704
  s_branch L_wr_15_e
L_wr_15_3:
  ds_read_b64_tr_b16 a[8:9], v48 offset:0
  ds_read_b64_tr_b16 a[10:11], v48 offset:512
  ds_read_b64_tr_b16 a[12:13], v48 offset:8192
  ds_read_b64_tr_b16 a[14:15], v48 offset:8704
  ds_read_b64_tr_b16 a[72:73], v49 offset:0
  ds_read_b64_tr_b16 a[74:75], v49 offset:512
  ds_read_b64_tr_b16 a[76:77], v49 offset:8192
  ds_read_b64_tr_b16 a[78:79], v49 offset:8704
L_wr_15_e:
  s_waitcnt lgkmcnt(0)
  s_waitcnt vmcnt(8)
  s_barrier
  s_add_u32 m0, s56, 49152
  s_mov_b32 s68, 1572864
  buffer_load_dwordx4 v44, s[48:51], s68 offen  lds
  s_add_u32 m0, s56, 53248
  s_mov_b32 s68, 1638400
  buffer_load_dwordx4 v44, s[48:51], s68 offen  lds
  s_add_u32 m0, s56, 57344
  s_mov_b32 s68, 1835008
  buffer_load_dwordx4 v44, s[48:51], s68 offen  lds
  s_add_u32 m0, s56, 61440
  s_mov_b32 s68, 1900544
  buffer_load_dwordx4 v44, s[48:51], s68 offen  lds
  v_add_u32 v48, 0, v46
  v_add_u32 v49, 0, v47
  s_cmp_lg_u32 s44, 0
  s_cbranch_scc1 L_wr_16_1
  ds_read_b64_tr_b16 a[128:129], v48 offset:0
  ds_read_b64_tr_b16 a[130:131], v48 offset:512
  ds_read_b64_tr_b16 a[132:133], v48 offset:8192
  ds_read_b64_tr_b16 a[134:135], v48 offset:8704
  ds_read_b64_tr_b16 a[192:193], v49 offset:0
  ds_read_b64_tr_b16 a[194:195], v49 offset:512
  ds_read_b64_tr_b16 a[196:197], v49 offset:8192
  ds_read_b64_tr_b16 a[198:199], v49 offset:8704
  s_branch L_wr_16_e
L_wr_16_1:
  s_cmp_lg_u32 s44, 1
  s_cbranch_scc1 L_wr_16_2
  ds_read_b64_tr_b16 a[144:145], v48 offset:0
  ds_read_b64_tr_b16 a[146:147], v48 offset:512
  ds_read_b64_tr_b16 a[148:149], v48 offset:8192
  ds_read_b64_tr_b16 a[150:151], v48 offset:8704
  ds_read_b64_tr_b16 a[208:209], v49 offset:0
  ds_read_b64_tr_b16 a[210:211], v49 offset:512
  ds_read_b64_tr_b16 a[212:213], v49 offset:8192
  ds_read_b64_tr_b16 a[214:215], v49 offset:8704
  s_branch L_wr_16_e
L_wr_16_2:
  s_cmp_lg_u32 s44, 2
  s_cbranch_scc1 L_wr_16_3
  ds_read_b64_tr_b16 a[160:161], v48 offset:0
  ds_read_b64_tr_b16 a[162:163], v48 offset:512
  ds_read_b64_tr_b16 a[164:165], v48 offset:8192
  ds_read_b64_tr_b16 a[166:167], v48 offset:8704
  ds_read_b64_tr_b16 a[224:225], v49 offset:0
  ds_read_b64_tr_b16 a[226:227], v49 offset:512
  ds_read_b64_tr_b16 a[228:229], v49 offset:8192
  ds_read_b64_tr_b16 a[230:231], v49 offset:8704
  s_branch L_wr_16_e
L_wr_16_3:
  ds_read_b64_tr_b16 a[176:177], v48 offset:0
  ds_read_b64_tr_b16 a[178:179], v48 offset:512
  ds_read_b64_tr_b16 a[180:181], v48 offset:8192
  ds_read_b64_tr_b16 a[182:183], v48 offset:8704
  ds_read_b64_tr_b16 a[240:241], v49 offset:0
  ds_read_b64_tr_b16 a[242:243], v49 offset:512
  ds_read_b64_tr_b16 a[244:245], v49 offset:8192
  ds_read_b64_tr_b16 a[246:247], v49 offset:8704
L_wr_16_e:
  s_waitcnt lgkmcnt(0)
  s_waitcnt vmcnt(8)
  s_barrier
  s_add_u32 m0, s56, 65536
  s_mov_b32 s68, 2097152
  buffer_load_dwordx4 v44, s[48:51], s68 offen  lds
  s_add_u32 m0, s56, 69632
  s_mov_b32 s68, 2162688
  buffer_load_dwordx4 v44, s[48:51], s68 offen  lds
  s_add_u32 m0, s56, 73728
  s_mov_b32 s68, 2359296
  buffer_load_dwordx4 v44, s[48:51], s68 offen  lds
  s_add_u32 m0, s56, 77824
  s_mov_b32 s68, 2424832
  buffer_load_dwordx4 v44, s[48:51], s68 offen  lds
  v_add_u32 v48, 16384, v46
  v_add_u32 v49, 16384, v47
  s_cmp_lg_u32 s44, 0
  s_cbranch_scc1 L_wr_17_1
  ds_read_b64_tr_b16 a[136:137], v48 offset:0
  ds_read_b64_tr_b16 a[138:139], v48 offset:512
  ds_read_b64_tr_b16 a[140:141], v48 offset:8192
  ds_read_b64_tr_b16 a[142:143], v48 offset:8704
  ds_read_b64_tr_b16 a[200:201], v49 offset:0
  ds_read_b64_tr_b16 a[202:203], v49 offset:512
  ds_read_b64_tr_b16 a[204:205], v49 offset:8192
  ds_read_b64_tr_b16 a[206:207], v49 offset:8704
  s_branch L_wr_17_e
L_wr_17_1:
  s_cmp_lg_u32 s44, 1
  s_cbranch_scc1 L_wr_17_2
  ds_read_b64_tr_b16 a[152:153], v48 offset:0
  ds_read_b64_tr_b16 a[154:155], v48 offset:512
  ds_read_b64_tr_b16 a[156:157], v48 offset:8192
  ds_read_b64_tr_b16 a[158:159], v48 offset:8704
  ds_read_b64_tr_b16 a[216:217], v49 offset:0
  ds_read_b64_tr_b16 a[218:219], v49 offset:512
  ds_read_b64_tr_b16 a[220:221], v49 offset:8192
  ds_read_b64_tr_b16 a[222:223], v49 offset:8704
  s_branch L_wr_17_e
L_wr_17_2:
  s_cmp_lg_u32 s44, 2
  s_cbranch_scc1 L_wr_17_3
  ds_read_b64_tr_b16 a[168:169], v48 offset:0
  ds_read_b64_tr_b16 a[170:171], v48 offset:512
  ds_read_b64_tr_b16 a[172:173], v48 offset:8192
  ds_read_b64_tr_b16 a[174:175], v48 offset:8704
  ds_read_b64_tr_b16 a[232:233], v49 offset:0
  ds_read_b64_tr_b16 a[234:235], v49 offset:512
  ds_read_b64_tr_b16 a[236:237], v49 offset:8192
  ds_read_b64_tr_b16 a[238:239], v49 offset:8704
  s_branch L_wr_17_e
L_wr_17_3:
  ds_read_b64_tr_b16 a[184:185], v48 offset:0
  ds_read_b64_tr_b16 a[186:187], v48 offset:512
  ds_read_b64_tr_b16 a[188:189], v48 offset:8192
  ds_read_b64_tr_b16 a[190:191], v48 offset:8704
  ds_read_b64_tr_b16 a[248:249], v49 offset:0
  ds_read_b64_tr_b16 a[250:251], v49 offset:512
  ds_read_b64_tr_b16 a[252:253], v49 offset:8192
  ds_read_b64_tr_b16 a[254:255], v49 offset:8704
L_wr_17_e:
  s_waitcnt lgkmcnt(0)
  s_waitcnt vmcnt(8)
  s_barrier
  s_add_u32 m0, s56, 81920
  s_mov_b32 s68, 2621440
  buffer_load_dwordx4 v44, s[48:51], s68 offen  lds
  s_add_u32 m0, s56, 86016
  s_mov_b32 s68, 2686976
  buffer_load_dwordx4 v44, s[48:51], s68 offen  lds
  s_add_u32 m0, s56, 90112
  s_mov_b32 s68, 2883584
  buffer_load_dwordx4 v44, s[48:51], s68 offen  lds
  s_add_u32 m0, s56, 94208
  s_mov_b32 s68, 2949120
  buffer_load_dwordx4 v44, s[48:51], s68 offen  lds
  v_add_u32 v48, 32768, v46
  v_add_u32 v49, 32768, v47
  s_cmp_lg_u32 s44, 0
  s_cbranch_scc1 L_wr_18_1
  ds_read_b64_tr_b16 a[144:145], v48 offset:0
  ds_read_b64_tr_b16 a[146:147], v48 offset:512
  ds_read_b64_tr_b16 a[148:149], v48 offset:8192
  ds_read_b64_tr_b16 a[150:151], v48 offset:8704
  ds_read_b64_tr_b16 a[208:209], v49 offset:0
  ds_read_b64_tr_b16 a[210:211], v49 offset:512
  ds_read_b64_tr_b16 a[212:213], v49 offset:8192
  ds_read_b64_tr_b16 a[214:215], v49 offset:8704
  s_branch L_wr_18_e
L_wr_18_1:
  s_cmp_lg_u32 s44, 1
  s_cbranch_scc1 L_wr_18_2
  ds_read_b64_tr_b16 a[128:129], v48 offset:0
  ds_read_b64_tr_b16 a[130:131], v48 offset:512
  ds_read_b64_tr_b16 a[132:133], v48 offset:8192
  ds_read_b64_tr_b16 a[134:135], v48 offset:8704
  ds_read_b64_tr_b16 a[192:193], v49 offset:0
  ds_read_b64_tr_b16 a[194:195], v49 offset:512
  ds_read_b64_tr_b16 a[196:197], v49 offset:8192
  ds_read_b64_tr_b16 a[198:199], v49 offset:8704
  s_branch L_wr_18_e
L_wr_18_2:
  s_cmp_lg_u32 s44, 2
  s_cbranch_scc1 L_wr_18_3
  ds_read_b64_tr_b16 a[176:177], v48 offset:0
  ds_read_b64_tr_b16 a[178:179], v48 offset:512
  ds_read_b64_tr_b16 a[180:181], v48 offset:8192
  ds_read_b64_tr_b16 a[182:183], v48 offset:8704
  ds_read_b64_tr_b16 a[240:241], v49 offset:0
  ds_read_b64_tr_b16 a[242:243], v49 offset:512
  ds_read_b64_tr_b16 a[244:245], v49 offset:8192
  ds_read_b64_tr_b16 a[246:247], v49 offset:8704
  s_branch L_wr_18_e
L_wr_18_3:
  ds_read_b64_tr_b16 a[160:161], v48 offset:0
  ds_read_b64_tr_b16 a[162:163], v48 offset:512
  ds_read_b64_tr_b16 a[164:165], v48 offset:8192
  ds_read_b64_tr_b16 a[166:167], v48 offset:8704
  ds_read_b64_tr_b16 a[224:225], v49 offset:0
  ds_read_b64_tr_b16 a[226:227], v49 offset:512
  ds_read_b64_tr_b16 a[228:229], v49 offset:8192
  ds_read_b64_tr_b16 a[230:231], v49 offset:8704
L_wr_18_e:
  s_waitcnt lgkmcnt(0)
  s_waitcnt vmcnt(8)
  s_barrier
  s_add_u32 m0, s56, 98304
  s_mov_b32 s68, 3145728
  buffer_load_dwordx4 v44, s[48:51], s68 offen  lds
  s_add_u32 m0, s56, 102400
  s_mov_b32 s68, 3211264
  buffer_load_dwordx4 v44, s[48:51], s68 offen  lds
  s_add_u32 m0, s56, 106496
  s_mov_b32 s68, 3407872
  buffer_load_dwordx4 v44, s[48:51], s68 offen  lds
  s_add_u32 m0, s56, 110592
  s_mov_b32 s68, 3473408
  buffer_load_dwordx4 v44, s[48:51], s68 offen  lds
  v_add_u32 v48, 49152, v46
  v_add_u32 v49, 49152, v47
  s_cmp_lg_u32 s44, 0
  s_cbranch_scc1 L_wr_19_1
  ds_read_b64_tr_b16 a[152:153], v48 offset:0
  ds_read_b64_tr_b16 a[154:155], v48 offset:512
  ds_read_b64_tr_b16 a[156:157], v48 offset:8192
  ds_read_b64_tr_b16 a[158:159], v48 offset:8704
  ds_read_b64_tr_b16 a[216:217], v49 offset:0
  ds_read_b64_tr_b16 a[218:219], v49 offset:512
  ds_read_b64_tr_b16 a[220:221], v49 offset:8192
  ds_read_b64_tr_b16 a[222:223], v49 offset:8704
  s_branch L_wr_19_e
L_wr_19_1:
  s_cmp_lg_u32 s44, 1
  s_cbranch_scc1 L_wr_19_2
  ds_read_b64_tr_b16 a[136:137], v48 offset:0
  ds_read_b64_tr_b16 a[138:139], v48 offset:512
  ds_read_b64_tr_b16 a[140:141], v48 offset:8192
  ds_read_b64_tr_b16 a[142:143], v48 offset:8704
  ds_read_b64_tr_b16 a[200:201], v49 offset:0
  ds_read_b64_tr_b16 a[202:203], v49 offset:512
  ds_read_b64_tr_b16 a[204:205], v49 offset:8192
  ds_read_b64_tr_b16 a[206:207], v49 offset:8704
  s_branch L_wr_19_e
L_wr_19_2:
  s_cmp_lg_u32 s44, 2
  s_cbranch_scc1 L_wr_19_3
  ds_read_b64_tr_b16 a[184:185], v48 offset:0
  ds_read_b64_tr_b16 a[186:187], v48 offset:512
  ds_read_b64_tr_b16 a[188:189], v48 offset:8192
  ds_read_b64_tr_b16 a[190:191], v48 offset:8704
  ds_read_b64_tr_b16 a[248:249], v49 offset:0
  ds_read_b64_tr_b16 a[250:251], v49 offset:512
  ds_read_b64_tr_b16 a[252:253], v49 offset:8192
  ds_read_b64_tr_b16 a[254:255], v49 offset:8704
  s_branch L_wr_19_e
L_wr_19_3:
  ds_read_b64_tr_b16 a[168:169], v48 offset:0
  ds_read_b64_tr_b16 a[170:171], v48 offset:512
  ds_read_b64_tr_b16 a[172:173], v48 offset:8192
  ds_read_b64_tr_b16 a[174:175], v48 offset:8704
  ds_read_b64_tr_b16 a[232:233], v49 offset:0
  ds_read_b64_tr_b16 a[234:235], v49 offset:512
  ds_read_b64_tr_b16 a[236:237], v49 offset:8192
  ds_read_b64_tr_b16 a[238:239], v49 offset:8704
L_wr_19_e:
  s_waitcnt lgkmcnt(0)
  s_waitcnt vmcnt(8)
  s_barrier
  s_add_u32 m0, s56, 114688
  s_mov_b32 s68, 3670016
  buffer_load_dwordx4 v44, s[48:51], s68 offen  lds
  s_add_u32 m0, s56, 118784
  s_mov_b32 s68, 3735552
  buffer_load_dwordx4 v44, s[48:51], s68 offen  lds
  s_add_u32 m0, s56, 122880
  s_mov_b32 s68, 3932160
  buffer_load_dwordx4 v44, s[48:51], s68 offen  lds
  s_add_u32 m0, s56, 126976
  s_mov_b32 s68, 3997696
  buffer_load_dwordx4 v44, s[48:51], s68 offen  lds
  v_add_u32 v48, 65536, v46
  v_add_u32 v49, 65536, v47
  s_cmp_lg_u32 s44, 0
  s_cbranch_scc1 L_wr_20_1
  ds_read_b64_tr_b16 a[160:161], v48 offset:0
  ds_read_b64_tr_b16 a[162:163], v48 offset:512
  ds_read_b64_tr_b16 a[164:165], v48 offset:8192
  ds_read_b64_tr_b16 a[166:167], v48 offset:8704
  ds_read_b64_tr_b16 a[224:225], v49 offset:0
  ds_read_b64_tr_b16 a[226:227], v49 offset:512
  ds_read_b64_tr_b16 a[228:229], v49 offset:8192
  ds_read_b64_tr_b16 a[230:231], v49 offset:8704
  s_branch L_wr_20_e
L_wr_20_1:
  s_cmp_lg_u32 s44, 1
  s_cbranch_scc1 L_wr_20_2
  ds_read_b64_tr_b16 a[176:177], v48 offset:0
  ds_read_b64_tr_b16 a[178:179], v48 offset:512
  ds_read_b64_tr_b16 a[180:181], v48 offset:8192
  ds_read_b64_tr_b16 a[182:183], v48 offset:8704
  ds_read_b64_tr_b16 a[240:241], v49 offset:0
  ds_read_b64_tr_b16 a[242:243], v49 offset:512
  ds_read_b64_tr_b16 a[244:245], v49 offset:8192
  ds_read_b64_tr_b16 a[246:247], v49 offset:8704
  s_branch L_wr_20_e
L_wr_20_2:
  s_cmp_lg_u32 s44, 2
  s_cbranch_scc1 L_wr_20_3
  ds_read_b64_tr_b16 a[128:129], v48 offset:0
  ds_read_b64_tr_b16 a[130:131], v48 offset:512
  ds_read_b64_tr_b16 a[132:133], v48 offset:8192
  ds_read_b64_tr_b16 a[134:135], v48 offset:8704
  ds_read_b64_tr_b16 a[192:193], v49 offset:0
  ds_read_b64_tr_b16 a[194:195], v49 offset:512
  ds_read_b64_tr_b16 a[196:197], v49 offset:8192
  ds_read_b64_tr_b16 a[198:199], v49 offset:8704
  s_branch L_wr_20_e
L_wr_20_3:
  ds_read_b64_tr_b16 a[144:145], v48 offset:0
  ds_read_b64_tr_b16 a[146:147], v48 offset:512
  ds_read_b64_tr_b16 a[148:149], v48 offset:8192
  ds_read_b64_tr_b16 a[150:151], v48 offset:8704
  ds_read_b64_tr_b16 a[208:209], v49 offset:0
  ds_read_b64_tr_b16 a[210:211], v49 offset:512
  ds_read_b64_tr_b16 a[212:213], v49 offset:8192
  ds_read_b64_tr_b16 a[214:215], v49 offset:8704
L_wr_20_e:
  s_waitcnt lgkmcnt(0)
  s_waitcnt vmcnt(8)
  s_barrier
  s_mov_b32 s48, s28
  s_and_b32 s49, s29, 0xffff
  s_add_u32 m0, s56, 0
  s_mov_b32 s68, 0
  buffer_load_dwordx4 v44, s[48:51], s68 offen  lds
  s_add_u32 m0, s56, 4096
  s_mov_b32 s68, 65536
  buffer_load_dwordx4 v44, s[48:51], s68 offen  lds
  s_add_u32 m0, s56, 8192
  s_mov_b32 s68, 262144
  buffer_load_dwordx4 v44, s[48:51], s68 offen  lds
  s_add_u32 m0, s56, 12288
  s_mov_b32 s68, 327680
  buffer_load_dwordx4 v44, s[48:51], s68 offen  lds
  v_add_u32 v48, 81920, v46
  v_add_u32 v49, 81920, v47
  s_cmp_lg_u32 s44, 0
  s_cbranch_scc1 L_wr_21_1
  ds_read_b64_tr_b16 a[168:169], v48 offset:0
  ds_read_b64_tr_b16 a[170:171], v48 offset:512
  ds_read_b64_tr_b16 a[172:173], v48 offset:8192
  ds_read_b64_tr_b16 a[174:175], v48 offset:8704
  ds_read_b64_tr_b16 a[232:233], v49 offset:0
  ds_read_b64_tr_b16 a[234:235], v49 offset:512
  ds_read_b64_tr_b16 a[236:237], v49 offset:8192
  ds_read_b64_tr_b16 a[238:239], v49 offset:8704
  s_branch L_wr_21_e
L_wr_21_1:
  s_cmp_lg_u32 s44, 1
  s_cbranch_scc1 L_wr_21_2
  ds_read_b64_tr_b16 a[184:185], v48 offset:0
  ds_read_b64_tr_b16 a[186:187], v48 offset:512
  ds_read_b64_tr_b16 a[188:189], v48 offset:8192
  ds_read_b64_tr_b16 a[190:191], v48 offset:8704
  ds_read_b64_tr_b16 a[248:249], v49 offset:0
  ds_read_b64_tr_b16 a[250:251], v49 offset:512
  ds_read_b64_tr_b16 a[252:253], v49 offset:8192
  ds_read_b64_tr_b16 a[254:255], v49 offset:8704
  s_branch L_wr_21_e
L_wr_21_2:
  s_cmp_lg_u32 s44, 2
  s_cbranch_scc1 L_wr_21_3
  ds_read_b64_tr_b16 a[136:137], v48 offset:0
  ds_read_b64_tr_b16 a[138:139], v48 offset:512
  ds_read_b64_tr_b16 a[140:141], v48 offset:8192
  ds_read_b64_tr_b16 a[142:143], v48 offset:8704
  ds_read_b64_tr_b16 a[200:201], v49 offset:0
  ds_read_b64_tr_b16 a[202:203], v49 offset:512
  ds_read_b64_tr_b16 a[204:205], v49 offset:8192
  ds_read_b64_tr_b16 a[206:207], v49 offset:8704
  s_branch L_wr_21_e
L_wr_21_3:
  ds_read_b64_tr_b16 a[152:153], v48 offset:0
  ds_read_b64_tr_b16 a[154:155], v48 offset:512
  ds_read_b64_tr_b16 a[156:157], v48 offset:8192
  ds_read_b64_tr_b16 a[158:159], v48 offset:8704
  ds_read_b64_tr_b16 a[216:217], v49 offset:0
  ds_read_b64_tr_b16 a[218:219], v49 offset:512
  ds_read_b64_tr_b16 a[220:221], v49 offset:8192
  ds_read_b64_tr_b16 a[222:223], v49 offset:8704
L_wr_21_e:
  s_waitcnt lgkmcnt(0)
  s_waitcnt vmcnt(8)
  s_barrier
  s_add_u32 m0, s56, 16384
  s_mov_b32 s68, 524288
  buffer_load_dwordx4 v44, s[48:51], s68 offen  lds
  s_add_u32 m0, s56, 20480
  s_mov_b32 s68, 589824
  buffer_load_dwordx4 v44, s[48:51], s68 offen  lds
  s_add_u32 m0, s56, 24576
  s_mov_b32 s68, 786432
  buffer_load_dwordx4 v44, s[48:51], s68 offen  lds
  s_add_u32 m0, s56, 28672
  s_mov_b32 s68, 851968
  buffer_load_dwordx4 v44, s[48:51], s68 offen  lds
  v_add_u32 v48, 98304, v46
  v_add_u32 v49, 98304, v47
  s_cmp_lg_u32 s44, 0
  s_cbranch_scc1 L_wr_22_1
  ds_read_b64_tr_b16 a[176:177], v48 offset:0
  ds_read_b64_tr_b16 a[178:179], v48 offset:512
  ds_read_b64_tr_b16 a[180:181], v48 offset:8192
  ds_read_b64_tr_b16 a[182:183], v48 offset:8704
  ds_read_b64_tr_b16 a[240:241], v49 offset:0
  ds_read_b64_tr_b16 a[242:243], v49 offset:512
  ds_read_b64_tr_b16 a[244:245], v49 offset:8192
  ds_read_b64_tr_b16 a[246:247], v49 offset:8704
  s_branch L_wr_22_e
L_wr_22_1:
  s_cmp_lg_u32 s44, 1
  s_cbranch_scc1 L_wr_22_2
  ds_read_b64_tr_b16 a[160:161], v48 offset:0
  ds_read_b64_tr_b16 a[162:163], v48 offset:512
  ds_read_b64_tr_b16 a[164:165], v48 offset:8192
  ds_read_b64_tr_b16 a[166:167], v48 offset:8704
  ds_read_b64_tr_b16 a[224:225], v49 offset:0
  ds_read_b64_tr_b16 a[226:227], v49 offset:512
  ds_read_b64_tr_b16 a[228:229], v49 offset:8192
  ds_read_b64_tr_b16 a[230:231], v49 offset:8704
  s_branch L_wr_22_e
L_wr_22_2:
  s_cmp_lg_u32 s44, 2
  s_cbranch_scc1 L_wr_22_3
  ds_read_b64_tr_b16 a[144:145], v48 offset:0
  ds_read_b64_tr_b16 a[146:147], v48 offset:512
  ds_read_b64_tr_b16 a[148:149], v48 offset:8192
  ds_read_b64_tr_b16 a[150:151], v48 offset:8704
  ds_read_b64_tr_b16 a[208:209], v49 offset:0
  ds_read_b64_tr_b16 a[210:211], v49 offset:512
  ds_read_b64_tr_b16 a[212:213], v49 offset:8192
  ds_read_b64_tr_b16 a[214:215], v49 offset:8704
  s_branch L_wr_22_e
L_wr_22_3:
  ds_read_b64_tr_b16 a[128:129], v48 offset:0
  ds_read_b64_tr_b16 a[130:131], v48 offset:512
  ds_read_b64_tr_b16 a[132:133], v48 offset:8192
  ds_read_b64_tr_b16 a[134:135], v48 offset:8704
  ds_read_b64_tr_b16 a[192:193], v49 offset:0
  ds_read_b64_tr_b16 a[194:195], v49 offset:512
  ds_read_b64_tr_b16 a[196:197], v49 offset:8192
  ds_read_b64_tr_b16 a[198:199], v49 offset:8704
L_wr_22_e:
  s_waitcnt lgkmcnt(0)
  s_waitcnt vmcnt(8)
  s_barrier
  s_add_u32 m0, s56, 32768
  s_mov_b32 s68, 1048576
  buffer_load_dwordx4 v44, s[48:51], s68 offen  lds
  s_add_u32 m0, s56, 36864
  s_mov_b32 s68, 1114112
  buffer_load_dwordx4 v44, s[48:51], s68 offen  lds
  s_add_u32 m0, s56, 40960
  s_mov_b32 s68, 1310720
  buffer_load_dwordx4 v44, s[48:51], s68 offen  lds
  s_add_u32 m0, s56, 45056
  s_mov_b32 s68, 1376256
  buffer_load_dwordx4 v44, s[48:51], s68 offen  lds
  v_add_u32 v48, 114688, v46
  v_add_u32 v49, 114688, v47
  s_cmp_lg_u32 s44, 0
  s_cbranch_scc1 L_wr_23_1
  ds_read_b64_tr_b16 a[184:185], v48 offset:0
  ds_read_b64_tr_b16 a[186:187], v48 offset:512
  ds_read_b64_tr_b16 a[188:189], v48 offset:8192
  ds_read_b64_tr_b16 a[190:191], v48 offset:8704
  ds_read_b64_tr_b16 a[248:249], v49 offset:0
  ds_read_b64_tr_b16 a[250:251], v49 offset:512
  ds_read_b64_tr_b16 a[252:253], v49 offset:8192
  ds_read_b64_tr_b16 a[254:255], v49 offset:8704
  s_branch L_wr_23_e
L_wr_23_1:
  s_cmp_lg_u32 s44, 1
  s_cbranch_scc1 L_wr_23_2
  ds_read_b64_tr_b16 a[168:169], v48 offset:0
  ds_read_b64_tr_b16 a[170:171], v48 offset:512
  ds_read_b64_tr_b16 a[172:173], v48 offset:8192
  ds_read_b64_tr_b16 a[174:175], v48 offset:8704
  ds_read_b64_tr_b16 a[232:233], v49 offset:0
  ds_read_b64_tr_b16 a[234:235], v49 offset:512
  ds_read_b64_tr_b16 a[236:237], v49 offset:8192
  ds_read_b64_tr_b16 a[238:239], v49 offset:8704
  s_branch L_wr_23_e
L_wr_23_2:
  s_cmp_lg_u32 s44, 2
  s_cbranch_scc1 L_wr_23_3
  ds_read_b64_tr_b16 a[152:153], v48 offset:0
  ds_read_b64_tr_b16 a[154:155], v48 offset:512
  ds_read_b64_tr_b16 a[156:157], v48 offset:8192
  ds_read_b64_tr_b16 a[158:159], v48 offset:8704
  ds_read_b64_tr_b16 a[216:217], v49 offset:0
  ds_read_b64_tr_b16 a[218:219], v49 offset:512
  ds_read_b64_tr_b16 a[220:221], v49 offset:8192
  ds_read_b64_tr_b16 a[222:223], v49 offset:8704
  s_branch L_wr_23_e
L_wr_23_3:
  ds_read_b64_tr_b16 a[136:137], v48 offset:0
  ds_read_b64_tr_b16 a[138:139], v48 offset:512
  ds_read_b64_tr_b16 a[140:141], v48 offset:8192
  ds_read_b64_tr_b16 a[142:143], v48 offset:8704
  ds_read_b64_tr_b16 a[200:201], v49 offset:0
  ds_read_b64_tr_b16 a[202:203], v49 offset:512
  ds_read_b64_tr_b16 a[204:205], v49 offset:8192
  ds_read_b64_tr_b16 a[206:207], v49 offset:8704
L_wr_23_e:
  s_waitcnt lgkmcnt(0)
  s_waitcnt vmcnt(8)
  s_barrier
  s_add_u32 m0, s56, 49152
  s_mov_b32 s68, 1572864
  buffer_load_dwordx4 v44, s[48:51], s68 offen  lds
  s_add_u32 m0, s56, 53248
  s_mov_b32 s68, 1638400
  buffer_load_dwordx4 v44, s[48:51], s68 offen  lds
  s_add_u32 m0, s56, 57344
  s_mov_b32 s68, 1835008
  buffer_load_dwordx4 v44, s[48:51], s68 offen  lds
  s_add_u32 m0, s56, 61440
  s_mov_b32 s68, 1900544
  buffer_load_dwordx4 v44, s[48:51], s68 offen  lds
  v_add_u32 v48, 0, v46
  v_add_u32 v49, 0, v47
  ds_read_b64_tr_b16 v[108:109], v48 offset:0
  ds_read_b64_tr_b16 v[110:111], v48 offset:512
  ds_read_b64_tr_b16 v[112:113], v48 offset:8192
  ds_read_b64_tr_b16 v[114:115], v48 offset:8704
  ds_read_b64_tr_b16 v[116:117], v49 offset:0
  ds_read_b64_tr_b16 v[118:119], v49 offset:512
  ds_read_b64_tr_b16 v[120:121], v49 offset:8192
  ds_read_b64_tr_b16 v[122:123], v49 offset:8704
  s_waitcnt lgkmcnt(0)
  s_barrier
  v_add_u32 v48, 0, v3
  ds_write_b128 v48, v[108:111] offset:0
  ds_write_b128 v48, v[112:115] offset:1024
  ds_write_b128 v48, v[116:119] offset:2048
  ds_write_b128 v48, v[120:123] offset:3072
  s_waitcnt lgkmcnt(0)
  s_waitcnt vmcnt(8)
  s_barrier
  s_add_u32 m0, s56, 65536
  s_mov_b32 s68, 2097152
  buffer_load_dwordx4 v44, s[48:51], s68 offen  lds
  s_add_u32 m0, s56, 69632
  s_mov_b32 s68, 2162688
  buffer_load_dwordx4 v44, s[48:51], s68 offen  lds
  s_add_u32 m0, s56, 73728
  s_mov_b32 s68, 2359296
  buffer_load_dwordx4 v44, s[48:51], s68 offen  lds
  s_add_u32 m0, s56, 77824
  s_mov_b32 s68, 2424832
  buffer_load_dwordx4 v44, s[48:51], s68 offen  lds
  v_add_u32 v48, 16384, v46
  v_add_u32 v49, 16384, v47
  ds_read_b64_tr_b16 v[108:109], v48 offset:0
  ds_read_b64_tr_b16 v[110:111], v48 offset:512
  ds_read_b64_tr_b16 v[112:113], v48 offset:8192
  ds_read_b64_tr_b16 v[114:115], v48 offset:8704
  ds_read_b64_tr_b16 v[116:117], v49 offset:0
  ds_read_b64_tr_b16 v[118:119], v49 offset:512
  ds_read_b64_tr_b16 v[120:121], v49 offset:8192
  ds_read_b64_tr_b16 v[122:123], v49 offset:8704
  s_waitcnt lgkmcnt(0)
  s_barrier
  v_add_u32 v48, 16384, v3
  ds_write_b128 v48, v[108:111] offset:0
  ds_write_b128 v48, v[112:115] offset:1024
  ds_write_b128 v48, v[116:119] offset:2048
  ds_write_b128 v48, v[120:123] offset:3072
  s_waitcnt lgkmcnt(0)
  s_waitcnt vmcnt(8)
  s_barrier
  s_add_u32 m0, s56, 81920
  s_mov_b32 s68, 2621440
  buffer_load_dwordx4 v44, s[48:51], s68 offen  lds
  s_add_u32 m0, s56, 86016
  s_mov_b32 s68, 2686976
  buffer_load_dwordx4 v44, s[48:51], s68 offen  lds
  s_add_u32 m0, s56, 90112
  s_mov_b32 s68, 2883584
  buffer_load_dwordx4 v44, s[48:51], s68 offen  lds
  s_add_u32 m0, s56, 94208
  s_mov_b32 s68, 2949120
  buffer_load_dwordx4 v44, s[48:51], s68 offen  lds
  v_add_u32 v48, 32768, v46
  v_add_u32 v49, 32768, v47
  ds_read_b64_tr_b16 v[108:109], v48 offset:0
  ds_read_b64_tr_b16 v[110:111], v48 offset:512
  ds_read_b64_tr_b16 v[112:113], v48 offset:8192
  ds_read_b64_tr_b16 v[114:115], v48 offset:8704
  ds_read_b64_tr_b16 v[116:117], v49 offset:0
  ds_read_b64_tr_b16 v[118:119], v49 offset:512
  ds_read_b64_tr_b16 v[120:121], v49 offset:8192
  ds_read_b64_tr_b16 v[122:123], v49 offset:8704
  s_waitcnt lgkmcnt(0)
  s_barrier
  v_add_u32 v48, 32768, v3
  ds_write_b128 v48, v[108:111] offset:0
  ds_write_b128 v48, v[112:115] offset:1024
  ds_write_b128 v48, v[116:119] offset:2048
  ds_write_b128 v48, v[120:123] offset:3072
  s_waitcnt lgkmcnt(0)
  s_waitcnt vmcnt(8)
  s_barrier
  buffer_load_dwordx2 v[52:53], v17, s[52:55], 0 offen sc1
  buffer_load_dword v4, v17, s[40:43], s60 offen sc1
  s_add_u32 m0, s56, 98304
  s_mov_b32 s68, 3145728
  buffer_load_dwordx4 v44, s[48:51], s68 offen  lds
  s_add_u32 m0, s56, 102400
  s_mov_b32 s68, 3211264
  buffer_load_dwordx4 v44, s[48:51], s68 offen  lds
  s_add_u32 m0, s56, 106496
  s_mov_b32 s68, 3407872
  buffer_load_dwordx4 v44, s[48:51], s68 offen  lds
  s_add_u32 m0, s56, 110592
  s_mov_b32 s68, 3473408
  buffer_load_dwordx4 v44, s[48:51], s68 offen  lds
  v_add_u32 v48, 49152, v46
  v_add_u32 v49, 49152, v47
  ds_read_b64_tr_b16 v[108:109], v48 offset:0
  ds_read_b64_tr_b16 v[110:111], v48 offset:512
  ds_read_b64_tr_b16 v[112:113], v48 offset:8192
  ds_read_b64_tr_b16 v[114:115], v48 offset:8704
  ds_read_b64_tr_b16 v[116:117], v49 offset:0
  ds_read_b64_tr_b16 v[118:119], v49 offset:512
  ds_read_b64_tr_b16 v[120:121], v49 offset:8192
  ds_read_b64_tr_b16 v[122:123], v49 offset:8704
  s_waitcnt lgkmcnt(0)
  s_barrier
  v_add_u32 v48, 49152, v3
  ds_write_b128 v48, v[108:111] offset:0
  ds_write_b128 v48, v[112:115] offset:1024
  ds_write_b128 v48, v[116:119] offset:2048
  ds_write_b128 v48, v[120:123] offset:3072
  s_waitcnt lgkmcnt(0)
  s_waitcnt vmcnt(8)
  s_barrier
  s_add_u32 m0, s56, 114688
  s_mov_b32 s68, 3670016
  buffer_load_dwordx4 v44, s[48:51], s68 offen  lds
  s_add_u32 m0, s56, 118784
  s_mov_b32 s68, 3735552
  buffer_load_dwordx4 v44, s[48:51], s68 offen  lds
  s_add_u32 m0, s56, 122880
  s_mov_b32 s68, 3932160
  buffer_load_dwordx4 v44, s[48:51], s68 offen  lds
  s_add_u32 m0, s56, 126976
  s_mov_b32 s68, 3997696
  buffer_load_dwordx4 v44, s[48:51], s68 offen  lds
  v_add_u32 v48, 65536, v46
  v_add_u32 v49, 65536, v47
  ds_read_b64_tr_b16 v[108:109], v48 offset:0
  ds_read_b64_tr_b16 v[110:111], v48 offset:512
  ds_read_b64_tr_b16 v[112:113], v48 offset:8192
  ds_read_b64_tr_b16 v[114:115], v48 offset:8704
  ds_read_b64_tr_b16 v[116:117], v49 offset:0
  ds_read_b64_tr_b16 v[118:119], v49 offset:512
  ds_read_b64_tr_b16 v[120:121], v49 offset:8192
  ds_read_b64_tr_b16 v[122:123], v49 offset:8704
  s_waitcnt lgkmcnt(0)
  s_barrier
  v_add_u32 v48, 65536, v3
  ds_write_b128 v48, v[108:111] offset:0
  ds_write_b128 v48, v[112:115] offset:1024
  ds_write_b128 v48, v[116:119] offset:2048
  ds_write_b128 v48, v[120:123] offset:3072
  s_waitcnt lgkmcnt(0)
  s_waitcnt vmcnt(8)
  s_barrier
  v_add_u32 v48, 81920, v46
  v_add_u32 v49, 81920, v47
  ds_read_b64_tr_b16 v[108:109], v48 offset:0
  ds_read_b64_tr_b16 v[110:111], v48 offset:512
  ds_read_b64_tr_b16 v[112:113], v48 offset:8192
  ds_read_b64_tr_b16 v[114:115], v48 offset:8704
  ds_read_b64_tr_b16 v[116:117], v49 offset:0
  ds_read_b64_tr_b16 v[118:119], v49 offset:512
  ds_read_b64_tr_b16 v[120:121], v49 offset:8192
  ds_read_b64_tr_b16 v[122:123], v49 offset:8704
  s_waitcnt lgkmcnt(0)
  s_barrier
  v_add_u32 v48, 81920, v3
  ds_write_b128 v48, v[108:111] offset:0
  ds_write_b128 v48, v[112:115] offset:1024
  ds_write_b128 v48, v[116:119] offset:2048
  ds_write_b128 v48, v[120:123] offset:3072
  s_waitcnt lgkmcnt(0)
  s_waitcnt vmcnt(4)
  s_barrier
L_team_init:
  v_sad_u8 v54, v52, 0, 0
  v_sad_u8 v54, v53, 0, v54
  v_cmp_gt_u32 vcc, 32, v54
  v_cmp_gt_u32 s[4:5], 2, v4
  s_nop 0
  s_or_b64 vcc, vcc, s[4:5]
  s_cbranch_scc0 L_team_ready
  buffer_load_dwordx2 v[52:53], v17, s[52:55], 0 offen sc1
  buffer_load_dword v4, v17, s[40:43], s60 offen sc1
  s_add_u32 s67, s67, 1
  s_cmp_gt_u32 s67, 1048576
  s_cbranch_scc1 L_exit
  s_waitcnt vmcnt(0)
  s_branch L_team_init
L_team_ready:
  s_lshl_b32 s69, s46, 3
  s_mov_b32 m0, s70
  s_mov_b32 s57, s72
  buffer_load_dwordx4 v2, s[40:43], s57 offen sc1 lds
  buffer_load_dwordx4 v2, s[40:43], s57 offen offset:1024 sc1 lds
  s_mov_b32 m0, s71
  s_add_u32 s58, s57, 0x1000000
  buffer_load_dwordx4 v2, s[40:43], s58 offen sc1 lds
  buffer_load_dwordx4 v2, s[40:43], s58 offen offset:1024 sc1 lds
  v_lshrrev_b64 v[52:53], s69, v[52:53]
  v_and_b32 v52, 0xff, v52
  v_cmp_eq_u32 s[4:5], v52, v54
  v_add_u32 v48, 98304, v46
  v_add_u32 v49, 98304, v47
  ds_read_b64_tr_b16 v[108:109], v48 offset:0
  ds_read_b64_tr_b16 v[110:111], v48 offset:512
  ds_read_b64_tr_b16 v[112:113], v48 offset:8192
  ds_read_b64_tr_b16 v[114:115], v48 offset:8704
  ds_read_b64_tr_b16 v[116:117], v49 offset:0
  ds_read_b64_tr_b16 v[118:119], v49 offset:512
  ds_read_b64_tr_b16 v[120:121], v49 offset:8192
  ds_read_b64_tr_b16 v[122:123], v49 offset:8704
  s_waitcnt lgkmcnt(0)
  s_barrier
  v_add_u32 v48, 98304, v3
  ds_write_b128 v48, v[108:111] offset:0
  ds_write_b128 v48, v[112:115] offset:1024
  ds_write_b128 v48, v[116:119] offset:2048
  ds_write_b128 v48, v[120:123] offset:3072
  s_waitcnt lgkmcnt(0)
  s_waitcnt vmcnt(4)
  s_barrier
  v_add_u32 v48, 114688, v46
  v_add_u32 v49, 114688, v47
  ds_read_b64_tr_b16 v[108:109], v48 offset:0
  ds_read_b64_tr_b16 v[110:111], v48 offset:512
  ds_read_b64_tr_b16 v[112:113], v48 offset:8192
  ds_read_b64_tr_b16 v[114:115], v48 offset:8704
  ds_read_b64_tr_b16 v[116:117], v49 offset:0
  ds_read_b64_tr_b16 v[118:119], v49 offset:512
  ds_read_b64_tr_b16 v[120:121], v49 offset:8192
  ds_read_b64_tr_b16 v[122:123], v49 offset:8704
  s_waitcnt lgkmcnt(0)
  s_barrier
  v_add_u32 v48, 114688, v3
  ds_write_b128 v48, v[108:111] offset:0
  ds_write_b128 v48, v[112:115] offset:1024
  ds_write_b128 v48, v[116:119] offset:2048
  ds_write_b128 v48, v[120:123] offset:3072
  s_waitcnt lgkmcnt(0)
  s_lshl_b32 s68, s44, 15
  v_add_u32 v3, s68, v3
  s_mov_b32 s56, -1
  s_mov_b32 s65, 0
  s_lshl_b32 s61, s45, 12
  s_lshl_b32 s68, s44, 10
  s_sub_u32 s61, s61, s68
  s_add_u32 s61, s61, 0xbfc0000
  ds_read_b128 v[76:79], v3 offset:0
  ds_read_b128 v[80:83], v3 offset:1024
  ds_read_b128 v[84:87], v3 offset:2048
  ds_read_b128 v[88:91], v3 offset:3072
  ds_read_b128 v[92:95], v3 offset:16384
  ds_read_b128 v[96:99], v3 offset:17408
  ds_read_b128 v[100:103], v3 offset:18432
  ds_read_b128 v[104:107], v3 offset:19456
  v_xor_b32 v3, 0x8000, v3
  ds_read_b128 v[108:111], v3 offset:0
  ds_read_b128 v[112:115], v3 offset:1024
  s_add_u32 s56, s56, 1
  s_xor_b32 s65, s65, 1
  s_add_u32 s68, s56, 1
  s_min_u32 s68, s68, 63
  s_lshl_b32 s68, s68, 13
  s_add_u32 s57, s72, s68
  s_add_u32 s58, s57, 0x1000000
  s_add_u32 s68, s56, 3
  s_min_u32 s92, s68, 64
  s_add_u32 s61, s61, 0x20000
  s_xor_b32 s70, s70, 0x2000
  v_mov_b64 v[52:53], 0
  v_mov_b64 v[54:55], 0
  v_mov_b64 v[56:57], 0
  v_mov_b64 v[58:59], 0
  v_mov_b64 v[60:61], 0
  v_mov_b64 v[62:63], 0
  v_mov_b64 v[64:65], 0
  v_mov_b64 v[66:67], 0
  v_mov_b64 v[68:69], 0
  v_mov_b64 v[70:71], 0
  v_mov_b64 v[72:73], 0
  v_mov_b64 v[74:75], 0
  v_xor_b32 v32, 2048, v2
  v_xor_b32 v40, 4096, v2
  v_xor_b32 v48, 6144, v2
  v_min_u32 v124, -2, v124
  v_bfe_u32 v45, v2, 9, 1
  v_and_b32 v4, 0x1ff, v2
  v_lshlrev_b32 v4, 2, v4
  s_add_u32 s59, s57, s73
  v_lshl_add_u32 v4, v45, 24, v4
  s_sub_u32 s68, s60, s59
  v_writelane_b32 v4, s68, 1
  s_waitcnt vmcnt(0)
  ds_read_b128 v[116:119], v2 offset:8192
  ds_read_b128 v[120:123], v2 offset:9216
  s_cmp_eq_u32 s4, 0
  s_cbranch_scc1 L_entry_x
  s_branch L_entry_f
L_poll2_f:
  buffer_load_dwordx4 v[20:23], v2, s[40:43], s63 offen sc1
  buffer_load_dwordx4 v[24:27], v2, s[40:43], s63 offen offset:1024 sc1
  s_nop 15
  s_nop 6
  buffer_load_dwordx4 v[28:31], v2, s[40:43], s63 offen sc1
  buffer_load_dwordx4 v[36:39], v2, s[40:43], s63 offen offset:1024 sc1
  ds_read_b128 v[116:119], v2 offset:8192
  ds_read_b128 v[120:123], v2 offset:9216
  v_readlane_b32 s69, v4, 1
  v_xor_b32 v10, 0x2000, v10
  s_waitcnt vmcnt(5)
  v_xor_b32 v32, 2048, v2
  v_xor_b32 v40, 4096, v2
  v_xor_b32 v48, 6144, v2
  s_cmp_lt_u32 s69, s92
  s_cbranch_scc1 L_fs_f
L_fsback_f:
  s_add_u32 s56, s56, 1
  s_xor_b32 s65, s65, 1
  s_add_u32 s68, s56, 1
  s_min_u32 s68, s68, 63
  s_lshl_b32 s68, s68, 13
  s_add_u32 s57, s72, s68
  s_add_u32 s58, s57, 0x1000000
  s_add_u32 s68, s56, 3
  s_min_u32 s92, s68, 64
  s_add_u32 s61, s61, 0x20000
  s_xor_b32 s70, s70, 0x2000
  v_min_u32 v124, -2, v124
  v_bfe_u32 v45, v2, 9, 1
  v_and_b32 v4, 0x1ff, v2
  v_lshlrev_b32 v4, 2, v4
  s_add_u32 s59, s57, s73
  v_lshl_add_u32 v4, v45, 24, v4
  s_sub_u32 s68, s60, s59
  v_writelane_b32 v4, s68, 1
L_entry_f:
  s_waitcnt vmcnt(3)
  ds_write_b128 v2, v[20:23] offset:0
  v_smfmac_f32_16x16x64_bf16 v[52:55], v[20:23], a[0:7], v1
  s_waitcnt vmcnt(2)
  ds_write_b128 v2, v[24:27] offset:1024
  v_max3_u32 v44, v20, v21, v22
  v_max3_u32 v44, v44, v23, v24
  v_max3_u32 v44, v44, v25, v26
  v_max_u32 v44, v44, v27
  v_cmp_eq_u32 vcc, -1, v44
  v_smfmac_f32_16x16x64_bf16 v[56:59], v[20:23], a[64:71], v1
  s_mov_b32 m0, s70
  v_smfmac_f32_16x16x64_bf16 v[52:55], v[24:27], a[8:15], v1
  s_cbranch_vccnz L_retry2_f
  buffer_load_dwordx4 v2, s[40:43], s57 offen offset:0 sc1 lds
  v_smfmac_f32_16x16x64_bf16 v[56:59], v[24:27], a[72:79], v1
  buffer_load_dwordx4 v2, s[40:43], s57 offen offset:1024 sc1 lds
  s_mov_b32 m0, s71
  v_smfmac_f32_16x16x64_bf16 v[60:63], v[20:23], a[128:135], v1
  s_waitcnt lgkmcnt(2)
  buffer_load_dwordx4 v2, s[40:43], s58 offen offset:0 sc1 lds
  v_smfmac_f32_16x16x64_bf16 v[64:67], v[20:23], a[192:199], v1
  buffer_load_dwordx4 v2, s[40:43], s58 offen offset:1024 sc1 lds
  v_smfmac_f32_16x16x64_bf16 v[60:63], v[24:27], a[136:143], v1
  s_waitcnt vmcnt(4) lgkmcnt(0)
  s_barrier
  ds_read_b128 v[28:31], v32 offset:0
  ds_read_b128 v[32:35], v32 offset:1024
  v_smfmac_f32_16x16x64_bf16 v[64:67], v[24:27], a[200:207], v1
  ds_read_b128 v[36:39], v40 offset:0
  buffer_load_dword v4, v4, s[40:43], s59 offen sc1
  v_smfmac_f32_16x16x64_bf16 v[68:71], v[20:23], v[76:83], v1
  ds_read_b128 v[40:43], v40 offset:1024
  ds_read_b128 v[44:47], v48 offset:0
  v_smfmac_f32_16x16x64_bf16 v[72:75], v[20:23], v[84:91], v1
  ds_read_b128 v[48:51], v48 offset:1024
  v_smfmac_f32_16x16x64_bf16 v[68:71], v[24:27], v[92:99], v1
  buffer_store_dwordx4 v[124:127], v2, s[40:43], s61 offen sc1
  v_smfmac_f32_16x16x64_bf16 v[72:75], v[24:27], v[100:107], v1
  s_waitcnt lgkmcnt(5)
  ds_read_b128 v[76:79], v3 offset:16384
  v_smfmac_f32_16x16x64_bf16 v[52:55], v[28:31], a[16:23], v1
  s_waitcnt lgkmcnt(5)
  ds_read_b128 v[20:23], v3 offset:2048
  v_smfmac_f32_16x16x64_bf16 v[52:55], v[32:35], a[24:31], v1
  s_waitcnt lgkmcnt(5)
  ds_read_b128 v[24:27], v3 offset:3072
  v_smfmac_f32_16x16x64_bf16 v[52:55], v[36:39], a[32:39], v1
  s_waitcnt lgkmcnt(5)
  ds_read_b128 v[80:83], v3 offset:17408
  v_smfmac_f32_16x16x64_bf16 v[52:55], v[40:43], a[40:47], v1
  s_waitcnt lgkmcnt(4)
  ds_read_b128 v[84:87], v3 offset:18432
  v_smfmac_f32_16x16x64_bf16 v[52:55], v[44:47], a[48:55], v1
  ds_read_b128 v[88:91], v3 offset:19456
  v_smfmac_f32_16x16x64_bf16 v[52:55], v[48:51], a[56:63], v1
  s_nop 0
  ds_read_b128 v[92:95], v0 offset:0
  v_xor_b32 v3, 0x18000, v3
  v_smfmac_f32_16x16x64_bf16 v[68:71], v[28:31], v[108:115], v1
  s_nop 0
  ds_read_b128 v[96:99], v0 offset:2048
  v_smfmac_f32_16x16x64_bf16 v[56:59], v[28:31], a[80:87], v1
  s_nop 0
  ds_read_b128 v[108:111], v3 offset:0
  v_add_f32 v52, v52, v53
  v_smfmac_f32_16x16x64_bf16 v[56:59], v[32:35], a[88:95], v1
  s_waitcnt lgkmcnt(6)
  ds_read_b128 v[112:115], v3 offset:1024
  v_add_f32 v54, v54, v55
  v_smfmac_f32_16x16x64_bf16 v[72:75], v[28:31], v[20:27], v1
  ds_read_b128 v[100:103], v0 offset:4096
  v_mul_f32 v52, s88, v52
  v_smfmac_f32_16x16x64_bf16 v[56:59], v[36:39], a[96:103], v1
  ds_read_b128 v[20:23], v3 offset:2048
  v_mul_f32 v54, s88, v54
  v_smfmac_f32_16x16x64_bf16 v[56:59], v[40:43], a[104:111], v1
  ds_read_b128 v[24:27], v3 offset:3072
  v_cvt_pk_bf16_f32 v52, v52, v52
  v_smfmac_f32_16x16x64_bf16 v[56:59], v[44:47], a[112:119], v1
  s_barrier
  v_cvt_pk_bf16_f32 v53, v54, v54
  v_smfmac_f32_16x16x64_bf16 v[56:59], v[48:51], a[120:127], v1
  s_waitcnt lgkmcnt(7)
  ds_write_b64 v5, v[52:53] offset:0
  v_smfmac_f32_16x16x64_bf16 v[68:71], v[32:35], v[76:83], v1
  s_nop 0
  ds_read_b128 v[104:107], v0 offset:6144
  v_smfmac_f32_16x16x64_bf16 v[72:75], v[32:35], v[84:91], v1
  s_nop 0
  ds_read_b128 v[76:79], v3 offset:16384
  v_add_f32 v56, v56, v57
  v_smfmac_f32_16x16x64_bf16 v[60:63], v[28:31], a[144:151], v1
  ds_read_b128 v[80:83], v3 offset:17408
  v_add_f32 v58, v58, v59
  v_smfmac_f32_16x16x64_bf16 v[60:63], v[32:35], a[152:159], v1
  s_waitcnt lgkmcnt(4)
  ds_read_b128 v[84:87], v3 offset:18432
  v_mul_f32 v56, s88, v56
  v_smfmac_f32_16x16x64_bf16 v[68:71], v[36:39], v[108:115], v1
  ds_read_b128 v[88:91], v3 offset:19456
  v_mul_f32 v58, s88, v58
  v_smfmac_f32_16x16x64_bf16 v[60:63], v[36:39], a[160:167], v1
  v_cvt_pk_bf16_f32 v56, v56, v56
  v_smfmac_f32_16x16x64_bf16 v[72:75], v[36:39], v[20:27], v1
  v_cvt_pk_bf16_f32 v57, v58, v58
  v_smfmac_f32_16x16x64_bf16 v[60:63], v[40:43], a[168:175], v1
  ds_write_b64 v5, v[56:57] offset:2048
  v_xor_b32 v3, 0x8000, v3
  v_smfmac_f32_16x16x64_bf16 v[60:63], v[44:47], a[176:183], v1
  ds_read_b128 v[108:111], v3 offset:0
  v_smfmac_f32_16x16x64_bf16 v[60:63], v[48:51], a[184:191], v1
  s_waitcnt lgkmcnt(2)
  ds_read_b128 v[112:115], v3 offset:1024
  v_smfmac_f32_16x16x64_bf16 v[68:71], v[40:43], v[76:83], v1
  s_nop 0
  ds_read_b128 v[20:23], v3 offset:16384
  v_smfmac_f32_16x16x64_bf16 v[72:75], v[40:43], v[84:91], v1
  s_nop 0
  ds_read_b128 v[24:27], v3 offset:17408
  v_add_f32 v60, v60, v61
  v_smfmac_f32_16x16x64_bf16 v[64:67], v[28:31], a[208:215], v1
  s_waitcnt lgkmcnt(4)
  s_barrier
  v_add_f32 v62, v62, v63
  v_smfmac_f32_16x16x64_bf16 v[64:67], v[32:35], a[216:223], v1
  ds_read_b64_tr_b16 v[76:77], v6 offset:0
  ds_read_b64_tr_b16 v[78:79], v6 offset:2048
  v_smfmac_f32_16x16x64_bf16 v[64:67], v[36:39], a[224:231], v1
  ds_read_b64_tr_b16 v[80:81], v6 offset:512
  ds_read_b64_tr_b16 v[82:83], v6 offset:2560
  v_smfmac_f32_16x16x64_bf16 v[64:67], v[40:43], a[232:239], v1
  ds_read_b64_tr_b16 v[84:85], v6 offset:1024
  ds_read_b64_tr_b16 v[86:87], v6 offset:3072
  v_smfmac_f32_16x16x64_bf16 v[64:67], v[44:47], a[240:247], v1
  ds_read_b64_tr_b16 v[88:89], v6 offset:1536
  ds_read_b64_tr_b16 v[90:91], v6 offset:3584
  v_smfmac_f32_16x16x64_bf16 v[64:67], v[48:51], a[248:255], v1
  s_waitcnt lgkmcnt(8)
  ds_read_b128 v[28:31], v0 offset:1024
  v_cvt_pk_bf16_f32 v124, v60, v62
  v_smfmac_f32_16x16x64_bf16 v[68:71], v[44:47], v[108:115], v1
  s_nop 0
  ds_read_b128 v[32:35], v0 offset:3072
  v_smfmac_f32_16x16x64_bf16 v[68:71], v[48:51], v[20:27], v1
  s_waitcnt lgkmcnt(2)
  ds_read_b128 v[36:39], v0 offset:5120
  v_add_f32 v64, v64, v65
  v_mfma_f32_16x16x32_bf16 v[52:55], v[92:95], v[76:79], 0
  v_add_f32 v66, v66, v67
  v_cvt_pk_bf16_f32 v125, v64, v66
  v_mfma_f32_16x16x32_bf16 v[52:55], v[96:99], v[80:83], v[52:55]
  ds_write2st64_b32 v5, v124, v125 offset0:16 offset1:24
  ds_read_b128 v[40:43], v0 offset:7168
  v_mfma_f32_16x16x32_bf16 v[52:55], v[100:103], v[84:87], v[52:55]
  ds_read_b128 v[108:111], v3 offset:2048
  v_add_f32 v68, v68, v69
  v_mfma_f32_16x16x32_bf16 v[52:55], v[104:107], v[88:91], v[52:55]
  s_waitcnt lgkmcnt(3)
  ds_read_b128 v[112:115], v3 offset:3072
  v_add_f32 v70, v70, v71
  v_mfma_f32_16x16x32_bf16 v[56:59], v[28:31], v[76:79], 0
  ds_read_b128 v[20:23], v3 offset:18432
  v_cvt_pk_bf16_f32 v126, v68, v70
  v_mfma_f32_16x16x32_bf16 v[56:59], v[32:35], v[80:83], v[56:59]
  ds_read_b128 v[24:27], v3 offset:19456
  v_mfma_f32_16x16x32_bf16 v[56:59], v[36:39], v[84:87], v[56:59]
  s_waitcnt lgkmcnt(4)
  s_barrier
  ds_read_b64_tr_b16 v[92:93], v6 offset:4096
  ds_read_b64_tr_b16 v[94:95], v6 offset:6144
  v_mfma_f32_16x16x32_bf16 v[56:59], v[40:43], v[88:91], v[56:59]
  s_waitcnt lgkmcnt(4)
  ds_read_b64_tr_b16 v[96:97], v6 offset:4608
  ds_read_b64_tr_b16 v[98:99], v6 offset:6656
  v_smfmac_f32_16x16x64_bf16 v[72:75], v[44:47], v[108:115], v1
  s_waitcnt lgkmcnt(4)
  ds_read_b64_tr_b16 v[100:101], v6 offset:5120
  ds_read_b64_tr_b16 v[102:103], v6 offset:7168
  v_smfmac_f32_16x16x64_bf16 v[72:75], v[48:51], v[20:27], v1
  ds_read_b64_tr_b16 v[104:105], v6 offset:5632
  ds_read_b64_tr_b16 v[106:107], v6 offset:7680
  v_exp_f32 v28, v52
  v_exp_f32 v29, v53
  v_exp_f32 v30, v54
  s_waitcnt lgkmcnt(4)
  v_mfma_f32_16x16x32_bf16 v[60:63], v[92:95], v[76:79], 0
  v_exp_f32 v31, v55
  v_mfma_f32_16x16x32_bf16 v[60:63], v[96:99], v[80:83], v[60:63]
  s_waitcnt lgkmcnt(0)
  v_exp_f32 v36, v56
  v_mfma_f32_16x16x32_bf16 v[60:63], v[100:103], v[84:87], v[60:63]
  v_exp_f32 v37, v57
  v_mfma_f32_16x16x32_bf16 v[60:63], v[104:107], v[88:91], v[60:63]
  s_cmp_eq_u32 s56, 63
  v_exp_f32 v38, v58
  v_exp_f32 v39, v59
  v_cvt_pk_bf16_f32 v32, v28, v29
  v_cvt_pk_bf16_f32 v33, v30, v31
  v_cvt_pk_bf16_f32 v34, v36, v37
  v_cvt_pk_bf16_f32 v35, v38, v39
  v_add_f32 v72, v72, v73
  v_exp_f32 v28, v60
  v_mfma_f32_16x16x32_bf16 v[64:67], v[12:15], v[32:35], 0
  v_exp_f32 v29, v61
  v_mfma_f32_16x16x32_bf16 v[80:83], v[116:119], v[32:35], 0
  v_add_f32 v74, v74, v75
  v_cvt_pk_bf16_f32 v16, v28, v29
  v_mfma_f32_16x16x32_bf16 v[84:87], v[120:123], v[32:35], 0
  v_cvt_pk_bf16_f32 v127, v72, v74
  v_cvt_pk_bf16_f32 v19, v28, v29
  v_mfma_f32_16x16x16_bf16 v[64:67], v[12:13], v[16:17], v[64:67]
  s_cbranch_scc1 L_team_last
  v_xor_b32 v3, 0x18000, v3
  v_mov_b64 v[44:45], 0
  v_mfma_f32_16x16x16_bf16 v[80:83], v[126:127], v[16:17], v[80:83]
  s_nop 0
  v_mov_b64 v[46:47], 0
  v_mov_b64 v[48:49], 0
  v_mfma_f32_16x16x16_bf16 v[84:87], v[126:127], v[18:19], v[84:87]
  v_rcp_f32 v65, v64
  v_subrev_u32 v66, s89, v64
  v_cmp_le_u32 vcc, s91, v66
  v_mov_b64 v[50:51], 0
L_smback_f:
  v_mul_f32 v80, v80, v65
  v_mul_f32 v81, v81, v65
  v_mul_f32 v82, v82, v65
  v_mul_f32 v83, v83, v65
  v_cvt_pk_bf16_f32 v88, v80, v81
  v_cvt_pk_bf16_f32 v89, v82, v83
  ds_write_b64 v7, v[88:89]
  v_mul_f32 v84, v84, v65
  v_mul_f32 v85, v85, v65
  v_mul_f32 v86, v86, v65
  v_mul_f32 v87, v87, v65
  v_cvt_pk_bf16_f32 v90, v84, v85
  v_cvt_pk_bf16_f32 v91, v86, v87
  s_cbranch_vccnz L_smslow_f
  ds_write_b64 v7, v[90:91] offset:8
  v_xor_b32 v96, 512, v7
  v_xor_b32 v100, 1024, v7
  v_xor_b32 v104, 1536, v7
  v_mov_b64 v[36:37], 0
  v_mov_b64 v[38:39], 0
  v_mov_b64 v[40:41], 0
  v_mov_b64 v[42:43], 0
  v_lshrrev_b32 v24, 16, v12
  v_cndmask_b32 v24, v24, 1.0, s[94:95]
  v_cndmask_b32 v20, 0, v24, s[80:81]
  v_cndmask_b32 v21, 0, v24, s[82:83]
  v_cndmask_b32 v22, 0, v24, s[84:85]
  v_cndmask_b32 v23, 0, v24, s[86:87]
  v_smfmac_f32_16x16x64_bf16 v[48:51], v[88:91], v[224:231], v1
  s_waitcnt lgkmcnt(0)
  s_barrier
  ds_read_b128 v[96:99], v96
  v_smfmac_f32_16x16x64_bf16 v[44:47], v[88:91], v[192:199], v1
  ds_read_b128 v[100:103], v100
  ds_read_b128 v[104:107], v104
  v_smfmac_f32_16x16x64_bf16 v[40:43], v[88:91], v[160:167], v1
  v_mov_b64 v[60:61], 0
  v_smfmac_f32_16x16x64_bf16 v[36:39], v[88:91], v[128:135], v1
  v_mov_b64 v[62:63], 0
  v_mov_b64 v[64:65], 0
  v_mov_b64 v[66:67], 0
  s_waitcnt lgkmcnt(2)
  v_smfmac_f32_16x16x64_bf16 v[36:39], v[96:99], v[136:143], v1
  s_waitcnt lgkmcnt(1)
  v_mov_b64 v[52:53], 0
  v_smfmac_f32_16x16x64_bf16 v[36:39], v[100:103], v[144:151], v1
  s_waitcnt lgkmcnt(0)
  v_mov_b64 v[54:55], 0
  v_smfmac_f32_16x16x64_bf16 v[36:39], v[104:107], v[152:159], v1
  s_nop 1
  v_mov_b64 v[56:57], 0
  v_smfmac_f32_16x16x64_bf16 v[40:43], v[96:99], v[168:175], v1
  s_nop 1
  v_mov_b64 v[58:59], 0
  v_smfmac_f32_16x16x64_bf16 v[40:43], v[100:103], v[176:183], v1
  v_cvt_pk_bf16_f32 v36, v36, v37
  v_cvt_pk_bf16_f32 v37, v38, v39
  v_and_or_b32 v36, v36, -2, s65
  v_smfmac_f32_16x16x64_bf16 v[40:43], v[104:107], v[184:191], v1
  s_nop 1
  buffer_store_dwordx2 v[36:37], v8, s[40:43], s74 offen
  v_smfmac_f32_16x16x64_bf16 v[44:47], v[96:99], v[200:207], v1
  s_nop 2
  v_smfmac_f32_16x16x64_bf16 v[44:47], v[100:103], v[208:215], v1
  v_cvt_pk_bf16_f32 v40, v40, v41
  v_cvt_pk_bf16_f32 v41, v42, v43
  v_and_or_b32 v40, v40, -2, s65
  v_smfmac_f32_16x16x64_bf16 v[44:47], v[104:107], v[216:223], v1
  s_nop 1
  buffer_store_dwordx2 v[40:41], v8, s[40:43], s75 offen
  v_smfmac_f32_16x16x64_bf16 v[48:51], v[96:99], v[232:239], v1
  s_nop 2
  v_smfmac_f32_16x16x64_bf16 v[48:51], v[100:103], v[240:247], v1
  v_cvt_pk_bf16_f32 v44, v44, v45
  v_cvt_pk_bf16_f32 v45, v46, v47
  v_and_or_b32 v44, v44, -2, s65
  v_smfmac_f32_16x16x64_bf16 v[48:51], v[104:107], v[248:255], v1
  s_nop 1
  buffer_store_dwordx2 v[44:45], v8, s[40:43], s76 offen
  s_nop 4
  v_cvt_pk_bf16_f32 v48, v48, v49
  v_cvt_pk_bf16_f32 v49, v50, v51
  v_and_or_b32 v48, v48, -2, s65
  buffer_store_dwordx2 v[48:49], v8, s[40:43], s77 offen
  s_barrier
  s_nop 15
  s_nop 9
  s_cmp_lt_u32 s44, 1
  s_cbranch_scc1 L_poll1_f
  s_nop 9
  s_cmp_lt_u32 s44, 2
  s_cbranch_scc1 L_poll1_f
  s_nop 9
  s_cmp_lt_u32 s44, 3
  s_cbranch_scc1 L_poll1_f
  s_nop 9
L_poll1_f:
  buffer_load_dwordx4 v[28:31], v9, s[40:43], s62 offen sc1
  buffer_load_dwordx4 v[32:35], v9, s[40:43], s62 offen offset:1024 sc1
  v_mov_b64 v[64:65], 0
  v_mov_b64 v[66:67], 0
  v_mov_b64 v[68:69], 0
  v_mov_b64 v[70:71], 0
  v_mov_b64 v[72:73], 0
  v_mov_b64 v[74:75], 0
  s_xor_b32 s63, s63, 0x2000
  v_xor_b32 v0, 0x2000, v0
  v_xor_b32 v7, 0x2000, v7
  s_nop 15
  s_nop 3
  buffer_load_dwordx4 v[36:39], v9, s[40:43], s62 offen sc1
  buffer_load_dwordx4 v[40:43], v9, s[40:43], s62 offen offset:1024 sc1
  ds_read_b128 v[76:79], v3 offset:0
  ds_read_b128 v[80:83], v3 offset:1024
  ds_read_b128 v[84:87], v3 offset:2048
  ds_read_b128 v[88:91], v3 offset:3072
  ds_read_b128 v[92:95], v3 offset:16384
  ds_read_b128 v[96:99], v3 offset:17408
  ds_read_b128 v[100:103], v3 offset:18432
  ds_read_b128 v[104:107], v3 offset:19456
  v_xor_b32 v3, 0x8000, v3
  ds_read_b128 v[108:111], v3 offset:0
  ds_read_b128 v[112:115], v3 offset:1024
L_poll1b_f:
  s_waitcnt vmcnt(3)
  v_mfma_f32_16x16x32_bf16 v[24:27], v[28:31], v[20:23], 0
  v_bitop3_b32 v44, v28, v30, s65 bitop3:0x7e
  s_waitcnt vmcnt(2)
  v_mfma_f32_16x16x32_bf16 v[24:27], v[32:35], v[20:23], v[24:27]
  v_bitop3_b32 v45, v32, v34, s65 bitop3:0x7e
  v_or_b32 v44, v44, v45
  v_and_b32 v44, 1, v44
  v_cmp_ne_u32 vcc, 0, v44
  s_nop 2
  s_cbranch_vccnz L_retry1_f
L_got1_f:
  v_add_f32 v24, v24, v25
  v_add_f32 v26, v26, v27
  s_nop 1
  v_permlane16_swap_b32 v24, v26
  v_add_f32 v24, v24, v26
  v_cvt_pk_bf16_f32 v24, v24, v17
  v_min_u32 v24, s90, v24
  v_cndmask_b32 v24, v24, -1, s[78:79]
  buffer_store_short v24, v10, s[40:43], s64 offen
  s_nop 15
  s_nop 15
  s_nop 15
  s_nop 1
  s_branch L_poll2_f
L_retry2_f:
  s_waitcnt vmcnt(0)
  v_max3_u32 v44, v28, v29, v30
  v_max3_u32 v45, v31, v36, v37
  v_max3_u32 v44, v44, v38, v39
  v_max_u32 v44, v44, v45
  v_cmp_eq_u32 vcc, -1, v44
  v_mov_b64 v[20:21], v[28:29]
  v_mov_b64 v[22:23], v[30:31]
  v_mov_b64 v[24:25], v[36:37]
  v_mov_b64 v[26:27], v[38:39]
  v_mov_b64 v[52:53], 0
  v_mov_b64 v[54:55], 0
  v_mov_b64 v[56:57], 0
  v_mov_b64 v[58:59], 0
  s_cbranch_vccz L_entry_f
  buffer_load_dwordx4 v[20:23], v2, s[40:43], s63 offen sc1
  buffer_load_dwordx4 v[24:27], v2, s[40:43], s63 offen offset:1024 sc1
  s_add_u32 s67, s67, 1
  s_cmp_gt_u32 s67, 1048576
  s_cbranch_scc1 L_exit
  s_nop 15
  s_nop 3
  buffer_load_dwordx4 v[28:31], v2, s[40:43], s63 offen sc1
  buffer_load_dwordx4 v[36:39], v2, s[40:43], s63 offen offset:1024 sc1
  s_branch L_entry_f
L_retry1_f:
  buffer_load_dwordx4 v[28:31], v9, s[40:43], s62 offen sc1
  buffer_load_dwordx4 v[32:35], v9, s[40:43], s62 offen offset:1024 sc1
  s_waitcnt vmcnt(3)
  v_mfma_f32_16x16x32_bf16 v[24:27], v[36:39], v[20:23], 0
  v_bitop3_b32 v44, v36, v38, s65 bitop3:0x7e
  s_waitcnt vmcnt(2)
  v_mfma_f32_16x16x32_bf16 v[24:27], v[40:43], v[20:23], v[24:27]
  v_bitop3_b32 v45, v40, v42, s65 bitop3:0x7e
  v_or_b32 v44, v44, v45
  v_and_b32 v44, 1, v44
  v_cmp_ne_u32 vcc, 0, v44
  s_nop 2
  s_cbranch_vccnz L_retry1b_f
  v_add_f32 v24, v24, v25
  v_add_f32 v26, v26, v27
  s_nop 1
  v_permlane16_swap_b32 v24, v26
  v_add_f32 v24, v24, v26
  v_cvt_pk_bf16_f32 v24, v24, v17
  v_min_u32 v24, s90, v24
  v_cndmask_b32 v24, v24, -1, s[78:79]
  buffer_store_short v24, v10, s[40:43], s64 offen
  s_nop 15
  s_nop 15
  s_nop 15
  s_nop 1
  s_branch L_poll2_f
L_retry1b_f:
  buffer_load_dwordx4 v[36:39], v9, s[40:43], s62 offen sc1
  buffer_load_dwordx4 v[40:43], v9, s[40:43], s62 offen offset:1024 sc1
  s_add_u32 s67, s67, 1
  s_cmp_gt_u32 s67, 1048576
  s_cbranch_scc1 L_exit
  s_branch L_poll1b_f
L_smslow_f:
  v_max3_f32 v30, v52, v53, v54
  v_max3_f32 v30, v30, v55, v56
  v_max3_f32 v30, v30, v57, v58
  v_max3_f32 v30, v30, v59, v60
  v_max_f32 v30, v30, v61
  v_mov_b32 v28, v30
  s_nop 1
  v_permlane32_swap_b32 v28, v30
  v_max_f32 v30, v30, v28
  v_mov_b32 v28, v30
  s_nop 1
  v_permlane16_swap_b32 v28, v30
  v_max_f32 v30, v30, v28
  v_sub_f32 v28, v52, v30
  v_sub_f32 v29, v53, v30
  v_exp_f32 v28, v28
  v_exp_f32 v29, v29
  s_nop 0
  v_cvt_pk_bf16_f32 v32, v28, v29
  v_sub_f32 v28, v54, v30
  v_sub_f32 v29, v55, v30
  v_exp_f32 v28, v28
  v_exp_f32 v29, v29
  s_nop 0
  v_cvt_pk_bf16_f32 v33, v28, v29
  v_sub_f32 v28, v56, v30
  v_sub_f32 v29, v57, v30
  v_exp_f32 v28, v28
  v_exp_f32 v29, v29
  s_nop 0
  v_cvt_pk_bf16_f32 v34, v28, v29
  v_sub_f32 v28, v58, v30
  v_sub_f32 v29, v59, v30
  v_exp_f32 v28, v28
  v_exp_f32 v29, v29
  s_nop 0
  v_cvt_pk_bf16_f32 v35, v28, v29
  v_sub_f32 v28, v60, v30
  v_sub_f32 v29, v61, v30
  v_exp_f32 v28, v28
  v_exp_f32 v29, v29
  s_nop 0
  v_cvt_pk_bf16_f32 v16, v28, v29
  v_cvt_pk_bf16_f32 v19, v28, v29
  s_nop 1
  v_mfma_f32_16x16x32_bf16 v[64:67], v[12:15], v[32:35], 0
  v_mfma_f32_16x16x32_bf16 v[80:83], v[116:119], v[32:35], 0
  v_mfma_f32_16x16x32_bf16 v[84:87], v[120:123], v[32:35], 0
  s_nop 3
  v_mfma_f32_16x16x16_bf16 v[64:67], v[12:13], v[16:17], v[64:67]
  v_mfma_f32_16x16x16_bf16 v[80:83], v[126:127], v[16:17], v[80:83]
  v_mfma_f32_16x16x16_bf16 v[84:87], v[126:127], v[18:19], v[84:87]
  s_nop 7
  v_rcp_f32 v65, v64
  s_mov_b64 vcc, 0
  s_branch L_smback_f
L_fs_f:
  buffer_load_dword v4, v17, s[40:43], s60 offen sc1
  s_add_u32 s67, s67, 1
  s_cmp_gt_u32 s67, 1048576
  s_cbranch_scc1 L_exit
  s_waitcnt vmcnt(0)
  v_cmp_gt_u32 vcc, s92, v4
  s_cbranch_vccnz L_fs_f
  s_branch L_fsback_f
L_poll2_x:
  buffer_load_dwordx4 v[20:23], v2, s[40:43], s63 offen sc1
  buffer_load_dwordx4 v[24:27], v2, s[40:43], s63 offen offset:1024 sc1
  s_nop 15
  s_nop 6
  buffer_load_dwordx4 v[28:31], v2, s[40:43], s63 offen sc1
  buffer_load_dwordx4 v[36:39], v2, s[40:43], s63 offen offset:1024 sc1
  ds_read_b128 v[116:119], v2 offset:8192
  ds_read_b128 v[120:123], v2 offset:9216
  v_readlane_b32 s69, v4, 1
  v_xor_b32 v10, 0x2000, v10
  s_waitcnt vmcnt(5)
  v_xor_b32 v32, 2048, v2
  v_xor_b32 v40, 4096, v2
  v_xor_b32 v48, 6144, v2
  s_cmp_lt_u32 s69, s92
  s_cbranch_scc1 L_fs_x
L_fsback_x:
  s_add_u32 s56, s56, 1
  s_xor_b32 s65, s65, 1
  s_add_u32 s68, s56, 1
  s_min_u32 s68, s68, 63
  s_lshl_b32 s68, s68, 13
  s_add_u32 s57, s72, s68
  s_add_u32 s58, s57, 0x1000000
  s_add_u32 s68, s56, 3
  s_min_u32 s92, s68, 64
  s_add_u32 s61, s61, 0x20000
  s_xor_b32 s70, s70, 0x2000
  v_min_u32 v124, -2, v124
  v_bfe_u32 v45, v2, 9, 1
  v_and_b32 v4, 0x1ff, v2
  v_lshlrev_b32 v4, 2, v4
  s_add_u32 s59, s57, s73
  v_lshl_add_u32 v4, v45, 24, v4
  s_sub_u32 s68, s60, s59
  v_writelane_b32 v4, s68, 1
L_entry_x:
  s_waitcnt vmcnt(3)
  ds_write_b128 v2, v[20:23] offset:0
  v_smfmac_f32_16x16x64_bf16 v[52:55], v[20:23], a[0:7], v1
  s_waitcnt vmcnt(2)
  ds_write_b128 v2, v[24:27] offset:1024
  v_max3_u32 v44, v20, v21, v22
  v_max3_u32 v44, v44, v23, v24
  v_max3_u32 v44, v44, v25, v26
  v_max_u32 v44, v44, v27
  v_cmp_eq_u32 vcc, -1, v44
  v_smfmac_f32_16x16x64_bf16 v[56:59], v[20:23], a[64:71], v1
  s_mov_b32 m0, s70
  v_smfmac_f32_16x16x64_bf16 v[52:55], v[24:27], a[8:15], v1
  s_cbranch_vccnz L_retry2_x
  buffer_load_dwordx4 v2, s[40:43], s57 offen offset:0 sc1 lds
  v_smfmac_f32_16x16x64_bf16 v[56:59], v[24:27], a[72:79], v1
  buffer_load_dwordx4 v2, s[40:43], s57 offen offset:1024 sc1 lds
  s_mov_b32 m0, s71
  v_smfmac_f32_16x16x64_bf16 v[60:63], v[20:23], a[128:135], v1
  s_waitcnt lgkmcnt(2)
  buffer_load_dwordx4 v2, s[40:43], s58 offen offset:0 sc1 lds
  v_smfmac_f32_16x16x64_bf16 v[64:67], v[20:23], a[192:199], v1
  buffer_load_dwordx4 v2, s[40:43], s58 offen offset:1024 sc1 lds
  v_smfmac_f32_16x16x64_bf16 v[60:63], v[24:27], a[136:143], v1
  s_waitcnt vmcnt(4) lgkmcnt(0)
  s_barrier
  ds_read_b128 v[28:31], v32 offset:0
  ds_read_b128 v[32:35], v32 offset:1024
  v_smfmac_f32_16x16x64_bf16 v[64:67], v[24:27], a[200:207], v1
  ds_read_b128 v[36:39], v40 offset:0
  buffer_load_dword v4, v4, s[40:43], s59 offen sc1
  v_smfmac_f32_16x16x64_bf16 v[68:71], v[20:23], v[76:83], v1
  ds_read_b128 v[40:43], v40 offset:1024
  ds_read_b128 v[44:47], v48 offset:0
  v_smfmac_f32_16x16x64_bf16 v[72:75], v[20:23], v[84:91], v1
  ds_read_b128 v[48:51], v48 offset:1024
  v_smfmac_f32_16x16x64_bf16 v[68:71], v[24:27], v[92:99], v1
  buffer_store_dwordx4 v[124:127], v2, s[40:43], s61 offen sc1
  v_smfmac_f32_16x16x64_bf16 v[72:75], v[24:27], v[100:107], v1
  s_waitcnt lgkmcnt(5)
  ds_read_b128 v[76:79], v3 offset:16384
  v_smfmac_f32_16x16x64_bf16 v[52:55], v[28:31], a[16:23], v1
  s_waitcnt lgkmcnt(5)
  ds_read_b128 v[20:23], v3 offset:2048
  v_smfmac_f32_16x16x64_bf16 v[52:55], v[32:35], a[24:31], v1
  s_waitcnt lgkmcnt(5)
  ds_read_b128 v[24:27], v3 offset:3072
  v_smfmac_f32_16x16x64_bf16 v[52:55], v[36:39], a[32:39], v1
  s_waitcnt lgkmcnt(5)
  ds_read_b128 v[80:83], v3 offset:17408
  v_smfmac_f32_16x16x64_bf16 v[52:55], v[40:43], a[40:47], v1
  s_waitcnt lgkmcnt(4)
  ds_read_b128 v[84:87], v3 offset:18432
  v_smfmac_f32_16x16x64_bf16 v[52:55], v[44:47], a[48:55], v1
  ds_read_b128 v[88:91], v3 offset:19456
  v_smfmac_f32_16x16x64_bf16 v[52:55], v[48:51], a[56:63], v1
  s_nop 0
  ds_read_b128 v[92:95], v0 offset:0
  v_xor_b32 v3, 0x18000, v3
  v_smfmac_f32_16x16x64_bf16 v[68:71], v[28:31], v[108:115], v1
  s_nop 0
  ds_read_b128 v[96:99], v0 offset:2048
  v_smfmac_f32_16x16x64_bf16 v[56:59], v[28:31], a[80:87], v1
  s_nop 0
  ds_read_b128 v[108:111], v3 offset:0
  v_add_f32 v52, v52, v53
  v_smfmac_f32_16x16x64_bf16 v[56:59], v[32:35], a[88:95], v1
  s_waitcnt lgkmcnt(6)
  ds_read_b128 v[112:115], v3 offset:1024
  v_add_f32 v54, v54, v55
  v_smfmac_f32_16x16x64_bf16 v[72:75], v[28:31], v[20:27], v1
  ds_read_b128 v[100:103], v0 offset:4096
  v_mul_f32 v52, s88, v52
  v_smfmac_f32_16x16x64_bf16 v[56:59], v[36:39], a[96:103], v1
  ds_read_b128 v[20:23], v3 offset:2048
  v_mul_f32 v54, s88, v54
  v_smfmac_f32_16x16x64_bf16 v[56:59], v[40:43], a[104:111], v1
  ds_read_b128 v[24:27], v3 offset:3072
  v_cvt_pk_bf16_f32 v52, v52, v52
  v_smfmac_f32_16x16x64_bf16 v[56:59], v[44:47], a[112:119], v1
  s_barrier
  v_cvt_pk_bf16_f32 v53, v54, v54
  v_smfmac_f32_16x16x64_bf16 v[56:59], v[48:51], a[120:127], v1
  s_waitcnt lgkmcnt(7)
  ds_write_b64 v5, v[52:53] offset:0
  v_smfmac_f32_16x16x64_bf16 v[68:71], v[32:35], v[76:83], v1
  s_nop 0
  ds_read_b128 v[104:107], v0 offset:6144
  v_smfmac_f32_16x16x64_bf16 v[72:75], v[32:35], v[84:91], v1
  s_nop 0
  ds_read_b128 v[76:79], v3 offset:16384
  v_add_f32 v56, v56, v57
  v_smfmac_f32_16x16x64_bf16 v[60:63], v[28:31], a[144:151], v1
  ds_read_b128 v[80:83], v3 offset:17408
  v_add_f32 v58, v58, v59
  v_smfmac_f32_16x16x64_bf16 v[60:63], v[32:35], a[152:159], v1
  s_waitcnt lgkmcnt(4)
  ds_read_b128 v[84:87], v3 offset:18432
  v_mul_f32 v56, s88, v56
  v_smfmac_f32_16x16x64_bf16 v[68:71], v[36:39], v[108:115], v1
  ds_read_b128 v[88:91], v3 offset:19456
  v_mul_f32 v58, s88, v58
  v_smfmac_f32_16x16x64_bf16 v[60:63], v[36:39], a[160:167], v1
  v_cvt_pk_bf16_f32 v56, v56, v56
  v_smfmac_f32_16x16x64_bf16 v[72:75], v[36:39], v[20:27], v1
  v_cvt_pk_bf16_f32 v57, v58, v58
  v_smfmac_f32_16x16x64_bf16 v[60:63], v[40:43], a[168:175], v1
  ds_write_b64 v5, v[56:57] offset:2048
  v_xor_b32 v3, 0x8000, v3
  v_smfmac_f32_16x16x64_bf16 v[60:63], v[44:47], a[176:183], v1
  ds_read_b128 v[108:111], v3 offset:0
  v_smfmac_f32_16x16x64_bf16 v[60:63], v[48:51], a[184:191], v1
  s_waitcnt lgkmcnt(2)
  ds_read_b128 v[112:115], v3 offset:1024
  v_smfmac_f32_16x16x64_bf16 v[68:71], v[40:43], v[76:83], v1
  s_nop 0
  ds_read_b128 v[20:23], v3 offset:16384
  v_smfmac_f32_16x16x64_bf16 v[72:75], v[40:43], v[84:91], v1
  s_nop 0
  ds_read_b128 v[24:27], v3 offset:17408
  v_add_f32 v60, v60, v61
  v_smfmac_f32_16x16x64_bf16 v[64:67], v[28:31], a[208:215], v1
  s_waitcnt lgkmcnt(4)
  s_barrier
  v_add_f32 v62, v62, v63
  v_smfmac_f32_16x16x64_bf16 v[64:67], v[32:35], a[216:223], v1
  ds_read_b64_tr_b16 v[76:77], v6 offset:0
  ds_read_b64_tr_b16 v[78:79], v6 offset:2048
  v_smfmac_f32_16x16x64_bf16 v[64:67], v[36:39], a[224:231], v1
  ds_read_b64_tr_b16 v[80:81], v6 offset:512
  ds_read_b64_tr_b16 v[82:83], v6 offset:2560
  v_smfmac_f32_16x16x64_bf16 v[64:67], v[40:43], a[232:239], v1
  ds_read_b64_tr_b16 v[84:85], v6 offset:1024
  ds_read_b64_tr_b16 v[86:87], v6 offset:3072
  v_smfmac_f32_16x16x64_bf16 v[64:67], v[44:47], a[240:247], v1
  ds_read_b64_tr_b16 v[88:89], v6 offset:1536
  ds_read_b64_tr_b16 v[90:91], v6 offset:3584
  v_smfmac_f32_16x16x64_bf16 v[64:67], v[48:51], a[248:255], v1
  s_waitcnt lgkmcnt(8)
  ds_read_b128 v[28:31], v0 offset:1024
  v_cvt_pk_bf16_f32 v124, v60, v62
  v_smfmac_f32_16x16x64_bf16 v[68:71], v[44:47], v[108:115], v1
  s_nop 0
  ds_read_b128 v[32:35], v0 offset:3072
  v_smfmac_f32_16x16x64_bf16 v[68:71], v[48:51], v[20:27], v1
  s_waitcnt lgkmcnt(2)
  ds_read_b128 v[36:39], v0 offset:5120
  v_add_f32 v64, v64, v65
  v_mfma_f32_16x16x32_bf16 v[52:55], v[92:95], v[76:79], 0
  v_add_f32 v66, v66, v67
  v_cvt_pk_bf16_f32 v125, v64, v66
  v_mfma_f32_16x16x32_bf16 v[52:55], v[96:99], v[80:83], v[52:55]
  ds_write2st64_b32 v5, v124, v125 offset0:16 offset1:24
  ds_read_b128 v[40:43], v0 offset:7168
  v_mfma_f32_16x16x32_bf16 v[52:55], v[100:103], v[84:87], v[52:55]
  ds_read_b128 v[108:111], v3 offset:2048
  v_add_f32 v68, v68, v69
  v_mfma_f32_16x16x32_bf16 v[52:55], v[104:107], v[88:91], v[52:55]
  s_waitcnt lgkmcnt(3)
  ds_read_b128 v[112:115], v3 offset:3072
  v_add_f32 v70, v70, v71
  v_mfma_f32_16x16x32_bf16 v[56:59], v[28:31], v[76:79], 0
  ds_read_b128 v[20:23], v3 offset:18432
  v_cvt_pk_bf16_f32 v126, v68, v70
  v_mfma_f32_16x16x32_bf16 v[56:59], v[32:35], v[80:83], v[56:59]
  ds_read_b128 v[24:27], v3 offset:19456
  v_mfma_f32_16x16x32_bf16 v[56:59], v[36:39], v[84:87], v[56:59]
  s_waitcnt lgkmcnt(4)
  s_barrier
  ds_read_b64_tr_b16 v[92:93], v6 offset:4096
  ds_read_b64_tr_b16 v[94:95], v6 offset:6144
  v_mfma_f32_16x16x32_bf16 v[56:59], v[40:43], v[88:91], v[56:59]
  s_waitcnt lgkmcnt(4)
  ds_read_b64_tr_b16 v[96:97], v6 offset:4608
  ds_read_b64_tr_b16 v[98:99], v6 offset:6656
  v_smfmac_f32_16x16x64_bf16 v[72:75], v[44:47], v[108:115], v1
  s_waitcnt lgkmcnt(4)
  ds_read_b64_tr_b16 v[100:101], v6 offset:5120
  ds_read_b64_tr_b16 v[102:103], v6 offset:7168
  v_smfmac_f32_16x16x64_bf16 v[72:75], v[48:51], v[20:27], v1
  ds_read_b64_tr_b16 v[104:105], v6 offset:5632
  ds_read_b64_tr_b16 v[106:107], v6 offset:7680
  v_exp_f32 v28, v52
  v_exp_f32 v29, v53
  v_exp_f32 v30, v54
  s_waitcnt lgkmcnt(4)
  v_mfma_f32_16x16x32_bf16 v[60:63], v[92:95], v[76:79], 0
  v_exp_f32 v31, v55
  v_mfma_f32_16x16x32_bf16 v[60:63], v[96:99], v[80:83], v[60:63]
  s_waitcnt lgkmcnt(0)
  v_exp_f32 v36, v56
  v_mfma_f32_16x16x32_bf16 v[60:63], v[100:103], v[84:87], v[60:63]
  v_exp_f32 v37, v57
  v_mfma_f32_16x16x32_bf16 v[60:63], v[104:107], v[88:91], v[60:63]
  s_cmp_eq_u32 s56, 63
  v_exp_f32 v38, v58
  v_exp_f32 v39, v59
  v_cvt_pk_bf16_f32 v32, v28, v29
  v_cvt_pk_bf16_f32 v33, v30, v31
  v_cvt_pk_bf16_f32 v34, v36, v37
  v_cvt_pk_bf16_f32 v35, v38, v39
  v_add_f32 v72, v72, v73
  v_exp_f32 v28, v60
  v_mfma_f32_16x16x32_bf16 v[64:67], v[12:15], v[32:35], 0
  v_exp_f32 v29, v61
  v_mfma_f32_16x16x32_bf16 v[80:83], v[116:119], v[32:35], 0
  v_add_f32 v74, v74, v75
  v_cvt_pk_bf16_f32 v16, v28, v29
  v_mfma_f32_16x16x32_bf16 v[84:87], v[120:123], v[32:35], 0
  v_cvt_pk_bf16_f32 v127, v72, v74
  v_cvt_pk_bf16_f32 v19, v28, v29
  v_mfma_f32_16x16x16_bf16 v[64:67], v[12:13], v[16:17], v[64:67]
  s_cbranch_scc1 L_team_last
  v_xor_b32 v3, 0x18000, v3
  v_mov_b64 v[44:45], 0
  v_mfma_f32_16x16x16_bf16 v[80:83], v[126:127], v[16:17], v[80:83]
  s_nop 0
  v_mov_b64 v[46:47], 0
  v_mov_b64 v[48:49], 0
  v_mfma_f32_16x16x16_bf16 v[84:87], v[126:127], v[18:19], v[84:87]
  v_rcp_f32 v65, v64
  v_subrev_u32 v66, s89, v64
  v_cmp_le_u32 vcc, s91, v66
  v_mov_b64 v[50:51], 0
L_smback_x:
  v_mul_f32 v80, v80, v65
  v_mul_f32 v81, v81, v65
  v_mul_f32 v82, v82, v65
  v_mul_f32 v83, v83, v65
  v_cvt_pk_bf16_f32 v88, v80, v81
  v_cvt_pk_bf16_f32 v89, v82, v83
  ds_write_b64 v7, v[88:89]
  v_mul_f32 v84, v84, v65
  v_mul_f32 v85, v85, v65
  v_mul_f32 v86, v86, v65
  v_mul_f32 v87, v87, v65
  v_cvt_pk_bf16_f32 v90, v84, v85
  v_cvt_pk_bf16_f32 v91, v86, v87
  s_cbranch_vccnz L_smslow_x
  ds_write_b64 v7, v[90:91] offset:8
  v_xor_b32 v96, 512, v7
  v_xor_b32 v100, 1024, v7
  v_xor_b32 v104, 1536, v7
  v_mov_b64 v[36:37], 0
  v_mov_b64 v[38:39], 0
  v_mov_b64 v[40:41], 0
  v_mov_b64 v[42:43], 0
  v_lshrrev_b32 v24, 16, v12
  v_cndmask_b32 v24, v24, 1.0, s[94:95]
  v_cndmask_b32 v20, 0, v24, s[80:81]
  v_cndmask_b32 v21, 0, v24, s[82:83]
  v_cndmask_b32 v22, 0, v24, s[84:85]
  v_cndmask_b32 v23, 0, v24, s[86:87]
  v_smfmac_f32_16x16x64_bf16 v[48:51], v[88:91], v[224:231], v1
  s_waitcnt lgkmcnt(0)
  s_barrier
  ds_read_b128 v[96:99], v96
  v_smfmac_f32_16x16x64_bf16 v[44:47], v[88:91], v[192:199], v1
  ds_read_b128 v[100:103], v100
  ds_read_b128 v[104:107], v104
  v_smfmac_f32_16x16x64_bf16 v[40:43], v[88:91], v[160:167], v1
  v_mov_b64 v[60:61], 0
  v_smfmac_f32_16x16x64_bf16 v[36:39], v[88:91], v[128:135], v1
  v_mov_b64 v[62:63], 0
  v_mov_b64 v[64:65], 0
  v_mov_b64 v[66:67], 0
  s_waitcnt lgkmcnt(2)
  v_smfmac_f32_16x16x64_bf16 v[36:39], v[96:99], v[136:143], v1
  s_waitcnt lgkmcnt(1)
  v_mov_b64 v[52:53], 0
  v_smfmac_f32_16x16x64_bf16 v[36:39], v[100:103], v[144:151], v1
  s_waitcnt lgkmcnt(0)
  v_mov_b64 v[54:55], 0
  v_smfmac_f32_16x16x64_bf16 v[36:39], v[104:107], v[152:159], v1
  s_nop 1
  v_mov_b64 v[56:57], 0
  v_smfmac_f32_16x16x64_bf16 v[40:43], v[96:99], v[168:175], v1
  s_nop 1
  v_mov_b64 v[58:59], 0
  v_smfmac_f32_16x16x64_bf16 v[40:43], v[100:103], v[176:183], v1
  v_cvt_pk_bf16_f32 v36, v36, v37
  v_cvt_pk_bf16_f32 v37, v38, v39
  v_and_or_b32 v36, v36, -2, s65
  v_smfmac_f32_16x16x64_bf16 v[40:43], v[104:107], v[184:191], v1
  s_nop 1
  buffer_store_dwordx2 v[36:37], v8, s[40:43], s74 offen sc1
  v_smfmac_f32_16x16x64_bf16 v[44:47], v[96:99], v[200:207], v1
  s_nop 2
  v_smfmac_f32_16x16x64_bf16 v[44:47], v[100:103], v[208:215], v1
  v_cvt_pk_bf16_f32 v40, v40, v41
  v_cvt_pk_bf16_f32 v41, v42, v43
  v_and_or_b32 v40, v40, -2, s65
  v_smfmac_f32_16x16x64_bf16 v[44:47], v[104:107], v[216:223], v1
  s_nop 1
  buffer_store_dwordx2 v[40:41], v8, s[40:43], s75 offen sc1
  v_smfmac_f32_16x16x64_bf16 v[48:51], v[96:99], v[232:239], v1
  s_nop 2
  v_smfmac_f32_16x16x64_bf16 v[48:51], v[100:103], v[240:247], v1
  v_cvt_pk_bf16_f32 v44, v44, v45
  v_cvt_pk_bf16_f32 v45, v46, v47
  v_and_or_b32 v44, v44, -2, s65
  v_smfmac_f32_16x16x64_bf16 v[48:51], v[104:107], v[248:255], v1
  s_nop 1
  buffer_store_dwordx2 v[44:45], v8, s[40:43], s76 offen sc1
  s_nop 4
  v_cvt_pk_bf16_f32 v48, v48, v49
  v_cvt_pk_bf16_f32 v49, v50, v51
  v_and_or_b32 v48, v48, -2, s65
  buffer_store_dwordx2 v[48:49], v8, s[40:43], s77 offen sc1
  s_barrier
  s_nop 15
  s_nop 9
  s_cmp_lt_u32 s44, 1
  s_cbranch_scc1 L_poll1_x
  s_nop 9
  s_cmp_lt_u32 s44, 2
  s_cbranch_scc1 L_poll1_x
  s_nop 9
  s_cmp_lt_u32 s44, 3
  s_cbranch_scc1 L_poll1_x
  s_nop 9
L_poll1_x:
  buffer_load_dwordx4 v[28:31], v9, s[40:43], s62 offen sc1
  buffer_load_dwordx4 v[32:35], v9, s[40:43], s62 offen offset:1024 sc1
  v_mov_b64 v[64:65], 0
  v_mov_b64 v[66:67], 0
  v_mov_b64 v[68:69], 0
  v_mov_b64 v[70:71], 0
  v_mov_b64 v[72:73], 0
  v_mov_b64 v[74:75], 0
  s_xor_b32 s63, s63, 0x2000
  v_xor_b32 v0, 0x2000, v0
  v_xor_b32 v7, 0x2000, v7
  s_nop 15
  s_nop 3
  buffer_load_dwordx4 v[36:39], v9, s[40:43], s62 offen sc1
  buffer_load_dwordx4 v[40:43], v9, s[40:43], s62 offen offset:1024 sc1
  ds_read_b128 v[76:79], v3 offset:0
  ds_read_b128 v[80:83], v3 offset:1024
  ds_read_b128 v[84:87], v3 offset:2048
  ds_read_b128 v[88:91], v3 offset:3072
  ds_read_b128 v[92:95], v3 offset:16384
  ds_read_b128 v[96:99], v3 offset:17408
  ds_read_b128 v[100:103], v3 offset:18432
  ds_read_b128 v[104:107], v3 offset:19456
  v_xor_b32 v3, 0x8000, v3
  ds_read_b128 v[108:111], v3 offset:0
  ds_read_b128 v[112:115], v3 offset:1024
L_poll1b_x:
  s_waitcnt vmcnt(3)
  v_mfma_f32_16x16x32_bf16 v[24:27], v[28:31], v[20:23], 0
  v_bitop3_b32 v44, v28, v30, s65 bitop3:0x7e
  s_waitcnt vmcnt(2)
  v_mfma_f32_16x16x32_bf16 v[24:27], v[32:35], v[20:23], v[24:27]
  v_bitop3_b32 v45, v32, v34, s65 bitop3:0x7e
  v_or_b32 v44, v44, v45
  v_and_b32 v44, 1, v44
  v_cmp_ne_u32 vcc, 0, v44
  s_nop 2
  s_cbranch_vccnz L_retry1_x
L_got1_x:
  v_add_f32 v24, v24, v25
  v_add_f32 v26, v26, v27
  s_nop 1
  v_permlane16_swap_b32 v24, v26
  v_add_f32 v24, v24, v26
  v_cvt_pk_bf16_f32 v24, v24, v17
  v_min_u32 v24, s90, v24
  v_cndmask_b32 v24, v24, -1, s[78:79]
  buffer_store_short v24, v10, s[40:43], s64 offen sc1
  s_nop 15
  s_nop 15
  s_nop 15
  s_nop 1
  s_branch L_poll2_x
L_retry2_x:
  s_waitcnt vmcnt(0)
  v_max3_u32 v44, v28, v29, v30
  v_max3_u32 v45, v31, v36, v37
  v_max3_u32 v44, v44, v38, v39
  v_max_u32 v44, v44, v45
  v_cmp_eq_u32 vcc, -1, v44
  v_mov_b64 v[20:21], v[28:29]
  v_mov_b64 v[22:23], v[30:31]
  v_mov_b64 v[24:25], v[36:37]
  v_mov_b64 v[26:27], v[38:39]
  v_mov_b64 v[52:53], 0
  v_mov_b64 v[54:55], 0
  v_mov_b64 v[56:57], 0
  v_mov_b64 v[58:59], 0
  s_cbranch_vccz L_entry_x
  buffer_load_dwordx4 v[20:23], v2, s[40:43], s63 offen sc1
  buffer_load_dwordx4 v[24:27], v2, s[40:43], s63 offen offset:1024 sc1
  s_add_u32 s67, s67, 1
  s_cmp_gt_u32 s67, 1048576
  s_cbranch_scc1 L_exit
  s_nop 15
  s_nop 3
  buffer_load_dwordx4 v[28:31], v2, s[40:43], s63 offen sc1
  buffer_load_dwordx4 v[36:39], v2, s[40:43], s63 offen offset:1024 sc1
  s_branch L_entry_x
L_retry1_x:
  buffer_load_dwordx4 v[28:31], v9, s[40:43], s62 offen sc1
  buffer_load_dwordx4 v[32:35], v9, s[40:43], s62 offen offset:1024 sc1
  s_waitcnt vmcnt(3)
  v_mfma_f32_16x16x32_bf16 v[24:27], v[36:39], v[20:23], 0
  v_bitop3_b32 v44, v36, v38, s65 bitop3:0x7e
  s_waitcnt vmcnt(2)
  v_mfma_f32_16x16x32_bf16 v[24:27], v[40:43], v[20:23], v[24:27]
  v_bitop3_b32 v45, v40, v42, s65 bitop3:0x7e
  v_or_b32 v44, v44, v45
  v_and_b32 v44, 1, v44
  v_cmp_ne_u32 vcc, 0, v44
  s_nop 2
  s_cbranch_vccnz L_retry1b_x
  v_add_f32 v24, v24, v25
  v_add_f32 v26, v26, v27
  s_nop 1
  v_permlane16_swap_b32 v24, v26
  v_add_f32 v24, v24, v26
  v_cvt_pk_bf16_f32 v24, v24, v17
  v_min_u32 v24, s90, v24
  v_cndmask_b32 v24, v24, -1, s[78:79]
  buffer_store_short v24, v10, s[40:43], s64 offen sc1
  s_nop 15
  s_nop 15
  s_nop 15
  s_nop 1
  s_branch L_poll2_x
L_retry1b_x:
  buffer_load_dwordx4 v[36:39], v9, s[40:43], s62 offen sc1
  buffer_load_dwordx4 v[40:43], v9, s[40:43], s62 offen offset:1024 sc1
  s_add_u32 s67, s67, 1
  s_cmp_gt_u32 s67, 1048576
  s_cbranch_scc1 L_exit
  s_branch L_poll1b_x
L_smslow_x:
  v_max3_f32 v30, v52, v53, v54
  v_max3_f32 v30, v30, v55, v56
  v_max3_f32 v30, v30, v57, v58
  v_max3_f32 v30, v30, v59, v60
  v_max_f32 v30, v30, v61
  v_mov_b32 v28, v30
  s_nop 1
  v_permlane32_swap_b32 v28, v30
  v_max_f32 v30, v30, v28
  v_mov_b32 v28, v30
  s_nop 1
  v_permlane16_swap_b32 v28, v30
  v_max_f32 v30, v30, v28
  v_sub_f32 v28, v52, v30
  v_sub_f32 v29, v53, v30
  v_exp_f32 v28, v28
  v_exp_f32 v29, v29
  s_nop 0
  v_cvt_pk_bf16_f32 v32, v28, v29
  v_sub_f32 v28, v54, v30
  v_sub_f32 v29, v55, v30
  v_exp_f32 v28, v28
  v_exp_f32 v29, v29
  s_nop 0
  v_cvt_pk_bf16_f32 v33, v28, v29
  v_sub_f32 v28, v56, v30
  v_sub_f32 v29, v57, v30
  v_exp_f32 v28, v28
  v_exp_f32 v29, v29
  s_nop 0
  v_cvt_pk_bf16_f32 v34, v28, v29
  v_sub_f32 v28, v58, v30
  v_sub_f32 v29, v59, v30
  v_exp_f32 v28, v28
  v_exp_f32 v29, v29
  s_nop 0
  v_cvt_pk_bf16_f32 v35, v28, v29
  v_sub_f32 v28, v60, v30
  v_sub_f32 v29, v61, v30
  v_exp_f32 v28, v28
  v_exp_f32 v29, v29
  s_nop 0
  v_cvt_pk_bf16_f32 v16, v28, v29
  v_cvt_pk_bf16_f32 v19, v28, v29
  s_nop 1
  v_mfma_f32_16x16x32_bf16 v[64:67], v[12:15], v[32:35], 0
  v_mfma_f32_16x16x32_bf16 v[80:83], v[116:119], v[32:35], 0
  v_mfma_f32_16x16x32_bf16 v[84:87], v[120:123], v[32:35], 0
  s_nop 3
  v_mfma_f32_16x16x16_bf16 v[64:67], v[12:13], v[16:17], v[64:67]
  v_mfma_f32_16x16x16_bf16 v[80:83], v[126:127], v[16:17], v[80:83]
  v_mfma_f32_16x16x16_bf16 v[84:87], v[126:127], v[18:19], v[84:87]
  s_nop 7
  v_rcp_f32 v65, v64
  s_mov_b64 vcc, 0
  s_branch L_smback_x
L_fs_x:
  buffer_load_dword v4, v17, s[40:43], s60 offen sc1
  s_add_u32 s67, s67, 1
  s_cmp_gt_u32 s67, 1048576
  s_cbranch_scc1 L_exit
  s_waitcnt vmcnt(0)
  v_cmp_gt_u32 vcc, s92, v4
  s_cbranch_vccnz L_fs_x
  s_branch L_fsback_x
L_team_last:
  s_add_u32 s61, s61, 0x20000
  v_min_u32 v124, -2, v124
  buffer_store_dwordx4 v[124:127], v2, s[40:43], s61 offen sc1
  s_waitcnt vmcnt(0)
  s_endpgm
L_exit:
  s_endpgm
.p2align 8
.type L_ptab,@object
L_ptab:
.long 0xd,0x10,0x1047005,0xe,0,0xc0,0x1e,0x180,0x240,4,4,4,4,4,4,4,4,4,4,4,4,4,4,4,4,4,4,4,4,4,4,4
.long 0x1d,0x10,0x1047015,0xe,0x1000,0x10c0,0x1e,0x1180,0x1240,4,4,4,4,4,4,4,4,4,4,4,4,4,4,4,4,4,4,4,4,4,4,4
.long 0x2d,0x10,0x1047025,0xe,0x2000,0x20c0,0x1e,0x2180,0x2240,4,4,4,4,4,4,4,4,4,4,4,4,4,4,4,4,4,4,4,4,4,4,4
.long 0x3d,0x10,0x1047035,0xe,0x3000,0x30c0,0x1e,0x3180,0x3240,4,4,4,4,4,4,4,4,4,4,4,4,4,4,4,4,4,4,4,4,4,4,4
.long 0x100d,0x32,0x846005,6,0x20,0x80,0xe0,0x140,0x1a0,0x200,0x260,0x2c0,0x320,0x380,0x3e0,4,4,4,4,4,4,4,4,4,4,4,4,4,4,4,4,4
.long 0x101d,0x32,0x846015,0x16,0x20,0x80,0xe0,0x140,0x1a0,0x200,0x260,0x2c0,0x320,0x380,0x3e0,4,4,4,4,4,4,4,4,4,4,4,4,4,4,4,4,4
.long 0x102d,0x32,0x846025,0x26,0x20,0x80,0xe0,0x140,0x1a0,0x200,0x260,0x2c0,0x320,0x380,0x3e0,4,4,4,4,4,4,4,4,4,4,4,4,4,4,4,4,4
.long 0x103d,0x32,0x846035,0x36,0x20,0x80,0xe0,0x140,0x1a0,0x200,0x260,0x2c0,0x320,0x380,0x3e0,4,4,4,4,4,4,4,4,4,4,4,4,4,4,4,4,4
.long 0x200d,0x54,0x1055005,0x1850005,0xe,0x10,0xd0,0x1e,0x190,0x250,4,4,4,4,4,4,4,4,4,4,4,4,4,4,4,4,4,4,4,4,4,4
.long 0x201d,0x54,0x1055015,0x1850015,0xe,0x1010,0x10d0,0x1e,0x1190,0x1250,4,4,4,4,4,4,4,4,4,4,4,4,4,4,4,4,4,4,4,4,4,4
.long 0x202d,0x54,0x1055025,0x1850025,0xe,0x2010,0x20d0,0x1e,0x2190,0x2250,4,4,4,4,4,4,4,4,4,4,4,4,4,4,4,4,4,4,4,4,4,4
.long 0x203d,0x54,0x1055035,0x1850035,0xe,0x3010,0x30d0,0x1e,0x3190,0x3250,4,4,4,4,4,4,4,4,4,4,4,4,4,4,4,4,4,4,4,4,4,4
.long 0x300d,0x76,0x854005,0x2051005,0xe,0x20,0xe0,0x1e,0x1a0,0x260,4,4,4,4,4,4,4,4,4,4,4,4,4,4,4,4,4,4,4,4,4,4
.long 0x301d,0x76,0x854015,0x2051015,0xe,0x1020,0x10e0,0x1e,0x11a0,0x1260,4,4,4,4,4,4,4,4,4,4,4,4,4,4,4,4,4,4,4,4,4,4
.long 0x302d,0x76,0x854025,0x2051025,0xe,0x2020,0x20e0,0x1e,0x21a0,0x2260,4,4,4,4,4,4,4,4,4,4,4,4,4,4,4,4,4,4,4,4,4,4
.long 0x303d,0x76,0x854035,0x2051035,0xe,0x3020,0x30e0,0x1e,0x31a0,0x3260,4,4,4,4,4,4,4,4,4,4,4,4,4,4,4,4,4,4,4,4,4,4
.long 0x400d,0x3276,0x2043005,6,0x40,0xa0,0x100,0x160,0x1c0,0x220,0x280,0x2e0,0x340,0x3a0,4,4,4,4,4,4,4,4,4,4,4,4,4,4,4,4,4,4
.long 0x401d,0x3276,0x2043015,0x16,0x40,0xa0,0x100,0x160,0x1c0,0x220,0x280,0x2e0,0x340,0x3a0,4,4,4,4,4,4,4,4,4,4,4,4,4,4,4,4,4,4
.long 0x402d,0x3276,0x2043025,0x26,0x40,0xa0,0x100,0x160,0x1c0,0x220,0x280,0x2e0,0x340,0x3a0,4,4,4,4,4,4,4,4,4,4,4,4,4,4,4,4,4,4
.long 0x403d,0x3276,0x2043035,0x36,0x40,0xa0,0x100,0x160,0x1c0,0x220,0x280,0x2e0,0x340,0x3a0,4,4,4,4,4,4,4,4,4,4,4,4,4,4,4,4,4,4
.long 0x500d,0x1054,0x1842005,6,0,0x60,0xc0,0x120,0x180,0x1e0,0x240,0x2a0,0x300,0x360,0x3c0,4,4,4,4,4,4,4,4,4,4,4,4,4,4,4,4,4
.long 0x501d,0x1054,0x1842015,0x16,0,0x60,0xc0,0x120,0x180,0x1e0,0x240,0x2a0,0x300,0x360,0x3c0,4,4,4,4,4,4,4,4,4,4,4,4,4,4,4,4,4
.long 0x502d,0x1054,0x1842025,0x26,0,0x60,0xc0,0x120,0x180,0x1e0,0x240,0x2a0,0x300,0x360,0x3c0,4,4,4,4,4,4,4,4,4,4,4,4,4,4,4,4,4
.long 0x503d,0x1054,0x1842035,0x36,0,0x60,0xc0,0x120,0x180,0x1e0,0x240,0x2a0,0x300,0x360,0x3c0,4,4,4,4,4,4,4,4,4,4,4,4,4,4,4,4,4
.long 0x600d,0x76543210,0x1e,0x300,0x340,0x380,0x3c0,4,4,4,4,4,4,4,4,4,4,4,4,4,4,4,4,4,4,4,4,4,4,4,4,4
.long 0x601d,0x76543210,0x1e,0x1300,0x1340,0x1380,0x13c0,4,4,4,4,4,4,4,4,4,4,4,4,4,4,4,4,4,4,4,4,4,4,4,4,4
.long 0x602d,0x76543210,0x1e,0x2300,0x2340,0x2380,0x23c0,4,4,4,4,4,4,4,4,4,4,4,4,4,4,4,4,4,4,4,4,4,4,4,4,4
.long 0x603d,0x76543210,0x1e,0x3300,0x3340,0x3380,0x33c0,4,4,4,4,4,4,4,4,4,4,4,4,4,4,4,4,4,4,4,4,4,4,4,4,4
.long 0x4d,0x10,0x1047045,0xe,0x4000,0x40c0,0x1e,0x4180,0x4240,4,4,4,4,4,4,4,4,4,4,4,4,4,4,4,4,4,4,4,4,4,4,4
.long 0x5d,0x10,0x1047055,0xe,0x5000,0x50c0,0x1e,0x5180,0x5240,4,4,4,4,4,4,4,4,4,4,4,4,4,4,4,4,4,4,4,4,4,4,4
.long 0x6d,0x10,0x1047065,0xe,0x6000,0x60c0,0x1e,0x6180,0x6240,4,4,4,4,4,4,4,4,4,4,4,4,4,4,4,4,4,4,4,4,4,4,4
.long 0x7d,0x10,0x1047075,0xe,0x7000,0x70c0,0x1e,0x7180,0x7240,4,4,4,4,4,4,4,4,4,4,4,4,4,4,4,4,4,4,4,4,4,4,4
.long 0x104d,0x32,0x846045,0x46,0x20,0x80,0xe0,0x140,0x1a0,0x200,0x260,0x2c0,0x320,0x380,0x3e0,4,4,4,4,4,4,4,4,4,4,4,4,4,4,4,4,4
.long 0x105d,0x32,0x846055,0x56,0x20,0x80,0xe0,0x140,0x1a0,0x200,0x260,0x2c0,0x320,0x380,0x3e0,4,4,4,4,4,4,4,4,4,4,4,4,4,4,4,4,4
.long 0x106d,0x32,0x846065,0x66,0x20,0x80,0xe0,0x140,0x1a0,0x200,0x260,0x2c0,0x320,0x380,0x3e0,4,4,4,4,4,4,4,4,4,4,4,4,4,4,4,4,4
.long 0x107d,0x32,0x846075,0x76,0x20,0x80,0xe0,0x140,0x1a0,0x200,0x260,0x2c0,0x320,0x380,0x3e0,4,4,4,4,4,4,4,4,4,4,4,4,4,4,4,4,4
.long 0x204d,0x54,0x1055045,0x1850045,0xe,0x4010,0x40d0,0x1e,0x4190,0x4250,4,4,4,4,4,4,4,4,4,4,4,4,4,4,4,4,4,4,4,4,4,4
.long 0x205d,0x54,0x1055055,0x1850055,0xe,0x5010,0x50d0,0x1e,0x5190,0x5250,4,4,4,4,4,4,4,4,4,4,4,4,4,4,4,4,4,4,4,4,4,4
.long 0x206d,0x54,0x1055065,0x1850065,0xe,0x6010,0x60d0,0x1e,0x6190,0x6250,4,4,4,4,4,4,4,4,4,4,4,4,4,4,4,4,4,4,4,4,4,4
.long 0x207d,0x54,0x1055075,0x1850075,0xe,0x7010,0x70d0,0x1e,0x7190,0x7250,4,4,4,4,4,4,4,4,4,4,4,4,4,4,4,4,4,4,4,4,4,4
.long 0x304d,0x76,0x854045,0x2051045,0xe,0x4020,0x40e0,0x1e,0x41a0,0x4260,4,4,4,4,4,4,4,4,4,4,4,4,4,4,4,4,4,4,4,4,4,4
.long 0x305d,0x76,0x854055,0x2051055,0xe,0x5020,0x50e0,0x1e,0x51a0,0x5260,4,4,4,4,4,4,4,4,4,4,4,4,4,4,4,4,4,4,4,4,4,4
.long 0x306d,0x76,0x854065,0x2051065,0xe,0x6020,0x60e0,0x1e,0x61a0,0x6260,4,4,4,4,4,4,4,4,4,4,4,4,4,4,4,4,4,4,4,4,4,4
.long 0x307d,0x76,0x854075,0x2051075,0xe,0x7020,0x70e0,0x1e,0x71a0,0x7260,4,4,4,4,4,4,4,4,4,4,4,4,4,4,4,4,4,4,4,4,4,4
.long 0x404d,0x3276,0x2043045,0x46,0x40,0xa0,0x100,0x160,0x1c0,0x220,0x280,0x2e0,0x340,0x3a0,4,4,4,4,4,4,4,4,4,4,4,4,4,4,4,4,4,4
.long 0x405d,0x3276,0x2043055,0x56,0x40,0xa0,0x100,0x160,0x1c0,0x220,0x280,0x2e0,0x340,0x3a0,4,4,4,4,4,4,4,4,4,4,4,4,4,4,4,4,4,4
.long 0x406d,0x3276,0x2043065,0x66,0x40,0xa0,0x100,0x160,0x1c0,0x220,0x280,0x2e0,0x340,0x3a0,4,4,4,4,4,4,4,4,4,4,4,4,4,4,4,4,4,4
.long 0x407d,0x3276,0x2043075,0x76,0x40,0xa0,0x100,0x160,0x1c0,0x220,0x280,0x2e0,0x340,0x3a0,4,4,4,4,4,4,4,4,4,4,4,4,4,4,4,4,4,4
.long 0x504d,0x1054,0x1842045,0x46,0,0x60,0xc0,0x120,0x180,0x1e0,0x240,0x2a0,0x300,0x360,0x3c0,4,4,4,4,4,4,4,4,4,4,4,4,4,4,4,4,4
.long 0x505d,0x1054,0x1842055,0x56,0,0x60,0xc0,0x120,0x180,0x1e0,0x240,0x2a0,0x300,0x360,0x3c0,4,4,4,4,4,4,4,4,4,4,4,4,4,4,4,4,4
.long 0x506d,0x1054,0x1842065,0x66,0,0x60,0xc0,0x120,0x180,0x1e0,0x240,0x2a0,0x300,0x360,0x3c0,4,4,4,4,4,4,4,4,4,4,4,4,4,4,4,4,4
.long 0x507d,0x1054,0x1842075,0x76,0,0x60,0xc0,0x120,0x180,0x1e0,0x240,0x2a0,0x300,0x360,0x3c0,4,4,4,4,4,4,4,4,4,4,4,4,4,4,4,4,4
.long 0x604d,0x76543210,0x1e,0x4300,0x4340,0x4380,0x43c0,4,4,4,4,4,4,4,4,4,4,4,4,4,4,4,4,4,4,4,4,4,4,4,4,4
.long 0x605d,0x76543210,0x1e,0x5300,0x5340,0x5380,0x53c0,4,4,4,4,4,4,4,4,4,4,4,4,4,4,4,4,4,4,4,4,4,4,4,4,4
.long 0x606d,0x76543210,0x1e,0x6300,0x6340,0x6380,0x63c0,4,4,4,4,4,4,4,4,4,4,4,4,4,4,4,4,4,4,4,4,4,4,4,4,4
.long 0x607d,0x76543210,0x1e,0x7300,0x7340,0x7380,0x73c0,4,4,4,4,4,4,4,4,4,4,4,4,4,4,4,4,4,4,4,4,4,4,4,4,4
.long 0x8d,0x10,0x1047085,0xe,0x30,0xf0,0x1e,0x1b0,0x270,4,4,4,4,4,4,4,4,4,4,4,4,4,4,4,4,4,4,4,4,4,4,4
.long 0x9d,0x10,0x1047095,0xe,0x1030,0x10f0,0x1e,0x11b0,0x1270,4,4,4,4,4,4,4,4,4,4,4,4,4,4,4,4,4,4,4,4,4,4,4
.long 0xad,0x10,0x10470a5,0xe,0x2030,0x20f0,0x1e,0x21b0,0x2270,4,4,4,4,4,4,4,4,4,4,4,4,4,4,4,4,4,4,4,4,4,4,4
.long 0xbd,0x10,0x10470b5,0xe,0x3030,0x30f0,0x1e,0x31b0,0x3270,4,4,4,4,4,4,4,4,4,4,4,4,4,4,4,4,4,4,4,4,4,4,4
.long 0x108d,0x32,0x846085,0x86,0x20,0x80,0xe0,0x140,0x1a0,0x200,0x260,0x2c0,0x320,0x380,0x3e0,4,4,4,4,4,4,4,4,4,4,4,4,4,4,4,4,4
.long 0x109d,0x32,0x846095,0x96,0x20,0x80,0xe0,0x140,0x1a0,0x200,0x260,0x2c0,0x320,0x380,0x3e0,4,4,4,4,4,4,4,4,4,4,4,4,4,4,4,4,4
.long 0x10ad,0x32,0x8460a5,0xa6,0x20,0x80,0xe0,0x140,0x1a0,0x200,0x260,0x2c0,0x320,0x380,0x3e0,4,4,4,4,4,4,4,4,4,4,4,4,4,4,4,4,4
.long 0x10bd,0x32,0x8460b5,0xb6,0x20,0x80,0xe0,0x140,0x1a0,0x200,0x260,0x2c0,0x320,0x380,0x3e0,4,4,4,4,4,4,4,4,4,4,4,4,4,4,4,4,4
.long 0x208d,0x54,0x1055085,0x1850085,0xe,0x40,0x100,0x1e,0x1c0,0x280,4,4,4,4,4,4,4,4,4,4,4,4,4,4,4,4,4,4,4,4,4,4
.long 0x209d,0x54,0x1055095,0x1850095,0xe,0x1040,0x1100,0x1e,0x11c0,0x1280,4,4,4,4,4,4,4,4,4,4,4,4,4,4,4,4,4,4,4,4,4,4
.long 0x20ad,0x54,0x10550a5,0x18500a5,0xe,0x2040,0x2100,0x1e,0x21c0,0x2280,4,4,4,4,4,4,4,4,4,4,4,4,4,4,4,4,4,4,4,4,4,4
.long 0x20bd,0x54,0x10550b5,0x18500b5,0xe,0x3040,0x3100,0x1e,0x31c0,0x3280,4,4,4,4,4,4,4,4,4,4,4,4,4,4,4,4,4,4,4,4,4,4
.long 0x308d,0x76,0x854085,0x2051085,0xe,0x50,0x110,0x1e,0x1d0,0x290,4,4,4,4,4,4,4,4,4,4,4,4,4,4,4,4,4,4,4,4,4,4
.long 0x309d,0x76,0x854095,0x2051095,0xe,0x1050,0x1110,0x1e,0x11d0,0x1290,4,4,4,4,4,4,4,4,4,4,4,4,4,4,4,4,4,4,4,4,4,4
.long 0x30ad,0x76,0x8540a5,0x20510a5,0xe,0x2050,0x2110,0x1e,0x21d0,0x2290,4,4,4,4,4,4,4,4,4,4,4,4,4,4,4,4,4,4,4,4,4,4
.long 0x30bd,0x76,0x8540b5,0x20510b5,0xe,0x3050,0x3110,0x1e,0x31d0,0x3290,4,4,4,4,4,4,4,4,4,4,4,4,4,4,4,4,4,4,4,4,4,4
.long 0x408d,0x3276,0x2043085,0x86,0x40,0xa0,0x100,0x160,0x1c0,0x220,0x280,0x2e0,0x340,0x3a0,4,4,4,4,4,4,4,4,4,4,4,4,4,4,4,4,4,4
.long 0x409d,0x3276,0x2043095,0x96,0x40,0xa0,0x100,0x160,0x1c0,0x220,0x280,0x2e0,0x340,0x3a0,4,4,4,4,4,4,4,4,4,4,4,4,4,4,4,4,4,4
.long 0x40ad,0x3276,0x20430a5,0xa6,0x40,0xa0,0x100,0x160,0x1c0,0x220,0x280,0x2e0,0x340,0x3a0,4,4,4,4,4,4,4,4,4,4,4,4,4,4,4,4,4,4
.long 0x40bd,0x3276,0x20430b5,0xb6,0x40,0xa0,0x100,0x160,0x1c0,0x220,0x280,0x2e0,0x340,0x3a0,4,4,4,4,4,4,4,4,4,4,4,4,4,4,4,4,4,4
.long 0x508d,0x1054,0x1842085,0x86,0,0x60,0xc0,0x120,0x180,0x1e0,0x240,0x2a0,0x300,0x360,0x3c0,4,4,4,4,4,4,4,4,4,4,4,4,4,4,4,4,4
.long 0x509d,0x1054,0x1842095,0x96,0,0x60,0xc0,0x120,0x180,0x1e0,0x240,0x2a0,0x300,0x360,0x3c0,4,4,4,4,4,4,4,4,4,4,4,4,4,4,4,4,4
.long 0x50ad,0x1054,0x18420a5,0xa6,0,0x60,0xc0,0x120,0x180,0x1e0,0x240,0x2a0,0x300,0x360,0x3c0,4,4,4,4,4,4,4,4,4,4,4,4,4,4,4,4,4
.long 0x50bd,0x1054,0x18420b5,0xb6,0,0x60,0xc0,0x120,0x180,0x1e0,0x240,0x2a0,0x300,0x360,0x3c0,4,4,4,4,4,4,4,4,4,4,4,4,4,4,4,4,4
.long 0x608d,0x76543210,0x1e,0x310,0x350,0x390,0x3d0,4,4,4,4,4,4,4,4,4,4,4,4,4,4,4,4,4,4,4,4,4,4,4,4,4
.long 0x609d,0x76543210,0x1e,0x1310,0x1350,0x1390,0x13d0,4,4,4,4,4,4,4,4,4,4,4,4,4,4,4,4,4,4,4,4,4,4,4,4,4
.long 0x60ad,0x76543210,0x1e,0x2310,0x2350,0x2390,0x23d0,4,4,4,4,4,4,4,4,4,4,4,4,4,4,4,4,4,4,4,4,4,4,4,4,4
.long 0x60bd,0x76543210,0x1e,0x3310,0x3350,0x3390,0x33d0,4,4,4,4,4,4,4,4,4,4,4,4,4,4,4,4,4,4,4,4,4,4,4,4,4
.long 0xcd,0x10,0x10470c5,0xe,0x4030,0x40f0,0x1e,0x41b0,0x4270,4,4,4,4,4,4,4,4,4,4,4,4,4,4,4,4,4,4,4,4,4,4,4
.long 0xdd,0x10,0x10470d5,0xe,0x5030,0x50f0,0x1e,0x51b0,0x5270,4,4,4,4,4,4,4,4,4,4,4,4,4,4,4,4,4,4,4,4,4,4,4
.long 0xed,0x10,0x10470e5,0xe,0x6030,0x60f0,0x1e,0x61b0,0x6270,4,4,4,4,4,4,4,4,4,4,4,4,4,4,4,4,4,4,4,4,4,4,4
.long 0xfd,0x10,0x10470f5,0xe,0x7030,0x70f0,0x1e,0x71b0,0x7270,4,4,4,4,4,4,4,4,4,4,4,4,4,4,4,4,4,4,4,4,4,4,4
.long 0x10cd,0x32,0x8460c5,0xc6,0x20,0x80,0xe0,0x140,0x1a0,0x200,0x260,0x2c0,0x320,0x380,0x3e0,4,4,4,4,4,4,4,4,4,4,4,4,4,4,4,4,4
.long 0x10dd,0x32,0x8460d5,0xd6,0x20,0x80,0xe0,0x140,0x1a0,0x200,0x260,0x2c0,0x320,0x380,0x3e0,4,4,4,4,4,4,4,4,4,4,4,4,4,4,4,4,4
.long 0x10ed,0x32,0x8460e5,0xe6,0x20,0x80,0xe0,0x140,0x1a0,0x200,0x260,0x2c0,0x320,0x380,0x3e0,4,4,4,4,4,4,4,4,4,4,4,4,4,4,4,4,4
.long 0x10fd,0x32,0x8460f5,0xf6,0x20,0x80,0xe0,0x140,0x1a0,0x200,0x260,0x2c0,0x320,0x380,0x3e0,4,4,4,4,4,4,4,4,4,4,4,4,4,4,4,4,4
.long 0x20cd,0x54,0x10550c5,0x18500c5,0xe,0x4040,0x4100,0x1e,0x41c0,0x4280,4,4,4,4,4,4,4,4,4,4,4,4,4,4,4,4,4,4,4,4,4,4
.long 0x20dd,0x54,0x10550d5,0x18500d5,0xe,0x5040,0x5100,0x1e,0x51c0,0x5280,4,4,4,4,4,4,4,4,4,4,4,4,4,4,4,4,4,4,4,4,4,4
.long 0x20ed,0x54,0x10550e5,0x18500e5,0xe,0x6040,0x6100,0x1e,0x61c0,0x6280,4,4,4,4,4,4,4,4,4,4,4,4,4,4,4,4,4,4,4,4,4,4
.long 0x20fd,0x54,0x10550f5,0x18500f5,0xe,0x7040,0x7100,0x1e,0x71c0,0x7280,4,4,4,4,4,4,4,4,4,4,4,4,4,4,4,4,4,4,4,4,4,4
.long 0x30cd,0x76,0x8540c5,0x20510c5,0xe,0x4050,0x4110,0x1e,0x41d0,0x4290,4,4,4,4,4,4,4,4,4,4,4,4,4,4,4,4,4,4,4,4,4,4
.long 0x30dd,0x76,0x8540d5,0x20510d5,0xe,0x5050,0x5110,0x1e,0x51d0,0x5290,4,4,4,4,4,4,4,4,4,4,4,4,4,4,4,4,4,4,4,4,4,4
.long 0x30ed,0x76,0x8540e5,0x20510e5,0xe,0x6050,0x6110,0x1e,0x61d0,0x6290,4,4,4,4,4,4,4,4,4,4,4,4,4,4,4,4,4,4,4,4,4,4
.long 0x30fd,0x76,0x8540f5,0x20510f5,0xe,0x7050,0x7110,0x1e,0x71d0,0x7290,4,4,4,4,4,4,4,4,4,4,4,4,4,4,4,4,4,4,4,4,4,4
.long 0x40cd,0x3276,0x20430c5,0xc6,0x40,0xa0,0x100,0x160,0x1c0,0x220,0x280,0x2e0,0x340,0x3a0,4,4,4,4,4,4,4,4,4,4,4,4,4,4,4,4,4,4
.long 0x40dd,0x3276,0x20430d5,0xd6,0x40,0xa0,0x100,0x160,0x1c0,0x220,0x280,0x2e0,0x340,0x3a0,4,4,4,4,4,4,4,4,4,4,4,4,4,4,4,4,4,4
.long 0x40ed,0x3276,0x20430e5,0xe6,0x40,0xa0,0x100,0x160,0x1c0,0x220,0x280,0x2e0,0x340,0x3a0,4,4,4,4,4,4,4,4,4,4,4,4,4,4,4,4,4,4
.long 0x40fd,0x3276,0x20430f5,0xf6,0x40,0xa0,0x100,0x160,0x1c0,0x220,0x280,0x2e0,0x340,0x3a0,4,4,4,4,4,4,4,4,4,4,4,4,4,4,4,4,4,4
.long 0x50cd,0x1054,0x18420c5,0xc6,0,0x60,0xc0,0x120,0x180,0x1e0,0x240,0x2a0,0x300,0x360,0x3c0,4,4,4,4,4,4,4,4,4,4,4,4,4,4,4,4,4
.long 0x50dd,0x1054,0x18420d5,0xd6,0,0x60,0xc0,0x120,0x180,0x1e0,0x240,0x2a0,0x300,0x360,0x3c0,4,4,4,4,4,4,4,4,4,4,4,4,4,4,4,4,4
.long 0x50ed,0x1054,0x18420e5,0xe6,0,0x60,0xc0,0x120,0x180,0x1e0,0x240,0x2a0,0x300,0x360,0x3c0,4,4,4,4,4,4,4,4,4,4,4,4,4,4,4,4,4
.long 0x50fd,0x1054,0x18420f5,0xf6,0,0x60,0xc0,0x120,0x180,0x1e0,0x240,0x2a0,0x300,0x360,0x3c0,4,4,4,4,4,4,4,4,4,4,4,4,4,4,4,4,4
.long 0x60cd,0x76543210,0x1e,0x4310,0x4350,0x4390,0x43d0,4,4,4,4,4,4,4,4,4,4,4,4,4,4,4,4,4,4,4,4,4,4,4,4,4
.long 0x60dd,0x76543210,0x1e,0x5310,0x5350,0x5390,0x53d0,4,4,4,4,4,4,4,4,4,4,4,4,4,4,4,4,4,4,4,4,4,4,4,4,4
.long 0x60ed,0x76543210,0x1e,0x6310,0x6350,0x6390,0x63d0,4,4,4,4,4,4,4,4,4,4,4,4,4,4,4,4,4,4,4,4,4,4,4,4,4
.long 0x60fd,0x76543210,0x1e,0x7310,0x7350,0x7390,0x73d0,4,4,4,4,4,4,4,4,4,4,4,4,4,4,4,4,4,4,4,4,4,4,4,4,4
.long 0x10d,0x10,0x1047105,0xe,0x60,0x120,0x1e,0x1e0,0x2a0,4,4,4,4,4,4,4,4,4,4,4,4,4,4,4,4,4,4,4,4,4,4,4
.long 0x11d,0x10,0x1047115,0xe,0x1060,0x1120,0x1e,0x11e0,0x12a0,4,4,4,4,4,4,4,4,4,4,4,4,4,4,4,4,4,4,4,4,4,4,4
.long 0x12d,0x10,0x1047125,0xe,0x2060,0x2120,0x1e,0x21e0,0x22a0,4,4,4,4,4,4,4,4,4,4,4,4,4,4,4,4,4,4,4,4,4,4,4
.long 0x13d,0x10,0x1047135,0xe,0x3060,0x3120,0x1e,0x31e0,0x32a0,4,4,4,4,4,4,4,4,4,4,4,4,4,4,4,4,4,4,4,4,4,4,4
.long 0x110d,0x32,0x846105,6,0x30,0x90,0xf0,0x150,0x1b0,0x210,0x270,0x2d0,0x330,0x390,0x3f0,4,4,4,4,4,4,4,4,4,4,4,4,4,4,4,4,4
.long 0x111d,0x32,0x846115,0x16,0x30,0x90,0xf0,0x150,0x1b0,0x210,0x270,0x2d0,0x330,0x390,0x3f0,4,4,4,4,4,4,4,4,4,4,4,4,4,4,4,4,4
.long 0x112d,0x32,0x846125,0x26,0x30,0x90,0xf0,0x150,0x1b0,0x210,0x270,0x2d0,0x330,0x390,0x3f0,4,4,4,4,4,4,4,4,4,4,4,4,4,4,4,4,4
.long 0x113d,0x32,0x846135,0x36,0x30,0x90,0xf0,0x150,0x1b0,0x210,0x270,0x2d0,0x330,0x390,0x3f0,4,4,4,4,4,4,4,4,4,4,4,4,4,4,4,4,4
.long 0x210d,0x54,0x1055105,0x1850105,0xe,0x70,0x130,0x1e,0x1f0,0x2b0,4,4,4,4,4,4,4,4,4,4,4,4,4,4,4,4,4,4,4,4,4,4
.long 0x211d,0x54,0x1055115,0x1850115,0xe,0x1070,0x1130,0x1e,0x11f0,0x12b0,4,4,4,4,4,4,4,4,4,4,4,4,4,4,4,4,4,4,4,4,4,4
.long 0x212d,0x54,0x1055125,0x1850125,0xe,0x2070,0x2130,0x1e,0x21f0,0x22b0,4,4,4,4,4,4,4,4,4,4,4,4,4,4,4,4,4,4,4,4,4,4
.long 0x213d,0x54,0x1055135,0x1850135,0xe,0x3070,0x3130,0x1e,0x31f0,0x32b0,4,4,4,4,4,4,4,4,4,4,4,4,4,4,4,4,4,4,4,4,4,4
.long 0x310d,0x76,0x854105,0x2051105,0xe,0x80,0x140,0x1e,0x200,0x2c0,4,4,4,4,4,4,4,4,4,4,4,4,4,4,4,4,4,4,4,4,4,4
.long 0x311d,0x76,0x854115,0x2051115,0xe,0x1080,0x1140,0x1e,0x1200,0x12c0,4,4,4,4,4,4,4,4,4,4,4,4,4,4,4,4,4,4,4,4,4,4
.long 0x312d,0x76,0x854125,0x2051125,0xe,0x2080,0x2140,0x1e,0x2200,0x22c0,4,4,4,4,4,4,4,4,4,4,4,4,4,4,4,4,4,4,4,4,4,4
.long 0x313d,0x76,0x854135,0x2051135,0xe,0x3080,0x3140,0x1e,0x3200,0x32c0,4,4,4,4,4,4,4,4,4,4,4,4,4,4,4,4,4,4,4,4,4,4
.long 0x410d,0x3276,0x2043105,6,0x50,0xb0,0x110,0x170,0x1d0,0x230,0x290,0x2f0,0x350,0x3b0,4,4,4,4,4,4,4,4,4,4,4,4,4,4,4,4,4,4
.long 0x411d,0x3276,0x2043115,0x16,0x50,0xb0,0x110,0x170,0x1d0,0x230,0x290,0x2f0,0x350,0x3b0,4,4,4,4,4,4,4,4,4,4,4,4,4,4,4,4,4,4
.long 0x412d,0x3276,0x2043125,0x26,0x50,0xb0,0x110,0x170,0x1d0,0x230,0x290,0x2f0,0x350,0x3b0,4,4,4,4,4,4,4,4,4,4,4,4,4,4,4,4,4,4
.long 0x413d,0x3276,0x2043135,0x36,0x50,0xb0,0x110,0x170,0x1d0,0x230,0x290,0x2f0,0x350,0x3b0,4,4,4,4,4,4,4,4,4,4,4,4,4,4,4,4,4,4
.long 0x510d,0x1054,0x1842105,6,0x10,0x70,0xd0,0x130,0x190,0x1f0,0x250,0x2b0,0x310,0x370,0x3d0,4,4,4,4,4,4,4,4,4,4,4,4,4,4,4,4,4
.long 0x511d,0x1054,0x1842115,0x16,0x10,0x70,0xd0,0x130,0x190,0x1f0,0x250,0x2b0,0x310,0x370,0x3d0,4,4,4,4,4,4,4,4,4,4,4,4,4,4,4,4,4
.long 0x512d,0x1054,0x1842125,0x26,0x10,0x70,0xd0,0x130,0x190,0x1f0,0x250,0x2b0,0x310,0x370,0x3d0,4,4,4,4,4,4,4,4,4,4,4,4,4,4,4,4,4
.long 0x513d,0x1054,0x1842135,0x36,0x10,0x70,0xd0,0x130,0x190,0x1f0,0x250,0x2b0,0x310,0x370,0x3d0,4,4,4,4,4,4,4,4,4,4,4,4,4,4,4,4,4
.long 0x610d,0x76543210,0x1e,0x320,0x360,0x3a0,0x3e0,4,4,4,4,4,4,4,4,4,4,4,4,4,4,4,4,4,4,4,4,4,4,4,4,4
.long 0x611d,0x76543210,0x1e,0x1320,0x1360,0x13a0,0x13e0,4,4,4,4,4,4,4,4,4,4,4,4,4,4,4,4,4,4,4,4,4,4,4,4,4
.long 0x612d,0x76543210,0x1e,0x2320,0x2360,0x23a0,0x23e0,4,4,4,4,4,4,4,4,4,4,4,4,4,4,4,4,4,4,4,4,4,4,4,4,4
.long 0x613d,0x76543210,0x1e,0x3320,0x3360,0x33a0,0x33e0,4,4,4,4,4,4,4,4,4,4,4,4,4,4,4,4,4,4,4,4,4,4,4,4,4
.long 0x14d,0x10,0x1047145,0xe,0x4060,0x4120,0x1e,0x41e0,0x42a0,4,4,4,4,4,4,4,4,4,4,4,4,4,4,4,4,4,4,4,4,4,4,4
.long 0x15d,0x10,0x1047155,0xe,0x5060,0x5120,0x1e,0x51e0,0x52a0,4,4,4,4,4,4,4,4,4,4,4,4,4,4,4,4,4,4,4,4,4,4,4
.long 0x16d,0x10,0x1047165,0xe,0x6060,0x6120,0x1e,0x61e0,0x62a0,4,4,4,4,4,4,4,4,4,4,4,4,4,4,4,4,4,4,4,4,4,4,4
.long 0x17d,0x10,0x1047175,0xe,0x7060,0x7120,0x1e,0x71e0,0x72a0,4,4,4,4,4,4,4,4,4,4,4,4,4,4,4,4,4,4,4,4,4,4,4
.long 0x114d,0x32,0x846145,0x46,0x30,0x90,0xf0,0x150,0x1b0,0x210,0x270,0x2d0,0x330,0x390,0x3f0,4,4,4,4,4,4,4,4,4,4,4,4,4,4,4,4,4
.long 0x115d,0x32,0x846155,0x56,0x30,0x90,0xf0,0x150,0x1b0,0x210,0x270,0x2d0,0x330,0x390,0x3f0,4,4,4,4,4,4,4,4,4,4,4,4,4,4,4,4,4
.long 0x116d,0x32,0x846165,0x66,0x30,0x90,0xf0,0x150,0x1b0,0x210,0x270,0x2d0,0x330,0x390,0x3f0,4,4,4,4,4,4,4,4,4,4,4,4,4,4,4,4,4
.long 0x117d,0x32,0x846175,0x76,0x30,0x90,0xf0,0x150,0x1b0,0x210,0x270,0x2d0,0x330,0x390,0x3f0,4,4,4,4,4,4,4,4,4,4,4,4,4,4,4,4,4
.long 0x214d,0x54,0x1055145,0x1850145,0xe,0x4070,0x4130,0x1e,0x41f0,0x42b0,4,4,4,4,4,4,4,4,4,4,4,4,4,4,4,4,4,4,4,4,4,4
.long 0x215d,0x54,0x1055155,0x1850155,0xe,0x5070,0x5130,0x1e,0x51f0,0x52b0,4,4,4,4,4,4,4,4,4,4,4,4,4,4,4,4,4,4,4,4,4,4
.long 0x216d,0x54,0x1055165,0x1850165,0xe,0x6070,0x6130,0x1e,0x61f0,0x62b0,4,4,4,4,4,4,4,4,4,4,4,4,4,4,4,4,4,4,4,4,4,4
.long 0x217d,0x54,0x1055175,0x1850175,0xe,0x7070,0x7130,0x1e,0x71f0,0x72b0,4,4,4,4,4,4,4,4,4,4,4,4,4,4,4,4,4,4,4,4,4,4
.long 0x314d,0x76,0x854145,0x2051145,0xe,0x4080,0x4140,0x1e,0x4200,0x42c0,4,4,4,4,4,4,4,4,4,4,4,4,4,4,4,4,4,4,4,4,4,4
.long 0x315d,0x76,0x854155,0x2051155,0xe,0x5080,0x5140,0x1e,0x5200,0x52c0,4,4,4,4,4,4,4,4,4,4,4,4,4,4,4,4,4,4,4,4,4,4
.long 0x316d,0x76,0x854165,0x2051165,0xe,0x6080,0x6140,0x1e,0x6200,0x62c0,4,4,4,4,4,4,4,4,4,4,4,4,4,4,4,4,4,4,4,4,4,4
.long 0x317d,0x76,0x854175,0x2051175,0xe,0x7080,0x7140,0x1e,0x7200,0x72c0,4,4,4,4,4,4,4,4,4,4,4,4,4,4,4,4,4,4,4,4,4,4
.long 0x414d,0x3276,0x2043145,0x46,0x50,0xb0,0x110,0x170,0x1d0,0x230,0x290,0x2f0,0x350,0x3b0,4,4,4,4,4,4,4,4,4,4,4,4,4,4,4,4,4,4
.long 0x415d,0x3276,0x2043155,0x56,0x50,0xb0,0x110,0x170,0x1d0,0x230,0x290,0x2f0,0x350,0x3b0,4,4,4,4,4,4,4,4,4,4,4,4,4,4,4,4,4,4
.long 0x416d,0x3276,0x2043165,0x66,0x50,0xb0,0x110,0x170,0x1d0,0x230,0x290,0x2f0,0x350,0x3b0,4,4,4,4,4,4,4,4,4,4,4,4,4,4,4,4,4,4
.long 0x417d,0x3276,0x2043175,0x76,0x50,0xb0,0x110,0x170,0x1d0,0x230,0x290,0x2f0,0x350,0x3b0,4,4,4,4,4,4,4,4,4,4,4,4,4,4,4,4,4,4
.long 0x514d,0x1054,0x1842145,0x46,0x10,0x70,0xd0,0x130,0x190,0x1f0,0x250,0x2b0,0x310,0x370,0x3d0,4,4,4,4,4,4,4,4,4,4,4,4,4,4,4,4,4
.long 0x515d,0x1054,0x1842155,0x56,0x10,0x70,0xd0,0x130,0x190,0x1f0,0x250,0x2b0,0x310,0x370,0x3d0,4,4,4,4,4,4,4,4,4,4,4,4,4,4,4,4,4
.long 0x516d,0x1054,0x1842165,0x66,0x10,0x70,0xd0,0x130,0x190,0x1f0,0x250,0x2b0,0x310,0x370,0x3d0,4,4,4,4,4,4,4,4,4,4,4,4,4,4,4,4,4
.long 0x517d,0x1054,0x1842175,0x76,0x10,0x70,0xd0,0x130,0x190,0x1f0,0x250,0x2b0,0x310,0x370,0x3d0,4,4,4,4,4,4,4,4,4,4,4,4,4,4,4,4,4
.long 0x614d,0x76543210,0x1e,0x4320,0x4360,0x43a0,0x43e0,4,4,4,4,4,4,4,4,4,4,4,4,4,4,4,4,4,4,4,4,4,4,4,4,4
.long 0x615d,0x76543210,0x1e,0x5320,0x5360,0x53a0,0x53e0,4,4,4,4,4,4,4,4,4,4,4,4,4,4,4,4,4,4,4,4,4,4,4,4,4
.long 0x616d,0x76543210,0x1e,0x6320,0x6360,0x63a0,0x63e0,4,4,4,4,4,4,4,4,4,4,4,4,4,4,4,4,4,4,4,4,4,4,4,4,4
.long 0x617d,0x76543210,0x1e,0x7320,0x7360,0x73a0,0x73e0,4,4,4,4,4,4,4,4,4,4,4,4,4,4,4,4,4,4,4,4,4,4,4,4,4
.long 0x18d,0x10,0x1047185,0xe,0x90,0x150,0x1e,0x210,0x2d0,4,4,4,4,4,4,4,4,4,4,4,4,4,4,4,4,4,4,4,4,4,4,4
.long 0x19d,0x10,0x1047195,0xe,0x1090,0x1150,0x1e,0x1210,0x12d0,4,4,4,4,4,4,4,4,4,4,4,4,4,4,4,4,4,4,4,4,4,4,4
.long 0x1ad,0x10,0x10471a5,0xe,0x2090,0x2150,0x1e,0x2210,0x22d0,4,4,4,4,4,4,4,4,4,4,4,4,4,4,4,4,4,4,4,4,4,4,4
.long 0x1bd,0x10,0x10471b5,0xe,0x3090,0x3150,0x1e,0x3210,0x32d0,4,4,4,4,4,4,4,4,4,4,4,4,4,4,4,4,4,4,4,4,4,4,4
.long 0x118d,0x32,0x846185,0x86,0x30,0x90,0xf0,0x150,0x1b0,0x210,0x270,0x2d0,0x330,0x390,0x3f0,4,4,4,4,4,4,4,4,4,4,4,4,4,4,4,4,4
.long 0x119d,0x32,0x846195,0x96,0x30,0x90,0xf0,0x150,0x1b0,0x210,0x270,0x2d0,0x330,0x390,0x3f0,4,4,4,4,4,4,4,4,4,4,4,4,4,4,4,4,4
.long 0x11ad,0x32,0x8461a5,0xa6,0x30,0x90,0xf0,0x150,0x1b0,0x210,0x270,0x2d0,0x330,0x390,0x3f0,4,4,4,4,4,4,4,4,4,4,4,4,4,4,4,4,4
.long 0x11bd,0x32,0x8461b5,0xb6,0x30,0x90,0xf0,0x150,0x1b0,0x210,0x270,0x2d0,0x330,0x390,0x3f0,4,4,4,4,4,4,4,4,4,4,4,4,4,4,4,4,4
.long 0x218d,0x54,0x1055185,0x1850185,0xe,0xa0,0x160,0x1e,0x220,0x2e0,4,4,4,4,4,4,4,4,4,4,4,4,4,4,4,4,4,4,4,4,4,4
.long 0x219d,0x54,0x1055195,0x1850195,0xe,0x10a0,0x1160,0x1e,0x1220,0x12e0,4,4,4,4,4,4,4,4,4,4,4,4,4,4,4,4,4,4,4,4,4,4
.long 0x21ad,0x54,0x10551a5,0x18501a5,0xe,0x20a0,0x2160,0x1e,0x2220,0x22e0,4,4,4,4,4,4,4,4,4,4,4,4,4,4,4,4,4,4,4,4,4,4
.long 0x21bd,0x54,0x10551b5,0x18501b5,0xe,0x30a0,0x3160,0x1e,0x3220,0x32e0,4,4,4,4,4,4,4,4,4,4,4,4,4,4,4,4,4,4,4,4,4,4
.long 0x318d,0x76,0x854185,0x2051185,0xe,0xb0,0x170,0x1e,0x230,0x2f0,4,4,4,4,4,4,4,4,4,4,4,4,4,4,4,4,4,4,4,4,4,4
.long 0x319d,0x76,0x854195,0x2051195,0xe,0x10b0,0x1170,0x1e,0x1230,0x12f0,4,4,4,4,4,4,4,4,4,4,4,4,4,4,4,4,4,4,4,4,4,4
.long 0x31ad,0x76,0x8541a5,0x20511a5,0xe,0x20b0,0x2170,0x1e,0x2230,0x22f0,4,4,4,4,4,4,4,4,4,4,4,4,4,4,4,4,4,4,4,4,4,4
.long 0x31bd,0x76,0x8541b5,0x20511b5,0xe,0x30b0,0x3170,0x1e,0x3230,0x32f0,4,4,4,4,4,4,4,4,4,4,4,4,4,4,4,4,4,4,4,4,4,4
.long 0x418d,0x3276,0x2043185,0x86,0x50,0xb0,0x110,0x170,0x1d0,0x230,0x290,0x2f0,0x350,0x3b0,4,4,4,4,4,4,4,4,4,4,4,4,4,4,4,4,4,4
.long 0x419d,0x3276,0x2043195,0x96,0x50,0xb0,0x110,0x170,0x1d0,0x230,0x290,0x2f0,0x350,0x3b0,4,4,4,4,4,4,4,4,4,4,4,4,4,4,4,4,4,4
.long 0x41ad,0x3276,0x20431a5,0xa6,0x50,0xb0,0x110,0x170,0x1d0,0x230,0x290,0x2f0,0x350,0x3b0,4,4,4,4,4,4,4,4,4,4,4,4,4,4,4,4,4,4
.long 0x41bd,0x3276,0x20431b5,0xb6,0x50,0xb0,0x110,0x170,0x1d0,0x230,0x290,0x2f0,0x350,0x3b0,4,4,4,4,4,4,4,4,4,4,4,4,4,4,4,4,4,4
.long 0x518d,0x1054,0x1842185,0x86,0x10,0x70,0xd0,0x130,0x190,0x1f0,0x250,0x2b0,0x310,0x370,0x3d0,4,4,4,4,4,4,4,4,4,4,4,4,4,4,4,4,4
.long 0x519d,0x1054,0x1842195,0x96,0x10,0x70,0xd0,0x130,0x190,0x1f0,0x250,0x2b0,0x310,0x370,0x3d0,4,4,4,4,4,4,4,4,4,4,4,4,4,4,4,4,4
.long 0x51ad,0x1054,0x18421a5,0xa6,0x10,0x70,0xd0,0x130,0x190,0x1f0,0x250,0x2b0,0x310,0x370,0x3d0,4,4,4,4,4,4,4,4,4,4,4,4,4,4,4,4,4
.long 0x51bd,0x1054,0x18421b5,0xb6,0x10,0x70,0xd0,0x130,0x190,0x1f0,0x250,0x2b0,0x310,0x370,0x3d0,4,4,4,4,4,4,4,4,4,4,4,4,4,4,4,4,4
.long 0x618d,0x76543210,0x1e,0x330,0x370,0x3b0,0x3f0,4,4,4,4,4,4,4,4,4,4,4,4,4,4,4,4,4,4,4,4,4,4,4,4,4
.long 0x619d,0x76543210,0x1e,0x1330,0x1370,0x13b0,0x13f0,4,4,4,4,4,4,4,4,4,4,4,4,4,4,4,4,4,4,4,4,4,4,4,4,4
.long 0x61ad,0x76543210,0x1e,0x2330,0x2370,0x23b0,0x23f0,4,4,4,4,4,4,4,4,4,4,4,4,4,4,4,4,4,4,4,4,4,4,4,4,4
.long 0x61bd,0x76543210,0x1e,0x3330,0x3370,0x33b0,0x33f0,4,4,4,4,4,4,4,4,4,4,4,4,4,4,4,4,4,4,4,4,4,4,4,4,4
.long 0x1cd,0x10,0x10471c5,0xe,0x4090,0x4150,0x1e,0x4210,0x42d0,4,4,4,4,4,4,4,4,4,4,4,4,4,4,4,4,4,4,4,4,4,4,4
.long 0x1dd,0x10,0x10471d5,0xe,0x5090,0x5150,0x1e,0x5210,0x52d0,4,4,4,4,4,4,4,4,4,4,4,4,4,4,4,4,4,4,4,4,4,4,4
.long 0x1ed,0x10,0x10471e5,0xe,0x6090,0x6150,0x1e,0x6210,0x62d0,4,4,4,4,4,4,4,4,4,4,4,4,4,4,4,4,4,4,4,4,4,4,4
.long 0x1fd,0x10,0x10471f5,0xe,0x7090,0x7150,0x1e,0x7210,0x72d0,4,4,4,4,4,4,4,4,4,4,4,4,4,4,4,4,4,4,4,4,4,4,4
.long 0x11cd,0x32,0x8461c5,0xc6,0x30,0x90,0xf0,0x150,0x1b0,0x210,0x270,0x2d0,0x330,0x390,0x3f0,4,4,4,4,4,4,4,4,4,4,4,4,4,4,4,4,4
.long 0x11dd,0x32,0x8461d5,0xd6,0x30,0x90,0xf0,0x150,0x1b0,0x210,0x270,0x2d0,0x330,0x390,0x3f0,4,4,4,4,4,4,4,4,4,4,4,4,4,4,4,4,4
.long 0x11ed,0x32,0x8461e5,0xe6,0x30,0x90,0xf0,0x150,0x1b0,0x210,0x270,0x2d0,0x330,0x390,0x3f0,4,4,4,4,4,4,4,4,4,4,4,4,4,4,4,4,4
.long 0x11fd,0x32,0x8461f5,0xf6,0x30,0x90,0xf0,0x150,0x1b0,0x210,0x270,0x2d0,0x330,0x390,0x3f0,4,4,4,4,4,4,4,4,4,4,4,4,4,4,4,4,4
.long 0x21cd,0x54,0x10551c5,0x18501c5,0xe,0x40a0,0x4160,0x1e,0x4220,0x42e0,4,4,4,4,4,4,4,4,4,4,4,4,4,4,4,4,4,4,4,4,4,4
.long 0x21dd,0x54,0x10551d5,0x18501d5,0xe,0x50a0,0x5160,0x1e,0x5220,0x52e0,4,4,4,4,4,4,4,4,4,4,4,4,4,4,4,4,4,4,4,4,4,4
.long 0x21ed,0x54,0x10551e5,0x18501e5,0xe,0x60a0,0x6160,0x1e,0x6220,0x62e0,4,4,4,4,4,4,4,4,4,4,4,4,4,4,4,4,4,4,4,4,4,4
.long 0x21fd,0x54,0x10551f5,0x18501f5,0xe,0x70a0,0x7160,0x1e,0x7220,0x72e0,4,4,4,4,4,4,4,4,4,4,4,4,4,4,4,4,4,4,4,4,4,4
.long 0x31cd,0x76,0x8541c5,0x20511c5,0xe,0x40b0,0x4170,0x1e,0x4230,0x42f0,4,4,4,4,4,4,4,4,4,4,4,4,4,4,4,4,4,4,4,4,4,4
.long 0x31dd,0x76,0x8541d5,0x20511d5,0xe,0x50b0,0x5170,0x1e,0x5230,0x52f0,4,4,4,4,4,4,4,4,4,4,4,4,4,4,4,4,4,4,4,4,4,4
.long 0x31ed,0x76,0x8541e5,0x20511e5,0xe,0x60b0,0x6170,0x1e,0x6230,0x62f0,4,4,4,4,4,4,4,4,4,4,4,4,4,4,4,4,4,4,4,4,4,4
.long 0x31fd,0x76,0x8541f5,0x20511f5,0xe,0x70b0,0x7170,0x1e,0x7230,0x72f0,4,4,4,4,4,4,4,4,4,4,4,4,4,4,4,4,4,4,4,4,4,4
.long 0x41cd,0x3276,0x20431c5,0xc6,0x50,0xb0,0x110,0x170,0x1d0,0x230,0x290,0x2f0,0x350,0x3b0,4,4,4,4,4,4,4,4,4,4,4,4,4,4,4,4,4,4
.long 0x41dd,0x3276,0x20431d5,0xd6,0x50,0xb0,0x110,0x170,0x1d0,0x230,0x290,0x2f0,0x350,0x3b0,4,4,4,4,4,4,4,4,4,4,4,4,4,4,4,4,4,4
.long 0x41ed,0x3276,0x20431e5,0xe6,0x50,0xb0,0x110,0x170,0x1d0,0x230,0x290,0x2f0,0x350,0x3b0,4,4,4,4,4,4,4,4,4,4,4,4,4,4,4,4,4,4
.long 0x41fd,0x3276,0x20431f5,0xf6,0x50,0xb0,0x110,0x170,0x1d0,0x230,0x290,0x2f0,0x350,0x3b0,4,4,4,4,4,4,4,4,4,4,4,4,4,4,4,4,4,4
.long 0x51cd,0x1054,0x18421c5,0xc6,0x10,0x70,0xd0,0x130,0x190,0x1f0,0x250,0x2b0,0x310,0x370,0x3d0,4,4,4,4,4,4,4,4,4,4,4,4,4,4,4,4,4
.long 0x51dd,0x1054,0x18421d5,0xd6,0x10,0x70,0xd0,0x130,0x190,0x1f0,0x250,0x2b0,0x310,0x370,0x3d0,4,4,4,4,4,4,4,4,4,4,4,4,4,4,4,4,4
.long 0x51ed,0x1054,0x18421e5,0xe6,0x10,0x70,0xd0,0x130,0x190,0x1f0,0x250,0x2b0,0x310,0x370,0x3d0,4,4,4,4,4,4,4,4,4,4,4,4,4,4,4,4,4
.long 0x51fd,0x1054,0x18421f5,0xf6,0x10,0x70,0xd0,0x130,0x190,0x1f0,0x250,0x2b0,0x310,0x370,0x3d0,4,4,4,4,4,4,4,4,4,4,4,4,4,4,4,4,4
.long 0x61cd,0x76543210,0x1e,0x4330,0x4370,0x43b0,0x43f0,4,4,4,4,4,4,4,4,4,4,4,4,4,4,4,4,4,4,4,4,4,4,4,4,4
.long 0x61dd,0x76543210,0x1e,0x5330,0x5370,0x53b0,0x53f0,4,4,4,4,4,4,4,4,4,4,4,4,4,4,4,4,4,4,4,4,4,4,4,4,4
.long 0x61ed,0x76543210,0x1e,0x6330,0x6370,0x63b0,0x63f0,4,4,4,4,4,4,4,4,4,4,4,4,4,4,4,4,4,4,4,4,4,4,4,4,4
.long 0x61fd,0x76543210,0x1e,0x7330,0x7370,0x73b0,0x73f0,4,4,4,4,4,4,4,4,4,4,4,4,4,4,4,4,4,4,4,4,4,4,4,4,4
.section .rodata,"a"
.p2align 6
.amdhsa_kernel gated_mix__compressed_kv_cla__memory_aug_recurrent_mem_tr__prompt_kernel
  .amdhsa_next_free_vgpr 512
  .amdhsa_next_free_sgpr 102
  .amdhsa_accum_offset 256
  .amdhsa_group_segment_fixed_size 0
  .amdhsa_kernarg_size 136
  .amdhsa_user_sgpr_count 2
  .amdhsa_user_sgpr_kernarg_segment_ptr 1
  .amdhsa_system_sgpr_workgroup_id_x 1
  .amdhsa_float_denorm_mode_32 3
.end_amdhsa_kernel
```
